```python
import torch

def _softmax(x, axis=-1):
    return torch.softmax(x, dim=axis)
def _gelu(x):
    return torch.nn.functional.gelu(x, approximate="tanh")
def _silu(x):
    return torch.nn.functional.silu(x)
def _sigmoid(x):
    return torch.sigmoid(x)
def _layernorm(x, axis=-1, eps=1e-5):
    m = x.mean(dim=axis, keepdim=True)
    v = x.var(dim=axis, keepdim=True, unbiased=False)
    return (x - m) / torch.sqrt(v + eps)
def _scatter_add(tgt, idx, src, axis=0):
    return tgt.clone().index_add_(axis, idx, src)
def _segment_sum(src, seg, n):
    out = torch.zeros((n,) + src.shape[1:], dtype=src.dtype)
    return out.index_add_(0, seg, src)
def _pad(x, pw):
    flat = tuple(v for pair in reversed(pw) for v in pair)
    return torch.nn.functional.pad(x, flat)

kernel_name = 'interleave_layers__linear_attn_block__glu_gated_geglu__prompt'

def setup_inputs():

    _w = (lambda a: (lambda t: t.to(torch.bfloat16) if t.is_floating_point() else t)(torch.as_tensor(a)))
    def _A_setup():
        B, S, D = 1, 2048, 576
        return {
            "x": _w((lambda *s: torch.randn(*s, dtype=torch.bfloat16) * 0.05)(B, S, D)),
            "wqkv": _w((lambda *s: torch.randn(*s, dtype=torch.bfloat16) * 0.05)(D, 3 * D)),
            "wo": _w((lambda *s: torch.randn(*s, dtype=torch.bfloat16) * 0.05)(D, D)),
        }
    _A_in = _A_setup()

    def _B_setup():
        B, S, Dm, Df = 1, 2048, 576, 4608
        return {
            "x": _w((lambda *s: torch.randn(*s, dtype=torch.bfloat16) * 0.05)(B, S, Dm)),
            "w_gate": _w((lambda *s: torch.randn(*s, dtype=torch.bfloat16) * 0.8)(Dm, Df) * (Dm ** -0.5)),
            "w_up": _w((lambda *s: torch.randn(*s, dtype=torch.bfloat16) * 0.8)(Dm, Df) * (Dm ** -0.5)),
            "w_down": _w((lambda *s: torch.randn(*s, dtype=torch.bfloat16) * 0.8)(Df, Dm) * (Df ** -0.5)),
        }
    _B_in = _B_setup()

    return {
        "A_x": _A_in["x"],
        "A_wqkv": _A_in["wqkv"],
        "A_wo": _A_in["wo"],
        "B_x": _B_in["x"],
        "B_w_gate": _B_in["w_gate"],
        "B_w_up": _B_in["w_up"],
        "B_w_down": _B_in["w_down"],
    }

def reference(A_x, A_wqkv, A_wo, B_x, B_w_gate, B_w_up, B_w_down):
    def _A_ref(x, wqkv, wo):
        B, S, D = x.shape
        H = 32; Dh = D // H
        qkv = (lambda x, *d: x.permute(*d))((x @ wqkv).reshape(B, S, 3, H, Dh), 2, 0, 3, 1, 4)
        q, k, v = qkv[0], qkv[1], qkv[2]
        phi = lambda t: torch.where(t > 0, t + 1, torch.exp(t)) + 1e-6
        pq, pk = phi(q), phi(k)
        kv = torch.einsum("bhsd,bhse->bhde", pk, v)
        z = torch.einsum("bhsd->bhd", pk)
        num = torch.einsum("bhqd,bhde->bhqe", pq, kv)
        den = torch.einsum("bhqd,bhd->bhq", pq, z)[..., None] + 1e-6
        o = num / den
        return (lambda x, *d: x.permute(*d))(o, 0, 2, 1, 3).reshape(B, S, D) @ wo

    def _B_ref(x, w_gate, w_up, w_down):
        g = torch.einsum("bsd,df->bsf", x, w_gate)
        u = torch.einsum("bsd,df->bsf", x, w_up)
        h = _gelu(g) * u
        return torch.einsum("bsf,fd->bsd", h, w_down)

    x = A_x
    x = x + _A_ref(_layernorm(x, axis=-1), A_wqkv, A_wo)
    x = x + _B_ref(_layernorm(x, axis=-1), B_w_gate, B_w_up, B_w_down)
    x = x + _A_ref(_layernorm(x, axis=-1), A_wqkv, A_wo)
    x = x + _B_ref(_layernorm(x, axis=-1), B_w_gate, B_w_up, B_w_down)
    return x
```

```asm
; @launch grid=(256,1,1) block=(256,1,1) lds=159744
.amdgcn_target "amdgcn-amd-amdhsa--gfx950"
.text
.globl interleave_layers__linear_attn_block__glu_gated_geglu__prompt_kernel
.p2align 8
.type interleave_layers__linear_attn_block__glu_gated_geglu__prompt_kernel,@function
interleave_layers__linear_attn_block__glu_gated_geglu__prompt_kernel:
    s_cmp_ge_u32 s2, 256
    s_cbranch_scc1 interleave_layers__linear_attn_block__glu_gated_geglu__prompt_kernel_end
    s_load_dwordx2 s[4:5], s[0:1], 72
    s_mov_b32 s6, 268435456
    s_mov_b32 s7, 0x00020000
    s_load_dwordx4 s[40:43], s[0:1], 0
    s_load_dwordx2 s[44:45], s[0:1], 16
    s_load_dwordx2 s[12:13], s[0:1], 32
    s_load_dwordx2 s[16:17], s[0:1], 40
    s_load_dwordx2 s[48:49], s[0:1], 64
    s_getpc_b64 s[60:61]
interleave_layers__linear_attn_block__glu_gated_geglu__prompt_kernel_pc0:
    s_lshr_b32 s62, s2, 3
    s_lshl_b32 s62, s62, 9
    v_and_b32 v142, 3, v0
    v_lshl_add_u32 v142, v142, 7, s62
    v_min_u32 v142, interleave_layers__linear_attn_block__glu_gated_geglu__prompt_kernel_end-interleave_layers__linear_attn_block__glu_gated_geglu__prompt_kernel_pc0-4, v142
    global_load_dword v143, v142, s[60:61]
    v_lshrrev_b32 v10, 6, v0
    v_and_b32 v1, 63, v0
    s_mov_b32 s11, 0x00020000
    s_mov_b32 s15, 0x00020000
    s_mov_b32 s19, 0x00020000
    s_mov_b32 s51, 0x00020000
    s_mov_b32 s50, 256
    v_readfirstlane_b32 s20, v10
    s_mov_b32 s14, 5308416
    s_mov_b32 s18, 5308416
    v_lshrrev_b32 v2, 4, v1
    v_bfe_u32 v3, v1, 2, 2
    v_and_b32 v4, 3, v1
    v_lshlrev_b32 v5, 4, v1
    v_mov_b32 v92, 0
    v_mov_b32 v93, 0
    v_mov_b32 v94, 0
    v_mov_b32 v95, 0
    s_and_b32 s21, s20, 1
    s_lshr_b32 s22, s20, 1
    s_mul_i32 s34, s20, 9216
    s_mov_b32 s53, 0
    s_mov_b32 s3, 1
    s_mov_b32 s52, 0
    v_mov_b32 v91, 0
    s_sub_u32 s25, s2, 0
    s_cmp_lt_u32 s2, 128
    s_cbranch_scc1 interleave_layers__linear_attn_block__glu_gated_geglu__prompt_kernel_ln
    s_sub_u32 s25, s2, 128
    s_cmp_lt_u32 s2, 200
    s_cbranch_scc1 interleave_layers__linear_attn_block__glu_gated_geglu__prompt_kernel_wq
    s_sub_u32 s25, s2, 200
    s_cmp_lt_u32 s2, 218
    s_cbranch_scc1 interleave_layers__linear_attn_block__glu_gated_geglu__prompt_kernel_wo
    s_sub_u32 s25, s2, 218
    s_cmp_lt_u32 s2, 250
    s_cbranch_scc1 interleave_layers__linear_attn_block__glu_gated_geglu__prompt_kernel_wx
    s_waitcnt lgkmcnt(0)
    s_cmp_lg_u32 s2, 255
    s_cbranch_scc1 interleave_layers__linear_attn_block__glu_gated_geglu__prompt_kernel_nzc
    v_lshlrev_b32 v6, 4, v0
    s_mov_b32 s31, 20119552
    v_mov_b32 v7, 1
    buffer_store_dwordx4 v[92:95], v6, s[4:7], s31 offen sc1
    s_addk_i32 s31, 4096
    buffer_store_dwordx4 v[92:95], v6, s[4:7], s31 offen sc1
    s_waitcnt vmcnt(0)
    s_barrier
    buffer_store_dword v7, off, s[48:51], 0 sc1
interleave_layers__linear_attn_block__glu_gated_geglu__prompt_kernel_nzc:
    s_cmp_lg_u32 s2, 254
    s_cbranch_scc1 interleave_layers__linear_attn_block__glu_gated_geglu__prompt_kernel_nzq
    v_lshlrev_b32 v6, 4, v0
    s_mov_b32 s31, 20054016
    s_mov_b32 s52, 20123648
    s_mov_b32 s53, 0xffff
    v_mov_b32 v91, 1
    buffer_store_dwordx4 v[92:95], v6, s[4:7], s31 offen sc1
    s_addk_i32 s31, 4096
    buffer_store_dwordx4 v[92:95], v6, s[4:7], s31 offen sc1
    s_addk_i32 s31, 4096
    buffer_store_dwordx4 v[92:95], v6, s[4:7], s31 offen sc1
    s_addk_i32 s31, 4096
    buffer_store_dwordx4 v[92:95], v6, s[4:7], s31 offen sc1
    s_addk_i32 s31, 4096
    buffer_store_dwordx4 v[92:95], v6, s[4:7], s31 offen sc1
    s_addk_i32 s31, 4096
    buffer_store_dwordx4 v[92:95], v6, s[4:7], s31 offen sc1
    s_addk_i32 s31, 4096
    buffer_store_dwordx4 v[92:95], v6, s[4:7], s31 offen sc1
    s_addk_i32 s31, 4096
    buffer_store_dwordx4 v[92:95], v6, s[4:7], s31 offen sc1
interleave_layers__linear_attn_block__glu_gated_geglu__prompt_kernel_nzq:
    s_getpc_b64 s[60:61]
interleave_layers__linear_attn_block__glu_gated_geglu__prompt_kernelidle_pc:
    s_add_u32 s60, s60, qkv0_part-interleave_layers__linear_attn_block__glu_gated_geglu__prompt_kernelidle_pc
    s_addc_u32 s61, s61, (qkv0_part-interleave_layers__linear_attn_block__glu_gated_geglu__prompt_kernelidle_pc)>>32
    s_bfe_u32 s62, s2, 0x50003
    s_lshl_b32 s62, s62, 12
    v_and_b32 v142, 31, v0
    v_lshl_add_u32 v142, v142, 7, s62
    v_min_u32 v142, qkv0_part_end-qkv0_part-4, v142
    global_load_dword v143, v142, s[60:61]
    buffer_load_dword v90, off, s[48:51], 0 sc1
    s_waitcnt vmcnt(0)
    s_barrier
    s_branch interleave_layers__linear_attn_block__glu_gated_geglu__prompt_kernel_join
interleave_layers__linear_attn_block__glu_gated_geglu__prompt_kernel_ln:
    s_mov_b32 s10, 2359296
    s_mul_i32 s23, s25, 18432
    s_lshl_b32 s29, s20, 6
    s_add_u32 s28, s23, s29
    s_cmp_lt_u32 s20, 2
    s_cselect_b32 s24, 0, 268435456
    s_add_u32 s29, s28, s24
    v_and_b32 v6, 15, v1
    v_mul_u32_u24 v7, 1152, v6
    v_lshl_add_u32 v7, v2, 4, v7
    s_waitcnt lgkmcnt(0)
    s_mov_b32 s8, s40
    s_mov_b32 s9, s41
    buffer_load_dwordx4 v[16:19], v7, s[8:11], s28 offen offset:0
    buffer_load_dwordx4 v[20:23], v7, s[8:11], s28 offen offset:256
    buffer_load_dwordx4 v[24:27], v7, s[8:11], s28 offen offset:512
    buffer_load_dwordx4 v[28:31], v7, s[8:11], s28 offen offset:768
    buffer_load_dwordx4 v[32:35], v7, s[8:11], s29 offen offset:1024
    s_getpc_b64 s[60:61]
interleave_layers__linear_attn_block__glu_gated_geglu__prompt_kernelln_pc:
    s_add_u32 s60, s60, qkv0_part-interleave_layers__linear_attn_block__glu_gated_geglu__prompt_kernelln_pc
    s_addc_u32 s61, s61, (qkv0_part-interleave_layers__linear_attn_block__glu_gated_geglu__prompt_kernelln_pc)>>32
    s_bfe_u32 s62, s2, 0x50003
    s_lshl_b32 s62, s62, 12
    v_and_b32 v142, 31, v0
    v_lshl_add_u32 v142, v142, 7, s62
    v_min_u32 v142, qkv0_part_end-qkv0_part-4, v142
    global_load_dword v143, v142, s[60:61]
    s_lshl_b32 s29, s20, 10
    s_add_u32 s30, s23, s29
    s_add_u32 s30, s30, 20971520
    s_lshr_b32 s29, s25, 3
    s_lshl_b32 s52, s29, 7
    s_add_u32 s52, s52, 20119552
    s_mul_i32 s29, s29, 4096
    s_add_u32 s30, s30, s29
    s_mov_b32 s53, 1
    v_mov_b32 v91, 9
    v_mov_b32 v8, 0
    v_mov_b32 v9, 0
    v_mov_b32 v11, 0x3f803f80
    s_waitcnt vmcnt(5)
    v_dot2c_f32_bf16 v8, v16, v11
    v_dot2c_f32_bf16 v9, v16, v16
    v_dot2c_f32_bf16 v8, v17, v11
    v_dot2c_f32_bf16 v9, v17, v17
    v_dot2c_f32_bf16 v8, v18, v11
    v_dot2c_f32_bf16 v9, v18, v18
    v_dot2c_f32_bf16 v8, v19, v11
    v_dot2c_f32_bf16 v9, v19, v19
    s_waitcnt vmcnt(4)
    v_dot2c_f32_bf16 v8, v20, v11
    v_dot2c_f32_bf16 v9, v20, v20
    v_dot2c_f32_bf16 v8, v21, v11
    v_dot2c_f32_bf16 v9, v21, v21
    v_dot2c_f32_bf16 v8, v22, v11
    v_dot2c_f32_bf16 v9, v22, v22
    v_dot2c_f32_bf16 v8, v23, v11
    v_dot2c_f32_bf16 v9, v23, v23
    s_waitcnt vmcnt(3)
    v_dot2c_f32_bf16 v8, v24, v11
    v_dot2c_f32_bf16 v9, v24, v24
    v_dot2c_f32_bf16 v8, v25, v11
    v_dot2c_f32_bf16 v9, v25, v25
    v_dot2c_f32_bf16 v8, v26, v11
    v_dot2c_f32_bf16 v9, v26, v26
    v_dot2c_f32_bf16 v8, v27, v11
    v_dot2c_f32_bf16 v9, v27, v27
    s_waitcnt vmcnt(2)
    v_dot2c_f32_bf16 v8, v28, v11
    v_dot2c_f32_bf16 v9, v28, v28
    v_dot2c_f32_bf16 v8, v29, v11
    v_dot2c_f32_bf16 v9, v29, v29
    v_dot2c_f32_bf16 v8, v30, v11
    v_dot2c_f32_bf16 v9, v30, v30
    v_dot2c_f32_bf16 v8, v31, v11
    v_dot2c_f32_bf16 v9, v31, v31
    s_waitcnt vmcnt(1)
    v_dot2c_f32_bf16 v8, v32, v11
    v_dot2c_f32_bf16 v9, v32, v32
    v_dot2c_f32_bf16 v8, v33, v11
    v_dot2c_f32_bf16 v9, v33, v33
    v_dot2c_f32_bf16 v8, v34, v11
    v_dot2c_f32_bf16 v9, v34, v34
    v_dot2c_f32_bf16 v8, v35, v11
    v_dot2c_f32_bf16 v9, v35, v35
    v_lshlrev_b32 v12, 3, v0
    v_lshlrev_b32 v13, 3, v1
    s_nop 0
    ds_write_b64 v12, v[8:9]
    v_lshlrev_b32 v40, 16, v16
    v_and_b32 v41, 0xffff0000, v16
    v_lshlrev_b32 v42, 16, v17
    v_and_b32 v43, 0xffff0000, v17
    v_lshlrev_b32 v44, 16, v18
    v_and_b32 v45, 0xffff0000, v18
    v_lshlrev_b32 v46, 16, v19
    v_and_b32 v47, 0xffff0000, v19
    v_lshlrev_b32 v48, 16, v20
    v_and_b32 v49, 0xffff0000, v20
    v_lshlrev_b32 v50, 16, v21
    v_and_b32 v51, 0xffff0000, v21
    v_lshlrev_b32 v52, 16, v22
    v_and_b32 v53, 0xffff0000, v22
    v_lshlrev_b32 v54, 16, v23
    v_and_b32 v55, 0xffff0000, v23
    v_lshlrev_b32 v56, 16, v24
    v_and_b32 v57, 0xffff0000, v24
    v_lshlrev_b32 v58, 16, v25
    v_and_b32 v59, 0xffff0000, v25
    v_lshlrev_b32 v60, 16, v26
    v_and_b32 v61, 0xffff0000, v26
    v_lshlrev_b32 v62, 16, v27
    v_and_b32 v63, 0xffff0000, v27
    v_lshlrev_b32 v64, 16, v28
    v_and_b32 v65, 0xffff0000, v28
    v_lshlrev_b32 v66, 16, v29
    v_and_b32 v67, 0xffff0000, v29
    v_lshlrev_b32 v68, 16, v30
    v_and_b32 v69, 0xffff0000, v30
    v_lshlrev_b32 v70, 16, v31
    v_and_b32 v71, 0xffff0000, v31
    v_lshlrev_b32 v72, 16, v32
    v_and_b32 v73, 0xffff0000, v32
    v_lshlrev_b32 v74, 16, v33
    v_and_b32 v75, 0xffff0000, v33
    v_lshlrev_b32 v76, 16, v34
    v_and_b32 v77, 0xffff0000, v34
    v_lshlrev_b32 v78, 16, v35
    v_and_b32 v79, 0xffff0000, v35
    s_waitcnt lgkmcnt(0)
    s_barrier
    ds_read_b64 v[16:17], v13 offset:0
    ds_read_b64 v[18:19], v13 offset:512
    ds_read_b64 v[20:21], v13 offset:1024
    ds_read_b64 v[22:23], v13 offset:1536
    s_waitcnt lgkmcnt(0)
    v_pk_add_f32 v[16:17], v[16:17], v[18:19]
    v_pk_add_f32 v[20:21], v[20:21], v[22:23]
    v_pk_add_f32 v[16:17], v[16:17], v[20:21]
    v_mov_b32 v18, v16
    v_mov_b32 v19, v17
    s_nop 1
    v_permlane32_swap_b32 v16, v18
    v_permlane32_swap_b32 v17, v19
    v_pk_add_f32 v[16:17], v[16:17], v[18:19]
    v_mov_b32 v18, v16
    v_mov_b32 v19, v17
    s_nop 1
    v_permlane16_swap_b32 v16, v18
    v_permlane16_swap_b32 v17, v19
    v_pk_add_f32 v[16:17], v[16:17], v[18:19]
    v_mul_f32 v14, 0xbae38e39, v16
    v_mul_f32 v15, 0xbae38e39, v16
    v_mul_f32 v17, 0x3ae38e39, v17
    v_fma_f32 v17, -v14, v14, v17
    v_max_f32 v17, 0, v17
    v_add_f32 v17, 0x3727c5ac, v17
    v_rsq_f32 v9, v17
    v_pk_add_f32 v[40:41], v[40:41], v[14:15]
    v_pk_add_f32 v[42:43], v[42:43], v[14:15]
    v_pk_add_f32 v[44:45], v[44:45], v[14:15]
    v_pk_add_f32 v[46:47], v[46:47], v[14:15]
    v_cvt_pk_bf16_f32 v16, v40, v41
    v_cvt_pk_bf16_f32 v17, v42, v43
    v_cvt_pk_bf16_f32 v18, v44, v45
    v_cvt_pk_bf16_f32 v19, v46, v47
    buffer_store_dwordx4 v[16:19], v5, s[4:7], s30 offen sc1
    s_add_u32 s30, s30, 4096
    v_pk_add_f32 v[48:49], v[48:49], v[14:15]
    v_pk_add_f32 v[50:51], v[50:51], v[14:15]
    v_pk_add_f32 v[52:53], v[52:53], v[14:15]
    v_pk_add_f32 v[54:55], v[54:55], v[14:15]
    v_cvt_pk_bf16_f32 v20, v48, v49
    v_cvt_pk_bf16_f32 v21, v50, v51
    v_cvt_pk_bf16_f32 v22, v52, v53
    v_cvt_pk_bf16_f32 v23, v54, v55
    buffer_store_dwordx4 v[20:23], v5, s[4:7], s30 offen sc1
    s_add_u32 s30, s30, 4096
    v_pk_add_f32 v[56:57], v[56:57], v[14:15]
    v_pk_add_f32 v[58:59], v[58:59], v[14:15]
    v_pk_add_f32 v[60:61], v[60:61], v[14:15]
    v_pk_add_f32 v[62:63], v[62:63], v[14:15]
    v_cvt_pk_bf16_f32 v24, v56, v57
    v_cvt_pk_bf16_f32 v25, v58, v59
    v_cvt_pk_bf16_f32 v26, v60, v61
    v_cvt_pk_bf16_f32 v27, v62, v63
    buffer_store_dwordx4 v[24:27], v5, s[4:7], s30 offen sc1
    s_add_u32 s30, s30, 4096
    v_pk_add_f32 v[64:65], v[64:65], v[14:15]
    v_pk_add_f32 v[66:67], v[66:67], v[14:15]
    v_pk_add_f32 v[68:69], v[68:69], v[14:15]
    v_pk_add_f32 v[70:71], v[70:71], v[14:15]
    v_cvt_pk_bf16_f32 v28, v64, v65
    v_cvt_pk_bf16_f32 v29, v66, v67
    v_cvt_pk_bf16_f32 v30, v68, v69
    v_cvt_pk_bf16_f32 v31, v70, v71
    buffer_store_dwordx4 v[28:31], v5, s[4:7], s30 offen sc1
    s_add_u32 s30, s30, 4096
    v_pk_add_f32 v[72:73], v[72:73], v[14:15]
    v_pk_add_f32 v[74:75], v[74:75], v[14:15]
    v_pk_add_f32 v[76:77], v[76:77], v[14:15]
    v_pk_add_f32 v[78:79], v[78:79], v[14:15]
    v_cvt_pk_bf16_f32 v32, v72, v73
    v_cvt_pk_bf16_f32 v33, v74, v75
    v_cvt_pk_bf16_f32 v34, v76, v77
    v_cvt_pk_bf16_f32 v35, v78, v79
    s_add_u32 s30, s30, s24
    buffer_store_dwordx4 v[32:35], v5, s[4:7], s30 offen sc1
    s_add_u32 s30, s30, 4096
    v_cmp_gt_u32 vcc, 16, v0
    v_lshlrev_b32 v12, 2, v0
    v_mov_b32 v13, 268435456
    v_sub_f32 v14, 0, v14
    v_cndmask_b32 v12, v13, v12, vcc
    s_lshl_b32 s31, s25, 6
    s_add_u32 s32, s31, 20840448
    s_add_u32 s31, s31, 20873216
    buffer_store_dword v9, v12, s[4:7], s32 offen sc1
    buffer_store_dword v14, v12, s[4:7], s31 offen sc1
    buffer_load_dword v90, off, s[48:51], 0 sc1
    s_waitcnt vmcnt(0)
    s_barrier
    s_branch interleave_layers__linear_attn_block__glu_gated_geglu__prompt_kernel_join
interleave_layers__linear_attn_block__glu_gated_geglu__prompt_kernel_wq:
    s_mov_b32 s10, 1990656
    s_and_b32 s23, s25, 3
    s_lshr_b32 s24, s25, 2
    s_mul_i32 s28, s24, 110592
    s_mul_i32 s29, s23, 288
    s_add_u32 s28, s28, s29
    s_lshl_b32 s34, s20, 10
    v_add_u32 v6, 0, v0
    v_mul_u32_u24 v7, 3641, v6
    v_lshrrev_b32 v7, 16, v7
    v_mul_u32_u24 v7, 864, v7
    v_lshl_add_u32 v16, v6, 4, v7
    v_add_u32 v6, 256, v0
    v_mul_u32_u24 v7, 3641, v6
    v_lshrrev_b32 v7, 16, v7
    v_mul_u32_u24 v7, 864, v7
    v_lshl_add_u32 v17, v6, 4, v7
    v_add_u32 v6, 512, v0
    v_mul_u32_u24 v7, 3641, v6
    v_lshrrev_b32 v7, 16, v7
    v_mul_u32_u24 v7, 864, v7
    v_lshl_add_u32 v18, v6, 4, v7
    v_add_u32 v6, 768, v0
    v_mul_u32_u24 v7, 3641, v6
    v_lshrrev_b32 v7, 16, v7
    v_mul_u32_u24 v7, 864, v7
    v_lshl_add_u32 v19, v6, 4, v7
    v_add_u32 v6, 1024, v0
    v_mul_u32_u24 v7, 3641, v6
    v_lshrrev_b32 v7, 16, v7
    v_mul_u32_u24 v7, 864, v7
    v_lshl_add_u32 v20, v6, 4, v7
    v_add_u32 v6, 1280, v0
    v_mul_u32_u24 v7, 3641, v6
    v_lshrrev_b32 v7, 16, v7
    v_mul_u32_u24 v7, 864, v7
    v_lshl_add_u32 v21, v6, 4, v7
    v_add_u32 v6, 1536, v0
    v_mul_u32_u24 v7, 3641, v6
    v_lshrrev_b32 v7, 16, v7
    v_mul_u32_u24 v7, 864, v7
    v_lshl_add_u32 v22, v6, 4, v7
    s_waitcnt lgkmcnt(0)
    s_mov_b32 s8, s42
    s_mov_b32 s9, s43
    s_add_u32 m0, s34, 0
    s_nop 0
    buffer_load_dwordx4 v16, s[8:11], s28 offen lds
    s_add_u32 m0, s34, 4096
    s_nop 0
    buffer_load_dwordx4 v17, s[8:11], s28 offen lds
    s_add_u32 m0, s34, 8192
    s_nop 0
    buffer_load_dwordx4 v18, s[8:11], s28 offen lds
    s_add_u32 m0, s34, 12288
    s_nop 0
    buffer_load_dwordx4 v19, s[8:11], s28 offen lds
    s_add_u32 m0, s34, 16384
    s_nop 0
    buffer_load_dwordx4 v20, s[8:11], s28 offen lds
    s_add_u32 m0, s34, 20480
    s_nop 0
    buffer_load_dwordx4 v21, s[8:11], s28 offen lds
    s_add_u32 m0, s34, 24576
    s_nop 0
    buffer_load_dwordx4 v22, s[8:11], s28 offen lds
    s_lshl_b32 s26, s24, 2
    s_add_u32 s26, s26, s20
    s_lshl_b32 s27, s26, 10
    s_mul_i32 s28, s23, 12288
    s_add_u32 s28, s28, 19988480
    s_cmp_lt_u32 s26, 12
    s_cselect_b32 s28, s28, 268435456
    s_add_u32 s28, s28, s27
    buffer_store_dwordx4 v[92:95], v5, s[4:7], s28 offen sc1
    s_getpc_b64 s[60:61]
interleave_layers__linear_attn_block__glu_gated_geglu__prompt_kernelwq_pc:
    s_add_u32 s60, s60, qkv0_part-interleave_layers__linear_attn_block__glu_gated_geglu__prompt_kernelwq_pc
    s_addc_u32 s61, s61, (qkv0_part-interleave_layers__linear_attn_block__glu_gated_geglu__prompt_kernelwq_pc)>>32
    s_bfe_u32 s62, s2, 0x50003
    s_lshl_b32 s62, s62, 12
    v_and_b32 v142, 31, v0
    v_lshl_add_u32 v142, v142, 7, s62
    v_min_u32 v142, qkv0_part_end-qkv0_part-4, v142
    global_load_dword v143, v142, s[60:61]
    s_lshl_b32 s30, s23, 2
    s_add_u32 s30, s30, s20
    s_mul_i32 s30, s30, 126
    s_mul_i32 s29, s24, 7
    s_add_u32 s30, s30, s29
    s_lshl_b32 s30, s30, 10
    s_add_u32 s30, s30, 16777216
    s_mul_i32 s29, s20, 72
    v_lshl_add_u32 v6, v2, 3, v3
    v_mul_u32_u24 v6, 864, v6
    v_add_u32 v6, s29, v6
    v_lshl_add_u32 v7, v4, 3, v6
    v_and_b32 v9, 1, v4
    v_cmp_eq_u32 vcc, 0, v9
    v_lshrrev_b32 v8, 1, v4
    v_add_u32 v8, 1, v8
    v_cndmask_b32 v8, 0, v8, vcc
    v_mul_u32_u24 v8, 288, v8
    v_add_u32 v8, v8, v6
    v_lshl_add_u32 v9, v4, 2, v3
    v_lshl_add_u32 v9, v2, 4, v9
    v_lshlrev_b32 v9, 4, v9
    s_add_u32 s31, s30, 4096
    s_lshl_b32 s52, s23, 9
    s_add_u32 s52, s52, 20121600
    s_mov_b32 s53, 15
    v_mov_b32 v91, 4
    s_waitcnt vmcnt(2)
    s_barrier
    ds_read_b64_tr_b16 v[16:17], v7 offset:0
    ds_read_b64_tr_b16 v[18:19], v7 offset:3456
    ds_read_b64_tr_b16 v[20:21], v7 offset:40
    ds_read_b64_tr_b16 v[22:23], v7 offset:3496
    ds_read_b64_tr_b16 v[24:25], v7 offset:288
    ds_read_b64_tr_b16 v[26:27], v7 offset:3744
    ds_read_b64_tr_b16 v[28:29], v7 offset:328
    ds_read_b64_tr_b16 v[30:31], v7 offset:3784
    ds_read_b64_tr_b16 v[32:33], v7 offset:576
    ds_read_b64_tr_b16 v[34:35], v7 offset:4032
    ds_read_b64_tr_b16 v[36:37], v7 offset:616
    ds_read_b64_tr_b16 v[38:39], v7 offset:4072
    ds_read_b64_tr_b16 v[40:41], v8 offset:32
    ds_read_b64_tr_b16 v[42:43], v8 offset:3488
    s_waitcnt lgkmcnt(12)
    buffer_store_dwordx4 v[16:19], v5, s[4:7], s30 offen offset:0 sc1
    s_waitcnt lgkmcnt(10)
    buffer_store_dwordx4 v[20:23], v5, s[4:7], s30 offen offset:1024 sc1
    s_waitcnt lgkmcnt(8)
    buffer_store_dwordx4 v[24:27], v5, s[4:7], s30 offen offset:2048 sc1
    v_lshrrev_b32 v9, 2, v9
    s_waitcnt lgkmcnt(0)
    ds_bpermute_b32 v40, v9, v40
    ds_bpermute_b32 v41, v9, v41
    ds_bpermute_b32 v42, v9, v42
    ds_bpermute_b32 v43, v9, v43
    buffer_store_dwordx4 v[28:31], v5, s[4:7], s30 offen offset:3072 sc1
    buffer_store_dwordx4 v[32:35], v5, s[4:7], s31 offen offset:0 sc1
    buffer_store_dwordx4 v[36:39], v5, s[4:7], s31 offen offset:1024 sc1
    s_waitcnt lgkmcnt(0)
    buffer_store_dwordx4 v[40:43], v5, s[4:7], s31 offen offset:2048 sc1
    buffer_load_dword v90, off, s[48:51], 0 sc1
    s_waitcnt vmcnt(0)
    s_barrier
    s_branch interleave_layers__linear_attn_block__glu_gated_geglu__prompt_kernel_join
interleave_layers__linear_attn_block__glu_gated_geglu__prompt_kernel_wo:
    s_mov_b32 s10, 663552
    s_mul_i32 s28, s25, 36
    s_lshl_b32 s29, s20, 3
    s_add_u32 s28, s28, s29
    s_lshl_b32 s29, s22, 2
    s_add_u32 s28, s28, s29
    s_and_b32 s29, s25, 1
    s_lshl_b32 s29, s29, 2
    s_add_u32 s29, s29, s20
    s_mul_i32 s29, s29, 72
    s_add_u32 s29, s29, 16
    s_cmp_lt_u32 s25, 16
    s_cselect_b32 s28, s28, s29
    s_cselect_b32 s32, 0, 36864
    s_cselect_b64 s[36:37], -1, 0
    s_mul_i32 s28, s28, 1152
    v_lshrrev_b32 v6, 5, v1
    v_mul_u32_u24 v6, s32, v6
    v_add_u32 v6, v6, v5
    v_add_u32 v7, s32, v5
    s_waitcnt lgkmcnt(0)
    s_mov_b32 s8, s44
    s_mov_b32 s9, s45
    v_lshrrev_b32 v8, 3, v0
    v_min_u32 v8, 1, v8
    v_lshl_add_u32 v8, v8, 28, v5
    s_lshl_b32 s31, s25, 7
    s_add_u32 s31, s31, 19922944
    buffer_store_dwordx4 v[92:95], v8, s[4:7], s31 offen sc1
    s_add_u32 m0, s34, 0
    s_add_u32 s31, s28, 0
    buffer_load_dwordx4 v5, s[8:11], s31 offen offset:0 lds
    buffer_load_dwordx4 v5, s[8:11], s31 offen offset:1024 lds
    buffer_load_dwordx4 v5, s[8:11], s31 offen offset:2048 lds
    buffer_load_dwordx4 v5, s[8:11], s31 offen offset:3072 lds
    s_add_u32 m0, s34, 4096
    s_add_u32 s31, s28, 4096
    buffer_load_dwordx4 v6, s[8:11], s31 offen offset:0 lds
    buffer_load_dwordx4 v7, s[8:11], s31 offen offset:1024 lds
    buffer_load_dwordx4 v7, s[8:11], s31 offen offset:2048 lds
    buffer_load_dwordx4 v7, s[8:11], s31 offen offset:3072 lds
    s_add_u32 m0, s34, 8192
    s_add_u32 s31, s28, 8192
    buffer_load_dwordx4 v7, s[8:11], s31 offen offset:0 lds
    s_and_b32 s26, s2, 7
    s_bfe_u32 s35, s2, 0x10003
    s_lshr_b32 s27, s2, 4
    s_mul_i32 s28, s27, 294912
    s_mul_i32 s29, s26, 1152
    s_add_u32 s28, s28, s29
    s_mul_i32 s29, s35, 576
    s_add_u32 s28, s28, s29
    s_cmp_lt_u32 s20, 2
    s_cselect_b32 s31, s28, 268435456
    v_add_u32 v6, 0, v0
    v_mul_u32_u24 v7, 1821, v6
    v_lshrrev_b32 v7, 16, v7
    v_mul_u32_u24 v8, 8640, v7
    v_lshl_add_u32 v8, v6, 4, v8
    buffer_load_dwordx4 v[196:199], v8, s[12:15], s28 offen
    buffer_load_dwordx4 v[200:203], v8, s[16:19], s28 offen
    v_mul_u32_u24 v236, 32, v7
    v_lshl_add_u32 v236, v6, 5, v236
    v_add_u32 v6, 256, v0
    v_mul_u32_u24 v7, 1821, v6
    v_lshrrev_b32 v7, 16, v7
    v_mul_u32_u24 v8, 8640, v7
    v_lshl_add_u32 v8, v6, 4, v8
    buffer_load_dwordx4 v[204:207], v8, s[12:15], s28 offen
    buffer_load_dwordx4 v[208:211], v8, s[16:19], s28 offen
    v_mul_u32_u24 v237, 32, v7
    v_lshl_add_u32 v237, v6, 5, v237
    v_add_u32 v6, 512, v0
    v_mul_u32_u24 v7, 1821, v6
    v_lshrrev_b32 v7, 16, v7
    v_mul_u32_u24 v8, 8640, v7
    v_lshl_add_u32 v8, v6, 4, v8
    buffer_load_dwordx4 v[212:215], v8, s[12:15], s28 offen
    buffer_load_dwordx4 v[216:219], v8, s[16:19], s28 offen
    v_mul_u32_u24 v238, 32, v7
    v_lshl_add_u32 v238, v6, 5, v238
    v_add_u32 v6, 768, v0
    v_mul_u32_u24 v7, 1821, v6
    v_lshrrev_b32 v7, 16, v7
    v_mul_u32_u24 v8, 8640, v7
    v_lshl_add_u32 v8, v6, 4, v8
    buffer_load_dwordx4 v[220:223], v8, s[12:15], s28 offen
    buffer_load_dwordx4 v[224:227], v8, s[16:19], s28 offen
    v_mul_u32_u24 v239, 32, v7
    v_lshl_add_u32 v239, v6, 5, v239
    v_add_u32 v6, 1024, v0
    v_mul_u32_u24 v7, 1821, v6
    v_lshrrev_b32 v7, 16, v7
    v_mul_u32_u24 v8, 8640, v7
    v_lshl_add_u32 v8, v6, 4, v8
    buffer_load_dwordx4 v[228:231], v8, s[12:15], s31 offen
    buffer_load_dwordx4 v[232:235], v8, s[16:19], s31 offen
    v_mul_u32_u24 v240, 32, v7
    v_lshl_add_u32 v240, v6, 5, v240
    s_cmp_ge_u32 s27, 9
    s_cselect_b32 s28, 18, 0
    s_add_u32 s33, s27, s28
    s_lshl_b32 s29, s26, 1
    s_add_u32 s29, s29, s35
    s_mul_i32 s29, s29, 253
    s_add_u32 s33, s33, s29
    s_lshl_b32 s33, s33, 2
    s_add_u32 s33, s33, s20
    s_lshl_b32 s33, s33, 10
    s_add_u32 s33, s33, 0
    s_getpc_b64 s[60:61]
interleave_layers__linear_attn_block__glu_gated_geglu__prompt_kernelwo_pc:
    s_add_u32 s60, s60, qkv0_part-interleave_layers__linear_attn_block__glu_gated_geglu__prompt_kernelwo_pc
    s_addc_u32 s61, s61, (qkv0_part-interleave_layers__linear_attn_block__glu_gated_geglu__prompt_kernelwo_pc)>>32
    s_bfe_u32 s62, s2, 0x50003
    s_lshl_b32 s62, s62, 12
    v_and_b32 v142, 31, v0
    v_lshl_add_u32 v142, v142, 7, s62
    v_min_u32 v142, qkv0_part_end-qkv0_part-4, v142
    global_load_dword v143, v142, s[60:61]
    s_mul_i32 s30, s20, 162
    s_mul_i32 s29, s25, 3
    s_add_u32 s30, s30, s29
    s_lshl_b32 s30, s30, 10
    s_add_u32 s30, s30, 18939904
    v_lshl_add_u32 v6, v2, 2, v3
    v_lshl_add_u32 v7, v3, 2, v2
    v_cndmask_b32 v6, v7, v6, s[36:37]
    v_mul_u32_u24 v6, 1152, v6
    s_mul_i32 s26, s20, 288
    v_add_u32 v6, s26, v6
    v_lshl_add_u32 v7, v4, 4, v6
    v_and_b32 v8, 1, v4
    v_lshl_add_u32 v8, v8, 4, v6
    v_lshrrev_b32 v9, 1, v4
    v_lshl_add_u32 v8, v9, 3, v8
    s_mov_b32 s52, 20123648
    s_mov_b32 s53, 0xffff
    v_mov_b32 v91, 1
    s_waitcnt vmcnt(11)
    s_barrier
    ds_read_b64_tr_b16 v[16:17], v7 offset:0
    ds_read_b64_tr_b16 v[18:19], v7 offset:18432
    ds_read_b64_tr_b16 v[20:21], v7 offset:8
    ds_read_b64_tr_b16 v[22:23], v7 offset:18440
    ds_read_b64_tr_b16 v[24:25], v8 offset:64
    ds_read_b64_tr_b16 v[26:27], v8 offset:18496
    ds_read_b64_tr_b16 v[28:29], v7 offset:96
    ds_read_b64_tr_b16 v[30:31], v7 offset:18528
    ds_read_b64_tr_b16 v[32:33], v7 offset:104
    ds_read_b64_tr_b16 v[34:35], v7 offset:18536
    ds_read_b64_tr_b16 v[36:37], v8 offset:160
    ds_read_b64_tr_b16 v[38:39], v8 offset:18592
    ds_read_b64_tr_b16 v[40:41], v7 offset:192
    ds_read_b64_tr_b16 v[42:43], v7 offset:18624
    s_waitcnt lgkmcnt(12)
    ds_read_b64_tr_b16 v[44:45], v7 offset:200
    ds_read_b64_tr_b16 v[46:47], v7 offset:18632
    s_waitcnt lgkmcnt(12)
    ds_read_b64_tr_b16 v[48:49], v8 offset:256
    ds_read_b64_tr_b16 v[50:51], v8 offset:18688
    s_add_u32 s31, s30, 0
    buffer_store_dwordx4 v[16:19], v5, s[4:7], s31 offen sc1
    s_add_u32 s31, s30, 1024
    buffer_store_dwordx4 v[20:23], v5, s[4:7], s31 offen sc1
    s_add_u32 s31, s30, 2048
    s_waitcnt lgkmcnt(12)
    buffer_store_dwordx4 v[24:27], v5, s[4:7], s31 offen sc1
    s_add_u32 s31, s30, 55296
    s_waitcnt lgkmcnt(10)
    buffer_store_dwordx4 v[28:31], v5, s[4:7], s31 offen sc1
    s_add_u32 s31, s30, 56320
    s_waitcnt lgkmcnt(8)
    buffer_store_dwordx4 v[32:35], v5, s[4:7], s31 offen sc1
    s_add_u32 s31, s30, 57344
    s_waitcnt lgkmcnt(6)
    buffer_store_dwordx4 v[36:39], v5, s[4:7], s31 offen sc1
    s_add_u32 s31, s30, 110592
    s_waitcnt lgkmcnt(4)
    buffer_store_dwordx4 v[40:43], v5, s[4:7], s31 offen sc1
    s_add_u32 s31, s30, 111616
    s_waitcnt lgkmcnt(2)
    buffer_store_dwordx4 v[44:47], v5, s[4:7], s31 offen sc1
    s_add_u32 s31, s30, 112640
    s_waitcnt lgkmcnt(0)
    buffer_store_dwordx4 v[48:51], v5, s[4:7], s31 offen sc1
    v_lshrrev_b32 v6, 3, v0
    v_and_b32 v7, 7, v0
    v_mul_u32_u24 v8, 1152, v6
    v_lshl_add_u32 v8, v7, 4, v8
    ds_read_b128 v[52:55], v8 offset:0
    ds_read_b128 v[56:59], v8 offset:128
    ds_read_b128 v[60:63], v8 offset:256
    ds_read_b128 v[64:67], v8 offset:384
    ds_read_b128 v[68:71], v8 offset:512
    ds_read_b128 v[72:75], v8 offset:640
    ds_read_b128 v[76:79], v8 offset:768
    ds_read_b128 v[80:83], v8 offset:896
    ds_read_b128 v[84:87], v8 offset:1024
    v_mov_b32 v9, 0
    v_mov_b32 v11, 0x3f803f80
    s_waitcnt lgkmcnt(0)
    v_dot2c_f32_bf16 v9, v52, v11
    v_dot2c_f32_bf16 v9, v53, v11
    v_dot2c_f32_bf16 v9, v54, v11
    v_dot2c_f32_bf16 v9, v55, v11
    v_dot2c_f32_bf16 v9, v56, v11
    v_dot2c_f32_bf16 v9, v57, v11
    v_dot2c_f32_bf16 v9, v58, v11
    v_dot2c_f32_bf16 v9, v59, v11
    v_dot2c_f32_bf16 v9, v60, v11
    v_dot2c_f32_bf16 v9, v61, v11
    v_dot2c_f32_bf16 v9, v62, v11
    v_dot2c_f32_bf16 v9, v63, v11
    v_dot2c_f32_bf16 v9, v64, v11
    v_dot2c_f32_bf16 v9, v65, v11
    v_dot2c_f32_bf16 v9, v66, v11
    v_dot2c_f32_bf16 v9, v67, v11
    v_dot2c_f32_bf16 v9, v68, v11
    v_dot2c_f32_bf16 v9, v69, v11
    v_dot2c_f32_bf16 v9, v70, v11
    v_dot2c_f32_bf16 v9, v71, v11
    v_dot2c_f32_bf16 v9, v72, v11
    v_dot2c_f32_bf16 v9, v73, v11
    v_dot2c_f32_bf16 v9, v74, v11
    v_dot2c_f32_bf16 v9, v75, v11
    v_dot2c_f32_bf16 v9, v76, v11
    v_dot2c_f32_bf16 v9, v77, v11
    v_dot2c_f32_bf16 v9, v78, v11
    v_dot2c_f32_bf16 v9, v79, v11
    v_dot2c_f32_bf16 v9, v80, v11
    v_dot2c_f32_bf16 v9, v81, v11
    v_dot2c_f32_bf16 v9, v82, v11
    v_dot2c_f32_bf16 v9, v83, v11
    v_dot2c_f32_bf16 v9, v84, v11
    v_dot2c_f32_bf16 v9, v85, v11
    v_dot2c_f32_bf16 v9, v86, v11
    v_dot2c_f32_bf16 v9, v87, v11
    s_nop 3
    v_add_f32_dpp v9, v9, v9 quad_perm:[1,0,3,2] row_mask:0xf bank_mask:0xf
    s_nop 1
    v_add_f32_dpp v9, v9, v9 quad_perm:[2,3,0,1] row_mask:0xf bank_mask:0xf
    s_nop 1
    v_add_f32_dpp v9, v9, v9 row_half_mirror row_mask:0xf bank_mask:0xf
    v_mul_f32 v9, 0x3ae38e39, v9
    v_cvt_pk_bf16_f32 v12, v9, v9
    v_lshlrev_b32 v13, 16, v12
    v_sub_f32 v13, v9, v13
    v_cvt_pk_bf16_f32 v13, v13, v13
    v_bfe_u32 v14, v6, 2, 2
    v_and_b32 v15, 3, v6
    v_cndmask_b32 v52, v15, v14, s[36:37]
    v_cndmask_b32 v53, v14, v15, s[36:37]
    v_lshrrev_b32 v14, 4, v6
    v_lshl_add_u32 v53, v14, 2, v53
    v_lshlrev_b32 v53, 1, v53
    v_lshl_add_u32 v52, v52, 4, v53
    s_lshl_b32 s31, s25, 7
    s_add_u32 s31, s31, 19922944
    v_cmp_eq_u32 vcc, 0, v7
    s_and_saveexec_b64 s[38:39], vcc
    buffer_store_short v12, v52, s[4:7], s31 offen sc1
    buffer_store_short v13, v52, s[4:7], s31 offen offset:64 sc1
    s_mov_b64 exec, -1
    buffer_load_dword v90, off, s[48:51], 0 sc1
    s_waitcnt vmcnt(0)
    s_barrier
    s_branch interleave_layers__linear_attn_block__glu_gated_geglu__prompt_kernel_join
interleave_layers__linear_attn_block__glu_gated_geglu__prompt_kernel_wx:
    s_waitcnt lgkmcnt(0)
    s_add_u32 s25, s25, 256
    s_and_b32 s26, s25, 7
    s_bfe_u32 s35, s25, 0x10003
    s_lshr_b32 s27, s25, 4
    s_mul_i32 s28, s27, 294912
    s_mul_i32 s29, s26, 1152
    s_add_u32 s28, s28, s29
    s_mul_i32 s29, s35, 576
    s_add_u32 s28, s28, s29
    s_cmp_lt_u32 s20, 2
    s_cselect_b32 s31, s28, 268435456
    v_add_u32 v6, 0, v0
    v_mul_u32_u24 v7, 1821, v6
    v_lshrrev_b32 v7, 16, v7
    v_mul_u32_u24 v8, 8640, v7
    v_lshl_add_u32 v8, v6, 4, v8
    buffer_load_dwordx4 v[16:19], v8, s[12:15], s28 offen
    buffer_load_dwordx4 v[20:23], v8, s[16:19], s28 offen
    v_mul_u32_u24 v11, 32, v7
    v_lshl_add_u32 v11, v6, 5, v11
    v_add_u32 v6, 256, v0
    v_mul_u32_u24 v7, 1821, v6
    v_lshrrev_b32 v7, 16, v7
    v_mul_u32_u24 v8, 8640, v7
    v_lshl_add_u32 v8, v6, 4, v8
    buffer_load_dwordx4 v[24:27], v8, s[12:15], s28 offen
    buffer_load_dwordx4 v[28:31], v8, s[16:19], s28 offen
    v_mul_u32_u24 v12, 32, v7
    v_lshl_add_u32 v12, v6, 5, v12
    v_add_u32 v6, 512, v0
    v_mul_u32_u24 v7, 1821, v6
    v_lshrrev_b32 v7, 16, v7
    v_mul_u32_u24 v8, 8640, v7
    v_lshl_add_u32 v8, v6, 4, v8
    buffer_load_dwordx4 v[32:35], v8, s[12:15], s28 offen
    buffer_load_dwordx4 v[36:39], v8, s[16:19], s28 offen
    v_mul_u32_u24 v13, 32, v7
    v_lshl_add_u32 v13, v6, 5, v13
    v_add_u32 v6, 768, v0
    v_mul_u32_u24 v7, 1821, v6
    v_lshrrev_b32 v7, 16, v7
    v_mul_u32_u24 v8, 8640, v7
    v_lshl_add_u32 v8, v6, 4, v8
    buffer_load_dwordx4 v[40:43], v8, s[12:15], s28 offen
    buffer_load_dwordx4 v[44:47], v8, s[16:19], s28 offen
    v_mul_u32_u24 v14, 32, v7
    v_lshl_add_u32 v14, v6, 5, v14
    v_add_u32 v6, 1024, v0
    v_mul_u32_u24 v7, 1821, v6
    v_lshrrev_b32 v7, 16, v7
    v_mul_u32_u24 v8, 8640, v7
    v_lshl_add_u32 v8, v6, 4, v8
    buffer_load_dwordx4 v[48:51], v8, s[12:15], s31 offen
    buffer_load_dwordx4 v[52:55], v8, s[16:19], s31 offen
    v_mul_u32_u24 v15, 32, v7
    v_lshl_add_u32 v15, v6, 5, v15
    s_cmp_ge_u32 s27, 9
    s_cselect_b32 s28, 18, 0
    s_add_u32 s30, s27, s28
    s_lshl_b32 s29, s26, 1
    s_add_u32 s29, s29, s35
    s_mul_i32 s29, s29, 253
    s_add_u32 s30, s30, s29
    s_lshl_b32 s30, s30, 2
    s_add_u32 s30, s30, s20
    s_lshl_b32 s30, s30, 10
    s_add_u32 s30, s30, 0
    s_and_b32 s26, s2, 7
    s_bfe_u32 s35, s2, 0x10003
    s_lshr_b32 s27, s2, 4
    s_mul_i32 s28, s27, 294912
    s_mul_i32 s29, s26, 1152
    s_add_u32 s28, s28, s29
    s_mul_i32 s29, s35, 576
    s_add_u32 s28, s28, s29
    s_cmp_lt_u32 s20, 2
    s_cselect_b32 s31, s28, 268435456
    v_add_u32 v6, 0, v0
    v_mul_u32_u24 v7, 1821, v6
    v_lshrrev_b32 v7, 16, v7
    v_mul_u32_u24 v8, 8640, v7
    v_lshl_add_u32 v8, v6, 4, v8
    buffer_load_dwordx4 v[196:199], v8, s[12:15], s28 offen
    buffer_load_dwordx4 v[200:203], v8, s[16:19], s28 offen
    v_mul_u32_u24 v236, 32, v7
    v_lshl_add_u32 v236, v6, 5, v236
    v_add_u32 v6, 256, v0
    v_mul_u32_u24 v7, 1821, v6
    v_lshrrev_b32 v7, 16, v7
    v_mul_u32_u24 v8, 8640, v7
    v_lshl_add_u32 v8, v6, 4, v8
    buffer_load_dwordx4 v[204:207], v8, s[12:15], s28 offen
    buffer_load_dwordx4 v[208:211], v8, s[16:19], s28 offen
    v_mul_u32_u24 v237, 32, v7
    v_lshl_add_u32 v237, v6, 5, v237
    v_add_u32 v6, 512, v0
    v_mul_u32_u24 v7, 1821, v6
    v_lshrrev_b32 v7, 16, v7
    v_mul_u32_u24 v8, 8640, v7
    v_lshl_add_u32 v8, v6, 4, v8
    buffer_load_dwordx4 v[212:215], v8, s[12:15], s28 offen
    buffer_load_dwordx4 v[216:219], v8, s[16:19], s28 offen
    v_mul_u32_u24 v238, 32, v7
    v_lshl_add_u32 v238, v6, 5, v238
    v_add_u32 v6, 768, v0
    v_mul_u32_u24 v7, 1821, v6
    v_lshrrev_b32 v7, 16, v7
    v_mul_u32_u24 v8, 8640, v7
    v_lshl_add_u32 v8, v6, 4, v8
    buffer_load_dwordx4 v[220:223], v8, s[12:15], s28 offen
    buffer_load_dwordx4 v[224:227], v8, s[16:19], s28 offen
    v_mul_u32_u24 v239, 32, v7
    v_lshl_add_u32 v239, v6, 5, v239
    v_add_u32 v6, 1024, v0
    v_mul_u32_u24 v7, 1821, v6
    v_lshrrev_b32 v7, 16, v7
    v_mul_u32_u24 v8, 8640, v7
    v_lshl_add_u32 v8, v6, 4, v8
    buffer_load_dwordx4 v[228:231], v8, s[12:15], s31 offen
    buffer_load_dwordx4 v[232:235], v8, s[16:19], s31 offen
    v_mul_u32_u24 v240, 32, v7
    v_lshl_add_u32 v240, v6, 5, v240
    s_cmp_ge_u32 s27, 9
    s_cselect_b32 s28, 18, 0
    s_add_u32 s33, s27, s28
    s_lshl_b32 s29, s26, 1
    s_add_u32 s29, s29, s35
    s_mul_i32 s29, s29, 253
    s_add_u32 s33, s33, s29
    s_lshl_b32 s33, s33, 2
    s_add_u32 s33, s33, s20
    s_lshl_b32 s33, s33, 10
    s_add_u32 s33, s33, 0
    s_getpc_b64 s[60:61]
interleave_layers__linear_attn_block__glu_gated_geglu__prompt_kernelwx_pc:
    s_add_u32 s60, s60, qkv0_part-interleave_layers__linear_attn_block__glu_gated_geglu__prompt_kernelwx_pc
    s_addc_u32 s61, s61, (qkv0_part-interleave_layers__linear_attn_block__glu_gated_geglu__prompt_kernelwx_pc)>>32
    s_bfe_u32 s62, s2, 0x50003
    s_lshl_b32 s62, s62, 12
    v_and_b32 v142, 31, v0
    v_lshl_add_u32 v142, v142, 7, s62
    v_min_u32 v142, qkv0_part_end-qkv0_part-4, v142
    global_load_dword v143, v142, s[60:61]
    s_waitcnt vmcnt(19)
    v_swap_b32 v17, v20
    v_swap_b32 v19, v22
    ds_write_b128 v11, v[16:19]
    ds_write_b128 v11, v[20:23] offset:16
    s_waitcnt vmcnt(17)
    v_swap_b32 v25, v28
    v_swap_b32 v27, v30
    ds_write_b128 v12, v[24:27]
    ds_write_b128 v12, v[28:31] offset:16
    s_waitcnt vmcnt(15)
    v_swap_b32 v33, v36
    v_swap_b32 v35, v38
    ds_write_b128 v13, v[32:35]
    ds_write_b128 v13, v[36:39] offset:16
    s_waitcnt vmcnt(13)
    v_swap_b32 v41, v44
    v_swap_b32 v43, v46
    ds_write_b128 v14, v[40:43]
    ds_write_b128 v14, v[44:47] offset:16
    s_waitcnt vmcnt(11)
    v_swap_b32 v49, v52
    v_swap_b32 v51, v54
    ds_write_b128 v15, v[48:51]
    ds_write_b128 v15, v[52:55] offset:16
    v_lshl_add_u32 v6, v2, 3, v3
    v_mul_u32_u24 v6, 1184, v6
    v_and_b32 v7, 1, v4
    v_lshl_add_u32 v6, v7, 4, v6
    v_lshrrev_b32 v7, 1, v4
    v_lshl_add_u32 v6, v7, 3, v6
    s_mul_i32 s29, s20, 288
    s_add_u32 s29, s29, 0
    v_add_u32 v6, s29, v6
    s_waitcnt lgkmcnt(0)
    s_barrier
    ds_read_b64_tr_b16 v[16:17], v6 offset:0
    ds_read_b64_tr_b16 v[18:19], v6 offset:4736
    ds_read_b64_tr_b16 v[20:21], v6 offset:32
    ds_read_b64_tr_b16 v[22:23], v6 offset:4768
    ds_read_b64_tr_b16 v[24:25], v6 offset:64
    ds_read_b64_tr_b16 v[26:27], v6 offset:4800
    ds_read_b64_tr_b16 v[28:29], v6 offset:96
    ds_read_b64_tr_b16 v[30:31], v6 offset:4832
    ds_read_b64_tr_b16 v[32:33], v6 offset:128
    ds_read_b64_tr_b16 v[34:35], v6 offset:4864
    ds_read_b64_tr_b16 v[36:37], v6 offset:160
    ds_read_b64_tr_b16 v[38:39], v6 offset:4896
    ds_read_b64_tr_b16 v[40:41], v6 offset:192
    ds_read_b64_tr_b16 v[42:43], v6 offset:4928
    s_waitcnt lgkmcnt(12)
    ds_read_b64_tr_b16 v[44:45], v6 offset:224
    ds_read_b64_tr_b16 v[46:47], v6 offset:4960
    s_waitcnt lgkmcnt(12)
    ds_read_b64_tr_b16 v[48:49], v6 offset:256
    ds_read_b64_tr_b16 v[50:51], v6 offset:4992
    s_add_u32 s31, s30, 0
    buffer_store_dwordx4 v[16:19], v5, s[4:7], s31 offen sc1
    s_add_u32 s31, s30, 36864
    buffer_store_dwordx4 v[20:23], v5, s[4:7], s31 offen sc1
    s_add_u32 s31, s30, 73728
    s_waitcnt lgkmcnt(12)
    buffer_store_dwordx4 v[24:27], v5, s[4:7], s31 offen sc1
    s_add_u32 s31, s30, 221184
    s_waitcnt lgkmcnt(10)
    buffer_store_dwordx4 v[28:31], v5, s[4:7], s31 offen sc1
    s_add_u32 s31, s30, 258048
    s_waitcnt lgkmcnt(8)
    buffer_store_dwordx4 v[32:35], v5, s[4:7], s31 offen sc1
    s_add_u32 s31, s30, 294912
    s_waitcnt lgkmcnt(6)
    buffer_store_dwordx4 v[36:39], v5, s[4:7], s31 offen sc1
    s_add_u32 s31, s30, 442368
    s_waitcnt lgkmcnt(4)
    buffer_store_dwordx4 v[40:43], v5, s[4:7], s31 offen sc1
    s_add_u32 s31, s30, 479232
    s_waitcnt lgkmcnt(2)
    buffer_store_dwordx4 v[44:47], v5, s[4:7], s31 offen sc1
    s_add_u32 s31, s30, 516096
    s_waitcnt lgkmcnt(0)
    buffer_store_dwordx4 v[48:51], v5, s[4:7], s31 offen sc1
    buffer_load_dword v90, off, s[48:51], 0 sc1
    s_waitcnt vmcnt(0)
    s_barrier
    s_branch interleave_layers__linear_attn_block__glu_gated_geglu__prompt_kernel_join
interleave_layers__linear_attn_block__glu_gated_geglu__prompt_kernel_join:
    s_mov_b32 s8, 0
    s_cmp_lg_u32 s20, 3
    s_cbranch_scc1 interleave_layers__linear_attn_block__glu_gated_geglu__prompt_kernel_na
interleave_layers__linear_attn_block__glu_gated_geglu__prompt_kernel_db:
    v_readfirstlane_b32 s27, v90
    s_add_u32 s8, s8, 1
    s_cmp_lg_u32 s27, 0
    s_cbranch_scc1 interleave_layers__linear_attn_block__glu_gated_geglu__prompt_kernel_dbk
    buffer_load_dword v90, off, s[48:51], 0 sc1
    s_waitcnt vmcnt(0)
    s_cmp_lt_u32 s8, 0x80000
    s_cbranch_scc1 interleave_layers__linear_attn_block__glu_gated_geglu__prompt_kernel_db
interleave_layers__linear_attn_block__glu_gated_geglu__prompt_kernel_dbk:
    s_cmp_eq_u32 s53, 0
    s_cbranch_scc1 interleave_layers__linear_attn_block__glu_gated_geglu__prompt_kernel_na
    v_lshlrev_b32 v7, 7, v1
    s_mov_b32 exec_hi, 0
    s_mov_b32 exec_lo, s53
    buffer_atomic_add v91, v7, s[4:7], s52 offen sc1
    s_mov_b64 exec, -1
interleave_layers__linear_attn_block__glu_gated_geglu__prompt_kernel_na:
    s_cmp_ge_u32 s2, 200
    s_cbranch_scc0 interleave_layers__linear_attn_block__glu_gated_geglu__prompt_kernel_w1l
    s_cmp_lt_u32 s2, 250
    s_cbranch_scc1 interleave_layers__linear_attn_block__glu_gated_geglu__prompt_kernel_w1d
interleave_layers__linear_attn_block__glu_gated_geglu__prompt_kernel_w1l:
    s_and_b32 s26, s2, 7
    s_bfe_u32 s35, s2, 0x10003
    s_lshr_b32 s27, s2, 4
    s_mul_i32 s28, s27, 294912
    s_mul_i32 s29, s26, 1152
    s_add_u32 s28, s28, s29
    s_mul_i32 s29, s35, 576
    s_add_u32 s28, s28, s29
    s_cmp_lt_u32 s20, 2
    s_cselect_b32 s31, s28, 268435456
    v_add_u32 v6, 0, v0
    v_mul_u32_u24 v7, 1821, v6
    v_lshrrev_b32 v7, 16, v7
    v_mul_u32_u24 v8, 8640, v7
    v_lshl_add_u32 v8, v6, 4, v8
    buffer_load_dwordx4 v[196:199], v8, s[12:15], s28 offen
    buffer_load_dwordx4 v[200:203], v8, s[16:19], s28 offen
    v_mul_u32_u24 v236, 32, v7
    v_lshl_add_u32 v236, v6, 5, v236
    v_add_u32 v6, 256, v0
    v_mul_u32_u24 v7, 1821, v6
    v_lshrrev_b32 v7, 16, v7
    v_mul_u32_u24 v8, 8640, v7
    v_lshl_add_u32 v8, v6, 4, v8
    buffer_load_dwordx4 v[204:207], v8, s[12:15], s28 offen
    buffer_load_dwordx4 v[208:211], v8, s[16:19], s28 offen
    v_mul_u32_u24 v237, 32, v7
    v_lshl_add_u32 v237, v6, 5, v237
    v_add_u32 v6, 512, v0
    v_mul_u32_u24 v7, 1821, v6
    v_lshrrev_b32 v7, 16, v7
    v_mul_u32_u24 v8, 8640, v7
    v_lshl_add_u32 v8, v6, 4, v8
    buffer_load_dwordx4 v[212:215], v8, s[12:15], s28 offen
    buffer_load_dwordx4 v[216:219], v8, s[16:19], s28 offen
    v_mul_u32_u24 v238, 32, v7
    v_lshl_add_u32 v238, v6, 5, v238
    v_add_u32 v6, 768, v0
    v_mul_u32_u24 v7, 1821, v6
    v_lshrrev_b32 v7, 16, v7
    v_mul_u32_u24 v8, 8640, v7
    v_lshl_add_u32 v8, v6, 4, v8
    buffer_load_dwordx4 v[220:223], v8, s[12:15], s28 offen
    buffer_load_dwordx4 v[224:227], v8, s[16:19], s28 offen
    v_mul_u32_u24 v239, 32, v7
    v_lshl_add_u32 v239, v6, 5, v239
    v_add_u32 v6, 1024, v0
    v_mul_u32_u24 v7, 1821, v6
    v_lshrrev_b32 v7, 16, v7
    v_mul_u32_u24 v8, 8640, v7
    v_lshl_add_u32 v8, v6, 4, v8
    buffer_load_dwordx4 v[228:231], v8, s[12:15], s31 offen
    buffer_load_dwordx4 v[232:235], v8, s[16:19], s31 offen
    v_mul_u32_u24 v240, 32, v7
    v_lshl_add_u32 v240, v6, 5, v240
    s_cmp_ge_u32 s27, 9
    s_cselect_b32 s28, 18, 0
    s_add_u32 s33, s27, s28
    s_lshl_b32 s29, s26, 1
    s_add_u32 s29, s29, s35
    s_mul_i32 s29, s29, 253
    s_add_u32 s33, s33, s29
    s_lshl_b32 s33, s33, 2
    s_add_u32 s33, s33, s20
    s_lshl_b32 s33, s33, 10
    s_add_u32 s33, s33, 0
interleave_layers__linear_attn_block__glu_gated_geglu__prompt_kernel_w1d:
    v_lshl_add_u32 v6, v2, 3, v3
    v_mul_u32_u24 v6, 1184, v6
    v_and_b32 v7, 1, v4
    v_lshl_add_u32 v6, v7, 4, v6
    v_lshrrev_b32 v7, 1, v4
    v_lshl_add_u32 v6, v7, 3, v6
    s_mul_i32 s29, s20, 288
    s_add_u32 s29, s29, 0
    v_add_u32 v6, s29, v6
    v_mov_b32 v241, v6
    s_bfe_u32 s21, s2, 0x10002
    s_lshl_b32 s21, s21, 3
    s_bfe_u32 s22, s2, 0x30003
    s_add_u32 s21, s21, s22
    s_and_b32 s22, s2, 3
    s_lshl_b32 s22, s22, 2
    s_lshr_b32 s23, s2, 6
    s_add_u32 s22, s22, s23
    s_lshl_b32 s31, s2, 12
    s_add_u32 s31, s31, 39845888
    v_lshlrev_b32 v7, 4, v0
    buffer_store_dwordx4 v[92:95], v7, s[4:7], s31 offen sc1
    s_cmp_lg_u32 s20, 3
    s_cbranch_scc1 interleave_layers__linear_attn_block__glu_gated_geglu__prompt_kernel_pk
    s_lshl_b32 s26, s21, 7
    s_and_b32 s27, s22, 12
    s_and_b32 s28, s21, 3
    s_add_u32 s27, s27, s28
    s_lshl_b32 s27, s27, 7
    s_add_u32 s27, s27, 2048
    s_sub_u32 s27, s27, s26
    s_add_u32 s26, s26, 20119552
    s_add_u32 s27, s27, s26
interleave_layers__linear_attn_block__glu_gated_geglu__prompt_kernel_ps:
    s_mov_b32 s28, 0
    s_atomic_add s28, s[4:5], s26 offset:0 glc
    s_mov_b32 s29, 0
    s_atomic_add s29, s[4:5], s27 offset:0 glc
    s_add_u32 s8, s8, 1
    s_waitcnt lgkmcnt(0)
    s_min_u32 s28, s28, s29
    s_cmp_ge_u32 s28, 72
    s_cbranch_scc1 interleave_layers__linear_attn_block__glu_gated_geglu__prompt_kernel_psk
    s_cmp_lt_u32 s8, 0x80000
    s_cbranch_scc1 interleave_layers__linear_attn_block__glu_gated_geglu__prompt_kernel_ps
interleave_layers__linear_attn_block__glu_gated_geglu__prompt_kernel_psk:
interleave_layers__linear_attn_block__glu_gated_geglu__prompt_kernel_pk:
    s_mov_b64 exec, -1
    s_barrier
    s_branch qkv0_part_body
interleave_layers__linear_attn_block__glu_gated_geglu__prompt_kernel_end:
    s_endpgm
qkv0_part:
    s_branch qkv0_part_body
.p2align 12
qkv0_part_body:
    v_and_b32 v2, 63, v0
    v_lshlrev_b32 v1, 4, v2
    v_and_b32 v11, 15, v2
    v_lshrrev_b32 v12, 4, v2
    s_mul_i32 s24, s21, 151552
    s_mul_i32 s27, s20, 36864
    s_add_u32 s24, s24, s27
    s_add_u32 s24, s24, 20971520
    s_lshl_b32 s26, s20, 10
    s_mul_i32 s25, s22, 129024
    s_add_u32 s25, s25, s26
    s_add_u32 s25, s25, 16777216
    s_cmp_lt_u32 s20, 2
    s_cselect_b32 s49, s25, 0x10000000
    v_add_u32 v3, 18432, v1
    v_add_u32 v10, 0x10000, v1
    s_waitcnt lgkmcnt(0)
    s_add_u32 m0, s26, 0
    s_add_u32 s31, s25, 0
    buffer_load_dwordx4 v1, s[4:7], s31 offen sc1 lds
    s_add_u32 m0, s26, 4096
    s_add_u32 s31, s25, 4096
    buffer_load_dwordx4 v1, s[4:7], s31 offen sc1 lds
    s_add_u32 m0, s26, 8192
    s_add_u32 s31, s25, 8192
    buffer_load_dwordx4 v1, s[4:7], s31 offen sc1 lds
    s_add_u32 m0, s26, 12288
    s_add_u32 s31, s25, 12288
    buffer_load_dwordx4 v1, s[4:7], s31 offen sc1 lds
    s_add_u32 s30, s24, 0
    buffer_load_dwordx4 a[0:3], v1, s[4:7], s30 offen offset:0 sc1
    buffer_load_dwordx4 a[4:7], v3, s[4:7], s30 offen offset:0 sc1
    s_add_u32 m0, s26, 16384
    s_add_u32 s31, s25, 16384
    buffer_load_dwordx4 v1, s[4:7], s31 offen sc1 lds
    s_add_u32 m0, s26, 20480
    s_add_u32 s31, s25, 20480
    buffer_load_dwordx4 v1, s[4:7], s31 offen sc1 lds
    buffer_load_dwordx4 a[8:11], v1, s[4:7], s30 offen offset:1024 sc1
    buffer_load_dwordx4 a[12:15], v3, s[4:7], s30 offen offset:1024 sc1
    s_lshl_b32 s27, s21, 9
    s_lshl_b32 s28, s20, 7
    s_add_u32 s27, s27, s28
    s_add_u32 s27, s27, 20840448
    v_lshlrev_b32 v13, 2, v11
    v_lshlrev_b32 v14, 4, v12
    s_add_u32 m0, s26, 24576
    s_add_u32 s31, s25, 24576
    buffer_load_dwordx4 v1, s[4:7], s31 offen sc1 lds
    buffer_load_dwordx4 a[16:19], v1, s[4:7], s30 offen offset:2048 sc1
    s_mov_b64 exec, 0
    s_cmp_eq_u32 s20, 0
    s_cbranch_scc1 qkv0_part_pad0_0x
    s_cmp_eq_u32 s20, 1
    s_cbranch_scc1 qkv0_part_padret0
    s_cmp_eq_u32 s20, 2
    s_cbranch_scc1 qkv0_part_padret0
    s_branch qkv0_part_padret0
qkv0_part_padret0:
    s_mov_b64 exec, -1
    buffer_load_dwordx4 a[20:23], v3, s[4:7], s30 offen offset:2048 sc1
    s_add_u32 m0, s26, 28672
    s_add_u32 s31, s25, 28672
    buffer_load_dwordx4 v1, s[4:7], s31 offen sc1 lds
    s_add_u32 m0, s26, 32768
    s_add_u32 s31, s25, 32768
    buffer_load_dwordx4 v1, s[4:7], s31 offen sc1 lds
    buffer_load_dwordx4 a[24:27], v1, s[4:7], s30 offen offset:3072 sc1
    s_getpc_b64 s[60:61]
qkv0_partq_pc:
    s_add_u32 s60, s60, ffn0_part-qkv0_partq_pc
    s_addc_u32 s61, s61, (ffn0_part-qkv0_partq_pc)>>32
    s_bfe_u32 s62, s2, 0x50003
    s_lshl_b32 s62, s62, 12
    v_and_b32 v190, 31, v0
    v_lshl_add_u32 v190, v190, 7, s62
    v_min_u32 v190, ffn0_part_end-ffn0_part-4, v190
    s_lshl_b32 s50, s21, 7
    s_add_u32 s50, s50, 20123648
    s_cmp_eq_u32 s20, 3
    s_cselect_b32 s52, 19, 0
    s_cselect_b32 s53, s50, 0x10000000
    v_mov_b32 v187, 0
    s_waitcnt vmcnt(12)
    s_barrier
    ds_read_b128 v[88:91], v1 offset:2048
    ds_read_b128 v[92:95], v1 offset:3072
    ds_read_b128 v[104:107], v1 offset:6144
    ds_read_b128 v[96:99], v1 offset:4096
    ds_read_b128 v[100:103], v1 offset:5120
    ds_read_b128 v[80:83], v1 offset:0
    ds_read_b128 v[84:87], v1 offset:1024
    s_waitcnt vmcnt(10) lgkmcnt(4)
    s_mov_b32 s54, 132096
    s_mul_i32 s42, s20, 3072
    s_add_u32 s42, s42, 132096
    s_and_b32 s29, s2, 1
    s_lshl_b32 s29, s29, 1
    s_bfe_u32 s23, s2, 0x10003
    s_add_u32 s29, s29, s23
    s_mul_i32 s29, s29, 3
    s_add_u32 s29, s29, s20
    s_mul_i32 s29, s29, 55296
    s_add_u32 s29, s29, 18939904
    s_cmp_eq_u32 s20, 3
    s_cselect_b32 s29, 0x10000000, s29
    v_mfma_f32_16x16x32_bf16 v[32:35], a[0:3], v[88:91], 0
    ds_read_b128 v[116:119], v1 offset:9216
    ds_read_b128 v[120:123], v1 offset:10240
    v_mfma_f32_16x16x32_bf16 v[36:39], a[4:7], v[88:91], 0
    v_mfma_f32_16x16x32_bf16 v[40:43], a[0:3], v[92:95], 0
    buffer_load_dwordx4 a[28:31], v3, s[4:7], s30 offen offset:3072 sc1
    v_mfma_f32_16x16x32_bf16 v[44:47], a[4:7], v[92:95], 0
    s_add_u32 m0, s26, 36864
    ds_read_b128 v[132:135], v1 offset:13312
    ds_read_b128 v[124:127], v1 offset:11264
    v_mfma_f32_16x16x32_bf16 v[64:67], a[0:3], v[104:107], 0
    s_add_u32 s31, s25, 36864
    v_mfma_f32_16x16x32_bf16 v[68:71], a[4:7], v[104:107], 0
    s_waitcnt lgkmcnt(4)
    buffer_load_dwordx4 v1, s[4:7], s31 offen sc1 lds
    v_mfma_f32_16x16x32_bf16 v[48:51], a[0:3], v[96:99], 0
    s_add_u32 m0, s26, 40960
    ds_read_b128 v[128:131], v1 offset:12288
    ds_read_b128 v[108:111], v1 offset:7168
    v_mfma_f32_16x16x32_bf16 v[52:55], a[4:7], v[96:99], 0
    s_add_u32 s31, s25, 40960
    v_mfma_f32_16x16x32_bf16 v[56:59], a[0:3], v[100:103], 0
    buffer_load_dwordx4 v1, s[4:7], s31 offen sc1 lds
    v_mfma_f32_16x16x32_bf16 v[60:63], a[4:7], v[100:103], 0
    s_add_u32 s30, s24, 4096
    ds_read_b128 v[112:115], v1 offset:8192
    v_mfma_f32_16x16x32_bf16 v[16:19], v[80:83], a[0:3], 0
    buffer_load_dwordx4 a[32:35], v1, s[4:7], s30 offen offset:0 sc1
    v_mfma_f32_16x16x32_bf16 v[24:27], v[80:83], a[4:7], 0
    s_waitcnt vmcnt(9)
    v_mfma_f32_16x16x32_bf16 v[20:23], v[84:87], a[0:3], 0
    s_barrier
    v_mfma_f32_16x16x32_bf16 v[28:31], v[84:87], a[4:7], 0
    s_waitcnt lgkmcnt(0)
    v_mfma_f32_16x16x32_bf16 v[32:35], a[8:11], v[116:119], v[32:35]
    ds_read_b128 v[88:91], v1 offset:16384
    ds_read_b128 v[92:95], v1 offset:17408
    v_mfma_f32_16x16x32_bf16 v[36:39], a[12:15], v[116:119], v[36:39]
    buffer_load_dwordx4 a[36:39], v3, s[4:7], s30 offen offset:0 sc1
    v_mfma_f32_16x16x32_bf16 v[40:43], a[8:11], v[120:123], v[40:43]
    s_add_u32 m0, s26, 45056
    s_add_u32 s31, s25, 45056
    v_mfma_f32_16x16x32_bf16 v[44:47], a[12:15], v[120:123], v[44:47]
    ds_read_b128 v[104:107], v1 offset:20480
    ds_read_b128 v[96:99], v1 offset:18432
    v_mfma_f32_16x16x32_bf16 v[64:67], a[8:11], v[132:135], v[64:67]
    buffer_load_dwordx4 v1, s[4:7], s31 offen sc1 lds
    v_mfma_f32_16x16x32_bf16 v[68:71], a[12:15], v[132:135], v[68:71]
    s_add_u32 m0, s26, 49152
    s_add_u32 s31, s25, 49152
    v_mfma_f32_16x16x32_bf16 v[48:51], a[8:11], v[124:127], v[48:51]
    ds_read_b128 v[100:103], v1 offset:19456
    ds_read_b128 v[80:83], v1 offset:14336
    v_mfma_f32_16x16x32_bf16 v[52:55], a[12:15], v[124:127], v[52:55]
    buffer_load_dwordx4 v1, s[4:7], s31 offen sc1 lds
    v_mfma_f32_16x16x32_bf16 v[56:59], a[8:11], v[128:131], v[56:59]
    v_swap_b32 v197, v200
    v_mfma_f32_16x16x32_bf16 v[60:63], a[12:15], v[128:131], v[60:63]
    ds_read_b128 v[84:87], v1 offset:15360
    v_mfma_f32_16x16x32_bf16 v[16:19], v[108:111], a[8:11], v[16:19]
    buffer_load_dwordx4 a[40:43], v1, s[4:7], s30 offen offset:1024 sc1
    v_mfma_f32_16x16x32_bf16 v[24:27], v[108:111], a[12:15], v[24:27]
    v_swap_b32 v199, v202
    v_mfma_f32_16x16x32_bf16 v[20:23], v[112:115], a[8:11], v[20:23]
    v_swap_b32 v205, v208
    v_mfma_f32_16x16x32_bf16 v[28:31], v[112:115], a[12:15], v[28:31]
    s_waitcnt vmcnt(11) lgkmcnt(0)
    v_swap_b32 v207, v210
    v_mfma_f32_16x16x32_bf16 v[32:35], a[16:19], v[88:91], v[32:35]
    ds_read_b128 v[116:119], v1 offset:23552
    ds_read_b128 v[120:123], v1 offset:24576
    v_mfma_f32_16x16x32_bf16 v[36:39], a[20:23], v[88:91], v[36:39]
    buffer_load_dwordx4 a[44:47], v3, s[4:7], s30 offen offset:1024 sc1
    v_mfma_f32_16x16x32_bf16 v[40:43], a[16:19], v[92:95], v[40:43]
    s_add_u32 m0, s26, 53248
    s_add_u32 s31, s25, 53248
    v_mfma_f32_16x16x32_bf16 v[44:47], a[20:23], v[92:95], v[44:47]
    ds_read_b128 v[132:135], v1 offset:27648
    ds_read_b128 v[124:127], v1 offset:25600
    v_mfma_f32_16x16x32_bf16 v[64:67], a[16:19], v[104:107], v[64:67]
    buffer_load_dwordx4 v1, s[4:7], s31 offen sc1 lds
    v_mfma_f32_16x16x32_bf16 v[68:71], a[20:23], v[104:107], v[68:71]
    buffer_load_dword v136, v13, s[4:7], s27 offen offset:0 sc1
    v_mfma_f32_16x16x32_bf16 v[48:51], a[16:19], v[96:99], v[48:51]
    ds_read_b128 v[128:131], v1 offset:26624
    ds_read_b128 v[108:111], v1 offset:21504
    v_mfma_f32_16x16x32_bf16 v[52:55], a[20:23], v[96:99], v[52:55]
    buffer_load_dwordx4 a[48:51], v1, s[4:7], s30 offen offset:2048 sc1
    v_mfma_f32_16x16x32_bf16 v[56:59], a[16:19], v[100:103], v[56:59]
    v_swap_b32 v213, v216
    v_mfma_f32_16x16x32_bf16 v[60:63], a[20:23], v[100:103], v[60:63]
    ds_read_b128 v[112:115], v1 offset:22528
    v_mfma_f32_16x16x32_bf16 v[16:19], v[80:83], a[16:19], v[16:19]
    buffer_load_dwordx4 a[52:55], v3, s[4:7], s30 offen offset:2048 sc1
    v_mfma_f32_16x16x32_bf16 v[24:27], v[80:83], a[20:23], v[24:27]
    s_waitcnt vmcnt(10)
    buffer_load_dwordx4 v[144:147], v14, s[4:7], s27 offen offset:0 sc1
    v_mfma_f32_16x16x32_bf16 v[20:23], v[84:87], a[16:19], v[20:23]
    s_barrier
    v_swap_b32 v215, v218
    v_mfma_f32_16x16x32_bf16 v[28:31], v[84:87], a[20:23], v[28:31]
    s_waitcnt lgkmcnt(0)
    v_swap_b32 v221, v224
    v_mfma_f32_16x16x32_bf16 v[32:35], a[24:27], v[116:119], v[32:35]
    s_add_u32 m0, s26, 57344
    ds_read_b128 v[88:91], v1 offset:30720
    ds_read_b128 v[92:95], v1 offset:31744
    v_mfma_f32_16x16x32_bf16 v[36:39], a[28:31], v[116:119], v[36:39]
    s_add_u32 s31, s25, 57344
    v_swap_b32 v223, v226
    v_mfma_f32_16x16x32_bf16 v[40:43], a[24:27], v[120:123], v[40:43]
    buffer_load_dwordx4 v1, s[4:7], s31 offen sc1 lds
    v_mfma_f32_16x16x32_bf16 v[44:47], a[28:31], v[120:123], v[44:47]
    s_add_u32 m0, s26, 61440
    ds_read_b128 v[104:107], v1 offset:34816
    ds_read_b128 v[96:99], v1 offset:32768
    v_mfma_f32_16x16x32_bf16 v[64:67], a[24:27], v[132:135], v[64:67]
    s_add_u32 s31, s25, 61440
    v_swap_b32 v229, v232
    v_mfma_f32_16x16x32_bf16 v[68:71], a[28:31], v[132:135], v[68:71]
    buffer_load_dwordx4 v1, s[4:7], s31 offen sc1 lds
    v_mfma_f32_16x16x32_bf16 v[48:51], a[24:27], v[124:127], v[48:51]
    ds_read_b128 v[100:103], v1 offset:33792
    ds_read_b128 v[80:83], v1 offset:28672
    v_mfma_f32_16x16x32_bf16 v[52:55], a[28:31], v[124:127], v[52:55]
    buffer_load_dwordx4 a[56:59], v1, s[4:7], s30 offen offset:3072 sc1
    v_mfma_f32_16x16x32_bf16 v[56:59], a[24:27], v[128:131], v[56:59]
    buffer_load_dword v138, v13, s[4:7], s27 offen offset:64 sc1
    v_mfma_f32_16x16x32_bf16 v[60:63], a[28:31], v[128:131], v[60:63]
    ds_read_b128 v[84:87], v1 offset:29696
    v_mfma_f32_16x16x32_bf16 v[16:19], v[108:111], a[24:27], v[16:19]
    buffer_load_dwordx4 a[60:63], v3, s[4:7], s30 offen offset:3072 sc1
    v_mfma_f32_16x16x32_bf16 v[24:27], v[108:111], a[28:31], v[24:27]
    buffer_load_dwordx4 v[148:151], v14, s[4:7], s27 offen offset:64 sc1
    v_mfma_f32_16x16x32_bf16 v[20:23], v[112:115], a[24:27], v[20:23]
    v_swap_b32 v231, v234
    v_mfma_f32_16x16x32_bf16 v[28:31], v[112:115], a[28:31], v[28:31]
    s_waitcnt vmcnt(15) lgkmcnt(0)
    v_mfma_f32_16x16x32_bf16 v[32:35], a[32:35], v[88:91], v[32:35]
    s_add_u32 m0, s26, 65536
    ds_read_b128 v[116:119], v1 offset:37888
    ds_read_b128 v[120:123], v1 offset:38912
    v_mfma_f32_16x16x32_bf16 v[36:39], a[36:39], v[88:91], v[36:39]
    s_add_u32 s31, s25, 65536
    v_mfma_f32_16x16x32_bf16 v[40:43], a[32:35], v[92:95], v[40:43]
    buffer_load_dwordx4 v1, s[4:7], s31 offen sc1 lds
    v_mfma_f32_16x16x32_bf16 v[44:47], a[36:39], v[92:95], v[44:47]
    s_add_u32 m0, s26, 69632
    ds_read_b128 v[132:135], v1 offset:41984
    ds_read_b128 v[124:127], v1 offset:39936
    v_mfma_f32_16x16x32_bf16 v[64:67], a[32:35], v[104:107], v[64:67]
    s_add_u32 s31, s25, 69632
    v_mfma_f32_16x16x32_bf16 v[68:71], a[36:39], v[104:107], v[68:71]
    buffer_load_dwordx4 v1, s[4:7], s31 offen sc1 lds
    v_mfma_f32_16x16x32_bf16 v[48:51], a[32:35], v[96:99], v[48:51]
    s_add_u32 s30, s24, 8192
    ds_read_b128 v[128:131], v1 offset:40960
    ds_read_b128 v[108:111], v1 offset:35840
    v_mfma_f32_16x16x32_bf16 v[52:55], a[36:39], v[96:99], v[52:55]
    buffer_load_dwordx4 a[64:67], v1, s[4:7], s30 offen offset:0 sc1
    v_mfma_f32_16x16x32_bf16 v[56:59], a[32:35], v[100:103], v[56:59]
    v_mfma_f32_16x16x32_bf16 v[60:63], a[36:39], v[100:103], v[60:63]
    ds_read_b128 v[112:115], v1 offset:36864
    v_mfma_f32_16x16x32_bf16 v[16:19], v[80:83], a[32:35], v[16:19]
    buffer_load_dwordx4 a[68:71], v3, s[4:7], s30 offen offset:0 sc1
    v_mfma_f32_16x16x32_bf16 v[24:27], v[80:83], a[36:39], v[24:27]
    s_waitcnt vmcnt(14)
    v_mfma_f32_16x16x32_bf16 v[20:23], v[84:87], a[32:35], v[20:23]
    s_barrier
    v_mfma_f32_16x16x32_bf16 v[28:31], v[84:87], a[36:39], v[28:31]
    s_waitcnt lgkmcnt(0)
    v_mfma_f32_16x16x32_bf16 v[32:35], a[40:43], v[116:119], v[32:35]
    s_add_u32 m0, s26, 73728
    ds_read_b128 v[88:91], v1 offset:45056
    ds_read_b128 v[92:95], v1 offset:46080
    v_mfma_f32_16x16x32_bf16 v[36:39], a[44:47], v[116:119], v[36:39]
    s_add_u32 s31, s25, 73728
    v_mfma_f32_16x16x32_bf16 v[40:43], a[40:43], v[120:123], v[40:43]
    buffer_load_dwordx4 v1, s[4:7], s31 offen sc1 lds
    v_mfma_f32_16x16x32_bf16 v[44:47], a[44:47], v[120:123], v[44:47]
    s_add_u32 m0, s26, 77824
    ds_read_b128 v[104:107], v1 offset:49152
    ds_read_b128 v[96:99], v1 offset:47104
    v_mfma_f32_16x16x32_bf16 v[64:67], a[40:43], v[132:135], v[64:67]
    s_add_u32 s31, s25, 77824
    v_mfma_f32_16x16x32_bf16 v[68:71], a[44:47], v[132:135], v[68:71]
    buffer_load_dwordx4 v1, s[4:7], s31 offen sc1 lds
    v_mfma_f32_16x16x32_bf16 v[48:51], a[40:43], v[124:127], v[48:51]
    ds_read_b128 v[100:103], v1 offset:48128
    ds_read_b128 v[80:83], v1 offset:43008
    v_mfma_f32_16x16x32_bf16 v[52:55], a[44:47], v[124:127], v[52:55]
    buffer_load_dwordx4 a[72:75], v1, s[4:7], s30 offen offset:1024 sc1
    v_mfma_f32_16x16x32_bf16 v[56:59], a[40:43], v[128:131], v[56:59]
    v_mfma_f32_16x16x32_bf16 v[60:63], a[44:47], v[128:131], v[60:63]
    ds_read_b128 v[84:87], v1 offset:44032
    v_mfma_f32_16x16x32_bf16 v[16:19], v[108:111], a[40:43], v[16:19]
    buffer_load_dwordx4 a[76:79], v3, s[4:7], s30 offen offset:1024 sc1
    v_mfma_f32_16x16x32_bf16 v[24:27], v[108:111], a[44:47], v[24:27]
    v_mfma_f32_16x16x32_bf16 v[20:23], v[112:115], a[40:43], v[20:23]
    v_mfma_f32_16x16x32_bf16 v[28:31], v[112:115], a[44:47], v[28:31]
    s_waitcnt vmcnt(15) lgkmcnt(0)
    v_mfma_f32_16x16x32_bf16 v[32:35], a[48:51], v[88:91], v[32:35]
    s_add_u32 m0, s26, 81920
    ds_read_b128 v[116:119], v1 offset:52224
    ds_read_b128 v[120:123], v1 offset:53248
    v_mfma_f32_16x16x32_bf16 v[36:39], a[52:55], v[88:91], v[36:39]
    s_add_u32 s31, s25, 81920
    v_mfma_f32_16x16x32_bf16 v[40:43], a[48:51], v[92:95], v[40:43]
    buffer_load_dwordx4 v1, s[4:7], s31 offen sc1 lds
    v_mfma_f32_16x16x32_bf16 v[44:47], a[52:55], v[92:95], v[44:47]
    ds_read_b128 v[132:135], v1 offset:56320
    ds_read_b128 v[124:127], v1 offset:54272
    v_mfma_f32_16x16x32_bf16 v[64:67], a[48:51], v[104:107], v[64:67]
    buffer_load_dwordx4 a[80:83], v1, s[4:7], s30 offen offset:2048 sc1
    v_mfma_f32_16x16x32_bf16 v[68:71], a[52:55], v[104:107], v[68:71]
    v_mfma_f32_16x16x32_bf16 v[48:51], a[48:51], v[96:99], v[48:51]
    ds_read_b128 v[128:131], v1 offset:55296
    ds_read_b128 v[108:111], v1 offset:50176
    v_mfma_f32_16x16x32_bf16 v[52:55], a[52:55], v[96:99], v[52:55]
    buffer_load_dwordx4 a[84:87], v3, s[4:7], s30 offen offset:2048 sc1
    v_mfma_f32_16x16x32_bf16 v[56:59], a[48:51], v[100:103], v[56:59]
    s_add_u32 m0, s26, 86016
    s_add_u32 s31, s25, 86016
    v_mfma_f32_16x16x32_bf16 v[60:63], a[52:55], v[100:103], v[60:63]
    ds_read_b128 v[112:115], v1 offset:51200
    v_mfma_f32_16x16x32_bf16 v[16:19], v[80:83], a[48:51], v[16:19]
    buffer_load_dwordx4 v1, s[4:7], s31 offen sc1 lds
    v_mfma_f32_16x16x32_bf16 v[24:27], v[80:83], a[52:55], v[24:27]
    s_waitcnt vmcnt(10)
    v_mfma_f32_16x16x32_bf16 v[20:23], v[84:87], a[48:51], v[20:23]
    s_barrier
    v_mfma_f32_16x16x32_bf16 v[28:31], v[84:87], a[52:55], v[28:31]
    s_waitcnt lgkmcnt(0)
    ds_write_b128 v236, v[196:199] offset:0
    v_mfma_f32_16x16x32_bf16 v[32:35], a[56:59], v[116:119], v[32:35]
    s_add_u32 m0, s26, 90112
    ds_read_b128 v[88:91], v1 offset:59392
    ds_read_b128 v[92:95], v1 offset:60416
    v_mfma_f32_16x16x32_bf16 v[36:39], a[60:63], v[116:119], v[36:39]
    s_add_u32 s31, s25, 90112
    ds_write_b128 v236, v[200:203] offset:16
    v_mfma_f32_16x16x32_bf16 v[40:43], a[56:59], v[120:123], v[40:43]
    buffer_load_dwordx4 v1, s[4:7], s31 offen sc1 lds
    v_mfma_f32_16x16x32_bf16 v[44:47], a[60:63], v[120:123], v[44:47]
    ds_read_b128 v[104:107], v1 offset:63488
    ds_read_b128 v[96:99], v1 offset:61440
    v_mfma_f32_16x16x32_bf16 v[64:67], a[56:59], v[132:135], v[64:67]
    buffer_load_dwordx4 a[88:91], v1, s[4:7], s30 offen offset:3072 sc1
    v_mfma_f32_16x16x32_bf16 v[68:71], a[60:63], v[132:135], v[68:71]
    s_mov_b64 exec, 1
    buffer_atomic_add v187, off, s[4:7], s53 sc0 sc1
    s_mov_b64 exec, -1
    v_mfma_f32_16x16x32_bf16 v[48:51], a[56:59], v[124:127], v[48:51]
    ds_read_b128 v[100:103], v1 offset:62464
    ds_read_b128 v[80:83], v1 offset:57344
    v_mfma_f32_16x16x32_bf16 v[52:55], a[60:63], v[124:127], v[52:55]
    buffer_load_dwordx4 a[92:95], v3, s[4:7], s30 offen offset:3072 sc1
    v_mfma_f32_16x16x32_bf16 v[56:59], a[56:59], v[128:131], v[56:59]
    s_add_u32 m0, s26, 94208
    s_add_u32 s31, s25, 94208
    v_mfma_f32_16x16x32_bf16 v[60:63], a[60:63], v[128:131], v[60:63]
    ds_read_b128 v[84:87], v1 offset:58368
    v_mfma_f32_16x16x32_bf16 v[16:19], v[108:111], a[56:59], v[16:19]
    buffer_load_dwordx4 v1, s[4:7], s31 offen sc1 lds
    v_mfma_f32_16x16x32_bf16 v[24:27], v[108:111], a[60:63], v[24:27]
    ds_write_b128 v237, v[204:207] offset:0
    v_mfma_f32_16x16x32_bf16 v[20:23], v[112:115], a[56:59], v[20:23]
    ds_write_b128 v237, v[208:211] offset:16
    v_mfma_f32_16x16x32_bf16 v[28:31], v[112:115], a[60:63], v[28:31]
    s_waitcnt vmcnt(13) lgkmcnt(2)
    ds_write_b128 v238, v[212:215] offset:0
    v_mfma_f32_16x16x32_bf16 v[32:35], a[64:67], v[88:91], v[32:35]
    s_add_u32 m0, s26, 98304
    ds_read_b128 v[116:119], v10 offset:1024
    ds_read_b128 v[120:123], v10 offset:2048
    v_mfma_f32_16x16x32_bf16 v[36:39], a[68:71], v[88:91], v[36:39]
    s_add_u32 s31, s25, 98304
    ds_write_b128 v238, v[216:219] offset:16
    v_mfma_f32_16x16x32_bf16 v[40:43], a[64:67], v[92:95], v[40:43]
    buffer_load_dwordx4 v1, s[4:7], s31 offen sc1 lds
    v_mfma_f32_16x16x32_bf16 v[44:47], a[68:71], v[92:95], v[44:47]
    s_add_u32 s30, s24, 12288
    ds_read_b128 v[132:135], v10 offset:5120
    ds_read_b128 v[124:127], v10 offset:3072
    v_mfma_f32_16x16x32_bf16 v[64:67], a[64:67], v[104:107], v[64:67]
    buffer_load_dwordx4 a[96:99], v1, s[4:7], s30 offen offset:0 sc1
    v_mfma_f32_16x16x32_bf16 v[68:71], a[68:71], v[104:107], v[68:71]
    ds_write_b128 v239, v[220:223] offset:0
    v_mfma_f32_16x16x32_bf16 v[48:51], a[64:67], v[96:99], v[48:51]
    ds_read_b128 v[128:131], v10 offset:4096
    ds_read_b128 v[108:111], v1 offset:64512
    v_mfma_f32_16x16x32_bf16 v[52:55], a[68:71], v[96:99], v[52:55]
    buffer_load_dwordx4 a[100:103], v3, s[4:7], s30 offen offset:0 sc1
    v_mfma_f32_16x16x32_bf16 v[56:59], a[64:67], v[100:103], v[56:59]
    s_add_u32 m0, s26, 102400
    s_add_u32 s31, s25, 102400
    v_mfma_f32_16x16x32_bf16 v[60:63], a[68:71], v[100:103], v[60:63]
    ds_read_b128 v[112:115], v10 offset:0
    v_mfma_f32_16x16x32_bf16 v[16:19], v[80:83], a[64:67], v[16:19]
    buffer_load_dwordx4 v1, s[4:7], s31 offen sc1 lds
    v_mfma_f32_16x16x32_bf16 v[24:27], v[80:83], a[68:71], v[24:27]
    s_waitcnt vmcnt(12)
    ds_write_b128 v239, v[224:227] offset:16
    v_mfma_f32_16x16x32_bf16 v[20:23], v[84:87], a[64:67], v[20:23]
    s_barrier
    ds_write_b128 v240, v[228:231] offset:0
    v_mfma_f32_16x16x32_bf16 v[28:31], v[84:87], a[68:71], v[28:31]
    s_waitcnt lgkmcnt(2)
    ds_write_b128 v240, v[232:235] offset:16
    v_mfma_f32_16x16x32_bf16 v[32:35], a[72:75], v[116:119], v[32:35]
    s_add_u32 m0, s26, 106496
    ds_read_b128 v[88:91], v10 offset:8192
    ds_read_b128 v[92:95], v10 offset:9216
    v_mfma_f32_16x16x32_bf16 v[36:39], a[76:79], v[116:119], v[36:39]
    s_add_u32 s31, s25, 106496
    v_mfma_f32_16x16x32_bf16 v[40:43], a[72:75], v[120:123], v[40:43]
    buffer_load_dwordx4 v1, s[4:7], s31 offen sc1 lds
    v_mfma_f32_16x16x32_bf16 v[44:47], a[76:79], v[120:123], v[44:47]
    ds_read_b128 v[104:107], v10 offset:12288
    ds_read_b128 v[96:99], v10 offset:10240
    v_mfma_f32_16x16x32_bf16 v[64:67], a[72:75], v[132:135], v[64:67]
    buffer_load_dwordx4 a[104:107], v1, s[4:7], s30 offen offset:1024 sc1
    v_mfma_f32_16x16x32_bf16 v[68:71], a[76:79], v[132:135], v[68:71]
    v_mfma_f32_16x16x32_bf16 v[48:51], a[72:75], v[124:127], v[48:51]
    ds_read_b128 v[100:103], v10 offset:11264
    ds_read_b128 v[80:83], v10 offset:6144
    v_mfma_f32_16x16x32_bf16 v[52:55], a[76:79], v[124:127], v[52:55]
    buffer_load_dwordx4 a[108:111], v3, s[4:7], s30 offen offset:1024 sc1
    v_mfma_f32_16x16x32_bf16 v[56:59], a[72:75], v[128:131], v[56:59]
    s_add_u32 m0, s26, 110592
    s_add_u32 s31, s25, 110592
    v_mfma_f32_16x16x32_bf16 v[60:63], a[76:79], v[128:131], v[60:63]
    ds_read_b128 v[84:87], v10 offset:7168
    v_mfma_f32_16x16x32_bf16 v[16:19], v[108:111], a[72:75], v[16:19]
    buffer_load_dwordx4 v1, s[4:7], s31 offen sc1 lds
    v_mfma_f32_16x16x32_bf16 v[24:27], v[108:111], a[76:79], v[24:27]
    v_mfma_f32_16x16x32_bf16 v[20:23], v[112:115], a[72:75], v[20:23]
    v_mfma_f32_16x16x32_bf16 v[28:31], v[112:115], a[76:79], v[28:31]
    s_waitcnt vmcnt(14) lgkmcnt(0)
    v_mfma_f32_16x16x32_bf16 v[32:35], a[80:83], v[88:91], v[32:35]
    ds_read_b128 v[116:119], v10 offset:15360
    ds_read_b128 v[120:123], v10 offset:16384
    v_mfma_f32_16x16x32_bf16 v[36:39], a[84:87], v[88:91], v[36:39]
    buffer_load_dwordx4 a[112:115], v1, s[4:7], s30 offen offset:2048 sc1
    v_mfma_f32_16x16x32_bf16 v[40:43], a[80:83], v[92:95], v[40:43]
    v_mfma_f32_16x16x32_bf16 v[44:47], a[84:87], v[92:95], v[44:47]
    ds_read_b128 v[132:135], v10 offset:19456
    ds_read_b128 v[124:127], v10 offset:17408
    v_mfma_f32_16x16x32_bf16 v[64:67], a[80:83], v[104:107], v[64:67]
    buffer_load_dwordx4 a[116:119], v3, s[4:7], s30 offen offset:2048 sc1
    v_mfma_f32_16x16x32_bf16 v[68:71], a[84:87], v[104:107], v[68:71]
    s_add_u32 m0, s26, 114688
    s_add_u32 s31, s25, 114688
    v_mfma_f32_16x16x32_bf16 v[48:51], a[80:83], v[96:99], v[48:51]
    ds_read_b128 v[128:131], v10 offset:18432
    ds_read_b128 v[108:111], v10 offset:13312
    v_mfma_f32_16x16x32_bf16 v[52:55], a[84:87], v[96:99], v[52:55]
    buffer_load_dwordx4 v1, s[4:7], s31 offen sc1 lds
    v_mfma_f32_16x16x32_bf16 v[56:59], a[80:83], v[100:103], v[56:59]
    s_add_u32 m0, s26, 118784
    s_add_u32 s31, s25, 118784
    v_mfma_f32_16x16x32_bf16 v[60:63], a[84:87], v[100:103], v[60:63]
    ds_read_b128 v[112:115], v10 offset:14336
    v_mfma_f32_16x16x32_bf16 v[16:19], v[80:83], a[80:83], v[16:19]
    buffer_load_dwordx4 v1, s[4:7], s31 offen sc1 lds
    v_mfma_f32_16x16x32_bf16 v[24:27], v[80:83], a[84:87], v[24:27]
    s_waitcnt vmcnt(11)
    v_mfma_f32_16x16x32_bf16 v[20:23], v[84:87], a[80:83], v[20:23]
    s_barrier
    v_mfma_f32_16x16x32_bf16 v[28:31], v[84:87], a[84:87], v[28:31]
    s_waitcnt lgkmcnt(0)
    ds_read_b64_tr_b16 v[196:197], v241 offset:0
    ds_read_b64_tr_b16 v[198:199], v241 offset:4736
    v_mfma_f32_16x16x32_bf16 v[32:35], a[88:91], v[116:119], v[32:35]
    ds_read_b128 v[88:91], v10 offset:22528
    ds_read_b128 v[92:95], v10 offset:23552
    v_mfma_f32_16x16x32_bf16 v[36:39], a[92:95], v[116:119], v[36:39]
    buffer_load_dwordx4 a[120:123], v1, s[4:7], s30 offen offset:3072 sc1
    v_mfma_f32_16x16x32_bf16 v[40:43], a[88:91], v[120:123], v[40:43]
    ds_read_b64_tr_b16 v[200:201], v241 offset:32
    ds_read_b64_tr_b16 v[202:203], v241 offset:4768
    v_mfma_f32_16x16x32_bf16 v[44:47], a[92:95], v[120:123], v[44:47]
    ds_read_b128 v[104:107], v10 offset:26624
    ds_read_b128 v[96:99], v10 offset:24576
    v_mfma_f32_16x16x32_bf16 v[64:67], a[88:91], v[132:135], v[64:67]
    buffer_load_dwordx4 a[124:127], v3, s[4:7], s30 offen offset:3072 sc1
    v_mfma_f32_16x16x32_bf16 v[68:71], a[92:95], v[132:135], v[68:71]
    s_add_u32 m0, s26, 122880
    s_add_u32 s31, s25, 122880
    ds_read_b64_tr_b16 v[204:205], v241 offset:64
    v_mfma_f32_16x16x32_bf16 v[48:51], a[88:91], v[124:127], v[48:51]
    ds_read_b128 v[100:103], v10 offset:25600
    ds_read_b128 v[80:83], v10 offset:20480
    v_mfma_f32_16x16x32_bf16 v[52:55], a[92:95], v[124:127], v[52:55]
    buffer_load_dwordx4 v1, s[4:7], s31 offen sc1 lds
    v_mfma_f32_16x16x32_bf16 v[56:59], a[88:91], v[128:131], v[56:59]
    s_add_u32 m0, s26, 126976
    s_add_u32 s31, s49, 126976
    ds_read_b64_tr_b16 v[206:207], v241 offset:4800
    v_mfma_f32_16x16x32_bf16 v[60:63], a[92:95], v[128:131], v[60:63]
    ds_read_b128 v[84:87], v10 offset:21504
    ds_read_b64_tr_b16 v[208:209], v241 offset:96
    v_mfma_f32_16x16x32_bf16 v[16:19], v[108:111], a[88:91], v[16:19]
    buffer_load_dwordx4 v1, s[4:7], s31 offen sc1 lds
    v_mfma_f32_16x16x32_bf16 v[24:27], v[108:111], a[92:95], v[24:27]
    ds_read_b64_tr_b16 v[210:211], v241 offset:4832
    ds_read_b64_tr_b16 v[212:213], v241 offset:128
    v_mfma_f32_16x16x32_bf16 v[20:23], v[112:115], a[88:91], v[20:23]
    ds_read_b64_tr_b16 v[214:215], v241 offset:4864
    ds_read_b64_tr_b16 v[216:217], v241 offset:160
    v_mfma_f32_16x16x32_bf16 v[28:31], v[112:115], a[92:95], v[28:31]
    s_waitcnt vmcnt(13) lgkmcnt(5)
    ds_read_b64_tr_b16 v[218:219], v241 offset:4896
    ds_read_b64_tr_b16 a[216:217], v241 offset:192
    v_mfma_f32_16x16x32_bf16 v[32:35], a[96:99], v[88:91], v[32:35]
    s_add_u32 s30, s24, 16384
    ds_read_b128 v[116:119], v10 offset:29696
    ds_read_b128 v[120:123], v10 offset:30720
    v_mfma_f32_16x16x32_bf16 v[36:39], a[100:103], v[88:91], v[36:39]
    buffer_load_dwordx4 a[128:131], v1, s[4:7], s30 offen offset:0 sc1
    v_mfma_f32_16x16x32_bf16 v[40:43], a[96:99], v[92:95], v[40:43]
    s_mul_i32 s28, s22, 3072
    ds_read_b64_tr_b16 a[218:219], v241 offset:4928
    ds_read_b64_tr_b16 a[220:221], v241 offset:224
    v_mfma_f32_16x16x32_bf16 v[44:47], a[100:103], v[92:95], v[44:47]
    s_add_u32 s28, s28, 19988480
    ds_read_b128 v[132:135], v10 offset:33792
    ds_read_b128 v[124:127], v10 offset:31744
    v_mfma_f32_16x16x32_bf16 v[64:67], a[96:99], v[104:107], v[64:67]
    buffer_load_dwordx4 a[132:135], v3, s[4:7], s30 offen offset:0 sc1
    v_mfma_f32_16x16x32_bf16 v[68:71], a[100:103], v[104:107], v[68:71]
    s_lshl_b32 s43, s21, 2
    ds_read_b64_tr_b16 a[222:223], v241 offset:4960
    ds_read_b64_tr_b16 a[224:225], v241 offset:256
    v_mfma_f32_16x16x32_bf16 v[48:51], a[96:99], v[96:99], v[48:51]
    s_add_u32 s43, s43, s20
    ds_read_b128 v[128:131], v10 offset:32768
    ds_read_b128 v[108:111], v10 offset:27648
    v_mfma_f32_16x16x32_bf16 v[52:55], a[100:103], v[96:99], v[52:55]
    buffer_load_dwordx4 a[136:139], v1, s[4:7], s30 offen offset:1024 sc1
    v_mfma_f32_16x16x32_bf16 v[56:59], a[96:99], v[100:103], v[56:59]
    s_lshl_b32 s43, s43, 4
    ds_read_b64_tr_b16 a[226:227], v241 offset:4992
    v_mul_f32 v152, 0x3fb8aa3b, v144
    v_mfma_f32_16x16x32_bf16 v[60:63], a[100:103], v[100:103], v[60:63]
    s_add_u32 s43, s43, s22
    ds_read_b128 v[112:115], v10 offset:28672
    v_mul_f32 v153, 0x3fb8aa3b, v145
    v_mfma_f32_16x16x32_bf16 v[16:19], v[80:83], a[96:99], v[16:19]
    buffer_load_dwordx4 a[140:143], v3, s[4:7], s30 offen offset:1024 sc1
qkv0_part_pad0_0x:
    s_cbranch_execz qkv0_part_padret0
    v_readfirstlane_b32 s51, v187
    s_nop 0
    s_cmp_ge_u32 s51, s52
    s_cbranch_scc0 qkv0_part_wow
qkv0_part_wob:
    v_mfma_f32_16x16x32_bf16 v[24:27], v[80:83], a[100:103], v[24:27]
    s_waitcnt vmcnt(12)
    v_mul_f32 v154, 0x3fb8aa3b, v146
    v_mul_f32 v155, 0x3fb8aa3b, v147
    v_mfma_f32_16x16x32_bf16 v[20:23], v[84:87], a[96:99], v[20:23]
    s_barrier
    v_mul_f32 v156, 0x3fb8aa3b, v148
    v_mul_f32 v157, 0x3fb8aa3b, v149
    v_mfma_f32_16x16x32_bf16 v[28:31], v[84:87], a[100:103], v[28:31]
    s_waitcnt lgkmcnt(0)
    v_mul_f32 v158, 0x3fb8aa3b, v150
    v_mul_f32 v159, 0x3fb8aa3b, v151
    v_mfma_f32_16x16x32_bf16 v[32:35], a[104:107], v[116:119], v[32:35]
    ds_read_b128 v[88:91], v10 offset:36864
    ds_read_b128 v[92:95], v10 offset:37888
    v_mfma_f32_16x16x32_bf16 v[36:39], a[108:111], v[116:119], v[36:39]
    global_load_dword v191, v190, s[60:61]
    v_mfma_f32_16x16x32_bf16 v[40:43], a[104:107], v[120:123], v[40:43]
    s_mul_i32 s43, s43, 2304
    v_mul_f32 v140, 0x3fb8aa3b, v136
    v_mul_f32 v141, 0x3fb8aa3b, v136
    v_mfma_f32_16x16x32_bf16 v[44:47], a[108:111], v[120:123], v[44:47]
    s_add_u32 s43, s43, 33554432
    ds_read_b128 v[104:107], v10 offset:40960
    ds_read_b128 v[96:99], v10 offset:38912
    v_mfma_f32_16x16x32_bf16 v[64:67], a[104:107], v[132:135], v[64:67]
    s_lshl_b32 s14, s22, 4
    v_mov_b32 v137, v136
    v_mul_f32 v142, 0x3fb8aa3b, v138
    v_mfma_f32_16x16x32_bf16 v[68:71], a[108:111], v[132:135], v[68:71]
    s_add_u32 s14, s14, s21
    v_mul_f32 v143, 0x3fb8aa3b, v138
    v_mov_b32 v139, v138
    v_mfma_f32_16x16x32_bf16 v[48:51], a[104:107], v[124:127], v[48:51]
    s_and_b32 s15, s14, 0
    ds_read_b128 v[100:103], v10 offset:39936
    ds_read_b128 v[80:83], v10 offset:34816
    v_mfma_f32_16x16x32_bf16 v[52:55], a[108:111], v[124:127], v[52:55]
    s_lshr_b32 s14, s14, 0
    v_lshrrev_b32 v7, 2, v11
    v_mov_b32 v8, 897988541
    v_mfma_f32_16x16x32_bf16 v[56:59], a[104:107], v[128:131], v[56:59]
    s_lshl_b32 s14, s14, 5
    v_lshl_add_u32 v7, v7, 6, v14
    v_mov_b32 v9, 897988541
    v_mfma_f32_16x16x32_bf16 v[60:63], a[108:111], v[128:131], v[60:63]
    s_add_u32 s14, s14, s15
    ds_read_b128 v[84:87], v10 offset:35840
    v_mov_b32 v15, 0x10000000
    v_mfma_f32_16x16x32_bf16 v[16:19], v[108:111], a[104:107], v[16:19]
    s_lshl_b32 s14, s14, 2
    v_and_b32 v13, 3, v11
    v_add_u32 v4, s42, v1
    v_mfma_f32_16x16x32_bf16 v[24:27], v[108:111], a[108:111], v[24:27]
    s_add_u32 s14, s14, 20054016
    v_cmp_eq_u32 vcc, 1, v13
    v_lshl_add_u32 v5, v2, 3, s42
    v_mfma_f32_16x16x32_bf16 v[20:23], v[112:115], a[104:107], v[20:23]
    s_add_u32 s31, s33, 0
    v_and_b32 v13, 2, v11
    v_lshlrev_b32 v6, 2, v0
    v_mfma_f32_16x16x32_bf16 v[28:31], v[112:115], a[108:111], v[28:31]
    s_waitcnt vmcnt(11) lgkmcnt(0)
    v_cndmask_b32 v7, v15, v7, vcc
    v_lshl_add_u32 v186, v0, 2, s54
    v_mfma_f32_16x16x32_bf16 v[32:35], a[112:115], v[88:91], v[32:35]
    ds_read_b128 v[116:119], v10 offset:44032
    ds_read_b128 v[120:123], v10 offset:45056
    v_mfma_f32_16x16x32_bf16 v[36:39], a[116:119], v[88:91], v[36:39]
    v_cmp_ne_u32 s[40:41], 0, v13
    v_mfma_f32_16x16x32_bf16 v[40:43], a[112:115], v[92:95], v[40:43]
    v_lshrrev_b32 v13, 3, v11
    v_mfma_f32_16x16x32_bf16 v[44:47], a[116:119], v[92:95], v[44:47]
    ds_read_b128 v[132:135], v10 offset:48128
    ds_read_b128 v[124:127], v10 offset:46080
    v_mfma_f32_16x16x32_bf16 v[64:67], a[112:115], v[104:107], v[64:67]
    v_and_b32 v14, 1, v11
    v_mfma_f32_16x16x32_bf16 v[68:71], a[116:119], v[104:107], v[68:71]
    v_cndmask_b32 v13, v14, v13, s[40:41]
    v_mfma_f32_16x16x32_bf16 v[48:51], a[112:115], v[96:99], v[48:51]
    ds_read_b128 v[128:131], v10 offset:47104
    ds_read_b128 v[108:111], v10 offset:41984
    v_mfma_f32_16x16x32_bf16 v[52:55], a[116:119], v[96:99], v[52:55]
    v_lshrrev_b32 v14, 1, v12
    v_mfma_f32_16x16x32_bf16 v[56:59], a[112:115], v[100:103], v[56:59]
    v_cmp_ne_u32 s[34:35], 0, v13
    v_mfma_f32_16x16x32_bf16 v[60:63], a[116:119], v[100:103], v[60:63]
    ds_read_b128 v[112:115], v10 offset:43008
    v_cmp_ne_u32 s[36:37], 0, v14
    v_mfma_f32_16x16x32_bf16 v[16:19], v[80:83], a[112:115], v[16:19]
    v_cmp_eq_u32 s[38:39], v13, v14
    v_mfma_f32_16x16x32_bf16 v[24:27], v[80:83], a[116:119], v[24:27]
    s_waitcnt vmcnt(5)
    v_mov_b32 v15, 0x3f803f80
    v_mfma_f32_16x16x32_bf16 v[20:23], v[84:87], a[112:115], v[20:23]
    s_barrier
    v_lshrrev_b32 v185, 2, v11
    v_mfma_f32_16x16x32_bf16 v[28:31], v[84:87], a[116:119], v[28:31]
    s_waitcnt lgkmcnt(0)
    v_cndmask_b32 v185, 0, v185, s[40:41]
    v_mfma_f32_16x16x32_bf16 v[32:35], a[120:123], v[116:119], v[32:35]
    ds_read_b128 v[88:91], v10 offset:51200
    ds_read_b128 v[92:95], v10 offset:52224
    v_mfma_f32_16x16x32_bf16 v[36:39], a[124:127], v[116:119], v[36:39]
    v_and_b32 v13, 3, v11
    v_mfma_f32_16x16x32_bf16 v[40:43], a[120:123], v[120:123], v[40:43]
    v_add_u32 v185, v185, v13
    v_mfma_f32_16x16x32_bf16 v[44:47], a[124:127], v[120:123], v[44:47]
    ds_read_b128 v[104:107], v10 offset:55296
    ds_read_b128 v[96:99], v10 offset:53248
    v_mfma_f32_16x16x32_bf16 v[64:67], a[120:123], v[132:135], v[64:67]
    v_mad_u32_u24 v185, v12, 6, v185
    v_mfma_f32_16x16x32_bf16 v[68:71], a[124:127], v[132:135], v[68:71]
    v_cmp_eq_u32 vcc, 3, v13
    v_mfma_f32_16x16x32_bf16 v[48:51], a[120:123], v[124:127], v[48:51]
    ds_read_b128 v[100:103], v10 offset:54272
    ds_read_b128 v[80:83], v10 offset:49152
    v_mfma_f32_16x16x32_bf16 v[52:55], a[124:127], v[124:127], v[52:55]
    v_nop
    v_mfma_f32_16x16x32_bf16 v[56:59], a[120:123], v[128:131], v[56:59]
    v_cndmask_b32 v185, v185, 24, vcc
    v_mfma_f32_16x16x32_bf16 v[60:63], a[124:127], v[128:131], v[60:63]
    ds_read_b128 v[84:87], v10 offset:50176
    v_lshl_add_u32 v185, v185, 4, s42
    v_mfma_f32_16x16x32_bf16 v[16:19], v[108:111], a[120:123], v[16:19]
    buffer_store_dwordx4 v[196:199], v1, s[4:7], s31 offen sc1
    v_mfma_f32_16x16x32_bf16 v[24:27], v[108:111], a[124:127], v[24:27]
    v_mfma_f32_16x16x32_bf16 v[20:23], v[112:115], a[120:123], v[20:23]
    v_mfma_f32_16x16x32_bf16 v[28:31], v[112:115], a[124:127], v[28:31]
    s_waitcnt vmcnt(4) lgkmcnt(0)
    v_mfma_f32_16x16x32_bf16 v[32:35], a[128:131], v[88:91], v[32:35]
    ds_read_b128 v[116:119], v10 offset:58368
    ds_read_b128 v[120:123], v10 offset:59392
    v_mfma_f32_16x16x32_bf16 v[36:39], a[132:135], v[88:91], v[36:39]
    v_mfma_f32_16x16x32_bf16 v[40:43], a[128:131], v[92:95], v[40:43]
    v_mfma_f32_16x16x32_bf16 v[44:47], a[132:135], v[92:95], v[44:47]
    ds_read_b128 v[132:135], v10 offset:62464
    ds_read_b128 v[124:127], v10 offset:60416
    v_mfma_f32_16x16x32_bf16 v[64:67], a[128:131], v[104:107], v[64:67]
    v_mfma_f32_16x16x32_bf16 v[68:71], a[132:135], v[104:107], v[68:71]
    v_mfma_f32_16x16x32_bf16 v[48:51], a[128:131], v[96:99], v[48:51]
    ds_read_b128 v[128:131], v10 offset:61440
    ds_read_b128 v[108:111], v10 offset:56320
    v_mfma_f32_16x16x32_bf16 v[52:55], a[132:135], v[96:99], v[52:55]
    v_mfma_f32_16x16x32_bf16 v[56:59], a[128:131], v[100:103], v[56:59]
    v_mfma_f32_16x16x32_bf16 v[60:63], a[132:135], v[100:103], v[60:63]
    ds_read_b128 v[112:115], v10 offset:57344
    v_mfma_f32_16x16x32_bf16 v[16:19], v[80:83], a[128:131], v[16:19]
    s_add_u32 s31, s33, 36864
    v_mfma_f32_16x16x32_bf16 v[24:27], v[80:83], a[132:135], v[24:27]
    buffer_store_dwordx4 v[200:203], v1, s[4:7], s31 offen sc1
    v_mfma_f32_16x16x32_bf16 v[20:23], v[84:87], a[128:131], v[20:23]
    v_mfma_f32_16x16x32_bf16 v[28:31], v[84:87], a[132:135], v[28:31]
    s_waitcnt vmcnt(3) lgkmcnt(0)
    v_mfma_f32_16x16x32_bf16 v[32:35], a[136:139], v[116:119], v[32:35]
    v_mfma_f32_16x16x32_bf16 v[36:39], a[140:143], v[116:119], v[36:39]
    v_mfma_f32_16x16x32_bf16 v[40:43], a[136:139], v[120:123], v[40:43]
    v_mfma_f32_16x16x32_bf16 v[44:47], a[140:143], v[120:123], v[44:47]
    v_mfma_f32_16x16x32_bf16 v[64:67], a[136:139], v[132:135], v[64:67]
    v_mfma_f32_16x16x32_bf16 v[68:71], a[140:143], v[132:135], v[68:71]
    v_mfma_f32_16x16x32_bf16 v[48:51], a[136:139], v[124:127], v[48:51]
    v_mfma_f32_16x16x32_bf16 v[52:55], a[140:143], v[124:127], v[52:55]
    v_mfma_f32_16x16x32_bf16 v[56:59], a[136:139], v[128:131], v[56:59]
    v_mfma_f32_16x16x32_bf16 v[60:63], a[140:143], v[128:131], v[60:63]
    v_mfma_f32_16x16x32_bf16 v[16:19], v[108:111], a[136:139], v[16:19]
    v_mfma_f32_16x16x32_bf16 v[24:27], v[108:111], a[140:143], v[24:27]
    v_mfma_f32_16x16x32_bf16 v[20:23], v[112:115], a[136:139], v[20:23]
    v_mfma_f32_16x16x32_bf16 v[28:31], v[112:115], a[140:143], v[28:31]
    v_pk_mul_f32 v[160:161], v[32:33], v[152:153]
    v_pk_mul_f32 v[162:163], v[34:35], v[154:155]
    v_pk_mul_f32 v[164:165], v[36:37], v[156:157]
    v_pk_mul_f32 v[166:167], v[38:39], v[158:159]
    v_exp_f32 v160, v160 clamp
    v_pk_fma_f32 v[32:33], v[32:33], v[144:145], v[8:9]
    v_exp_f32 v161, v161 clamp
    v_exp_f32 v162, v162 clamp
    v_pk_fma_f32 v[34:35], v[34:35], v[146:147], v[8:9]
    v_exp_f32 v163, v163 clamp
    v_exp_f32 v164, v164 clamp
    v_pk_fma_f32 v[36:37], v[36:37], v[148:149], v[8:9]
    s_add_u32 s31, s33, 73728
    buffer_store_dwordx4 v[204:207], v1, s[4:7], s31 offen sc1
    v_exp_f32 v165, v165 clamp
    v_exp_f32 v166, v166 clamp
    v_pk_fma_f32 v[38:39], v[38:39], v[150:151], v[8:9]
    v_exp_f32 v167, v167 clamp
    v_max_f32 v32, v8, v32
    v_max_f32 v33, v8, v33
    v_max_f32 v34, v8, v34
    v_max_f32 v35, v8, v35
    v_max_f32 v36, v8, v36
    v_max_f32 v37, v8, v37
    v_max_f32 v38, v8, v38
    v_max_f32 v39, v8, v39
    s_add_u32 s31, s33, 221184
    buffer_store_dwordx4 v[208:211], v1, s[4:7], s31 offen sc1
    v_pk_add_f32 v[32:33], v[32:33], v[160:161]
    v_pk_add_f32 v[34:35], v[34:35], v[162:163]
    v_pk_add_f32 v[36:37], v[36:37], v[164:165]
    v_pk_add_f32 v[38:39], v[38:39], v[166:167]
    v_cvt_pk_bf16_f32 v80, v32, v33
    v_cvt_pk_bf16_f32 v81, v34, v35
    v_cvt_pk_bf16_f32 v82, v36, v37
    v_cvt_pk_bf16_f32 v83, v38, v39
    v_pk_mul_f32 v[160:161], v[40:41], v[152:153]
    v_pk_mul_f32 v[162:163], v[42:43], v[154:155]
    v_pk_mul_f32 v[164:165], v[44:45], v[156:157]
    v_pk_mul_f32 v[166:167], v[46:47], v[158:159]
    s_add_u32 s31, s33, 258048
    buffer_store_dwordx4 v[212:215], v1, s[4:7], s31 offen sc1
    v_exp_f32 v160, v160 clamp
    v_pk_fma_f32 v[40:41], v[40:41], v[144:145], v[8:9]
    v_exp_f32 v161, v161 clamp
    v_exp_f32 v162, v162 clamp
    v_pk_fma_f32 v[42:43], v[42:43], v[146:147], v[8:9]
    v_exp_f32 v163, v163 clamp
    v_exp_f32 v164, v164 clamp
    v_pk_fma_f32 v[44:45], v[44:45], v[148:149], v[8:9]
    v_exp_f32 v165, v165 clamp
    v_exp_f32 v166, v166 clamp
    v_pk_fma_f32 v[46:47], v[46:47], v[150:151], v[8:9]
    v_exp_f32 v167, v167 clamp
    s_add_u32 s31, s33, 294912
    buffer_store_dwordx4 v[216:219], v1, s[4:7], s31 offen sc1
    v_max_f32 v40, v8, v40
    v_max_f32 v41, v8, v41
    v_max_f32 v42, v8, v42
    v_max_f32 v43, v8, v43
    v_max_f32 v44, v8, v44
    v_max_f32 v45, v8, v45
    v_max_f32 v46, v8, v46
    v_max_f32 v47, v8, v47
    v_pk_add_f32 v[40:41], v[40:41], v[160:161]
    v_pk_add_f32 v[42:43], v[42:43], v[162:163]
    v_pk_add_f32 v[44:45], v[44:45], v[164:165]
    v_pk_add_f32 v[46:47], v[46:47], v[166:167]
    s_add_u32 s23, s29, 8192
    buffer_load_dwordx4 a[144:147], v1, s[4:7], s23 offen offset:1024 sc1
    v_cvt_pk_bf16_f32 v84, v40, v41
    v_cvt_pk_bf16_f32 v85, v42, v43
    v_cvt_pk_bf16_f32 v86, v44, v45
    v_cvt_pk_bf16_f32 v87, v46, v47
    v_pk_mul_f32 v[160:161], v[64:65], v[152:153]
    v_pk_mul_f32 v[162:163], v[66:67], v[154:155]
    v_pk_mul_f32 v[164:165], v[68:69], v[156:157]
    v_pk_mul_f32 v[166:167], v[70:71], v[158:159]
    v_exp_f32 v160, v160 clamp
    v_pk_fma_f32 v[176:177], v[64:65], v[144:145], v[8:9]
    v_exp_f32 v161, v161 clamp
    v_exp_f32 v162, v162 clamp
    buffer_load_dwordx4 a[148:151], v1, s[4:7], s23 offen offset:2048 sc1
    v_pk_fma_f32 v[178:179], v[66:67], v[146:147], v[8:9]
    v_exp_f32 v163, v163 clamp
    v_exp_f32 v164, v164 clamp
    v_pk_fma_f32 v[180:181], v[68:69], v[148:149], v[8:9]
    v_exp_f32 v165, v165 clamp
    v_exp_f32 v166, v166 clamp
    v_pk_fma_f32 v[182:183], v[70:71], v[150:151], v[8:9]
    v_exp_f32 v167, v167 clamp
    v_max_f32 v176, v8, v176
    v_max_f32 v177, v8, v177
    v_max_f32 v178, v8, v178
    v_max_f32 v179, v8, v179
    buffer_load_dwordx4 a[152:155], v1, s[4:7], s23 offen offset:3072 sc1
    v_max_f32 v180, v8, v180
    v_max_f32 v181, v8, v181
    v_max_f32 v182, v8, v182
    v_max_f32 v183, v8, v183
    v_pk_add_f32 v[176:177], v[176:177], v[160:161]
    v_pk_add_f32 v[178:179], v[178:179], v[162:163]
    v_pk_add_f32 v[180:181], v[180:181], v[164:165]
    v_pk_add_f32 v[182:183], v[182:183], v[166:167]
    v_cvt_pk_bf16_f32 v96, v176, v177
    v_cvt_pk_bf16_f32 v97, v178, v179
    v_cvt_pk_bf16_f32 v98, v180, v181
    v_cvt_pk_bf16_f32 v99, v182, v183
    s_add_u32 s23, s29, 20480
    buffer_load_dwordx4 a[156:159], v1, s[4:7], s23 offen offset:1024 sc1
    v_pk_mul_f32 v[64:65], v[64:65], v[144:145]
    v_pk_mul_f32 v[66:67], v[66:67], v[146:147]
    v_pk_mul_f32 v[68:69], v[68:69], v[148:149]
    v_pk_mul_f32 v[70:71], v[70:71], v[150:151]
    v_cvt_pk_bf16_f32 v100, v64, v65
    v_cvt_pk_bf16_f32 v101, v66, v67
    v_cvt_pk_bf16_f32 v102, v68, v69
    v_cvt_pk_bf16_f32 v103, v70, v71
    v_cndmask_b32 v100, v15, v100, s[40:41]
    v_cndmask_b32 v101, v15, v101, s[40:41]
    v_cndmask_b32 v102, v15, v102, s[40:41]
    v_cndmask_b32 v103, v15, v103, s[40:41]
    buffer_load_dwordx4 a[160:163], v1, s[4:7], s23 offen offset:2048 sc1
    v_pk_mul_f32 v[48:49], v[48:49], v[144:145]
    v_pk_mul_f32 v[50:51], v[50:51], v[146:147]
    v_pk_mul_f32 v[52:53], v[52:53], v[148:149]
    v_pk_mul_f32 v[54:55], v[54:55], v[150:151]
    v_cvt_pk_bf16_f32 v88, v48, v49
    v_cvt_pk_bf16_f32 v89, v50, v51
    v_cvt_pk_bf16_f32 v90, v52, v53
    v_cvt_pk_bf16_f32 v91, v54, v55
    v_pk_mul_f32 v[56:57], v[56:57], v[144:145]
    v_pk_mul_f32 v[58:59], v[58:59], v[146:147]
    v_pk_mul_f32 v[60:61], v[60:61], v[148:149]
    v_pk_mul_f32 v[62:63], v[62:63], v[150:151]
    buffer_load_dwordx4 a[164:167], v1, s[4:7], s23 offen offset:3072 sc1
    v_cvt_pk_bf16_f32 v92, v56, v57
    v_cvt_pk_bf16_f32 v93, v58, v59
    v_cvt_pk_bf16_f32 v94, v60, v61
    v_cvt_pk_bf16_f32 v95, v62, v63
    s_nop 0
    v_mfma_f32_16x16x32_bf16 v[112:115], v[80:83], v[100:103], 0
    v_cvt_pk_bf16_f32 v132, v176, v180
    v_mfma_f32_16x16x32_bf16 v[116:119], v[84:87], v[100:103], 0
    v_cvt_pk_bf16_f32 v133, v177, v181
    v_mfma_f32_16x16x32_bf16 v[128:131], v[96:99], v[100:103], 0
    v_cvt_pk_bf16_f32 v134, v178, v182
    v_mfma_f32_16x16x32_bf16 v[120:123], v[96:99], v[88:91], 0
    v_cvt_pk_bf16_f32 v135, v179, v183
    s_add_u32 s23, s29, 32768
    buffer_load_dwordx4 a[168:171], v1, s[4:7], s23 offen offset:1024 sc1
    v_mfma_f32_16x16x32_bf16 v[124:127], v[96:99], v[92:95], 0
    v_mfma_f32_16x16x32_bf16 v[104:107], v[80:83], v[88:91], 0
    v_mfma_f32_16x16x32_bf16 v[108:111], v[84:87], v[92:95], 0
    v_cndmask_b32 v112, v112, v116, s[34:35]
    v_cndmask_b32 v113, v113, v117, s[34:35]
    v_cndmask_b32 v114, v114, v118, s[34:35]
    v_cndmask_b32 v115, v115, v119, s[34:35]
    v_cndmask_b32 v121, 0, v128, s[38:39]
    v_cndmask_b32 v120, v120, v124, s[36:37]
    ds_write_b128 v185, v[112:115] offset:2560
    ds_write_b64 v5, v[120:121] offset:2048
    ds_write_b128 v4, v[104:107]
    ds_write_b128 v4, v[108:111] offset:1024
    buffer_store_dwordx4 v[132:135], v7, s[4:7], s43 offen offset:2048 sc1
    s_waitcnt lgkmcnt(0)
    s_barrier
    ds_read2st64_b32 v[104:105], v186 offset0:0 offset1:12
    ds_read2st64_b32 v[106:107], v186 offset0:24 offset1:36
    ds_read2st64_b32 v[108:109], v186 offset0:4 offset1:16
    ds_read2st64_b32 v[110:111], v186 offset0:28 offset1:40
    ds_read2st64_b32 v[112:113], v186 offset0:8 offset1:20
    ds_read2st64_b32 v[114:115], v186 offset0:32 offset1:44
    s_waitcnt lgkmcnt(4)
    v_pk_add_f32 v[104:105], v[104:105], v[106:107]
    v_add_f32 v104, v104, v105
    buffer_atomic_add_f32 v104, v6, s[4:7], s28 offen offset:0
    s_waitcnt lgkmcnt(2)
    v_pk_add_f32 v[108:109], v[108:109], v[110:111]
    buffer_load_dwordx4 a[172:175], v1, s[4:7], s23 offen offset:2048 sc1
    v_add_f32 v108, v108, v109
    buffer_atomic_add_f32 v108, v6, s[4:7], s28 offen offset:1024
    s_waitcnt lgkmcnt(0)
    v_pk_add_f32 v[112:113], v[112:113], v[114:115]
    v_add_f32 v112, v112, v113
    buffer_atomic_add_f32 v112, v6, s[4:7], s28 offen offset:2048
qkv0_part_na:
    v_pk_mul_f32 v[160:161], v[16:17], v[140:141]
    v_pk_mul_f32 v[162:163], v[18:19], v[140:141]
    v_pk_mul_f32 v[164:165], v[20:21], v[140:141]
    v_pk_mul_f32 v[166:167], v[22:23], v[140:141]
    v_exp_f32 v160, v160 clamp
    v_pk_fma_f32 v[176:177], v[16:17], v[136:137], v[8:9]
    v_exp_f32 v161, v161 clamp
    v_exp_f32 v162, v162 clamp
    v_pk_fma_f32 v[178:179], v[18:19], v[136:137], v[8:9]
    buffer_load_dwordx4 a[176:179], v1, s[4:7], s23 offen offset:3072 sc1
    v_exp_f32 v163, v163 clamp
    v_exp_f32 v164, v164 clamp
    v_pk_fma_f32 v[180:181], v[20:21], v[136:137], v[8:9]
    v_exp_f32 v165, v165 clamp
    v_exp_f32 v166, v166 clamp
    v_pk_fma_f32 v[182:183], v[22:23], v[136:137], v[8:9]
    v_exp_f32 v167, v167 clamp
    v_max_f32 v176, v8, v176
    v_max_f32 v177, v8, v177
    v_max_f32 v178, v8, v178
    v_max_f32 v179, v8, v179
    v_max_f32 v180, v8, v180
    s_add_u32 s23, s29, 45056
    buffer_load_dwordx4 a[180:183], v1, s[4:7], s23 offen offset:1024 sc1
    v_max_f32 v181, v8, v181
    v_max_f32 v182, v8, v182
    v_max_f32 v183, v8, v183
    v_pk_add_f32 v[176:177], v[176:177], v[160:161]
    v_pk_add_f32 v[178:179], v[178:179], v[162:163]
    v_pk_add_f32 v[180:181], v[180:181], v[164:165]
    v_pk_add_f32 v[182:183], v[182:183], v[166:167]
    v_cvt_pk_bf16_f32 v80, v176, v177
    v_cvt_pk_bf16_f32 v81, v178, v179
    v_cvt_pk_bf16_f32 v82, v180, v181
    v_cvt_pk_bf16_f32 v83, v182, v183
    buffer_store_dwordx4 v[80:83], v1, s[4:7], s43 offen offset:0 sc1
    v_pk_mul_f32 v[160:161], v[24:25], v[142:143]
    v_pk_mul_f32 v[162:163], v[26:27], v[142:143]
    v_pk_mul_f32 v[164:165], v[28:29], v[142:143]
    v_pk_mul_f32 v[166:167], v[30:31], v[142:143]
    v_exp_f32 v160, v160 clamp
    v_pk_fma_f32 v[176:177], v[24:25], v[138:139], v[8:9]
    v_exp_f32 v161, v161 clamp
    v_exp_f32 v162, v162 clamp
    v_pk_fma_f32 v[178:179], v[26:27], v[138:139], v[8:9]
    v_exp_f32 v163, v163 clamp
    v_exp_f32 v164, v164 clamp
    v_pk_fma_f32 v[180:181], v[28:29], v[138:139], v[8:9]
    v_exp_f32 v165, v165 clamp
    v_exp_f32 v166, v166 clamp
    v_pk_fma_f32 v[182:183], v[30:31], v[138:139], v[8:9]
    v_exp_f32 v167, v167 clamp
    v_max_f32 v176, v8, v176
    v_max_f32 v177, v8, v177
    v_max_f32 v178, v8, v178
    v_max_f32 v179, v8, v179
    v_max_f32 v180, v8, v180
    v_max_f32 v181, v8, v181
    v_max_f32 v182, v8, v182
    v_max_f32 v183, v8, v183
    v_pk_add_f32 v[176:177], v[176:177], v[160:161]
    v_pk_add_f32 v[178:179], v[178:179], v[162:163]
    v_pk_add_f32 v[180:181], v[180:181], v[164:165]
    v_pk_add_f32 v[182:183], v[182:183], v[166:167]
    v_cvt_pk_bf16_f32 v84, v176, v177
    v_cvt_pk_bf16_f32 v85, v178, v179
    v_cvt_pk_bf16_f32 v86, v180, v181
    v_cvt_pk_bf16_f32 v87, v182, v183
    buffer_store_dwordx4 v[84:87], v1, s[4:7], s43 offen offset:1024 sc1
    s_branch ffn0_part_body
qkv0_part_wow:
    s_mov_b32 s51, 0
    s_atomic_add s51, s[4:5], s50 offset:0 glc
    s_add_u32 s8, s8, 1
    s_waitcnt lgkmcnt(0)
    s_cmp_ge_u32 s51, 19
    s_cbranch_scc1 qkv0_part_wowk
    s_cmp_lt_u32 s8, 0x80000
    s_cbranch_scc1 qkv0_part_wow
qkv0_part_wowk:
    s_branch qkv0_part_wob
qkv0_part_end:
    s_endpgm
ffn0_part:
    s_branch ffn0_part_body
.p2align 12
ffn0_part_body:
    v_and_b32 v2, 63, v0
    v_lshrrev_b32 v10, 6, v0
    s_and_b32 s21, s2, 7
    s_lshl_b32 s21, s21, 1
    s_bfe_u32 s23, s2, 65539
    s_add_u32 s21, s21, s23
    s_lshr_b32 s22, s2, 4
    v_readfirstlane_b32 s20, v10
    s_lshl_b32 s12, s22, 2
    s_lshr_b32 s13, s21, 2
    s_add_u32 s12, s12, s13
    s_and_b32 s13, s21, 3
    v_lshlrev_b32 v1, 4, v2
    v_lshlrev_b32 v3, 3, v2
    v_lshlrev_b32 v4, 2, v2
    v_and_b32 v11, 15, v2
    v_lshrrev_b32 v12, 4, v2
    s_mul_i32 s24, s20, 12288
    s_add_u32 s24, s24, 19988480
    s_lshl_b32 s25, s12, 2
    s_add_u32 s25, s25, s20
    s_mul_i32 s25, s25, 9216
    s_add_u32 s25, s25, 33554432
    s_mul_i32 s26, s13, 3
    s_add_u32 s26, s26, s20
    s_mul_i32 s29, s26, 55296
    s_add_u32 s29, s29, 18939904
    s_cmp_eq_u32 s20, 3
    s_cbranch_scc1 ffn0_part_s3a
    s_add_u32 s30, s29, 45056
    buffer_load_dwordx4 a[184:187], v1, s[4:7], s30 offen offset:2048 sc1
    buffer_load_dwordx4 a[188:191], v1, s[4:7], s30 offen offset:3072 sc1
    s_add_u32 s30, s29, 49152
    buffer_load_dwordx4 a[192:195], v1, s[4:7], s30 offen offset:0 sc1
    buffer_load_dwordx4 a[196:199], v1, s[4:7], s30 offen offset:1024 sc1
    buffer_load_dwordx4 a[200:203], v1, s[4:7], s30 offen offset:2048 sc1
    buffer_load_dwordx4 a[204:207], v1, s[4:7], s30 offen offset:3072 sc1
    s_add_u32 s30, s29, 53248
    buffer_load_dwordx4 a[208:211], v1, s[4:7], s30 offen offset:0 sc1
    buffer_load_dwordx4 a[212:215], v1, s[4:7], s30 offen offset:1024 sc1
    s_add_u32 s30, s29, 0
    buffer_load_dwordx4 a[0:3], v1, s[4:7], s30 offen offset:0 sc1
    buffer_load_dwordx4 a[4:7], v1, s[4:7], s30 offen offset:1024 sc1
ffn0_part_s3a:
    v_and_b32 v13, 2, v11
    v_cmp_ne_u32 vcc, 0, v13
    v_lshrrev_b32 v13, 3, v11
    v_and_b32 v14, 1, v11
    v_cndmask_b32 v13, v14, v13, vcc
    v_cmp_ne_u32 s[34:35], 0, v13
    v_cmp_lt_u32 s[36:37], 31, v2
    v_lshrrev_b32 v15, 2, v11
    v_add_u32 v15, 2, v15
    v_cndmask_b32 v15, v14, v15, vcc
    v_mad_u32_u24 v15, v12, 6, v15
    v_lshlrev_b32 v15, 4, v15
    v_mov_b32 v73, 0
    v_mov_b32 v79, 0
    v_mov_b32 v81, 0
    v_mov_b32 v87, 0
    v_mov_b32 v89, 0
    v_mov_b32 v95, 0
    v_mov_b32 v97, 0
    v_mov_b32 v103, 0
    v_mov_b32 v105, 0
    v_mov_b32 v111, 0
    v_mov_b32 v113, 0
    v_mov_b32 v119, 0
    v_mov_b32 v121, 0
    v_mov_b32 v127, 0
    v_mov_b32 v129, 0
    v_mov_b32 v135, 0
    v_mov_b32 v137, 0
    v_mov_b32 v143, 0
    v_mov_b32 v145, 0
    v_mov_b32 v151, 0
    v_mov_b32 v153, 0
    v_mov_b32 v159, 0
    v_mov_b32 v161, 0
    v_mov_b32 v167, 0
    s_lshl_b32 s27, s20, 12
    v_add_u32 v5, s27, v1
    s_lshr_b32 s27, s20, 1
    s_lshl_b32 s27, s27, 10
    s_and_b32 s28, s20, 1
    s_lshl_b32 s28, s28, 3
    s_add_u32 s27, s27, s28
    s_add_u32 s27, s27, 16384
    v_add_u32 v6, s27, v1
    v_mov_b32 v8, 897988541
    v_mov_b32 v9, 897988541
    s_mul_i32 s27, s12, 36864
    s_mul_i32 s28, s26, 1536
    s_add_u32 s27, s27, s28
    s_lshr_b32 s28, s12, 2
    s_mul_i32 s28, s28, 4096
    s_add_u32 s27, s27, s28
    s_add_u32 s40, s27, 20971520
    s_add_u32 s41, s27, 20989952
    s_add_u32 s42, s27, 27262976
    s_add_u32 s43, s27, 27281408
    v_lshrrev_b32 v7, 5, v2
    v_mul_u32_u24 v7, 17920, v7
    v_add_u32 v7, v7, v1
    s_load_dwordx2 s[16:17], s[0:1], 48
    s_mov_b32 s18, 5308416
    s_mov_b32 s19, 0x00020000
    s_and_b32 s44, s2, 7
    s_lshl_b32 s44, s44, 1
    s_bfe_u32 s45, s2, 0x10003
    s_add_u32 s44, s44, s45
    s_lshr_b32 s45, s2, 4
    s_mul_i32 s28, s45, 72
    s_cmp_gt_u32 s45, 4
    s_cselect_b32 s27, 320, 0
    s_sub_u32 s28, s28, s27
    s_lshl_b32 s27, s20, 3
    s_add_u32 s28, s28, s27
    s_mul_i32 s27, s20, 72
    s_add_u32 s27, s27, 32
    s_cmp_eq_u32 s45, 4
    s_cselect_b32 s28, s27, s28
    s_mul_i32 s27, s44, 288
    s_add_u32 s28, s28, s27
    s_mul_i32 s28, s28, 1152
    s_cmp_lt_u32 s2, 144
    s_cselect_b32 s46, s28, 268435456
    s_mul_i32 s47, s20, 9216
    s_waitcnt lgkmcnt(0)
    v_mov_b32 v254, 1
    v_lshlrev_b32 v10, 7, v0
    s_mov_b32 s9, 20054016
    s_mov_b32 s8, 0
    s_cmp_eq_u32 s20, 3
    s_cbranch_scc1 ffn0_part_s3b
    s_waitcnt vmcnt(10)
    s_barrier
    s_and_b32 s14, s14, 0xfffff800
    s_lshl_b32 s27, s20, 9
    s_add_u32 s14, s14, s27
    s_atomic_add s3, s[4:5], s14 offset:0
    s_atomic_add s3, s[4:5], s14 offset:128
    s_atomic_add s3, s[4:5], s14 offset:256
    s_atomic_add s3, s[4:5], s14 offset:384
    s_add_u32 s30, s29, 0
    buffer_load_dwordx4 a[8:11], v1, s[4:7], s30 offen offset:2048 sc1
    s_add_u32 s30, s29, 12288
    buffer_load_dwordx4 a[12:15], v1, s[4:7], s30 offen offset:0 sc1
    buffer_load_dwordx4 a[16:19], v1, s[4:7], s30 offen offset:1024 sc1
    buffer_load_dwordx4 a[20:23], v1, s[4:7], s30 offen offset:2048 sc1
    s_add_u32 s30, s29, 24576
    buffer_load_dwordx4 a[24:27], v1, s[4:7], s30 offen offset:0 sc1
    buffer_load_dwordx4 a[28:31], v1, s[4:7], s30 offen offset:1024 sc1
    buffer_load_dwordx4 a[32:35], v1, s[4:7], s30 offen offset:2048 sc1
    s_add_u32 s30, s29, 36864
    buffer_load_dwordx4 a[36:39], v1, s[4:7], s30 offen offset:0 sc1
    buffer_load_dwordx4 a[40:43], v1, s[4:7], s30 offen offset:1024 sc1
    buffer_load_dwordx4 a[44:47], v1, s[4:7], s30 offen offset:2048 sc1
    s_add_u32 s30, s29, 0
    buffer_load_dwordx4 a[48:51], v1, s[4:7], s30 offen offset:3072 sc1
    s_add_u32 s30, s29, 4096
    buffer_load_dwordx4 a[52:55], v1, s[4:7], s30 offen offset:0 sc1
    buffer_load_dwordx4 a[56:59], v1, s[4:7], s30 offen offset:1024 sc1
    s_add_u32 s30, s29, 12288
    buffer_load_dwordx4 a[60:63], v1, s[4:7], s30 offen offset:3072 sc1
    s_add_u32 s30, s29, 16384
    buffer_load_dwordx4 a[64:67], v1, s[4:7], s30 offen offset:0 sc1
    buffer_load_dwordx4 a[68:71], v1, s[4:7], s30 offen offset:1024 sc1
    s_branch ffn0_part_s3c
ffn0_part_s3b:
    s_waitcnt vmcnt(0)
    s_barrier
    s_and_b32 s14, s14, 0xfffff800
    s_lshl_b32 s27, s20, 9
    s_add_u32 s14, s14, s27
    s_atomic_add s3, s[4:5], s14 offset:0
    s_atomic_add s3, s[4:5], s14 offset:128
    s_atomic_add s3, s[4:5], s14 offset:256
    s_atomic_add s3, s[4:5], s14 offset:384
    v_and_b32 v13, 1, v11
    v_lshlrev_b32 v13, 6, v13
    v_lshl_add_u32 v13, v12, 4, v13
    s_mov_b32 s30, 19922944
    buffer_load_dwordx4 a[144:147], v13, s[4:7], s30 offen offset:0 sc1
    buffer_load_dwordx4 a[148:151], v13, s[4:7], s30 offen offset:128 sc1
    buffer_load_dwordx4 a[152:155], v13, s[4:7], s30 offen offset:256 sc1
    buffer_load_dwordx4 a[156:159], v13, s[4:7], s30 offen offset:384 sc1
    buffer_load_dwordx4 a[160:163], v13, s[4:7], s30 offen offset:512 sc1
    buffer_load_dwordx4 a[164:167], v13, s[4:7], s30 offen offset:640 sc1
    buffer_load_dwordx4 a[168:171], v13, s[4:7], s30 offen offset:768 sc1
    buffer_load_dwordx4 a[172:175], v13, s[4:7], s30 offen offset:896 sc1
    buffer_load_dwordx4 a[176:179], v13, s[4:7], s30 offen offset:1024 sc1
    buffer_load_dwordx4 a[180:183], v13, s[4:7], s30 offen offset:1152 sc1
    buffer_load_dwordx4 a[184:187], v13, s[4:7], s30 offen offset:1280 sc1
    buffer_load_dwordx4 a[188:191], v13, s[4:7], s30 offen offset:1408 sc1
    buffer_load_dwordx4 a[192:195], v13, s[4:7], s30 offen offset:1536 sc1
    buffer_load_dwordx4 a[196:199], v13, s[4:7], s30 offen offset:1664 sc1
    buffer_load_dwordx4 a[200:203], v13, s[4:7], s30 offen offset:1792 sc1
    buffer_load_dwordx4 a[204:207], v13, s[4:7], s30 offen offset:1920 sc1
    buffer_load_dwordx4 a[208:211], v13, s[4:7], s30 offen offset:2048 sc1
    buffer_load_dwordx4 a[212:215], v13, s[4:7], s30 offen offset:2176 sc1
ffn0_part_s3c:
    s_mov_b64 exec, 0
    s_cmp_eq_u32 s20, 0
    s_cbranch_scc1 ffn0_part_pad0_0x
    s_cmp_eq_u32 s20, 1
    s_cbranch_scc1 ffn0_part_pad0_1x
    s_cmp_eq_u32 s20, 2
    s_cbranch_scc1 ffn0_part_pad0_2x
    s_branch ffn0_part_pad0_3x
ffn0_part_padret0:
    s_mov_b64 exec, -1
    s_lshl_b32 s48, s20, 13
    s_add_u32 s9, s9, s48
    s_lshl_b32 s48, s22, 7
    s_add_u32 s9, s9, s48
ffn0_part_sq:
    s_mov_b32 s48, 0
    s_atomic_add s48, s[4:5], s9 offset:0 glc
    s_mov_b32 s49, 0
    s_atomic_add s49, s[4:5], s9 offset:2048 glc
    s_mov_b32 s50, 0
    s_atomic_add s50, s[4:5], s9 offset:4096 glc
    s_mov_b32 s51, 0
    s_atomic_add s51, s[4:5], s9 offset:6144 glc
    s_add_u32 s8, s8, 1
    s_waitcnt lgkmcnt(0)
    s_min_u32 s48, s48, s49
    s_min_u32 s48, s48, s50
    s_min_u32 s48, s48, s51
    s_cmp_ge_u32 s48, 16
    s_cbranch_scc1 ffn0_part_sqk
    s_cmp_lt_u32 s8, 0x80000
    s_cbranch_scc1 ffn0_part_sq
ffn0_part_sqk:
    buffer_load_dwordx4 v[16:19], v1, s[4:7], s24 offen offset:0 sc1
    buffer_load_dwordx4 v[20:23], v1, s[4:7], s24 offen offset:1024 sc1
    buffer_load_dwordx4 v[24:27], v15, s[4:7], s24 offen offset:2560 sc1
    buffer_load_dwordx2 v[28:29], v3, s[4:7], s24 offen offset:2048 sc1
    buffer_load_dwordx4 v[74:77], v1, s[4:7], s25 offen offset:0 sc1
    buffer_load_dwordx4 v[82:85], v1, s[4:7], s25 offen offset:1024 sc1
    buffer_load_dword v72, v4, s[4:7], s25 offen offset:2048 sc1
    s_add_u32 s24, s24, 3072
    s_add_u32 s25, s25, 2304
    buffer_load_dwordx4 v[30:33], v1, s[4:7], s24 offen offset:0 sc1
    buffer_load_dwordx4 v[34:37], v1, s[4:7], s24 offen offset:1024 sc1
    buffer_load_dwordx4 v[38:41], v15, s[4:7], s24 offen offset:2560 sc1
    buffer_load_dwordx2 v[42:43], v3, s[4:7], s24 offen offset:2048 sc1
    buffer_load_dwordx4 v[90:93], v1, s[4:7], s25 offen offset:0 sc1
    buffer_load_dwordx4 v[98:101], v1, s[4:7], s25 offen offset:1024 sc1
    buffer_load_dword v88, v4, s[4:7], s25 offen offset:2048 sc1
    s_add_u32 s24, s24, 3072
    s_add_u32 s25, s25, 2304
    buffer_load_dwordx4 v[44:47], v1, s[4:7], s24 offen offset:0 sc1
    buffer_load_dwordx4 v[48:51], v1, s[4:7], s24 offen offset:1024 sc1
    buffer_load_dwordx4 v[52:55], v15, s[4:7], s24 offen offset:2560 sc1
    buffer_load_dwordx2 v[56:57], v3, s[4:7], s24 offen offset:2048 sc1
    buffer_load_dwordx4 v[106:109], v1, s[4:7], s25 offen offset:0 sc1
    buffer_load_dwordx4 v[114:117], v1, s[4:7], s25 offen offset:1024 sc1
    buffer_load_dword v104, v4, s[4:7], s25 offen offset:2048 sc1
    s_add_u32 s24, s24, 3072
    s_add_u32 s25, s25, 2304
    buffer_load_dwordx4 v[58:61], v1, s[4:7], s24 offen offset:0 sc1
    buffer_load_dwordx4 v[62:65], v1, s[4:7], s24 offen offset:1024 sc1
    buffer_load_dwordx4 v[66:69], v15, s[4:7], s24 offen offset:2560 sc1
    buffer_load_dwordx2 v[70:71], v3, s[4:7], s24 offen offset:2048 sc1
    buffer_load_dwordx4 v[122:125], v1, s[4:7], s25 offen offset:0 sc1
    buffer_load_dwordx4 v[130:133], v1, s[4:7], s25 offen offset:1024 sc1
    buffer_load_dword v120, v4, s[4:7], s25 offen offset:2048 sc1
    s_cmp_eq_u32 s20, 3
    s_cbranch_scc1 ffn0_part_w3
    v_mov_b32 v252, 897988541
    v_mov_b32 v253, 897988541
    v_mov_b32 v254, 0
    v_mov_b32 v255, 0
    s_waitcnt vmcnt(24)
    v_cvt_pk_bf16_f32 v24, v24, v25
    v_cvt_pk_bf16_f32 v25, v26, v27
    v_cvt_pk_bf16_f32 v28, v28, 0
    v_cvt_pk_bf16_f32 v29, v29, 0
    v_cvt_pk_bf16_f32 v138, v16, v17
    v_cvt_pk_bf16_f32 v139, v18, v19
    v_cvt_pk_bf16_f32 v140, v20, v21
    v_cvt_pk_bf16_f32 v141, v22, v23
    v_cndmask_b32 v146, v24, 0, s[34:35]
    v_cndmask_b32 v147, v25, 0, s[34:35]
    v_cndmask_b32 v148, 0, v24, s[34:35]
    v_cndmask_b32 v149, 0, v25, s[34:35]
    s_waitcnt vmcnt(21)
    v_mov_b32 v78, v72
    v_lshrrev_b32 v80, 16, v72
    v_lshrrev_b32 v86, 16, v72
    v_cndmask_b32 v144, v29, 0, s[36:37]
    v_cndmask_b32 v150, 0, v29, s[36:37]
    v_cndmask_b32 v136, v28, 0, s[36:37]
    v_cndmask_b32 v142, 0, v28, s[36:37]
    s_nop 0
    v_mfma_f32_16x16x32_bf16 v[176:179], v[144:147], v[72:75], v[252:255]
    s_waitcnt vmcnt(17)
    v_cvt_pk_bf16_f32 v38, v38, v39
    v_cvt_pk_bf16_f32 v39, v40, v41
    v_mfma_f32_16x16x32_bf16 v[176:179], v[148:151], v[76:79], v[176:179]
    s_add_u32 s30, s29, 27648
    buffer_load_dwordx4 a[72:75], v1, s[4:7], s30 offen sc1
    v_cvt_pk_bf16_f32 v42, v42, 0
    v_cvt_pk_bf16_f32 v43, v43, 0
    v_cvt_pk_bf16_f32 v154, v30, v31
    v_mfma_f32_16x16x32_bf16 v[188:191], v[144:147], v[80:83], v[252:255]
    v_cvt_pk_bf16_f32 v155, v32, v33
    v_cvt_pk_bf16_f32 v156, v34, v35
    v_mfma_f32_16x16x32_bf16 v[188:191], v[148:151], v[84:87], v[188:191]
    s_add_u32 s30, s29, 28672
    buffer_load_dwordx4 a[76:79], v1, s[4:7], s30 offen sc1
    v_cvt_pk_bf16_f32 v157, v36, v37
    v_cndmask_b32 v162, v38, 0, s[34:35]
    v_cndmask_b32 v163, v39, 0, s[34:35]
    v_mfma_f32_16x16x32_bf16 v[168:171], v[136:139], v[72:75], 0
    v_cndmask_b32 v164, 0, v38, s[34:35]
    v_cndmask_b32 v165, 0, v39, s[34:35]
    s_waitcnt vmcnt(16)
    v_mfma_f32_16x16x32_bf16 v[172:175], v[140:143], v[76:79], 0
    s_add_u32 s30, s29, 29696
    buffer_load_dwordx4 a[80:83], v1, s[4:7], s30 offen sc1
    v_mov_b32 v94, v88
    v_lshrrev_b32 v96, 16, v88
    v_mfma_f32_16x16x32_bf16 v[180:183], v[136:139], v[80:83], 0
    v_lshrrev_b32 v102, 16, v88
    v_cndmask_b32 v160, v43, 0, s[36:37]
    v_cndmask_b32 v166, 0, v43, s[36:37]
    v_mfma_f32_16x16x32_bf16 v[184:187], v[140:143], v[84:87], 0
    s_add_u32 s30, s29, 39936
    buffer_load_dwordx4 a[84:87], v1, s[4:7], s30 offen sc1
    v_cndmask_b32 v152, v42, 0, s[36:37]
    v_cndmask_b32 v158, 0, v42, s[36:37]
    v_mfma_f32_16x16x32_bf16 v[200:203], v[160:163], v[88:91], v[252:255]
    v_rcp_f32 v176, v176
    v_rcp_f32 v177, v177
    v_rcp_f32 v188, v188
    v_rcp_f32 v189, v189
    v_mul_f32 v168, v168, v176
    v_mfma_f32_16x16x32_bf16 v[200:203], v[164:167], v[92:95], v[200:203]
    s_add_u32 s30, s29, 40960
    buffer_load_dwordx4 a[88:91], v1, s[4:7], s30 offen sc1
    v_mul_f32 v169, v169, v176
    v_mul_f32 v170, v170, v176
    v_mul_f32 v171, v171, v176
    v_mul_f32 v172, v172, v177
    v_mfma_f32_16x16x32_bf16 v[212:215], v[160:163], v[96:99], v[252:255]
    v_mul_f32 v173, v173, v177
    v_mul_f32 v174, v174, v177
    v_mul_f32 v175, v175, v177
    v_cndmask_b32 v176, v176, v177, s[36:37]
    v_mfma_f32_16x16x32_bf16 v[212:215], v[164:167], v[100:103], v[212:215]
    s_add_u32 s30, s29, 41984
    buffer_load_dwordx4 a[92:95], v1, s[4:7], s30 offen sc1
    v_cvt_pk_bf16_f32 v216, v168, v169
    v_cvt_pk_bf16_f32 v217, v170, v171
    v_cvt_pk_bf16_f32 v218, v172, v173
    v_cvt_pk_bf16_f32 v219, v174, v175
    v_mfma_f32_16x16x32_bf16 v[192:195], v[152:155], v[88:91], 0
    v_mul_f32 v232, v178, v176
    v_mfma_f32_16x16x32_bf16 v[196:199], v[156:159], v[92:95], 0
    s_add_u32 m0, s47, 65536
    s_add_u32 s45, s46, 0
    buffer_load_dwordx4 v1, s[16:19], s45 offen lds
    ds_write_b128 v5, v[216:219] offset:0
    v_mul_f32 v180, v180, v188
    v_mul_f32 v181, v181, v188
    v_mul_f32 v182, v182, v188
    v_mul_f32 v183, v183, v188
    v_mul_f32 v184, v184, v189
    v_mul_f32 v185, v185, v189
    v_mul_f32 v186, v186, v189
    v_mfma_f32_16x16x32_bf16 v[204:207], v[152:155], v[96:99], 0
    v_mul_f32 v187, v187, v189
    v_cndmask_b32 v188, v188, v189, s[36:37]
    v_cvt_pk_bf16_f32 v220, v180, v181
    v_cvt_pk_bf16_f32 v221, v182, v183
    v_mfma_f32_16x16x32_bf16 v[208:211], v[156:159], v[100:103], 0
    s_add_u32 s30, s29, 6144
    buffer_load_dwordx4 a[96:99], v1, s[4:7], s30 offen sc1
    v_cvt_pk_bf16_f32 v222, v184, v185
    v_cvt_pk_bf16_f32 v223, v186, v187
    v_mul_f32 v236, v190, v188
    ds_write_b128 v5, v[220:223] offset:18432
    s_waitcnt vmcnt(18)
    v_cvt_pk_bf16_f32 v52, v52, v53
    v_cvt_pk_bf16_f32 v53, v54, v55
    v_cvt_pk_bf16_f32 v56, v56, 0
    v_cvt_pk_bf16_f32 v57, v57, 0
    v_cvt_pk_bf16_f32 v138, v44, v45
    v_cvt_pk_bf16_f32 v139, v46, v47
    v_cvt_pk_bf16_f32 v140, v48, v49
    v_cvt_pk_bf16_f32 v141, v50, v51
    s_waitcnt lgkmcnt(0)
    s_barrier
    ds_read_b128 v[72:75], v1 offset:0
    ds_read_b128 v[76:79], v1 offset:18432
    ds_read_b128 v[80:83], v1 offset:4096
    ds_read_b128 v[84:87], v1 offset:22528
    ds_read_b128 v[88:91], v1 offset:8192
    ds_read_b128 v[92:95], v1 offset:26624
    v_cndmask_b32 v146, v52, 0, s[34:35]
    v_cndmask_b32 v147, v53, 0, s[34:35]
    v_cndmask_b32 v148, 0, v52, s[34:35]
    v_cndmask_b32 v149, 0, v53, s[34:35]
    s_waitcnt lgkmcnt(4)
    v_mfma_f32_16x16x32_bf16 v[16:19], a[0:3], v[72:75], 0
    ds_read_b128 v[96:99], v1 offset:12288
    ds_read_b128 v[100:103], v1 offset:30720
    v_rcp_f32 v200, v200
    v_rcp_f32 v201, v201
    v_rcp_f32 v212, v212
    v_mfma_f32_16x16x32_bf16 v[24:27], a[0:3], v[76:79], 0
    s_add_u32 m0, s47, 66560
    s_add_u32 s45, s46, 1024
    buffer_load_dwordx4 v1, s[16:19], s45 offen lds
    v_rcp_f32 v213, v213
    v_mul_f32 v192, v192, v200
    v_mfma_f32_16x16x32_bf16 v[20:23], a[4:7], v[72:75], 0
    v_mul_f32 v193, v193, v200
    v_mul_f32 v194, v194, v200
    v_mul_f32 v195, v195, v200
    v_mfma_f32_16x16x32_bf16 v[28:31], a[4:7], v[76:79], 0
    s_add_u32 s30, s29, 7168
    buffer_load_dwordx4 a[100:103], v1, s[4:7], s30 offen sc1
    v_mul_f32 v196, v196, v201
    v_mul_f32 v197, v197, v201
    v_mfma_f32_16x16x32_bf16 v[32:35], a[8:11], v[72:75], 0
    v_mul_f32 v198, v198, v201
    v_mul_f32 v199, v199, v201
    v_cndmask_b32 v200, v200, v201, s[36:37]
    v_mfma_f32_16x16x32_bf16 v[36:39], a[8:11], v[76:79], 0
    s_add_u32 m0, s47, 67584
    s_add_u32 s45, s46, 2048
    buffer_load_dwordx4 v1, s[16:19], s45 offen lds
    v_cvt_pk_bf16_f32 v224, v192, v193
    v_cvt_pk_bf16_f32 v225, v194, v195
    s_waitcnt lgkmcnt(4)
    v_mfma_f32_16x16x32_bf16 v[16:19], a[12:15], v[80:83], v[16:19]
    v_cvt_pk_bf16_f32 v226, v196, v197
    v_cvt_pk_bf16_f32 v227, v198, v199
    v_mfma_f32_16x16x32_bf16 v[24:27], a[12:15], v[84:87], v[24:27]
    s_add_u32 s30, s29, 8192
    buffer_load_dwordx4 a[104:107], v1, s[4:7], s30 offen sc1
    v_mul_f32 v233, v202, v200
    v_mfma_f32_16x16x32_bf16 v[20:23], a[16:19], v[80:83], v[20:23]
    ds_write_b128 v5, v[224:227] offset:1024
    v_mul_f32 v204, v204, v212
    v_mul_f32 v205, v205, v212
    v_mul_f32 v206, v206, v212
    v_mfma_f32_16x16x32_bf16 v[28:31], a[16:19], v[84:87], v[28:31]
    s_add_u32 m0, s47, 68608
    s_add_u32 s45, s46, 3072
    buffer_load_dwordx4 v1, s[16:19], s45 offen lds
    v_mul_f32 v207, v207, v212
    v_mul_f32 v208, v208, v213
    v_mul_f32 v209, v209, v213
    v_mfma_f32_16x16x32_bf16 v[32:35], a[20:23], v[80:83], v[32:35]
    v_mul_f32 v210, v210, v213
    v_mul_f32 v211, v211, v213
    v_mfma_f32_16x16x32_bf16 v[36:39], a[20:23], v[84:87], v[36:39]
    s_add_u32 s30, s29, 18432
    buffer_load_dwordx4 a[108:111], v1, s[4:7], s30 offen sc1
    v_cndmask_b32 v212, v212, v213, s[36:37]
    v_cvt_pk_bf16_f32 v228, v204, v205
    v_cvt_pk_bf16_f32 v229, v206, v207
    s_waitcnt lgkmcnt(3)
    v_mfma_f32_16x16x32_bf16 v[16:19], a[24:27], v[88:91], v[16:19]
    v_cvt_pk_bf16_f32 v230, v208, v209
    v_cvt_pk_bf16_f32 v231, v210, v211
    v_mfma_f32_16x16x32_bf16 v[24:27], a[24:27], v[92:95], v[24:27]
    s_add_u32 m0, s47, 69632
    s_add_u32 s45, s46, 4096
    buffer_load_dwordx4 v1, s[16:19], s45 offen lds
    v_mul_f32 v237, v214, v212
    v_mfma_f32_16x16x32_bf16 v[20:23], a[28:31], v[88:91], v[20:23]
    ds_write_b128 v5, v[228:231] offset:19456
    s_waitcnt vmcnt(22)
    v_mov_b32 v110, v104
    v_lshrrev_b32 v112, 16, v104
    v_mfma_f32_16x16x32_bf16 v[28:31], a[28:31], v[92:95], v[28:31]
    s_add_u32 s30, s29, 19456
    buffer_load_dwordx4 a[112:115], v1, s[4:7], s30 offen sc1
    v_lshrrev_b32 v118, 16, v104
    v_cndmask_b32 v144, v57, 0, s[36:37]
    v_mfma_f32_16x16x32_bf16 v[32:35], a[32:35], v[88:91], v[32:35]
    v_cndmask_b32 v150, 0, v57, s[36:37]
    v_cndmask_b32 v136, v56, 0, s[36:37]
    v_cndmask_b32 v142, 0, v56, s[36:37]
    v_mfma_f32_16x16x32_bf16 v[36:39], a[32:35], v[92:95], v[36:39]
    s_add_u32 m0, s47, 70656
    s_add_u32 s45, s46, 5120
    buffer_load_dwordx4 v1, s[16:19], s45 offen lds
    s_waitcnt lgkmcnt(0)
    s_barrier
    v_mfma_f32_16x16x32_bf16 v[16:19], a[36:39], v[96:99], v[16:19]
    ds_read_b128 v[72:75], v1 offset:1024
    ds_read_b128 v[76:79], v1 offset:19456
    ds_read_b128 v[80:83], v1 offset:5120
    ds_read_b128 v[84:87], v1 offset:23552
    ds_read_b128 v[88:91], v1 offset:9216
    ds_read_b128 v[92:95], v1 offset:27648
    v_mfma_f32_16x16x32_bf16 v[24:27], a[36:39], v[100:103], v[24:27]
    s_add_u32 s30, s29, 20480
    buffer_load_dwordx4 a[116:119], v1, s[4:7], s30 offen sc1
    v_mfma_f32_16x16x32_bf16 v[20:23], a[40:43], v[96:99], v[20:23]
    v_mfma_f32_16x16x32_bf16 v[28:31], a[40:43], v[100:103], v[28:31]
    s_add_u32 m0, s47, 71680
    s_add_u32 s45, s46, 6144
    buffer_load_dwordx4 v1, s[16:19], s45 offen lds
    v_mfma_f32_16x16x32_bf16 v[32:35], a[44:47], v[96:99], v[32:35]
    v_mfma_f32_16x16x32_bf16 v[36:39], a[44:47], v[100:103], v[36:39]
    s_add_u32 s30, s29, 30720
    buffer_load_dwordx4 a[120:123], v1, s[4:7], s30 offen sc1
    s_add_u32 s31, s33, 442368
    buffer_store_dwordx4 a[216:219], v1, s[4:7], s31 offen sc1
    v_mfma_f32_16x16x32_bf16 v[176:179], v[144:147], v[104:107], v[252:255]
    s_waitcnt vmcnt(24)
    v_cvt_pk_bf16_f32 v66, v66, v67
    v_mfma_f32_16x16x32_bf16 v[176:179], v[148:151], v[108:111], v[176:179]
    s_add_u32 m0, s47, 72704
    s_add_u32 s45, s46, 7168
    buffer_load_dwordx4 v1, s[16:19], s45 offen lds
    v_cvt_pk_bf16_f32 v67, v68, v69
    v_cvt_pk_bf16_f32 v70, v70, 0
    v_mfma_f32_16x16x32_bf16 v[188:191], v[144:147], v[112:115], v[252:255]
    v_cvt_pk_bf16_f32 v71, v71, 0
    v_mfma_f32_16x16x32_bf16 v[188:191], v[148:151], v[116:119], v[188:191]
    s_add_u32 s30, s29, 31744
    buffer_load_dwordx4 a[124:127], v1, s[4:7], s30 offen sc1
    v_cvt_pk_bf16_f32 v154, v58, v59
    v_cvt_pk_bf16_f32 v155, v60, v61
    v_mfma_f32_16x16x32_bf16 v[168:171], v[136:139], v[104:107], 0
    v_cvt_pk_bf16_f32 v156, v62, v63
    v_cvt_pk_bf16_f32 v157, v64, v65
    v_mfma_f32_16x16x32_bf16 v[172:175], v[140:143], v[108:111], 0
    s_add_u32 m0, s47, 73728
    s_add_u32 s45, s46, 8192
    buffer_load_dwordx4 v1, s[16:19], s45 offen lds
    v_cndmask_b32 v162, v66, 0, s[34:35]
    v_mfma_f32_16x16x32_bf16 v[180:183], v[136:139], v[112:115], 0
    v_cndmask_b32 v163, v67, 0, s[34:35]
    v_cndmask_b32 v164, 0, v66, s[34:35]
    v_mfma_f32_16x16x32_bf16 v[184:187], v[140:143], v[116:119], 0
    s_add_u32 s30, s29, 32768
    buffer_load_dwordx4 a[128:131], v1, s[4:7], s30 offen sc1
    v_cndmask_b32 v165, 0, v67, s[34:35]
    s_waitcnt lgkmcnt(4)
    v_mfma_f32_16x16x32_bf16 v[16:19], a[48:51], v[72:75], v[16:19]
    ds_read_b128 v[96:99], v1 offset:13312
    ds_read_b128 v[100:103], v1 offset:31744
    v_rcp_f32 v176, v176
    v_rcp_f32 v177, v177
    v_rcp_f32 v188, v188
    v_mfma_f32_16x16x32_bf16 v[24:27], a[48:51], v[76:79], v[24:27]
    s_add_u32 s30, s29, 43008
    buffer_load_dwordx4 a[132:135], v1, s[4:7], s30 offen sc1
    v_rcp_f32 v189, v189
    v_mul_f32 v168, v168, v176
    v_mfma_f32_16x16x32_bf16 v[20:23], a[52:55], v[72:75], v[20:23]
    v_mul_f32 v169, v169, v176
    v_mul_f32 v170, v170, v176
    v_mul_f32 v171, v171, v176
    v_mfma_f32_16x16x32_bf16 v[28:31], a[52:55], v[76:79], v[28:31]
    s_add_u32 s30, s29, 44032
    buffer_load_dwordx4 a[136:139], v1, s[4:7], s30 offen sc1
    v_mul_f32 v172, v172, v177
    v_mul_f32 v173, v173, v177
    v_mfma_f32_16x16x32_bf16 v[32:35], a[56:59], v[72:75], v[32:35]
    v_mul_f32 v174, v174, v177
    v_mul_f32 v175, v175, v177
    v_cndmask_b32 v176, v176, v177, s[36:37]
    v_mfma_f32_16x16x32_bf16 v[36:39], a[56:59], v[76:79], v[36:39]
    s_add_u32 s30, s29, 45056
    buffer_load_dwordx4 a[140:143], v1, s[4:7], s30 offen sc1
    v_cvt_pk_bf16_f32 v216, v168, v169
    v_cvt_pk_bf16_f32 v217, v170, v171
    s_waitcnt lgkmcnt(4)
    v_mfma_f32_16x16x32_bf16 v[16:19], a[60:63], v[80:83], v[16:19]
    v_cvt_pk_bf16_f32 v218, v172, v173
    v_cvt_pk_bf16_f32 v219, v174, v175
    v_mfma_f32_16x16x32_bf16 v[24:27], a[60:63], v[84:87], v[24:27]
    buffer_load_dwordx4 v[240:243], v1, s[4:7], s40 offen offset:0 sc1
    v_mul_f32 v234, v178, v176
    v_mfma_f32_16x16x32_bf16 v[20:23], a[64:67], v[80:83], v[20:23]
    ds_write_b128 v5, v[216:219] offset:2048
    v_mul_f32 v180, v180, v188
    v_mul_f32 v181, v181, v188
    v_mul_f32 v182, v182, v188
    v_mfma_f32_16x16x32_bf16 v[28:31], a[64:67], v[84:87], v[28:31]
    buffer_load_dwordx4 v[244:247], v1, s[4:7], s41 offen offset:0 sc1
    v_mul_f32 v183, v183, v188
    v_mul_f32 v184, v184, v189
    v_mul_f32 v185, v185, v189
    v_mfma_f32_16x16x32_bf16 v[32:35], a[68:71], v[80:83], v[32:35]
    v_mul_f32 v186, v186, v189
    v_mul_f32 v187, v187, v189
    v_mfma_f32_16x16x32_bf16 v[36:39], a[68:71], v[84:87], v[36:39]
    buffer_load_dwordx4 v[248:251], v7, s[4:7], s40 offen offset:1024 sc1
    v_cndmask_b32 v188, v188, v189, s[36:37]
    v_cvt_pk_bf16_f32 v220, v180, v181
    v_cvt_pk_bf16_f32 v221, v182, v183
    s_waitcnt vmcnt(28) lgkmcnt(3)
    v_mfma_f32_16x16x32_bf16 v[16:19], a[72:75], v[88:91], v[16:19]
    v_cvt_pk_bf16_f32 v222, v184, v185
    v_cvt_pk_bf16_f32 v223, v186, v187
    v_mfma_f32_16x16x32_bf16 v[24:27], a[72:75], v[92:95], v[24:27]
    v_mul_f32 v238, v190, v188
    v_mfma_f32_16x16x32_bf16 v[20:23], a[76:79], v[88:91], v[20:23]
    ds_write_b128 v5, v[220:223] offset:20480
    v_mov_b32 v126, v120
    v_lshrrev_b32 v128, 16, v120
    v_mfma_f32_16x16x32_bf16 v[28:31], a[76:79], v[92:95], v[28:31]
    v_lshrrev_b32 v134, 16, v120
    v_cndmask_b32 v160, v71, 0, s[36:37]
    v_mfma_f32_16x16x32_bf16 v[32:35], a[80:83], v[88:91], v[32:35]
    v_cndmask_b32 v166, 0, v71, s[36:37]
    v_cndmask_b32 v152, v70, 0, s[36:37]
    v_cndmask_b32 v158, 0, v70, s[36:37]
    v_mfma_f32_16x16x32_bf16 v[36:39], a[80:83], v[92:95], v[36:39]
    s_waitcnt lgkmcnt(0)
    s_barrier
    s_waitcnt vmcnt(25)
    v_mfma_f32_16x16x32_bf16 v[16:19], a[84:87], v[96:99], v[16:19]
    ds_read_b128 v[72:75], v1 offset:2048
    ds_read_b128 v[76:79], v1 offset:20480
    ds_read_b128 v[80:83], v1 offset:6144
    ds_read_b128 v[84:87], v1 offset:24576
    ds_read_b128 v[88:91], v1 offset:10240
    ds_read_b128 v[92:95], v1 offset:28672
    v_mfma_f32_16x16x32_bf16 v[24:27], a[84:87], v[100:103], v[24:27]
    v_mfma_f32_16x16x32_bf16 v[20:23], a[88:91], v[96:99], v[20:23]
ffn0_part_pad0_0x:
    s_cbranch_execz ffn0_part_pad0_4x
    v_mfma_f32_16x16x32_bf16 v[28:31], a[88:91], v[100:103], v[28:31]
    v_mfma_f32_16x16x32_bf16 v[32:35], a[92:95], v[96:99], v[32:35]
    v_mfma_f32_16x16x32_bf16 v[36:39], a[92:95], v[100:103], v[36:39]
    s_add_u32 s31, s33, 479232
    buffer_store_dwordx4 a[220:223], v1, s[4:7], s31 offen sc1
    v_mfma_f32_16x16x32_bf16 v[200:203], v[160:163], v[120:123], v[252:255]
    v_mfma_f32_16x16x32_bf16 v[200:203], v[164:167], v[124:127], v[200:203]
    v_mfma_f32_16x16x32_bf16 v[212:215], v[160:163], v[128:131], v[252:255]
    v_mfma_f32_16x16x32_bf16 v[212:215], v[164:167], v[132:135], v[212:215]
    v_mfma_f32_16x16x32_bf16 v[192:195], v[152:155], v[120:123], 0
    v_mfma_f32_16x16x32_bf16 v[196:199], v[156:159], v[124:127], 0
    v_mfma_f32_16x16x32_bf16 v[204:207], v[152:155], v[128:131], 0
    v_rcp_f32 v200, v200
    v_rcp_f32 v201, v201
    v_rcp_f32 v212, v212
    v_mfma_f32_16x16x32_bf16 v[208:211], v[156:159], v[132:135], 0
    v_rcp_f32 v213, v213
    v_mul_f32 v192, v192, v200
    s_waitcnt vmcnt(20) lgkmcnt(4)
    v_mfma_f32_16x16x32_bf16 v[16:19], a[96:99], v[72:75], v[16:19]
    ds_read_b128 v[96:99], v1 offset:14336
    ds_read_b128 v[100:103], v1 offset:32768
    v_mul_f32 v193, v193, v200
    v_mul_f32 v194, v194, v200
    v_mfma_f32_16x16x32_bf16 v[24:27], a[96:99], v[76:79], v[24:27]
    v_mul_f32 v195, v195, v200
    v_mul_f32 v196, v196, v201
    v_mul_f32 v197, v197, v201
    v_mfma_f32_16x16x32_bf16 v[20:23], a[100:103], v[72:75], v[20:23]
    v_mul_f32 v198, v198, v201
    v_mul_f32 v199, v199, v201
    v_mfma_f32_16x16x32_bf16 v[28:31], a[100:103], v[76:79], v[28:31]
    v_cndmask_b32 v200, v200, v201, s[36:37]
    v_cvt_pk_bf16_f32 v224, v192, v193
    v_mfma_f32_16x16x32_bf16 v[32:35], a[104:107], v[72:75], v[32:35]
    v_cvt_pk_bf16_f32 v225, v194, v195
    v_cvt_pk_bf16_f32 v226, v196, v197
    v_cvt_pk_bf16_f32 v227, v198, v199
    v_mfma_f32_16x16x32_bf16 v[36:39], a[104:107], v[76:79], v[36:39]
    v_mul_f32 v235, v202, v200
    s_waitcnt vmcnt(14) lgkmcnt(4)
    v_mfma_f32_16x16x32_bf16 v[16:19], a[108:111], v[80:83], v[16:19]
    ds_write_b128 v5, v[224:227] offset:3072
    v_mul_f32 v204, v204, v212
    v_mul_f32 v205, v205, v212
    v_mfma_f32_16x16x32_bf16 v[24:27], a[108:111], v[84:87], v[24:27]
    v_mul_f32 v206, v206, v212
    v_mul_f32 v207, v207, v212
    v_mul_f32 v208, v208, v213
    v_mfma_f32_16x16x32_bf16 v[20:23], a[112:115], v[80:83], v[20:23]
    v_mul_f32 v209, v209, v213
    v_mul_f32 v210, v210, v213
    v_mfma_f32_16x16x32_bf16 v[28:31], a[112:115], v[84:87], v[28:31]
    v_mul_f32 v211, v211, v213
    v_cndmask_b32 v212, v212, v213, s[36:37]
    v_mfma_f32_16x16x32_bf16 v[32:35], a[116:119], v[80:83], v[32:35]
    v_cvt_pk_bf16_f32 v228, v204, v205
    v_cvt_pk_bf16_f32 v229, v206, v207
    v_cvt_pk_bf16_f32 v230, v208, v209
    v_mfma_f32_16x16x32_bf16 v[36:39], a[116:119], v[84:87], v[36:39]
    v_cvt_pk_bf16_f32 v231, v210, v211
    v_mul_f32 v239, v214, v212
    s_waitcnt vmcnt(7) lgkmcnt(3)
    v_mfma_f32_16x16x32_bf16 v[16:19], a[120:123], v[88:91], v[16:19]
    ds_write_b128 v5, v[228:231] offset:21504
    v_cvt_pk_bf16_f32 v232, v232, v233
    v_mfma_f32_16x16x32_bf16 v[24:27], a[120:123], v[92:95], v[24:27]
    v_cvt_pk_bf16_f32 v233, v234, v235
    v_mfma_f32_16x16x32_bf16 v[20:23], a[124:127], v[88:91], v[20:23]
    ds_write_b64 v6, v[232:233] offset:0
    v_cvt_pk_bf16_f32 v236, v236, v237
    v_cvt_pk_bf16_f32 v237, v238, v239
    v_mfma_f32_16x16x32_bf16 v[28:31], a[124:127], v[92:95], v[28:31]
    ds_write_b64 v6, v[236:237] offset:18432
    v_lshlrev_b32 v13, 2, v11
    v_lshrrev_b32 v14, 5, v2
    v_mfma_f32_16x16x32_bf16 v[32:35], a[128:131], v[88:91], v[32:35]
    v_lshl_add_u32 v14, v14, 6, v13
    v_and_b32 v15, 1, v12
    v_cmp_eq_u32 vcc, 0, v15
    v_mfma_f32_16x16x32_bf16 v[36:39], a[128:131], v[92:95], v[36:39]
    s_waitcnt lgkmcnt(0)
    s_barrier
    s_waitcnt vmcnt(4)
    v_mfma_f32_16x16x32_bf16 v[16:19], a[132:135], v[96:99], v[16:19]
    ds_read_b128 v[72:75], v1 offset:3072
    ds_read_b128 v[76:79], v1 offset:21504
    ds_read_b128 v[80:83], v1 offset:7168
    ds_read_b128 v[84:87], v1 offset:25600
    ds_read_b128 v[88:91], v1 offset:11264
    ds_read_b128 v[92:95], v1 offset:29696
    v_mfma_f32_16x16x32_bf16 v[24:27], a[132:135], v[100:103], v[24:27]
    v_mfma_f32_16x16x32_bf16 v[20:23], a[136:139], v[96:99], v[20:23]
    v_mfma_f32_16x16x32_bf16 v[28:31], a[136:139], v[100:103], v[28:31]
    v_mfma_f32_16x16x32_bf16 v[32:35], a[140:143], v[96:99], v[32:35]
    v_mfma_f32_16x16x32_bf16 v[36:39], a[140:143], v[100:103], v[36:39]
    s_add_u32 s31, s33, 516096
    buffer_store_dwordx4 a[224:227], v1, s[4:7], s31 offen sc1
    s_waitcnt lgkmcnt(4)
    v_mfma_f32_16x16x32_bf16 v[16:19], a[144:147], v[72:75], v[16:19]
    ds_read_b128 v[96:99], v1 offset:15360
    ds_read_b128 v[100:103], v1 offset:33792
    s_waitcnt vmcnt(2)
    v_mfma_f32_16x16x32_bf16 v[24:27], a[144:147], v[76:79], v[24:27]
    v_lshlrev_b32 v168, 16, v240
    v_mfma_f32_16x16x32_bf16 v[20:23], a[148:151], v[72:75], v[20:23]
    v_and_b32 v169, 0xffff0000, v240
    v_mfma_f32_16x16x32_bf16 v[28:31], a[148:151], v[76:79], v[28:31]
    v_lshlrev_b32 v170, 16, v241
    v_mfma_f32_16x16x32_bf16 v[32:35], a[152:155], v[72:75], v[32:35]
    v_and_b32 v171, 0xffff0000, v241
    v_mfma_f32_16x16x32_bf16 v[36:39], a[152:155], v[76:79], v[36:39]
    v_lshlrev_b32 v172, 16, v242
    s_waitcnt lgkmcnt(4)
    v_mfma_f32_16x16x32_bf16 v[16:19], a[156:159], v[80:83], v[16:19]
    ds_read_b128 v[72:75], v1 offset:16384
    ds_read_b128 v[76:79], v1 offset:34816
    v_and_b32 v173, 0xffff0000, v242
    v_mfma_f32_16x16x32_bf16 v[24:27], a[156:159], v[84:87], v[24:27]
    v_lshlrev_b32 v174, 16, v243
    v_mfma_f32_16x16x32_bf16 v[20:23], a[160:163], v[80:83], v[20:23]
    v_and_b32 v175, 0xffff0000, v243
    v_mfma_f32_16x16x32_bf16 v[28:31], a[160:163], v[84:87], v[28:31]
    v_lshlrev_b32 v176, 16, v244
    v_mfma_f32_16x16x32_bf16 v[32:35], a[164:167], v[80:83], v[32:35]
    v_mfma_f32_16x16x32_bf16 v[36:39], a[164:167], v[84:87], v[36:39]
    v_and_b32 v177, 0xffff0000, v244
    s_waitcnt lgkmcnt(4)
    v_mfma_f32_16x16x32_bf16 v[16:19], a[168:171], v[88:91], v[16:19]
    ds_read_b128 v[80:83], v1 offset:17408
    ds_read_b128 v[84:87], v1 offset:35840
    v_lshlrev_b32 v178, 16, v245
    v_mfma_f32_16x16x32_bf16 v[24:27], a[168:171], v[92:95], v[24:27]
    v_and_b32 v179, 0xffff0000, v245
    v_mfma_f32_16x16x32_bf16 v[20:23], a[172:175], v[88:91], v[20:23]
    v_lshlrev_b32 v180, 16, v246
    v_mfma_f32_16x16x32_bf16 v[28:31], a[172:175], v[92:95], v[28:31]
    v_and_b32 v181, 0xffff0000, v246
    v_mfma_f32_16x16x32_bf16 v[32:35], a[176:179], v[88:91], v[32:35]
    v_lshlrev_b32 v182, 16, v247
    v_mfma_f32_16x16x32_bf16 v[36:39], a[176:179], v[92:95], v[36:39]
    v_and_b32 v183, 0xffff0000, v247
    s_waitcnt lgkmcnt(4)
    v_mfma_f32_16x16x32_bf16 v[16:19], a[180:183], v[96:99], v[16:19]
    v_lshlrev_b32 v184, 16, v248
    v_mfma_f32_16x16x32_bf16 v[24:27], a[180:183], v[100:103], v[24:27]
    v_and_b32 v185, 0xffff0000, v248
    v_mfma_f32_16x16x32_bf16 v[20:23], a[184:187], v[96:99], v[20:23]
    v_mfma_f32_16x16x32_bf16 v[28:31], a[184:187], v[100:103], v[28:31]
    v_lshlrev_b32 v186, 16, v249
    v_mfma_f32_16x16x32_bf16 v[32:35], a[188:191], v[96:99], v[32:35]
    v_and_b32 v187, 0xffff0000, v249
    v_mfma_f32_16x16x32_bf16 v[36:39], a[188:191], v[100:103], v[36:39]
    v_lshlrev_b32 v188, 16, v250
    s_waitcnt lgkmcnt(2)
    v_mfma_f32_16x16x32_bf16 v[16:19], a[192:195], v[72:75], v[16:19]
    v_and_b32 v189, 0xffff0000, v250
    v_mfma_f32_16x16x32_bf16 v[24:27], a[192:195], v[76:79], v[24:27]
    v_lshlrev_b32 v190, 16, v251
    v_mfma_f32_16x16x32_bf16 v[20:23], a[196:199], v[72:75], v[20:23]
    v_and_b32 v191, 0xffff0000, v251
    v_mfma_f32_16x16x32_bf16 v[28:31], a[196:199], v[76:79], v[28:31]
    s_lshl_b32 s27, s12, 7
    v_mfma_f32_16x16x32_bf16 v[32:35], a[200:203], v[72:75], v[32:35]
    s_add_u32 s27, s27, 39960576
    v_mfma_f32_16x16x32_bf16 v[36:39], a[200:203], v[76:79], v[36:39]
    s_barrier
    ds_read_b32 v192, v13 offset:36864
    ds_read_b32 v194, v13 offset:36928
    ds_read_b32 v196, v14 offset:36864
    s_waitcnt lgkmcnt(3)
    v_mfma_f32_16x16x32_bf16 v[16:19], a[204:207], v[80:83], v[16:19]
    v_mfma_f32_16x16x32_bf16 v[24:27], a[204:207], v[84:87], v[24:27]
    v_mfma_f32_16x16x32_bf16 v[20:23], a[208:211], v[80:83], v[20:23]
    v_mfma_f32_16x16x32_bf16 v[28:31], a[208:211], v[84:87], v[28:31]
    v_mfma_f32_16x16x32_bf16 v[32:35], a[212:215], v[80:83], v[32:35]
    v_mfma_f32_16x16x32_bf16 v[36:39], a[212:215], v[84:87], v[36:39]
    s_waitcnt lgkmcnt(0)
    v_pk_add_f32 v[168:169], v[168:169], v[192:193] op_sel_hi:[1,0] neg_lo:[0,1] neg_hi:[0,1]
    v_pk_add_f32 v[170:171], v[170:171], v[192:193] op_sel_hi:[1,0] neg_lo:[0,1] neg_hi:[0,1]
    v_pk_add_f32 v[172:173], v[172:173], v[192:193] op_sel_hi:[1,0] neg_lo:[0,1] neg_hi:[0,1]
    v_pk_add_f32 v[174:175], v[174:175], v[192:193] op_sel_hi:[1,0] neg_lo:[0,1] neg_hi:[0,1]
    v_pk_add_f32 v[176:177], v[176:177], v[194:195] op_sel_hi:[1,0] neg_lo:[0,1] neg_hi:[0,1]
    v_pk_add_f32 v[178:179], v[178:179], v[194:195] op_sel_hi:[1,0] neg_lo:[0,1] neg_hi:[0,1]
    v_pk_add_f32 v[180:181], v[180:181], v[194:195] op_sel_hi:[1,0] neg_lo:[0,1] neg_hi:[0,1]
    v_pk_add_f32 v[182:183], v[182:183], v[194:195] op_sel_hi:[1,0] neg_lo:[0,1] neg_hi:[0,1]
    v_pk_add_f32 v[184:185], v[184:185], v[196:197] op_sel_hi:[1,0] neg_lo:[0,1] neg_hi:[0,1]
    v_pk_add_f32 v[186:187], v[186:187], v[196:197] op_sel_hi:[1,0] neg_lo:[0,1] neg_hi:[0,1]
    v_pk_add_f32 v[188:189], v[188:189], v[196:197] op_sel_hi:[1,0] neg_lo:[0,1] neg_hi:[0,1]
    v_pk_add_f32 v[190:191], v[190:191], v[196:197] op_sel_hi:[1,0] neg_lo:[0,1] neg_hi:[0,1]
    v_pk_add_f32 v[16:17], v[16:17], v[168:169]
    v_pk_add_f32 v[18:19], v[18:19], v[170:171]
    v_pk_add_f32 v[20:21], v[20:21], v[172:173]
    v_pk_add_f32 v[22:23], v[22:23], v[174:175]
    v_cvt_pk_bf16_f32 v200, v16, v17
    v_cvt_pk_bf16_f32 v201, v18, v19
    v_cvt_pk_bf16_f32 v202, v20, v21
    v_cvt_pk_bf16_f32 v203, v22, v23
    buffer_store_dwordx4 v[200:203], v1, s[4:7], s42 offen sc1
    v_permlane32_swap_b32 v32, v36
    v_permlane32_swap_b32 v33, v37
    v_permlane32_swap_b32 v34, v38
    v_permlane32_swap_b32 v35, v39
    v_pk_add_f32 v[24:25], v[24:25], v[176:177]
    v_pk_add_f32 v[26:27], v[26:27], v[178:179]
    v_pk_add_f32 v[28:29], v[28:29], v[180:181]
    v_pk_add_f32 v[30:31], v[30:31], v[182:183]
    v_cvt_pk_bf16_f32 v204, v24, v25
    v_cvt_pk_bf16_f32 v205, v26, v27
    v_cvt_pk_bf16_f32 v206, v28, v29
    v_cvt_pk_bf16_f32 v207, v30, v31
    buffer_store_dwordx4 v[204:207], v1, s[4:7], s43 offen sc1
    v_pk_add_f32 v[32:33], v[32:33], v[184:185]
    v_pk_add_f32 v[34:35], v[34:35], v[186:187]
    v_pk_add_f32 v[36:37], v[36:37], v[188:189]
    v_pk_add_f32 v[38:39], v[38:39], v[190:191]
    v_cvt_pk_bf16_f32 v208, v32, v33
    v_cvt_pk_bf16_f32 v209, v34, v35
    v_cvt_pk_bf16_f32 v210, v36, v37
    v_cvt_pk_bf16_f32 v211, v38, v39
    buffer_store_dwordx4 v[208:211], v7, s[4:7], s42 offen offset:1024 sc1
    v_pk_mul_f32 v[192:193], v[16:17], v[16:17]
    v_pk_mul_f32 v[194:195], v[24:25], v[24:25]
    v_pk_mul_f32 v[196:197], v[32:33], v[32:33]
    v_pk_fma_f32 v[192:193], v[18:19], v[18:19], v[192:193]
    v_pk_fma_f32 v[194:195], v[26:27], v[26:27], v[194:195]
    v_pk_fma_f32 v[196:197], v[34:35], v[34:35], v[196:197]
    v_pk_fma_f32 v[192:193], v[20:21], v[20:21], v[192:193]
    v_pk_fma_f32 v[194:195], v[28:29], v[28:29], v[194:195]
    v_pk_fma_f32 v[196:197], v[36:37], v[36:37], v[196:197]
    v_pk_fma_f32 v[192:193], v[22:23], v[22:23], v[192:193]
    v_pk_fma_f32 v[194:195], v[30:31], v[30:31], v[194:195]
    v_pk_fma_f32 v[196:197], v[38:39], v[38:39], v[196:197]
    v_add_f32 v192, v192, v193
    v_add_f32 v193, v194, v195
    v_add_f32 v194, v196, v197
    s_nop 0
    v_permlane32_swap_b32 v192, v193
    v_add_f32 v192, v192, v193
    v_add_f32 v192, v192, v194
    v_mov_b32 v193, v192
    s_nop 1
    v_permlane16_swap_b32 v192, v193
    v_add_f32 v192, v192, v193
    s_and_saveexec_b64 s[38:39], vcc
    buffer_atomic_add_f32 v192, v14, s[4:7], s27 offen
    s_mov_b64 exec, -1
    s_branch ffn0_part_ffn
ffn0_part_w3:
    v_mov_b32 v252, 897988541
    v_mov_b32 v253, 897988541
    v_mov_b32 v254, 0
    v_mov_b32 v255, 0
    s_waitcnt vmcnt(24)
    v_cvt_pk_bf16_f32 v24, v24, v25
    v_cvt_pk_bf16_f32 v25, v26, v27
    v_cvt_pk_bf16_f32 v28, v28, 0
    v_cvt_pk_bf16_f32 v29, v29, 0
    v_cvt_pk_bf16_f32 v138, v16, v17
    v_cvt_pk_bf16_f32 v139, v18, v19
    v_cvt_pk_bf16_f32 v140, v20, v21
    v_cvt_pk_bf16_f32 v141, v22, v23
    v_cndmask_b32 v146, v24, 0, s[34:35]
    v_cndmask_b32 v147, v25, 0, s[34:35]
    v_cndmask_b32 v148, 0, v24, s[34:35]
    v_cndmask_b32 v149, 0, v25, s[34:35]
    s_waitcnt vmcnt(21)
    v_mov_b32 v78, v72
    v_lshrrev_b32 v80, 16, v72
    v_lshrrev_b32 v86, 16, v72
    v_cndmask_b32 v144, v29, 0, s[36:37]
    v_cndmask_b32 v150, 0, v29, s[36:37]
    v_cndmask_b32 v136, v28, 0, s[36:37]
    v_cndmask_b32 v142, 0, v28, s[36:37]
    s_nop 0
    v_mfma_f32_16x16x32_bf16 v[176:179], v[144:147], v[72:75], v[252:255]
    s_waitcnt vmcnt(17)
    v_cvt_pk_bf16_f32 v38, v38, v39
    v_cvt_pk_bf16_f32 v39, v40, v41
    v_mfma_f32_16x16x32_bf16 v[176:179], v[148:151], v[76:79], v[176:179]
    s_add_u32 m0, s47, 65536
    s_add_u32 s45, s46, 0
    buffer_load_dwordx4 v1, s[16:19], s45 offen lds
    v_cvt_pk_bf16_f32 v42, v42, 0
    v_cvt_pk_bf16_f32 v43, v43, 0
    v_cvt_pk_bf16_f32 v154, v30, v31
    v_mfma_f32_16x16x32_bf16 v[188:191], v[144:147], v[80:83], v[252:255]
    v_cvt_pk_bf16_f32 v155, v32, v33
    v_cvt_pk_bf16_f32 v156, v34, v35
    v_mfma_f32_16x16x32_bf16 v[188:191], v[148:151], v[84:87], v[188:191]
    s_add_u32 m0, s47, 66560
    s_add_u32 s45, s46, 1024
    buffer_load_dwordx4 v1, s[16:19], s45 offen lds
    v_cvt_pk_bf16_f32 v157, v36, v37
    v_cndmask_b32 v162, v38, 0, s[34:35]
    v_cndmask_b32 v163, v39, 0, s[34:35]
    v_mfma_f32_16x16x32_bf16 v[168:171], v[136:139], v[72:75], 0
    v_cndmask_b32 v164, 0, v38, s[34:35]
    v_cndmask_b32 v165, 0, v39, s[34:35]
    s_waitcnt vmcnt(16)
    v_mfma_f32_16x16x32_bf16 v[172:175], v[140:143], v[76:79], 0
    s_add_u32 m0, s47, 67584
    s_add_u32 s45, s46, 2048
    buffer_load_dwordx4 v1, s[16:19], s45 offen lds
    v_mov_b32 v94, v88
    v_lshrrev_b32 v96, 16, v88
    v_mfma_f32_16x16x32_bf16 v[180:183], v[136:139], v[80:83], 0
    v_lshrrev_b32 v102, 16, v88
    v_cndmask_b32 v160, v43, 0, s[36:37]
    v_cndmask_b32 v166, 0, v43, s[36:37]
    v_mfma_f32_16x16x32_bf16 v[184:187], v[140:143], v[84:87], 0
    s_add_u32 m0, s47, 68608
    s_add_u32 s45, s46, 3072
    buffer_load_dwordx4 v1, s[16:19], s45 offen lds
    v_cndmask_b32 v152, v42, 0, s[36:37]
    v_cndmask_b32 v158, 0, v42, s[36:37]
    v_mfma_f32_16x16x32_bf16 v[200:203], v[160:163], v[88:91], v[252:255]
    v_rcp_f32 v176, v176
    v_rcp_f32 v177, v177
    v_rcp_f32 v188, v188
    v_rcp_f32 v189, v189
    v_mul_f32 v168, v168, v176
    v_mfma_f32_16x16x32_bf16 v[200:203], v[164:167], v[92:95], v[200:203]
    s_add_u32 m0, s47, 69632
    s_add_u32 s45, s46, 4096
    buffer_load_dwordx4 v1, s[16:19], s45 offen lds
    v_mul_f32 v169, v169, v176
    v_mul_f32 v170, v170, v176
    v_mul_f32 v171, v171, v176
    v_mul_f32 v172, v172, v177
    v_mfma_f32_16x16x32_bf16 v[212:215], v[160:163], v[96:99], v[252:255]
    v_mul_f32 v173, v173, v177
    v_mul_f32 v174, v174, v177
    v_mul_f32 v175, v175, v177
    v_cndmask_b32 v176, v176, v177, s[36:37]
    v_mfma_f32_16x16x32_bf16 v[212:215], v[164:167], v[100:103], v[212:215]
    s_add_u32 m0, s47, 70656
    s_add_u32 s45, s46, 5120
    buffer_load_dwordx4 v1, s[16:19], s45 offen lds
    v_cvt_pk_bf16_f32 v216, v168, v169
    v_cvt_pk_bf16_f32 v217, v170, v171
    v_cvt_pk_bf16_f32 v218, v172, v173
    v_cvt_pk_bf16_f32 v219, v174, v175
    v_mfma_f32_16x16x32_bf16 v[192:195], v[152:155], v[88:91], 0
    v_mul_f32 v232, v178, v176
    v_mfma_f32_16x16x32_bf16 v[196:199], v[156:159], v[92:95], 0
    s_add_u32 m0, s47, 71680
    s_add_u32 s45, s46, 6144
    buffer_load_dwordx4 v1, s[16:19], s45 offen lds
    ds_write_b128 v5, v[216:219] offset:0
    v_mul_f32 v180, v180, v188
    v_mul_f32 v181, v181, v188
    v_mul_f32 v182, v182, v188
    v_mul_f32 v183, v183, v188
    v_mul_f32 v184, v184, v189
    v_mul_f32 v185, v185, v189
    v_mul_f32 v186, v186, v189
    v_mfma_f32_16x16x32_bf16 v[204:207], v[152:155], v[96:99], 0
    v_mul_f32 v187, v187, v189
    v_cndmask_b32 v188, v188, v189, s[36:37]
    v_cvt_pk_bf16_f32 v220, v180, v181
    v_cvt_pk_bf16_f32 v221, v182, v183
    v_mfma_f32_16x16x32_bf16 v[208:211], v[156:159], v[100:103], 0
    s_add_u32 m0, s47, 72704
    s_add_u32 s45, s46, 7168
    buffer_load_dwordx4 v1, s[16:19], s45 offen lds
    v_cvt_pk_bf16_f32 v222, v184, v185
    v_cvt_pk_bf16_f32 v223, v186, v187
    v_mul_f32 v236, v190, v188
    ds_write_b128 v5, v[220:223] offset:18432
    s_waitcnt vmcnt(18)
    v_cvt_pk_bf16_f32 v52, v52, v53
    v_cvt_pk_bf16_f32 v53, v54, v55
    v_cvt_pk_bf16_f32 v56, v56, 0
    v_cvt_pk_bf16_f32 v57, v57, 0
    v_cvt_pk_bf16_f32 v138, v44, v45
    v_cvt_pk_bf16_f32 v139, v46, v47
    v_cvt_pk_bf16_f32 v140, v48, v49
    v_cvt_pk_bf16_f32 v141, v50, v51
    s_waitcnt lgkmcnt(0)
    s_barrier
    ds_read_b128 v[72:75], v1 offset:0
    ds_read_b128 v[76:79], v1 offset:18432
    ds_read_b128 v[80:83], v1 offset:4096
    ds_read_b128 v[84:87], v1 offset:22528
    ds_read_b128 v[88:91], v1 offset:8192
    ds_read_b128 v[92:95], v1 offset:26624
    v_cndmask_b32 v146, v52, 0, s[34:35]
    v_cndmask_b32 v147, v53, 0, s[34:35]
    v_cndmask_b32 v148, 0, v52, s[34:35]
    v_cndmask_b32 v149, 0, v53, s[34:35]
    s_waitcnt lgkmcnt(4)
    v_mfma_f32_16x16x32_bf16 v[16:19], a[144:147], v[72:75], 0
    ds_read_b128 v[96:99], v1 offset:12288
    ds_read_b128 v[100:103], v1 offset:30720
    v_rcp_f32 v200, v200
    v_rcp_f32 v201, v201
    v_rcp_f32 v212, v212
    v_rcp_f32 v213, v213
    v_mul_f32 v192, v192, v200
    v_mul_f32 v193, v193, v200
    v_mul_f32 v194, v194, v200
    v_mfma_f32_16x16x32_bf16 v[24:27], a[144:147], v[76:79], 0
    s_add_u32 m0, s47, 73728
    s_add_u32 s45, s46, 8192
    buffer_load_dwordx4 v1, s[16:19], s45 offen lds
    v_mul_f32 v195, v195, v200
    v_mul_f32 v196, v196, v201
    v_mul_f32 v197, v197, v201
    v_mul_f32 v198, v198, v201
    v_mul_f32 v199, v199, v201
    v_cndmask_b32 v200, v200, v201, s[36:37]
    v_cvt_pk_bf16_f32 v224, v192, v193
    s_waitcnt lgkmcnt(4)
    v_mfma_f32_16x16x32_bf16 v[16:19], a[160:163], v[80:83], v[16:19]
    v_cvt_pk_bf16_f32 v225, v194, v195
    v_cvt_pk_bf16_f32 v226, v196, v197
    v_cvt_pk_bf16_f32 v227, v198, v199
    v_mul_f32 v233, v202, v200
    v_mfma_f32_16x16x32_bf16 v[24:27], a[160:163], v[84:87], v[24:27]
    ds_write_b128 v5, v[224:227] offset:1024
    v_mul_f32 v204, v204, v212
    v_mul_f32 v205, v205, v212
    v_mul_f32 v206, v206, v212
    v_mul_f32 v207, v207, v212
    v_mul_f32 v208, v208, v213
    v_mul_f32 v209, v209, v213
    v_mul_f32 v210, v210, v213
    v_mul_f32 v211, v211, v213
    s_waitcnt lgkmcnt(3)
    v_mfma_f32_16x16x32_bf16 v[16:19], a[176:179], v[88:91], v[16:19]
    v_cndmask_b32 v212, v212, v213, s[36:37]
    v_cvt_pk_bf16_f32 v228, v204, v205
    v_cvt_pk_bf16_f32 v229, v206, v207
    v_cvt_pk_bf16_f32 v230, v208, v209
    v_cvt_pk_bf16_f32 v231, v210, v211
    v_mul_f32 v237, v214, v212
    v_mfma_f32_16x16x32_bf16 v[24:27], a[176:179], v[92:95], v[24:27]
    ds_write_b128 v5, v[228:231] offset:19456
    s_waitcnt vmcnt(16)
    v_mov_b32 v110, v104
    v_lshrrev_b32 v112, 16, v104
    v_lshrrev_b32 v118, 16, v104
    v_cndmask_b32 v144, v57, 0, s[36:37]
    v_cndmask_b32 v150, 0, v57, s[36:37]
    s_waitcnt lgkmcnt(2)
    v_mfma_f32_16x16x32_bf16 v[16:19], a[192:195], v[96:99], v[16:19]
    v_cndmask_b32 v136, v56, 0, s[36:37]
    v_cndmask_b32 v142, 0, v56, s[36:37]
    s_waitcnt lgkmcnt(0)
    s_barrier
    ds_read_b128 v[72:75], v1 offset:1024
    ds_read_b128 v[76:79], v1 offset:19456
    ds_read_b128 v[80:83], v1 offset:5120
    ds_read_b128 v[84:87], v1 offset:23552
    ds_read_b128 v[88:91], v1 offset:9216
    ds_read_b128 v[92:95], v1 offset:27648
    v_mfma_f32_16x16x32_bf16 v[24:27], a[192:195], v[100:103], v[24:27]
    s_add_u32 s31, s33, 442368
    buffer_store_dwordx4 a[216:219], v1, s[4:7], s31 offen sc1
    v_mfma_f32_16x16x32_bf16 v[176:179], v[144:147], v[104:107], v[252:255]
    s_waitcnt vmcnt(13)
    v_cvt_pk_bf16_f32 v66, v66, v67
    v_mfma_f32_16x16x32_bf16 v[176:179], v[148:151], v[108:111], v[176:179]
    v_cvt_pk_bf16_f32 v67, v68, v69
    v_cvt_pk_bf16_f32 v70, v70, 0
    v_mfma_f32_16x16x32_bf16 v[188:191], v[144:147], v[112:115], v[252:255]
    v_cvt_pk_bf16_f32 v71, v71, 0
    v_mfma_f32_16x16x32_bf16 v[188:191], v[148:151], v[116:119], v[188:191]
    v_cvt_pk_bf16_f32 v154, v58, v59
    v_cvt_pk_bf16_f32 v155, v60, v61
    v_mfma_f32_16x16x32_bf16 v[168:171], v[136:139], v[104:107], 0
    v_cvt_pk_bf16_f32 v156, v62, v63
    v_cvt_pk_bf16_f32 v157, v64, v65
    v_mfma_f32_16x16x32_bf16 v[172:175], v[140:143], v[108:111], 0
    v_cndmask_b32 v162, v66, 0, s[34:35]
    v_mfma_f32_16x16x32_bf16 v[180:183], v[136:139], v[112:115], 0
    v_cndmask_b32 v163, v67, 0, s[34:35]
    v_cndmask_b32 v164, 0, v66, s[34:35]
    v_mfma_f32_16x16x32_bf16 v[184:187], v[140:143], v[116:119], 0
    v_cndmask_b32 v165, 0, v67, s[34:35]
    s_waitcnt lgkmcnt(4)
    v_mfma_f32_16x16x32_bf16 v[16:19], a[148:151], v[72:75], v[16:19]
    ds_read_b128 v[96:99], v1 offset:13312
    ds_read_b128 v[100:103], v1 offset:31744
    v_rcp_f32 v176, v176
    v_rcp_f32 v177, v177
    v_rcp_f32 v188, v188
    v_rcp_f32 v189, v189
    v_mul_f32 v168, v168, v176
    v_mul_f32 v169, v169, v176
    v_mul_f32 v170, v170, v176
    v_mfma_f32_16x16x32_bf16 v[24:27], a[148:151], v[76:79], v[24:27]
    v_mul_f32 v171, v171, v176
    v_mul_f32 v172, v172, v177
    v_mul_f32 v173, v173, v177
    v_mul_f32 v174, v174, v177
    v_mul_f32 v175, v175, v177
    v_cndmask_b32 v176, v176, v177, s[36:37]
    v_cvt_pk_bf16_f32 v216, v168, v169
    s_waitcnt lgkmcnt(4)
    v_mfma_f32_16x16x32_bf16 v[16:19], a[164:167], v[80:83], v[16:19]
    v_cvt_pk_bf16_f32 v217, v170, v171
    v_cvt_pk_bf16_f32 v218, v172, v173
    v_cvt_pk_bf16_f32 v219, v174, v175
    v_mul_f32 v234, v178, v176
    v_mfma_f32_16x16x32_bf16 v[24:27], a[164:167], v[84:87], v[24:27]
    ds_write_b128 v5, v[216:219] offset:2048
    v_mul_f32 v180, v180, v188
    v_mul_f32 v181, v181, v188
    v_mul_f32 v182, v182, v188
    v_mul_f32 v183, v183, v188
    v_mul_f32 v184, v184, v189
    v_mul_f32 v185, v185, v189
    v_mul_f32 v186, v186, v189
    v_mul_f32 v187, v187, v189
    s_waitcnt lgkmcnt(3)
    v_mfma_f32_16x16x32_bf16 v[16:19], a[180:183], v[88:91], v[16:19]
    v_cndmask_b32 v188, v188, v189, s[36:37]
    v_cvt_pk_bf16_f32 v220, v180, v181
    v_cvt_pk_bf16_f32 v221, v182, v183
    v_cvt_pk_bf16_f32 v222, v184, v185
    v_cvt_pk_bf16_f32 v223, v186, v187
    v_mul_f32 v238, v190, v188
    v_mfma_f32_16x16x32_bf16 v[24:27], a[180:183], v[92:95], v[24:27]
    ds_write_b128 v5, v[220:223] offset:20480
    s_waitcnt vmcnt(10)
    v_mov_b32 v126, v120
    v_lshrrev_b32 v128, 16, v120
    v_lshrrev_b32 v134, 16, v120
    v_cndmask_b32 v160, v71, 0, s[36:37]
    v_cndmask_b32 v166, 0, v71, s[36:37]
    s_waitcnt lgkmcnt(2)
    v_mfma_f32_16x16x32_bf16 v[16:19], a[196:199], v[96:99], v[16:19]
    v_cndmask_b32 v152, v70, 0, s[36:37]
    v_cndmask_b32 v158, 0, v70, s[36:37]
    s_waitcnt lgkmcnt(0)
    s_barrier
    ds_read_b128 v[72:75], v1 offset:2048
    ds_read_b128 v[76:79], v1 offset:20480
    ds_read_b128 v[80:83], v1 offset:6144
    ds_read_b128 v[84:87], v1 offset:24576
    ds_read_b128 v[88:91], v1 offset:10240
    ds_read_b128 v[92:95], v1 offset:28672
    v_mfma_f32_16x16x32_bf16 v[24:27], a[196:199], v[100:103], v[24:27]
    s_add_u32 s31, s33, 479232
    buffer_store_dwordx4 a[220:223], v1, s[4:7], s31 offen sc1
    v_mfma_f32_16x16x32_bf16 v[200:203], v[160:163], v[120:123], v[252:255]
    v_mfma_f32_16x16x32_bf16 v[200:203], v[164:167], v[124:127], v[200:203]
    v_mfma_f32_16x16x32_bf16 v[212:215], v[160:163], v[128:131], v[252:255]
    v_mfma_f32_16x16x32_bf16 v[212:215], v[164:167], v[132:135], v[212:215]
    v_mfma_f32_16x16x32_bf16 v[192:195], v[152:155], v[120:123], 0
    v_mfma_f32_16x16x32_bf16 v[196:199], v[156:159], v[124:127], 0
    v_mfma_f32_16x16x32_bf16 v[204:207], v[152:155], v[128:131], 0
    v_mfma_f32_16x16x32_bf16 v[208:211], v[156:159], v[132:135], 0
    s_waitcnt lgkmcnt(4)
    v_mfma_f32_16x16x32_bf16 v[16:19], a[152:155], v[72:75], v[16:19]
    ds_read_b128 v[96:99], v1 offset:14336
    ds_read_b128 v[100:103], v1 offset:32768
    v_rcp_f32 v200, v200
    v_rcp_f32 v201, v201
    v_rcp_f32 v212, v212
    v_rcp_f32 v213, v213
    v_mul_f32 v192, v192, v200
    v_mul_f32 v193, v193, v200
    v_mul_f32 v194, v194, v200
    v_mfma_f32_16x16x32_bf16 v[24:27], a[152:155], v[76:79], v[24:27]
    v_mul_f32 v195, v195, v200
    v_mul_f32 v196, v196, v201
    v_mul_f32 v197, v197, v201
    v_mul_f32 v198, v198, v201
    v_mul_f32 v199, v199, v201
    v_cndmask_b32 v200, v200, v201, s[36:37]
    v_cvt_pk_bf16_f32 v224, v192, v193
    s_waitcnt lgkmcnt(4)
    v_mfma_f32_16x16x32_bf16 v[16:19], a[168:171], v[80:83], v[16:19]
    v_cvt_pk_bf16_f32 v225, v194, v195
    v_cvt_pk_bf16_f32 v226, v196, v197
    v_cvt_pk_bf16_f32 v227, v198, v199
    v_mul_f32 v235, v202, v200
    v_mfma_f32_16x16x32_bf16 v[24:27], a[168:171], v[84:87], v[24:27]
    ds_write_b128 v5, v[224:227] offset:3072
    v_mul_f32 v204, v204, v212
    v_mul_f32 v205, v205, v212
    v_mul_f32 v206, v206, v212
    v_mul_f32 v207, v207, v212
    v_mul_f32 v208, v208, v213
    v_mul_f32 v209, v209, v213
    v_mul_f32 v210, v210, v213
    v_mul_f32 v211, v211, v213
    v_cndmask_b32 v212, v212, v213, s[36:37]
    s_waitcnt lgkmcnt(3)
    v_mfma_f32_16x16x32_bf16 v[16:19], a[184:187], v[88:91], v[16:19]
    v_cvt_pk_bf16_f32 v228, v204, v205
    v_cvt_pk_bf16_f32 v229, v206, v207
    v_cvt_pk_bf16_f32 v230, v208, v209
    v_cvt_pk_bf16_f32 v231, v210, v211
    v_mul_f32 v239, v214, v212
    v_mfma_f32_16x16x32_bf16 v[24:27], a[184:187], v[92:95], v[24:27]
    ds_write_b128 v5, v[228:231] offset:21504
    v_cvt_pk_bf16_f32 v232, v232, v233
    v_cvt_pk_bf16_f32 v233, v234, v235
    s_waitcnt lgkmcnt(2)
    v_mfma_f32_16x16x32_bf16 v[16:19], a[200:203], v[96:99], v[16:19]
    ds_write_b64 v6, v[232:233] offset:0
    v_cvt_pk_bf16_f32 v236, v236, v237
    v_cvt_pk_bf16_f32 v237, v238, v239
    ds_write_b64 v6, v[236:237] offset:18432
    v_lshlrev_b32 v13, 2, v11
    v_lshrrev_b32 v14, 5, v2
    v_lshl_add_u32 v14, v14, 6, v13
    v_and_b32 v15, 1, v12
    v_cmp_eq_u32 vcc, 0, v15
    s_waitcnt lgkmcnt(0)
    s_barrier
    ds_read_b128 v[72:75], v1 offset:3072
ffn0_part_pad0_1x:
    s_cbranch_execz ffn0_part_pad0_5x
    ds_read_b128 v[76:79], v1 offset:21504
    ds_read_b128 v[80:83], v1 offset:7168
    ds_read_b128 v[84:87], v1 offset:25600
    ds_read_b128 v[88:91], v1 offset:11264
    ds_read_b128 v[92:95], v1 offset:29696
    v_mfma_f32_16x16x32_bf16 v[24:27], a[200:203], v[100:103], v[24:27]
    s_add_u32 s31, s33, 516096
    buffer_store_dwordx4 a[224:227], v1, s[4:7], s31 offen sc1
    s_waitcnt lgkmcnt(4)
    v_mfma_f32_16x16x32_bf16 v[16:19], a[156:159], v[72:75], v[16:19]
    ds_read_b128 v[96:99], v1 offset:15360
    ds_read_b128 v[100:103], v1 offset:33792
    v_and_b32 v13, 1, v12
    v_mfma_f32_16x16x32_bf16 v[24:27], a[156:159], v[76:79], v[24:27]
    s_waitcnt lgkmcnt(4)
    v_mfma_f32_16x16x32_bf16 v[16:19], a[172:175], v[80:83], v[16:19]
    ds_read_b128 v[72:75], v1 offset:16384
    ds_read_b128 v[76:79], v1 offset:34816
    v_mfma_f32_16x16x32_bf16 v[24:27], a[172:175], v[84:87], v[24:27]
    s_waitcnt lgkmcnt(4)
    v_mfma_f32_16x16x32_bf16 v[16:19], a[188:191], v[88:91], v[16:19]
    ds_read_b128 v[80:83], v1 offset:17408
    ds_read_b128 v[84:87], v1 offset:35840
    v_mfma_f32_16x16x32_bf16 v[24:27], a[188:191], v[92:95], v[24:27]
    s_waitcnt lgkmcnt(4)
    v_mfma_f32_16x16x32_bf16 v[16:19], a[204:207], v[96:99], v[16:19]
    v_cmp_ne_u32 vcc, 0, v13
    v_mfma_f32_16x16x32_bf16 v[24:27], a[204:207], v[100:103], v[24:27]
    s_waitcnt lgkmcnt(2)
    v_mfma_f32_16x16x32_bf16 v[16:19], a[208:211], v[72:75], v[16:19]
    v_mfma_f32_16x16x32_bf16 v[24:27], a[208:211], v[76:79], v[24:27]
    s_waitcnt lgkmcnt(0)
    v_mfma_f32_16x16x32_bf16 v[16:19], a[212:215], v[80:83], v[16:19]
    v_mfma_f32_16x16x32_bf16 v[24:27], a[212:215], v[84:87], v[24:27]
    s_waitcnt vmcnt(3)
    s_nop 7
    v_add_f32 v16, v16, v17
    v_add_f32 v24, v24, v25
    v_cndmask_b32 v16, v16, v24, vcc
    ds_write_b32 v4, v16 offset:36864
    s_waitcnt lgkmcnt(0)
    s_barrier
    s_cmp_lg_u32 s13, 0
    s_cbranch_scc1 ffn0_part_ndm
    s_lshl_b32 s27, s12, 7
    s_add_u32 s27, s27, 20905984
    s_mov_b64 exec, 0xffffffff
    buffer_store_dword v16, v4, s[4:7], s27 offen sc1
    s_mov_b64 exec, -1
ffn0_part_ndm:
ffn0_part_ffn:
    v_lshlrev_b32 v1, 4, v2
    v_lshlrev_b32 v3, 4, v0
    s_mul_i32 s24, s21, 1036288
    s_add_u32 s24, s24, 0
    s_mul_i32 s25, s22, 151552
    s_add_u32 s25, s25, 27262976
    s_lshl_b32 s26, s20, 10
    s_cmp_ge_u32 s20, 1
    s_cselect_b32 s27, 27648, 0
    s_add_u32 s16, s25, s27
    s_cmp_ge_u32 s20, 2
    s_cselect_b32 s27, 27648, 0
    s_add_u32 s17, s25, s27
    s_cmp_ge_u32 s20, 3
    s_cselect_b32 s27, 27648, 0
    s_add_u32 s18, s25, s27
    s_add_u32 s30, s24, 0
    buffer_load_dwordx4 a[0:3], v3, s[4:7], s30 offen sc1
    s_add_u32 s30, s24, 4096
    buffer_load_dwordx4 a[4:7], v3, s[4:7], s30 offen sc1
    s_add_u32 s30, s24, 8192
    buffer_load_dwordx4 a[8:11], v3, s[4:7], s30 offen sc1
    s_add_u32 s30, s24, 12288
    buffer_load_dwordx4 a[12:15], v3, s[4:7], s30 offen sc1
    v_and_b32 v11, 15, v2
    v_lshrrev_b32 v12, 4, v2
    v_add_u32 v4, 0x10000, v1
    v_add_u32 v5, 0x20000, v1
    v_lshrrev_b32 v13, 3, v11
    v_mul_u32_u24 v13, 4608, v13
    v_and_b32 v14, 7, v11
    v_lshl_add_u32 v13, v14, 4, v13
    v_lshl_add_u32 v6, v12, 7, v13
    v_lshrrev_b32 v14, 1, v12
    v_mul_u32_u24 v14, 18432, v14
    v_add_u32 v13, v13, v14
    v_and_b32 v14, 1, v12
    v_lshl_add_u32 v7, v14, 7, v13
    s_lshr_b32 s27, s20, 1
    s_lshl_b32 s27, s27, 8
    s_add_u32 s27, s27, 4096
    s_sub_u32 s27, s27, s26
    v_add_u32 v7, s27, v7
    s_lshl_b32 s27, s22, 4
    s_add_u32 s27, s27, s21
    s_xor_b32 s28, s27, 1
    s_mul_i32 s46, s27, 77824
    s_add_u32 s46, s46, 125829120
    s_mul_i32 s47, s28, 77824
    s_add_u32 s47, s47, 125829120
    s_lshl_b32 s48, s27, 9
    s_lshl_b32 s49, s28, 9
    s_lshl_b32 s27, s20, 5
    s_add_u32 s27, s27, 40108032
    s_add_u32 s48, s48, s27
    s_add_u32 s49, s49, s27
    s_add_u32 s28, s47, s26
    s_and_b32 s19, s20, 1
    s_mul_i32 s27, s19, 9216
    s_add_u32 s32, s28, s27
    s_sub_u32 s33, s28, s27
    s_add_u32 s36, s32, 0
    s_add_u32 s37, s33, 9216
    s_add_u32 s38, s32, 18432
    s_add_u32 s39, s33, 27648
    s_add_u32 s40, s32, 36864
    s_add_u32 s41, s33, 46080
    s_add_u32 s42, s32, 55296
    s_add_u32 s43, s33, 64512
    s_mov_b32 s8, 0
    s_mul_i32 s34, s20, 9216
    s_add_u32 s34, s34, 4096
    v_add_u32 v9, 5120, v3
    s_lshl_b32 s27, s20, 2
    s_add_u32 s27, s27, 4096
    v_add_u32 v8, s27, v1
    v_add_u32 v253, s34, v1
    s_mov_b32 s29, 0xc09d30fc
    s_lshl_b32 s44, s22, 9
    s_add_u32 s44, s44, 39960576
    v_lshlrev_b32 v13, 2, v11
    s_mov_b32 s45, 0x3c017fae
    v_mov_b32 v252, 0x383ef424
    s_mul_i32 s27, s19, 9216
    v_add_u32 v11, s27, v1
    v_add_u32 v12, 73728, v11
    s_sub_u32 s27, 9216, s27
    v_add_u32 v14, s27, v1
    v_add_u32 v15, 73728, v14
    s_lshl_b32 s15, s21, 7
    s_add_u32 s15, s15, 40570880
    s_cmp_eq_u32 s20, 3
    s_cselect_b32 s13, 16, 0
    s_cselect_b32 s14, s15, 0x10000000
    v_and_b32 v232, 63, v0
    v_bfe_u32 v233, v232, 3, 1
    v_lshlrev_b32 v233, 3, v233
    v_lshrrev_b32 v234, 4, v232
    v_lshl_add_u32 v233, v234, 1, v233
    v_bfe_u32 v234, v232, 2, 1
    v_add_u32 v233, v233, v234
    v_mul_u32_u24 v233, 1152, v233
    v_and_b32 v234, 3, v232
    s_lshl_b32 s27, s20, 7
    s_add_u32 s27, s27, 65536
    v_lshl_add_u32 v235, v234, 4, v233
    v_add_u32 v235, s27, v235
    s_lshr_b32 s27, s20, 1
    s_lshl_b32 s27, s27, 5
    s_add_u32 s27, s27, 65536
    v_and_b32 v234, 1, v232
    v_lshl_add_u32 v236, v234, 4, v233
    v_bfe_u32 v234, v232, 1, 1
    v_lshl_add_u32 v236, v234, 3, v236
    v_add_u32 v236, s27, v236
    ds_read_b64_tr_b16 v[144:145], v235 offset:0
    ds_read_b64_tr_b16 v[146:147], v235 offset:18432
    ds_read_b64_tr_b16 v[148:149], v235 offset:8
    ds_read_b64_tr_b16 v[150:151], v235 offset:18440
    ds_read_b64_tr_b16 v[152:153], v235 offset:64
    ds_read_b64_tr_b16 v[154:155], v235 offset:18496
    ds_read_b64_tr_b16 v[156:157], v235 offset:72
    ds_read_b64_tr_b16 v[158:159], v235 offset:18504
    ds_read_b64_tr_b16 v[160:161], v236 offset:512
    ds_read_b64_tr_b16 v[162:163], v236 offset:18944
    ds_read_b64_tr_b16 v[164:165], v235 offset:576
    ds_read_b64_tr_b16 v[166:167], v235 offset:19008
    ds_read_b64_tr_b16 v[168:169], v235 offset:584
    ds_read_b64_tr_b16 v[170:171], v235 offset:19016
    s_waitcnt lgkmcnt(8)
    ds_read_b64_tr_b16 v[172:173], v235 offset:640
    ds_read_b64_tr_b16 v[174:175], v235 offset:19072
    ds_read_b64_tr_b16 v[176:177], v235 offset:648
    ds_read_b64_tr_b16 v[178:179], v235 offset:19080
    ds_read_b64_tr_b16 v[180:181], v236 offset:1088
    ds_read_b64_tr_b16 v[182:183], v236 offset:19520
    s_lshr_b32 s101, s2, 4
    s_movk_i32 s96, 182
    s_cmp_lt_u32 s101, 5
    s_cselect_b32 s96, 162, s96
    s_cselect_b32 s97, 5, 4
    s_movk_i32 s98, 223
    s_cmp_lt_u32 s101, 4
    s_cselect_b32 s98, 207, s98
    s_cselect_b32 s99, 4, 5
    s_bitcmp0_b32 s2, 3
    s_cselect_b32 s27, s96, s98
    s_cselect_b32 s98, s98, s96
    s_cselect_b32 s28, s97, s99
    s_cselect_b32 s99, s99, s97
    s_lshl_b32 s97, s28, 12
    s_lshl_b32 s99, s99, 12
    s_and_b32 s100, s2, 7
    s_mul_i32 s28, s100, 506
    s_add_u32 s28, s28, s101
    s_add_u32 s96, s27, s28
    s_add_u32 s98, s98, s28
    s_add_u32 s98, s98, 253
    s_lshl_b32 s96, s96, 12
    s_lshl_b32 s98, s98, 12
    s_lshl_b32 s100, s100, 2
    s_add_u32 s100, s100, s20
    s_lshl_b32 s100, s100, 7
    s_add_u32 s100, s100, 40566784
    s_cmp_lt_u32 s2, 144
    s_cselect_b32 s27, 0, 268435456
    s_add_u32 s96, s96, s27
    s_add_u32 s98, s98, s27
    s_add_u32 s101, s100, s27
    s_waitcnt lgkmcnt(0)
    s_lshl_b32 s9, s22, 11
    s_add_u32 s9, s9, 39976960
    s_lshl_b32 s27, s21, 7
    s_add_u32 s27, s27, s9
    v_mov_b32 v254, 1
    v_and_b32 v10, 15, v2
    v_lshlrev_b32 v10, 7, v10
    s_cmp_lg_u32 s20, 3
    s_cbranch_scc1 ffn0_part_backx
    s_add_u32 s30, s24, 16384
    buffer_load_dwordx4 a[16:19], v3, s[4:7], s30 offen sc1
    s_add_u32 s30, s24, 20480
    buffer_load_dwordx4 a[20:23], v3, s[4:7], s30 offen sc1
    s_add_u32 s30, s24, 24576
    buffer_load_dwordx4 a[24:27], v3, s[4:7], s30 offen sc1
    s_add_u32 s30, s24, 28672
    buffer_load_dwordx4 a[28:31], v3, s[4:7], s30 offen sc1
    s_add_u32 s30, s24, 32768
    buffer_load_dwordx4 a[32:35], v3, s[4:7], s30 offen sc1
    s_add_u32 s30, s24, 36864
    buffer_load_dwordx4 a[36:39], v3, s[4:7], s30 offen sc1
    s_add_u32 s30, s24, 40960
    buffer_load_dwordx4 a[40:43], v3, s[4:7], s30 offen sc1
    s_add_u32 s30, s24, 45056
    buffer_load_dwordx4 a[44:47], v3, s[4:7], s30 offen sc1
    s_add_u32 s30, s24, 49152
    buffer_load_dwordx4 a[48:51], v3, s[4:7], s30 offen sc1
    s_add_u32 s30, s24, 53248
    buffer_load_dwordx4 a[52:55], v3, s[4:7], s30 offen sc1
    s_add_u32 s30, s24, 57344
    buffer_load_dwordx4 a[56:59], v3, s[4:7], s30 offen sc1
    s_waitcnt vmcnt(15)
    s_barrier
    s_mul_i32 s35, s20, 512
    s_add_u32 s35, s35, s9
    s_atomic_add s3, s[4:5], s35 offset:0
    s_atomic_add s3, s[4:5], s35 offset:128
    s_atomic_add s3, s[4:5], s35 offset:256
    s_atomic_add s3, s[4:5], s35 offset:384
    s_add_u32 s30, s24, 61440
    buffer_load_dwordx4 a[60:63], v3, s[4:7], s30 offen sc1
    s_add_u32 s30, s24, 65536
    buffer_load_dwordx4 a[64:67], v3, s[4:7], s30 offen sc1
    s_add_u32 s30, s24, 69632
    buffer_load_dwordx4 a[68:71], v3, s[4:7], s30 offen sc1
    s_add_u32 s30, s24, 73728
    buffer_load_dwordx4 a[72:75], v3, s[4:7], s30 offen sc1
    s_add_u32 s30, s24, 77824
    buffer_load_dwordx4 a[76:79], v3, s[4:7], s30 offen sc1
    s_add_u32 s30, s24, 81920
    buffer_load_dwordx4 a[80:83], v3, s[4:7], s30 offen sc1
    s_add_u32 s30, s24, 86016
    buffer_load_dwordx4 a[84:87], v3, s[4:7], s30 offen sc1
    s_add_u32 s30, s24, 90112
    buffer_load_dwordx4 a[88:91], v3, s[4:7], s30 offen sc1
    s_add_u32 s30, s24, 94208
    buffer_load_dwordx4 a[92:95], v3, s[4:7], s30 offen sc1
    s_add_u32 s30, s24, 98304
    buffer_load_dwordx4 a[96:99], v3, s[4:7], s30 offen sc1
    s_add_u32 s30, s24, 102400
    buffer_load_dwordx4 a[100:103], v3, s[4:7], s30 offen sc1
    s_add_u32 s30, s24, 106496
    buffer_load_dwordx4 a[104:107], v3, s[4:7], s30 offen sc1
    s_add_u32 s30, s24, 110592
    buffer_load_dwordx4 a[108:111], v3, s[4:7], s30 offen sc1
    s_add_u32 s30, s24, 114688
    buffer_load_dwordx4 a[112:115], v3, s[4:7], s30 offen sc1
    s_add_u32 s30, s24, 118784
    buffer_load_dwordx4 a[116:119], v3, s[4:7], s30 offen sc1
    s_add_u32 s30, s24, 122880
    buffer_load_dwordx4 a[120:123], v3, s[4:7], s30 offen sc1
    s_atomic_add s3, s[4:5], s15 offset:0
ffn0_part_slowx:
    s_mov_b32 s28, 0
    s_atomic_add s28, s[4:5], s27 offset:0 glc
    s_add_u32 s8, s8, 1
    s_waitcnt lgkmcnt(0)
    s_cmp_ge_u32 s28, 16
    s_cbranch_scc1 ffn0_part_slowxk
    s_cmp_lt_u32 s8, 0x80000
    s_cbranch_scc1 ffn0_part_slowx
ffn0_part_slowxk:
    s_branch ffn0_part_backy
ffn0_part_backx:
    s_add_u32 s30, s24, 16384
    buffer_load_dwordx4 a[16:19], v3, s[4:7], s30 offen sc1
    s_add_u32 s30, s24, 20480
    buffer_load_dwordx4 a[20:23], v3, s[4:7], s30 offen sc1
    s_add_u32 s30, s24, 24576
    buffer_load_dwordx4 a[24:27], v3, s[4:7], s30 offen sc1
    s_add_u32 s30, s24, 28672
    buffer_load_dwordx4 a[28:31], v3, s[4:7], s30 offen sc1
    s_add_u32 s30, s24, 32768
    buffer_load_dwordx4 a[32:35], v3, s[4:7], s30 offen sc1
    s_add_u32 s30, s24, 36864
    buffer_load_dwordx4 a[36:39], v3, s[4:7], s30 offen sc1
    s_waitcnt vmcnt(10)
    s_barrier
    s_mul_i32 s35, s20, 512
    s_add_u32 s35, s35, s9
    s_atomic_add s3, s[4:5], s35 offset:0
    s_atomic_add s3, s[4:5], s35 offset:128
    s_atomic_add s3, s[4:5], s35 offset:256
    s_atomic_add s3, s[4:5], s35 offset:384
    s_add_u32 s30, s24, 40960
    buffer_load_dwordx4 a[40:43], v3, s[4:7], s30 offen sc1
    s_add_u32 s30, s24, 45056
    buffer_load_dwordx4 a[44:47], v3, s[4:7], s30 offen sc1
    s_add_u32 s30, s24, 49152
    buffer_load_dwordx4 a[48:51], v3, s[4:7], s30 offen sc1
    s_add_u32 s30, s24, 53248
    buffer_load_dwordx4 a[52:55], v3, s[4:7], s30 offen sc1
    s_add_u32 s30, s24, 57344
    buffer_load_dwordx4 a[56:59], v3, s[4:7], s30 offen sc1
    s_add_u32 s30, s24, 61440
    buffer_load_dwordx4 a[60:63], v3, s[4:7], s30 offen sc1
    s_add_u32 s30, s24, 65536
    buffer_load_dwordx4 a[64:67], v3, s[4:7], s30 offen sc1
    s_add_u32 s30, s24, 69632
    buffer_load_dwordx4 a[68:71], v3, s[4:7], s30 offen sc1
    s_add_u32 s30, s24, 73728
    buffer_load_dwordx4 a[72:75], v3, s[4:7], s30 offen sc1
    s_add_u32 s30, s24, 77824
    buffer_load_dwordx4 a[76:79], v3, s[4:7], s30 offen sc1
    s_add_u32 s30, s24, 81920
    buffer_load_dwordx4 a[80:83], v3, s[4:7], s30 offen sc1
    s_add_u32 s30, s24, 86016
    buffer_load_dwordx4 a[84:87], v3, s[4:7], s30 offen sc1
    s_add_u32 s30, s24, 90112
    buffer_load_dwordx4 a[88:91], v3, s[4:7], s30 offen sc1
    s_add_u32 s30, s24, 94208
    buffer_load_dwordx4 a[92:95], v3, s[4:7], s30 offen sc1
    s_add_u32 s30, s24, 98304
    buffer_load_dwordx4 a[96:99], v3, s[4:7], s30 offen sc1
    s_add_u32 s30, s24, 102400
    buffer_load_dwordx4 a[100:103], v3, s[4:7], s30 offen sc1
    s_add_u32 s30, s24, 106496
    buffer_load_dwordx4 a[104:107], v3, s[4:7], s30 offen sc1
    s_add_u32 s30, s24, 110592
    buffer_load_dwordx4 a[108:111], v3, s[4:7], s30 offen sc1
    s_add_u32 s30, s24, 114688
    buffer_load_dwordx4 a[112:115], v3, s[4:7], s30 offen sc1
    s_add_u32 s30, s24, 118784
    buffer_load_dwordx4 a[116:119], v3, s[4:7], s30 offen sc1
    s_add_u32 s30, s24, 122880
    buffer_load_dwordx4 a[120:123], v3, s[4:7], s30 offen sc1
ffn0_part_backy:
    s_barrier
    s_add_u32 m0, s26, 0
    s_add_u32 s31, s25, 0
    buffer_load_dwordx4 v3, s[4:7], s31 offen sc1 lds
    s_add_u32 m0, s26, 4096
    s_add_u32 s31, s25, 4096
    buffer_load_dwordx4 v3, s[4:7], s31 offen sc1 lds
    s_add_u32 m0, s26, 8192
    s_add_u32 s31, s16, 8192
    buffer_load_dwordx4 v3, s[4:7], s31 offen sc1 lds
    s_add_u32 m0, s26, 12288
    s_add_u32 s31, s25, 39936
    buffer_load_dwordx4 v3, s[4:7], s31 offen sc1 lds
    s_add_u32 m0, s26, 16384
    s_add_u32 s31, s17, 44032
    buffer_load_dwordx4 v3, s[4:7], s31 offen sc1 lds
    s_add_u32 m0, s26, 20480
    s_add_u32 s31, s25, 75776
    buffer_load_dwordx4 v3, s[4:7], s31 offen sc1 lds
    s_add_u32 m0, s26, 24576
    s_add_u32 s31, s18, 79872
    buffer_load_dwordx4 v3, s[4:7], s31 offen sc1 lds
    s_add_u32 s30, s24, 126976
    buffer_load_dwordx4 a[124:127], v3, s[4:7], s30 offen sc1
    s_add_u32 s30, s24, 131072
    buffer_load_dwordx4 a[128:131], v3, s[4:7], s30 offen sc1
    s_add_u32 s30, s24, 135168
    buffer_load_dwordx4 a[132:135], v3, s[4:7], s30 offen sc1
    s_waitcnt vmcnt(7)
    s_barrier
    ds_read_b128 v[184:187], v1 offset:0
    ds_read_b128 v[188:191], v1 offset:1024
    ds_read_b128 v[192:195], v1 offset:2048
    ds_read_b128 v[196:199], v1 offset:3072
    ds_read_b128 v[200:203], v1 offset:4096
    ds_read_b128 v[204:207], v1 offset:5120
    ds_read_b128 v[208:211], v1 offset:6144
    ds_read_b128 v[212:215], v1 offset:7168
    ds_read_b128 v[216:219], v1 offset:8192
    s_waitcnt lgkmcnt(6)
    s_getpc_b64 s[10:11]
ffn0_parts_pc:
    s_add_u32 s10, s10, ffn0_part-ffn0_parts_pc
    s_addc_u32 s11, s11, (ffn0_part-ffn0_parts_pc)>>32
    s_bfe_u32 s12, s2, 0x50003
    s_lshl_b32 s12, s12, 12
    v_mov_b32 v254, 0
    s_add_u32 s52, s46, 0
    s_add_u32 s53, s46, 9216
    s_add_u32 s54, s46, 18432
    s_add_u32 s60, s46, 27648
    s_add_u32 s61, s46, 36864
    s_add_u32 s62, s46, 46080
    s_add_u32 s63, s46, 55296
    s_add_u32 s23, s46, 64512
    v_mfma_f32_16x16x32_bf16 v[16:19], a[0:3], v[184:187], 0
    s_add_u32 m0, s26, 28672
    v_mfma_f32_16x16x32_bf16 v[16:19], a[4:7], v[188:191], v[16:19]
    s_add_u32 s31, s25, 111616
    v_mfma_f32_16x16x32_bf16 v[16:19], a[8:11], v[192:195], v[16:19]
    s_waitcnt lgkmcnt(3)
    v_mfma_f32_16x16x32_bf16 v[16:19], a[12:15], v[196:199], v[16:19]
    buffer_load_dwordx4 v3, s[4:7], s31 offen sc1 lds
    v_mfma_f32_16x16x32_bf16 v[16:19], a[16:19], v[200:203], v[16:19]
    s_add_u32 m0, s26, 32768
    v_mfma_f32_16x16x32_bf16 v[16:19], a[20:23], v[204:207], v[16:19]
    s_waitcnt vmcnt(5) lgkmcnt(0)
    v_mfma_f32_16x16x32_bf16 v[16:19], a[24:27], v[208:211], v[16:19]
    s_add_u32 s31, s25, 115712
    v_mfma_f32_16x16x32_bf16 v[16:19], a[28:31], v[212:215], v[16:19]
    buffer_load_dwordx4 v3, s[4:7], s31 offen sc1 lds
    v_mfma_f32_16x16x32_bf16 v[16:19], a[32:35], v[216:219], v[16:19]
    s_add_u32 m0, s26, 36864
    v_mfma_f32_16x16x32_bf16 v[20:23], a[36:39], v[184:187], 0
    s_add_u32 s31, s25, 18432
    ds_read_b128 v[220:223], v1 offset:9216
    ds_read_b128 v[224:227], v1 offset:10240
    v_mfma_f32_16x16x32_bf16 v[20:23], a[40:43], v[188:191], v[20:23]
    s_barrier
    ds_read_b128 v[228:231], v1 offset:11264
    v_mfma_f32_16x16x32_bf16 v[20:23], a[44:47], v[192:195], v[20:23]
    buffer_load_dwordx4 v3, s[4:7], s31 offen sc1 lds
    v_mfma_f32_16x16x32_bf16 v[20:23], a[48:51], v[196:199], v[20:23]
    s_add_u32 m0, s26, 40960
    v_mfma_f32_16x16x32_bf16 v[20:23], a[52:55], v[200:203], v[20:23]
    s_add_u32 s31, s25, 22528
    v_mfma_f32_16x16x32_bf16 v[20:23], a[56:59], v[204:207], v[20:23]
    v_mfma_f32_16x16x32_bf16 v[20:23], a[60:63], v[208:211], v[20:23]
    buffer_load_dwordx4 v3, s[4:7], s31 offen sc1 lds
    v_mfma_f32_16x16x32_bf16 v[20:23], a[64:67], v[212:215], v[20:23]
    s_add_u32 m0, s26, 45056
    ds_read_b128 a[232:235], v1 offset:12288
    ds_read_b128 a[236:239], v1 offset:13312
    v_mfma_f32_16x16x32_bf16 v[20:23], a[68:71], v[216:219], v[20:23]
    s_add_u32 s31, s16, 26624
    ds_read_b128 a[240:243], v1 offset:14336
    v_mfma_f32_16x16x32_bf16 v[24:27], a[72:75], v[184:187], 0
    ds_read_b128 a[244:247], v1 offset:15360
    ds_read_b128 a[248:251], v1 offset:16384
    v_mfma_f32_16x16x32_bf16 v[24:27], a[76:79], v[188:191], v[24:27]
    ds_read_b128 a[252:255], v1 offset:17408
    v_mfma_f32_16x16x32_bf16 v[24:27], a[80:83], v[192:195], v[24:27]
    buffer_load_dwordx4 v3, s[4:7], s31 offen sc1 lds
    v_mfma_f32_16x16x32_bf16 v[24:27], a[84:87], v[196:199], v[24:27]
    s_add_u32 m0, s26, 49152
    v_mfma_f32_16x16x32_bf16 v[24:27], a[88:91], v[200:203], v[24:27]
    s_add_u32 s31, s25, 58368
    v_mfma_f32_16x16x32_bf16 v[24:27], a[92:95], v[204:207], v[24:27]
    v_mfma_f32_16x16x32_bf16 v[24:27], a[96:99], v[208:211], v[24:27]
    buffer_load_dwordx4 v3, s[4:7], s31 offen sc1 lds
    v_mfma_f32_16x16x32_bf16 v[24:27], a[100:103], v[212:215], v[24:27]
    v_mfma_f32_16x16x32_bf16 v[24:27], a[104:107], v[216:219], v[24:27]
    s_waitcnt lgkmcnt(3)
    v_mfma_f32_16x16x32_bf16 v[28:31], a[0:3], v[220:223], 0
    s_add_u32 m0, s26, 53248
    v_mfma_f32_16x16x32_bf16 v[28:31], a[4:7], v[224:227], v[28:31]
    s_add_u32 s31, s17, 62464
    v_mfma_f32_16x16x32_bf16 v[28:31], a[8:11], v[228:231], v[28:31]
    buffer_load_dwordx4 v3, s[4:7], s31 offen sc1 lds
    v_mfma_f32_16x16x32_bf16 v[28:31], a[12:15], a[232:235], v[28:31]
    v_mfma_f32_16x16x32_bf16 v[28:31], a[16:19], a[236:239], v[28:31]
    s_add_u32 s30, s24, 139264
    v_mfma_f32_16x16x32_bf16 v[28:31], a[20:23], a[240:243], v[28:31]
    s_waitcnt lgkmcnt(0)
    v_mfma_f32_16x16x32_bf16 v[28:31], a[24:27], a[244:247], v[28:31]
    buffer_load_dwordx4 a[136:139], v3, s[4:7], s30 offen sc1
    v_mfma_f32_16x16x32_bf16 v[28:31], a[28:31], a[248:251], v[28:31]
    v_mfma_f32_16x16x32_bf16 v[28:31], a[32:35], a[252:255], v[28:31]
    v_mfma_f32_16x16x32_bf16 v[32:35], a[36:39], v[220:223], 0
    s_add_u32 s30, s24, 143360
    ds_read_b128 v[184:187], v1 offset:18432
    ds_read_b128 v[188:191], v1 offset:19456
    v_mfma_f32_16x16x32_bf16 v[32:35], a[40:43], v[224:227], v[32:35]
    ds_read_b128 v[192:195], v1 offset:20480
    v_mfma_f32_16x16x32_bf16 v[32:35], a[44:47], v[228:231], v[32:35]
    buffer_load_dwordx4 a[140:143], v3, s[4:7], s30 offen sc1
    v_mfma_f32_16x16x32_bf16 v[32:35], a[48:51], a[232:235], v[32:35]
    s_add_u32 m0, s26, 57344
    v_mfma_f32_16x16x32_bf16 v[32:35], a[52:55], a[236:239], v[32:35]
    s_add_u32 s31, s25, 94208
    v_mfma_f32_16x16x32_bf16 v[32:35], a[56:59], a[240:243], v[32:35]
    v_mfma_f32_16x16x32_bf16 v[32:35], a[60:63], a[244:247], v[32:35]
    buffer_load_dwordx4 v3, s[4:7], s31 offen sc1 lds
    v_mfma_f32_16x16x32_bf16 v[32:35], a[64:67], a[248:251], v[32:35]
    s_waitcnt vmcnt(7)
    ds_read_b128 v[196:199], v1 offset:21504
    ds_read_b128 v[200:203], v1 offset:22528
    v_mfma_f32_16x16x32_bf16 v[32:35], a[68:71], a[252:255], v[32:35]
    s_barrier
    ds_read_b128 v[204:207], v1 offset:23552
    v_mfma_f32_16x16x32_bf16 v[36:39], a[72:75], v[220:223], 0
    s_add_u32 s30, s24, 147456
    ds_read_b128 v[208:211], v1 offset:24576
    ds_read_b128 v[212:215], v1 offset:25600
    v_mfma_f32_16x16x32_bf16 v[36:39], a[76:79], v[224:227], v[36:39]
    ds_read_b128 v[216:219], v1 offset:26624
    v_mfma_f32_16x16x32_bf16 v[36:39], a[80:83], v[228:231], v[36:39]
    buffer_load_dwordx4 a[144:147], v3, s[4:7], s30 offen sc1
    v_mfma_f32_16x16x32_bf16 v[36:39], a[84:87], a[232:235], v[36:39]
    v_mfma_f32_16x16x32_bf16 v[36:39], a[88:91], a[236:239], v[36:39]
    s_add_u32 m0, s26, 61440
    v_mfma_f32_16x16x32_bf16 v[36:39], a[92:95], a[240:243], v[36:39]
    s_add_u32 s31, s18, 98304
    v_mfma_f32_16x16x32_bf16 v[36:39], a[96:99], a[244:247], v[36:39]
    v_mfma_f32_16x16x32_bf16 v[36:39], a[100:103], a[248:251], v[36:39]
    buffer_load_dwordx4 v3, s[4:7], s31 offen sc1 lds
    v_mfma_f32_16x16x32_bf16 v[36:39], a[104:107], a[252:255], v[36:39]
    s_waitcnt lgkmcnt(3)
    v_mfma_f32_16x16x32_bf16 v[40:43], a[0:3], v[184:187], 0
    s_add_u32 s30, s24, 151552
    v_mfma_f32_16x16x32_bf16 v[40:43], a[4:7], v[188:191], v[40:43]
    v_mfma_f32_16x16x32_bf16 v[40:43], a[8:11], v[192:195], v[40:43]
    buffer_load_dwordx4 a[148:151], v3, s[4:7], s30 offen sc1
    v_mfma_f32_16x16x32_bf16 v[40:43], a[12:15], v[196:199], v[40:43]
    v_mfma_f32_16x16x32_bf16 v[40:43], a[16:19], v[200:203], v[40:43]
    v_mfma_f32_16x16x32_bf16 v[40:43], a[20:23], v[204:207], v[40:43]
    s_waitcnt lgkmcnt(0)
    v_mfma_f32_16x16x32_bf16 v[40:43], a[24:27], v[208:211], v[40:43]
    s_add_u32 s30, s24, 155648
    v_mfma_f32_16x16x32_bf16 v[40:43], a[28:31], v[212:215], v[40:43]
    buffer_load_dwordx4 a[152:155], v3, s[4:7], s30 offen sc1
    v_mfma_f32_16x16x32_bf16 v[40:43], a[32:35], v[216:219], v[40:43]
    s_add_u32 m0, s26, 65536
    v_mfma_f32_16x16x32_bf16 v[44:47], a[36:39], v[184:187], 0
    s_add_u32 s31, s25, 130048
    ds_read_b128 v[220:223], v1 offset:27648
    ds_read_b128 v[224:227], v1 offset:28672
    v_mfma_f32_16x16x32_bf16 v[44:47], a[40:43], v[188:191], v[44:47]
    ds_read_b128 v[228:231], v1 offset:29696
    v_mfma_f32_16x16x32_bf16 v[44:47], a[44:47], v[192:195], v[44:47]
    buffer_load_dwordx4 v3, s[4:7], s31 offen sc1 lds
    v_mfma_f32_16x16x32_bf16 v[44:47], a[48:51], v[196:199], v[44:47]
    buffer_load_dword v244, v13, s[4:7], s44 offen offset:0 sc1
    v_mfma_f32_16x16x32_bf16 v[44:47], a[52:55], v[200:203], v[44:47]
    v_mfma_f32_16x16x32_bf16 v[44:47], a[56:59], v[204:207], v[44:47]
    s_add_u32 s30, s24, 159744
    v_mfma_f32_16x16x32_bf16 v[44:47], a[60:63], v[208:211], v[44:47]
    buffer_load_dword v245, v13, s[4:7], s44 offen offset:128 sc1
    v_mfma_f32_16x16x32_bf16 v[44:47], a[64:67], v[212:215], v[44:47]
    ds_read_b128 a[232:235], v1 offset:30720
    ds_read_b128 a[236:239], v1 offset:31744
    v_mfma_f32_16x16x32_bf16 v[44:47], a[68:71], v[216:219], v[44:47]
    ds_read_b128 a[240:243], v1 offset:32768
    v_mfma_f32_16x16x32_bf16 v[48:51], a[72:75], v[184:187], 0
    ds_read_b128 a[244:247], v1 offset:33792
    ds_read_b128 a[248:251], v1 offset:34816
    v_mfma_f32_16x16x32_bf16 v[48:51], a[76:79], v[188:191], v[48:51]
    ds_read_b128 a[252:255], v1 offset:35840
    v_mfma_f32_16x16x32_bf16 v[48:51], a[80:83], v[192:195], v[48:51]
    buffer_load_dwordx4 a[156:159], v3, s[4:7], s30 offen sc1
    v_mfma_f32_16x16x32_bf16 v[48:51], a[84:87], v[196:199], v[48:51]
    s_add_u32 m0, s26, 69632
    v_mfma_f32_16x16x32_bf16 v[48:51], a[88:91], v[200:203], v[48:51]
    s_add_u32 s31, s25, 134144
    v_mfma_f32_16x16x32_bf16 v[48:51], a[92:95], v[204:207], v[48:51]
    buffer_load_dwordx4 v3, s[4:7], s31 offen sc1 lds
    v_mfma_f32_16x16x32_bf16 v[48:51], a[96:99], v[208:211], v[48:51]
    buffer_load_dword v246, v13, s[4:7], s44 offen offset:256 sc1
    v_mfma_f32_16x16x32_bf16 v[48:51], a[100:103], v[212:215], v[48:51]
    s_add_u32 s30, s24, 163840
    v_mfma_f32_16x16x32_bf16 v[48:51], a[104:107], v[216:219], v[48:51]
    s_waitcnt lgkmcnt(3)
    v_mfma_f32_16x16x32_bf16 v[52:55], a[0:3], v[220:223], 0
ffn0_part_pad0_2x:
    s_cbranch_execz ffn0_part_pad0_6x
    buffer_load_dwordx4 a[160:163], v3, s[4:7], s30 offen sc1
    v_mfma_f32_16x16x32_bf16 v[52:55], a[4:7], v[224:227], v[52:55]
    buffer_load_dword v247, v13, s[4:7], s44 offen offset:384 sc1
    v_mfma_f32_16x16x32_bf16 v[52:55], a[8:11], v[228:231], v[52:55]
    v_mfma_f32_16x16x32_bf16 v[52:55], a[12:15], a[232:235], v[52:55]
    s_add_u32 s30, s24, 167936
    v_mfma_f32_16x16x32_bf16 v[52:55], a[16:19], a[236:239], v[52:55]
    buffer_load_dword v248, v13, s[4:7], s44 offen offset:64 sc1
    v_mfma_f32_16x16x32_bf16 v[52:55], a[20:23], a[240:243], v[52:55]
    s_waitcnt lgkmcnt(0)
    v_mfma_f32_16x16x32_bf16 v[52:55], a[24:27], a[244:247], v[52:55]
    buffer_load_dwordx4 a[164:167], v3, s[4:7], s30 offen sc1
    v_mfma_f32_16x16x32_bf16 v[52:55], a[28:31], a[248:251], v[52:55]
    s_add_u32 m0, s26, 73728
    v_mfma_f32_16x16x32_bf16 v[52:55], a[32:35], a[252:255], v[52:55]
    s_add_u32 s31, s25, 9216
    v_mfma_f32_16x16x32_bf16 v[56:59], a[36:39], v[220:223], 0
    ds_read_b128 v[184:187], v1 offset:36864
    ds_read_b128 v[188:191], v1 offset:37888
    v_mfma_f32_16x16x32_bf16 v[56:59], a[40:43], v[224:227], v[56:59]
    s_waitcnt vmcnt(17)
    ds_read_b128 v[192:195], v1 offset:38912
    v_mfma_f32_16x16x32_bf16 v[56:59], a[44:47], v[228:231], v[56:59]
    buffer_load_dwordx4 v3, s[4:7], s31 offen sc1 lds
    v_mfma_f32_16x16x32_bf16 v[56:59], a[48:51], a[232:235], v[56:59]
    s_add_u32 s30, s24, 172032
    v_mfma_f32_16x16x32_bf16 v[56:59], a[52:55], a[236:239], v[56:59]
    buffer_load_dword v249, v13, s[4:7], s44 offen offset:192 sc1
    v_mfma_f32_16x16x32_bf16 v[56:59], a[56:59], a[240:243], v[56:59]
    buffer_load_dwordx4 a[168:171], v3, s[4:7], s30 offen sc1
    v_mfma_f32_16x16x32_bf16 v[56:59], a[60:63], a[244:247], v[56:59]
    s_barrier
    v_mfma_f32_16x16x32_bf16 v[56:59], a[64:67], a[248:251], v[56:59]
    s_add_u32 m0, s26, 77824
    ds_read_b128 v[196:199], v1 offset:39936
    ds_read_b128 v[200:203], v1 offset:40960
    v_mfma_f32_16x16x32_bf16 v[56:59], a[68:71], a[252:255], v[56:59]
    s_add_u32 s31, s25, 13312
    ds_read_b128 v[204:207], v1 offset:41984
    v_mfma_f32_16x16x32_bf16 v[60:63], a[72:75], v[220:223], 0
    ds_read_b128 v[208:211], v1 offset:43008
    ds_read_b128 v[212:215], v1 offset:44032
    v_mfma_f32_16x16x32_bf16 v[60:63], a[76:79], v[224:227], v[60:63]
    ds_read_b128 v[216:219], v1 offset:45056
    v_mfma_f32_16x16x32_bf16 v[60:63], a[80:83], v[228:231], v[60:63]
    buffer_load_dwordx4 v3, s[4:7], s31 offen sc1 lds
    v_mfma_f32_16x16x32_bf16 v[60:63], a[84:87], a[232:235], v[60:63]
    s_add_u32 s30, s24, 176128
    v_mfma_f32_16x16x32_bf16 v[60:63], a[88:91], a[236:239], v[60:63]
    buffer_load_dword v250, v13, s[4:7], s44 offen offset:320 sc1
    v_mfma_f32_16x16x32_bf16 v[60:63], a[92:95], a[240:243], v[60:63]
    buffer_load_dwordx4 a[172:175], v3, s[4:7], s30 offen sc1
    v_mfma_f32_16x16x32_bf16 v[60:63], a[96:99], a[244:247], v[60:63]
    v_mfma_f32_16x16x32_bf16 v[60:63], a[100:103], a[248:251], v[60:63]
    buffer_load_dword v251, v13, s[4:7], s44 offen offset:448 sc1
    v_mfma_f32_16x16x32_bf16 v[60:63], a[104:107], a[252:255], v[60:63]
    s_waitcnt lgkmcnt(3)
    v_mfma_f32_16x16x32_bf16 v[64:67], a[0:3], v[184:187], 0
    s_add_u32 s30, s24, 180224
    v_mfma_f32_16x16x32_bf16 v[64:67], a[4:7], v[188:191], v[64:67]
    buffer_load_dwordx4 a[176:179], v3, s[4:7], s30 offen sc1
    v_mfma_f32_16x16x32_bf16 v[64:67], a[8:11], v[192:195], v[64:67]
    s_add_u32 m0, s26, 81920
    v_mfma_f32_16x16x32_bf16 v[64:67], a[12:15], v[196:199], v[64:67]
    s_add_u32 s31, s16, 17408
    v_mfma_f32_16x16x32_bf16 v[64:67], a[16:19], v[200:203], v[64:67]
    v_mfma_f32_16x16x32_bf16 v[64:67], a[20:23], v[204:207], v[64:67]
    s_waitcnt lgkmcnt(0)
    v_mfma_f32_16x16x32_bf16 v[64:67], a[24:27], v[208:211], v[64:67]
    buffer_load_dwordx4 v3, s[4:7], s31 offen sc1 lds
    v_mfma_f32_16x16x32_bf16 v[64:67], a[28:31], v[212:215], v[64:67]
    v_mfma_f32_16x16x32_bf16 v[64:67], a[32:35], v[216:219], v[64:67]
    s_add_u32 s30, s24, 184320
    v_mfma_f32_16x16x32_bf16 v[68:71], a[36:39], v[184:187], 0
    ds_read_b128 v[220:223], v1 offset:46080
    ds_read_b128 v[224:227], v1 offset:47104
    v_mfma_f32_16x16x32_bf16 v[68:71], a[40:43], v[188:191], v[68:71]
    ds_read_b128 v[228:231], v1 offset:48128
    v_mfma_f32_16x16x32_bf16 v[68:71], a[44:47], v[192:195], v[68:71]
    buffer_load_dwordx4 a[180:183], v3, s[4:7], s30 offen sc1
    v_mfma_f32_16x16x32_bf16 v[68:71], a[48:51], v[196:199], v[68:71]
    v_mfma_f32_16x16x32_bf16 v[68:71], a[52:55], v[200:203], v[68:71]
    s_add_u32 s30, s24, 188416
    v_mfma_f32_16x16x32_bf16 v[68:71], a[56:59], v[204:207], v[68:71]
    v_mfma_f32_16x16x32_bf16 v[68:71], a[60:63], v[208:211], v[68:71]
    buffer_load_dwordx4 a[184:187], v3, s[4:7], s30 offen sc1
    v_mfma_f32_16x16x32_bf16 v[68:71], a[64:67], v[212:215], v[68:71]
    s_add_u32 m0, s26, 86016
    ds_read_b128 a[232:235], v1 offset:49152
    ds_read_b128 a[236:239], v1 offset:50176
    v_mfma_f32_16x16x32_bf16 v[68:71], a[68:71], v[216:219], v[68:71]
    s_add_u32 s31, s25, 49152
    ds_read_b128 a[240:243], v1 offset:51200
    v_mfma_f32_16x16x32_bf16 v[72:75], a[72:75], v[184:187], 0
    ds_read_b128 a[244:247], v1 offset:52224
    ds_read_b128 a[248:251], v1 offset:53248
    v_mfma_f32_16x16x32_bf16 v[72:75], a[76:79], v[188:191], v[72:75]
    ds_read_b128 a[252:255], v1 offset:54272
    v_mfma_f32_16x16x32_bf16 v[72:75], a[80:83], v[192:195], v[72:75]
    buffer_load_dwordx4 v3, s[4:7], s31 offen sc1 lds
    v_mfma_f32_16x16x32_bf16 v[72:75], a[84:87], v[196:199], v[72:75]
    v_mfma_f32_16x16x32_bf16 v[72:75], a[88:91], v[200:203], v[72:75]
    s_add_u32 s30, s24, 192512
    v_mfma_f32_16x16x32_bf16 v[72:75], a[92:95], v[204:207], v[72:75]
    v_mfma_f32_16x16x32_bf16 v[72:75], a[96:99], v[208:211], v[72:75]
    buffer_load_dwordx4 a[188:191], v3, s[4:7], s30 offen sc1
    v_mfma_f32_16x16x32_bf16 v[72:75], a[100:103], v[212:215], v[72:75]
    s_add_u32 m0, s26, 90112
    v_mfma_f32_16x16x32_bf16 v[72:75], a[104:107], v[216:219], v[72:75]
    s_waitcnt lgkmcnt(3)
    v_mfma_f32_16x16x32_bf16 v[76:79], a[0:3], v[220:223], 0
    s_add_u32 s31, s17, 53248
    v_mfma_f32_16x16x32_bf16 v[76:79], a[4:7], v[224:227], v[76:79]
    buffer_load_dwordx4 v3, s[4:7], s31 offen sc1 lds
    v_mfma_f32_16x16x32_bf16 v[76:79], a[8:11], v[228:231], v[76:79]
    v_mfma_f32_16x16x32_bf16 v[76:79], a[12:15], a[232:235], v[76:79]
    v_mfma_f32_16x16x32_bf16 v[76:79], a[16:19], a[236:239], v[76:79]
    s_add_u32 s30, s24, 196608
    v_mfma_f32_16x16x32_bf16 v[76:79], a[20:23], a[240:243], v[76:79]
    s_waitcnt lgkmcnt(0)
    v_mfma_f32_16x16x32_bf16 v[76:79], a[24:27], a[244:247], v[76:79]
    buffer_load_dwordx4 a[192:195], v3, s[4:7], s30 offen sc1
    v_mfma_f32_16x16x32_bf16 v[76:79], a[28:31], a[248:251], v[76:79]
    v_mfma_f32_16x16x32_bf16 v[76:79], a[32:35], a[252:255], v[76:79]
    s_waitcnt vmcnt(20)
    v_mfma_f32_16x16x32_bf16 v[80:83], a[36:39], v[220:223], 0
    s_add_u32 s30, s24, 200704
    ds_read_b128 v[184:187], v1 offset:55296
    ds_read_b128 v[188:191], v1 offset:56320
    v_mfma_f32_16x16x32_bf16 v[80:83], a[40:43], v[224:227], v[80:83]
    s_barrier
    ds_read_b128 v[192:195], v1 offset:57344
    v_mfma_f32_16x16x32_bf16 v[80:83], a[44:47], v[228:231], v[80:83]
    buffer_load_dwordx4 a[196:199], v3, s[4:7], s30 offen sc1
    v_mfma_f32_16x16x32_bf16 v[80:83], a[48:51], a[232:235], v[80:83]
    s_add_u32 m0, s26, 94208
    v_mfma_f32_16x16x32_bf16 v[80:83], a[52:55], a[236:239], v[80:83]
    s_add_u32 s31, s25, 84992
    v_mfma_f32_16x16x32_bf16 v[80:83], a[56:59], a[240:243], v[80:83]
    v_mfma_f32_16x16x32_bf16 v[80:83], a[60:63], a[244:247], v[80:83]
    buffer_load_dwordx4 v3, s[4:7], s31 offen sc1 lds
    v_mfma_f32_16x16x32_bf16 v[80:83], a[64:67], a[248:251], v[80:83]
    ds_read_b128 v[196:199], v1 offset:58368
    ds_read_b128 v[200:203], v1 offset:59392
    v_mfma_f32_16x16x32_bf16 v[80:83], a[68:71], a[252:255], v[80:83]
    ds_read_b128 v[204:207], v1 offset:60416
    v_mfma_f32_16x16x32_bf16 v[84:87], a[72:75], v[220:223], 0
    s_add_u32 s30, s24, 204800
    ds_read_b128 v[208:211], v1 offset:61440
    ds_read_b128 v[212:215], v1 offset:62464
    v_mfma_f32_16x16x32_bf16 v[84:87], a[76:79], v[224:227], v[84:87]
    ds_read_b128 v[216:219], v1 offset:63488
    v_mfma_f32_16x16x32_bf16 v[84:87], a[80:83], v[228:231], v[84:87]
    buffer_load_dwordx4 a[200:203], v3, s[4:7], s30 offen sc1
    v_mfma_f32_16x16x32_bf16 v[84:87], a[84:87], a[232:235], v[84:87]
    v_mfma_f32_16x16x32_bf16 v[84:87], a[88:91], a[236:239], v[84:87]
    s_add_u32 s30, s24, 208896
    v_mfma_f32_16x16x32_bf16 v[84:87], a[92:95], a[240:243], v[84:87]
    v_mfma_f32_16x16x32_bf16 v[84:87], a[96:99], a[244:247], v[84:87]
    buffer_load_dwordx4 a[204:207], v3, s[4:7], s30 offen sc1
    v_mfma_f32_16x16x32_bf16 v[84:87], a[100:103], a[248:251], v[84:87]
    v_mfma_f32_16x16x32_bf16 v[84:87], a[104:107], a[252:255], v[84:87]
    s_waitcnt lgkmcnt(3)
    v_mfma_f32_16x16x32_bf16 v[88:91], a[0:3], v[184:187], 0
    s_add_u32 m0, s26, 98304
    v_mfma_f32_16x16x32_bf16 v[88:91], a[4:7], v[188:191], v[88:91]
    s_add_u32 s31, s18, 89088
    v_mfma_f32_16x16x32_bf16 v[88:91], a[8:11], v[192:195], v[88:91]
    buffer_load_dwordx4 v3, s[4:7], s31 offen sc1 lds
    v_mfma_f32_16x16x32_bf16 v[88:91], a[12:15], v[196:199], v[88:91]
    v_mfma_f32_16x16x32_bf16 v[88:91], a[16:19], v[200:203], v[88:91]
    v_mfma_f32_16x16x32_bf16 v[88:91], a[20:23], v[204:207], v[88:91]
    s_waitcnt lgkmcnt(0)
    v_mfma_f32_16x16x32_bf16 v[88:91], a[24:27], v[208:211], v[88:91]
    s_add_u32 s30, s24, 212992
    v_mfma_f32_16x16x32_bf16 v[88:91], a[28:31], v[212:215], v[88:91]
    buffer_load_dwordx4 a[208:211], v3, s[4:7], s30 offen sc1
    v_mfma_f32_16x16x32_bf16 v[88:91], a[32:35], v[216:219], v[88:91]
    s_add_u32 m0, s26, 102400
    v_mfma_f32_16x16x32_bf16 v[92:95], a[36:39], v[184:187], 0
    s_add_u32 s31, s25, 120832
    ds_read_b128 v[220:223], v1 offset:64512
    ds_read_b128 v[224:227], v4 offset:0
    v_mfma_f32_16x16x32_bf16 v[92:95], a[40:43], v[188:191], v[92:95]
    ds_read_b128 v[228:231], v4 offset:1024
    v_mfma_f32_16x16x32_bf16 v[92:95], a[44:47], v[192:195], v[92:95]
    buffer_load_dwordx4 v3, s[4:7], s31 offen sc1 lds
    v_mfma_f32_16x16x32_bf16 v[92:95], a[48:51], v[196:199], v[92:95]
    v_mfma_f32_16x16x32_bf16 v[92:95], a[52:55], v[200:203], v[92:95]
    v_mfma_f32_16x16x32_bf16 v[92:95], a[56:59], v[204:207], v[92:95]
    s_add_u32 s30, s24, 217088
    v_mfma_f32_16x16x32_bf16 v[92:95], a[60:63], v[208:211], v[92:95]
    v_mfma_f32_16x16x32_bf16 v[92:95], a[64:67], v[212:215], v[92:95]
    ds_read_b128 a[232:235], v4 offset:2048
    ds_read_b128 a[236:239], v4 offset:3072
    v_mfma_f32_16x16x32_bf16 v[92:95], a[68:71], v[216:219], v[92:95]
    ds_read_b128 a[240:243], v4 offset:4096
    v_mfma_f32_16x16x32_bf16 v[96:99], a[72:75], v[184:187], 0
    ds_read_b128 a[244:247], v4 offset:5120
    ds_read_b128 a[248:251], v4 offset:6144
    v_mfma_f32_16x16x32_bf16 v[96:99], a[76:79], v[188:191], v[96:99]
    ds_read_b128 a[252:255], v4 offset:7168
    v_mfma_f32_16x16x32_bf16 v[96:99], a[80:83], v[192:195], v[96:99]
    buffer_load_dwordx4 a[212:215], v3, s[4:7], s30 offen sc1
    v_mfma_f32_16x16x32_bf16 v[96:99], a[84:87], v[196:199], v[96:99]
    s_add_u32 m0, s26, 106496
    v_mfma_f32_16x16x32_bf16 v[96:99], a[88:91], v[200:203], v[96:99]
    s_add_u32 s31, s25, 124928
    v_mfma_f32_16x16x32_bf16 v[96:99], a[92:95], v[204:207], v[96:99]
    buffer_load_dwordx4 v3, s[4:7], s31 offen sc1 lds
    v_mfma_f32_16x16x32_bf16 v[96:99], a[96:99], v[208:211], v[96:99]
    v_mfma_f32_16x16x32_bf16 v[96:99], a[100:103], v[212:215], v[96:99]
    v_mfma_f32_16x16x32_bf16 v[96:99], a[104:107], v[216:219], v[96:99]
    s_waitcnt lgkmcnt(3)
    v_mfma_f32_16x16x32_bf16 v[100:103], a[0:3], v[220:223], 0
    s_add_u32 s30, s24, 221184
    v_mfma_f32_16x16x32_bf16 v[100:103], a[4:7], v[224:227], v[100:103]
    buffer_load_dwordx4 a[0:3], v3, s[4:7], s30 offen sc1
    v_mfma_f32_16x16x32_bf16 v[100:103], a[8:11], v[228:231], v[100:103]
    v_mfma_f32_16x16x32_bf16 v[100:103], a[12:15], a[232:235], v[100:103]
    s_add_u32 s30, s24, 225280
    v_mfma_f32_16x16x32_bf16 v[100:103], a[16:19], a[236:239], v[100:103]
    v_mfma_f32_16x16x32_bf16 v[100:103], a[20:23], a[240:243], v[100:103]
    s_waitcnt vmcnt(16) lgkmcnt(0)
    v_mfma_f32_16x16x32_bf16 v[100:103], a[24:27], a[244:247], v[100:103]
    buffer_load_dwordx4 a[4:7], v3, s[4:7], s30 offen sc1
    v_mfma_f32_16x16x32_bf16 v[100:103], a[28:31], a[248:251], v[100:103]
    s_add_u32 m0, s26, 110592
    v_mfma_f32_16x16x32_bf16 v[100:103], a[32:35], a[252:255], v[100:103]
    s_add_u32 s31, s25, 27648
    v_mfma_f32_16x16x32_bf16 v[104:107], a[36:39], v[220:223], 0
    s_barrier
    ds_read_b128 v[184:187], v4 offset:8192
    ds_read_b128 v[188:191], v4 offset:9216
    v_mfma_f32_16x16x32_bf16 v[104:107], a[40:43], v[224:227], v[104:107]
    ds_read_b128 v[192:195], v4 offset:10240
    v_mfma_f32_16x16x32_bf16 v[104:107], a[44:47], v[228:231], v[104:107]
    buffer_load_dwordx4 v3, s[4:7], s31 offen sc1 lds
    v_mfma_f32_16x16x32_bf16 v[104:107], a[48:51], a[232:235], v[104:107]
    s_add_u32 s30, s24, 229376
    v_mfma_f32_16x16x32_bf16 v[104:107], a[52:55], a[236:239], v[104:107]
    s_mov_b64 exec, 1
    buffer_atomic_add v254, off, s[4:7], s14 sc0 sc1
    s_mov_b64 exec, -1
    v_mfma_f32_16x16x32_bf16 v[104:107], a[56:59], a[240:243], v[104:107]
    buffer_load_dwordx4 a[8:11], v3, s[4:7], s30 offen sc1
    v_mfma_f32_16x16x32_bf16 v[104:107], a[60:63], a[244:247], v[104:107]
    v_mfma_f32_16x16x32_bf16 v[104:107], a[64:67], a[248:251], v[104:107]
    s_add_u32 m0, s26, 114688
    ds_read_b128 v[196:199], v4 offset:11264
    ds_read_b128 v[200:203], v4 offset:12288
    v_mfma_f32_16x16x32_bf16 v[104:107], a[68:71], a[252:255], v[104:107]
    s_add_u32 s31, s25, 31744
    ds_read_b128 v[204:207], v4 offset:13312
    v_mfma_f32_16x16x32_bf16 v[108:111], a[72:75], v[220:223], 0
    ds_read_b128 v[208:211], v4 offset:14336
    ds_read_b128 v[212:215], v4 offset:15360
    v_mfma_f32_16x16x32_bf16 v[108:111], a[76:79], v[224:227], v[108:111]
    ds_read_b128 v[216:219], v4 offset:16384
    v_mfma_f32_16x16x32_bf16 v[108:111], a[80:83], v[228:231], v[108:111]
    buffer_load_dwordx4 v3, s[4:7], s31 offen sc1 lds
    v_mfma_f32_16x16x32_bf16 v[108:111], a[84:87], a[232:235], v[108:111]
    s_add_u32 s30, s24, 233472
    v_mfma_f32_16x16x32_bf16 v[108:111], a[88:91], a[236:239], v[108:111]
    v_mfma_f32_16x16x32_bf16 v[108:111], a[92:95], a[240:243], v[108:111]
    buffer_load_dwordx4 a[12:15], v3, s[4:7], s30 offen sc1
    v_mfma_f32_16x16x32_bf16 v[108:111], a[96:99], a[244:247], v[108:111]
    v_mfma_f32_16x16x32_bf16 v[108:111], a[100:103], a[248:251], v[108:111]
    v_mfma_f32_16x16x32_bf16 v[108:111], a[104:107], a[252:255], v[108:111]
    s_waitcnt lgkmcnt(3)
    v_fma_f32 v244, v244, s45, v252
    v_fma_f32 v245, v245, s45, v252
    v_mfma_f32_16x16x32_bf16 v[16:19], a[108:111], v[184:187], v[16:19]
    s_add_u32 s30, s24, 237568
    v_rsq_f32 v244, v244
    v_mfma_f32_16x16x32_bf16 v[16:19], a[112:115], v[188:191], v[16:19]
    buffer_load_dwordx4 a[16:19], v3, s[4:7], s30 offen sc1
    v_mfma_f32_16x16x32_bf16 v[16:19], a[116:119], v[192:195], v[16:19]
    s_add_u32 m0, s26, 118784
    v_rsq_f32 v245, v245
    v_mfma_f32_16x16x32_bf16 v[16:19], a[120:123], v[196:199], v[16:19]
    s_add_u32 s31, s16, 35840
    v_fma_f32 v246, v246, s45, v252
    v_fma_f32 v247, v247, s45, v252
    v_mfma_f32_16x16x32_bf16 v[16:19], a[124:127], v[200:203], v[16:19]
    v_rsq_f32 v246, v246
    v_mfma_f32_16x16x32_bf16 v[16:19], a[128:131], v[204:207], v[16:19]
    s_waitcnt lgkmcnt(0)
    v_rsq_f32 v247, v247
    v_mfma_f32_16x16x32_bf16 v[16:19], a[132:135], v[208:211], v[16:19]
    buffer_load_dwordx4 v3, s[4:7], s31 offen sc1 lds
    v_mfma_f32_16x16x32_bf16 v[16:19], a[136:139], v[212:215], v[16:19]
    v_fma_f32 v248, v248, s45, v252
    v_fma_f32 v249, v249, s45, v252
    v_mfma_f32_16x16x32_bf16 v[16:19], a[140:143], v[216:219], v[16:19]
    s_add_u32 s30, s24, 241664
    v_rsq_f32 v248, v248
    v_mfma_f32_16x16x32_bf16 v[20:23], a[144:147], v[184:187], v[20:23]
    ds_read_b128 v[220:223], v4 offset:17408
    ds_read_b128 v[224:227], v4 offset:18432
    v_mfma_f32_16x16x32_bf16 v[20:23], a[148:151], v[188:191], v[20:23]
    s_waitcnt vmcnt(11)
    ds_read_b128 v[228:231], v4 offset:19456
    v_fma_f32 v250, v250, s45, v252
    v_mfma_f32_16x16x32_bf16 v[20:23], a[152:155], v[192:195], v[20:23]
    buffer_load_dwordx4 a[20:23], v3, s[4:7], s30 offen sc1
    v_mfma_f32_16x16x32_bf16 v[20:23], a[156:159], v[196:199], v[20:23]
    s_barrier
    v_rsq_f32 v249, v249
    v_mfma_f32_16x16x32_bf16 v[20:23], a[160:163], v[200:203], v[20:23]
    s_add_u32 s30, s24, 245760
    v_rsq_f32 v250, v250
    v_mfma_f32_16x16x32_bf16 v[20:23], a[164:167], v[204:207], v[20:23]
    s_waitcnt vmcnt(11)
    v_fma_f32 v251, v251, s45, v252
    v_and_b32 v13, 31, v0
    v_mfma_f32_16x16x32_bf16 v[20:23], a[168:171], v[208:211], v[20:23]
    buffer_load_dwordx4 a[24:27], v3, s[4:7], s30 offen sc1
    v_mfma_f32_16x16x32_bf16 v[20:23], a[172:175], v[212:215], v[20:23]
    s_add_u32 m0, s26, 122880
    ds_read_b128 a[232:235], v4 offset:20480
    ds_read_b128 a[236:239], v4 offset:21504
    v_mfma_f32_16x16x32_bf16 v[20:23], a[176:179], v[216:219], v[20:23]
    s_add_u32 s31, s25, 67584
    ds_read_b128 a[240:243], v4 offset:22528
    v_mov_b32 v252, 1
    v_mfma_f32_16x16x32_bf16 v[24:27], a[180:183], v[184:187], v[24:27]
    ds_read_b128 a[244:247], v4 offset:23552
    ds_read_b128 a[248:251], v4 offset:24576
    v_mfma_f32_16x16x32_bf16 v[24:27], a[184:187], v[188:191], v[24:27]
    ds_read_b128 a[252:255], v4 offset:25600
    v_lshl_add_u32 v13, v13, 7, s12
    v_mfma_f32_16x16x32_bf16 v[24:27], a[188:191], v[192:195], v[24:27]
    buffer_load_dwordx4 v3, s[4:7], s31 offen sc1 lds
    v_mfma_f32_16x16x32_bf16 v[24:27], a[192:195], v[196:199], v[24:27]
    v_rsq_f32 v251, v251
    v_mfma_f32_16x16x32_bf16 v[24:27], a[196:199], v[200:203], v[24:27]
    s_add_u32 s30, s24, 249856
    v_min_u32 v13, ffn0_part_end-ffn0_part-4, v13
    v_mul_f32 v16, v16, v244
    v_mfma_f32_16x16x32_bf16 v[24:27], a[200:203], v[204:207], v[24:27]
    v_mul_f32 v17, v17, v244
    v_fma_f32 v232, -v16, v16, s29
    v_mfma_f32_16x16x32_bf16 v[24:27], a[204:207], v[208:211], v[24:27]
    buffer_load_dwordx4 a[28:31], v3, s[4:7], s30 offen sc1
    v_mfma_f32_16x16x32_bf16 v[24:27], a[208:211], v[212:215], v[24:27]
    s_add_u32 m0, s26, 126976
    v_fma_f32 v233, -v17, v17, s29
    v_mul_f32 v232, v232, v16
    v_mfma_f32_16x16x32_bf16 v[24:27], a[212:215], v[216:219], v[24:27]
    s_waitcnt lgkmcnt(3)
    v_mul_f32 v233, v233, v17
    v_mul_f32 v18, v16, v18
    v_mfma_f32_16x16x32_bf16 v[28:31], a[108:111], v[220:223], v[28:31]
    s_add_u32 s31, s17, 71680
    v_exp_f32 v232, v232
    v_mfma_f32_16x16x32_bf16 v[28:31], a[112:115], v[224:227], v[28:31]
    buffer_load_dwordx4 v3, s[4:7], s31 offen sc1 lds
    v_mfma_f32_16x16x32_bf16 v[28:31], a[116:119], v[228:231], v[28:31]
    v_exp_f32 v233, v233
    v_mfma_f32_16x16x32_bf16 v[28:31], a[120:123], a[232:235], v[28:31]
    v_mul_f32 v19, v17, v19
    v_add_f32 v232, 1.0, v232
    v_mfma_f32_16x16x32_bf16 v[28:31], a[124:127], a[236:239], v[28:31]
    s_add_u32 s30, s24, 253952
    v_add_f32 v233, 1.0, v233
    v_mul_f32 v20, v20, v244
    v_mfma_f32_16x16x32_bf16 v[28:31], a[128:131], a[240:243], v[28:31]
    s_waitcnt lgkmcnt(0)
    v_rcp_f32 v232, v232
    v_mfma_f32_16x16x32_bf16 v[28:31], a[132:135], a[244:247], v[28:31]
    buffer_load_dwordx4 a[32:35], v3, s[4:7], s30 offen sc1
    v_mfma_f32_16x16x32_bf16 v[28:31], a[136:139], a[248:251], v[28:31]
    v_rcp_f32 v233, v233
    v_mfma_f32_16x16x32_bf16 v[28:31], a[140:143], a[252:255], v[28:31]
    v_mul_f32 v232, v18, v232
    v_mul_f32 v233, v19, v233
    v_mfma_f32_16x16x32_bf16 v[32:35], a[144:147], v[220:223], v[32:35]
    s_add_u32 s30, s24, 258048
    ds_read_b128 v[184:187], v4 offset:26624
    ds_read_b128 v[188:191], v4 offset:27648
    v_mfma_f32_16x16x32_bf16 v[32:35], a[148:151], v[224:227], v[32:35]
    ds_read_b128 v[192:195], v4 offset:28672
    v_cvt_pk_bf16_f32 v112, v232, v233
    v_mfma_f32_16x16x32_bf16 v[32:35], a[152:155], v[228:231], v[32:35]
    buffer_load_dwordx4 a[36:39], v3, s[4:7], s30 offen sc1
    v_mfma_f32_16x16x32_bf16 v[32:35], a[156:159], a[232:235], v[32:35]
    s_add_u32 m0, s26, 131072
    v_mul_f32 v21, v21, v244
    v_fma_f32 v234, -v20, v20, s29
    v_mfma_f32_16x16x32_bf16 v[32:35], a[160:163], a[236:239], v[32:35]
    s_add_u32 s31, s25, 103424
    v_fma_f32 v235, -v21, v21, s29
    v_mul_f32 v234, v234, v20
    v_mfma_f32_16x16x32_bf16 v[32:35], a[164:167], a[240:243], v[32:35]
    v_mul_f32 v235, v235, v21
    v_mul_f32 v22, v20, v22
    v_mfma_f32_16x16x32_bf16 v[32:35], a[168:171], a[244:247], v[32:35]
    buffer_load_dwordx4 v3, s[4:7], s31 offen sc1 lds
    v_mfma_f32_16x16x32_bf16 v[32:35], a[172:175], a[248:251], v[32:35]
    ds_read_b128 v[196:199], v4 offset:29696
    ds_read_b128 v[200:203], v4 offset:30720
    v_mfma_f32_16x16x32_bf16 v[32:35], a[176:179], a[252:255], v[32:35]
    ds_read_b128 v[204:207], v4 offset:31744
    v_mul_f32 v23, v21, v23
    v_mfma_f32_16x16x32_bf16 v[36:39], a[180:183], v[220:223], v[36:39]
    s_add_u32 s30, s24, 262144
    ds_read_b128 v[208:211], v4 offset:32768
    ds_read_b128 v[212:215], v4 offset:33792
    v_mfma_f32_16x16x32_bf16 v[36:39], a[184:187], v[224:227], v[36:39]
    ds_read_b128 v[216:219], v4 offset:34816
    v_mul_f32 v24, v24, v244
    v_mfma_f32_16x16x32_bf16 v[36:39], a[188:191], v[228:231], v[36:39]
    buffer_load_dwordx4 a[40:43], v3, s[4:7], s30 offen sc1
    v_mfma_f32_16x16x32_bf16 v[36:39], a[192:195], a[232:235], v[36:39]
    v_exp_f32 v234, v234
    v_mfma_f32_16x16x32_bf16 v[36:39], a[196:199], a[236:239], v[36:39]
    s_add_u32 s30, s24, 266240
    v_exp_f32 v235, v235
    v_mfma_f32_16x16x32_bf16 v[36:39], a[200:203], a[240:243], v[36:39]
    v_add_f32 v234, 1.0, v234
    v_add_f32 v235, 1.0, v235
    v_mfma_f32_16x16x32_bf16 v[36:39], a[204:207], a[244:247], v[36:39]
    buffer_load_dwordx4 a[44:47], v3, s[4:7], s30 offen sc1
    v_mfma_f32_16x16x32_bf16 v[36:39], a[208:211], a[248:251], v[36:39]
    v_rcp_f32 v234, v234
    v_mfma_f32_16x16x32_bf16 v[36:39], a[212:215], a[252:255], v[36:39]
    s_waitcnt lgkmcnt(3)
    v_rcp_f32 v235, v235
    v_mfma_f32_16x16x32_bf16 v[40:43], a[108:111], v[184:187], v[40:43]
    s_add_u32 m0, s26, 135168
    v_mul_f32 v234, v22, v234
    v_mul_f32 v235, v23, v235
    v_mfma_f32_16x16x32_bf16 v[40:43], a[112:115], v[188:191], v[40:43]
    s_add_u32 s31, s18, 107520
    v_cvt_pk_bf16_f32 v113, v234, v235
    v_mul_f32 v25, v25, v244
    v_mfma_f32_16x16x32_bf16 v[40:43], a[116:119], v[192:195], v[40:43]
    buffer_load_dwordx4 v3, s[4:7], s31 offen sc1 lds
    v_mfma_f32_16x16x32_bf16 v[40:43], a[120:123], v[196:199], v[40:43]
    s_waitcnt vmcnt(16)
    v_readfirstlane_b32 s27, v254
    s_nop 0
    s_cmp_ge_u32 s27, s13
    s_cbranch_scc0 ffn0_part_w1w
ffn0_part_w1b:
    v_mfma_f32_16x16x32_bf16 v[40:43], a[124:127], v[200:203], v[40:43]
    v_fma_f32 v236, -v24, v24, s29
    v_fma_f32 v237, -v25, v25, s29
    v_mfma_f32_16x16x32_bf16 v[40:43], a[128:131], v[204:207], v[40:43]
    s_waitcnt lgkmcnt(0)
    v_mul_f32 v236, v236, v24
    v_mul_f32 v237, v237, v25
    v_mfma_f32_16x16x32_bf16 v[40:43], a[132:135], v[208:211], v[40:43]
    s_add_u32 s30, s24, 270336
    v_exp_f32 v236, v236
    v_mfma_f32_16x16x32_bf16 v[40:43], a[136:139], v[212:215], v[40:43]
    buffer_load_dwordx4 a[48:51], v3, s[4:7], s30 offen sc1
    v_mfma_f32_16x16x32_bf16 v[40:43], a[140:143], v[216:219], v[40:43]
    s_add_u32 m0, s26, 139264
    v_exp_f32 v237, v237
    v_mfma_f32_16x16x32_bf16 v[44:47], a[144:147], v[184:187], v[44:47]
    s_add_u32 s31, s25, 139264
    ds_read_b128 v[220:223], v4 offset:35840
    ds_read_b128 v[224:227], v4 offset:36864
    v_mfma_f32_16x16x32_bf16 v[44:47], a[148:151], v[188:191], v[44:47]
    ds_read_b128 v[228:231], v4 offset:37888
    v_mul_f32 v26, v24, v26
    v_mfma_f32_16x16x32_bf16 v[44:47], a[152:155], v[192:195], v[44:47]
    buffer_load_dwordx4 v3, s[4:7], s31 offen sc1 lds
    v_mfma_f32_16x16x32_bf16 v[44:47], a[156:159], v[196:199], v[44:47]
    v_mul_f32 v27, v25, v27
    v_add_f32 v236, 1.0, v236
    v_mfma_f32_16x16x32_bf16 v[44:47], a[160:163], v[200:203], v[44:47]
    v_add_f32 v237, 1.0, v237
    v_mul_f32 v28, v28, v245
    v_mfma_f32_16x16x32_bf16 v[44:47], a[164:167], v[204:207], v[44:47]
    s_add_u32 s30, s24, 274432
    v_rcp_f32 v236, v236
    v_mfma_f32_16x16x32_bf16 v[44:47], a[168:171], v[208:211], v[44:47]
    v_rcp_f32 v237, v237
    v_mfma_f32_16x16x32_bf16 v[44:47], a[172:175], v[212:215], v[44:47]
    s_waitcnt vmcnt(10)
    ds_read_b128 a[232:235], v4 offset:38912
    ds_read_b128 a[236:239], v4 offset:39936
    v_mfma_f32_16x16x32_bf16 v[44:47], a[176:179], v[216:219], v[44:47]
    s_barrier
    ds_read_b128 a[240:243], v4 offset:40960
    v_mul_f32 v236, v26, v236
    v_mfma_f32_16x16x32_bf16 v[48:51], a[180:183], v[184:187], v[48:51]
    ds_read_b128 a[244:247], v4 offset:41984
    ds_read_b128 a[248:251], v4 offset:43008
    v_mfma_f32_16x16x32_bf16 v[48:51], a[184:187], v[188:191], v[48:51]
    ds_read_b128 a[252:255], v4 offset:44032
    v_mul_f32 v237, v27, v237
    v_mfma_f32_16x16x32_bf16 v[48:51], a[188:191], v[192:195], v[48:51]
    buffer_load_dwordx4 a[52:55], v3, s[4:7], s30 offen sc1
    v_mfma_f32_16x16x32_bf16 v[48:51], a[192:195], v[196:199], v[48:51]
    s_add_u32 m0, s26, 143360
    v_cvt_pk_bf16_f32 v114, v236, v237
    v_mul_f32 v29, v29, v245
    v_mfma_f32_16x16x32_bf16 v[48:51], a[196:199], v[200:203], v[48:51]
    s_add_u32 s31, s25, 143360
    v_fma_f32 v238, -v28, v28, s29
    v_fma_f32 v239, -v29, v29, s29
    v_mfma_f32_16x16x32_bf16 v[48:51], a[200:203], v[204:207], v[48:51]
    buffer_load_dwordx4 v3, s[4:7], s31 offen sc1 lds
    v_mfma_f32_16x16x32_bf16 v[48:51], a[204:207], v[208:211], v[48:51]
    v_mul_f32 v238, v238, v28
    v_mul_f32 v239, v239, v29
    v_mfma_f32_16x16x32_bf16 v[48:51], a[208:211], v[212:215], v[48:51]
    s_add_u32 s30, s24, 278528
    v_exp_f32 v238, v238
    v_mfma_f32_16x16x32_bf16 v[48:51], a[212:215], v[216:219], v[48:51]
    s_waitcnt lgkmcnt(3)
    v_exp_f32 v239, v239
    v_mfma_f32_16x16x32_bf16 v[52:55], a[108:111], v[220:223], v[52:55]
    buffer_load_dwordx4 a[56:59], v3, s[4:7], s30 offen sc1
    v_mfma_f32_16x16x32_bf16 v[52:55], a[112:115], v[224:227], v[52:55]
    v_mul_f32 v30, v28, v30
    v_mul_f32 v31, v29, v31
    v_mfma_f32_16x16x32_bf16 v[52:55], a[116:119], v[228:231], v[52:55]
    v_add_f32 v238, 1.0, v238
    v_add_f32 v239, 1.0, v239
    v_mfma_f32_16x16x32_bf16 v[52:55], a[120:123], a[232:235], v[52:55]
    s_add_u32 s30, s24, 282624
    v_rcp_f32 v238, v238
    v_mfma_f32_16x16x32_bf16 v[52:55], a[124:127], a[236:239], v[52:55]
    v_rcp_f32 v239, v239
    v_mfma_f32_16x16x32_bf16 v[52:55], a[128:131], a[240:243], v[52:55]
    s_waitcnt lgkmcnt(0)
    v_mul_f32 v238, v30, v238
    v_mul_f32 v239, v31, v239
    v_mfma_f32_16x16x32_bf16 v[52:55], a[132:135], a[244:247], v[52:55]
    buffer_load_dwordx4 a[60:63], v3, s[4:7], s30 offen sc1
    v_mfma_f32_16x16x32_bf16 v[52:55], a[136:139], a[248:251], v[52:55]
    s_add_u32 s30, s24, 286720
    v_cvt_pk_bf16_f32 v116, v238, v239
    v_mul_f32 v32, v32, v245
    v_mfma_f32_16x16x32_bf16 v[52:55], a[140:143], a[252:255], v[52:55]
    v_mul_f32 v33, v33, v245
    v_fma_f32 v240, -v32, v32, s29
    v_mfma_f32_16x16x32_bf16 v[56:59], a[144:147], v[220:223], v[56:59]
    ds_read_b128 v[184:187], v4 offset:45056
    ds_read_b128 v[188:191], v4 offset:46080
    v_mfma_f32_16x16x32_bf16 v[56:59], a[148:151], v[224:227], v[56:59]
    ds_read_b128 v[192:195], v4 offset:47104
    v_fma_f32 v241, -v33, v33, s29
    v_mfma_f32_16x16x32_bf16 v[56:59], a[152:155], v[228:231], v[56:59]
    buffer_load_dwordx4 a[64:67], v3, s[4:7], s30 offen sc1
    v_mfma_f32_16x16x32_bf16 v[56:59], a[156:159], a[232:235], v[56:59]
    s_add_u32 s30, s24, 290816
    v_mul_f32 v240, v240, v32
    v_mul_f32 v241, v241, v33
    v_mfma_f32_16x16x32_bf16 v[56:59], a[160:163], a[236:239], v[56:59]
    v_exp_f32 v240, v240
    v_mfma_f32_16x16x32_bf16 v[56:59], a[164:167], a[240:243], v[56:59]
    buffer_load_dwordx4 a[68:71], v3, s[4:7], s30 offen sc1
    v_mfma_f32_16x16x32_bf16 v[56:59], a[168:171], a[244:247], v[56:59]
    v_exp_f32 v241, v241
    v_mfma_f32_16x16x32_bf16 v[56:59], a[172:175], a[248:251], v[56:59]
    ds_read_b128 v[196:199], v4 offset:48128
    ds_read_b128 v[200:203], v4 offset:49152
    v_mfma_f32_16x16x32_bf16 v[56:59], a[176:179], a[252:255], v[56:59]
    s_add_u32 s30, s24, 294912
    ds_read_b128 v[204:207], v4 offset:50176
    v_mul_f32 v34, v32, v34
    v_mfma_f32_16x16x32_bf16 v[60:63], a[180:183], v[220:223], v[60:63]
ffn0_part_pad0_3x:
    s_cbranch_execz ffn0_part_pad0_7x
    ds_read_b128 v[208:211], v4 offset:51200
    ds_read_b128 v[212:215], v4 offset:52224
    v_mfma_f32_16x16x32_bf16 v[60:63], a[184:187], v[224:227], v[60:63]
    ds_read_b128 v[216:219], v4 offset:53248
    v_mul_f32 v35, v33, v35
    v_mfma_f32_16x16x32_bf16 v[60:63], a[188:191], v[228:231], v[60:63]
    buffer_load_dwordx4 a[72:75], v3, s[4:7], s30 offen sc1
    v_mfma_f32_16x16x32_bf16 v[60:63], a[192:195], a[232:235], v[60:63]
    s_add_u32 s30, s24, 299008
    v_add_f32 v240, 1.0, v240
    v_add_f32 v241, 1.0, v241
    v_mfma_f32_16x16x32_bf16 v[60:63], a[196:199], a[236:239], v[60:63]
    v_rcp_f32 v240, v240
    v_mfma_f32_16x16x32_bf16 v[60:63], a[200:203], a[240:243], v[60:63]
    buffer_load_dwordx4 a[76:79], v3, s[4:7], s30 offen sc1
    v_mfma_f32_16x16x32_bf16 v[60:63], a[204:207], a[244:247], v[60:63]
    v_rcp_f32 v241, v241
    v_mfma_f32_16x16x32_bf16 v[60:63], a[208:211], a[248:251], v[60:63]
    v_mul_f32 v240, v34, v240
    v_mul_f32 v241, v35, v241
    v_mfma_f32_16x16x32_bf16 v[60:63], a[212:215], a[252:255], v[60:63]
    s_waitcnt lgkmcnt(3)
    v_cvt_pk_bf16_f32 v117, v240, v241
    v_mul_f32 v36, v36, v245
    v_mfma_f32_16x16x32_bf16 v[64:67], a[108:111], v[184:187], v[64:67]
    s_add_u32 s30, s24, 303104
    v_mul_f32 v37, v37, v245
    v_fma_f32 v242, -v36, v36, s29
    v_mfma_f32_16x16x32_bf16 v[64:67], a[112:115], v[188:191], v[64:67]
    buffer_load_dwordx4 a[80:83], v3, s[4:7], s30 offen sc1
    v_mfma_f32_16x16x32_bf16 v[64:67], a[116:119], v[192:195], v[64:67]
    v_fma_f32 v243, -v37, v37, s29
    v_mul_f32 v242, v242, v36
    v_mfma_f32_16x16x32_bf16 v[64:67], a[120:123], v[196:199], v[64:67]
    s_add_u32 s30, s24, 307200
    v_mul_f32 v243, v243, v37
    v_mul_f32 v38, v36, v38
    v_mfma_f32_16x16x32_bf16 v[64:67], a[124:127], v[200:203], v[64:67]
    v_exp_f32 v242, v242
    v_mfma_f32_16x16x32_bf16 v[64:67], a[128:131], v[204:207], v[64:67]
    s_waitcnt lgkmcnt(0)
    v_exp_f32 v243, v243
    v_mfma_f32_16x16x32_bf16 v[64:67], a[132:135], v[208:211], v[64:67]
    buffer_load_dwordx4 a[84:87], v3, s[4:7], s30 offen sc1
    v_mfma_f32_16x16x32_bf16 v[64:67], a[136:139], v[212:215], v[64:67]
    v_mul_f32 v39, v37, v39
    v_add_f32 v242, 1.0, v242
    v_mfma_f32_16x16x32_bf16 v[64:67], a[140:143], v[216:219], v[64:67]
    s_add_u32 s30, s24, 311296
    v_add_f32 v243, 1.0, v243
    v_mul_f32 v40, v40, v246
    v_mfma_f32_16x16x32_bf16 v[68:71], a[144:147], v[184:187], v[68:71]
    ds_read_b128 v[220:223], v4 offset:54272
    ds_read_b128 v[224:227], v4 offset:55296
    v_mfma_f32_16x16x32_bf16 v[68:71], a[148:151], v[188:191], v[68:71]
    ds_read_b128 v[228:231], v4 offset:56320
    v_mul_f32 v41, v41, v246
    v_mfma_f32_16x16x32_bf16 v[68:71], a[152:155], v[192:195], v[68:71]
    buffer_load_dwordx4 a[88:91], v3, s[4:7], s30 offen sc1
    v_mfma_f32_16x16x32_bf16 v[68:71], a[156:159], v[196:199], v[68:71]
    v_rcp_f32 v242, v242
    v_mfma_f32_16x16x32_bf16 v[68:71], a[160:163], v[200:203], v[68:71]
    s_add_u32 s30, s24, 315392
    v_rcp_f32 v243, v243
    v_mfma_f32_16x16x32_bf16 v[68:71], a[164:167], v[204:207], v[68:71]
    v_mul_f32 v242, v38, v242
    v_mul_f32 v243, v39, v243
    v_mfma_f32_16x16x32_bf16 v[68:71], a[168:171], v[208:211], v[68:71]
    buffer_load_dwordx4 a[92:95], v3, s[4:7], s30 offen sc1
    v_mfma_f32_16x16x32_bf16 v[68:71], a[172:175], v[212:215], v[68:71]
    s_waitcnt vmcnt(10)
    ds_read_b128 a[232:235], v4 offset:57344
    ds_read_b128 a[236:239], v4 offset:58368
    v_mfma_f32_16x16x32_bf16 v[68:71], a[176:179], v[216:219], v[68:71]
    s_add_u32 s30, s24, 319488
    ds_read_b128 a[240:243], v4 offset:59392
    v_cvt_pk_bf16_f32 v118, v242, v243
    v_mfma_f32_16x16x32_bf16 v[72:75], a[180:183], v[184:187], v[72:75]
    s_barrier
    ds_read_b128 a[244:247], v4 offset:60416
    ds_read_b128 a[248:251], v4 offset:61440
    v_mfma_f32_16x16x32_bf16 v[72:75], a[184:187], v[188:191], v[72:75]
    ds_read_b128 a[252:255], v4 offset:62464
    v_fma_f32 v232, -v40, v40, s29
    v_mfma_f32_16x16x32_bf16 v[72:75], a[188:191], v[192:195], v[72:75]
    buffer_load_dwordx4 a[96:99], v3, s[4:7], s30 offen sc1
    v_mfma_f32_16x16x32_bf16 v[72:75], a[192:195], v[196:199], v[72:75]
    v_fma_f32 v233, -v41, v41, s29
    v_mul_f32 v232, v232, v40
    v_mfma_f32_16x16x32_bf16 v[72:75], a[196:199], v[200:203], v[72:75]
    s_add_u32 s30, s24, 323584
    v_mul_f32 v233, v233, v41
    v_mul_f32 v42, v40, v42
    v_mfma_f32_16x16x32_bf16 v[72:75], a[200:203], v[204:207], v[72:75]
    v_exp_f32 v232, v232
    v_mfma_f32_16x16x32_bf16 v[72:75], a[204:207], v[208:211], v[72:75]
    buffer_load_dwordx4 a[100:103], v3, s[4:7], s30 offen sc1
    v_mfma_f32_16x16x32_bf16 v[72:75], a[208:211], v[212:215], v[72:75]
    v_exp_f32 v233, v233
    v_mfma_f32_16x16x32_bf16 v[72:75], a[212:215], v[216:219], v[72:75]
    s_waitcnt lgkmcnt(3)
    v_mul_f32 v43, v41, v43
    v_add_f32 v232, 1.0, v232
    v_mfma_f32_16x16x32_bf16 v[76:79], a[108:111], v[220:223], v[76:79]
    s_add_u32 s30, s24, 327680
    v_add_f32 v233, 1.0, v233
    v_mul_f32 v44, v44, v246
    v_mfma_f32_16x16x32_bf16 v[76:79], a[112:115], v[224:227], v[76:79]
    buffer_load_dwordx4 a[104:107], v3, s[4:7], s30 offen sc1
    v_mfma_f32_16x16x32_bf16 v[76:79], a[116:119], v[228:231], v[76:79]
    v_rcp_f32 v232, v232
    v_mfma_f32_16x16x32_bf16 v[76:79], a[120:123], a[232:235], v[76:79]
    v_rcp_f32 v233, v233
    v_mfma_f32_16x16x32_bf16 v[76:79], a[124:127], a[236:239], v[76:79]
    v_mul_f32 v232, v42, v232
    v_mul_f32 v233, v43, v233
    v_mfma_f32_16x16x32_bf16 v[76:79], a[128:131], a[240:243], v[76:79]
    s_waitcnt lgkmcnt(0)
    v_cvt_pk_bf16_f32 v120, v232, v233
    v_mul_f32 v45, v45, v246
    v_mfma_f32_16x16x32_bf16 v[76:79], a[132:135], a[244:247], v[76:79]
    v_fma_f32 v234, -v44, v44, s29
    v_fma_f32 v235, -v45, v45, s29
    v_mfma_f32_16x16x32_bf16 v[76:79], a[136:139], a[248:251], v[76:79]
    v_mul_f32 v234, v234, v44
    v_mul_f32 v235, v235, v45
    v_mfma_f32_16x16x32_bf16 v[76:79], a[140:143], a[252:255], v[76:79]
    v_exp_f32 v234, v234
    v_mfma_f32_16x16x32_bf16 v[80:83], a[144:147], v[220:223], v[80:83]
    ds_read_b128 v[184:187], v4 offset:63488
    ds_read_b128 v[188:191], v4 offset:64512
    v_mfma_f32_16x16x32_bf16 v[80:83], a[148:151], v[224:227], v[80:83]
    ds_read_b128 v[192:195], v5 offset:0
    v_mul_f32 v46, v44, v46
    v_mfma_f32_16x16x32_bf16 v[80:83], a[152:155], v[228:231], v[80:83]
    v_exp_f32 v235, v235
    v_mfma_f32_16x16x32_bf16 v[80:83], a[156:159], a[232:235], v[80:83]
    v_mul_f32 v47, v45, v47
    v_add_f32 v234, 1.0, v234
    v_mfma_f32_16x16x32_bf16 v[80:83], a[160:163], a[236:239], v[80:83]
    v_add_f32 v235, 1.0, v235
    v_mul_f32 v48, v48, v246
    v_mfma_f32_16x16x32_bf16 v[80:83], a[164:167], a[240:243], v[80:83]
    v_rcp_f32 v234, v234
    v_mfma_f32_16x16x32_bf16 v[80:83], a[168:171], a[244:247], v[80:83]
    v_rcp_f32 v235, v235
    v_mfma_f32_16x16x32_bf16 v[80:83], a[172:175], a[248:251], v[80:83]
    ds_read_b128 v[196:199], v5 offset:1024
    ds_read_b128 v[200:203], v5 offset:2048
    v_mfma_f32_16x16x32_bf16 v[80:83], a[176:179], a[252:255], v[80:83]
    ds_read_b128 v[204:207], v5 offset:3072
    v_mul_f32 v234, v46, v234
    v_mfma_f32_16x16x32_bf16 v[84:87], a[180:183], v[220:223], v[84:87]
    ds_read_b128 v[208:211], v5 offset:4096
    ds_read_b128 v[212:215], v5 offset:5120
    v_mfma_f32_16x16x32_bf16 v[84:87], a[184:187], v[224:227], v[84:87]
    ds_read_b128 v[216:219], v5 offset:6144
    v_mul_f32 v235, v47, v235
    v_mfma_f32_16x16x32_bf16 v[84:87], a[188:191], v[228:231], v[84:87]
    v_cvt_pk_bf16_f32 v121, v234, v235
    v_mul_f32 v49, v49, v246
    v_mfma_f32_16x16x32_bf16 v[84:87], a[192:195], a[232:235], v[84:87]
    v_fma_f32 v236, -v48, v48, s29
    v_fma_f32 v237, -v49, v49, s29
    v_mfma_f32_16x16x32_bf16 v[84:87], a[196:199], a[236:239], v[84:87]
    v_mul_f32 v236, v236, v48
    v_mul_f32 v237, v237, v49
    v_mfma_f32_16x16x32_bf16 v[84:87], a[200:203], a[240:243], v[84:87]
    v_exp_f32 v236, v236
    v_mfma_f32_16x16x32_bf16 v[84:87], a[204:207], a[244:247], v[84:87]
    v_exp_f32 v237, v237
    v_mfma_f32_16x16x32_bf16 v[84:87], a[208:211], a[248:251], v[84:87]
    v_mul_f32 v50, v48, v50
    v_mul_f32 v51, v49, v51
    v_mfma_f32_16x16x32_bf16 v[84:87], a[212:215], a[252:255], v[84:87]
    s_waitcnt lgkmcnt(3)
    v_add_f32 v236, 1.0, v236
    v_add_f32 v237, 1.0, v237
    v_mfma_f32_16x16x32_bf16 v[88:91], a[108:111], v[184:187], v[88:91]
    v_rcp_f32 v236, v236
    v_mfma_f32_16x16x32_bf16 v[88:91], a[112:115], v[188:191], v[88:91]
    v_rcp_f32 v237, v237
    v_mfma_f32_16x16x32_bf16 v[88:91], a[116:119], v[192:195], v[88:91]
    v_mul_f32 v236, v50, v236
    v_mul_f32 v237, v51, v237
    v_mfma_f32_16x16x32_bf16 v[88:91], a[120:123], v[196:199], v[88:91]
    v_cvt_pk_bf16_f32 v122, v236, v237
    v_mul_f32 v52, v52, v247
    v_mfma_f32_16x16x32_bf16 v[88:91], a[124:127], v[200:203], v[88:91]
    v_mul_f32 v53, v53, v247
    v_fma_f32 v238, -v52, v52, s29
    v_mfma_f32_16x16x32_bf16 v[88:91], a[128:131], v[204:207], v[88:91]
    s_waitcnt lgkmcnt(0)
    v_fma_f32 v239, -v53, v53, s29
    v_mul_f32 v238, v238, v52
    v_mfma_f32_16x16x32_bf16 v[88:91], a[132:135], v[208:211], v[88:91]
    v_mul_f32 v239, v239, v53
    v_mul_f32 v54, v52, v54
    v_mfma_f32_16x16x32_bf16 v[88:91], a[136:139], v[212:215], v[88:91]
    v_exp_f32 v238, v238
    v_mfma_f32_16x16x32_bf16 v[88:91], a[140:143], v[216:219], v[88:91]
    v_exp_f32 v239, v239
    v_mfma_f32_16x16x32_bf16 v[92:95], a[144:147], v[184:187], v[92:95]
    ds_read_b128 v[220:223], v5 offset:7168
    ds_read_b128 v[224:227], v5 offset:8192
    v_mfma_f32_16x16x32_bf16 v[92:95], a[148:151], v[188:191], v[92:95]
    ds_read_b128 v[228:231], v5 offset:9216
    v_mul_f32 v55, v53, v55
    v_mfma_f32_16x16x32_bf16 v[92:95], a[152:155], v[192:195], v[92:95]
    v_add_f32 v238, 1.0, v238
    v_add_f32 v239, 1.0, v239
    v_mfma_f32_16x16x32_bf16 v[92:95], a[156:159], v[196:199], v[92:95]
    v_rcp_f32 v238, v238
    v_mfma_f32_16x16x32_bf16 v[92:95], a[160:163], v[200:203], v[92:95]
    v_rcp_f32 v239, v239
    v_mfma_f32_16x16x32_bf16 v[92:95], a[164:167], v[204:207], v[92:95]
    v_mul_f32 v238, v54, v238
    v_mul_f32 v239, v55, v239
    v_mfma_f32_16x16x32_bf16 v[92:95], a[168:171], v[208:211], v[92:95]
    v_cvt_pk_bf16_f32 v124, v238, v239
    v_mul_f32 v56, v56, v247
    v_mfma_f32_16x16x32_bf16 v[92:95], a[172:175], v[212:215], v[92:95]
    ds_read_b128 a[232:235], v5 offset:10240
    ds_read_b128 a[236:239], v5 offset:11264
    v_mfma_f32_16x16x32_bf16 v[92:95], a[176:179], v[216:219], v[92:95]
    ds_read_b128 a[240:243], v5 offset:12288
    v_mul_f32 v57, v57, v247
    v_mfma_f32_16x16x32_bf16 v[96:99], a[180:183], v[184:187], v[96:99]
    ds_read_b128 a[244:247], v5 offset:13312
    ds_read_b128 a[248:251], v5 offset:14336
    v_mfma_f32_16x16x32_bf16 v[96:99], a[184:187], v[188:191], v[96:99]
    ds_read_b128 a[252:255], v5 offset:15360
    v_fma_f32 v240, -v56, v56, s29
    v_mfma_f32_16x16x32_bf16 v[96:99], a[188:191], v[192:195], v[96:99]
    v_fma_f32 v241, -v57, v57, s29
    v_mul_f32 v240, v240, v56
    v_mfma_f32_16x16x32_bf16 v[96:99], a[192:195], v[196:199], v[96:99]
    v_mul_f32 v241, v241, v57
    v_mul_f32 v58, v56, v58
    v_mfma_f32_16x16x32_bf16 v[96:99], a[196:199], v[200:203], v[96:99]
    v_exp_f32 v240, v240
    v_mfma_f32_16x16x32_bf16 v[96:99], a[200:203], v[204:207], v[96:99]
    v_exp_f32 v241, v241
    v_mfma_f32_16x16x32_bf16 v[96:99], a[204:207], v[208:211], v[96:99]
    v_mul_f32 v59, v57, v59
    v_add_f32 v240, 1.0, v240
    v_mfma_f32_16x16x32_bf16 v[96:99], a[208:211], v[212:215], v[96:99]
    v_add_f32 v241, 1.0, v241
    v_mul_f32 v60, v60, v247
    v_mfma_f32_16x16x32_bf16 v[96:99], a[212:215], v[216:219], v[96:99]
    s_waitcnt lgkmcnt(3)
    v_rcp_f32 v240, v240
    v_mfma_f32_16x16x32_bf16 v[100:103], a[108:111], v[220:223], v[100:103]
    v_rcp_f32 v241, v241
    v_mfma_f32_16x16x32_bf16 v[100:103], a[112:115], v[224:227], v[100:103]
    v_mul_f32 v240, v58, v240
    v_mul_f32 v241, v59, v241
    v_mfma_f32_16x16x32_bf16 v[100:103], a[116:119], v[228:231], v[100:103]
    v_cvt_pk_bf16_f32 v125, v240, v241
    v_mul_f32 v61, v61, v247
    v_mfma_f32_16x16x32_bf16 v[100:103], a[120:123], a[232:235], v[100:103]
    v_fma_f32 v242, -v60, v60, s29
    v_fma_f32 v243, -v61, v61, s29
    v_mfma_f32_16x16x32_bf16 v[100:103], a[124:127], a[236:239], v[100:103]
    v_mul_f32 v242, v242, v60
    v_mul_f32 v243, v243, v61
    v_mfma_f32_16x16x32_bf16 v[100:103], a[128:131], a[240:243], v[100:103]
    s_waitcnt lgkmcnt(0)
    v_exp_f32 v242, v242
    v_mfma_f32_16x16x32_bf16 v[100:103], a[132:135], a[244:247], v[100:103]
    v_exp_f32 v243, v243
    v_mfma_f32_16x16x32_bf16 v[100:103], a[136:139], a[248:251], v[100:103]
    v_mul_f32 v62, v60, v62
    v_mul_f32 v63, v61, v63
    v_mfma_f32_16x16x32_bf16 v[100:103], a[140:143], a[252:255], v[100:103]
    v_add_f32 v242, 1.0, v242
    v_add_f32 v243, 1.0, v243
    v_mfma_f32_16x16x32_bf16 v[104:107], a[144:147], v[220:223], v[104:107]
    ds_read_b128 v[184:187], v1 offset:0
    ds_read_b128 v[188:191], v1 offset:1024
    v_mfma_f32_16x16x32_bf16 v[104:107], a[148:151], v[224:227], v[104:107]
    ds_read_b128 v[192:195], v1 offset:2048
    v_mul_f32 v64, v64, v248
    v_mfma_f32_16x16x32_bf16 v[104:107], a[152:155], v[228:231], v[104:107]
    v_rcp_f32 v242, v242
    v_mfma_f32_16x16x32_bf16 v[104:107], a[156:159], a[232:235], v[104:107]
    v_rcp_f32 v243, v243
    v_mfma_f32_16x16x32_bf16 v[104:107], a[160:163], a[236:239], v[104:107]
    v_mul_f32 v242, v62, v242
    v_mul_f32 v243, v63, v243
    v_mfma_f32_16x16x32_bf16 v[104:107], a[164:167], a[240:243], v[104:107]
    v_cvt_pk_bf16_f32 v126, v242, v243
    v_mul_f32 v65, v65, v248
    v_mfma_f32_16x16x32_bf16 v[104:107], a[168:171], a[244:247], v[104:107]
    v_fma_f32 v232, -v64, v64, s29
    v_fma_f32 v233, -v65, v65, s29
    v_mfma_f32_16x16x32_bf16 v[104:107], a[172:175], a[248:251], v[104:107]
    ds_read_b128 v[196:199], v1 offset:3072
    ds_read_b128 v[200:203], v1 offset:4096
    v_mfma_f32_16x16x32_bf16 v[104:107], a[176:179], a[252:255], v[104:107]
    ds_read_b128 v[204:207], v1 offset:5120
    v_mul_f32 v232, v232, v64
    v_mfma_f32_16x16x32_bf16 v[108:111], a[180:183], v[220:223], v[108:111]
    ds_read_b128 v[208:211], v1 offset:6144
    ds_read_b128 v[212:215], v1 offset:7168
    v_mfma_f32_16x16x32_bf16 v[108:111], a[184:187], v[224:227], v[108:111]
    ds_read_b128 v[216:219], v1 offset:8192
    v_mul_f32 v233, v233, v65
    v_mfma_f32_16x16x32_bf16 v[108:111], a[188:191], v[228:231], v[108:111]
    v_exp_f32 v232, v232
    v_mfma_f32_16x16x32_bf16 v[108:111], a[192:195], a[232:235], v[108:111]
    v_exp_f32 v233, v233
    v_mfma_f32_16x16x32_bf16 v[108:111], a[196:199], a[236:239], v[108:111]
    v_mul_f32 v66, v64, v66
    v_mul_f32 v67, v65, v67
    v_mfma_f32_16x16x32_bf16 v[108:111], a[200:203], a[240:243], v[108:111]
    v_add_f32 v232, 1.0, v232
    v_add_f32 v233, 1.0, v233
    v_mfma_f32_16x16x32_bf16 v[108:111], a[204:207], a[244:247], v[108:111]
    v_rcp_f32 v232, v232
    v_mfma_f32_16x16x32_bf16 v[108:111], a[208:211], a[248:251], v[108:111]
    s_add_u32 s30, s24, 331776
    v_rcp_f32 v233, v233
    v_mfma_f32_16x16x32_bf16 v[108:111], a[212:215], a[252:255], v[108:111]
    s_waitcnt lgkmcnt(3)
    v_mul_f32 v232, v66, v232
    v_mul_f32 v233, v67, v233
    v_mfma_f32_16x16x32_bf16 v[16:19], a[0:3], v[184:187], 0
    buffer_load_dwordx4 a[108:111], v3, s[4:7], s30 offen sc1
    v_mfma_f32_16x16x32_bf16 v[16:19], a[4:7], v[188:191], v[16:19]
    v_cvt_pk_bf16_f32 v128, v232, v233
    v_mul_f32 v68, v68, v248
    v_mfma_f32_16x16x32_bf16 v[16:19], a[8:11], v[192:195], v[16:19]
    s_add_u32 s30, s24, 335872
    v_mul_f32 v69, v69, v248
    v_fma_f32 v234, -v68, v68, s29
    v_mfma_f32_16x16x32_bf16 v[16:19], a[12:15], v[196:199], v[16:19]
    v_fma_f32 v235, -v69, v69, s29
    v_mul_f32 v234, v234, v68
    v_mfma_f32_16x16x32_bf16 v[16:19], a[16:19], v[200:203], v[16:19]
    buffer_load_dwordx4 a[112:115], v3, s[4:7], s30 offen sc1
    v_mfma_f32_16x16x32_bf16 v[16:19], a[20:23], v[204:207], v[16:19]
    s_waitcnt lgkmcnt(0)
    v_mul_f32 v235, v235, v69
    v_mul_f32 v70, v68, v70
    v_mfma_f32_16x16x32_bf16 v[16:19], a[24:27], v[208:211], v[16:19]
    v_exp_f32 v234, v234
    v_mfma_f32_16x16x32_bf16 v[16:19], a[28:31], v[212:215], v[16:19]
    s_add_u32 s30, s24, 339968
    v_exp_f32 v235, v235
    v_mfma_f32_16x16x32_bf16 v[16:19], a[32:35], v[216:219], v[16:19]
    s_waitcnt vmcnt(11)
    v_mul_f32 v71, v69, v71
    v_add_f32 v234, 1.0, v234
    v_mfma_f32_16x16x32_bf16 v[20:23], a[36:39], v[184:187], 0
    ds_read_b128 v[220:223], v1 offset:9216
    ds_read_b128 v[224:227], v1 offset:10240
    v_mfma_f32_16x16x32_bf16 v[20:23], a[40:43], v[188:191], v[20:23]
    ds_read_b128 v[228:231], v1 offset:11264
    v_add_f32 v235, 1.0, v235
    v_mfma_f32_16x16x32_bf16 v[20:23], a[44:47], v[192:195], v[20:23]
    buffer_load_dwordx4 a[116:119], v3, s[4:7], s30 offen sc1
    v_mfma_f32_16x16x32_bf16 v[20:23], a[48:51], v[196:199], v[20:23]
    v_rcp_f32 v234, v234
    v_mfma_f32_16x16x32_bf16 v[20:23], a[52:55], v[200:203], v[20:23]
    s_add_u32 s30, s24, 344064
    v_rcp_f32 v235, v235
    v_mfma_f32_16x16x32_bf16 v[20:23], a[56:59], v[204:207], v[20:23]
    v_mul_f32 v234, v70, v234
    v_mul_f32 v235, v71, v235
    v_mfma_f32_16x16x32_bf16 v[20:23], a[60:63], v[208:211], v[20:23]
    buffer_load_dwordx4 a[120:123], v3, s[4:7], s30 offen sc1
    v_mfma_f32_16x16x32_bf16 v[20:23], a[64:67], v[212:215], v[20:23]
    ds_read_b128 a[232:235], v1 offset:12288
    ds_read_b128 a[236:239], v1 offset:13312
    v_mfma_f32_16x16x32_bf16 v[20:23], a[68:71], v[216:219], v[20:23]
    s_waitcnt vmcnt(4)
    ds_read_b128 a[240:243], v1 offset:14336
    v_cvt_pk_bf16_f32 v129, v234, v235
    v_mfma_f32_16x16x32_bf16 v[24:27], a[72:75], v[184:187], 0
    s_add_u32 s30, s24, 348160
    ds_read_b128 a[244:247], v1 offset:15360
    ds_read_b128 a[248:251], v1 offset:16384
    v_mfma_f32_16x16x32_bf16 v[24:27], a[76:79], v[188:191], v[24:27]
    ds_read_b128 a[252:255], v1 offset:17408
    v_mul_f32 v72, v72, v248
    v_mfma_f32_16x16x32_bf16 v[24:27], a[80:83], v[192:195], v[24:27]
    buffer_load_dwordx4 a[124:127], v3, s[4:7], s30 offen sc1
    v_mfma_f32_16x16x32_bf16 v[24:27], a[84:87], v[196:199], v[24:27]
    v_mul_f32 v73, v73, v248
    v_fma_f32 v236, -v72, v72, s29
    v_mfma_f32_16x16x32_bf16 v[24:27], a[88:91], v[200:203], v[24:27]
    v_fma_f32 v237, -v73, v73, s29
    v_mul_f32 v236, v236, v72
    v_mfma_f32_16x16x32_bf16 v[24:27], a[92:95], v[204:207], v[24:27]
    v_mul_f32 v237, v237, v73
    v_mul_f32 v74, v72, v74
    v_mfma_f32_16x16x32_bf16 v[24:27], a[96:99], v[208:211], v[24:27]
    s_add_u32 s30, s24, 352256
    v_exp_f32 v236, v236
    v_mfma_f32_16x16x32_bf16 v[24:27], a[100:103], v[212:215], v[24:27]
    v_exp_f32 v237, v237
    v_mfma_f32_16x16x32_bf16 v[24:27], a[104:107], v[216:219], v[24:27]
    s_waitcnt lgkmcnt(3)
    v_mul_f32 v75, v73, v75
    v_add_f32 v236, 1.0, v236
    v_mfma_f32_16x16x32_bf16 v[28:31], a[0:3], v[220:223], 0
    buffer_load_dwordx4 a[128:131], v3, s[4:7], s30 offen sc1
    v_mfma_f32_16x16x32_bf16 v[28:31], a[4:7], v[224:227], v[28:31]
    v_add_f32 v237, 1.0, v237
    v_mul_f32 v76, v76, v249
    v_mfma_f32_16x16x32_bf16 v[28:31], a[8:11], v[228:231], v[28:31]
    s_add_u32 s30, s24, 356352
    v_rcp_f32 v236, v236
    v_mfma_f32_16x16x32_bf16 v[28:31], a[12:15], a[232:235], v[28:31]
    v_rcp_f32 v237, v237
    v_mfma_f32_16x16x32_bf16 v[28:31], a[16:19], a[236:239], v[28:31]
    buffer_load_dwordx4 a[132:135], v3, s[4:7], s30 offen sc1
    v_mfma_f32_16x16x32_bf16 v[28:31], a[20:23], a[240:243], v[28:31]
    s_waitcnt lgkmcnt(0)
    v_mul_f32 v236, v74, v236
    v_mul_f32 v237, v75, v237
    v_mfma_f32_16x16x32_bf16 v[28:31], a[24:27], a[244:247], v[28:31]
    v_cvt_pk_bf16_f32 v130, v236, v237
    v_mul_f32 v77, v77, v249
    v_mfma_f32_16x16x32_bf16 v[28:31], a[28:31], a[248:251], v[28:31]
    v_fma_f32 v238, -v76, v76, s29
    v_fma_f32 v239, -v77, v77, s29
    v_mfma_f32_16x16x32_bf16 v[28:31], a[32:35], a[252:255], v[28:31]
    s_add_u32 s30, s24, 360448
    v_mul_f32 v238, v238, v76
    v_mul_f32 v239, v239, v77
    v_mfma_f32_16x16x32_bf16 v[32:35], a[36:39], v[220:223], 0
    ds_read_b128 v[184:187], v1 offset:18432
    ds_read_b128 v[188:191], v1 offset:19456
    v_mfma_f32_16x16x32_bf16 v[32:35], a[40:43], v[224:227], v[32:35]
    ds_read_b128 v[192:195], v1 offset:20480
    v_mul_f32 v78, v76, v78
    v_mfma_f32_16x16x32_bf16 v[32:35], a[44:47], v[228:231], v[32:35]
    buffer_load_dwordx4 a[136:139], v3, s[4:7], s30 offen sc1
    v_mfma_f32_16x16x32_bf16 v[32:35], a[48:51], a[232:235], v[32:35]
    v_exp_f32 v238, v238
    v_mfma_f32_16x16x32_bf16 v[32:35], a[52:55], a[236:239], v[32:35]
    s_add_u32 s30, s24, 364544
    v_exp_f32 v239, v239
    v_mfma_f32_16x16x32_bf16 v[32:35], a[56:59], a[240:243], v[32:35]
    v_mul_f32 v79, v77, v79
    v_add_f32 v238, 1.0, v238
    v_mfma_f32_16x16x32_bf16 v[32:35], a[60:63], a[244:247], v[32:35]
    buffer_load_dwordx4 a[140:143], v3, s[4:7], s30 offen sc1
    v_mfma_f32_16x16x32_bf16 v[32:35], a[64:67], a[248:251], v[32:35]
    ds_read_b128 v[196:199], v1 offset:21504
    ds_read_b128 v[200:203], v1 offset:22528
    v_mfma_f32_16x16x32_bf16 v[32:35], a[68:71], a[252:255], v[32:35]
    ds_read_b128 v[204:207], v1 offset:23552
    v_add_f32 v239, 1.0, v239
    v_mfma_f32_16x16x32_bf16 v[36:39], a[72:75], v[220:223], 0
    ds_read_b128 v[208:211], v1 offset:24576
    ds_read_b128 v[212:215], v1 offset:25600
    v_mfma_f32_16x16x32_bf16 v[36:39], a[76:79], v[224:227], v[36:39]
    s_add_u32 s30, s24, 368640
    ds_read_b128 v[216:219], v1 offset:26624
    v_mul_f32 v80, v80, v249
    v_mfma_f32_16x16x32_bf16 v[36:39], a[80:83], v[228:231], v[36:39]
    v_rcp_f32 v238, v238
    v_mfma_f32_16x16x32_bf16 v[36:39], a[84:87], a[232:235], v[36:39]
    buffer_load_dwordx4 a[144:147], v3, s[4:7], s30 offen sc1
    v_mfma_f32_16x16x32_bf16 v[36:39], a[88:91], a[236:239], v[36:39]
    v_rcp_f32 v239, v239
    v_mfma_f32_16x16x32_bf16 v[36:39], a[92:95], a[240:243], v[36:39]
    v_mul_f32 v238, v78, v238
    v_mul_f32 v239, v79, v239
    v_mfma_f32_16x16x32_bf16 v[36:39], a[96:99], a[244:247], v[36:39]
    s_add_u32 s30, s24, 372736
    v_cvt_pk_bf16_f32 v132, v238, v239
    v_mul_f32 v81, v81, v249
    v_mfma_f32_16x16x32_bf16 v[36:39], a[100:103], a[248:251], v[36:39]
    v_fma_f32 v240, -v80, v80, s29
    v_fma_f32 v241, -v81, v81, s29
    v_mfma_f32_16x16x32_bf16 v[36:39], a[104:107], a[252:255], v[36:39]
    s_waitcnt lgkmcnt(3)
    v_mul_f32 v240, v240, v80
    v_mul_f32 v241, v241, v81
    v_mfma_f32_16x16x32_bf16 v[40:43], a[0:3], v[184:187], 0
    buffer_load_dwordx4 a[148:151], v3, s[4:7], s30 offen sc1
    v_mfma_f32_16x16x32_bf16 v[40:43], a[4:7], v[188:191], v[40:43]
    v_exp_f32 v240, v240
    v_mfma_f32_16x16x32_bf16 v[40:43], a[8:11], v[192:195], v[40:43]
    v_exp_f32 v241, v241
    v_mfma_f32_16x16x32_bf16 v[40:43], a[12:15], v[196:199], v[40:43]
    s_add_u32 s30, s24, 376832
    v_mul_f32 v82, v80, v82
    v_mul_f32 v83, v81, v83
    v_mfma_f32_16x16x32_bf16 v[40:43], a[16:19], v[200:203], v[40:43]
    v_add_f32 v240, 1.0, v240
    v_add_f32 v241, 1.0, v241
    v_mfma_f32_16x16x32_bf16 v[40:43], a[20:23], v[204:207], v[40:43]
    s_waitcnt lgkmcnt(0)
    v_rcp_f32 v240, v240
    v_mfma_f32_16x16x32_bf16 v[40:43], a[24:27], v[208:211], v[40:43]
    buffer_load_dwordx4 a[152:155], v3, s[4:7], s30 offen sc1
    v_mfma_f32_16x16x32_bf16 v[40:43], a[28:31], v[212:215], v[40:43]
    v_rcp_f32 v241, v241
    v_mfma_f32_16x16x32_bf16 v[40:43], a[32:35], v[216:219], v[40:43]
    s_add_u32 s30, s24, 380928
    v_mul_f32 v240, v82, v240
    v_mul_f32 v241, v83, v241
    v_mfma_f32_16x16x32_bf16 v[44:47], a[36:39], v[184:187], 0
    ds_read_b128 v[220:223], v1 offset:27648
    ds_read_b128 v[224:227], v1 offset:28672
    v_mfma_f32_16x16x32_bf16 v[44:47], a[40:43], v[188:191], v[44:47]
    ds_read_b128 v[228:231], v1 offset:29696
    v_cvt_pk_bf16_f32 v133, v240, v241
    v_mfma_f32_16x16x32_bf16 v[44:47], a[44:47], v[192:195], v[44:47]
    buffer_load_dwordx4 a[156:159], v3, s[4:7], s30 offen sc1
    v_mfma_f32_16x16x32_bf16 v[44:47], a[48:51], v[196:199], v[44:47]
    v_mul_f32 v84, v84, v249
    v_mul_f32 v85, v85, v249
    v_mfma_f32_16x16x32_bf16 v[44:47], a[52:55], v[200:203], v[44:47]
    v_fma_f32 v242, -v84, v84, s29
    v_fma_f32 v243, -v85, v85, s29
    v_mfma_f32_16x16x32_bf16 v[44:47], a[56:59], v[204:207], v[44:47]
    s_add_u32 s30, s24, 385024
    v_mul_f32 v242, v242, v84
    v_mul_f32 v243, v243, v85
    v_mfma_f32_16x16x32_bf16 v[44:47], a[60:63], v[208:211], v[44:47]
    global_load_dword v255, v13, s[10:11]
    v_mfma_f32_16x16x32_bf16 v[44:47], a[64:67], v[212:215], v[44:47]
    ds_read_b128 a[232:235], v1 offset:30720
    ds_read_b128 a[236:239], v1 offset:31744
    v_mfma_f32_16x16x32_bf16 v[44:47], a[68:71], v[216:219], v[44:47]
    ds_read_b128 a[240:243], v1 offset:32768
    v_mul_f32 v86, v84, v86
    v_mfma_f32_16x16x32_bf16 v[48:51], a[72:75], v[184:187], 0
    ds_read_b128 a[244:247], v1 offset:33792
    ds_read_b128 a[248:251], v1 offset:34816
    v_mfma_f32_16x16x32_bf16 v[48:51], a[76:79], v[188:191], v[48:51]
    ds_read_b128 a[252:255], v1 offset:35840
    v_mul_f32 v87, v85, v87
    v_mfma_f32_16x16x32_bf16 v[48:51], a[80:83], v[192:195], v[48:51]
    buffer_load_dwordx4 a[160:163], v3, s[4:7], s30 offen sc1
    v_mfma_f32_16x16x32_bf16 v[48:51], a[84:87], v[196:199], v[48:51]
    v_exp_f32 v242, v242
    v_mfma_f32_16x16x32_bf16 v[48:51], a[88:91], v[200:203], v[48:51]
    s_add_u32 s30, s24, 389120
    v_exp_f32 v243, v243
    v_mfma_f32_16x16x32_bf16 v[48:51], a[92:95], v[204:207], v[48:51]
    v_add_f32 v242, 1.0, v242
    v_add_f32 v243, 1.0, v243
    v_mfma_f32_16x16x32_bf16 v[48:51], a[96:99], v[208:211], v[48:51]
    buffer_load_dwordx4 a[164:167], v3, s[4:7], s30 offen sc1
    v_mfma_f32_16x16x32_bf16 v[48:51], a[100:103], v[212:215], v[48:51]
    v_rcp_f32 v242, v242
    v_mfma_f32_16x16x32_bf16 v[48:51], a[104:107], v[216:219], v[48:51]
    s_waitcnt lgkmcnt(3)
    v_rcp_f32 v243, v243
    v_mfma_f32_16x16x32_bf16 v[52:55], a[0:3], v[220:223], 0
    s_add_u32 s30, s24, 393216
    v_mul_f32 v242, v86, v242
    v_mul_f32 v243, v87, v243
    v_mfma_f32_16x16x32_bf16 v[52:55], a[4:7], v[224:227], v[52:55]
    v_cvt_pk_bf16_f32 v134, v242, v243
    v_mul_f32 v88, v88, v250
    v_mfma_f32_16x16x32_bf16 v[52:55], a[8:11], v[228:231], v[52:55]
    buffer_load_dwordx4 a[168:171], v3, s[4:7], s30 offen sc1
    v_mfma_f32_16x16x32_bf16 v[52:55], a[12:15], a[232:235], v[52:55]
    v_mul_f32 v89, v89, v250
    v_fma_f32 v232, -v88, v88, s29
    v_mfma_f32_16x16x32_bf16 v[52:55], a[16:19], a[236:239], v[52:55]
    buffer_store_dwordx4 v[144:147], v3, s[4:7], s96 offen sc1
    v_mfma_f32_16x16x32_bf16 v[52:55], a[20:23], a[240:243], v[52:55]
    s_waitcnt lgkmcnt(0)
    v_fma_f32 v233, -v89, v89, s29
    v_mul_f32 v232, v232, v88
    v_mfma_f32_16x16x32_bf16 v[52:55], a[24:27], a[244:247], v[52:55]
    s_add_u32 s30, s24, 397312
    v_mul_f32 v233, v233, v89
    v_mul_f32 v90, v88, v90
    v_mfma_f32_16x16x32_bf16 v[52:55], a[28:31], a[248:251], v[52:55]
    v_exp_f32 v232, v232
    v_mfma_f32_16x16x32_bf16 v[52:55], a[32:35], a[252:255], v[52:55]
    buffer_load_dwordx4 a[172:175], v3, s[4:7], s30 offen sc1
    v_mfma_f32_16x16x32_bf16 v[56:59], a[36:39], v[220:223], 0
    ds_read_b128 v[184:187], v1 offset:36864
    ds_read_b128 v[188:191], v1 offset:37888
    v_mfma_f32_16x16x32_bf16 v[56:59], a[40:43], v[224:227], v[56:59]
    ds_read_b128 v[192:195], v1 offset:38912
    v_mul_f32 v91, v89, v91
    v_mfma_f32_16x16x32_bf16 v[56:59], a[44:47], v[228:231], v[56:59]
    s_add_u32 s30, s24, 401408
    v_exp_f32 v233, v233
    v_mfma_f32_16x16x32_bf16 v[56:59], a[48:51], a[232:235], v[56:59]
    v_add_f32 v232, 1.0, v232
    v_add_f32 v233, 1.0, v233
    v_mfma_f32_16x16x32_bf16 v[56:59], a[52:55], a[236:239], v[56:59]
    buffer_load_dwordx4 a[176:179], v3, s[4:7], s30 offen sc1
    v_mfma_f32_16x16x32_bf16 v[56:59], a[56:59], a[240:243], v[56:59]
    v_rcp_f32 v232, v232
    v_mfma_f32_16x16x32_bf16 v[56:59], a[60:63], a[244:247], v[56:59]
    v_rcp_f32 v233, v233
    v_mfma_f32_16x16x32_bf16 v[56:59], a[64:67], a[248:251], v[56:59]
    ds_read_b128 v[196:199], v1 offset:39936
    ds_read_b128 v[200:203], v1 offset:40960
    v_mfma_f32_16x16x32_bf16 v[56:59], a[68:71], a[252:255], v[56:59]
    s_add_u32 s30, s24, 405504
    ds_read_b128 v[204:207], v1 offset:41984
    v_mul_f32 v232, v90, v232
    v_mfma_f32_16x16x32_bf16 v[60:63], a[72:75], v[220:223], 0
    s_add_u32 s96, s96, s97
    ds_read_b128 v[208:211], v1 offset:43008
    ds_read_b128 v[212:215], v1 offset:44032
    v_mfma_f32_16x16x32_bf16 v[60:63], a[76:79], v[224:227], v[60:63]
    ds_read_b128 v[216:219], v1 offset:45056
    v_mul_f32 v233, v91, v233
    v_mfma_f32_16x16x32_bf16 v[60:63], a[80:83], v[228:231], v[60:63]
    buffer_load_dwordx4 a[180:183], v3, s[4:7], s30 offen sc1
    v_mfma_f32_16x16x32_bf16 v[60:63], a[84:87], a[232:235], v[60:63]
    v_cvt_pk_bf16_f32 v136, v232, v233
    v_mul_f32 v92, v92, v250
    v_mfma_f32_16x16x32_bf16 v[60:63], a[88:91], a[236:239], v[60:63]
    s_add_u32 s30, s24, 409600
    v_mul_f32 v93, v93, v250
    v_fma_f32 v234, -v92, v92, s29
    v_mfma_f32_16x16x32_bf16 v[60:63], a[92:95], a[240:243], v[60:63]
ffn0_part_pad0_4x:
    s_cbranch_execz ffn0_part_pad0_8x
    v_fma_f32 v235, -v93, v93, s29
    v_mul_f32 v234, v234, v92
    v_mfma_f32_16x16x32_bf16 v[60:63], a[96:99], a[244:247], v[60:63]
    buffer_load_dwordx4 a[184:187], v3, s[4:7], s30 offen sc1
    v_mfma_f32_16x16x32_bf16 v[60:63], a[100:103], a[248:251], v[60:63]
    v_mul_f32 v235, v235, v93
    v_mul_f32 v94, v92, v94
    v_mfma_f32_16x16x32_bf16 v[60:63], a[104:107], a[252:255], v[60:63]
    s_waitcnt lgkmcnt(3)
    v_exp_f32 v234, v234
    v_mfma_f32_16x16x32_bf16 v[64:67], a[0:3], v[184:187], 0
    v_exp_f32 v235, v235
    v_mfma_f32_16x16x32_bf16 v[64:67], a[4:7], v[188:191], v[64:67]
    s_add_u32 s30, s24, 413696
    v_mul_f32 v95, v93, v95
    v_add_f32 v234, 1.0, v234
    v_mfma_f32_16x16x32_bf16 v[64:67], a[8:11], v[192:195], v[64:67]
    v_add_f32 v235, 1.0, v235
    v_mul_f32 v96, v96, v250
    v_mfma_f32_16x16x32_bf16 v[64:67], a[12:15], v[196:199], v[64:67]
    buffer_load_dwordx4 a[188:191], v3, s[4:7], s30 offen sc1
    v_mfma_f32_16x16x32_bf16 v[64:67], a[16:19], v[200:203], v[64:67]
    v_rcp_f32 v234, v234
    v_mfma_f32_16x16x32_bf16 v[64:67], a[20:23], v[204:207], v[64:67]
    s_waitcnt lgkmcnt(0)
    v_rcp_f32 v235, v235
    v_mfma_f32_16x16x32_bf16 v[64:67], a[24:27], v[208:211], v[64:67]
    s_add_u32 s30, s24, 417792
    v_mul_f32 v234, v94, v234
    v_mul_f32 v235, v95, v235
    v_mfma_f32_16x16x32_bf16 v[64:67], a[28:31], v[212:215], v[64:67]
    v_cvt_pk_bf16_f32 v137, v234, v235
    v_mul_f32 v97, v97, v250
    v_mfma_f32_16x16x32_bf16 v[64:67], a[32:35], v[216:219], v[64:67]
    buffer_load_dwordx4 a[192:195], v3, s[4:7], s30 offen sc1
    v_mfma_f32_16x16x32_bf16 v[68:71], a[36:39], v[184:187], 0
    ds_read_b128 v[220:223], v1 offset:46080
    ds_read_b128 v[224:227], v1 offset:47104
    v_mfma_f32_16x16x32_bf16 v[68:71], a[40:43], v[188:191], v[68:71]
    s_mov_b32 s16, s22
    ds_read_b128 v[228:231], v1 offset:48128
    v_fma_f32 v236, -v96, v96, s29
    v_mfma_f32_16x16x32_bf16 v[68:71], a[44:47], v[192:195], v[68:71]
    s_and_b32 s17, s21, 1
    v_fma_f32 v237, -v97, v97, s29
    v_mul_f32 v236, v236, v96
    v_mfma_f32_16x16x32_bf16 v[68:71], a[48:51], v[196:199], v[68:71]
    s_add_u32 s30, s24, 421888
    v_mul_f32 v237, v237, v97
    v_mul_f32 v98, v96, v98
    v_mfma_f32_16x16x32_bf16 v[68:71], a[52:55], v[200:203], v[68:71]
    s_lshl_b32 s17, s17, 3
    v_exp_f32 v236, v236
    v_mfma_f32_16x16x32_bf16 v[68:71], a[56:59], v[204:207], v[68:71]
    buffer_load_dwordx4 a[196:199], v3, s[4:7], s30 offen sc1
    v_mfma_f32_16x16x32_bf16 v[68:71], a[60:63], v[208:211], v[68:71]
    s_lshr_b32 s18, s21, 1
    v_exp_f32 v237, v237
    v_mfma_f32_16x16x32_bf16 v[68:71], a[64:67], v[212:215], v[68:71]
    s_add_u32 s17, s17, s18
    ds_read_b128 a[232:235], v1 offset:49152
    ds_read_b128 a[236:239], v1 offset:50176
    v_mfma_f32_16x16x32_bf16 v[68:71], a[68:71], v[216:219], v[68:71]
    s_add_u32 s30, s24, 425984
    ds_read_b128 a[240:243], v1 offset:51200
    v_mul_f32 v99, v97, v99
    v_mfma_f32_16x16x32_bf16 v[72:75], a[72:75], v[184:187], 0
    s_bfe_u32 s18, s21, 0x20002
    ds_read_b128 a[244:247], v1 offset:52224
    ds_read_b128 a[248:251], v1 offset:53248
    v_mfma_f32_16x16x32_bf16 v[72:75], a[76:79], v[188:191], v[72:75]
    s_lshl_b32 s18, s18, 1
    ds_read_b128 a[252:255], v1 offset:54272
    v_add_f32 v236, 1.0, v236
    v_mfma_f32_16x16x32_bf16 v[72:75], a[80:83], v[192:195], v[72:75]
    buffer_load_dwordx4 a[200:203], v3, s[4:7], s30 offen sc1
    v_mfma_f32_16x16x32_bf16 v[72:75], a[84:87], v[196:199], v[72:75]
    s_and_b32 s28, s21, 1
    v_and_b32 v254, 7, v0
    v_add_f32 v237, 1.0, v237
    v_mfma_f32_16x16x32_bf16 v[72:75], a[88:91], v[200:203], v[72:75]
    s_add_u32 s18, s18, s28
    v_bfe_u32 v10, v0, 3, 3
    v_mul_f32 v100, v100, v251
    v_mfma_f32_16x16x32_bf16 v[72:75], a[92:95], v[204:207], v[72:75]
    s_add_u32 s30, s24, 430080
    v_lshlrev_b32 v254, 4, v254
    v_mul_f32 v101, v101, v251
    v_mfma_f32_16x16x32_bf16 v[72:75], a[96:99], v[208:211], v[72:75]
    s_mul_i32 s18, s18, 18432
    v_lshl_add_u32 v254, v10, 8, v254
    v_fma_f32 v238, -v100, v100, s29
    v_mfma_f32_16x16x32_bf16 v[72:75], a[100:103], v[212:215], v[72:75]
    buffer_load_dwordx4 a[204:207], v3, s[4:7], s30 offen sc1
    v_mfma_f32_16x16x32_bf16 v[72:75], a[104:107], v[216:219], v[72:75]
    s_waitcnt lgkmcnt(3)
    v_bfe_u32 v10, v0, 4, 2
    v_fma_f32 v239, -v101, v101, s29
    v_mfma_f32_16x16x32_bf16 v[76:79], a[0:3], v[220:223], 0
    s_add_u32 s18, s18, s25
    v_lshl_add_u32 v10, v10, 28, v254
    v_mul_f32 v238, v238, v100
    v_mfma_f32_16x16x32_bf16 v[76:79], a[4:7], v[224:227], v[76:79]
    s_add_u32 s30, s24, 434176
    v_add_u32 v10, 4096, v10
    v_mul_f32 v239, v239, v101
    v_mfma_f32_16x16x32_bf16 v[76:79], a[8:11], v[228:231], v[76:79]
    s_bfe_u32 s28, s21, 0x10001
    v_rcp_f32 v236, v236
    v_mfma_f32_16x16x32_bf16 v[76:79], a[12:15], a[232:235], v[76:79]
    buffer_load_dwordx4 a[208:211], v3, s[4:7], s30 offen sc1
    v_mfma_f32_16x16x32_bf16 v[76:79], a[16:19], a[236:239], v[76:79]
    s_lshl_b32 s28, s28, 7
    v_rcp_f32 v237, v237
    v_mfma_f32_16x16x32_bf16 v[76:79], a[20:23], a[240:243], v[76:79]
    s_waitcnt lgkmcnt(0)
    v_mul_f32 v236, v98, v236
    v_mul_f32 v237, v99, v237
    v_mfma_f32_16x16x32_bf16 v[76:79], a[24:27], a[244:247], v[76:79]
    s_add_u32 s18, s18, s28
    v_cvt_pk_bf16_f32 v138, v236, v237
    v_mul_f32 v102, v100, v102
    v_mfma_f32_16x16x32_bf16 v[76:79], a[28:31], a[248:251], v[76:79]
    s_add_u32 s30, s24, 438272
    v_exp_f32 v238, v238
    v_mfma_f32_16x16x32_bf16 v[76:79], a[32:35], a[252:255], v[76:79]
    s_mul_i32 s28, s20, 4608
    v_exp_f32 v239, v239
    v_mfma_f32_16x16x32_bf16 v[80:83], a[36:39], v[220:223], 0
    s_add_u32 s18, s18, s28
    ds_read_b128 v[184:187], v1 offset:55296
    ds_read_b128 v[188:191], v1 offset:56320
    v_mfma_f32_16x16x32_bf16 v[80:83], a[40:43], v[224:227], v[80:83]
    s_mul_i32 s28, s20, 3072
    ds_read_b128 v[192:195], v1 offset:57344
    v_mul_f32 v103, v101, v103
    v_mfma_f32_16x16x32_bf16 v[80:83], a[44:47], v[228:231], v[80:83]
    buffer_load_dwordx4 a[212:215], v3, s[4:7], s30 offen sc1
    v_mfma_f32_16x16x32_bf16 v[80:83], a[48:51], a[232:235], v[80:83]
    v_add_f32 v238, 1.0, v238
    v_add_f32 v239, 1.0, v239
    v_mfma_f32_16x16x32_bf16 v[80:83], a[52:55], a[236:239], v[80:83]
    buffer_store_dwordx4 v[148:151], v3, s[4:7], s96 offen sc1
    v_mfma_f32_16x16x32_bf16 v[80:83], a[56:59], a[240:243], v[80:83]
    v_rcp_f32 v238, v238
    v_mfma_f32_16x16x32_bf16 v[80:83], a[60:63], a[244:247], v[80:83]
    v_rcp_f32 v239, v239
    v_mfma_f32_16x16x32_bf16 v[80:83], a[64:67], a[248:251], v[80:83]
    ds_read_b128 v[196:199], v1 offset:58368
    ds_read_b128 v[200:203], v1 offset:59392
    v_mfma_f32_16x16x32_bf16 v[80:83], a[68:71], a[252:255], v[80:83]
    ds_read_b128 v[204:207], v1 offset:60416
    v_mul_f32 v238, v102, v238
    v_mfma_f32_16x16x32_bf16 v[84:87], a[72:75], v[220:223], 0
    ds_read_b128 v[208:211], v1 offset:61440
    ds_read_b128 v[212:215], v1 offset:62464
    v_mfma_f32_16x16x32_bf16 v[84:87], a[76:79], v[224:227], v[84:87]
    ds_read_b128 v[216:219], v1 offset:63488
    v_mul_f32 v239, v103, v239
    v_mfma_f32_16x16x32_bf16 v[84:87], a[80:83], v[228:231], v[84:87]
    v_cvt_pk_bf16_f32 v140, v238, v239
    v_mul_f32 v104, v104, v251
    v_mfma_f32_16x16x32_bf16 v[84:87], a[84:87], a[232:235], v[84:87]
    v_mul_f32 v105, v105, v251
    v_fma_f32 v240, -v104, v104, s29
    v_mfma_f32_16x16x32_bf16 v[84:87], a[88:91], a[236:239], v[84:87]
    v_fma_f32 v241, -v105, v105, s29
    v_mul_f32 v240, v240, v104
    v_mfma_f32_16x16x32_bf16 v[84:87], a[92:95], a[240:243], v[84:87]
    s_add_u32 m0, s28, 147456
    v_mul_f32 v241, v241, v105
    v_mul_f32 v106, v104, v106
    v_mfma_f32_16x16x32_bf16 v[84:87], a[96:99], a[244:247], v[84:87]
    buffer_load_dwordx4 v254, s[4:7], s18 offen offset:0 sc1 lds
    v_mfma_f32_16x16x32_bf16 v[84:87], a[100:103], a[248:251], v[84:87]
    s_add_u32 m0, s28, 146432
    v_exp_f32 v240, v240
    v_mfma_f32_16x16x32_bf16 v[84:87], a[104:107], a[252:255], v[84:87]
    s_waitcnt lgkmcnt(3)
    v_exp_f32 v241, v241
    v_mfma_f32_16x16x32_bf16 v[88:91], a[0:3], v[184:187], 0
    buffer_load_dwordx4 v254, s[4:7], s18 offen offset:2048 sc1 lds
    v_mfma_f32_16x16x32_bf16 v[88:91], a[4:7], v[188:191], v[88:91]
    s_add_u32 m0, s28, 149504
    v_mul_f32 v107, v105, v107
    v_add_f32 v240, 1.0, v240
    v_mfma_f32_16x16x32_bf16 v[88:91], a[8:11], v[192:195], v[88:91]
    buffer_load_dwordx4 v10, s[4:7], s18 offen offset:0 sc1 lds
    v_mfma_f32_16x16x32_bf16 v[88:91], a[12:15], v[196:199], v[88:91]
    s_add_u32 s96, s96, s97
    v_add_f32 v241, 1.0, v241
    v_mul_f32 v108, v108, v251
    v_mfma_f32_16x16x32_bf16 v[88:91], a[16:19], v[200:203], v[88:91]
    buffer_store_dwordx4 v[152:155], v3, s[4:7], s96 offen sc1
    v_mfma_f32_16x16x32_bf16 v[88:91], a[20:23], v[204:207], v[88:91]
    s_waitcnt lgkmcnt(0)
    v_rcp_f32 v240, v240
    v_mfma_f32_16x16x32_bf16 v[88:91], a[24:27], v[208:211], v[88:91]
    v_rcp_f32 v241, v241
    v_mfma_f32_16x16x32_bf16 v[88:91], a[28:31], v[212:215], v[88:91]
    v_mul_f32 v240, v106, v240
    v_mul_f32 v241, v107, v241
    v_mfma_f32_16x16x32_bf16 v[88:91], a[32:35], v[216:219], v[88:91]
    v_cvt_pk_bf16_f32 v141, v240, v241
    v_mul_f32 v109, v109, v251
    v_mfma_f32_16x16x32_bf16 v[92:95], a[36:39], v[184:187], 0
    ds_read_b128 v[220:223], v1 offset:64512
    ds_read_b128 v[224:227], v4 offset:0
    v_mfma_f32_16x16x32_bf16 v[92:95], a[40:43], v[188:191], v[92:95]
    ds_read_b128 v[228:231], v4 offset:1024
    v_fma_f32 v242, -v108, v108, s29
    v_mfma_f32_16x16x32_bf16 v[92:95], a[44:47], v[192:195], v[92:95]
    v_fma_f32 v243, -v109, v109, s29
    v_mul_f32 v242, v242, v108
    v_mfma_f32_16x16x32_bf16 v[92:95], a[48:51], v[196:199], v[92:95]
    v_mul_f32 v243, v243, v109
    v_mul_f32 v110, v108, v110
    v_mfma_f32_16x16x32_bf16 v[92:95], a[52:55], v[200:203], v[92:95]
    v_exp_f32 v242, v242
    v_mfma_f32_16x16x32_bf16 v[92:95], a[56:59], v[204:207], v[92:95]
    v_exp_f32 v243, v243
    v_mfma_f32_16x16x32_bf16 v[92:95], a[60:63], v[208:211], v[92:95]
    v_mul_f32 v111, v109, v111
    v_add_f32 v242, 1.0, v242
    v_mfma_f32_16x16x32_bf16 v[92:95], a[64:67], v[212:215], v[92:95]
    s_and_b32 s35, s2, 1
    ds_read_b128 a[232:235], v4 offset:2048
    ds_read_b128 a[236:239], v4 offset:3072
    v_mfma_f32_16x16x32_bf16 v[92:95], a[68:71], v[216:219], v[92:95]
    s_lshl_b32 s35, s35, 5
    ds_read_b128 a[240:243], v4 offset:4096
    v_add_f32 v243, 1.0, v243
    v_mfma_f32_16x16x32_bf16 v[96:99], a[72:75], v[184:187], 0
    s_lshr_b32 s27, s2, 3
    ds_read_b128 a[244:247], v4 offset:5120
    ds_read_b128 a[248:251], v4 offset:6144
    v_mfma_f32_16x16x32_bf16 v[96:99], a[76:79], v[188:191], v[96:99]
    s_add_u32 s35, s35, s27
    ds_read_b128 a[252:255], v4 offset:7168
    v_mfma_f32_16x16x32_bf16 v[96:99], a[80:83], v[192:195], v[96:99]
    s_mul_i32 s35, s35, 32256
    v_rcp_f32 v242, v242
    v_mfma_f32_16x16x32_bf16 v[96:99], a[84:87], v[196:199], v[96:99]
    s_add_u32 s35, s35, 16777216
    v_rcp_f32 v243, v243
    v_mfma_f32_16x16x32_bf16 v[96:99], a[88:91], v[200:203], v[96:99]
    s_add_u32 s96, s96, s97
    v_mul_f32 v242, v110, v242
    v_mul_f32 v243, v111, v243
    v_mfma_f32_16x16x32_bf16 v[96:99], a[92:95], v[204:207], v[96:99]
    buffer_store_dwordx4 v[156:159], v3, s[4:7], s96 offen sc1
    v_mfma_f32_16x16x32_bf16 v[96:99], a[96:99], v[208:211], v[96:99]
    v_cvt_pk_bf16_f32 v142, v242, v243
    v_mfma_f32_16x16x32_bf16 v[96:99], a[100:103], v[212:215], v[96:99]
    v_mfma_f32_16x16x32_bf16 v[96:99], a[104:107], v[216:219], v[96:99]
    s_waitcnt lgkmcnt(3)
    v_mfma_f32_16x16x32_bf16 v[100:103], a[0:3], v[220:223], 0
    v_mfma_f32_16x16x32_bf16 v[100:103], a[4:7], v[224:227], v[100:103]
    v_mfma_f32_16x16x32_bf16 v[100:103], a[8:11], v[228:231], v[100:103]
    v_mfma_f32_16x16x32_bf16 v[100:103], a[12:15], a[232:235], v[100:103]
    v_mfma_f32_16x16x32_bf16 v[100:103], a[16:19], a[236:239], v[100:103]
    v_mfma_f32_16x16x32_bf16 v[100:103], a[20:23], a[240:243], v[100:103]
    s_waitcnt lgkmcnt(0)
    v_mfma_f32_16x16x32_bf16 v[100:103], a[24:27], a[244:247], v[100:103]
    v_mfma_f32_16x16x32_bf16 v[100:103], a[28:31], a[248:251], v[100:103]
    v_lshrrev_b32 v2, 3, v0
    v_mfma_f32_16x16x32_bf16 v[100:103], a[32:35], a[252:255], v[100:103]
    v_lshlrev_b32 v2, 7, v2
    v_mfma_f32_16x16x32_bf16 v[104:107], a[36:39], v[220:223], 0
    ds_read_b128 v[184:187], v4 offset:8192
    ds_read_b128 v[188:191], v4 offset:9216
    v_mfma_f32_16x16x32_bf16 v[104:107], a[40:43], v[224:227], v[104:107]
    s_add_u32 s96, s96, s97
    ds_read_b128 v[192:195], v4 offset:10240
    v_mfma_f32_16x16x32_bf16 v[104:107], a[44:47], v[228:231], v[104:107]
    buffer_store_dwordx4 v[160:163], v3, s[4:7], s96 offen sc1
    v_mfma_f32_16x16x32_bf16 v[104:107], a[48:51], a[232:235], v[104:107]
    v_mfma_f32_16x16x32_bf16 v[104:107], a[52:55], a[236:239], v[104:107]
    v_mfma_f32_16x16x32_bf16 v[104:107], a[56:59], a[240:243], v[104:107]
    v_mfma_f32_16x16x32_bf16 v[104:107], a[60:63], a[244:247], v[104:107]
    v_mfma_f32_16x16x32_bf16 v[104:107], a[64:67], a[248:251], v[104:107]
    ds_read_b128 v[196:199], v4 offset:11264
    ds_read_b128 v[200:203], v4 offset:12288
    v_mfma_f32_16x16x32_bf16 v[104:107], a[68:71], a[252:255], v[104:107]
    ds_read_b128 v[204:207], v4 offset:13312
    v_mfma_f32_16x16x32_bf16 v[108:111], a[72:75], v[220:223], 0
    ds_read_b128 v[208:211], v4 offset:14336
    ds_read_b128 v[212:215], v4 offset:15360
    v_mfma_f32_16x16x32_bf16 v[108:111], a[76:79], v[224:227], v[108:111]
    ds_read_b128 v[216:219], v4 offset:16384
    v_mfma_f32_16x16x32_bf16 v[108:111], a[80:83], v[228:231], v[108:111]
    buffer_load_dword v255, v2, s[4:7], s35 offen sc1
    v_mfma_f32_16x16x32_bf16 v[108:111], a[84:87], a[232:235], v[108:111]
    v_mfma_f32_16x16x32_bf16 v[108:111], a[88:91], a[236:239], v[108:111]
    v_mfma_f32_16x16x32_bf16 v[108:111], a[92:95], a[240:243], v[108:111]
    v_mfma_f32_16x16x32_bf16 v[108:111], a[96:99], a[244:247], v[108:111]
    v_mfma_f32_16x16x32_bf16 v[108:111], a[100:103], a[248:251], v[108:111]
    s_add_u32 s30, s24, 442368
    v_mfma_f32_16x16x32_bf16 v[108:111], a[104:107], a[252:255], v[108:111]
    s_waitcnt vmcnt(28) lgkmcnt(3)
    v_mfma_f32_16x16x32_bf16 v[16:19], a[108:111], v[184:187], v[16:19]
    buffer_load_dwordx4 a[0:3], v3, s[4:7], s30 offen sc1
    v_mfma_f32_16x16x32_bf16 v[16:19], a[112:115], v[188:191], v[16:19]
    v_mfma_f32_16x16x32_bf16 v[16:19], a[116:119], v[192:195], v[16:19]
    s_add_u32 s30, s24, 446464
    v_mfma_f32_16x16x32_bf16 v[16:19], a[120:123], v[196:199], v[16:19]
    v_mfma_f32_16x16x32_bf16 v[16:19], a[124:127], v[200:203], v[16:19]
    buffer_load_dwordx4 a[4:7], v3, s[4:7], s30 offen sc1
    v_mfma_f32_16x16x32_bf16 v[16:19], a[128:131], v[204:207], v[16:19]
    s_waitcnt lgkmcnt(0)
    v_mfma_f32_16x16x32_bf16 v[16:19], a[132:135], v[208:211], v[16:19]
    buffer_store_dwordx4 v[164:167], v3, s[4:7], s98 offen sc1
    v_mfma_f32_16x16x32_bf16 v[16:19], a[136:139], v[212:215], v[16:19]
    s_add_u32 s30, s24, 450560
    v_mfma_f32_16x16x32_bf16 v[16:19], a[140:143], v[216:219], v[16:19]
    s_waitcnt vmcnt(20)
    v_mfma_f32_16x16x32_bf16 v[20:23], a[144:147], v[184:187], v[20:23]
    ds_read_b128 v[220:223], v4 offset:17408
    ds_read_b128 v[224:227], v4 offset:18432
    v_mfma_f32_16x16x32_bf16 v[20:23], a[148:151], v[188:191], v[20:23]
    ds_read_b128 v[228:231], v4 offset:19456
    v_mfma_f32_16x16x32_bf16 v[20:23], a[152:155], v[192:195], v[20:23]
    buffer_load_dwordx4 a[8:11], v3, s[4:7], s30 offen sc1
    v_mfma_f32_16x16x32_bf16 v[20:23], a[156:159], v[196:199], v[20:23]
    v_mul_f32 v16, v16, v244
    v_mul_f32 v17, v17, v244
    v_mfma_f32_16x16x32_bf16 v[20:23], a[160:163], v[200:203], v[20:23]
    s_add_u32 s30, s24, 454656
    v_fma_f32 v232, -v16, v16, s29
    v_fma_f32 v233, -v17, v17, s29
    v_mfma_f32_16x16x32_bf16 v[20:23], a[164:167], v[204:207], v[20:23]
    v_mul_f32 v232, v232, v16
    v_mul_f32 v233, v233, v17
    v_mfma_f32_16x16x32_bf16 v[20:23], a[168:171], v[208:211], v[20:23]
    buffer_load_dwordx4 a[12:15], v3, s[4:7], s30 offen sc1
    v_mfma_f32_16x16x32_bf16 v[20:23], a[172:175], v[212:215], v[20:23]
    ds_read_b128 a[232:235], v4 offset:20480
    ds_read_b128 a[236:239], v4 offset:21504
    v_mfma_f32_16x16x32_bf16 v[20:23], a[176:179], v[216:219], v[20:23]
    s_waitcnt vmcnt(13)
    ds_read_b128 a[240:243], v4 offset:22528
    v_mul_f32 v18, v16, v18
    v_mfma_f32_16x16x32_bf16 v[24:27], a[180:183], v[184:187], v[24:27]
    s_add_u32 s30, s24, 458752
    ds_read_b128 a[244:247], v4 offset:23552
    ds_read_b128 a[248:251], v4 offset:24576
    v_mfma_f32_16x16x32_bf16 v[24:27], a[184:187], v[188:191], v[24:27]
    ds_read_b128 a[252:255], v4 offset:25600
    v_mul_f32 v19, v17, v19
    v_mfma_f32_16x16x32_bf16 v[24:27], a[188:191], v[192:195], v[24:27]
    buffer_load_dwordx4 a[16:19], v3, s[4:7], s30 offen sc1
    v_mfma_f32_16x16x32_bf16 v[24:27], a[192:195], v[196:199], v[24:27]
    s_add_u32 s98, s98, s99
    v_exp_f32 v232, v232
    v_mfma_f32_16x16x32_bf16 v[24:27], a[196:199], v[200:203], v[24:27]
    v_exp_f32 v233, v233
    v_mfma_f32_16x16x32_bf16 v[24:27], a[200:203], v[204:207], v[24:27]
    s_add_u32 s35, s35, 4096
    v_add_f32 v232, 1.0, v232
    v_add_f32 v233, 1.0, v233
    v_mfma_f32_16x16x32_bf16 v[24:27], a[204:207], v[208:211], v[24:27]
    s_add_u32 s30, s24, 462848
    v_rcp_f32 v232, v232
    v_mfma_f32_16x16x32_bf16 v[24:27], a[208:211], v[212:215], v[24:27]
    buffer_load_dword v255, v2, s[4:7], s35 offen sc1
    v_mfma_f32_16x16x32_bf16 v[24:27], a[212:215], v[216:219], v[24:27]
    s_waitcnt lgkmcnt(3)
    v_rcp_f32 v233, v233
    v_mfma_f32_16x16x32_bf16 v[28:31], a[108:111], v[220:223], v[28:31]
    buffer_load_dwordx4 a[20:23], v3, s[4:7], s30 offen sc1
    v_mfma_f32_16x16x32_bf16 v[28:31], a[112:115], v[224:227], v[28:31]
    v_mul_f32 v232, v18, v232
    v_mul_f32 v233, v19, v233
    v_mfma_f32_16x16x32_bf16 v[28:31], a[116:119], v[228:231], v[28:31]
    s_add_u32 s30, s24, 466944
    v_cvt_pk_bf16_f32 v115, v232, v233
    v_mul_f32 v20, v20, v244
    v_mfma_f32_16x16x32_bf16 v[28:31], a[120:123], a[232:235], v[28:31]
    v_mul_f32 v21, v21, v244
    v_fma_f32 v234, -v20, v20, s29
    v_mfma_f32_16x16x32_bf16 v[28:31], a[124:127], a[236:239], v[28:31]
    buffer_load_dwordx4 a[24:27], v3, s[4:7], s30 offen sc1
    v_mfma_f32_16x16x32_bf16 v[28:31], a[128:131], a[240:243], v[28:31]
    s_waitcnt lgkmcnt(0)
    v_fma_f32 v235, -v21, v21, s29
    v_mul_f32 v234, v234, v20
    v_mfma_f32_16x16x32_bf16 v[28:31], a[132:135], a[244:247], v[28:31]
    buffer_store_dwordx4 v[168:171], v3, s[4:7], s98 offen sc1
    v_mfma_f32_16x16x32_bf16 v[28:31], a[136:139], a[248:251], v[28:31]
    v_mul_f32 v235, v235, v21
    v_mul_f32 v22, v20, v22
    v_mfma_f32_16x16x32_bf16 v[28:31], a[140:143], a[252:255], v[28:31]
    s_add_u32 s30, s24, 471040
    v_exp_f32 v234, v234
    v_mfma_f32_16x16x32_bf16 v[32:35], a[144:147], v[220:223], v[32:35]
    ds_read_b128 v[184:187], v4 offset:26624
    ds_read_b128 v[188:191], v4 offset:27648
    v_mfma_f32_16x16x32_bf16 v[32:35], a[148:151], v[224:227], v[32:35]
    ds_read_b128 v[192:195], v4 offset:28672
    v_mul_f32 v23, v21, v23
    v_mfma_f32_16x16x32_bf16 v[32:35], a[152:155], v[228:231], v[32:35]
    buffer_load_dwordx4 a[28:31], v3, s[4:7], s30 offen sc1
    v_mfma_f32_16x16x32_bf16 v[32:35], a[156:159], a[232:235], v[32:35]
    v_exp_f32 v235, v235
    v_mfma_f32_16x16x32_bf16 v[32:35], a[160:163], a[236:239], v[32:35]
    s_add_u32 s30, s24, 475136
    v_add_f32 v234, 1.0, v234
    v_add_f32 v235, 1.0, v235
    v_mfma_f32_16x16x32_bf16 v[32:35], a[164:167], a[240:243], v[32:35]
    v_rcp_f32 v234, v234
    v_mfma_f32_16x16x32_bf16 v[32:35], a[168:171], a[244:247], v[32:35]
    buffer_load_dwordx4 a[32:35], v3, s[4:7], s30 offen sc1
    v_mfma_f32_16x16x32_bf16 v[32:35], a[172:175], a[248:251], v[32:35]
    ds_read_b128 v[196:199], v4 offset:29696
    ds_read_b128 v[200:203], v4 offset:30720
    v_mfma_f32_16x16x32_bf16 v[32:35], a[176:179], a[252:255], v[32:35]
    ds_read_b128 v[204:207], v4 offset:31744
    v_mul_f32 v234, v22, v234
    v_mfma_f32_16x16x32_bf16 v[36:39], a[180:183], v[220:223], v[36:39]
    ds_read_b128 v[208:211], v4 offset:32768
    ds_read_b128 v[212:215], v4 offset:33792
    v_mfma_f32_16x16x32_bf16 v[36:39], a[184:187], v[224:227], v[36:39]
    s_add_u32 s30, s24, 479232
    ds_read_b128 v[216:219], v4 offset:34816
    v_mul_f32 v24, v24, v244
    v_mfma_f32_16x16x32_bf16 v[36:39], a[188:191], v[228:231], v[36:39]
    s_add_u32 s98, s98, s99
    v_rcp_f32 v235, v235
    v_mfma_f32_16x16x32_bf16 v[36:39], a[192:195], a[232:235], v[36:39]
    buffer_load_dwordx4 a[36:39], v3, s[4:7], s30 offen sc1
    v_mfma_f32_16x16x32_bf16 v[36:39], a[196:199], a[236:239], v[36:39]
    v_mul_f32 v235, v23, v235
    v_mul_f32 v25, v25, v244
    v_mfma_f32_16x16x32_bf16 v[36:39], a[200:203], a[240:243], v[36:39]
    buffer_store_dwordx4 v[172:175], v3, s[4:7], s98 offen sc1
    v_mfma_f32_16x16x32_bf16 v[36:39], a[204:207], a[244:247], v[36:39]
    s_add_u32 s30, s24, 483328
    v_fma_f32 v236, -v24, v24, s29
    v_fma_f32 v237, -v25, v25, s29
    v_mfma_f32_16x16x32_bf16 v[36:39], a[208:211], a[248:251], v[36:39]
    v_mul_f32 v236, v236, v24
    v_mul_f32 v237, v237, v25
    v_mfma_f32_16x16x32_bf16 v[36:39], a[212:215], a[252:255], v[36:39]
    s_waitcnt lgkmcnt(3)
    v_exp_f32 v236, v236
    v_mfma_f32_16x16x32_bf16 v[40:43], a[108:111], v[184:187], v[40:43]
    buffer_load_dwordx4 a[40:43], v3, s[4:7], s30 offen sc1
    v_mfma_f32_16x16x32_bf16 v[40:43], a[112:115], v[188:191], v[40:43]
    s_add_u32 s35, s35, 4096
    v_exp_f32 v237, v237
    v_mfma_f32_16x16x32_bf16 v[40:43], a[116:119], v[192:195], v[40:43]
    buffer_load_dword v255, v2, s[4:7], s35 offen sc1
    v_mfma_f32_16x16x32_bf16 v[40:43], a[120:123], v[196:199], v[40:43]
    s_add_u32 s30, s24, 487424
    v_mul_f32 v26, v24, v26
    v_mul_f32 v27, v25, v27
    v_mfma_f32_16x16x32_bf16 v[40:43], a[124:127], v[200:203], v[40:43]
    v_add_f32 v236, 1.0, v236
    v_add_f32 v237, 1.0, v237
    v_mfma_f32_16x16x32_bf16 v[40:43], a[128:131], v[204:207], v[40:43]
    s_waitcnt lgkmcnt(0)
    v_rcp_f32 v236, v236
    v_mfma_f32_16x16x32_bf16 v[40:43], a[132:135], v[208:211], v[40:43]
    buffer_load_dwordx4 a[44:47], v3, s[4:7], s30 offen sc1
    v_mfma_f32_16x16x32_bf16 v[40:43], a[136:139], v[212:215], v[40:43]
    v_rcp_f32 v237, v237
    v_mfma_f32_16x16x32_bf16 v[40:43], a[140:143], v[216:219], v[40:43]
    s_add_u32 s30, s24, 491520
    v_mul_f32 v236, v26, v236
    v_mul_f32 v237, v27, v237
    v_mfma_f32_16x16x32_bf16 v[44:47], a[144:147], v[184:187], v[44:47]
    ds_read_b128 v[220:223], v4 offset:35840
    ds_read_b128 v[224:227], v4 offset:36864
    v_mfma_f32_16x16x32_bf16 v[44:47], a[148:151], v[188:191], v[44:47]
    s_add_u32 s98, s98, s99
    ds_read_b128 v[228:231], v4 offset:37888
    v_cvt_pk_bf16_f32 v144, v236, v237
    v_mfma_f32_16x16x32_bf16 v[44:47], a[152:155], v[192:195], v[44:47]
    buffer_load_dwordx4 a[48:51], v3, s[4:7], s30 offen sc1
    v_mfma_f32_16x16x32_bf16 v[44:47], a[156:159], v[196:199], v[44:47]
    v_mul_f32 v28, v28, v245
    v_mul_f32 v29, v29, v245
    v_mfma_f32_16x16x32_bf16 v[44:47], a[160:163], v[200:203], v[44:47]
    buffer_store_dwordx4 v[176:179], v3, s[4:7], s98 offen sc1
    v_mfma_f32_16x16x32_bf16 v[44:47], a[164:167], v[204:207], v[44:47]
    s_add_u32 s30, s24, 495616
    v_cvt_pk_bf16_f32 v176, v234, v235
    v_fma_f32 v238, -v28, v28, s29
    v_mfma_f32_16x16x32_bf16 v[44:47], a[168:171], v[208:211], v[44:47]
    v_fma_f32 v239, -v29, v29, s29
    v_mul_f32 v238, v238, v28
    v_mfma_f32_16x16x32_bf16 v[44:47], a[172:175], v[212:215], v[44:47]
    ds_read_b128 a[232:235], v4 offset:38912
    ds_read_b128 a[236:239], v4 offset:39936
    v_mfma_f32_16x16x32_bf16 v[44:47], a[176:179], v[216:219], v[44:47]
    ds_read_b128 a[240:243], v4 offset:40960
    v_mul_f32 v239, v239, v29
    v_mfma_f32_16x16x32_bf16 v[48:51], a[180:183], v[184:187], v[48:51]
    ds_read_b128 a[244:247], v4 offset:41984
    ds_read_b128 a[248:251], v4 offset:43008
    v_mfma_f32_16x16x32_bf16 v[48:51], a[184:187], v[188:191], v[48:51]
    ds_read_b128 a[252:255], v4 offset:44032
    v_mul_f32 v30, v28, v30
    v_mfma_f32_16x16x32_bf16 v[48:51], a[188:191], v[192:195], v[48:51]
    v_exp_f32 v238, v238
    v_mfma_f32_16x16x32_bf16 v[48:51], a[192:195], v[196:199], v[48:51]
    v_exp_f32 v239, v239
    v_mfma_f32_16x16x32_bf16 v[48:51], a[196:199], v[200:203], v[48:51]
    v_mul_f32 v31, v29, v31
    v_add_f32 v238, 1.0, v238
    v_mfma_f32_16x16x32_bf16 v[48:51], a[200:203], v[204:207], v[48:51]
    buffer_load_dwordx4 a[52:55], v3, s[4:7], s30 offen sc1
    v_mfma_f32_16x16x32_bf16 v[48:51], a[204:207], v[208:211], v[48:51]
    v_add_f32 v239, 1.0, v239
    v_mul_f32 v32, v32, v245
    v_mfma_f32_16x16x32_bf16 v[48:51], a[208:211], v[212:215], v[48:51]
    s_add_u32 s30, s24, 499712
    v_rcp_f32 v238, v238
    v_mfma_f32_16x16x32_bf16 v[48:51], a[212:215], v[216:219], v[48:51]
    s_waitcnt lgkmcnt(3)
    v_rcp_f32 v239, v239
    v_mfma_f32_16x16x32_bf16 v[52:55], a[108:111], v[220:223], v[52:55]
    buffer_load_dwordx4 a[56:59], v3, s[4:7], s30 offen sc1
    v_mfma_f32_16x16x32_bf16 v[52:55], a[112:115], v[224:227], v[52:55]
    s_add_u32 s98, s98, s99
    v_mul_f32 v238, v30, v238
    v_mul_f32 v239, v31, v239
    v_mfma_f32_16x16x32_bf16 v[52:55], a[116:119], v[228:231], v[52:55]
    buffer_store_dwordx4 v[180:183], v3, s[4:7], s98 offen sc1
    v_mfma_f32_16x16x32_bf16 v[52:55], a[120:123], a[232:235], v[52:55]
    s_add_u32 s30, s24, 503808
    v_cvt_pk_bf16_f32 v119, v238, v239
    v_mul_f32 v33, v33, v245
    v_mfma_f32_16x16x32_bf16 v[52:55], a[124:127], a[236:239], v[52:55]
    v_fma_f32 v240, -v32, v32, s29
    v_fma_f32 v241, -v33, v33, s29
    v_mfma_f32_16x16x32_bf16 v[52:55], a[128:131], a[240:243], v[52:55]
    s_waitcnt lgkmcnt(0)
    v_mul_f32 v240, v240, v32
    v_mul_f32 v241, v241, v33
    v_mfma_f32_16x16x32_bf16 v[52:55], a[132:135], a[244:247], v[52:55]
    buffer_load_dwordx4 a[60:63], v3, s[4:7], s30 offen sc1
    v_mfma_f32_16x16x32_bf16 v[52:55], a[136:139], a[248:251], v[52:55]
    s_add_u32 s35, s35, 4096
    v_exp_f32 v240, v240
    v_mfma_f32_16x16x32_bf16 v[52:55], a[140:143], a[252:255], v[52:55]
    buffer_load_dword v255, v2, s[4:7], s35 offen sc1
    v_mfma_f32_16x16x32_bf16 v[56:59], a[144:147], v[220:223], v[56:59]
    s_add_u32 s30, s24, 507904
    ds_read_b128 v[184:187], v4 offset:45056
    ds_read_b128 v[188:191], v4 offset:46080
    v_mfma_f32_16x16x32_bf16 v[56:59], a[148:151], v[224:227], v[56:59]
    ds_read_b128 v[192:195], v4 offset:47104
    v_mul_f32 v34, v32, v34
    v_mfma_f32_16x16x32_bf16 v[56:59], a[152:155], v[228:231], v[56:59]
    buffer_load_dwordx4 a[64:67], v3, s[4:7], s30 offen sc1
    v_mfma_f32_16x16x32_bf16 v[56:59], a[156:159], a[232:235], v[56:59]
    v_exp_f32 v241, v241
    v_mfma_f32_16x16x32_bf16 v[56:59], a[160:163], a[236:239], v[56:59]
    buffer_store_dwordx4 v[112:115], v3, s[4:7], s52 offen sc1
    v_mfma_f32_16x16x32_bf16 v[56:59], a[164:167], a[240:243], v[56:59]
    s_add_u32 s30, s24, 512000
    v_mul_f32 v35, v33, v35
    v_add_f32 v240, 1.0, v240
    v_mfma_f32_16x16x32_bf16 v[56:59], a[168:171], a[244:247], v[56:59]
    v_add_f32 v241, 1.0, v241
    v_mul_f32 v36, v36, v245
    v_mfma_f32_16x16x32_bf16 v[56:59], a[172:175], a[248:251], v[56:59]
    ds_read_b128 v[196:199], v4 offset:48128
    ds_read_b128 v[200:203], v4 offset:49152
    v_mfma_f32_16x16x32_bf16 v[56:59], a[176:179], a[252:255], v[56:59]
    ds_read_b128 v[204:207], v4 offset:50176
    v_mul_f32 v37, v37, v245
    v_mfma_f32_16x16x32_bf16 v[60:63], a[180:183], v[220:223], v[60:63]
    ds_read_b128 v[208:211], v4 offset:51200
    ds_read_b128 v[212:215], v4 offset:52224
    v_mfma_f32_16x16x32_bf16 v[60:63], a[184:187], v[224:227], v[60:63]
    ds_read_b128 v[216:219], v4 offset:53248
    v_fma_f32 v242, -v36, v36, s29
    v_mfma_f32_16x16x32_bf16 v[60:63], a[188:191], v[228:231], v[60:63]
    buffer_load_dwordx4 a[68:71], v3, s[4:7], s30 offen sc1
    v_mfma_f32_16x16x32_bf16 v[60:63], a[192:195], a[232:235], v[60:63]
    v_rcp_f32 v240, v240
    v_mfma_f32_16x16x32_bf16 v[60:63], a[196:199], a[236:239], v[60:63]
    s_add_u32 s30, s24, 516096
    v_rcp_f32 v241, v241
    v_mfma_f32_16x16x32_bf16 v[60:63], a[200:203], a[240:243], v[60:63]
    v_mul_f32 v240, v34, v240
    v_mul_f32 v241, v35, v241
    v_mfma_f32_16x16x32_bf16 v[60:63], a[204:207], a[244:247], v[60:63]
    buffer_load_dwordx4 a[72:75], v3, s[4:7], s30 offen sc1
    v_mfma_f32_16x16x32_bf16 v[60:63], a[208:211], a[248:251], v[60:63]
    v_cvt_pk_bf16_f32 v177, v240, v241
    v_fma_f32 v243, -v37, v37, s29
    v_mfma_f32_16x16x32_bf16 v[60:63], a[212:215], a[252:255], v[60:63]
    s_waitcnt lgkmcnt(3)
    v_mul_f32 v242, v242, v36
    v_mul_f32 v243, v243, v37
    v_mfma_f32_16x16x32_bf16 v[64:67], a[108:111], v[184:187], v[64:67]
    s_add_u32 s30, s24, 520192
    v_exp_f32 v242, v242
    v_mfma_f32_16x16x32_bf16 v[64:67], a[112:115], v[188:191], v[64:67]
    v_exp_f32 v243, v243
    v_mfma_f32_16x16x32_bf16 v[64:67], a[116:119], v[192:195], v[64:67]
    buffer_load_dwordx4 a[76:79], v3, s[4:7], s30 offen sc1
    v_mfma_f32_16x16x32_bf16 v[64:67], a[120:123], v[196:199], v[64:67]
ffn0_part_pad0_5x:
    s_cbranch_execz ffn0_part_pad0_9x
    v_mul_f32 v38, v36, v38
    v_mul_f32 v39, v37, v39
    v_mfma_f32_16x16x32_bf16 v[64:67], a[124:127], v[200:203], v[64:67]
    v_add_f32 v242, 1.0, v242
    v_add_f32 v243, 1.0, v243
    v_mfma_f32_16x16x32_bf16 v[64:67], a[128:131], v[204:207], v[64:67]
    s_waitcnt lgkmcnt(0)
    v_rcp_f32 v242, v242
    v_mfma_f32_16x16x32_bf16 v[64:67], a[132:135], v[208:211], v[64:67]
    s_add_u32 s30, s24, 524288
    v_rcp_f32 v243, v243
    v_mfma_f32_16x16x32_bf16 v[64:67], a[136:139], v[212:215], v[64:67]
    v_mul_f32 v242, v38, v242
    v_mul_f32 v243, v39, v243
    v_mfma_f32_16x16x32_bf16 v[64:67], a[140:143], v[216:219], v[64:67]
    buffer_load_dwordx4 a[80:83], v3, s[4:7], s30 offen sc1
    v_mfma_f32_16x16x32_bf16 v[68:71], a[144:147], v[184:187], v[68:71]
    ds_read_b128 v[220:223], v4 offset:54272
    ds_read_b128 v[224:227], v4 offset:55296
    v_mfma_f32_16x16x32_bf16 v[68:71], a[148:151], v[188:191], v[68:71]
    ds_read_b128 v[228:231], v4 offset:56320
    v_cvt_pk_bf16_f32 v148, v242, v243
    v_mfma_f32_16x16x32_bf16 v[68:71], a[152:155], v[192:195], v[68:71]
    s_add_u32 s30, s24, 528384
    v_mul_f32 v40, v40, v246
    v_mul_f32 v41, v41, v246
    v_mfma_f32_16x16x32_bf16 v[68:71], a[156:159], v[196:199], v[68:71]
    s_add_u32 s35, s35, 4096
    v_fma_f32 v232, -v40, v40, s29
    v_fma_f32 v233, -v41, v41, s29
    v_mfma_f32_16x16x32_bf16 v[68:71], a[160:163], v[200:203], v[68:71]
    buffer_load_dword v255, v2, s[4:7], s35 offen sc1
    v_mfma_f32_16x16x32_bf16 v[68:71], a[164:167], v[204:207], v[68:71]
    v_mul_f32 v232, v232, v40
    v_mul_f32 v233, v233, v41
    v_mfma_f32_16x16x32_bf16 v[68:71], a[168:171], v[208:211], v[68:71]
    buffer_store_dwordx4 v[116:119], v3, s[4:7], s53 offen sc1
    v_mfma_f32_16x16x32_bf16 v[68:71], a[172:175], v[212:215], v[68:71]
    ds_read_b128 a[232:235], v4 offset:57344
    ds_read_b128 a[236:239], v4 offset:58368
    v_mfma_f32_16x16x32_bf16 v[68:71], a[176:179], v[216:219], v[68:71]
    ds_read_b128 a[240:243], v4 offset:59392
    v_mul_f32 v42, v40, v42
    v_mfma_f32_16x16x32_bf16 v[72:75], a[180:183], v[184:187], v[72:75]
    ds_read_b128 a[244:247], v4 offset:60416
    ds_read_b128 a[248:251], v4 offset:61440
    v_mfma_f32_16x16x32_bf16 v[72:75], a[184:187], v[188:191], v[72:75]
    ds_read_b128 a[252:255], v4 offset:62464
    v_mul_f32 v43, v41, v43
    v_mfma_f32_16x16x32_bf16 v[72:75], a[188:191], v[192:195], v[72:75]
    buffer_load_dwordx4 a[84:87], v3, s[4:7], s30 offen sc1
    v_mfma_f32_16x16x32_bf16 v[72:75], a[192:195], v[196:199], v[72:75]
    v_exp_f32 v232, v232
    v_mfma_f32_16x16x32_bf16 v[72:75], a[196:199], v[200:203], v[72:75]
    s_add_u32 s30, s24, 532480
    v_exp_f32 v233, v233
    v_mfma_f32_16x16x32_bf16 v[72:75], a[200:203], v[204:207], v[72:75]
    v_add_f32 v232, 1.0, v232
    v_add_f32 v233, 1.0, v233
    v_mfma_f32_16x16x32_bf16 v[72:75], a[204:207], v[208:211], v[72:75]
    buffer_load_dwordx4 a[88:91], v3, s[4:7], s30 offen sc1
    v_mfma_f32_16x16x32_bf16 v[72:75], a[208:211], v[212:215], v[72:75]
    v_rcp_f32 v232, v232
    v_mfma_f32_16x16x32_bf16 v[72:75], a[212:215], v[216:219], v[72:75]
    s_waitcnt lgkmcnt(3)
    v_rcp_f32 v233, v233
    v_mfma_f32_16x16x32_bf16 v[76:79], a[108:111], v[220:223], v[76:79]
    s_add_u32 s30, s24, 536576
    v_mul_f32 v232, v42, v232
    v_mul_f32 v233, v43, v233
    v_mfma_f32_16x16x32_bf16 v[76:79], a[112:115], v[224:227], v[76:79]
    v_cvt_pk_bf16_f32 v123, v232, v233
    v_mul_f32 v44, v44, v246
    v_mfma_f32_16x16x32_bf16 v[76:79], a[116:119], v[228:231], v[76:79]
    buffer_load_dwordx4 a[92:95], v3, s[4:7], s30 offen sc1
    v_mfma_f32_16x16x32_bf16 v[76:79], a[120:123], a[232:235], v[76:79]
    v_mul_f32 v45, v45, v246
    v_fma_f32 v234, -v44, v44, s29
    v_mfma_f32_16x16x32_bf16 v[76:79], a[124:127], a[236:239], v[76:79]
    v_fma_f32 v235, -v45, v45, s29
    v_mul_f32 v234, v234, v44
    v_mfma_f32_16x16x32_bf16 v[76:79], a[128:131], a[240:243], v[76:79]
    s_waitcnt lgkmcnt(0)
    v_mul_f32 v235, v235, v45
    v_mul_f32 v46, v44, v46
    v_mfma_f32_16x16x32_bf16 v[76:79], a[132:135], a[244:247], v[76:79]
    s_add_u32 s30, s24, 540672
    v_exp_f32 v234, v234
    v_mfma_f32_16x16x32_bf16 v[76:79], a[136:139], a[248:251], v[76:79]
    v_exp_f32 v235, v235
    v_mfma_f32_16x16x32_bf16 v[76:79], a[140:143], a[252:255], v[76:79]
    buffer_load_dwordx4 a[96:99], v3, s[4:7], s30 offen sc1
    v_mfma_f32_16x16x32_bf16 v[80:83], a[144:147], v[220:223], v[80:83]
    ds_read_b128 v[184:187], v4 offset:63488
    ds_read_b128 v[188:191], v4 offset:64512
    v_mfma_f32_16x16x32_bf16 v[80:83], a[148:151], v[224:227], v[80:83]
    ds_read_b128 v[192:195], v5 offset:0
    v_mul_f32 v47, v45, v47
    v_mfma_f32_16x16x32_bf16 v[80:83], a[152:155], v[228:231], v[80:83]
    s_add_u32 s30, s24, 544768
    v_add_f32 v234, 1.0, v234
    v_add_f32 v235, 1.0, v235
    v_mfma_f32_16x16x32_bf16 v[80:83], a[156:159], a[232:235], v[80:83]
    v_rcp_f32 v234, v234
    v_mfma_f32_16x16x32_bf16 v[80:83], a[160:163], a[236:239], v[80:83]
    buffer_load_dwordx4 a[100:103], v3, s[4:7], s30 offen sc1
    v_mfma_f32_16x16x32_bf16 v[80:83], a[164:167], a[240:243], v[80:83]
    v_rcp_f32 v235, v235
    v_mfma_f32_16x16x32_bf16 v[80:83], a[168:171], a[244:247], v[80:83]
    v_mul_f32 v234, v46, v234
    v_mul_f32 v235, v47, v235
    v_mfma_f32_16x16x32_bf16 v[80:83], a[172:175], a[248:251], v[80:83]
    s_add_u32 s35, s35, 4096
    ds_read_b128 v[196:199], v5 offset:1024
    ds_read_b128 v[200:203], v5 offset:2048
    v_mfma_f32_16x16x32_bf16 v[80:83], a[176:179], a[252:255], v[80:83]
    s_add_u32 s30, s24, 548864
    ds_read_b128 v[204:207], v5 offset:3072
    v_cvt_pk_bf16_f32 v178, v234, v235
    v_mfma_f32_16x16x32_bf16 v[84:87], a[180:183], v[220:223], v[84:87]
    ds_read_b128 v[208:211], v5 offset:4096
    ds_read_b128 v[212:215], v5 offset:5120
    v_mfma_f32_16x16x32_bf16 v[84:87], a[184:187], v[224:227], v[84:87]
    ds_read_b128 v[216:219], v5 offset:6144
    v_mul_f32 v48, v48, v246
    v_mfma_f32_16x16x32_bf16 v[84:87], a[188:191], v[228:231], v[84:87]
    buffer_load_dwordx4 a[104:107], v3, s[4:7], s30 offen sc1
    v_mfma_f32_16x16x32_bf16 v[84:87], a[192:195], a[232:235], v[84:87]
    buffer_load_dword v255, v2, s[4:7], s35 offen sc1
    v_mfma_f32_16x16x32_bf16 v[84:87], a[196:199], a[236:239], v[84:87]
    v_mul_f32 v49, v49, v246
    v_fma_f32 v236, -v48, v48, s29
    v_mfma_f32_16x16x32_bf16 v[84:87], a[200:203], a[240:243], v[84:87]
    v_fma_f32 v237, -v49, v49, s29
    v_mul_f32 v236, v236, v48
    v_mfma_f32_16x16x32_bf16 v[84:87], a[204:207], a[244:247], v[84:87]
    v_mul_f32 v237, v237, v49
    v_mul_f32 v50, v48, v50
    v_mfma_f32_16x16x32_bf16 v[84:87], a[208:211], a[248:251], v[84:87]
    v_exp_f32 v236, v236
    v_mfma_f32_16x16x32_bf16 v[84:87], a[212:215], a[252:255], v[84:87]
    s_waitcnt lgkmcnt(3)
    v_exp_f32 v237, v237
    v_mfma_f32_16x16x32_bf16 v[88:91], a[108:111], v[184:187], v[88:91]
    v_mul_f32 v51, v49, v51
    v_add_f32 v236, 1.0, v236
    v_mfma_f32_16x16x32_bf16 v[88:91], a[112:115], v[188:191], v[88:91]
    v_add_f32 v237, 1.0, v237
    v_mul_f32 v52, v52, v247
    v_mfma_f32_16x16x32_bf16 v[88:91], a[116:119], v[192:195], v[88:91]
    v_rcp_f32 v236, v236
    v_mfma_f32_16x16x32_bf16 v[88:91], a[120:123], v[196:199], v[88:91]
    v_rcp_f32 v237, v237
    v_mfma_f32_16x16x32_bf16 v[88:91], a[124:127], v[200:203], v[88:91]
    v_mul_f32 v236, v50, v236
    v_mul_f32 v237, v51, v237
    v_mfma_f32_16x16x32_bf16 v[88:91], a[128:131], v[204:207], v[88:91]
    s_waitcnt vmcnt(17) lgkmcnt(0)
    v_cvt_pk_bf16_f32 v152, v236, v237
    v_mul_f32 v53, v53, v247
    v_mfma_f32_16x16x32_bf16 v[88:91], a[132:135], v[208:211], v[88:91]
    s_mov_b64 exec, 1
    buffer_atomic_add v252, off, s[4:7], s101 offset:0 sc1
    s_mov_b64 exec, -1
    v_mfma_f32_16x16x32_bf16 v[88:91], a[136:139], v[212:215], v[88:91]
    v_fma_f32 v238, -v52, v52, s29
    v_fma_f32 v239, -v53, v53, s29
    v_mfma_f32_16x16x32_bf16 v[88:91], a[140:143], v[216:219], v[88:91]
    buffer_store_dwordx4 v[120:123], v3, s[4:7], s54 offen sc1
    v_mfma_f32_16x16x32_bf16 v[92:95], a[144:147], v[184:187], v[92:95]
    ds_read_b128 v[220:223], v5 offset:7168
    ds_read_b128 v[224:227], v5 offset:8192
    v_mfma_f32_16x16x32_bf16 v[92:95], a[148:151], v[188:191], v[92:95]
    ds_read_b128 v[228:231], v5 offset:9216
    v_mul_f32 v238, v238, v52
    v_mfma_f32_16x16x32_bf16 v[92:95], a[152:155], v[192:195], v[92:95]
    v_mul_f32 v239, v239, v53
    v_mul_f32 v54, v52, v54
    v_mfma_f32_16x16x32_bf16 v[92:95], a[156:159], v[196:199], v[92:95]
    v_exp_f32 v238, v238
    v_mfma_f32_16x16x32_bf16 v[92:95], a[160:163], v[200:203], v[92:95]
    v_exp_f32 v239, v239
    v_mfma_f32_16x16x32_bf16 v[92:95], a[164:167], v[204:207], v[92:95]
    v_mul_f32 v55, v53, v55
    v_add_f32 v238, 1.0, v238
    v_mfma_f32_16x16x32_bf16 v[92:95], a[168:171], v[208:211], v[92:95]
    v_add_f32 v239, 1.0, v239
    v_mul_f32 v56, v56, v247
    v_mfma_f32_16x16x32_bf16 v[92:95], a[172:175], v[212:215], v[92:95]
    ds_read_b128 a[232:235], v5 offset:10240
    ds_read_b128 a[236:239], v5 offset:11264
    v_mfma_f32_16x16x32_bf16 v[92:95], a[176:179], v[216:219], v[92:95]
    ds_read_b128 a[240:243], v5 offset:12288
    v_mul_f32 v57, v57, v247
    v_mfma_f32_16x16x32_bf16 v[96:99], a[180:183], v[184:187], v[96:99]
    ds_read_b128 a[244:247], v5 offset:13312
    ds_read_b128 a[248:251], v5 offset:14336
    v_mfma_f32_16x16x32_bf16 v[96:99], a[184:187], v[188:191], v[96:99]
    ds_read_b128 a[252:255], v5 offset:15360
    v_fma_f32 v240, -v56, v56, s29
    v_mfma_f32_16x16x32_bf16 v[96:99], a[188:191], v[192:195], v[96:99]
    v_rcp_f32 v238, v238
    v_mfma_f32_16x16x32_bf16 v[96:99], a[192:195], v[196:199], v[96:99]
    v_rcp_f32 v239, v239
    v_mfma_f32_16x16x32_bf16 v[96:99], a[196:199], v[200:203], v[96:99]
    v_mul_f32 v238, v54, v238
    v_mul_f32 v239, v55, v239
    v_mfma_f32_16x16x32_bf16 v[96:99], a[200:203], v[204:207], v[96:99]
    v_cvt_pk_bf16_f32 v127, v238, v239
    v_fma_f32 v241, -v57, v57, s29
    v_mfma_f32_16x16x32_bf16 v[96:99], a[204:207], v[208:211], v[96:99]
    s_add_u32 s35, s35, 4096
    v_mul_f32 v240, v240, v56
    v_mul_f32 v241, v241, v57
    v_mfma_f32_16x16x32_bf16 v[96:99], a[208:211], v[212:215], v[96:99]
    buffer_load_dword v255, v2, s[4:7], s35 offen sc1
    v_mfma_f32_16x16x32_bf16 v[96:99], a[212:215], v[216:219], v[96:99]
    s_waitcnt lgkmcnt(3)
    v_exp_f32 v240, v240
    v_mfma_f32_16x16x32_bf16 v[100:103], a[108:111], v[220:223], v[100:103]
    v_exp_f32 v241, v241
    v_mfma_f32_16x16x32_bf16 v[100:103], a[112:115], v[224:227], v[100:103]
    v_mul_f32 v58, v56, v58
    v_mul_f32 v59, v57, v59
    v_mfma_f32_16x16x32_bf16 v[100:103], a[116:119], v[228:231], v[100:103]
    v_add_f32 v240, 1.0, v240
    v_add_f32 v241, 1.0, v241
    v_mfma_f32_16x16x32_bf16 v[100:103], a[120:123], a[232:235], v[100:103]
    v_rcp_f32 v240, v240
    v_mfma_f32_16x16x32_bf16 v[100:103], a[124:127], a[236:239], v[100:103]
    v_rcp_f32 v241, v241
    v_mfma_f32_16x16x32_bf16 v[100:103], a[128:131], a[240:243], v[100:103]
    s_waitcnt lgkmcnt(0)
    v_mul_f32 v240, v58, v240
    v_mul_f32 v241, v59, v241
    v_mfma_f32_16x16x32_bf16 v[100:103], a[132:135], a[244:247], v[100:103]
    v_cvt_pk_bf16_f32 v179, v240, v241
    v_mul_f32 v60, v60, v247
    v_mfma_f32_16x16x32_bf16 v[100:103], a[136:139], a[248:251], v[100:103]
    v_mul_f32 v61, v61, v247
    v_fma_f32 v242, -v60, v60, s29
    v_mfma_f32_16x16x32_bf16 v[100:103], a[140:143], a[252:255], v[100:103]
    v_fma_f32 v243, -v61, v61, s29
    v_mul_f32 v242, v242, v60
    v_mfma_f32_16x16x32_bf16 v[104:107], a[144:147], v[220:223], v[104:107]
    ds_read_b128 v[184:187], v1 offset:0
    ds_read_b128 v[188:191], v1 offset:1024
    v_mfma_f32_16x16x32_bf16 v[104:107], a[148:151], v[224:227], v[104:107]
    ds_read_b128 v[192:195], v1 offset:2048
    v_mul_f32 v243, v243, v61
    v_mfma_f32_16x16x32_bf16 v[104:107], a[152:155], v[228:231], v[104:107]
    v_exp_f32 v242, v242
    v_mfma_f32_16x16x32_bf16 v[104:107], a[156:159], a[232:235], v[104:107]
    v_exp_f32 v243, v243
    v_mfma_f32_16x16x32_bf16 v[104:107], a[160:163], a[236:239], v[104:107]
    v_mul_f32 v62, v60, v62
    v_mul_f32 v63, v61, v63
    v_mfma_f32_16x16x32_bf16 v[104:107], a[164:167], a[240:243], v[104:107]
    v_add_f32 v242, 1.0, v242
    v_add_f32 v243, 1.0, v243
    v_mfma_f32_16x16x32_bf16 v[104:107], a[168:171], a[244:247], v[104:107]
    v_rcp_f32 v242, v242
    v_mfma_f32_16x16x32_bf16 v[104:107], a[172:175], a[248:251], v[104:107]
    ds_read_b128 v[196:199], v1 offset:3072
    ds_read_b128 v[200:203], v1 offset:4096
    v_mfma_f32_16x16x32_bf16 v[104:107], a[176:179], a[252:255], v[104:107]
    ds_read_b128 v[204:207], v1 offset:5120
    v_mul_f32 v242, v62, v242
    v_mfma_f32_16x16x32_bf16 v[108:111], a[180:183], v[220:223], v[108:111]
    ds_read_b128 v[208:211], v1 offset:6144
    ds_read_b128 v[212:215], v1 offset:7168
    v_mfma_f32_16x16x32_bf16 v[108:111], a[184:187], v[224:227], v[108:111]
    ds_read_b128 v[216:219], v1 offset:8192
    v_mul_f32 v64, v64, v248
    v_mfma_f32_16x16x32_bf16 v[108:111], a[188:191], v[228:231], v[108:111]
    v_rcp_f32 v243, v243
    v_mfma_f32_16x16x32_bf16 v[108:111], a[192:195], a[232:235], v[108:111]
    v_mul_f32 v243, v63, v243
    v_mul_f32 v65, v65, v248
    v_mfma_f32_16x16x32_bf16 v[108:111], a[196:199], a[236:239], v[108:111]
    v_cvt_pk_bf16_f32 v156, v242, v243
    v_fma_f32 v232, -v64, v64, s29
    v_mfma_f32_16x16x32_bf16 v[108:111], a[200:203], a[240:243], v[108:111]
    buffer_store_dwordx4 v[124:127], v3, s[4:7], s60 offen sc1
    v_mfma_f32_16x16x32_bf16 v[108:111], a[204:207], a[244:247], v[108:111]
    v_fma_f32 v233, -v65, v65, s29
    v_mul_f32 v232, v232, v64
    v_mfma_f32_16x16x32_bf16 v[108:111], a[208:211], a[248:251], v[108:111]
    s_add_u32 s30, s24, 552960
    v_mul_f32 v233, v233, v65
    v_mul_f32 v66, v64, v66
    v_mfma_f32_16x16x32_bf16 v[108:111], a[212:215], a[252:255], v[108:111]
    s_waitcnt lgkmcnt(3)
    v_exp_f32 v232, v232
    v_mfma_f32_16x16x32_bf16 v[16:19], a[0:3], v[184:187], 0
    v_exp_f32 v233, v233
    v_mfma_f32_16x16x32_bf16 v[16:19], a[4:7], v[188:191], v[16:19]
    buffer_load_dwordx4 a[108:111], v3, s[4:7], s30 offen sc1
    v_mfma_f32_16x16x32_bf16 v[16:19], a[8:11], v[192:195], v[16:19]
    s_add_u32 s35, s35, 3584
    v_mul_f32 v67, v65, v67
    v_add_f32 v232, 1.0, v232
    v_mfma_f32_16x16x32_bf16 v[16:19], a[12:15], v[196:199], v[16:19]
    s_add_u32 s30, s24, 557056
    v_add_f32 v233, 1.0, v233
    v_mul_f32 v68, v68, v248
    v_mfma_f32_16x16x32_bf16 v[16:19], a[16:19], v[200:203], v[16:19]
    buffer_load_dword v255, v2, s[4:7], s35 offen sc1
    v_mfma_f32_16x16x32_bf16 v[16:19], a[20:23], v[204:207], v[16:19]
    s_waitcnt lgkmcnt(0)
    v_rcp_f32 v232, v232
    v_mfma_f32_16x16x32_bf16 v[16:19], a[24:27], v[208:211], v[16:19]
    buffer_load_dwordx4 a[112:115], v3, s[4:7], s30 offen sc1
    v_mfma_f32_16x16x32_bf16 v[16:19], a[28:31], v[212:215], v[16:19]
    s_waitcnt vmcnt(19)
    v_rcp_f32 v233, v233
    v_mfma_f32_16x16x32_bf16 v[16:19], a[32:35], v[216:219], v[16:19]
    s_add_u32 s30, s24, 561152
    v_mul_f32 v232, v66, v232
    v_mul_f32 v233, v67, v233
    v_mfma_f32_16x16x32_bf16 v[20:23], a[36:39], v[184:187], 0
    ds_read_b128 v[220:223], v1 offset:9216
    ds_read_b128 v[224:227], v1 offset:10240
    v_mfma_f32_16x16x32_bf16 v[20:23], a[40:43], v[188:191], v[20:23]
    ds_read_b128 v[228:231], v1 offset:11264
    v_cvt_pk_bf16_f32 v131, v232, v233
    v_mfma_f32_16x16x32_bf16 v[20:23], a[44:47], v[192:195], v[20:23]
    buffer_load_dwordx4 a[116:119], v3, s[4:7], s30 offen sc1
    v_mfma_f32_16x16x32_bf16 v[20:23], a[48:51], v[196:199], v[20:23]
    v_mul_f32 v69, v69, v248
    v_fma_f32 v234, -v68, v68, s29
    v_mfma_f32_16x16x32_bf16 v[20:23], a[52:55], v[200:203], v[20:23]
    v_fma_f32 v235, -v69, v69, s29
    v_mul_f32 v234, v234, v68
    v_mfma_f32_16x16x32_bf16 v[20:23], a[56:59], v[204:207], v[20:23]
    s_add_u32 s30, s24, 565248
    v_mul_f32 v235, v235, v69
    v_mul_f32 v70, v68, v70
    v_mfma_f32_16x16x32_bf16 v[20:23], a[60:63], v[208:211], v[20:23]
    v_exp_f32 v234, v234
    v_mfma_f32_16x16x32_bf16 v[20:23], a[64:67], v[212:215], v[20:23]
    ds_read_b128 a[232:235], v1 offset:12288
    ds_read_b128 a[236:239], v1 offset:13312
    v_mfma_f32_16x16x32_bf16 v[20:23], a[68:71], v[216:219], v[20:23]
    s_waitcnt vmcnt(9)
    ds_read_b128 a[240:243], v1 offset:14336
    v_mul_f32 v71, v69, v71
    v_mfma_f32_16x16x32_bf16 v[24:27], a[72:75], v[184:187], 0
    ds_read_b128 a[244:247], v1 offset:15360
    ds_read_b128 a[248:251], v1 offset:16384
    v_mfma_f32_16x16x32_bf16 v[24:27], a[76:79], v[188:191], v[24:27]
    ds_read_b128 a[252:255], v1 offset:17408
    v_add_f32 v234, 1.0, v234
    v_mfma_f32_16x16x32_bf16 v[24:27], a[80:83], v[192:195], v[24:27]
    buffer_load_dwordx4 a[120:123], v3, s[4:7], s30 offen sc1
    v_mfma_f32_16x16x32_bf16 v[24:27], a[84:87], v[196:199], v[24:27]
    v_exp_f32 v235, v235
    v_mfma_f32_16x16x32_bf16 v[24:27], a[88:91], v[200:203], v[24:27]
    s_add_u32 s30, s24, 569344
    v_add_f32 v235, 1.0, v235
    v_mul_f32 v72, v72, v248
    v_mfma_f32_16x16x32_bf16 v[24:27], a[92:95], v[204:207], v[24:27]
    v_rcp_f32 v234, v234
    v_mfma_f32_16x16x32_bf16 v[24:27], a[96:99], v[208:211], v[24:27]
    buffer_load_dwordx4 a[124:127], v3, s[4:7], s30 offen sc1
    v_mfma_f32_16x16x32_bf16 v[24:27], a[100:103], v[212:215], v[24:27]
    v_rcp_f32 v235, v235
    v_mfma_f32_16x16x32_bf16 v[24:27], a[104:107], v[216:219], v[24:27]
    s_waitcnt lgkmcnt(3)
    v_mul_f32 v234, v70, v234
    v_mul_f32 v235, v71, v235
    v_mfma_f32_16x16x32_bf16 v[28:31], a[0:3], v[220:223], 0
    s_add_u32 s30, s24, 573440
    v_cvt_pk_bf16_f32 v180, v234, v235
    v_mul_f32 v73, v73, v248
    v_mfma_f32_16x16x32_bf16 v[28:31], a[4:7], v[224:227], v[28:31]
    v_fma_f32 v236, -v72, v72, s29
    v_fma_f32 v237, -v73, v73, s29
    v_mfma_f32_16x16x32_bf16 v[28:31], a[8:11], v[228:231], v[28:31]
    buffer_load_dwordx4 a[128:131], v3, s[4:7], s30 offen sc1
    v_mfma_f32_16x16x32_bf16 v[28:31], a[12:15], a[232:235], v[28:31]
    v_mul_f32 v236, v236, v72
    v_mul_f32 v237, v237, v73
    v_mfma_f32_16x16x32_bf16 v[28:31], a[16:19], a[236:239], v[28:31]
    v_exp_f32 v236, v236
    v_mfma_f32_16x16x32_bf16 v[28:31], a[20:23], a[240:243], v[28:31]
    s_waitcnt lgkmcnt(0)
    v_exp_f32 v237, v237
    v_mfma_f32_16x16x32_bf16 v[28:31], a[24:27], a[244:247], v[28:31]
    s_add_u32 s30, s24, 577536
    v_mul_f32 v74, v72, v74
    v_mul_f32 v75, v73, v75
    v_mfma_f32_16x16x32_bf16 v[28:31], a[28:31], a[248:251], v[28:31]
    v_add_f32 v236, 1.0, v236
    v_add_f32 v237, 1.0, v237
    v_mfma_f32_16x16x32_bf16 v[28:31], a[32:35], a[252:255], v[28:31]
    buffer_load_dwordx4 a[132:135], v3, s[4:7], s30 offen sc1
    v_mfma_f32_16x16x32_bf16 v[32:35], a[36:39], v[220:223], 0
    ds_read_b128 v[184:187], v1 offset:18432
    ds_read_b128 v[188:191], v1 offset:19456
    v_mfma_f32_16x16x32_bf16 v[32:35], a[40:43], v[224:227], v[32:35]
    ds_read_b128 v[192:195], v1 offset:20480
    v_mul_f32 v76, v76, v249
    v_mfma_f32_16x16x32_bf16 v[32:35], a[44:47], v[228:231], v[32:35]
    s_add_u32 s30, s24, 581632
    v_rcp_f32 v236, v236
    v_mfma_f32_16x16x32_bf16 v[32:35], a[48:51], a[232:235], v[32:35]
    v_rcp_f32 v237, v237
    v_mfma_f32_16x16x32_bf16 v[32:35], a[52:55], a[236:239], v[32:35]
    buffer_load_dwordx4 a[136:139], v3, s[4:7], s30 offen sc1
    v_mfma_f32_16x16x32_bf16 v[32:35], a[56:59], a[240:243], v[32:35]
    v_mul_f32 v236, v74, v236
    v_mul_f32 v237, v75, v237
    v_mfma_f32_16x16x32_bf16 v[32:35], a[60:63], a[244:247], v[32:35]
    v_cvt_pk_bf16_f32 v160, v236, v237
    v_mul_f32 v77, v77, v249
    v_mfma_f32_16x16x32_bf16 v[32:35], a[64:67], a[248:251], v[32:35]
    ds_read_b128 v[196:199], v1 offset:21504
    ds_read_b128 v[200:203], v1 offset:22528
    v_mfma_f32_16x16x32_bf16 v[32:35], a[68:71], a[252:255], v[32:35]
    s_add_u32 s30, s24, 585728
    ds_read_b128 v[204:207], v1 offset:23552
    v_fma_f32 v238, -v76, v76, s29
    v_mfma_f32_16x16x32_bf16 v[36:39], a[72:75], v[220:223], 0
    ds_read_b128 v[208:211], v1 offset:24576
    ds_read_b128 v[212:215], v1 offset:25600
    v_mfma_f32_16x16x32_bf16 v[36:39], a[76:79], v[224:227], v[36:39]
    ds_read_b128 v[216:219], v1 offset:26624
    v_fma_f32 v239, -v77, v77, s29
    v_mfma_f32_16x16x32_bf16 v[36:39], a[80:83], v[228:231], v[36:39]
    v_mul_f32 v238, v238, v76
    v_mul_f32 v239, v239, v77
    v_mfma_f32_16x16x32_bf16 v[36:39], a[84:87], a[232:235], v[36:39]
    v_exp_f32 v238, v238
    v_mfma_f32_16x16x32_bf16 v[36:39], a[88:91], a[236:239], v[36:39]
    buffer_load_dwordx4 a[140:143], v3, s[4:7], s30 offen sc1
    v_mfma_f32_16x16x32_bf16 v[36:39], a[92:95], a[240:243], v[36:39]
    v_exp_f32 v239, v239
    v_mfma_f32_16x16x32_bf16 v[36:39], a[96:99], a[244:247], v[36:39]
    s_add_u32 s30, s24, 589824
    v_mul_f32 v78, v76, v78
    v_mul_f32 v79, v77, v79
    v_mfma_f32_16x16x32_bf16 v[36:39], a[100:103], a[248:251], v[36:39]
    v_add_f32 v238, 1.0, v238
    v_add_f32 v239, 1.0, v239
    v_mfma_f32_16x16x32_bf16 v[36:39], a[104:107], a[252:255], v[36:39]
    s_waitcnt lgkmcnt(3)
    v_rcp_f32 v238, v238
    v_mfma_f32_16x16x32_bf16 v[40:43], a[0:3], v[184:187], 0
    buffer_load_dwordx4 a[144:147], v3, s[4:7], s30 offen sc1
    v_mfma_f32_16x16x32_bf16 v[40:43], a[4:7], v[188:191], v[40:43]
    v_rcp_f32 v239, v239
    v_mfma_f32_16x16x32_bf16 v[40:43], a[8:11], v[192:195], v[40:43]
    s_add_u32 s30, s24, 593920
    v_mov_b32 v254, 0
    v_mul_f32 v238, v78, v238
    v_mfma_f32_16x16x32_bf16 v[40:43], a[12:15], v[196:199], v[40:43]
    v_mul_f32 v239, v79, v239
    v_mul_f32 v80, v80, v249
    v_mfma_f32_16x16x32_bf16 v[40:43], a[16:19], v[200:203], v[40:43]
    buffer_load_dwordx4 a[148:151], v3, s[4:7], s30 offen sc1
    v_mfma_f32_16x16x32_bf16 v[40:43], a[20:23], v[204:207], v[40:43]
    s_waitcnt lgkmcnt(0)
    v_cvt_pk_bf16_f32 v135, v238, v239
    v_mul_f32 v81, v81, v249
    v_mfma_f32_16x16x32_bf16 v[40:43], a[24:27], v[208:211], v[40:43]
    buffer_store_dwordx4 v[128:131], v3, s[4:7], s61 offen sc1
    v_mfma_f32_16x16x32_bf16 v[40:43], a[28:31], v[212:215], v[40:43]
    v_fma_f32 v240, -v80, v80, s29
    v_fma_f32 v241, -v81, v81, s29
    v_mfma_f32_16x16x32_bf16 v[40:43], a[32:35], v[216:219], v[40:43]
    s_add_u32 s30, s24, 598016
    v_mul_f32 v240, v240, v80
    v_mul_f32 v241, v241, v81
    v_mfma_f32_16x16x32_bf16 v[44:47], a[36:39], v[184:187], 0
    ds_read_b128 v[220:223], v1 offset:27648
    ds_read_b128 v[224:227], v1 offset:28672
    v_mfma_f32_16x16x32_bf16 v[44:47], a[40:43], v[188:191], v[44:47]
    ds_read_b128 v[228:231], v1 offset:29696
    v_mul_f32 v82, v80, v82
    v_mfma_f32_16x16x32_bf16 v[44:47], a[44:47], v[192:195], v[44:47]
    buffer_load_dwordx4 a[152:155], v3, s[4:7], s30 offen sc1
    v_mfma_f32_16x16x32_bf16 v[44:47], a[48:51], v[196:199], v[44:47]
    v_exp_f32 v240, v240
    v_mfma_f32_16x16x32_bf16 v[44:47], a[52:55], v[200:203], v[44:47]
    s_add_u32 s30, s24, 602112
    v_exp_f32 v241, v241
    v_mfma_f32_16x16x32_bf16 v[44:47], a[56:59], v[204:207], v[44:47]
    v_mul_f32 v83, v81, v83
    v_add_f32 v240, 1.0, v240
    v_mfma_f32_16x16x32_bf16 v[44:47], a[60:63], v[208:211], v[44:47]
    buffer_load_dwordx4 a[156:159], v3, s[4:7], s30 offen sc1
    v_mfma_f32_16x16x32_bf16 v[44:47], a[64:67], v[212:215], v[44:47]
    ds_read_b128 a[232:235], v1 offset:30720
    ds_read_b128 a[236:239], v1 offset:31744
    v_mfma_f32_16x16x32_bf16 v[44:47], a[68:71], v[216:219], v[44:47]
    ds_read_b128 a[240:243], v1 offset:32768
    v_add_f32 v241, 1.0, v241
    v_mfma_f32_16x16x32_bf16 v[48:51], a[72:75], v[184:187], 0
    ds_read_b128 a[244:247], v1 offset:33792
    ds_read_b128 a[248:251], v1 offset:34816
    v_mfma_f32_16x16x32_bf16 v[48:51], a[76:79], v[188:191], v[48:51]
    s_add_u32 s30, s24, 606208
    ds_read_b128 a[252:255], v1 offset:35840
    v_mul_f32 v84, v84, v249
    v_mfma_f32_16x16x32_bf16 v[48:51], a[80:83], v[192:195], v[48:51]
    v_rcp_f32 v240, v240
    v_mfma_f32_16x16x32_bf16 v[48:51], a[84:87], v[196:199], v[48:51]
    buffer_load_dwordx4 a[160:163], v3, s[4:7], s30 offen sc1
    v_mfma_f32_16x16x32_bf16 v[48:51], a[88:91], v[200:203], v[48:51]
    s_mov_b64 exec, 1
    buffer_atomic_add v254, off, s[4:7], s100 sc0 sc1
    s_mov_b64 exec, -1
    v_mfma_f32_16x16x32_bf16 v[48:51], a[92:95], v[204:207], v[48:51]
    v_rcp_f32 v241, v241
    v_mfma_f32_16x16x32_bf16 v[48:51], a[96:99], v[208:211], v[48:51]
    s_add_u32 s30, s24, 610304
    v_mul_f32 v240, v82, v240
    v_mul_f32 v241, v83, v241
    v_mfma_f32_16x16x32_bf16 v[48:51], a[100:103], v[212:215], v[48:51]
    v_cvt_pk_bf16_f32 v181, v240, v241
    v_mul_f32 v85, v85, v249
    v_mfma_f32_16x16x32_bf16 v[48:51], a[104:107], v[216:219], v[48:51]
    s_waitcnt lgkmcnt(3)
    v_fma_f32 v242, -v84, v84, s29
    v_fma_f32 v243, -v85, v85, s29
    v_mfma_f32_16x16x32_bf16 v[52:55], a[0:3], v[220:223], 0
    buffer_load_dwordx4 a[164:167], v3, s[4:7], s30 offen sc1
    v_mfma_f32_16x16x32_bf16 v[52:55], a[4:7], v[224:227], v[52:55]
    v_mul_f32 v242, v242, v84
    v_mul_f32 v243, v243, v85
    v_mfma_f32_16x16x32_bf16 v[52:55], a[8:11], v[228:231], v[52:55]
    v_exp_f32 v242, v242
    v_mfma_f32_16x16x32_bf16 v[52:55], a[12:15], a[232:235], v[52:55]
    s_add_u32 s30, s24, 614400
    v_exp_f32 v243, v243
    v_mfma_f32_16x16x32_bf16 v[52:55], a[16:19], a[236:239], v[52:55]
    v_mul_f32 v86, v84, v86
    v_mul_f32 v87, v85, v87
    v_mfma_f32_16x16x32_bf16 v[52:55], a[20:23], a[240:243], v[52:55]
    s_waitcnt lgkmcnt(0)
    v_add_f32 v242, 1.0, v242
    v_add_f32 v243, 1.0, v243
    v_mfma_f32_16x16x32_bf16 v[52:55], a[24:27], a[244:247], v[52:55]
    buffer_load_dwordx4 a[168:171], v3, s[4:7], s30 offen sc1
    v_mfma_f32_16x16x32_bf16 v[52:55], a[28:31], a[248:251], v[52:55]
    v_rcp_f32 v242, v242
    v_mfma_f32_16x16x32_bf16 v[52:55], a[32:35], a[252:255], v[52:55]
    s_add_u32 s30, s24, 618496
    v_rcp_f32 v243, v243
    v_mfma_f32_16x16x32_bf16 v[56:59], a[36:39], v[220:223], 0
    ds_read_b128 v[184:187], v1 offset:36864
    ds_read_b128 v[188:191], v1 offset:37888
    v_mfma_f32_16x16x32_bf16 v[56:59], a[40:43], v[224:227], v[56:59]
    ds_read_b128 v[192:195], v1 offset:38912
    v_mul_f32 v242, v86, v242
    v_mfma_f32_16x16x32_bf16 v[56:59], a[44:47], v[228:231], v[56:59]
    buffer_load_dwordx4 a[172:175], v3, s[4:7], s30 offen sc1
    v_mfma_f32_16x16x32_bf16 v[56:59], a[48:51], a[232:235], v[56:59]
    v_mul_f32 v243, v87, v243
    v_mul_f32 v88, v88, v250
    v_mfma_f32_16x16x32_bf16 v[56:59], a[52:55], a[236:239], v[56:59]
    v_cvt_pk_bf16_f32 v164, v242, v243
    v_mul_f32 v89, v89, v250
    v_mfma_f32_16x16x32_bf16 v[56:59], a[56:59], a[240:243], v[56:59]
    s_add_u32 s30, s24, 622592
    v_fma_f32 v232, -v88, v88, s29
    v_fma_f32 v233, -v89, v89, s29
    v_mfma_f32_16x16x32_bf16 v[56:59], a[60:63], a[244:247], v[56:59]
    buffer_store_dwordx4 v[132:135], v3, s[4:7], s62 offen sc1
    v_mfma_f32_16x16x32_bf16 v[56:59], a[64:67], a[248:251], v[56:59]
    ds_read_b128 v[196:199], v1 offset:39936
    ds_read_b128 v[200:203], v1 offset:40960
    v_mfma_f32_16x16x32_bf16 v[56:59], a[68:71], a[252:255], v[56:59]
    ds_read_b128 v[204:207], v1 offset:41984
    v_mul_f32 v232, v232, v88
    v_mfma_f32_16x16x32_bf16 v[60:63], a[72:75], v[220:223], 0
    ds_read_b128 v[208:211], v1 offset:43008
    ds_read_b128 v[212:215], v1 offset:44032
    v_mfma_f32_16x16x32_bf16 v[60:63], a[76:79], v[224:227], v[60:63]
    ds_read_b128 v[216:219], v1 offset:45056
    v_mul_f32 v233, v233, v89
    v_mfma_f32_16x16x32_bf16 v[60:63], a[80:83], v[228:231], v[60:63]
    buffer_load_dwordx4 a[176:179], v3, s[4:7], s30 offen sc1
    v_mfma_f32_16x16x32_bf16 v[60:63], a[84:87], a[232:235], v[60:63]
    v_exp_f32 v232, v232
    v_mfma_f32_16x16x32_bf16 v[60:63], a[88:91], a[236:239], v[60:63]
    s_add_u32 s30, s24, 626688
    v_exp_f32 v233, v233
    v_mfma_f32_16x16x32_bf16 v[60:63], a[92:95], a[240:243], v[60:63]
    v_mul_f32 v90, v88, v90
    v_mul_f32 v91, v89, v91
    v_mfma_f32_16x16x32_bf16 v[60:63], a[96:99], a[244:247], v[60:63]
    buffer_load_dwordx4 a[180:183], v3, s[4:7], s30 offen sc1
    v_mfma_f32_16x16x32_bf16 v[60:63], a[100:103], a[248:251], v[60:63]
    v_add_f32 v232, 1.0, v232
    v_add_f32 v233, 1.0, v233
    v_mfma_f32_16x16x32_bf16 v[60:63], a[104:107], a[252:255], v[60:63]
    s_waitcnt lgkmcnt(3)
    v_rcp_f32 v232, v232
    v_mfma_f32_16x16x32_bf16 v[64:67], a[0:3], v[184:187], 0
    s_add_u32 s30, s24, 630784
    v_rcp_f32 v233, v233
    v_mfma_f32_16x16x32_bf16 v[64:67], a[4:7], v[188:191], v[64:67]
    v_mul_f32 v232, v90, v232
    v_mul_f32 v233, v91, v233
    v_mfma_f32_16x16x32_bf16 v[64:67], a[8:11], v[192:195], v[64:67]
    buffer_load_dwordx4 a[184:187], v3, s[4:7], s30 offen sc1
    v_mfma_f32_16x16x32_bf16 v[64:67], a[12:15], v[196:199], v[64:67]
    v_cvt_pk_bf16_f32 v139, v232, v233
    v_mul_f32 v92, v92, v250
    v_mfma_f32_16x16x32_bf16 v[64:67], a[16:19], v[200:203], v[64:67]
    v_mul_f32 v93, v93, v250
    v_fma_f32 v234, -v92, v92, s29
    v_mfma_f32_16x16x32_bf16 v[64:67], a[20:23], v[204:207], v[64:67]
    s_waitcnt lgkmcnt(0)
    v_fma_f32 v235, -v93, v93, s29
    v_mul_f32 v234, v234, v92
    v_mfma_f32_16x16x32_bf16 v[64:67], a[24:27], v[208:211], v[64:67]
ffn0_part_pad0_6x:
    s_cbranch_execz ffn0_part_pad0_10x
    s_add_u32 s30, s24, 634880
    v_mul_f32 v235, v235, v93
    v_mul_f32 v94, v92, v94
    v_mfma_f32_16x16x32_bf16 v[64:67], a[28:31], v[212:215], v[64:67]
    v_exp_f32 v234, v234
    v_mfma_f32_16x16x32_bf16 v[64:67], a[32:35], v[216:219], v[64:67]
    buffer_load_dwordx4 a[188:191], v3, s[4:7], s30 offen sc1
    v_mfma_f32_16x16x32_bf16 v[68:71], a[36:39], v[184:187], 0
    ds_read_b128 v[220:223], v1 offset:46080
    ds_read_b128 v[224:227], v1 offset:47104
    v_mfma_f32_16x16x32_bf16 v[68:71], a[40:43], v[188:191], v[68:71]
    ds_read_b128 v[228:231], v1 offset:48128
    v_mul_f32 v95, v93, v95
    v_mfma_f32_16x16x32_bf16 v[68:71], a[44:47], v[192:195], v[68:71]
    s_add_u32 s30, s24, 638976
    v_exp_f32 v235, v235
    v_mfma_f32_16x16x32_bf16 v[68:71], a[48:51], v[196:199], v[68:71]
    v_add_f32 v234, 1.0, v234
    v_add_f32 v235, 1.0, v235
    v_mfma_f32_16x16x32_bf16 v[68:71], a[52:55], v[200:203], v[68:71]
    buffer_load_dwordx4 a[192:195], v3, s[4:7], s30 offen sc1
    v_mfma_f32_16x16x32_bf16 v[68:71], a[56:59], v[204:207], v[68:71]
    v_rcp_f32 v234, v234
    v_mfma_f32_16x16x32_bf16 v[68:71], a[60:63], v[208:211], v[68:71]
    v_rcp_f32 v235, v235
    v_mfma_f32_16x16x32_bf16 v[68:71], a[64:67], v[212:215], v[68:71]
    ds_read_b128 a[232:235], v1 offset:49152
    ds_read_b128 a[236:239], v1 offset:50176
    v_mfma_f32_16x16x32_bf16 v[68:71], a[68:71], v[216:219], v[68:71]
    s_add_u32 s30, s24, 643072
    ds_read_b128 a[240:243], v1 offset:51200
    v_mul_f32 v234, v94, v234
    v_mfma_f32_16x16x32_bf16 v[72:75], a[72:75], v[184:187], 0
    ds_read_b128 a[244:247], v1 offset:52224
    ds_read_b128 a[248:251], v1 offset:53248
    v_mfma_f32_16x16x32_bf16 v[72:75], a[76:79], v[188:191], v[72:75]
    ds_read_b128 a[252:255], v1 offset:54272
    v_mul_f32 v235, v95, v235
    v_mfma_f32_16x16x32_bf16 v[72:75], a[80:83], v[192:195], v[72:75]
    buffer_load_dwordx4 a[196:199], v3, s[4:7], s30 offen sc1
    v_mfma_f32_16x16x32_bf16 v[72:75], a[84:87], v[196:199], v[72:75]
    v_cvt_pk_bf16_f32 v182, v234, v235
    v_mul_f32 v96, v96, v250
    v_mfma_f32_16x16x32_bf16 v[72:75], a[88:91], v[200:203], v[72:75]
    s_add_u32 s30, s24, 647168
    v_mul_f32 v97, v97, v250
    v_fma_f32 v236, -v96, v96, s29
    v_mfma_f32_16x16x32_bf16 v[72:75], a[92:95], v[204:207], v[72:75]
    v_fma_f32 v237, -v97, v97, s29
    v_mul_f32 v236, v236, v96
    v_mfma_f32_16x16x32_bf16 v[72:75], a[96:99], v[208:211], v[72:75]
    buffer_load_dwordx4 a[200:203], v3, s[4:7], s30 offen sc1
    v_mfma_f32_16x16x32_bf16 v[72:75], a[100:103], v[212:215], v[72:75]
    v_mul_f32 v237, v237, v97
    v_mul_f32 v98, v96, v98
    v_mfma_f32_16x16x32_bf16 v[72:75], a[104:107], v[216:219], v[72:75]
    s_waitcnt lgkmcnt(3)
    v_exp_f32 v236, v236
    v_mfma_f32_16x16x32_bf16 v[76:79], a[0:3], v[220:223], 0
    v_exp_f32 v237, v237
    v_mfma_f32_16x16x32_bf16 v[76:79], a[4:7], v[224:227], v[76:79]
    s_add_u32 s30, s24, 651264
    v_mul_f32 v99, v97, v99
    v_add_f32 v236, 1.0, v236
    v_mfma_f32_16x16x32_bf16 v[76:79], a[8:11], v[228:231], v[76:79]
    global_load_dword v255, v13, s[10:11]
    v_mfma_f32_16x16x32_bf16 v[76:79], a[12:15], a[232:235], v[76:79]
    buffer_load_dwordx4 a[204:207], v3, s[4:7], s30 offen sc1
    v_mfma_f32_16x16x32_bf16 v[76:79], a[16:19], a[236:239], v[76:79]
    v_add_f32 v237, 1.0, v237
    v_mul_f32 v100, v100, v251
    v_mfma_f32_16x16x32_bf16 v[76:79], a[20:23], a[240:243], v[76:79]
    s_waitcnt lgkmcnt(0)
    v_rcp_f32 v236, v236
    v_mfma_f32_16x16x32_bf16 v[76:79], a[24:27], a[244:247], v[76:79]
    s_add_u32 s30, s24, 655360
    v_rcp_f32 v237, v237
    v_mfma_f32_16x16x32_bf16 v[76:79], a[28:31], a[248:251], v[76:79]
    v_mul_f32 v236, v98, v236
    v_mul_f32 v237, v99, v237
    v_mfma_f32_16x16x32_bf16 v[76:79], a[32:35], a[252:255], v[76:79]
    v_cvt_pk_bf16_f32 v168, v236, v237
    v_mul_f32 v101, v101, v251
    v_mfma_f32_16x16x32_bf16 v[80:83], a[36:39], v[220:223], 0
    ds_read_b128 v[184:187], v1 offset:55296
    ds_read_b128 v[188:191], v1 offset:56320
    v_mfma_f32_16x16x32_bf16 v[80:83], a[40:43], v[224:227], v[80:83]
    ds_read_b128 v[192:195], v1 offset:57344
    v_fma_f32 v238, -v100, v100, s29
    v_mfma_f32_16x16x32_bf16 v[80:83], a[44:47], v[228:231], v[80:83]
    s_waitcnt vmcnt(13)
    v_readfirstlane_b32 s27, v254
    s_nop 0
    s_cmp_ge_u32 s27, 18
    s_cbranch_scc0 ffn0_part_wdw
ffn0_part_wdb:
    v_mfma_f32_16x16x32_bf16 v[80:83], a[48:51], a[232:235], v[80:83]
    s_mul_i32 s35, s22, 6
    v_bfe_u32 v2, v0, 3, 3
    v_fma_f32 v239, -v101, v101, s29
    v_mfma_f32_16x16x32_bf16 v[80:83], a[52:55], a[236:239], v[80:83]
    s_min_u32 s35, s35, 84
    v_min_u32 v2, 5, v2
    v_mul_f32 v238, v238, v100
    v_mfma_f32_16x16x32_bf16 v[80:83], a[56:59], a[240:243], v[80:83]
    s_lshl_b32 s35, s35, 12
    v_lshlrev_b32 v2, 5, v2
    v_mul_f32 v239, v239, v101
    v_mfma_f32_16x16x32_bf16 v[80:83], a[60:63], a[244:247], v[80:83]
    s_add_u32 s35, s35, s24
    v_and_or_b32 v2, v0, 7, v2
    v_mul_f32 v102, v100, v102
    v_mfma_f32_16x16x32_bf16 v[80:83], a[64:67], a[248:251], v[80:83]
    s_add_u32 s35, s35, s26
    ds_read_b128 v[196:199], v1 offset:58368
    ds_read_b128 v[200:203], v1 offset:59392
    v_mfma_f32_16x16x32_bf16 v[80:83], a[68:71], a[252:255], v[80:83]
    s_add_u32 s35, s35, 663552
    ds_read_b128 v[204:207], v1 offset:60416
    v_lshlrev_b32 v2, 7, v2
    v_mfma_f32_16x16x32_bf16 v[84:87], a[72:75], v[220:223], 0
    ds_read_b128 v[208:211], v1 offset:61440
    ds_read_b128 v[212:215], v1 offset:62464
    v_mfma_f32_16x16x32_bf16 v[84:87], a[76:79], v[224:227], v[84:87]
    ds_read_b128 v[216:219], v1 offset:63488
    v_mul_f32 v103, v101, v103
    v_mfma_f32_16x16x32_bf16 v[84:87], a[80:83], v[228:231], v[84:87]
    buffer_load_dwordx4 a[208:211], v3, s[4:7], s30 offen sc1
    v_mfma_f32_16x16x32_bf16 v[84:87], a[84:87], a[232:235], v[84:87]
    v_exp_f32 v238, v238
    v_mfma_f32_16x16x32_bf16 v[84:87], a[88:91], a[236:239], v[84:87]
    s_add_u32 s30, s24, 659456
    v_exp_f32 v239, v239
    v_mfma_f32_16x16x32_bf16 v[84:87], a[92:95], a[240:243], v[84:87]
    v_add_f32 v238, 1.0, v238
    v_add_f32 v239, 1.0, v239
    v_mfma_f32_16x16x32_bf16 v[84:87], a[96:99], a[244:247], v[84:87]
    buffer_load_dwordx4 a[212:215], v3, s[4:7], s30 offen sc1
    v_mfma_f32_16x16x32_bf16 v[84:87], a[100:103], a[248:251], v[84:87]
    buffer_load_dword v255, v2, s[4:7], s35 offen sc1
    v_mfma_f32_16x16x32_bf16 v[84:87], a[104:107], a[252:255], v[84:87]
    s_waitcnt lgkmcnt(3)
    v_rcp_f32 v238, v238
    v_mfma_f32_16x16x32_bf16 v[88:91], a[0:3], v[184:187], 0
    s_add_u32 s30, s24, 765952
    v_rcp_f32 v239, v239
    v_mfma_f32_16x16x32_bf16 v[88:91], a[4:7], v[188:191], v[88:91]
    v_mul_f32 v238, v102, v238
    v_mul_f32 v239, v103, v239
    v_mfma_f32_16x16x32_bf16 v[88:91], a[8:11], v[192:195], v[88:91]
    buffer_load_dwordx4 a[216:219], v3, s[4:7], s30 offen sc1
    v_mfma_f32_16x16x32_bf16 v[88:91], a[12:15], v[196:199], v[88:91]
    v_cvt_pk_bf16_f32 v143, v238, v239
    v_mul_f32 v104, v104, v251
    v_mfma_f32_16x16x32_bf16 v[88:91], a[16:19], v[200:203], v[88:91]
    v_mul_f32 v105, v105, v251
    v_fma_f32 v240, -v104, v104, s29
    v_mfma_f32_16x16x32_bf16 v[88:91], a[20:23], v[204:207], v[88:91]
    s_waitcnt lgkmcnt(0)
    v_fma_f32 v241, -v105, v105, s29
    v_mul_f32 v240, v240, v104
    v_mfma_f32_16x16x32_bf16 v[88:91], a[24:27], v[208:211], v[88:91]
    s_add_u32 s30, s24, 770048
    v_mul_f32 v241, v241, v105
    v_mul_f32 v106, v104, v106
    v_mfma_f32_16x16x32_bf16 v[88:91], a[28:31], v[212:215], v[88:91]
    buffer_load_dwordx4 a[220:223], v3, s[4:7], s30 offen sc1
    v_mfma_f32_16x16x32_bf16 v[88:91], a[32:35], v[216:219], v[88:91]
    v_exp_f32 v240, v240
    v_mfma_f32_16x16x32_bf16 v[92:95], a[36:39], v[184:187], 0
    s_add_u32 s30, s24, 774144
    ds_read_b128 v[220:223], v1 offset:64512
    ds_read_b128 v[224:227], v4 offset:0
    v_mfma_f32_16x16x32_bf16 v[92:95], a[40:43], v[188:191], v[92:95]
    ds_read_b128 v[228:231], v4 offset:1024
    v_mul_f32 v107, v105, v107
    v_mfma_f32_16x16x32_bf16 v[92:95], a[44:47], v[192:195], v[92:95]
    buffer_load_dwordx4 a[224:227], v3, s[4:7], s30 offen sc1
    v_mfma_f32_16x16x32_bf16 v[92:95], a[48:51], v[196:199], v[92:95]
    v_exp_f32 v241, v241
    v_mfma_f32_16x16x32_bf16 v[92:95], a[52:55], v[200:203], v[92:95]
    buffer_store_dwordx4 v[136:139], v3, s[4:7], s63 offen sc1
    v_mfma_f32_16x16x32_bf16 v[92:95], a[56:59], v[204:207], v[92:95]
    s_add_u32 s30, s24, 778240
    v_add_f32 v240, 1.0, v240
    v_add_f32 v241, 1.0, v241
    v_mfma_f32_16x16x32_bf16 v[92:95], a[60:63], v[208:211], v[92:95]
    v_rcp_f32 v240, v240
    v_mfma_f32_16x16x32_bf16 v[92:95], a[64:67], v[212:215], v[92:95]
    ds_read_b128 a[232:235], v4 offset:2048
    ds_read_b128 a[236:239], v4 offset:3072
    v_mfma_f32_16x16x32_bf16 v[92:95], a[68:71], v[216:219], v[92:95]
    ds_read_b128 a[240:243], v4 offset:4096
    v_mul_f32 v240, v106, v240
    v_mfma_f32_16x16x32_bf16 v[96:99], a[72:75], v[184:187], 0
    ds_read_b128 a[244:247], v4 offset:5120
    ds_read_b128 a[248:251], v4 offset:6144
    v_mfma_f32_16x16x32_bf16 v[96:99], a[76:79], v[188:191], v[96:99]
    ds_read_b128 a[252:255], v4 offset:7168
    v_mul_f32 v108, v108, v251
    v_mfma_f32_16x16x32_bf16 v[96:99], a[80:83], v[192:195], v[96:99]
    buffer_load_dwordx4 a[228:231], v3, s[4:7], s30 offen sc1
    v_mfma_f32_16x16x32_bf16 v[96:99], a[84:87], v[196:199], v[96:99]
    v_rcp_f32 v241, v241
    v_mfma_f32_16x16x32_bf16 v[96:99], a[88:91], v[200:203], v[96:99]
    v_mul_f32 v241, v107, v241
    v_mul_f32 v109, v109, v251
    v_mfma_f32_16x16x32_bf16 v[96:99], a[92:95], v[204:207], v[96:99]
    v_cvt_pk_bf16_f32 v183, v240, v241
    v_fma_f32 v242, -v108, v108, s29
    v_mfma_f32_16x16x32_bf16 v[96:99], a[96:99], v[208:211], v[96:99]
    v_fma_f32 v243, -v109, v109, s29
    v_mul_f32 v242, v242, v108
    v_mfma_f32_16x16x32_bf16 v[96:99], a[100:103], v[212:215], v[96:99]
    v_mul_f32 v243, v243, v109
    v_mul_f32 v110, v108, v110
    v_mfma_f32_16x16x32_bf16 v[96:99], a[104:107], v[216:219], v[96:99]
    s_waitcnt lgkmcnt(3)
    v_exp_f32 v242, v242
    v_mfma_f32_16x16x32_bf16 v[100:103], a[0:3], v[220:223], 0
    v_exp_f32 v243, v243
    v_mfma_f32_16x16x32_bf16 v[100:103], a[4:7], v[224:227], v[100:103]
    v_mul_f32 v111, v109, v111
    v_add_f32 v242, 1.0, v242
    v_mfma_f32_16x16x32_bf16 v[100:103], a[8:11], v[228:231], v[100:103]
    v_add_f32 v243, 1.0, v243
    v_mfma_f32_16x16x32_bf16 v[100:103], a[12:15], a[232:235], v[100:103]
    v_rcp_f32 v242, v242
    v_mfma_f32_16x16x32_bf16 v[100:103], a[16:19], a[236:239], v[100:103]
    v_rcp_f32 v243, v243
    v_mfma_f32_16x16x32_bf16 v[100:103], a[20:23], a[240:243], v[100:103]
    s_waitcnt lgkmcnt(0)
    v_mul_f32 v242, v110, v242
    v_mul_f32 v243, v111, v243
    v_mfma_f32_16x16x32_bf16 v[100:103], a[24:27], a[244:247], v[100:103]
    v_cvt_pk_bf16_f32 v172, v242, v243
    v_mfma_f32_16x16x32_bf16 v[100:103], a[28:31], a[248:251], v[100:103]
    buffer_store_dwordx4 v[140:143], v3, s[4:7], s23 offen sc1
    v_mfma_f32_16x16x32_bf16 v[100:103], a[32:35], a[252:255], v[100:103]
    v_mfma_f32_16x16x32_bf16 v[104:107], a[36:39], v[220:223], 0
    ds_read_b128 v[184:187], v4 offset:8192
    ds_read_b128 v[188:191], v4 offset:9216
    v_mfma_f32_16x16x32_bf16 v[104:107], a[40:43], v[224:227], v[104:107]
    ds_read_b128 v[192:195], v4 offset:10240
    v_mfma_f32_16x16x32_bf16 v[104:107], a[44:47], v[228:231], v[104:107]
    v_mfma_f32_16x16x32_bf16 v[104:107], a[48:51], a[232:235], v[104:107]
    v_mfma_f32_16x16x32_bf16 v[104:107], a[52:55], a[236:239], v[104:107]
    v_mfma_f32_16x16x32_bf16 v[104:107], a[56:59], a[240:243], v[104:107]
    v_mfma_f32_16x16x32_bf16 v[104:107], a[60:63], a[244:247], v[104:107]
    v_mfma_f32_16x16x32_bf16 v[104:107], a[64:67], a[248:251], v[104:107]
    ds_read_b128 v[196:199], v4 offset:11264
    ds_read_b128 v[200:203], v4 offset:12288
    v_mfma_f32_16x16x32_bf16 v[104:107], a[68:71], a[252:255], v[104:107]
    ds_read_b128 v[204:207], v4 offset:13312
    v_mfma_f32_16x16x32_bf16 v[108:111], a[72:75], v[220:223], 0
    ds_read_b128 v[208:211], v4 offset:14336
    ds_read_b128 v[212:215], v4 offset:15360
    v_mfma_f32_16x16x32_bf16 v[108:111], a[76:79], v[224:227], v[108:111]
    ds_read_b128 v[216:219], v4 offset:16384
    v_mfma_f32_16x16x32_bf16 v[108:111], a[80:83], v[228:231], v[108:111]
    v_mfma_f32_16x16x32_bf16 v[108:111], a[84:87], a[232:235], v[108:111]
    v_mfma_f32_16x16x32_bf16 v[108:111], a[88:91], a[236:239], v[108:111]
    v_mfma_f32_16x16x32_bf16 v[108:111], a[92:95], a[240:243], v[108:111]
    v_mfma_f32_16x16x32_bf16 v[108:111], a[96:99], a[244:247], v[108:111]
    v_mfma_f32_16x16x32_bf16 v[108:111], a[100:103], a[248:251], v[108:111]
    s_add_u32 s30, s24, 663552
    v_mfma_f32_16x16x32_bf16 v[108:111], a[104:107], a[252:255], v[108:111]
    s_waitcnt lgkmcnt(3)
    v_mfma_f32_16x16x32_bf16 v[16:19], a[108:111], v[184:187], v[16:19]
    buffer_load_dwordx4 a[0:3], v3, s[4:7], s30 offen sc1
    v_mfma_f32_16x16x32_bf16 v[16:19], a[112:115], v[188:191], v[16:19]
    s_add_u32 s30, s24, 667648
    v_mfma_f32_16x16x32_bf16 v[16:19], a[116:119], v[192:195], v[16:19]
    buffer_load_dwordx4 a[4:7], v3, s[4:7], s30 offen sc1
    v_mfma_f32_16x16x32_bf16 v[16:19], a[120:123], v[196:199], v[16:19]
    s_barrier
    v_mfma_f32_16x16x32_bf16 v[16:19], a[124:127], v[200:203], v[16:19]
    ds_write_b32 v8, v176 offset:0
    v_mfma_f32_16x16x32_bf16 v[16:19], a[128:131], v[204:207], v[16:19]
    s_waitcnt lgkmcnt(1)
    ds_write_b128 v3, v[112:115] offset:0
    v_mfma_f32_16x16x32_bf16 v[16:19], a[132:135], v[208:211], v[16:19]
    s_add_u32 s30, s24, 671744
    v_mfma_f32_16x16x32_bf16 v[16:19], a[136:139], v[212:215], v[16:19]
    buffer_load_dwordx4 a[8:11], v3, s[4:7], s30 offen sc1
    v_mfma_f32_16x16x32_bf16 v[16:19], a[140:143], v[216:219], v[16:19]
    s_waitcnt vmcnt(20)
    v_mfma_f32_16x16x32_bf16 v[20:23], a[144:147], v[184:187], v[20:23]
    s_add_u32 s30, s24, 675840
    ds_read_b128 v[220:223], v4 offset:17408
    ds_read_b128 v[224:227], v4 offset:18432
    v_mfma_f32_16x16x32_bf16 v[20:23], a[148:151], v[188:191], v[20:23]
    ds_read_b128 v[228:231], v4 offset:19456
    v_mfma_f32_16x16x32_bf16 v[20:23], a[152:155], v[192:195], v[20:23]
    buffer_load_dwordx4 a[12:15], v3, s[4:7], s30 offen sc1
    v_mfma_f32_16x16x32_bf16 v[20:23], a[156:159], v[196:199], v[20:23]
    ds_write_b32 v8, v177 offset:9216
    v_mfma_f32_16x16x32_bf16 v[20:23], a[160:163], v[200:203], v[20:23]
    ds_write_b128 v3, v[116:119] offset:9216
    v_mfma_f32_16x16x32_bf16 v[20:23], a[164:167], v[204:207], v[20:23]
    s_add_u32 s30, s24, 679936
    v_mul_f32 v16, v16, v244
    v_mul_f32 v17, v17, v244
    v_mfma_f32_16x16x32_bf16 v[20:23], a[168:171], v[208:211], v[20:23]
    v_fma_f32 v232, -v16, v16, s29
    v_fma_f32 v233, -v17, v17, s29
    v_mfma_f32_16x16x32_bf16 v[20:23], a[172:175], v[212:215], v[20:23]
    buffer_load_dwordx4 a[16:19], v3, s[4:7], s30 offen sc1
    v_mfma_f32_16x16x32_bf16 v[20:23], a[176:179], v[216:219], v[20:23]
    s_waitcnt vmcnt(12)
    v_mul_f32 v232, v232, v16
    v_mul_f32 v233, v233, v17
    v_mfma_f32_16x16x32_bf16 v[24:27], a[180:183], v[184:187], v[24:27]
    s_add_u32 s30, s24, 684032
    v_exp_f32 v232, v232
    v_mfma_f32_16x16x32_bf16 v[24:27], a[184:187], v[188:191], v[24:27]
    ds_read_b128 v[184:187], v4 offset:20480
    v_mul_f32 v18, v16, v18
    v_mfma_f32_16x16x32_bf16 v[24:27], a[188:191], v[192:195], v[24:27]
    ds_read_b128 v[188:191], v4 offset:21504
    v_mul_f32 v19, v17, v19
    v_mfma_f32_16x16x32_bf16 v[24:27], a[192:195], v[196:199], v[24:27]
    ds_read_b128 v[192:195], v4 offset:22528
    v_add_f32 v232, 1.0, v232
    v_mfma_f32_16x16x32_bf16 v[24:27], a[196:199], v[200:203], v[24:27]
    ds_read_b128 v[196:199], v4 offset:23552
    v_mul_f32 v20, v20, v244
    v_mfma_f32_16x16x32_bf16 v[24:27], a[200:203], v[204:207], v[24:27]
    ds_read_b128 v[200:203], v4 offset:24576
    v_mul_f32 v21, v21, v244
    v_mfma_f32_16x16x32_bf16 v[24:27], a[204:207], v[208:211], v[24:27]
    ds_read_b128 v[204:207], v4 offset:25600
    v_fma_f32 v234, -v20, v20, s29
    v_mfma_f32_16x16x32_bf16 v[24:27], a[208:211], v[212:215], v[24:27]
    buffer_load_dwordx4 a[20:23], v3, s[4:7], s30 offen sc1
    v_mfma_f32_16x16x32_bf16 v[24:27], a[212:215], v[216:219], v[24:27]
    s_waitcnt lgkmcnt(8)
    ds_write_b32 v8, v178 offset:18432
    v_mfma_f32_16x16x32_bf16 v[28:31], a[108:111], v[220:223], v[28:31]
    s_add_u32 s30, s24, 688128
    ds_write_b128 v3, v[120:123] offset:18432
    v_mfma_f32_16x16x32_bf16 v[28:31], a[112:115], v[224:227], v[28:31]
    buffer_load_dwordx4 a[24:27], v3, s[4:7], s30 offen sc1
    v_mfma_f32_16x16x32_bf16 v[28:31], a[116:119], v[228:231], v[28:31]
    s_waitcnt lgkmcnt(6)
    v_exp_f32 v233, v233
    v_mfma_f32_16x16x32_bf16 v[28:31], a[120:123], v[184:187], v[28:31]
    s_add_u32 s30, s24, 692224
    v_add_f32 v233, 1.0, v233
    v_fma_f32 v235, -v21, v21, s29
    v_mfma_f32_16x16x32_bf16 v[28:31], a[124:127], v[188:191], v[28:31]
    s_waitcnt lgkmcnt(4)
    v_rcp_f32 v232, v232
    v_mul_f32 v234, v234, v20
    v_mfma_f32_16x16x32_bf16 v[28:31], a[128:131], v[192:195], v[28:31]
    buffer_load_dwordx4 a[28:31], v3, s[4:7], s30 offen sc1
    v_mfma_f32_16x16x32_bf16 v[28:31], a[132:135], v[196:199], v[28:31]
    s_waitcnt lgkmcnt(2)
    ds_write_b32 v8, v179 offset:27648
    v_mfma_f32_16x16x32_bf16 v[28:31], a[136:139], v[200:203], v[28:31]
    s_add_u32 s30, s24, 696320
    v_rcp_f32 v233, v233
    v_mfma_f32_16x16x32_bf16 v[28:31], a[140:143], v[204:207], v[28:31]
    v_mul_f32 v232, v18, v232
    v_mul_f32 v233, v19, v233
    v_mfma_f32_16x16x32_bf16 v[32:35], a[144:147], v[220:223], v[32:35]
    ds_read_b128 v[208:211], v4 offset:26624
    ds_read_b128 v[212:215], v4 offset:27648
    v_mfma_f32_16x16x32_bf16 v[32:35], a[148:151], v[224:227], v[32:35]
    ds_read_b128 v[216:219], v4 offset:28672
    v_cvt_pk_bf16_f32 v145, v232, v233
    v_mfma_f32_16x16x32_bf16 v[32:35], a[152:155], v[228:231], v[32:35]
    buffer_load_dwordx4 a[32:35], v3, s[4:7], s30 offen sc1
    v_mul_f32 v235, v235, v21
    v_mfma_f32_16x16x32_bf16 v[32:35], a[156:159], v[184:187], v[32:35]
    s_add_u32 s30, s24, 700416
    ds_write_b128 v3, v[124:127] offset:27648
    v_mfma_f32_16x16x32_bf16 v[32:35], a[160:163], v[188:191], v[32:35]
    v_exp_f32 v234, v234
    v_mfma_f32_16x16x32_bf16 v[32:35], a[164:167], v[192:195], v[32:35]
    buffer_load_dwordx4 a[36:39], v3, s[4:7], s30 offen sc1
    v_mfma_f32_16x16x32_bf16 v[32:35], a[168:171], v[196:199], v[32:35]
    v_exp_f32 v235, v235
    v_mfma_f32_16x16x32_bf16 v[32:35], a[172:175], v[200:203], v[32:35]
    s_add_u32 s30, s24, 704512
    v_mul_f32 v22, v20, v22
    v_mul_f32 v23, v21, v23
    v_mfma_f32_16x16x32_bf16 v[32:35], a[176:179], v[204:207], v[32:35]
    v_add_f32 v234, 1.0, v234
    v_add_f32 v235, 1.0, v235
    v_mfma_f32_16x16x32_bf16 v[36:39], a[180:183], v[220:223], v[36:39]
    buffer_load_dwordx4 a[40:43], v3, s[4:7], s30 offen sc1
    v_mul_f32 v24, v24, v244
    v_mfma_f32_16x16x32_bf16 v[36:39], a[184:187], v[224:227], v[36:39]
    ds_read_b128 v[220:223], v4 offset:29696
    v_mul_f32 v25, v25, v244
    v_mfma_f32_16x16x32_bf16 v[36:39], a[188:191], v[228:231], v[36:39]
    s_add_u32 s30, s24, 708608
    ds_read_b128 v[224:227], v4 offset:30720
    v_fma_f32 v236, -v24, v24, s29
    v_mfma_f32_16x16x32_bf16 v[36:39], a[192:195], v[184:187], v[36:39]
    ds_read_b128 v[228:231], v4 offset:31744
    v_fma_f32 v237, -v25, v25, s29
    v_mfma_f32_16x16x32_bf16 v[36:39], a[196:199], v[188:191], v[36:39]
    ds_read_b128 v[184:187], v4 offset:32768
    v_mul_f32 v236, v236, v24
    v_mfma_f32_16x16x32_bf16 v[36:39], a[200:203], v[192:195], v[36:39]
    ds_read_b128 v[188:191], v4 offset:33792
    v_mul_f32 v237, v237, v25
    v_mfma_f32_16x16x32_bf16 v[36:39], a[204:207], v[196:199], v[36:39]
    ds_read_b128 v[192:195], v4 offset:34816
    v_mul_f32 v26, v24, v26
    v_mfma_f32_16x16x32_bf16 v[36:39], a[208:211], v[200:203], v[36:39]
    buffer_load_dwordx4 a[44:47], v3, s[4:7], s30 offen sc1
    v_mul_f32 v27, v25, v27
    v_mfma_f32_16x16x32_bf16 v[36:39], a[212:215], v[204:207], v[36:39]
    s_waitcnt lgkmcnt(7)
    ds_write_b32 v8, v180 offset:36864
    v_mfma_f32_16x16x32_bf16 v[40:43], a[108:111], v[208:211], v[40:43]
    s_add_u32 s30, s24, 712704
    ds_write_b128 v3, v[128:131] offset:36864
    v_mfma_f32_16x16x32_bf16 v[40:43], a[112:115], v[212:215], v[40:43]
    buffer_load_dwordx4 a[48:51], v3, s[4:7], s30 offen sc1
    v_mfma_f32_16x16x32_bf16 v[40:43], a[116:119], v[216:219], v[40:43]
    s_waitcnt lgkmcnt(6)
    v_rcp_f32 v234, v234
    v_mfma_f32_16x16x32_bf16 v[40:43], a[120:123], v[220:223], v[40:43]
    s_add_u32 s30, s24, 716800
    v_rcp_f32 v235, v235
    v_mfma_f32_16x16x32_bf16 v[40:43], a[124:127], v[224:227], v[40:43]
    s_waitcnt lgkmcnt(4)
    v_mul_f32 v234, v22, v234
    v_mul_f32 v235, v23, v235
    v_mfma_f32_16x16x32_bf16 v[40:43], a[128:131], v[228:231], v[40:43]
    buffer_load_dwordx4 a[52:55], v3, s[4:7], s30 offen sc1
    v_cvt_pk_bf16_f32 v146, v234, v235
    v_mfma_f32_16x16x32_bf16 v[40:43], a[132:135], v[184:187], v[40:43]
    s_waitcnt lgkmcnt(2)
    ds_write_b32 v8, v181 offset:46080
    v_mfma_f32_16x16x32_bf16 v[40:43], a[136:139], v[188:191], v[40:43]
    s_add_u32 s30, s24, 720896
    v_exp_f32 v236, v236
    v_mfma_f32_16x16x32_bf16 v[40:43], a[140:143], v[192:195], v[40:43]
    v_exp_f32 v237, v237
    v_mfma_f32_16x16x32_bf16 v[44:47], a[144:147], v[208:211], v[44:47]
    ds_read_b128 v[196:199], v4 offset:35840
    ds_read_b128 v[200:203], v4 offset:36864
    v_mfma_f32_16x16x32_bf16 v[44:47], a[148:151], v[212:215], v[44:47]
    ds_read_b128 v[204:207], v4 offset:37888
    v_add_f32 v236, 1.0, v236
    v_mfma_f32_16x16x32_bf16 v[44:47], a[152:155], v[216:219], v[44:47]
    buffer_load_dwordx4 a[56:59], v3, s[4:7], s30 offen sc1
    v_mfma_f32_16x16x32_bf16 v[44:47], a[156:159], v[220:223], v[44:47]
    s_add_u32 s30, s24, 724992
    ds_write_b128 v3, v[132:135] offset:46080
    v_add_f32 v237, 1.0, v237
    v_mfma_f32_16x16x32_bf16 v[44:47], a[160:163], v[224:227], v[44:47]
    v_rcp_f32 v236, v236
    v_mfma_f32_16x16x32_bf16 v[44:47], a[164:167], v[228:231], v[44:47]
    buffer_load_dwordx4 a[60:63], v3, s[4:7], s30 offen sc1
    v_mfma_f32_16x16x32_bf16 v[44:47], a[168:171], v[184:187], v[44:47]
    v_rcp_f32 v237, v237
    v_mfma_f32_16x16x32_bf16 v[44:47], a[172:175], v[188:191], v[44:47]
    s_add_u32 s30, s24, 729088
    v_mul_f32 v236, v26, v236
    v_mul_f32 v237, v27, v237
    v_mfma_f32_16x16x32_bf16 v[44:47], a[176:179], v[192:195], v[44:47]
    v_cvt_pk_bf16_f32 v147, v236, v237
    v_mul_f32 v28, v28, v245
    v_mfma_f32_16x16x32_bf16 v[48:51], a[180:183], v[208:211], v[48:51]
    buffer_load_dwordx4 a[64:67], v3, s[4:7], s30 offen sc1
    v_mfma_f32_16x16x32_bf16 v[48:51], a[184:187], v[212:215], v[48:51]
    ds_read_b128 v[208:211], v4 offset:38912
    v_mul_f32 v29, v29, v245
    v_fma_f32 v238, -v28, v28, s29
    v_mfma_f32_16x16x32_bf16 v[48:51], a[188:191], v[216:219], v[48:51]
    s_add_u32 s30, s24, 733184
    ds_read_b128 v[212:215], v4 offset:39936
    v_fma_f32 v239, -v29, v29, s29
    v_mfma_f32_16x16x32_bf16 v[48:51], a[192:195], v[220:223], v[48:51]
    ds_read_b128 v[216:219], v4 offset:40960
    v_mul_f32 v238, v238, v28
    v_mfma_f32_16x16x32_bf16 v[48:51], a[196:199], v[224:227], v[48:51]
    ds_read_b128 v[220:223], v4 offset:41984
    v_mul_f32 v239, v239, v29
    v_mfma_f32_16x16x32_bf16 v[48:51], a[200:203], v[228:231], v[48:51]
    ds_read_b128 v[224:227], v4 offset:43008
    v_mul_f32 v30, v28, v30
    v_mfma_f32_16x16x32_bf16 v[48:51], a[204:207], v[184:187], v[48:51]
    ds_read_b128 v[228:231], v4 offset:44032
    v_mul_f32 v31, v29, v31
    v_mfma_f32_16x16x32_bf16 v[48:51], a[208:211], v[188:191], v[48:51]
    ds_write_b32 v8, v182 offset:55296
    v_mfma_f32_16x16x32_bf16 v[48:51], a[212:215], v[192:195], v[48:51]
    s_waitcnt lgkmcnt(8)
    ds_write_b128 v3, v[136:139] offset:55296
    v_mul_f32 v32, v32, v245
    v_mfma_f32_16x16x32_bf16 v[52:55], a[108:111], v[196:199], v[52:55]
    buffer_load_dwordx4 a[68:71], v3, s[4:7], s30 offen sc1
    v_mfma_f32_16x16x32_bf16 v[52:55], a[112:115], v[200:203], v[52:55]
    s_add_u32 s30, s24, 737280
    ds_write_b128 v9, v[144:147] offset:0
    v_mfma_f32_16x16x32_bf16 v[52:55], a[116:119], v[204:207], v[52:55]
    s_waitcnt lgkmcnt(7)
    v_exp_f32 v238, v238
    v_mfma_f32_16x16x32_bf16 v[52:55], a[120:123], v[208:211], v[52:55]
    buffer_load_dwordx4 a[72:75], v3, s[4:7], s30 offen sc1
    v_mfma_f32_16x16x32_bf16 v[52:55], a[124:127], v[212:215], v[52:55]
    s_waitcnt lgkmcnt(5)
    v_exp_f32 v239, v239
    v_mfma_f32_16x16x32_bf16 v[52:55], a[128:131], v[216:219], v[52:55]
    s_add_u32 s30, s24, 741376
    ds_write_b32 v8, v183 offset:64512
    v_mfma_f32_16x16x32_bf16 v[52:55], a[132:135], v[220:223], v[52:55]
    s_waitcnt lgkmcnt(4)
    v_add_f32 v238, 1.0, v238
    v_add_f32 v239, 1.0, v239
    v_mul_f32 v33, v33, v245
    v_mfma_f32_16x16x32_bf16 v[52:55], a[136:139], v[224:227], v[52:55]
    buffer_load_dwordx4 a[76:79], v3, s[4:7], s30 offen sc1
    v_mfma_f32_16x16x32_bf16 v[52:55], a[140:143], v[228:231], v[52:55]
    v_rcp_f32 v238, v238
    v_mfma_f32_16x16x32_bf16 v[56:59], a[144:147], v[196:199], v[56:59]
    s_add_u32 s30, s24, 745472
    ds_read_b128 v[184:187], v4 offset:45056
    ds_read_b128 v[188:191], v4 offset:46080
    v_mfma_f32_16x16x32_bf16 v[56:59], a[148:151], v[200:203], v[56:59]
    ds_read_b128 v[192:195], v4 offset:47104
    v_mul_f32 v238, v30, v238
    v_mfma_f32_16x16x32_bf16 v[56:59], a[152:155], v[204:207], v[56:59]
    buffer_load_dwordx4 a[80:83], v3, s[4:7], s30 offen sc1
    v_mfma_f32_16x16x32_bf16 v[56:59], a[156:159], v[208:211], v[56:59]
    ds_write_b128 v3, v[140:143] offset:64512
    v_mfma_f32_16x16x32_bf16 v[56:59], a[160:163], v[212:215], v[56:59]
    v_rcp_f32 v239, v239
    v_fma_f32 v240, -v32, v32, s29
    v_mfma_f32_16x16x32_bf16 v[56:59], a[164:167], v[216:219], v[56:59]
    s_add_u32 s30, s24, 749568
    v_mul_f32 v239, v31, v239
    v_fma_f32 v241, -v33, v33, s29
    v_mfma_f32_16x16x32_bf16 v[56:59], a[168:171], v[220:223], v[56:59]
    v_cvt_pk_bf16_f32 v149, v238, v239
    v_mul_f32 v240, v240, v32
    v_mfma_f32_16x16x32_bf16 v[56:59], a[172:175], v[224:227], v[56:59]
    buffer_load_dwordx4 a[84:87], v3, s[4:7], s30 offen sc1
    v_mfma_f32_16x16x32_bf16 v[56:59], a[176:179], v[228:231], v[56:59]
    v_mul_f32 v241, v241, v33
    v_mul_f32 v34, v32, v34
    v_mfma_f32_16x16x32_bf16 v[60:63], a[180:183], v[196:199], v[60:63]
    s_add_u32 s30, s24, 753664
    v_exp_f32 v240, v240
    v_mfma_f32_16x16x32_bf16 v[60:63], a[184:187], v[200:203], v[60:63]
    ds_read_b128 v[196:199], v4 offset:48128
    v_mul_f32 v35, v33, v35
    v_mfma_f32_16x16x32_bf16 v[60:63], a[188:191], v[204:207], v[60:63]
    ds_read_b128 v[200:203], v4 offset:49152
    buffer_store_dwordx4 v[144:147], v9, s[4:7], s52 offen sc1
    v_mfma_f32_16x16x32_bf16 v[60:63], a[192:195], v[208:211], v[60:63]
    s_waitcnt lgkmcnt(2)
    ds_read_b128 v[204:207], v4 offset:50176
    v_add_f32 v240, 1.0, v240
    v_mfma_f32_16x16x32_bf16 v[60:63], a[196:199], v[212:215], v[60:63]
    s_barrier
    ds_read_b128 v[208:211], v4 offset:51200
    ds_read_b128 v[176:179], v253 offset:0
    v_mfma_f32_16x16x32_bf16 v[60:63], a[200:203], v[216:219], v[60:63]
    ds_read_b128 v[212:215], v4 offset:52224
    ds_read_b128 v[180:183], v253 offset:36864
    v_mfma_f32_16x16x32_bf16 v[60:63], a[204:207], v[220:223], v[60:63]
    ds_read_b128 v[216:219], v4 offset:53248
    v_mul_f32 v36, v36, v245
    v_mfma_f32_16x16x32_bf16 v[60:63], a[208:211], v[224:227], v[60:63]
    buffer_load_dwordx4 a[88:91], v3, s[4:7], s30 offen sc1
    v_mfma_f32_16x16x32_bf16 v[60:63], a[212:215], v[228:231], v[60:63]
    v_exp_f32 v241, v241
    v_mfma_f32_16x16x32_bf16 v[64:67], a[108:111], v[184:187], v[64:67]
    s_add_u32 s30, s24, 757760
    v_add_f32 v241, 1.0, v241
    v_rcp_f32 v240, v240
    v_mfma_f32_16x16x32_bf16 v[64:67], a[112:115], v[188:191], v[64:67]
    buffer_load_dwordx4 a[92:95], v3, s[4:7], s30 offen sc1
    v_mfma_f32_16x16x32_bf16 v[64:67], a[116:119], v[192:195], v[64:67]
    s_waitcnt lgkmcnt(6)
    v_rcp_f32 v241, v241
    v_mfma_f32_16x16x32_bf16 v[64:67], a[120:123], v[196:199], v[64:67]
    s_add_u32 s30, s24, 761856
    v_mul_f32 v240, v34, v240
    v_mul_f32 v241, v35, v241
    v_mfma_f32_16x16x32_bf16 v[64:67], a[124:127], v[200:203], v[64:67]
    s_waitcnt lgkmcnt(4)
    v_cvt_pk_bf16_f32 v150, v240, v241
    v_mul_f32 v37, v37, v245
    v_mfma_f32_16x16x32_bf16 v[64:67], a[128:131], v[204:207], v[64:67]
    buffer_load_dwordx4 a[96:99], v3, s[4:7], s30 offen sc1
    v_mfma_f32_16x16x32_bf16 v[64:67], a[132:135], v[208:211], v[64:67]
    s_waitcnt lgkmcnt(0)
    v_fma_f32 v242, -v36, v36, s29
    v_fma_f32 v243, -v37, v37, s29
    v_mfma_f32_16x16x32_bf16 v[64:67], a[136:139], v[212:215], v[64:67]
    s_add_u32 s30, s24, 782336
    v_mul_f32 v242, v242, v36
    v_mul_f32 v243, v243, v37
    v_mul_f32 v38, v36, v38
    v_mfma_f32_16x16x32_bf16 v[64:67], a[140:143], v[216:219], v[64:67]
ffn0_part_pad0_7x:
    s_cbranch_execz ffn0_part_padret0
    s_add_u32 s35, s46, 0
    v_exp_f32 v242, v242
    v_mfma_f32_16x16x32_bf16 v[68:71], a[144:147], v[184:187], v[68:71]
    ds_read_b128 v[220:223], v4 offset:54272
    ds_read_b128 v[224:227], v4 offset:55296
    v_mfma_f32_16x16x32_bf16 v[68:71], a[148:151], v[188:191], v[68:71]
    ds_read_b128 v[228:231], v4 offset:56320
    v_mul_f32 v39, v37, v39
    v_mfma_f32_16x16x32_bf16 v[68:71], a[152:155], v[192:195], v[68:71]
    buffer_load_dwordx4 a[232:235], v3, s[4:7], s30 offen sc1
    v_mfma_f32_16x16x32_bf16 v[68:71], a[156:159], v[196:199], v[68:71]
    s_add_u32 s30, s24, 786432
    v_exp_f32 v243, v243
    v_mfma_f32_16x16x32_bf16 v[68:71], a[160:163], v[200:203], v[68:71]
    buffer_store_dwordx4 v[176:179], v253, s[4:7], s35 offen sc1
    v_mfma_f32_16x16x32_bf16 v[68:71], a[164:167], v[204:207], v[68:71]
    s_add_u32 s35, s46, 36864
    v_add_f32 v242, 1.0, v242
    v_add_f32 v243, 1.0, v243
    v_mul_f32 v40, v40, v246
    v_mfma_f32_16x16x32_bf16 v[68:71], a[168:171], v[208:211], v[68:71]
    v_rcp_f32 v242, v242
    v_mfma_f32_16x16x32_bf16 v[68:71], a[172:175], v[212:215], v[68:71]
    v_rcp_f32 v243, v243
    v_mfma_f32_16x16x32_bf16 v[68:71], a[176:179], v[216:219], v[68:71]
    buffer_store_dwordx4 v[180:183], v253, s[4:7], s35 offen sc1
    v_mfma_f32_16x16x32_bf16 v[72:75], a[180:183], v[184:187], v[72:75]
    v_mul_f32 v242, v38, v242
    v_mul_f32 v243, v39, v243
    v_mfma_f32_16x16x32_bf16 v[72:75], a[184:187], v[188:191], v[72:75]
    ds_read_b128 v[184:187], v4 offset:57344
    v_cvt_pk_bf16_f32 v151, v242, v243
    v_mfma_f32_16x16x32_bf16 v[72:75], a[188:191], v[192:195], v[72:75]
    ds_read_b128 v[188:191], v4 offset:58368
    v_mul_f32 v41, v41, v246
    v_mfma_f32_16x16x32_bf16 v[72:75], a[192:195], v[196:199], v[72:75]
    ds_read_b128 v[192:195], v4 offset:59392
    buffer_store_dwordx4 v[148:151], v9, s[4:7], s53 offen sc1
    v_mfma_f32_16x16x32_bf16 v[72:75], a[196:199], v[200:203], v[72:75]
    ds_read_b128 v[196:199], v4 offset:60416
    v_fma_f32 v232, -v40, v40, s29
    v_mfma_f32_16x16x32_bf16 v[72:75], a[200:203], v[204:207], v[72:75]
    ds_read_b128 v[200:203], v4 offset:61440
    v_fma_f32 v233, -v41, v41, s29
    v_mfma_f32_16x16x32_bf16 v[72:75], a[204:207], v[208:211], v[72:75]
    ds_read_b128 v[204:207], v4 offset:62464
    v_mul_f32 v232, v232, v40
    v_mfma_f32_16x16x32_bf16 v[72:75], a[208:211], v[212:215], v[72:75]
    buffer_load_dwordx4 a[236:239], v3, s[4:7], s30 offen sc1
    v_mfma_f32_16x16x32_bf16 v[72:75], a[212:215], v[216:219], v[72:75]
    s_waitcnt lgkmcnt(6)
    ds_write_b128 v9, v[148:151] offset:9216
    v_mfma_f32_16x16x32_bf16 v[76:79], a[108:111], v[220:223], v[76:79]
    s_add_u32 s30, s24, 790528
    v_mul_f32 v233, v233, v41
    v_mul_f32 v42, v40, v42
    v_mfma_f32_16x16x32_bf16 v[76:79], a[112:115], v[224:227], v[76:79]
    buffer_load_dwordx4 a[240:243], v3, s[4:7], s30 offen sc1
    v_mul_f32 v43, v41, v43
    v_mfma_f32_16x16x32_bf16 v[76:79], a[116:119], v[228:231], v[76:79]
    s_waitcnt lgkmcnt(5)
    v_exp_f32 v232, v232
    v_mfma_f32_16x16x32_bf16 v[76:79], a[120:123], v[184:187], v[76:79]
    s_add_u32 s30, s24, 794624
    v_exp_f32 v233, v233
    v_mfma_f32_16x16x32_bf16 v[76:79], a[124:127], v[188:191], v[76:79]
    s_waitcnt lgkmcnt(3)
    v_add_f32 v232, 1.0, v232
    v_add_f32 v233, 1.0, v233
    v_mfma_f32_16x16x32_bf16 v[76:79], a[128:131], v[192:195], v[76:79]
    buffer_load_dwordx4 a[244:247], v3, s[4:7], s30 offen sc1
    v_mfma_f32_16x16x32_bf16 v[76:79], a[132:135], v[196:199], v[76:79]
    s_waitcnt lgkmcnt(1)
    v_rcp_f32 v232, v232
    v_mfma_f32_16x16x32_bf16 v[76:79], a[136:139], v[200:203], v[76:79]
    s_add_u32 s30, s24, 798720
    v_rcp_f32 v233, v233
    v_mfma_f32_16x16x32_bf16 v[76:79], a[140:143], v[204:207], v[76:79]
    v_mul_f32 v232, v42, v232
    v_mul_f32 v233, v43, v233
    v_mul_f32 v44, v44, v246
    v_mfma_f32_16x16x32_bf16 v[80:83], a[144:147], v[220:223], v[80:83]
    ds_read_b128 v[208:211], v4 offset:63488
    ds_read_b128 v[212:215], v4 offset:64512
    v_mfma_f32_16x16x32_bf16 v[80:83], a[148:151], v[224:227], v[80:83]
    ds_read_b128 v[216:219], v5 offset:0
    v_cvt_pk_bf16_f32 v153, v232, v233
    v_mfma_f32_16x16x32_bf16 v[80:83], a[152:155], v[228:231], v[80:83]
    v_mul_f32 v45, v45, v246
    v_fma_f32 v234, -v44, v44, s29
    v_mfma_f32_16x16x32_bf16 v[80:83], a[156:159], v[184:187], v[80:83]
    v_fma_f32 v235, -v45, v45, s29
    v_mul_f32 v234, v234, v44
    v_mfma_f32_16x16x32_bf16 v[80:83], a[160:163], v[188:191], v[80:83]
    v_mul_f32 v235, v235, v45
    v_mul_f32 v46, v44, v46
    v_mfma_f32_16x16x32_bf16 v[80:83], a[164:167], v[192:195], v[80:83]
    v_exp_f32 v234, v234
    v_mfma_f32_16x16x32_bf16 v[80:83], a[168:171], v[196:199], v[80:83]
    v_exp_f32 v235, v235
    v_mul_f32 v47, v45, v47
    v_mfma_f32_16x16x32_bf16 v[80:83], a[172:175], v[200:203], v[80:83]
    buffer_load_dwordx4 a[248:251], v3, s[4:7], s30 offen sc1
    v_mfma_f32_16x16x32_bf16 v[80:83], a[176:179], v[204:207], v[80:83]
    s_add_u32 s30, s24, 802816
    v_add_f32 v234, 1.0, v234
    v_add_f32 v235, 1.0, v235
    v_mfma_f32_16x16x32_bf16 v[84:87], a[180:183], v[220:223], v[84:87]
    buffer_load_dwordx4 a[252:255], v3, s[4:7], s30 offen sc1
    v_mfma_f32_16x16x32_bf16 v[84:87], a[184:187], v[224:227], v[84:87]
    ds_read_b128 v[220:223], v5 offset:1024
    v_mul_f32 v48, v48, v246
    v_mfma_f32_16x16x32_bf16 v[84:87], a[188:191], v[228:231], v[84:87]
    ds_read_b128 v[224:227], v5 offset:2048
    v_mul_f32 v49, v49, v246
    v_mfma_f32_16x16x32_bf16 v[84:87], a[192:195], v[184:187], v[84:87]
    s_add_u32 s30, s24, 806912
    ds_read_b128 v[228:231], v5 offset:3072
    v_fma_f32 v236, -v48, v48, s29
    v_mfma_f32_16x16x32_bf16 v[84:87], a[196:199], v[188:191], v[84:87]
    ds_read_b128 v[184:187], v5 offset:4096
    v_rcp_f32 v234, v234
    v_mfma_f32_16x16x32_bf16 v[84:87], a[200:203], v[192:195], v[84:87]
    ds_read_b128 v[188:191], v5 offset:5120
    v_mul_f32 v234, v46, v234
    v_mfma_f32_16x16x32_bf16 v[84:87], a[204:207], v[196:199], v[84:87]
    ds_read_b128 v[192:195], v5 offset:6144
    v_fma_f32 v237, -v49, v49, s29
    v_mfma_f32_16x16x32_bf16 v[84:87], a[208:211], v[200:203], v[84:87]
    buffer_load_dwordx4 a[100:103], v3, s[4:7], s30 offen sc1
    v_mfma_f32_16x16x32_bf16 v[84:87], a[212:215], v[204:207], v[84:87]
    s_waitcnt lgkmcnt(6)
    v_rcp_f32 v235, v235
    v_mfma_f32_16x16x32_bf16 v[88:91], a[108:111], v[208:211], v[88:91]
    s_add_u32 s30, s24, 811008
    v_mul_f32 v235, v47, v235
    v_mul_f32 v236, v236, v48
    v_mfma_f32_16x16x32_bf16 v[88:91], a[112:115], v[212:215], v[88:91]
    buffer_load_dwordx4 a[104:107], v3, s[4:7], s30 offen sc1
    v_mfma_f32_16x16x32_bf16 v[88:91], a[116:119], v[216:219], v[88:91]
    s_waitcnt lgkmcnt(4)
    v_cvt_pk_bf16_f32 v154, v234, v235
    v_mul_f32 v237, v237, v49
    v_mul_f32 v50, v48, v50
    v_mfma_f32_16x16x32_bf16 v[88:91], a[120:123], v[220:223], v[88:91]
    s_waitcnt vmcnt(8)
    v_exp_f32 v236, v236
    v_mfma_f32_16x16x32_bf16 v[88:91], a[124:127], v[224:227], v[88:91]
    s_waitcnt lgkmcnt(2)
    v_exp_f32 v237, v237
    v_mfma_f32_16x16x32_bf16 v[88:91], a[128:131], v[228:231], v[88:91]
    v_mul_f32 v51, v49, v51
    v_add_f32 v236, 1.0, v236
    v_mfma_f32_16x16x32_bf16 v[88:91], a[132:135], v[184:187], v[88:91]
    s_waitcnt lgkmcnt(0)
    v_add_f32 v237, 1.0, v237
    v_mul_f32 v52, v52, v247
    v_mfma_f32_16x16x32_bf16 v[88:91], a[136:139], v[188:191], v[88:91]
    v_rcp_f32 v236, v236
    v_mfma_f32_16x16x32_bf16 v[88:91], a[140:143], v[192:195], v[88:91]
    v_rcp_f32 v237, v237
    v_mfma_f32_16x16x32_bf16 v[92:95], a[144:147], v[208:211], v[92:95]
    ds_read_b128 v[196:199], v5 offset:7168
    ds_read_b128 v[200:203], v5 offset:8192
    buffer_store_dword v252, off, s[4:7], s48 offset:0 sc1
    v_mul_f32 v236, v50, v236
    v_mfma_f32_16x16x32_bf16 v[92:95], a[148:151], v[212:215], v[92:95]
    ds_read_b128 v[204:207], v5 offset:9216
    v_mul_f32 v237, v51, v237
    v_mfma_f32_16x16x32_bf16 v[92:95], a[152:155], v[216:219], v[92:95]
    v_cvt_pk_bf16_f32 v155, v236, v237
    v_mul_f32 v53, v53, v247
    v_mfma_f32_16x16x32_bf16 v[92:95], a[156:159], v[220:223], v[92:95]
    buffer_store_dwordx4 v[152:155], v9, s[4:7], s54 offen sc1
    v_mfma_f32_16x16x32_bf16 v[92:95], a[160:163], v[224:227], v[92:95]
    ds_write_b128 v9, v[152:155] offset:18432
    v_mfma_f32_16x16x32_bf16 v[92:95], a[164:167], v[228:231], v[92:95]
    v_fma_f32 v238, -v52, v52, s29
    v_fma_f32 v239, -v53, v53, s29
    v_mfma_f32_16x16x32_bf16 v[92:95], a[168:171], v[184:187], v[92:95]
    v_mul_f32 v238, v238, v52
    v_mul_f32 v239, v239, v53
    v_mfma_f32_16x16x32_bf16 v[92:95], a[172:175], v[188:191], v[92:95]
    v_exp_f32 v238, v238
    v_mul_f32 v54, v52, v54
    v_mfma_f32_16x16x32_bf16 v[92:95], a[176:179], v[192:195], v[92:95]
    v_exp_f32 v239, v239
    v_mfma_f32_16x16x32_bf16 v[96:99], a[180:183], v[208:211], v[96:99]
    v_mul_f32 v55, v53, v55
    v_add_f32 v238, 1.0, v238
    v_mfma_f32_16x16x32_bf16 v[96:99], a[184:187], v[212:215], v[96:99]
    ds_read_b128 v[208:211], v5 offset:10240
    v_add_f32 v239, 1.0, v239
    v_mfma_f32_16x16x32_bf16 v[96:99], a[188:191], v[216:219], v[96:99]
    ds_read_b128 v[212:215], v5 offset:11264
    v_mul_f32 v56, v56, v247
    v_mfma_f32_16x16x32_bf16 v[96:99], a[192:195], v[220:223], v[96:99]
    ds_read_b128 v[216:219], v5 offset:12288
    v_mul_f32 v57, v57, v247
    v_mfma_f32_16x16x32_bf16 v[96:99], a[196:199], v[224:227], v[96:99]
    ds_read_b128 v[220:223], v5 offset:13312
    v_fma_f32 v240, -v56, v56, s29
    v_mfma_f32_16x16x32_bf16 v[96:99], a[200:203], v[228:231], v[96:99]
    ds_read_b128 v[224:227], v5 offset:14336
    v_rcp_f32 v238, v238
    v_mfma_f32_16x16x32_bf16 v[96:99], a[204:207], v[184:187], v[96:99]
    ds_read_b128 v[228:231], v5 offset:15360
    v_mul_f32 v238, v54, v238
    v_mfma_f32_16x16x32_bf16 v[96:99], a[208:211], v[188:191], v[96:99]
    v_rcp_f32 v239, v239
    v_mfma_f32_16x16x32_bf16 v[96:99], a[212:215], v[192:195], v[96:99]
    s_waitcnt lgkmcnt(7)
    v_mul_f32 v239, v55, v239
    v_fma_f32 v241, -v57, v57, s29
    v_mfma_f32_16x16x32_bf16 v[100:103], a[108:111], v[196:199], v[100:103]
    s_add_u32 s30, s24, 815104
    ds_read_b128 v[184:187], v11 offset:0
    ds_read_b128 v[188:191], v11 offset:1024
    v_mfma_f32_16x16x32_bf16 v[100:103], a[112:115], v[200:203], v[100:103]
    ds_read_b128 v[192:195], v11 offset:2048
    v_cvt_pk_bf16_f32 v157, v238, v239
    v_mfma_f32_16x16x32_bf16 v[100:103], a[116:119], v[204:207], v[100:103]
    s_waitcnt lgkmcnt(7)
    v_mul_f32 v240, v240, v56
    v_mul_f32 v241, v241, v57
    v_mfma_f32_16x16x32_bf16 v[100:103], a[120:123], v[208:211], v[100:103]
    buffer_load_dwordx4 a[108:111], v3, s[4:7], s30 offen sc1
    v_mul_f32 v58, v56, v58
    v_mfma_f32_16x16x32_bf16 v[100:103], a[124:127], v[212:215], v[100:103]
    s_waitcnt lgkmcnt(5)
    v_exp_f32 v240, v240
    v_mfma_f32_16x16x32_bf16 v[100:103], a[128:131], v[216:219], v[100:103]
    s_add_u32 s30, s24, 819200
    v_exp_f32 v241, v241
    v_mfma_f32_16x16x32_bf16 v[100:103], a[132:135], v[220:223], v[100:103]
    s_waitcnt lgkmcnt(3)
    v_mul_f32 v59, v57, v59
    v_add_f32 v240, 1.0, v240
    v_mfma_f32_16x16x32_bf16 v[100:103], a[136:139], v[224:227], v[100:103]
    buffer_load_dwordx4 a[112:115], v3, s[4:7], s30 offen sc1
    v_mfma_f32_16x16x32_bf16 v[100:103], a[140:143], v[228:231], v[100:103]
    s_add_u32 s30, s24, 823296
    v_add_f32 v241, 1.0, v241
    v_mul_f32 v60, v60, v247
    v_mfma_f32_16x16x32_bf16 v[104:107], a[144:147], v[196:199], v[104:107]
    v_rcp_f32 v240, v240
    v_mfma_f32_16x16x32_bf16 v[104:107], a[148:151], v[200:203], v[104:107]
    buffer_load_dwordx4 a[116:119], v3, s[4:7], s30 offen sc1
    v_mul_f32 v240, v58, v240
    v_mfma_f32_16x16x32_bf16 v[104:107], a[152:155], v[204:207], v[104:107]
    v_rcp_f32 v241, v241
    v_mfma_f32_16x16x32_bf16 v[104:107], a[156:159], v[208:211], v[104:107]
    s_add_u32 s30, s24, 827392
    v_mul_f32 v241, v59, v241
    v_mul_f32 v61, v61, v247
    v_mfma_f32_16x16x32_bf16 v[104:107], a[160:163], v[212:215], v[104:107]
    v_cvt_pk_bf16_f32 v158, v240, v241
    v_fma_f32 v242, -v60, v60, s29
    v_mfma_f32_16x16x32_bf16 v[104:107], a[164:167], v[216:219], v[104:107]
    buffer_load_dwordx4 a[120:123], v3, s[4:7], s30 offen sc1
    v_mfma_f32_16x16x32_bf16 v[104:107], a[168:171], v[220:223], v[104:107]
    v_fma_f32 v243, -v61, v61, s29
    v_mul_f32 v242, v242, v60
    v_mfma_f32_16x16x32_bf16 v[104:107], a[172:175], v[224:227], v[104:107]
    v_mul_f32 v243, v243, v61
    v_mul_f32 v62, v60, v62
    v_mfma_f32_16x16x32_bf16 v[104:107], a[176:179], v[228:231], v[104:107]
    s_add_u32 s30, s24, 831488
    v_exp_f32 v242, v242
    v_mul_f32 v63, v61, v63
    v_mfma_f32_16x16x32_bf16 v[108:111], a[180:183], v[196:199], v[108:111]
    v_exp_f32 v243, v243
    v_mfma_f32_16x16x32_bf16 v[108:111], a[184:187], v[200:203], v[108:111]
    ds_read_b128 v[196:199], v11 offset:3072
    v_add_f32 v242, 1.0, v242
    v_mfma_f32_16x16x32_bf16 v[108:111], a[188:191], v[204:207], v[108:111]
    ds_read_b128 v[200:203], v11 offset:4096
    v_add_f32 v243, 1.0, v243
    v_mfma_f32_16x16x32_bf16 v[108:111], a[192:195], v[208:211], v[108:111]
    buffer_load_dwordx4 a[124:127], v3, s[4:7], s30 offen sc1
    v_mfma_f32_16x16x32_bf16 v[108:111], a[196:199], v[212:215], v[108:111]
    s_add_u32 s30, s24, 835584
    v_rcp_f32 v242, v242
    v_mfma_f32_16x16x32_bf16 v[108:111], a[200:203], v[216:219], v[108:111]
    buffer_load_dwordx4 a[128:131], v3, s[4:7], s30 offen sc1
    v_mfma_f32_16x16x32_bf16 v[108:111], a[204:207], v[220:223], v[108:111]
    v_rcp_f32 v243, v243
    v_mul_f32 v242, v62, v242
    v_mfma_f32_16x16x32_bf16 v[108:111], a[208:211], v[224:227], v[108:111]
    v_mul_f32 v243, v63, v243
    v_mul_f32 v64, v64, v248
    v_mfma_f32_16x16x32_bf16 v[108:111], a[212:215], v[228:231], v[108:111]
    s_waitcnt lgkmcnt(2)
    v_cvt_pk_bf16_f32 v159, v242, v243
    v_mul_f32 v65, v65, v248
    v_mfma_f32_16x16x32_bf16 v[16:19], a[0:3], v[184:187], 0
    s_add_u32 s30, s24, 839680
    ds_read_b128 v[204:207], v14 offset:0
    ds_read_b128 v[208:211], v14 offset:1024
    v_mfma_f32_16x16x32_bf16 v[16:19], a[4:7], v[188:191], v[16:19]
    s_barrier
    ds_read_b128 v[212:215], v14 offset:2048
    ds_read_b128 v[216:219], v14 offset:3072
    v_mfma_f32_16x16x32_bf16 v[16:19], a[8:11], v[192:195], v[16:19]
    s_waitcnt lgkmcnt(4)
    ds_read_b128 v[220:223], v14 offset:4096
    v_fma_f32 v232, -v64, v64, s29
    v_mfma_f32_16x16x32_bf16 v[16:19], a[12:15], v[196:199], v[16:19]
    buffer_load_dwordx4 a[132:135], v3, s[4:7], s30 offen sc1
    v_mfma_f32_16x16x32_bf16 v[16:19], a[16:19], v[200:203], v[16:19]
    s_add_u32 s30, s24, 843776
    ds_write_b128 v9, v[156:159] offset:27648
    v_fma_f32 v233, -v65, v65, s29
    v_mfma_f32_16x16x32_bf16 v[20:23], a[20:23], v[184:187], 0
    buffer_store_dwordx4 v[156:159], v9, s[4:7], s60 offen sc1
    v_mfma_f32_16x16x32_bf16 v[20:23], a[24:27], v[188:191], v[20:23]
    v_mul_f32 v232, v232, v64
    v_mul_f32 v233, v233, v65
    v_mfma_f32_16x16x32_bf16 v[20:23], a[28:31], v[192:195], v[20:23]
    v_exp_f32 v232, v232
    v_mfma_f32_16x16x32_bf16 v[20:23], a[32:35], v[196:199], v[20:23]
    v_exp_f32 v233, v233
    v_mfma_f32_16x16x32_bf16 v[20:23], a[36:39], v[200:203], v[20:23]
    v_mul_f32 v66, v64, v66
    v_mul_f32 v67, v65, v67
    v_mfma_f32_16x16x32_bf16 v[24:27], a[40:43], v[184:187], 0
    v_add_f32 v232, 1.0, v232
    v_add_f32 v233, 1.0, v233
    v_mfma_f32_16x16x32_bf16 v[24:27], a[44:47], v[188:191], v[24:27]
    v_rcp_f32 v232, v232
    v_mul_f32 v68, v68, v248
    v_mfma_f32_16x16x32_bf16 v[24:27], a[48:51], v[192:195], v[24:27]
    buffer_load_dwordx4 a[136:139], v3, s[4:7], s30 offen sc1
    v_mfma_f32_16x16x32_bf16 v[24:27], a[52:55], v[196:199], v[24:27]
    s_add_u32 s30, s24, 847872
    v_rcp_f32 v233, v233
    v_mfma_f32_16x16x32_bf16 v[24:27], a[56:59], v[200:203], v[24:27]
    buffer_load_dwordx4 a[140:143], v3, s[4:7], s30 offen sc1
    v_mfma_f32_16x16x32_bf16 v[28:31], a[60:63], v[184:187], 0
    v_mul_f32 v232, v66, v232
    v_mul_f32 v233, v67, v233
    v_mfma_f32_16x16x32_bf16 v[28:31], a[64:67], v[188:191], v[28:31]
    v_cvt_pk_bf16_f32 v161, v232, v233
    v_mul_f32 v69, v69, v248
    v_mfma_f32_16x16x32_bf16 v[28:31], a[68:71], v[192:195], v[28:31]
    v_fma_f32 v234, -v68, v68, s29
    v_fma_f32 v235, -v69, v69, s29
    v_mfma_f32_16x16x32_bf16 v[28:31], a[72:75], v[196:199], v[28:31]
    v_mul_f32 v234, v234, v68
    v_mul_f32 v235, v235, v69
    v_mul_f32 v70, v68, v70
    v_mfma_f32_16x16x32_bf16 v[28:31], a[76:79], v[200:203], v[28:31]
    buffer_load_dword v254, off, s[4:7], s49 offset:0 sc1
    v_mfma_f32_16x16x32_bf16 v[112:115], a[80:83], v[184:187], 0
    s_add_u32 s30, s24, 851968
    v_exp_f32 v234, v234
    v_mfma_f32_16x16x32_bf16 v[112:115], a[84:87], v[188:191], v[112:115]
    buffer_load_dwordx4 a[144:147], v3, s[4:7], s30 offen sc1
    v_mfma_f32_16x16x32_bf16 v[112:115], a[88:91], v[192:195], v[112:115]
    s_add_u32 s30, s24, 856064
    v_exp_f32 v235, v235
    v_mfma_f32_16x16x32_bf16 v[112:115], a[92:95], v[196:199], v[112:115]
    v_mul_f32 v71, v69, v71
    v_add_f32 v234, 1.0, v234
    v_mfma_f32_16x16x32_bf16 v[112:115], a[96:99], v[200:203], v[112:115]
    s_waitcnt lgkmcnt(1)
    v_add_f32 v235, 1.0, v235
    v_mul_f32 v72, v72, v248
    v_mfma_f32_16x16x32_bf16 v[116:119], a[0:3], v[204:207], 0
    ds_read_b128 v[224:227], v11 offset:18432
    ds_read_b128 v[228:231], v11 offset:19456
    v_mul_f32 v73, v73, v248
    v_mfma_f32_16x16x32_bf16 v[116:119], a[4:7], v[208:211], v[116:119]
    ds_read_b128 v[184:187], v11 offset:20480
    ds_read_b128 v[188:191], v11 offset:21504
    v_mfma_f32_16x16x32_bf16 v[116:119], a[8:11], v[212:215], v[116:119]
    ds_read_b128 v[192:195], v11 offset:22528
    v_fma_f32 v236, -v72, v72, s29
    v_mfma_f32_16x16x32_bf16 v[116:119], a[12:15], v[216:219], v[116:119]
    buffer_load_dwordx4 a[148:151], v3, s[4:7], s30 offen sc1
    v_mfma_f32_16x16x32_bf16 v[116:119], a[16:19], v[220:223], v[116:119]
    s_add_u32 s30, s24, 860160
    v_rcp_f32 v234, v234
    v_mfma_f32_16x16x32_bf16 v[120:123], a[20:23], v[204:207], 0
    buffer_load_dwordx4 a[152:155], v3, s[4:7], s30 offen sc1
    v_mfma_f32_16x16x32_bf16 v[120:123], a[24:27], v[208:211], v[120:123]
    v_rcp_f32 v235, v235
    v_mfma_f32_16x16x32_bf16 v[120:123], a[28:31], v[212:215], v[120:123]
    v_mul_f32 v234, v70, v234
    v_mul_f32 v235, v71, v235
    v_fma_f32 v237, -v73, v73, s29
    v_mfma_f32_16x16x32_bf16 v[120:123], a[32:35], v[216:219], v[120:123]
    s_add_u32 s30, s24, 864256
    v_cvt_pk_bf16_f32 v162, v234, v235
    v_mul_f32 v236, v236, v72
    v_mfma_f32_16x16x32_bf16 v[120:123], a[36:39], v[220:223], v[120:123]
    v_mul_f32 v237, v237, v73
    v_mul_f32 v74, v72, v74
    v_mfma_f32_16x16x32_bf16 v[124:127], a[40:43], v[204:207], 0
    buffer_load_dwordx4 a[156:159], v3, s[4:7], s30 offen sc1
    v_mfma_f32_16x16x32_bf16 v[124:127], a[44:47], v[208:211], v[124:127]
    v_exp_f32 v236, v236
    v_mfma_f32_16x16x32_bf16 v[124:127], a[48:51], v[212:215], v[124:127]
    s_add_u32 s30, s24, 868352
    v_exp_f32 v237, v237
    v_mfma_f32_16x16x32_bf16 v[124:127], a[52:55], v[216:219], v[124:127]
    v_mul_f32 v75, v73, v75
    v_add_f32 v236, 1.0, v236
    v_mfma_f32_16x16x32_bf16 v[124:127], a[56:59], v[220:223], v[124:127]
    buffer_load_dwordx4 a[160:163], v3, s[4:7], s30 offen sc1
    v_add_f32 v237, 1.0, v237
    v_mfma_f32_16x16x32_bf16 v[128:131], a[60:63], v[204:207], 0
    v_rcp_f32 v236, v236
    v_mfma_f32_16x16x32_bf16 v[128:131], a[64:67], v[208:211], v[128:131]
    s_add_u32 s30, s24, 872448
    v_rcp_f32 v237, v237
    v_mfma_f32_16x16x32_bf16 v[128:131], a[68:71], v[212:215], v[128:131]
    v_mul_f32 v236, v74, v236
    v_mul_f32 v237, v75, v237
    v_mfma_f32_16x16x32_bf16 v[128:131], a[72:75], v[216:219], v[128:131]
    buffer_load_dwordx4 a[164:167], v3, s[4:7], s30 offen sc1
    v_mfma_f32_16x16x32_bf16 v[128:131], a[76:79], v[220:223], v[128:131]
    s_waitcnt lgkmcnt(0)
    v_cvt_pk_bf16_f32 v163, v236, v237
    v_mul_f32 v76, v76, v249
    v_mfma_f32_16x16x32_bf16 v[132:135], a[0:3], v[224:227], 0
    s_add_u32 s30, s24, 876544
    ds_read_b128 v[196:199], v14 offset:18432
    ds_read_b128 v[200:203], v14 offset:19456
    v_mfma_f32_16x16x32_bf16 v[132:135], a[4:7], v[228:231], v[132:135]
    s_waitcnt vmcnt(9)
    ds_read_b128 v[204:207], v14 offset:20480
    ds_read_b128 v[208:211], v14 offset:21504
    v_mul_f32 v77, v77, v249
    v_mfma_f32_16x16x32_bf16 v[132:135], a[8:11], v[184:187], v[132:135]
    ds_read_b128 v[212:215], v14 offset:22528
    v_fma_f32 v238, -v76, v76, s29
    v_mfma_f32_16x16x32_bf16 v[132:135], a[12:15], v[188:191], v[132:135]
    buffer_load_dwordx4 a[168:171], v3, s[4:7], s30 offen sc1
    v_mfma_f32_16x16x32_bf16 v[132:135], a[16:19], v[192:195], v[132:135]
    ds_write_b128 v9, v[160:163] offset:36864
    v_mfma_f32_16x16x32_bf16 v[136:139], a[20:23], v[224:227], 0
    s_add_u32 s30, s24, 880640
    v_fma_f32 v239, -v77, v77, s29
    v_mul_f32 v238, v238, v76
    v_mfma_f32_16x16x32_bf16 v[136:139], a[24:27], v[228:231], v[136:139]
    buffer_store_dwordx4 v[160:163], v9, s[4:7], s61 offen sc1
    v_mfma_f32_16x16x32_bf16 v[136:139], a[28:31], v[184:187], v[136:139]
    buffer_store_dword v252, off, s[4:7], s48 offset:128 sc1
    v_mul_f32 v239, v239, v77
    v_mul_f32 v78, v76, v78
    v_mfma_f32_16x16x32_bf16 v[136:139], a[32:35], v[188:191], v[136:139]
    v_exp_f32 v238, v238
    v_mul_f32 v79, v77, v79
    v_mfma_f32_16x16x32_bf16 v[136:139], a[36:39], v[192:195], v[136:139]
    v_exp_f32 v239, v239
    v_mfma_f32_16x16x32_bf16 v[140:143], a[40:43], v[224:227], 0
    v_add_f32 v238, 1.0, v238
    v_add_f32 v239, 1.0, v239
    v_mfma_f32_16x16x32_bf16 v[140:143], a[44:47], v[228:231], v[140:143]
    v_rcp_f32 v238, v238
    v_mfma_f32_16x16x32_bf16 v[140:143], a[48:51], v[184:187], v[140:143]
    v_rcp_f32 v239, v239
    v_mfma_f32_16x16x32_bf16 v[140:143], a[52:55], v[188:191], v[140:143]
    v_mul_f32 v238, v78, v238
    v_mul_f32 v239, v79, v239
    v_mfma_f32_16x16x32_bf16 v[140:143], a[56:59], v[192:195], v[140:143]
    buffer_load_dwordx4 a[172:175], v3, s[4:7], s30 offen sc1
    v_mfma_f32_16x16x32_bf16 v[32:35], a[60:63], v[224:227], 0
    s_waitcnt vmcnt(10)
    v_readfirstlane_b32 s27, v254
    s_nop 0
    s_cmp_lg_u32 s27, 0
    s_cbranch_scc0 ffn0_part_slow0
ffn0_part_back0:
    v_cvt_pk_bf16_f32 v165, v238, v239
    v_mfma_f32_16x16x32_bf16 v[32:35], a[64:67], v[228:231], v[32:35]
    s_add_u32 s30, s24, 884736
    v_mul_f32 v80, v80, v249
    v_mul_f32 v81, v81, v249
    v_mfma_f32_16x16x32_bf16 v[32:35], a[68:71], v[184:187], v[32:35]
    buffer_load_dwordx4 a[176:179], v3, s[4:7], s30 offen sc1
    v_mfma_f32_16x16x32_bf16 v[32:35], a[72:75], v[188:191], v[32:35]
    s_add_u32 m0, s26, 73728
    v_fma_f32 v240, -v80, v80, s29
    v_fma_f32 v241, -v81, v81, s29
    v_mfma_f32_16x16x32_bf16 v[32:35], a[76:79], v[192:195], v[32:35]
    s_add_u32 s31, s47, 0
    v_mul_f32 v240, v240, v80
    v_mul_f32 v241, v241, v81
    v_mfma_f32_16x16x32_bf16 v[144:147], a[80:83], v[224:227], 0
    v_exp_f32 v240, v240
    v_mfma_f32_16x16x32_bf16 v[144:147], a[84:87], v[228:231], v[144:147]
    buffer_load_dwordx4 v3, s[4:7], s31 offen sc1 lds
    v_mfma_f32_16x16x32_bf16 v[144:147], a[88:91], v[184:187], v[144:147]
    v_exp_f32 v241, v241
    v_mul_f32 v82, v80, v82
    v_mfma_f32_16x16x32_bf16 v[144:147], a[92:95], v[188:191], v[144:147]
    s_add_u32 s30, s24, 888832
    v_mul_f32 v83, v81, v83
    v_add_f32 v240, 1.0, v240
    v_mfma_f32_16x16x32_bf16 v[144:147], a[96:99], v[192:195], v[144:147]
    s_waitcnt lgkmcnt(1)
    v_add_f32 v241, 1.0, v241
    v_mul_f32 v84, v84, v249
    v_mfma_f32_16x16x32_bf16 v[176:179], a[0:3], v[196:199], 0
    ds_read_b128 v[216:219], v11 offset:36864
    ds_read_b128 v[220:223], v11 offset:37888
    v_mfma_f32_16x16x32_bf16 v[176:179], a[4:7], v[200:203], v[176:179]
    ds_read_b128 v[184:187], v11 offset:38912
    ds_read_b128 v[188:191], v11 offset:39936
    v_mfma_f32_16x16x32_bf16 v[176:179], a[8:11], v[204:207], v[176:179]
    ds_read_b128 v[192:195], v11 offset:40960
    v_mul_f32 v85, v85, v249
    v_mfma_f32_16x16x32_bf16 v[176:179], a[12:15], v[208:211], v[176:179]
    buffer_load_dwordx4 a[180:183], v3, s[4:7], s30 offen sc1
    v_mfma_f32_16x16x32_bf16 v[176:179], a[16:19], v[212:215], v[176:179]
    s_add_u32 m0, s26, 82944
    v_rcp_f32 v240, v240
    v_fma_f32 v242, -v84, v84, s29
    v_mfma_f32_16x16x32_bf16 v[36:39], a[20:23], v[196:199], 0
    s_add_u32 s31, s47, 9216
    v_rcp_f32 v241, v241
    v_mfma_f32_16x16x32_bf16 v[36:39], a[24:27], v[200:203], v[36:39]
    buffer_load_dwordx4 v3, s[4:7], s31 offen sc1 lds
    v_mfma_f32_16x16x32_bf16 v[36:39], a[28:31], v[204:207], v[36:39]
    v_mul_f32 v240, v82, v240
    v_mul_f32 v241, v83, v241
    v_mfma_f32_16x16x32_bf16 v[36:39], a[32:35], v[208:211], v[36:39]
    s_add_u32 s30, s24, 892928
    v_cvt_pk_bf16_f32 v166, v240, v241
    v_fma_f32 v243, -v85, v85, s29
    v_mfma_f32_16x16x32_bf16 v[36:39], a[36:39], v[212:215], v[36:39]
    v_mul_f32 v242, v242, v84
    v_mul_f32 v243, v243, v85
    v_mfma_f32_16x16x32_bf16 v[180:183], a[40:43], v[196:199], 0
    buffer_load_dwordx4 a[184:187], v3, s[4:7], s30 offen sc1
    v_mfma_f32_16x16x32_bf16 v[180:183], a[44:47], v[200:203], v[180:183]
    s_add_u32 m0, s26, 92160
    v_exp_f32 v242, v242
    v_mul_f32 v86, v84, v86
    v_mfma_f32_16x16x32_bf16 v[180:183], a[48:51], v[204:207], v[180:183]
    s_add_u32 s31, s47, 18432
    v_exp_f32 v243, v243
    v_mfma_f32_16x16x32_bf16 v[180:183], a[52:55], v[208:211], v[180:183]
    v_mul_f32 v87, v85, v87
    v_add_f32 v242, 1.0, v242
    v_mfma_f32_16x16x32_bf16 v[180:183], a[56:59], v[212:215], v[180:183]
    buffer_load_dwordx4 v3, s[4:7], s31 offen sc1 lds
    v_mfma_f32_16x16x32_bf16 v[40:43], a[60:63], v[196:199], 0
    v_add_f32 v243, 1.0, v243
    v_mul_f32 v88, v88, v250
    v_mfma_f32_16x16x32_bf16 v[40:43], a[64:67], v[200:203], v[40:43]
    s_add_u32 s30, s24, 897024
    v_rcp_f32 v242, v242
    v_mfma_f32_16x16x32_bf16 v[40:43], a[68:71], v[204:207], v[40:43]
    v_rcp_f32 v243, v243
    v_mfma_f32_16x16x32_bf16 v[40:43], a[72:75], v[208:211], v[40:43]
    buffer_load_dwordx4 a[188:191], v3, s[4:7], s30 offen sc1
    v_mul_f32 v242, v86, v242
    v_mfma_f32_16x16x32_bf16 v[40:43], a[76:79], v[212:215], v[40:43]
    s_waitcnt lgkmcnt(0)
    v_mul_f32 v243, v87, v243
    v_mul_f32 v89, v89, v250
    v_mfma_f32_16x16x32_bf16 v[148:151], a[0:3], v[216:219], 0
    s_add_u32 m0, s26, 101376
    ds_read_b128 v[224:227], v14 offset:36864
    ds_read_b128 v[228:231], v14 offset:37888
    v_mfma_f32_16x16x32_bf16 v[148:151], a[4:7], v[220:223], v[148:151]
    s_add_u32 s31, s47, 27648
    ds_read_b128 v[196:199], v14 offset:38912
    ds_read_b128 v[200:203], v14 offset:39936
    v_mfma_f32_16x16x32_bf16 v[148:151], a[8:11], v[184:187], v[148:151]
    ds_read_b128 v[204:207], v14 offset:40960
    v_cvt_pk_bf16_f32 v167, v242, v243
    v_mfma_f32_16x16x32_bf16 v[148:151], a[12:15], v[188:191], v[148:151]
    buffer_load_dwordx4 v3, s[4:7], s31 offen sc1 lds
    v_mfma_f32_16x16x32_bf16 v[148:151], a[16:19], v[192:195], v[148:151]
    ds_write_b128 v9, v[164:167] offset:46080
    v_mfma_f32_16x16x32_bf16 v[44:47], a[20:23], v[216:219], 0
    s_add_u32 s30, s24, 901120
    v_fma_f32 v232, -v88, v88, s29
    v_fma_f32 v233, -v89, v89, s29
    v_mul_f32 v90, v88, v90
    v_mfma_f32_16x16x32_bf16 v[44:47], a[24:27], v[220:223], v[44:47]
    v_mul_f32 v232, v232, v88
    v_mul_f32 v233, v233, v89
    v_mfma_f32_16x16x32_bf16 v[44:47], a[28:31], v[184:187], v[44:47]
    buffer_load_dwordx4 a[192:195], v3, s[4:7], s30 offen sc1
    v_mfma_f32_16x16x32_bf16 v[44:47], a[32:35], v[188:191], v[44:47]
    s_add_u32 m0, s34, 73728
    v_exp_f32 v232, v232
    v_mfma_f32_16x16x32_bf16 v[44:47], a[36:39], v[192:195], v[44:47]
    s_add_u32 s31, s47, 0
    v_exp_f32 v233, v233
    v_mfma_f32_16x16x32_bf16 v[48:51], a[40:43], v[216:219], 0
    buffer_store_dwordx4 v[164:167], v9, s[4:7], s62 offen sc1
    v_mfma_f32_16x16x32_bf16 v[48:51], a[44:47], v[220:223], v[48:51]
    v_mul_f32 v91, v89, v91
    v_add_f32 v232, 1.0, v232
    v_mfma_f32_16x16x32_bf16 v[48:51], a[48:51], v[184:187], v[48:51]
    v_add_f32 v233, 1.0, v233
    v_rcp_f32 v232, v232
    v_mfma_f32_16x16x32_bf16 v[48:51], a[52:55], v[188:191], v[48:51]
    v_rcp_f32 v233, v233
    v_mfma_f32_16x16x32_bf16 v[48:51], a[56:59], v[192:195], v[48:51]
    v_mul_f32 v232, v90, v232
    v_mul_f32 v233, v91, v233
    v_mfma_f32_16x16x32_bf16 v[152:155], a[60:63], v[216:219], 0
    v_cvt_pk_bf16_f32 v169, v232, v233
    v_mul_f32 v92, v92, v250
    v_mfma_f32_16x16x32_bf16 v[152:155], a[64:67], v[220:223], v[152:155]
    v_mul_f32 v93, v93, v250
    v_fma_f32 v234, -v92, v92, s29
    v_mfma_f32_16x16x32_bf16 v[152:155], a[68:71], v[184:187], v[152:155]
    buffer_load_dwordx4 v253, s[4:7], s31 offen sc1 lds
    v_mfma_f32_16x16x32_bf16 v[152:155], a[72:75], v[188:191], v[152:155]
    s_add_u32 s30, s24, 905216
    v_fma_f32 v235, -v93, v93, s29
    v_mul_f32 v234, v234, v92
    v_mfma_f32_16x16x32_bf16 v[152:155], a[76:79], v[192:195], v[152:155]
    buffer_load_dwordx4 a[196:199], v3, s[4:7], s30 offen sc1
    v_mul_f32 v235, v235, v93
    v_mfma_f32_16x16x32_bf16 v[52:55], a[80:83], v[216:219], 0
ffn0_part_pad0_8x:
    s_cbranch_execz ffn0_part_padret0
    v_exp_f32 v234, v234
    v_mfma_f32_16x16x32_bf16 v[52:55], a[84:87], v[220:223], v[52:55]
    s_add_u32 m0, s34, 110592
    v_exp_f32 v235, v235
    v_mfma_f32_16x16x32_bf16 v[52:55], a[88:91], v[184:187], v[52:55]
    s_add_u32 s31, s47, 36864
    v_mul_f32 v94, v92, v94
    v_mul_f32 v95, v93, v95
    v_mfma_f32_16x16x32_bf16 v[52:55], a[92:95], v[188:191], v[52:55]
    v_add_f32 v234, 1.0, v234
    v_add_f32 v235, 1.0, v235
    v_mfma_f32_16x16x32_bf16 v[52:55], a[96:99], v[192:195], v[52:55]
    s_waitcnt lgkmcnt(1)
    v_rcp_f32 v234, v234
    v_mfma_f32_16x16x32_bf16 v[56:59], a[0:3], v[224:227], 0
    ds_read_b128 v[208:211], v11 offset:55296
    ds_read_b128 v[212:215], v11 offset:56320
    v_mfma_f32_16x16x32_bf16 v[56:59], a[4:7], v[228:231], v[56:59]
    ds_read_b128 v[184:187], v11 offset:57344
    ds_read_b128 v[188:191], v11 offset:58368
    v_mul_f32 v234, v94, v234
    v_mfma_f32_16x16x32_bf16 v[56:59], a[8:11], v[196:199], v[56:59]
    ds_read_b128 v[192:195], v11 offset:59392
    v_mul_f32 v96, v96, v250
    v_mfma_f32_16x16x32_bf16 v[56:59], a[12:15], v[200:203], v[56:59]
    buffer_load_dwordx4 v253, s[4:7], s31 offen sc1 lds
    v_mfma_f32_16x16x32_bf16 v[56:59], a[16:19], v[204:207], v[56:59]
    s_add_u32 s30, s24, 909312
    v_rcp_f32 v235, v235
    v_mfma_f32_16x16x32_bf16 v[60:63], a[20:23], v[224:227], 0
    buffer_load_dwordx4 a[200:203], v3, s[4:7], s30 offen sc1
    v_mfma_f32_16x16x32_bf16 v[60:63], a[24:27], v[228:231], v[60:63]
    v_mul_f32 v235, v95, v235
    v_mul_f32 v97, v97, v250
    v_mfma_f32_16x16x32_bf16 v[60:63], a[28:31], v[196:199], v[60:63]
    v_cvt_pk_bf16_f32 v170, v234, v235
    v_fma_f32 v236, -v96, v96, s29
    v_mfma_f32_16x16x32_bf16 v[60:63], a[32:35], v[200:203], v[60:63]
    s_add_u32 s30, s24, 913408
    v_fma_f32 v237, -v97, v97, s29
    v_mul_f32 v236, v236, v96
    v_mul_f32 v98, v96, v98
    v_mfma_f32_16x16x32_bf16 v[60:63], a[36:39], v[204:207], v[60:63]
    v_mul_f32 v237, v237, v97
    v_mul_f32 v99, v97, v99
    v_mfma_f32_16x16x32_bf16 v[64:67], a[40:43], v[224:227], 0
    buffer_load_dwordx4 a[204:207], v3, s[4:7], s30 offen sc1
    v_mfma_f32_16x16x32_bf16 v[64:67], a[44:47], v[228:231], v[64:67]
    v_exp_f32 v236, v236
    v_mfma_f32_16x16x32_bf16 v[64:67], a[48:51], v[196:199], v[64:67]
    s_add_u32 s30, s24, 917504
    v_exp_f32 v237, v237
    v_mfma_f32_16x16x32_bf16 v[64:67], a[52:55], v[200:203], v[64:67]
    v_add_f32 v236, 1.0, v236
    v_add_f32 v237, 1.0, v237
    v_mfma_f32_16x16x32_bf16 v[64:67], a[56:59], v[204:207], v[64:67]
    buffer_load_dwordx4 a[208:211], v3, s[4:7], s30 offen sc1
    v_mfma_f32_16x16x32_bf16 v[156:159], a[60:63], v[224:227], 0
    v_rcp_f32 v236, v236
    v_mul_f32 v100, v100, v251
    v_mfma_f32_16x16x32_bf16 v[156:159], a[64:67], v[228:231], v[156:159]
    s_add_u32 s30, s24, 921600
    v_rcp_f32 v237, v237
    v_mfma_f32_16x16x32_bf16 v[156:159], a[68:71], v[196:199], v[156:159]
    v_mul_f32 v236, v98, v236
    v_mul_f32 v237, v99, v237
    v_mfma_f32_16x16x32_bf16 v[156:159], a[72:75], v[200:203], v[156:159]
    buffer_load_dwordx4 a[212:215], v3, s[4:7], s30 offen sc1
    v_mfma_f32_16x16x32_bf16 v[156:159], a[76:79], v[204:207], v[156:159]
    s_waitcnt lgkmcnt(0)
    v_cvt_pk_bf16_f32 v171, v236, v237
    v_mul_f32 v101, v101, v251
    v_mfma_f32_16x16x32_bf16 v[68:71], a[0:3], v[208:211], 0
    s_add_u32 s30, s24, 925696
    ds_read_b128 v[216:219], v14 offset:55296
    ds_read_b128 v[220:223], v14 offset:56320
    v_mfma_f32_16x16x32_bf16 v[68:71], a[4:7], v[212:215], v[68:71]
    ds_read_b128 v[196:199], v14 offset:57344
    ds_read_b128 v[200:203], v14 offset:58368
    v_mfma_f32_16x16x32_bf16 v[68:71], a[8:11], v[184:187], v[68:71]
    ds_read_b128 v[204:207], v14 offset:59392
    buffer_store_dwordx4 v[168:171], v9, s[4:7], s63 offen sc1
    v_mfma_f32_16x16x32_bf16 v[68:71], a[12:15], v[188:191], v[68:71]
    ds_write_b128 v9, v[168:171] offset:55296
    v_mfma_f32_16x16x32_bf16 v[68:71], a[16:19], v[192:195], v[68:71]
    v_fma_f32 v238, -v100, v100, s29
    v_fma_f32 v239, -v101, v101, s29
    v_mfma_f32_16x16x32_bf16 v[72:75], a[20:23], v[208:211], 0
    v_mul_f32 v238, v238, v100
    v_mul_f32 v239, v239, v101
    v_mfma_f32_16x16x32_bf16 v[72:75], a[24:27], v[212:215], v[72:75]
    v_exp_f32 v238, v238
    v_mfma_f32_16x16x32_bf16 v[72:75], a[28:31], v[184:187], v[72:75]
    v_exp_f32 v239, v239
    v_mfma_f32_16x16x32_bf16 v[72:75], a[32:35], v[188:191], v[72:75]
    v_mul_f32 v102, v100, v102
    v_mul_f32 v103, v101, v103
    v_mfma_f32_16x16x32_bf16 v[72:75], a[36:39], v[192:195], v[72:75]
    v_add_f32 v238, 1.0, v238
    v_add_f32 v239, 1.0, v239
    v_mul_f32 v104, v104, v251
    v_mfma_f32_16x16x32_bf16 v[76:79], a[40:43], v[208:211], 0
    v_rcp_f32 v238, v238
    v_mfma_f32_16x16x32_bf16 v[76:79], a[44:47], v[212:215], v[76:79]
    buffer_load_dwordx4 v[160:163], v3, s[4:7], s30 offen sc1
    v_mfma_f32_16x16x32_bf16 v[76:79], a[48:51], v[184:187], v[76:79]
    v_rcp_f32 v239, v239
    v_mfma_f32_16x16x32_bf16 v[76:79], a[52:55], v[188:191], v[76:79]
    v_mul_f32 v238, v102, v238
    v_mul_f32 v239, v103, v239
    v_mfma_f32_16x16x32_bf16 v[76:79], a[56:59], v[192:195], v[76:79]
    v_cvt_pk_bf16_f32 v173, v238, v239
    v_mul_f32 v105, v105, v251
    v_mfma_f32_16x16x32_bf16 v[80:83], a[60:63], v[208:211], 0
    v_fma_f32 v240, -v104, v104, s29
    v_fma_f32 v241, -v105, v105, s29
    v_mfma_f32_16x16x32_bf16 v[80:83], a[64:67], v[212:215], v[80:83]
    v_mul_f32 v240, v240, v104
    v_mul_f32 v241, v241, v105
    v_mfma_f32_16x16x32_bf16 v[80:83], a[68:71], v[184:187], v[80:83]
    v_exp_f32 v240, v240
    v_mfma_f32_16x16x32_bf16 v[80:83], a[72:75], v[188:191], v[80:83]
    v_exp_f32 v241, v241
    v_mfma_f32_16x16x32_bf16 v[80:83], a[76:79], v[192:195], v[80:83]
    v_mul_f32 v106, v104, v106
    v_mul_f32 v107, v105, v107
    v_mfma_f32_16x16x32_bf16 v[84:87], a[80:83], v[208:211], 0
    v_add_f32 v240, 1.0, v240
    v_add_f32 v241, 1.0, v241
    v_mfma_f32_16x16x32_bf16 v[84:87], a[84:87], v[212:215], v[84:87]
    v_rcp_f32 v240, v240
    v_mfma_f32_16x16x32_bf16 v[84:87], a[88:91], v[184:187], v[84:87]
    v_rcp_f32 v241, v241
    v_mfma_f32_16x16x32_bf16 v[84:87], a[92:95], v[188:191], v[84:87]
    v_mul_f32 v240, v106, v240
    v_mul_f32 v241, v107, v241
    v_mfma_f32_16x16x32_bf16 v[84:87], a[96:99], v[192:195], v[84:87]
    s_waitcnt lgkmcnt(1)
    v_cvt_pk_bf16_f32 v174, v240, v241
    v_mul_f32 v108, v108, v251
    v_mfma_f32_16x16x32_bf16 v[88:91], a[0:3], v[216:219], 0
    s_barrier
    ds_read_b128 v[224:227], v11 offset:5120
    ds_read_b128 v[228:231], v11 offset:6144
    v_mfma_f32_16x16x32_bf16 v[88:91], a[4:7], v[220:223], v[88:91]
    ds_read_b128 v[184:187], v11 offset:7168
    ds_read_b128 v[188:191], v11 offset:8192
    v_mfma_f32_16x16x32_bf16 v[88:91], a[8:11], v[196:199], v[88:91]
    buffer_load_dword v254, off, s[4:7], s49 offset:128 sc1
    v_mfma_f32_16x16x32_bf16 v[88:91], a[12:15], v[200:203], v[88:91]
    s_add_u32 s30, s24, 929792
    v_mul_f32 v109, v109, v251
    v_fma_f32 v242, -v108, v108, s29
    v_mfma_f32_16x16x32_bf16 v[88:91], a[16:19], v[204:207], v[88:91]
    buffer_load_dwordx4 a[0:3], v3, s[4:7], s30 offen sc1
    v_mfma_f32_16x16x32_bf16 v[164:167], a[20:23], v[216:219], 0
    s_add_u32 s30, s24, 933888
    v_fma_f32 v243, -v109, v109, s29
    v_mul_f32 v242, v242, v108
    v_mfma_f32_16x16x32_bf16 v[164:167], a[24:27], v[220:223], v[164:167]
    buffer_load_dwordx4 a[4:7], v3, s[4:7], s30 offen sc1
    v_mfma_f32_16x16x32_bf16 v[164:167], a[28:31], v[196:199], v[164:167]
    v_mul_f32 v243, v243, v109
    v_mul_f32 v110, v108, v110
    v_mfma_f32_16x16x32_bf16 v[164:167], a[32:35], v[200:203], v[164:167]
    v_exp_f32 v242, v242
    v_mfma_f32_16x16x32_bf16 v[164:167], a[36:39], v[204:207], v[164:167]
    s_add_u32 s30, s24, 937984
    v_exp_f32 v243, v243
    v_mfma_f32_16x16x32_bf16 v[92:95], a[40:43], v[216:219], 0
    v_mul_f32 v111, v109, v111
    v_add_f32 v242, 1.0, v242
    v_mfma_f32_16x16x32_bf16 v[92:95], a[44:47], v[220:223], v[92:95]
    buffer_load_dwordx4 a[8:11], v3, s[4:7], s30 offen sc1
    v_mfma_f32_16x16x32_bf16 v[92:95], a[48:51], v[196:199], v[92:95]
    v_add_f32 v243, 1.0, v243
    v_mfma_f32_16x16x32_bf16 v[92:95], a[52:55], v[200:203], v[92:95]
    s_add_u32 s30, s24, 942080
    v_rcp_f32 v242, v242
    v_mfma_f32_16x16x32_bf16 v[92:95], a[56:59], v[204:207], v[92:95]
    v_rcp_f32 v243, v243
    v_mfma_f32_16x16x32_bf16 v[96:99], a[60:63], v[216:219], 0
    buffer_load_dwordx4 a[12:15], v3, s[4:7], s30 offen sc1
    v_mfma_f32_16x16x32_bf16 v[96:99], a[64:67], v[220:223], v[96:99]
    v_mul_f32 v242, v110, v242
    v_mul_f32 v243, v111, v243
    v_mfma_f32_16x16x32_bf16 v[96:99], a[68:71], v[196:199], v[96:99]
    s_add_u32 s30, s24, 946176
    v_cvt_pk_bf16_f32 v175, v242, v243
    v_mfma_f32_16x16x32_bf16 v[96:99], a[72:75], v[200:203], v[96:99]
    buffer_store_dwordx4 v[172:175], v9, s[4:7], s23 offen sc1
    v_mfma_f32_16x16x32_bf16 v[96:99], a[76:79], v[204:207], v[96:99]
    s_waitcnt lgkmcnt(0)
    v_mfma_f32_16x16x32_bf16 v[16:19], a[216:219], v[224:227], v[16:19]
    ds_read_b128 v[192:195], v14 offset:5120
    ds_read_b128 v[208:211], v14 offset:6144
    v_mfma_f32_16x16x32_bf16 v[16:19], a[220:223], v[228:231], v[16:19]
    ds_read_b128 v[212:215], v14 offset:7168
    ds_read_b128 v[196:199], v14 offset:8192
    v_mfma_f32_16x16x32_bf16 v[16:19], a[224:227], v[184:187], v[16:19]
    ds_write_b128 v9, v[172:175] offset:64512
    v_mfma_f32_16x16x32_bf16 v[16:19], a[228:231], v[188:191], v[16:19]
    v_mfma_f32_16x16x32_bf16 v[20:23], a[232:235], v[224:227], v[20:23]
    v_mfma_f32_16x16x32_bf16 v[20:23], a[236:239], v[228:231], v[20:23]
    v_mfma_f32_16x16x32_bf16 v[20:23], a[240:243], v[184:187], v[20:23]
    buffer_load_dwordx4 a[16:19], v3, s[4:7], s30 offen sc1
    v_mfma_f32_16x16x32_bf16 v[20:23], a[244:247], v[188:191], v[20:23]
    s_add_u32 s30, s24, 950272
    v_mfma_f32_16x16x32_bf16 v[24:27], a[248:251], v[224:227], v[24:27]
    buffer_load_dwordx4 a[20:23], v3, s[4:7], s30 offen sc1
    v_mfma_f32_16x16x32_bf16 v[24:27], a[252:255], v[228:231], v[24:27]
    v_mfma_f32_16x16x32_bf16 v[24:27], a[100:103], v[184:187], v[24:27]
    v_mfma_f32_16x16x32_bf16 v[24:27], a[104:107], v[188:191], v[24:27]
    s_add_u32 s30, s24, 954368
    v_mfma_f32_16x16x32_bf16 v[28:31], a[108:111], v[224:227], v[28:31]
    v_mfma_f32_16x16x32_bf16 v[28:31], a[112:115], v[228:231], v[28:31]
    buffer_load_dwordx4 a[24:27], v3, s[4:7], s30 offen sc1
    v_mfma_f32_16x16x32_bf16 v[28:31], a[116:119], v[184:187], v[28:31]
    v_mfma_f32_16x16x32_bf16 v[28:31], a[120:123], v[188:191], v[28:31]
    s_add_u32 s30, s24, 958464
    v_mfma_f32_16x16x32_bf16 v[112:115], a[124:127], v[224:227], v[112:115]
    v_mfma_f32_16x16x32_bf16 v[112:115], a[128:131], v[228:231], v[112:115]
    buffer_load_dwordx4 a[28:31], v3, s[4:7], s30 offen sc1
    v_mfma_f32_16x16x32_bf16 v[112:115], a[132:135], v[184:187], v[112:115]
    s_add_u32 m0, s26, 110592
    v_mfma_f32_16x16x32_bf16 v[112:115], a[136:139], v[188:191], v[112:115]
    s_waitcnt lgkmcnt(1)
    v_mfma_f32_16x16x32_bf16 v[116:119], a[216:219], v[192:195], v[116:119]
    s_add_u32 s31, s47, 36864
    ds_read_b128 v[200:203], v11 offset:23552
    ds_read_b128 v[204:207], v11 offset:24576
    v_mfma_f32_16x16x32_bf16 v[116:119], a[220:223], v[208:211], v[116:119]
    ds_read_b128 v[216:219], v11 offset:25600
    ds_read_b128 v[220:223], v11 offset:26624
    v_mfma_f32_16x16x32_bf16 v[116:119], a[224:227], v[212:215], v[116:119]
    buffer_load_dwordx4 v3, s[4:7], s31 offen sc1 lds
    v_mfma_f32_16x16x32_bf16 v[116:119], a[228:231], v[196:199], v[116:119]
    s_add_u32 s30, s24, 962560
    v_mfma_f32_16x16x32_bf16 v[120:123], a[232:235], v[192:195], v[120:123]
    v_mfma_f32_16x16x32_bf16 v[120:123], a[236:239], v[208:211], v[120:123]
    s_waitcnt vmcnt(10)
    v_readfirstlane_b32 s27, v254
    s_nop 0
    s_cmp_lg_u32 s27, 0
    s_cbranch_scc0 ffn0_part_slow1
ffn0_part_back1:
    v_mfma_f32_16x16x32_bf16 v[120:123], a[240:243], v[212:215], v[120:123]
    buffer_load_dwordx4 a[32:35], v3, s[4:7], s30 offen sc1
    v_mfma_f32_16x16x32_bf16 v[120:123], a[244:247], v[196:199], v[120:123]
    s_add_u32 m0, s26, 119808
    v_mfma_f32_16x16x32_bf16 v[124:127], a[248:251], v[192:195], v[124:127]
    s_add_u32 s31, s47, 46080
    v_mfma_f32_16x16x32_bf16 v[124:127], a[252:255], v[208:211], v[124:127]
    v_mfma_f32_16x16x32_bf16 v[124:127], a[100:103], v[212:215], v[124:127]
    buffer_load_dwordx4 v3, s[4:7], s31 offen sc1 lds
    v_mfma_f32_16x16x32_bf16 v[124:127], a[104:107], v[196:199], v[124:127]
    s_add_u32 m0, s26, 78848
    v_mfma_f32_16x16x32_bf16 v[128:131], a[108:111], v[192:195], v[128:131]
    s_add_u32 s31, s47, 5120
    v_mfma_f32_16x16x32_bf16 v[128:131], a[112:115], v[208:211], v[128:131]
    v_mfma_f32_16x16x32_bf16 v[128:131], a[116:119], v[212:215], v[128:131]
    buffer_load_dwordx4 v3, s[4:7], s31 offen sc1 lds
    v_mfma_f32_16x16x32_bf16 v[128:131], a[120:123], v[196:199], v[128:131]
    s_waitcnt lgkmcnt(0)
    v_mfma_f32_16x16x32_bf16 v[132:135], a[216:219], v[200:203], v[132:135]
    s_add_u32 m0, s26, 88064
    ds_read_b128 v[184:187], v14 offset:23552
    ds_read_b128 v[188:191], v14 offset:24576
    v_mfma_f32_16x16x32_bf16 v[132:135], a[220:223], v[204:207], v[132:135]
    s_add_u32 s31, s47, 14336
    ds_read_b128 v[224:227], v14 offset:25600
    ds_read_b128 v[228:231], v14 offset:26624
    v_mfma_f32_16x16x32_bf16 v[132:135], a[224:227], v[216:219], v[132:135]
    buffer_load_dwordx4 v3, s[4:7], s31 offen sc1 lds
    v_mfma_f32_16x16x32_bf16 v[132:135], a[228:231], v[220:223], v[132:135]
    s_waitcnt vmcnt(9)
    v_mfma_f32_16x16x32_bf16 v[136:139], a[232:235], v[200:203], v[136:139]
    s_add_u32 m0, s26, 129024
    v_mfma_f32_16x16x32_bf16 v[136:139], a[236:239], v[204:207], v[136:139]
    s_add_u32 s31, s47, 55296
    v_mfma_f32_16x16x32_bf16 v[136:139], a[240:243], v[216:219], v[136:139]
    buffer_store_dword v252, off, s[4:7], s48 offset:256 sc1
    v_mfma_f32_16x16x32_bf16 v[136:139], a[244:247], v[220:223], v[136:139]
    buffer_load_dwordx4 v3, s[4:7], s31 offen sc1 lds
    v_mfma_f32_16x16x32_bf16 v[140:143], a[248:251], v[200:203], v[140:143]
    s_add_u32 m0, s26, 97280
    v_mfma_f32_16x16x32_bf16 v[140:143], a[252:255], v[204:207], v[140:143]
    s_add_u32 s31, s47, 23552
    v_mfma_f32_16x16x32_bf16 v[140:143], a[100:103], v[216:219], v[140:143]
    v_mfma_f32_16x16x32_bf16 v[140:143], a[104:107], v[220:223], v[140:143]
    buffer_load_dwordx4 v3, s[4:7], s31 offen sc1 lds
    v_mfma_f32_16x16x32_bf16 v[32:35], a[108:111], v[200:203], v[32:35]
    s_add_u32 m0, s26, 138240
    v_mfma_f32_16x16x32_bf16 v[32:35], a[112:115], v[204:207], v[32:35]
    s_add_u32 s31, s47, 64512
    v_mfma_f32_16x16x32_bf16 v[32:35], a[116:119], v[216:219], v[32:35]
    v_mfma_f32_16x16x32_bf16 v[32:35], a[120:123], v[220:223], v[32:35]
    buffer_load_dwordx4 v3, s[4:7], s31 offen sc1 lds
    v_mfma_f32_16x16x32_bf16 v[144:147], a[124:127], v[200:203], v[144:147]
    v_mfma_f32_16x16x32_bf16 v[144:147], a[128:131], v[204:207], v[144:147]
    s_add_u32 m0, s26, 106496
    v_mfma_f32_16x16x32_bf16 v[144:147], a[132:135], v[216:219], v[144:147]
    s_add_u32 s31, s47, 32768
    v_mfma_f32_16x16x32_bf16 v[144:147], a[136:139], v[220:223], v[144:147]
    s_waitcnt lgkmcnt(0)
    v_mfma_f32_16x16x32_bf16 v[176:179], a[216:219], v[184:187], v[176:179]
    s_barrier
    ds_read_b128 v[192:195], v12 offset:0
    ds_read_b128 v[196:199], v12 offset:1024
    v_mfma_f32_16x16x32_bf16 v[176:179], a[220:223], v[188:191], v[176:179]
    ds_read_b128 v[208:211], v12 offset:2048
    ds_read_b128 v[212:215], v12 offset:3072
    v_mfma_f32_16x16x32_bf16 v[176:179], a[224:227], v[224:227], v[176:179]
    buffer_load_dwordx4 v3, s[4:7], s31 offen sc1 lds
    v_mfma_f32_16x16x32_bf16 v[176:179], a[228:231], v[228:231], v[176:179]
    s_add_u32 s30, s24, 966656
    v_mfma_f32_16x16x32_bf16 v[36:39], a[232:235], v[184:187], v[36:39]
    buffer_load_dwordx4 a[36:39], v3, s[4:7], s30 offen sc1
    v_mfma_f32_16x16x32_bf16 v[36:39], a[236:239], v[188:191], v[36:39]
    v_mfma_f32_16x16x32_bf16 v[36:39], a[240:243], v[224:227], v[36:39]
    v_mfma_f32_16x16x32_bf16 v[36:39], a[244:247], v[228:231], v[36:39]
    s_add_u32 s30, s24, 970752
    v_mfma_f32_16x16x32_bf16 v[180:183], a[248:251], v[184:187], v[180:183]
    v_mfma_f32_16x16x32_bf16 v[180:183], a[252:255], v[188:191], v[180:183]
    buffer_load_dwordx4 a[40:43], v3, s[4:7], s30 offen sc1
    v_mfma_f32_16x16x32_bf16 v[180:183], a[100:103], v[224:227], v[180:183]
    v_mfma_f32_16x16x32_bf16 v[180:183], a[104:107], v[228:231], v[180:183]
    s_add_u32 s30, s24, 974848
    v_mfma_f32_16x16x32_bf16 v[40:43], a[108:111], v[184:187], v[40:43]
    v_mfma_f32_16x16x32_bf16 v[40:43], a[112:115], v[188:191], v[40:43]
    buffer_load_dwordx4 a[44:47], v3, s[4:7], s30 offen sc1
    v_mfma_f32_16x16x32_bf16 v[40:43], a[116:119], v[224:227], v[40:43]
    v_mfma_f32_16x16x32_bf16 v[40:43], a[120:123], v[228:231], v[40:43]
    s_waitcnt lgkmcnt(0)
    v_mfma_f32_16x16x32_bf16 v[16:19], a[140:143], v[192:195], v[16:19]
    s_add_u32 s30, s24, 978944
    ds_read_b128 v[200:203], v15 offset:0
    ds_read_b128 v[204:207], v15 offset:1024
    v_mfma_f32_16x16x32_bf16 v[16:19], a[144:147], v[196:199], v[16:19]
    ds_read_b128 v[216:219], v15 offset:2048
    ds_read_b128 v[220:223], v15 offset:3072
    v_mfma_f32_16x16x32_bf16 v[16:19], a[148:151], v[208:211], v[16:19]
    buffer_load_dwordx4 a[48:51], v3, s[4:7], s30 offen sc1
    v_mfma_f32_16x16x32_bf16 v[16:19], a[152:155], v[212:215], v[16:19]
    s_add_u32 s30, s24, 983040
    v_mfma_f32_16x16x32_bf16 v[20:23], a[156:159], v[192:195], v[20:23]
    v_mfma_f32_16x16x32_bf16 v[20:23], a[160:163], v[196:199], v[20:23]
    buffer_load_dwordx4 a[52:55], v3, s[4:7], s30 offen sc1
    v_mfma_f32_16x16x32_bf16 v[20:23], a[164:167], v[208:211], v[20:23]
    v_mfma_f32_16x16x32_bf16 v[20:23], a[168:171], v[212:215], v[20:23]
    v_mfma_f32_16x16x32_bf16 v[24:27], a[172:175], v[192:195], v[24:27]
    s_add_u32 s30, s24, 987136
    v_mfma_f32_16x16x32_bf16 v[24:27], a[176:179], v[196:199], v[24:27]
    v_mfma_f32_16x16x32_bf16 v[24:27], a[180:183], v[208:211], v[24:27]
    buffer_load_dwordx4 a[56:59], v3, s[4:7], s30 offen sc1
    v_mfma_f32_16x16x32_bf16 v[24:27], a[184:187], v[212:215], v[24:27]
    v_mfma_f32_16x16x32_bf16 v[28:31], a[188:191], v[192:195], v[28:31]
    s_add_u32 s30, s24, 991232
    v_mfma_f32_16x16x32_bf16 v[28:31], a[192:195], v[196:199], v[28:31]
    v_mfma_f32_16x16x32_bf16 v[28:31], a[196:199], v[208:211], v[28:31]
    buffer_load_dwordx4 a[60:63], v3, s[4:7], s30 offen sc1
    v_mfma_f32_16x16x32_bf16 v[28:31], a[200:203], v[212:215], v[28:31]
    v_mfma_f32_16x16x32_bf16 v[112:115], a[204:207], v[192:195], v[112:115]
    s_add_u32 s30, s24, 995328
    v_mfma_f32_16x16x32_bf16 v[112:115], a[208:211], v[196:199], v[112:115]
    v_mfma_f32_16x16x32_bf16 v[112:115], a[212:215], v[208:211], v[112:115]
    buffer_load_dwordx4 a[64:67], v3, s[4:7], s30 offen sc1
    v_mfma_f32_16x16x32_bf16 v[112:115], v[160:163], v[212:215], v[112:115]
    s_waitcnt lgkmcnt(0)
    v_mfma_f32_16x16x32_bf16 v[116:119], a[140:143], v[200:203], v[116:119]
    ds_read_b128 v[184:187], v12 offset:18432
    ds_read_b128 v[188:191], v12 offset:19456
    v_mfma_f32_16x16x32_bf16 v[116:119], a[144:147], v[204:207], v[116:119]
    s_add_u32 s30, s24, 999424
    ds_read_b128 v[224:227], v12 offset:20480
    ds_read_b128 v[228:231], v12 offset:21504
    v_mfma_f32_16x16x32_bf16 v[116:119], a[148:151], v[216:219], v[116:119]
    v_mfma_f32_16x16x32_bf16 v[116:119], a[152:155], v[220:223], v[116:119]
    buffer_load_dwordx4 a[68:71], v3, s[4:7], s30 offen sc1
    v_mfma_f32_16x16x32_bf16 v[120:123], a[156:159], v[200:203], v[120:123]
    v_mfma_f32_16x16x32_bf16 v[120:123], a[160:163], v[204:207], v[120:123]
    s_add_u32 s30, s24, 1003520
    v_mfma_f32_16x16x32_bf16 v[120:123], a[164:167], v[216:219], v[120:123]
    v_mfma_f32_16x16x32_bf16 v[120:123], a[168:171], v[220:223], v[120:123]
    buffer_load_dwordx4 a[72:75], v3, s[4:7], s30 offen sc1
    v_mfma_f32_16x16x32_bf16 v[124:127], a[172:175], v[200:203], v[124:127]
    v_mfma_f32_16x16x32_bf16 v[124:127], a[176:179], v[204:207], v[124:127]
    s_add_u32 s30, s24, 1007616
    v_mfma_f32_16x16x32_bf16 v[124:127], a[180:183], v[216:219], v[124:127]
    v_mfma_f32_16x16x32_bf16 v[124:127], a[184:187], v[220:223], v[124:127]
    buffer_load_dwordx4 a[76:79], v3, s[4:7], s30 offen sc1
    v_mfma_f32_16x16x32_bf16 v[128:131], a[188:191], v[200:203], v[128:131]
    v_mfma_f32_16x16x32_bf16 v[128:131], a[192:195], v[204:207], v[128:131]
    v_mfma_f32_16x16x32_bf16 v[128:131], a[196:199], v[216:219], v[128:131]
    s_add_u32 s30, s24, 1011712
    v_mfma_f32_16x16x32_bf16 v[128:131], a[200:203], v[220:223], v[128:131]
    s_waitcnt lgkmcnt(0)
    v_mfma_f32_16x16x32_bf16 v[132:135], a[140:143], v[184:187], v[132:135]
    ds_read_b128 v[192:195], v15 offset:18432
    ds_read_b128 v[196:199], v15 offset:19456
    v_mfma_f32_16x16x32_bf16 v[132:135], a[144:147], v[188:191], v[132:135]
    ds_read_b128 v[208:211], v15 offset:20480
    ds_read_b128 v[212:215], v15 offset:21504
    v_mfma_f32_16x16x32_bf16 v[132:135], a[148:151], v[224:227], v[132:135]
    buffer_load_dwordx4 a[80:83], v3, s[4:7], s30 offen sc1
    v_mfma_f32_16x16x32_bf16 v[132:135], a[152:155], v[228:231], v[132:135]
    v_mfma_f32_16x16x32_bf16 v[136:139], a[156:159], v[184:187], v[136:139]
    buffer_load_dword v254, off, s[4:7], s49 offset:256 sc1
    v_mfma_f32_16x16x32_bf16 v[136:139], a[160:163], v[188:191], v[136:139]
    s_add_u32 s30, s24, 1015808
    v_mfma_f32_16x16x32_bf16 v[136:139], a[164:167], v[224:227], v[136:139]
    buffer_load_dwordx4 a[84:87], v3, s[4:7], s30 offen sc1
    v_mfma_f32_16x16x32_bf16 v[136:139], a[168:171], v[228:231], v[136:139]
    v_mfma_f32_16x16x32_bf16 v[140:143], a[172:175], v[184:187], v[140:143]
    s_add_u32 s30, s24, 1019904
    v_mfma_f32_16x16x32_bf16 v[140:143], a[176:179], v[188:191], v[140:143]
    v_mfma_f32_16x16x32_bf16 v[140:143], a[180:183], v[224:227], v[140:143]
    buffer_load_dwordx4 a[88:91], v3, s[4:7], s30 offen sc1
    v_mfma_f32_16x16x32_bf16 v[140:143], a[184:187], v[228:231], v[140:143]
    v_mfma_f32_16x16x32_bf16 v[32:35], a[188:191], v[184:187], v[32:35]
    s_add_u32 s30, s24, 1024000
    v_mfma_f32_16x16x32_bf16 v[32:35], a[192:195], v[188:191], v[32:35]
    v_mfma_f32_16x16x32_bf16 v[32:35], a[196:199], v[224:227], v[32:35]
    buffer_load_dwordx4 a[92:95], v3, s[4:7], s30 offen sc1
    v_mfma_f32_16x16x32_bf16 v[32:35], a[200:203], v[228:231], v[32:35]
    v_mfma_f32_16x16x32_bf16 v[144:147], a[204:207], v[184:187], v[144:147]
    s_add_u32 s30, s24, 1028096
    v_mfma_f32_16x16x32_bf16 v[144:147], a[208:211], v[188:191], v[144:147]
    v_mfma_f32_16x16x32_bf16 v[144:147], a[212:215], v[224:227], v[144:147]
    buffer_load_dwordx4 a[96:99], v3, s[4:7], s30 offen sc1
    v_mfma_f32_16x16x32_bf16 v[144:147], v[160:163], v[228:231], v[144:147]
    s_waitcnt vmcnt(17) lgkmcnt(0)
    v_mfma_f32_16x16x32_bf16 v[176:179], a[140:143], v[192:195], v[176:179]
    s_barrier
    ds_read_b128 v[200:203], v12 offset:4096
    ds_read_b128 v[204:207], v12 offset:5120
    v_mfma_f32_16x16x32_bf16 v[176:179], a[144:147], v[196:199], v[176:179]
    ds_read_b128 v[216:219], v12 offset:6144
    ds_read_b128 v[220:223], v12 offset:7168
    v_mfma_f32_16x16x32_bf16 v[176:179], a[148:151], v[208:211], v[176:179]
    ds_read_b128 v[184:187], v12 offset:8192
    v_mfma_f32_16x16x32_bf16 v[176:179], a[152:155], v[212:215], v[176:179]
    v_mfma_f32_16x16x32_bf16 v[36:39], a[156:159], v[192:195], v[36:39]
    v_mfma_f32_16x16x32_bf16 v[36:39], a[160:163], v[196:199], v[36:39]
    v_mfma_f32_16x16x32_bf16 v[36:39], a[164:167], v[208:211], v[36:39]
    v_mfma_f32_16x16x32_bf16 v[36:39], a[168:171], v[212:215], v[36:39]
    v_mfma_f32_16x16x32_bf16 v[180:183], a[172:175], v[192:195], v[180:183]
    v_mfma_f32_16x16x32_bf16 v[180:183], a[176:179], v[196:199], v[180:183]
    v_mfma_f32_16x16x32_bf16 v[180:183], a[180:183], v[208:211], v[180:183]
    v_mfma_f32_16x16x32_bf16 v[180:183], a[184:187], v[212:215], v[180:183]
    v_mfma_f32_16x16x32_bf16 v[40:43], a[188:191], v[192:195], v[40:43]
    v_mfma_f32_16x16x32_bf16 v[40:43], a[192:195], v[196:199], v[40:43]
    v_mfma_f32_16x16x32_bf16 v[40:43], a[196:199], v[208:211], v[40:43]
    v_mfma_f32_16x16x32_bf16 v[40:43], a[200:203], v[212:215], v[40:43]
    s_waitcnt lgkmcnt(0)
    v_mfma_f32_16x16x32_bf16 v[16:19], a[0:3], v[200:203], v[16:19]
    ds_read_b128 v[188:191], v15 offset:4096
    ds_read_b128 v[224:227], v15 offset:5120
    v_mfma_f32_16x16x32_bf16 v[16:19], a[4:7], v[204:207], v[16:19]
    ds_read_b128 v[228:231], v15 offset:6144
    ds_read_b128 v[192:195], v15 offset:7168
    v_mfma_f32_16x16x32_bf16 v[16:19], a[8:11], v[216:219], v[16:19]
    ds_read_b128 v[196:199], v15 offset:8192
    v_mfma_f32_16x16x32_bf16 v[16:19], a[12:15], v[220:223], v[16:19]
    v_mfma_f32_16x16x32_bf16 v[16:19], a[16:19], v[184:187], v[16:19]
    v_mfma_f32_16x16x32_bf16 v[20:23], a[20:23], v[200:203], v[20:23]
    v_mfma_f32_16x16x32_bf16 v[20:23], a[24:27], v[204:207], v[20:23]
    v_mfma_f32_16x16x32_bf16 v[20:23], a[28:31], v[216:219], v[20:23]
    v_mfma_f32_16x16x32_bf16 v[20:23], a[32:35], v[220:223], v[20:23]
    s_waitcnt vmcnt(8)
    v_cvt_pk_bf16_f32 v100, v16, v17
    v_cvt_pk_bf16_f32 v101, v18, v19
    v_mfma_f32_16x16x32_bf16 v[20:23], a[36:39], v[184:187], v[20:23]
    v_mfma_f32_16x16x32_bf16 v[24:27], a[40:43], v[200:203], v[24:27]
    v_mfma_f32_16x16x32_bf16 v[24:27], a[44:47], v[204:207], v[24:27]
    s_waitcnt vmcnt(4)
    v_readfirstlane_b32 s27, v254
    s_nop 0
    s_cmp_lg_u32 s27, 0
    s_cbranch_scc0 ffn0_part_slow2
ffn0_part_back2:
    v_mfma_f32_16x16x32_bf16 v[24:27], a[48:51], v[216:219], v[24:27]
    s_add_u32 m0, s26, 115712
    v_mfma_f32_16x16x32_bf16 v[24:27], a[52:55], v[220:223], v[24:27]
    s_add_u32 s31, s47, 41984
    v_cvt_pk_bf16_f32 v102, v20, v21
    v_cvt_pk_bf16_f32 v103, v22, v23
    v_mfma_f32_16x16x32_bf16 v[24:27], a[56:59], v[184:187], v[24:27]
    v_mfma_f32_16x16x32_bf16 v[28:31], a[60:63], v[200:203], v[28:31]
    buffer_load_dwordx4 v3, s[4:7], s31 offen sc1 lds
    v_mfma_f32_16x16x32_bf16 v[28:31], a[64:67], v[204:207], v[28:31]
    v_mfma_f32_16x16x32_bf16 v[28:31], a[68:71], v[216:219], v[28:31]
    s_waitcnt vmcnt(1)
    v_mfma_f32_16x16x32_bf16 v[28:31], a[72:75], v[220:223], v[28:31]
    s_add_u32 m0, s26, 124928
    v_cvt_pk_bf16_f32 v168, v24, v25
    v_cvt_pk_bf16_f32 v169, v26, v27
    v_mfma_f32_16x16x32_bf16 v[28:31], a[76:79], v[184:187], v[28:31]
    s_add_u32 s31, s47, 51200
    v_mfma_f32_16x16x32_bf16 v[112:115], a[80:83], v[200:203], v[112:115]
    v_mfma_f32_16x16x32_bf16 v[112:115], a[84:87], v[204:207], v[112:115]
    buffer_load_dwordx4 v3, s[4:7], s31 offen sc1 lds
    v_mfma_f32_16x16x32_bf16 v[112:115], a[88:91], v[216:219], v[112:115]
    v_mfma_f32_16x16x32_bf16 v[112:115], a[92:95], v[220:223], v[112:115]
    buffer_store_dwordx4 v[100:103], v6, s[4:7], s36 offen offset:0 sc1
    v_mfma_f32_16x16x32_bf16 v[112:115], a[96:99], v[184:187], v[112:115]
    s_waitcnt lgkmcnt(0)
    v_cvt_pk_bf16_f32 v170, v28, v29
    v_cvt_pk_bf16_f32 v171, v30, v31
    v_mfma_f32_16x16x32_bf16 v[116:119], a[0:3], v[188:191], v[116:119]
    s_add_u32 m0, s26, 134144
    ds_read_b128 v[208:211], v12 offset:22528
    ds_read_b128 v[212:215], v12 offset:23552
    v_mfma_f32_16x16x32_bf16 v[116:119], a[4:7], v[224:227], v[116:119]
    s_add_u32 s31, s47, 60416
    ds_read_b128 v[184:187], v12 offset:24576
    ds_read_b128 v[200:203], v12 offset:25600
    v_mfma_f32_16x16x32_bf16 v[116:119], a[8:11], v[228:231], v[116:119]
    ds_read_b128 v[204:207], v12 offset:26624
    v_mfma_f32_16x16x32_bf16 v[116:119], a[12:15], v[192:195], v[116:119]
    buffer_load_dwordx4 v3, s[4:7], s31 offen sc1 lds
    v_mfma_f32_16x16x32_bf16 v[116:119], a[16:19], v[196:199], v[116:119]
    v_cvt_pk_bf16_f32 v172, v112, v113
    v_cvt_pk_bf16_f32 v173, v114, v115
    v_mfma_f32_16x16x32_bf16 v[120:123], a[20:23], v[188:191], v[120:123]
    s_add_u32 m0, s26, 143360
    v_mfma_f32_16x16x32_bf16 v[120:123], a[24:27], v[224:227], v[120:123]
    s_add_u32 s31, s47, 69632
    v_mfma_f32_16x16x32_bf16 v[120:123], a[28:31], v[228:231], v[120:123]
    v_mfma_f32_16x16x32_bf16 v[120:123], a[32:35], v[192:195], v[120:123]
    buffer_load_dwordx4 v3, s[4:7], s31 offen sc1 lds
    v_mfma_f32_16x16x32_bf16 v[120:123], a[36:39], v[196:199], v[120:123]
    v_cvt_pk_bf16_f32 v104, v116, v117
    v_cvt_pk_bf16_f32 v105, v118, v119
    v_mfma_f32_16x16x32_bf16 v[124:127], a[40:43], v[188:191], v[124:127]
    buffer_store_dwordx4 v[168:171], v6, s[4:7], s36 offen offset:512 sc1
    v_mfma_f32_16x16x32_bf16 v[124:127], a[44:47], v[224:227], v[124:127]
    v_mfma_f32_16x16x32_bf16 v[124:127], a[48:51], v[228:231], v[124:127]
    v_mfma_f32_16x16x32_bf16 v[124:127], a[52:55], v[192:195], v[124:127]
    v_cvt_pk_bf16_f32 v106, v120, v121
    v_cvt_pk_bf16_f32 v107, v122, v123
    v_mfma_f32_16x16x32_bf16 v[124:127], a[56:59], v[196:199], v[124:127]
    buffer_store_dwordx4 v[104:107], v6, s[4:7], s37 offen offset:0 sc1
    v_mfma_f32_16x16x32_bf16 v[128:131], a[60:63], v[188:191], v[128:131]
    v_mfma_f32_16x16x32_bf16 v[128:131], a[64:67], v[224:227], v[128:131]
    v_mfma_f32_16x16x32_bf16 v[128:131], a[68:71], v[228:231], v[128:131]
    v_mfma_f32_16x16x32_bf16 v[128:131], a[72:75], v[192:195], v[128:131]
    v_cvt_pk_bf16_f32 v108, v124, v125
    v_cvt_pk_bf16_f32 v109, v126, v127
    v_mfma_f32_16x16x32_bf16 v[128:131], a[76:79], v[196:199], v[128:131]
    s_waitcnt lgkmcnt(0)
    v_mfma_f32_16x16x32_bf16 v[132:135], a[0:3], v[208:211], v[132:135]
    ds_read_b128 v[216:219], v15 offset:22528
    ds_read_b128 v[220:223], v15 offset:23552
    v_mfma_f32_16x16x32_bf16 v[132:135], a[4:7], v[212:215], v[132:135]
    ds_read_b128 v[188:191], v15 offset:24576
    ds_read_b128 v[192:195], v15 offset:25600
    v_mfma_f32_16x16x32_bf16 v[132:135], a[8:11], v[184:187], v[132:135]
    ds_read_b128 v[196:199], v15 offset:26624
    v_mfma_f32_16x16x32_bf16 v[132:135], a[12:15], v[200:203], v[132:135]
    v_cvt_pk_bf16_f32 v110, v128, v129
    v_cvt_pk_bf16_f32 v111, v130, v131
    v_mfma_f32_16x16x32_bf16 v[132:135], a[16:19], v[204:207], v[132:135]
ffn0_part_pad0_9x:
    s_cbranch_execz ffn0_part_padret0
    buffer_store_dwordx4 v[108:111], v6, s[4:7], s37 offen offset:512 sc1
    v_mfma_f32_16x16x32_bf16 v[136:139], a[20:23], v[208:211], v[136:139]
    v_mfma_f32_16x16x32_bf16 v[136:139], a[24:27], v[212:215], v[136:139]
    v_mfma_f32_16x16x32_bf16 v[136:139], a[28:31], v[184:187], v[136:139]
    v_mfma_f32_16x16x32_bf16 v[136:139], a[32:35], v[200:203], v[136:139]
    v_cvt_pk_bf16_f32 v100, v132, v133
    v_cvt_pk_bf16_f32 v101, v134, v135
    v_mfma_f32_16x16x32_bf16 v[136:139], a[36:39], v[204:207], v[136:139]
    v_mfma_f32_16x16x32_bf16 v[140:143], a[40:43], v[208:211], v[140:143]
    v_mfma_f32_16x16x32_bf16 v[140:143], a[44:47], v[212:215], v[140:143]
    v_mfma_f32_16x16x32_bf16 v[140:143], a[48:51], v[184:187], v[140:143]
    v_mfma_f32_16x16x32_bf16 v[140:143], a[52:55], v[200:203], v[140:143]
    v_cvt_pk_bf16_f32 v102, v136, v137
    v_cvt_pk_bf16_f32 v103, v138, v139
    v_mfma_f32_16x16x32_bf16 v[140:143], a[56:59], v[204:207], v[140:143]
    buffer_store_dwordx4 v[100:103], v6, s[4:7], s38 offen offset:0 sc1
    v_mfma_f32_16x16x32_bf16 v[32:35], a[60:63], v[208:211], v[32:35]
    v_mfma_f32_16x16x32_bf16 v[32:35], a[64:67], v[212:215], v[32:35]
    s_lshl_b32 s13, s22, 12
    v_mfma_f32_16x16x32_bf16 v[32:35], a[68:71], v[184:187], v[32:35]
    s_add_u32 s13, s13, 40370176
    v_mfma_f32_16x16x32_bf16 v[32:35], a[72:75], v[200:203], v[32:35]
    s_lshl_b32 s14, s22, 4
    v_cvt_pk_bf16_f32 v168, v140, v141
    v_cvt_pk_bf16_f32 v169, v142, v143
    v_mfma_f32_16x16x32_bf16 v[32:35], a[76:79], v[204:207], v[32:35]
    s_add_u32 s14, s14, s21
    v_mfma_f32_16x16x32_bf16 v[144:147], a[80:83], v[208:211], v[144:147]
    s_lshl_b32 s14, s14, 8
    v_mfma_f32_16x16x32_bf16 v[144:147], a[84:87], v[212:215], v[144:147]
    s_lshl_b32 s15, s20, 2
    v_mfma_f32_16x16x32_bf16 v[144:147], a[88:91], v[184:187], v[144:147]
    s_add_u32 s14, s14, s15
    v_mfma_f32_16x16x32_bf16 v[144:147], a[92:95], v[200:203], v[144:147]
    s_add_u32 s14, s14, 40370176
    v_cvt_pk_bf16_f32 v170, v32, v33
    v_cvt_pk_bf16_f32 v171, v34, v35
    v_mfma_f32_16x16x32_bf16 v[144:147], a[96:99], v[204:207], v[144:147]
    s_waitcnt lgkmcnt(0)
    v_mfma_f32_16x16x32_bf16 v[176:179], a[0:3], v[216:219], v[176:179]
    s_barrier
    ds_read_b128 v[224:227], v11 offset:41984
    ds_read_b128 v[228:231], v11 offset:43008
    v_mfma_f32_16x16x32_bf16 v[176:179], a[4:7], v[220:223], v[176:179]
    s_bfe_u32 s21, s2, 0x20001
    ds_read_b128 v[184:187], v11 offset:44032
    ds_read_b128 v[200:203], v11 offset:45056
    v_mfma_f32_16x16x32_bf16 v[176:179], a[8:11], v[188:191], v[176:179]
    buffer_store_dwordx4 v[168:171], v6, s[4:7], s38 offen offset:512 sc1
    v_mfma_f32_16x16x32_bf16 v[176:179], a[12:15], v[192:195], v[176:179]
    s_lshl_b32 s21, s21, 2
    v_cvt_pk_bf16_f32 v174, v144, v145
    v_cvt_pk_bf16_f32 v175, v146, v147
    v_mfma_f32_16x16x32_bf16 v[176:179], a[16:19], v[196:199], v[176:179]
    s_bfe_u32 s22, s2, 0x20003
    v_mfma_f32_16x16x32_bf16 v[36:39], a[20:23], v[216:219], v[36:39]
    s_add_u32 s21, s21, s22
    v_permlane32_swap_b32 v172, v174
    v_mfma_f32_16x16x32_bf16 v[36:39], a[24:27], v[220:223], v[36:39]
    s_and_b32 s22, s2, 1
    v_permlane32_swap_b32 v173, v175
    v_mfma_f32_16x16x32_bf16 v[36:39], a[28:31], v[188:191], v[36:39]
    s_lshl_b32 s22, s22, 3
    v_mfma_f32_16x16x32_bf16 v[36:39], a[32:35], v[192:195], v[36:39]
    buffer_store_dwordx4 v[172:175], v7, s[4:7], s36 offen sc1
    v_mfma_f32_16x16x32_bf16 v[36:39], a[36:39], v[196:199], v[36:39]
    s_lshr_b32 s15, s2, 5
    v_cvt_pk_bf16_f32 v104, v176, v177
    v_cvt_pk_bf16_f32 v105, v178, v179
    v_mfma_f32_16x16x32_bf16 v[180:183], a[40:43], v[216:219], v[180:183]
    s_add_u32 s22, s22, s15
    v_mfma_f32_16x16x32_bf16 v[180:183], a[44:47], v[220:223], v[180:183]
    s_lshl_b32 s15, s16, 12
    v_mfma_f32_16x16x32_bf16 v[180:183], a[48:51], v[188:191], v[180:183]
    s_add_u32 s15, s15, 40370176
    v_mfma_f32_16x16x32_bf16 v[180:183], a[52:55], v[192:195], v[180:183]
    s_lshl_b32 s27, s16, 4
    v_cvt_pk_bf16_f32 v106, v36, v37
    v_cvt_pk_bf16_f32 v107, v38, v39
    v_mfma_f32_16x16x32_bf16 v[180:183], a[56:59], v[196:199], v[180:183]
    s_lshr_b32 s28, s20, 1
    v_mfma_f32_16x16x32_bf16 v[40:43], a[60:63], v[216:219], v[40:43]
    s_sub_u32 s28, s27, s28
    v_mfma_f32_16x16x32_bf16 v[40:43], a[64:67], v[220:223], v[40:43]
    s_mul_i32 s44, s28, 77824
    v_mfma_f32_16x16x32_bf16 v[40:43], a[68:71], v[188:191], v[40:43]
    s_lshl_b32 s28, s17, 1
    v_mfma_f32_16x16x32_bf16 v[40:43], a[72:75], v[192:195], v[40:43]
    buffer_store_dwordx4 v[104:107], v6, s[4:7], s39 offen offset:0 sc1
    v_mfma_f32_16x16x32_bf16 v[40:43], a[76:79], v[196:199], v[40:43]
    s_waitcnt lgkmcnt(0)
    v_cvt_pk_bf16_f32 v108, v180, v181
    v_cvt_pk_bf16_f32 v109, v182, v183
    v_mfma_f32_16x16x32_bf16 v[148:151], a[216:219], v[224:227], v[148:151]
    s_and_b32 s27, s20, 1
    ds_read_b128 v[204:207], v12 offset:36864
    ds_read_b128 v[208:211], v12 offset:37888
    v_mfma_f32_16x16x32_bf16 v[148:151], a[220:223], v[228:231], v[148:151]
    s_add_u32 s28, s28, s27
    ds_read_b128 v[212:215], v12 offset:38912
    ds_read_b128 v[188:191], v12 offset:39936
    v_mfma_f32_16x16x32_bf16 v[148:151], a[224:227], v[184:187], v[148:151]
    s_mul_i32 s28, s28, 2304
    v_mfma_f32_16x16x32_bf16 v[148:151], a[228:231], v[200:203], v[148:151]
    s_add_u32 s44, s44, s28
    v_cvt_pk_bf16_f32 v110, v40, v41
    v_cvt_pk_bf16_f32 v111, v42, v43
    v_mfma_f32_16x16x32_bf16 v[44:47], a[232:235], v[224:227], v[44:47]
    s_add_u32 s44, s44, 125906944
    v_mfma_f32_16x16x32_bf16 v[44:47], a[236:239], v[228:231], v[44:47]
    s_lshl_b32 s18, 1, s17
    v_mfma_f32_16x16x32_bf16 v[44:47], a[240:243], v[184:187], v[44:47]
    s_lshl_b32 s32, s17, 8
    v_mfma_f32_16x16x32_bf16 v[44:47], a[244:247], v[200:203], v[44:47]
    s_add_u32 s32, s32, s13
    v_mfma_f32_16x16x32_bf16 v[48:51], a[248:251], v[224:227], v[48:51]
    buffer_store_dwordx4 v[108:111], v6, s[4:7], s39 offen offset:512 sc1
    v_mfma_f32_16x16x32_bf16 v[48:51], a[252:255], v[228:231], v[48:51]
    s_lshr_b32 s33, s20, 1
    v_mfma_f32_16x16x32_bf16 v[48:51], a[100:103], v[184:187], v[48:51]
    s_lshl_b32 s33, s33, 3
    v_mfma_f32_16x16x32_bf16 v[48:51], a[104:107], v[200:203], v[48:51]
    s_or_b32 s33, s33, 0x80000
    v_mfma_f32_16x16x32_bf16 v[152:155], a[108:111], v[224:227], v[152:155]
    s_mov_b32 s51, 0
    v_mfma_f32_16x16x32_bf16 v[152:155], a[112:115], v[228:231], v[152:155]
    v_lshrrev_b32 v13, 3, v0
    v_mfma_f32_16x16x32_bf16 v[152:155], a[116:119], v[184:187], v[152:155]
    v_min_u32 v13, 1, v13
    v_mfma_f32_16x16x32_bf16 v[152:155], a[120:123], v[200:203], v[152:155]
    v_lshlrev_b32 v13, 28, v13
    v_mfma_f32_16x16x32_bf16 v[52:55], a[124:127], v[224:227], v[52:55]
    v_lshl_add_u32 v13, v0, 8, v13
    v_mfma_f32_16x16x32_bf16 v[52:55], a[128:131], v[228:231], v[52:55]
    v_mov_b32 v255, s18
    v_mfma_f32_16x16x32_bf16 v[52:55], a[132:135], v[184:187], v[52:55]
    v_bfe_u32 v10, v0, 4, 2
    v_mfma_f32_16x16x32_bf16 v[52:55], a[136:139], v[200:203], v[52:55]
    s_waitcnt vmcnt(8) lgkmcnt(0)
    v_lshl_add_u32 v10, v10, 28, v1
    v_mfma_f32_16x16x32_bf16 v[148:151], a[140:143], v[204:207], v[148:151]
    s_barrier
    ds_read_b128 v[192:195], v12 offset:40960
    ds_read_b128 v[196:199], v12 offset:41984
    v_mfma_f32_16x16x32_bf16 v[148:151], a[144:147], v[208:211], v[148:151]
    ds_read_b128 v[216:219], v12 offset:43008
    ds_read_b128 v[220:223], v12 offset:44032
    v_mfma_f32_16x16x32_bf16 v[148:151], a[148:151], v[212:215], v[148:151]
    ds_read_b128 v[184:187], v12 offset:45056
    v_min_u32 v2, 1, v1
    v_mfma_f32_16x16x32_bf16 v[148:151], a[152:155], v[188:191], v[148:151]
    v_lshlrev_b32 v2, 28, v2
    v_mfma_f32_16x16x32_bf16 v[44:47], a[156:159], v[204:207], v[44:47]
    v_mov_b32 v254, 0
    v_mfma_f32_16x16x32_bf16 v[44:47], a[160:163], v[208:211], v[44:47]
    v_mfma_f32_16x16x32_bf16 v[44:47], a[164:167], v[212:215], v[44:47]
    v_mfma_f32_16x16x32_bf16 v[44:47], a[168:171], v[188:191], v[44:47]
    v_mfma_f32_16x16x32_bf16 v[48:51], a[172:175], v[204:207], v[48:51]
    v_mfma_f32_16x16x32_bf16 v[48:51], a[176:179], v[208:211], v[48:51]
    v_mfma_f32_16x16x32_bf16 v[48:51], a[180:183], v[212:215], v[48:51]
    v_mfma_f32_16x16x32_bf16 v[48:51], a[184:187], v[188:191], v[48:51]
    v_mfma_f32_16x16x32_bf16 v[152:155], a[188:191], v[204:207], v[152:155]
    v_mfma_f32_16x16x32_bf16 v[152:155], a[192:195], v[208:211], v[152:155]
    v_mfma_f32_16x16x32_bf16 v[152:155], a[196:199], v[212:215], v[152:155]
    v_mfma_f32_16x16x32_bf16 v[152:155], a[200:203], v[188:191], v[152:155]
    v_mfma_f32_16x16x32_bf16 v[52:55], a[204:207], v[204:207], v[52:55]
    v_mfma_f32_16x16x32_bf16 v[52:55], a[208:211], v[208:211], v[52:55]
    v_mfma_f32_16x16x32_bf16 v[52:55], a[212:215], v[212:215], v[52:55]
    v_mfma_f32_16x16x32_bf16 v[52:55], v[160:163], v[188:191], v[52:55]
    s_waitcnt lgkmcnt(0)
    v_mfma_f32_16x16x32_bf16 v[148:151], a[0:3], v[192:195], v[148:151]
    ds_read_b128 v[200:203], v14 offset:41984
    ds_read_b128 v[224:227], v14 offset:43008
    v_mfma_f32_16x16x32_bf16 v[148:151], a[4:7], v[196:199], v[148:151]
    ds_read_b128 v[228:231], v14 offset:44032
    ds_read_b128 v[188:191], v14 offset:45056
    v_mfma_f32_16x16x32_bf16 v[148:151], a[8:11], v[216:219], v[148:151]
    v_mfma_f32_16x16x32_bf16 v[148:151], a[12:15], v[220:223], v[148:151]
    v_mfma_f32_16x16x32_bf16 v[148:151], a[16:19], v[184:187], v[148:151]
    v_mfma_f32_16x16x32_bf16 v[44:47], a[20:23], v[192:195], v[44:47]
    v_mfma_f32_16x16x32_bf16 v[44:47], a[24:27], v[196:199], v[44:47]
    v_mfma_f32_16x16x32_bf16 v[44:47], a[28:31], v[216:219], v[44:47]
    v_mfma_f32_16x16x32_bf16 v[44:47], a[32:35], v[220:223], v[44:47]
    v_cvt_pk_bf16_f32 v100, v148, v149
    v_cvt_pk_bf16_f32 v101, v150, v151
    v_mfma_f32_16x16x32_bf16 v[44:47], a[36:39], v[184:187], v[44:47]
    v_mfma_f32_16x16x32_bf16 v[48:51], a[40:43], v[192:195], v[48:51]
    v_mfma_f32_16x16x32_bf16 v[48:51], a[44:47], v[196:199], v[48:51]
    v_mfma_f32_16x16x32_bf16 v[48:51], a[48:51], v[216:219], v[48:51]
    v_mfma_f32_16x16x32_bf16 v[48:51], a[52:55], v[220:223], v[48:51]
    v_cvt_pk_bf16_f32 v102, v44, v45
    v_cvt_pk_bf16_f32 v103, v46, v47
    v_mfma_f32_16x16x32_bf16 v[48:51], a[56:59], v[184:187], v[48:51]
    buffer_store_dwordx4 v[100:103], v6, s[4:7], s40 offen offset:0 sc1
    v_mfma_f32_16x16x32_bf16 v[152:155], a[60:63], v[192:195], v[152:155]
    v_mfma_f32_16x16x32_bf16 v[152:155], a[64:67], v[196:199], v[152:155]
    v_mfma_f32_16x16x32_bf16 v[152:155], a[68:71], v[216:219], v[152:155]
    v_mfma_f32_16x16x32_bf16 v[152:155], a[72:75], v[220:223], v[152:155]
    v_cvt_pk_bf16_f32 v168, v48, v49
    v_cvt_pk_bf16_f32 v169, v50, v51
    v_mfma_f32_16x16x32_bf16 v[152:155], a[76:79], v[184:187], v[152:155]
    v_mfma_f32_16x16x32_bf16 v[52:55], a[80:83], v[192:195], v[52:55]
    v_mfma_f32_16x16x32_bf16 v[52:55], a[84:87], v[196:199], v[52:55]
    v_mfma_f32_16x16x32_bf16 v[52:55], a[88:91], v[216:219], v[52:55]
    v_mfma_f32_16x16x32_bf16 v[52:55], a[92:95], v[220:223], v[52:55]
    v_cvt_pk_bf16_f32 v170, v152, v153
    v_cvt_pk_bf16_f32 v171, v154, v155
    v_mfma_f32_16x16x32_bf16 v[52:55], a[96:99], v[184:187], v[52:55]
    s_waitcnt lgkmcnt(0)
    v_mfma_f32_16x16x32_bf16 v[56:59], a[216:219], v[200:203], v[56:59]
    ds_read_b128 v[204:207], v15 offset:36864
    ds_read_b128 v[208:211], v15 offset:37888
    v_mfma_f32_16x16x32_bf16 v[56:59], a[220:223], v[224:227], v[56:59]
    ds_read_b128 v[212:215], v15 offset:38912
    ds_read_b128 v[184:187], v15 offset:39936
    v_mfma_f32_16x16x32_bf16 v[56:59], a[224:227], v[228:231], v[56:59]
    buffer_store_dwordx4 v[168:171], v6, s[4:7], s40 offen offset:512 sc1
    v_mfma_f32_16x16x32_bf16 v[56:59], a[228:231], v[188:191], v[56:59]
    v_cvt_pk_bf16_f32 v172, v52, v53
    v_cvt_pk_bf16_f32 v173, v54, v55
    v_mfma_f32_16x16x32_bf16 v[60:63], a[232:235], v[200:203], v[60:63]
    v_mfma_f32_16x16x32_bf16 v[60:63], a[236:239], v[224:227], v[60:63]
    v_mfma_f32_16x16x32_bf16 v[60:63], a[240:243], v[228:231], v[60:63]
    v_mfma_f32_16x16x32_bf16 v[60:63], a[244:247], v[188:191], v[60:63]
    v_mfma_f32_16x16x32_bf16 v[64:67], a[248:251], v[200:203], v[64:67]
    v_mfma_f32_16x16x32_bf16 v[64:67], a[252:255], v[224:227], v[64:67]
    v_mfma_f32_16x16x32_bf16 v[64:67], a[100:103], v[228:231], v[64:67]
    v_mfma_f32_16x16x32_bf16 v[64:67], a[104:107], v[188:191], v[64:67]
    v_mfma_f32_16x16x32_bf16 v[156:159], a[108:111], v[200:203], v[156:159]
    v_mfma_f32_16x16x32_bf16 v[156:159], a[112:115], v[224:227], v[156:159]
    s_waitcnt vmcnt(2)
    v_mfma_f32_16x16x32_bf16 v[156:159], a[116:119], v[228:231], v[156:159]
    s_barrier
    v_mfma_f32_16x16x32_bf16 v[156:159], a[120:123], v[188:191], v[156:159]
    s_waitcnt lgkmcnt(0)
    v_mfma_f32_16x16x32_bf16 v[56:59], a[140:143], v[204:207], v[56:59]
    ds_read_b128 v[192:195], v15 offset:40960
    ds_read_b128 v[196:199], v15 offset:41984
    v_mfma_f32_16x16x32_bf16 v[56:59], a[144:147], v[208:211], v[56:59]
    ds_read_b128 v[216:219], v15 offset:43008
    ds_read_b128 v[220:223], v15 offset:44032
    v_mfma_f32_16x16x32_bf16 v[56:59], a[148:151], v[212:215], v[56:59]
    ds_read_b128 v[188:191], v15 offset:45056
    v_mfma_f32_16x16x32_bf16 v[56:59], a[152:155], v[184:187], v[56:59]
    buffer_atomic_add v255, v13, s[4:7], s13 offen offset:128 sc1
    v_mfma_f32_16x16x32_bf16 v[60:63], a[156:159], v[204:207], v[60:63]
    v_mfma_f32_16x16x32_bf16 v[60:63], a[160:163], v[208:211], v[60:63]
    v_mfma_f32_16x16x32_bf16 v[60:63], a[164:167], v[212:215], v[60:63]
    v_mfma_f32_16x16x32_bf16 v[60:63], a[168:171], v[184:187], v[60:63]
    v_mfma_f32_16x16x32_bf16 v[64:67], a[172:175], v[204:207], v[64:67]
    v_mfma_f32_16x16x32_bf16 v[64:67], a[176:179], v[208:211], v[64:67]
    v_mfma_f32_16x16x32_bf16 v[64:67], a[180:183], v[212:215], v[64:67]
    buffer_atomic_add v254, v2, s[4:7], s32 offen offset:128 sc0 sc1
    v_mfma_f32_16x16x32_bf16 v[64:67], a[184:187], v[184:187], v[64:67]
    v_mfma_f32_16x16x32_bf16 v[156:159], a[188:191], v[204:207], v[156:159]
    v_mfma_f32_16x16x32_bf16 v[156:159], a[192:195], v[208:211], v[156:159]
    v_mfma_f32_16x16x32_bf16 v[156:159], a[196:199], v[212:215], v[156:159]
    v_mfma_f32_16x16x32_bf16 v[156:159], a[200:203], v[184:187], v[156:159]
    s_waitcnt lgkmcnt(0)
    v_mfma_f32_16x16x32_bf16 v[56:59], a[0:3], v[192:195], v[56:59]
    ds_read_b128 v[200:203], v11 offset:60416
    ds_read_b128 v[224:227], v11 offset:61440
    v_mfma_f32_16x16x32_bf16 v[56:59], a[4:7], v[196:199], v[56:59]
    ds_read_b128 v[228:231], v11 offset:62464
    ds_read_b128 v[184:187], v11 offset:63488
    v_mfma_f32_16x16x32_bf16 v[56:59], a[8:11], v[216:219], v[56:59]
    v_mfma_f32_16x16x32_bf16 v[56:59], a[12:15], v[220:223], v[56:59]
    v_mfma_f32_16x16x32_bf16 v[56:59], a[16:19], v[188:191], v[56:59]
    v_mfma_f32_16x16x32_bf16 v[60:63], a[20:23], v[192:195], v[60:63]
    v_mfma_f32_16x16x32_bf16 v[60:63], a[24:27], v[196:199], v[60:63]
    v_mfma_f32_16x16x32_bf16 v[60:63], a[28:31], v[216:219], v[60:63]
    v_mfma_f32_16x16x32_bf16 v[60:63], a[32:35], v[220:223], v[60:63]
    v_cvt_pk_bf16_f32 v104, v56, v57
    v_cvt_pk_bf16_f32 v105, v58, v59
    v_mfma_f32_16x16x32_bf16 v[60:63], a[36:39], v[188:191], v[60:63]
    v_mfma_f32_16x16x32_bf16 v[64:67], a[40:43], v[192:195], v[64:67]
    v_mfma_f32_16x16x32_bf16 v[64:67], a[44:47], v[196:199], v[64:67]
    v_mfma_f32_16x16x32_bf16 v[64:67], a[48:51], v[216:219], v[64:67]
    v_mfma_f32_16x16x32_bf16 v[64:67], a[52:55], v[220:223], v[64:67]
    v_cvt_pk_bf16_f32 v106, v60, v61
    v_cvt_pk_bf16_f32 v107, v62, v63
    v_mfma_f32_16x16x32_bf16 v[64:67], a[56:59], v[188:191], v[64:67]
    buffer_store_dwordx4 v[104:107], v6, s[4:7], s41 offen offset:0 sc1
    v_mfma_f32_16x16x32_bf16 v[156:159], a[60:63], v[192:195], v[156:159]
    v_mfma_f32_16x16x32_bf16 v[156:159], a[64:67], v[196:199], v[156:159]
    v_mfma_f32_16x16x32_bf16 v[156:159], a[68:71], v[216:219], v[156:159]
    v_mfma_f32_16x16x32_bf16 v[156:159], a[72:75], v[220:223], v[156:159]
    v_cvt_pk_bf16_f32 v108, v64, v65
    v_cvt_pk_bf16_f32 v109, v66, v67
    v_mfma_f32_16x16x32_bf16 v[156:159], a[76:79], v[188:191], v[156:159]
    s_waitcnt lgkmcnt(0)
    v_mfma_f32_16x16x32_bf16 v[68:71], a[216:219], v[200:203], v[68:71]
    ds_read_b128 v[204:207], v12 offset:55296
    ds_read_b128 v[208:211], v12 offset:56320
    v_mfma_f32_16x16x32_bf16 v[68:71], a[220:223], v[224:227], v[68:71]
    ds_read_b128 v[212:215], v12 offset:57344
    ds_read_b128 v[188:191], v12 offset:58368
    v_mfma_f32_16x16x32_bf16 v[68:71], a[224:227], v[228:231], v[68:71]
    v_mfma_f32_16x16x32_bf16 v[68:71], a[228:231], v[184:187], v[68:71]
    v_cvt_pk_bf16_f32 v110, v156, v157
    v_cvt_pk_bf16_f32 v111, v158, v159
    v_mfma_f32_16x16x32_bf16 v[72:75], a[232:235], v[200:203], v[72:75]
    buffer_store_dwordx4 v[108:111], v6, s[4:7], s41 offen offset:512 sc1
    v_mfma_f32_16x16x32_bf16 v[72:75], a[236:239], v[224:227], v[72:75]
    v_mfma_f32_16x16x32_bf16 v[72:75], a[240:243], v[228:231], v[72:75]
    v_mfma_f32_16x16x32_bf16 v[72:75], a[244:247], v[184:187], v[72:75]
    v_mfma_f32_16x16x32_bf16 v[76:79], a[248:251], v[200:203], v[76:79]
    v_mfma_f32_16x16x32_bf16 v[76:79], a[252:255], v[224:227], v[76:79]
    v_mfma_f32_16x16x32_bf16 v[76:79], a[100:103], v[228:231], v[76:79]
    v_mfma_f32_16x16x32_bf16 v[76:79], a[104:107], v[184:187], v[76:79]
    v_mfma_f32_16x16x32_bf16 v[80:83], a[108:111], v[200:203], v[80:83]
    v_mfma_f32_16x16x32_bf16 v[80:83], a[112:115], v[224:227], v[80:83]
    v_mfma_f32_16x16x32_bf16 v[80:83], a[116:119], v[228:231], v[80:83]
    v_mfma_f32_16x16x32_bf16 v[80:83], a[120:123], v[184:187], v[80:83]
    v_mfma_f32_16x16x32_bf16 v[84:87], a[124:127], v[200:203], v[84:87]
    v_mfma_f32_16x16x32_bf16 v[84:87], a[128:131], v[224:227], v[84:87]
    v_mfma_f32_16x16x32_bf16 v[84:87], a[132:135], v[228:231], v[84:87]
    v_mfma_f32_16x16x32_bf16 v[84:87], a[136:139], v[184:187], v[84:87]
    s_waitcnt lgkmcnt(0)
    v_mfma_f32_16x16x32_bf16 v[68:71], a[140:143], v[204:207], v[68:71]
    ds_read_b128 v[192:195], v12 offset:59392
    ds_read_b128 v[196:199], v12 offset:60416
    v_mfma_f32_16x16x32_bf16 v[68:71], a[144:147], v[208:211], v[68:71]
    ds_read_b128 v[216:219], v12 offset:61440
    ds_read_b128 v[220:223], v12 offset:62464
    v_mfma_f32_16x16x32_bf16 v[68:71], a[148:151], v[212:215], v[68:71]
    ds_read_b128 v[184:187], v12 offset:63488
    v_mfma_f32_16x16x32_bf16 v[68:71], a[152:155], v[188:191], v[68:71]
    s_waitcnt vmcnt(2)
    v_readfirstlane_b32 s50, v254
    v_mfma_f32_16x16x32_bf16 v[72:75], a[156:159], v[204:207], v[72:75]
    v_mfma_f32_16x16x32_bf16 v[72:75], a[160:163], v[208:211], v[72:75]
    s_bfe_u32 s50, s50, s33
    v_mfma_f32_16x16x32_bf16 v[72:75], a[164:167], v[212:215], v[72:75]
    s_andn2_b32 s53, s50, s51
    v_mfma_f32_16x16x32_bf16 v[72:75], a[168:171], v[188:191], v[72:75]
    s_ff1_i32_b32 s52, s53
    v_mfma_f32_16x16x32_bf16 v[76:79], a[172:175], v[204:207], v[76:79]
    s_lshl_b32 s27, 1, s52
    v_mfma_f32_16x16x32_bf16 v[76:79], a[176:179], v[208:211], v[76:79]
    s_and_b32 s27, s27, 0xff
    v_mfma_f32_16x16x32_bf16 v[76:79], a[180:183], v[212:215], v[76:79]
    s_or_b32 s51, s51, s27
    v_mfma_f32_16x16x32_bf16 v[76:79], a[184:187], v[188:191], v[76:79]
    s_mul_i32 s52, s52, 155648
    v_mfma_f32_16x16x32_bf16 v[80:83], a[188:191], v[204:207], v[80:83]
    s_add_u32 s52, s52, s44
    v_mfma_f32_16x16x32_bf16 v[80:83], a[192:195], v[208:211], v[80:83]
    s_cmp_eq_u32 s53, 0
    s_cselect_b32 s54, 0x10000000, s52
    v_mfma_f32_16x16x32_bf16 v[80:83], a[196:199], v[212:215], v[80:83]
    buffer_load_dwordx4 v[112:115], v1, s[4:7], s54 offen offset:0 sc1
    v_mfma_f32_16x16x32_bf16 v[80:83], a[200:203], v[188:191], v[80:83]
    s_andn2_b32 s53, s50, s51
    v_mfma_f32_16x16x32_bf16 v[84:87], a[204:207], v[204:207], v[84:87]
    s_ff1_i32_b32 s52, s53
    v_mfma_f32_16x16x32_bf16 v[84:87], a[208:211], v[208:211], v[84:87]
    s_lshl_b32 s27, 1, s52
    v_mfma_f32_16x16x32_bf16 v[84:87], a[212:215], v[212:215], v[84:87]
    buffer_load_dwordx4 v[116:119], v1, s[4:7], s54 offen offset:1024 sc1
    v_mfma_f32_16x16x32_bf16 v[84:87], v[160:163], v[188:191], v[84:87]
    s_waitcnt lgkmcnt(0)
    v_mfma_f32_16x16x32_bf16 v[68:71], a[0:3], v[192:195], v[68:71]
    s_and_b32 s27, s27, 0xff
    ds_read_b128 v[200:203], v14 offset:60416
    ds_read_b128 v[224:227], v14 offset:61440
    v_mfma_f32_16x16x32_bf16 v[68:71], a[4:7], v[196:199], v[68:71]
    s_or_b32 s51, s51, s27
    ds_read_b128 v[228:231], v14 offset:62464
    ds_read_b128 v[188:191], v14 offset:63488
    v_mfma_f32_16x16x32_bf16 v[68:71], a[8:11], v[216:219], v[68:71]
    buffer_load_dwordx4 v[120:123], v10, s[4:7], s54 offen offset:2048 sc1
    v_mfma_f32_16x16x32_bf16 v[68:71], a[12:15], v[220:223], v[68:71]
    s_mul_i32 s52, s52, 155648
    v_mfma_f32_16x16x32_bf16 v[68:71], a[16:19], v[184:187], v[68:71]
    s_add_u32 s52, s52, s44
    v_mfma_f32_16x16x32_bf16 v[72:75], a[20:23], v[192:195], v[72:75]
    s_cmp_eq_u32 s53, 0
    s_cselect_b32 s54, 0x10000000, s52
    v_mfma_f32_16x16x32_bf16 v[72:75], a[24:27], v[196:199], v[72:75]
    buffer_load_dwordx4 v[124:127], v1, s[4:7], s54 offen offset:0 sc1
    v_mfma_f32_16x16x32_bf16 v[72:75], a[28:31], v[216:219], v[72:75]
    s_andn2_b32 s53, s50, s51
    v_mfma_f32_16x16x32_bf16 v[72:75], a[32:35], v[220:223], v[72:75]
    s_ff1_i32_b32 s52, s53
    v_cvt_pk_bf16_f32 v100, v68, v69
    v_cvt_pk_bf16_f32 v101, v70, v71
    v_mfma_f32_16x16x32_bf16 v[72:75], a[36:39], v[184:187], v[72:75]
    s_lshl_b32 s27, 1, s52
    v_mfma_f32_16x16x32_bf16 v[76:79], a[40:43], v[192:195], v[76:79]
    buffer_load_dwordx4 v[128:131], v1, s[4:7], s54 offen offset:1024 sc1
    v_mfma_f32_16x16x32_bf16 v[76:79], a[44:47], v[196:199], v[76:79]
    s_and_b32 s27, s27, 0xff
    v_mfma_f32_16x16x32_bf16 v[76:79], a[48:51], v[216:219], v[76:79]
    s_or_b32 s51, s51, s27
    v_mfma_f32_16x16x32_bf16 v[76:79], a[52:55], v[220:223], v[76:79]
    s_mul_i32 s52, s52, 155648
    v_cvt_pk_bf16_f32 v102, v72, v73
    v_cvt_pk_bf16_f32 v103, v74, v75
    v_mfma_f32_16x16x32_bf16 v[76:79], a[56:59], v[184:187], v[76:79]
    buffer_store_dwordx4 v[100:103], v6, s[4:7], s42 offen offset:0 sc1
    v_mfma_f32_16x16x32_bf16 v[80:83], a[60:63], v[192:195], v[80:83]
    s_add_u32 s52, s52, s44
    v_mfma_f32_16x16x32_bf16 v[80:83], a[64:67], v[196:199], v[80:83]
    v_mfma_f32_16x16x32_bf16 v[80:83], a[68:71], v[216:219], v[80:83]
    v_mfma_f32_16x16x32_bf16 v[80:83], a[72:75], v[220:223], v[80:83]
    v_cvt_pk_bf16_f32 v168, v76, v77
    v_cvt_pk_bf16_f32 v169, v78, v79
    v_mfma_f32_16x16x32_bf16 v[80:83], a[76:79], v[184:187], v[80:83]
    buffer_load_dwordx4 v[132:135], v10, s[4:7], s54 offen offset:2048 sc1
    v_mfma_f32_16x16x32_bf16 v[84:87], a[80:83], v[192:195], v[84:87]
    s_cmp_eq_u32 s53, 0
    s_cselect_b32 s54, 0x10000000, s52
    v_mfma_f32_16x16x32_bf16 v[84:87], a[84:87], v[196:199], v[84:87]
    buffer_load_dwordx4 v[136:139], v1, s[4:7], s54 offen offset:0 sc1
    v_mfma_f32_16x16x32_bf16 v[84:87], a[88:91], v[216:219], v[84:87]
    v_mfma_f32_16x16x32_bf16 v[84:87], a[92:95], v[220:223], v[84:87]
    v_cvt_pk_bf16_f32 v170, v80, v81
    v_cvt_pk_bf16_f32 v171, v82, v83
    v_mfma_f32_16x16x32_bf16 v[84:87], a[96:99], v[184:187], v[84:87]
    s_waitcnt lgkmcnt(0)
    v_mfma_f32_16x16x32_bf16 v[88:91], a[216:219], v[200:203], v[88:91]
    ds_read_b128 v[204:207], v15 offset:55296
    ds_read_b128 v[208:211], v15 offset:56320
    v_mfma_f32_16x16x32_bf16 v[88:91], a[220:223], v[224:227], v[88:91]
    ds_read_b128 v[212:215], v15 offset:57344
    ds_read_b128 v[184:187], v15 offset:58368
    v_mfma_f32_16x16x32_bf16 v[88:91], a[224:227], v[228:231], v[88:91]
    buffer_store_dwordx4 v[168:171], v6, s[4:7], s42 offen offset:512 sc1
    v_mfma_f32_16x16x32_bf16 v[88:91], a[228:231], v[188:191], v[88:91]
    v_cvt_pk_bf16_f32 v174, v84, v85
    v_cvt_pk_bf16_f32 v175, v86, v87
    v_mfma_f32_16x16x32_bf16 v[164:167], a[232:235], v[200:203], v[164:167]
    v_mfma_f32_16x16x32_bf16 v[164:167], a[236:239], v[224:227], v[164:167]
    v_permlane32_swap_b32 v172, v174
    v_mfma_f32_16x16x32_bf16 v[164:167], a[240:243], v[228:231], v[164:167]
    v_permlane32_swap_b32 v173, v175
    v_mfma_f32_16x16x32_bf16 v[164:167], a[244:247], v[188:191], v[164:167]
    v_mfma_f32_16x16x32_bf16 v[92:95], a[248:251], v[200:203], v[92:95]
    buffer_store_dwordx4 v[172:175], v7, s[4:7], s40 offen sc1
    v_mfma_f32_16x16x32_bf16 v[92:95], a[252:255], v[224:227], v[92:95]
    v_mfma_f32_16x16x32_bf16 v[92:95], a[100:103], v[228:231], v[92:95]
    v_mfma_f32_16x16x32_bf16 v[92:95], a[104:107], v[188:191], v[92:95]
    v_mfma_f32_16x16x32_bf16 v[96:99], a[108:111], v[200:203], v[96:99]
    buffer_load_dwordx4 v[140:143], v1, s[4:7], s54 offen offset:1024 sc1
    v_mfma_f32_16x16x32_bf16 v[96:99], a[112:115], v[224:227], v[96:99]
    v_mfma_f32_16x16x32_bf16 v[96:99], a[116:119], v[228:231], v[96:99]
    v_mfma_f32_16x16x32_bf16 v[96:99], a[120:123], v[188:191], v[96:99]
    s_waitcnt lgkmcnt(0)
    v_mfma_f32_16x16x32_bf16 v[88:91], a[140:143], v[204:207], v[88:91]
    ds_read_b128 v[192:195], v15 offset:59392
    ds_read_b128 v[196:199], v15 offset:60416
    v_mfma_f32_16x16x32_bf16 v[88:91], a[144:147], v[208:211], v[88:91]
    ds_read_b128 v[216:219], v15 offset:61440
    ds_read_b128 v[220:223], v15 offset:62464
    v_mfma_f32_16x16x32_bf16 v[88:91], a[148:151], v[212:215], v[88:91]
    ds_read_b128 v[188:191], v15 offset:63488
    v_mfma_f32_16x16x32_bf16 v[88:91], a[152:155], v[184:187], v[88:91]
    buffer_load_dwordx4 v[144:147], v10, s[4:7], s54 offen offset:2048 sc1
    v_mfma_f32_16x16x32_bf16 v[164:167], a[156:159], v[204:207], v[164:167]
    v_mfma_f32_16x16x32_bf16 v[164:167], a[160:163], v[208:211], v[164:167]
    v_mfma_f32_16x16x32_bf16 v[164:167], a[164:167], v[212:215], v[164:167]
    v_mfma_f32_16x16x32_bf16 v[164:167], a[168:171], v[184:187], v[164:167]
    v_mfma_f32_16x16x32_bf16 v[92:95], a[172:175], v[204:207], v[92:95]
    v_mfma_f32_16x16x32_bf16 v[92:95], a[176:179], v[208:211], v[92:95]
    v_mfma_f32_16x16x32_bf16 v[92:95], a[180:183], v[212:215], v[92:95]
    v_mfma_f32_16x16x32_bf16 v[92:95], a[184:187], v[184:187], v[92:95]
    v_mfma_f32_16x16x32_bf16 v[96:99], a[188:191], v[204:207], v[96:99]
    v_mfma_f32_16x16x32_bf16 v[96:99], a[192:195], v[208:211], v[96:99]
    v_mfma_f32_16x16x32_bf16 v[96:99], a[196:199], v[212:215], v[96:99]
    v_mfma_f32_16x16x32_bf16 v[96:99], a[200:203], v[184:187], v[96:99]
    s_waitcnt lgkmcnt(0)
    v_mfma_f32_16x16x32_bf16 v[88:91], a[0:3], v[192:195], v[88:91]
    v_mfma_f32_16x16x32_bf16 v[88:91], a[4:7], v[196:199], v[88:91]
    v_mfma_f32_16x16x32_bf16 v[88:91], a[8:11], v[216:219], v[88:91]
    v_mfma_f32_16x16x32_bf16 v[88:91], a[12:15], v[220:223], v[88:91]
    v_mfma_f32_16x16x32_bf16 v[88:91], a[16:19], v[188:191], v[88:91]
    v_mfma_f32_16x16x32_bf16 v[164:167], a[20:23], v[192:195], v[164:167]
    v_mfma_f32_16x16x32_bf16 v[164:167], a[24:27], v[196:199], v[164:167]
    v_mfma_f32_16x16x32_bf16 v[164:167], a[28:31], v[216:219], v[164:167]
    v_mfma_f32_16x16x32_bf16 v[164:167], a[32:35], v[220:223], v[164:167]
    v_cvt_pk_bf16_f32 v104, v88, v89
    v_cvt_pk_bf16_f32 v105, v90, v91
    v_mfma_f32_16x16x32_bf16 v[164:167], a[36:39], v[188:191], v[164:167]
    v_mfma_f32_16x16x32_bf16 v[92:95], a[40:43], v[192:195], v[92:95]
    v_mfma_f32_16x16x32_bf16 v[92:95], a[44:47], v[196:199], v[92:95]
    v_mfma_f32_16x16x32_bf16 v[92:95], a[48:51], v[216:219], v[92:95]
    v_mfma_f32_16x16x32_bf16 v[92:95], a[52:55], v[220:223], v[92:95]
    v_cvt_pk_bf16_f32 v106, v164, v165
    v_cvt_pk_bf16_f32 v107, v166, v167
    v_mfma_f32_16x16x32_bf16 v[92:95], a[56:59], v[188:191], v[92:95]
    buffer_store_dwordx4 v[104:107], v6, s[4:7], s43 offen offset:0 sc1
    v_mfma_f32_16x16x32_bf16 v[96:99], a[60:63], v[192:195], v[96:99]
    v_mfma_f32_16x16x32_bf16 v[96:99], a[64:67], v[196:199], v[96:99]
    v_mfma_f32_16x16x32_bf16 v[96:99], a[68:71], v[216:219], v[96:99]
    v_mfma_f32_16x16x32_bf16 v[96:99], a[72:75], v[220:223], v[96:99]
    v_cvt_pk_bf16_f32 v108, v92, v93
    v_cvt_pk_bf16_f32 v109, v94, v95
    v_mfma_f32_16x16x32_bf16 v[96:99], a[76:79], v[188:191], v[96:99]
    s_nop 7
    v_cvt_pk_bf16_f32 v110, v96, v97
    v_cvt_pk_bf16_f32 v111, v98, v99
    s_nop 1
    buffer_store_dwordx4 v[108:111], v6, s[4:7], s43 offen offset:512 sc1
    v_and_b32 v2, 63, v0
    v_lshlrev_b32 v1, 4, v2
    v_and_b32 v11, 15, v2
    v_lshrrev_b32 v12, 4, v2
    s_mul_i32 s24, s21, 151552
    s_mul_i32 s27, s20, 36864
    s_add_u32 s24, s24, s27
    s_add_u32 s24, s24, 24117248
    s_lshl_b32 s26, s20, 10
    s_mul_i32 s25, s22, 129024
    s_add_u32 s25, s25, s26
    s_add_u32 s25, s25, 16777216
    s_cmp_lt_u32 s20, 2
    s_cselect_b32 s49, s25, 0x10000000
    v_add_u32 v3, 18432, v1
    v_add_u32 v10, 0x10000, v1
    s_barrier
    s_mov_b32 s50, 0
    s_atomic_add s50, s[4:5], s32 offset:128 glc
    s_lshl_b32 s27, s16, 4
    s_lshr_b32 s28, s20, 1
    s_sub_u32 s28, s27, s28
    s_mul_i32 s44, s28, 77824
    s_lshl_b32 s28, s17, 1
    s_and_b32 s29, s20, 1
    s_add_u32 s28, s28, s29
    s_mul_i32 s28, s28, 2304
    s_add_u32 s44, s44, s28
    s_add_u32 s44, s44, 125906944
    s_bfe_u32 s28, s17, 0x20001
    s_lshl_b32 s28, s28, 2
    s_add_u32 s27, s27, s28
    s_lshr_b32 s28, s17, 3
    s_lshl_b32 s28, s28, 1
    s_add_u32 s27, s27, s28
    s_and_b32 s28, s17, 1
    s_add_u32 s27, s27, s28
    v_and_b32 v8, 7, v2
    v_lshlrev_b32 v9, 2, v8
    s_lshl_b32 s47, s27, 5
    s_add_u32 s28, s47, 39960576
    s_add_u32 s29, s47, 20873216
    s_add_u32 s48, s47, 20905984
    buffer_load_dword v50, v9, s[4:7], s28 offen sc1
    buffer_load_dword v51, v9, s[4:7], s29 offen sc1
    buffer_load_dword v52, v9, s[4:7], s48 offen sc1
    s_mul_i32 s28, s20, 3072
    s_add_u32 s28, s28, 147456
    v_add_u32 v53, s28, v1
    ds_read_b128 v[160:163], v53 offset:0
    ds_read_b128 v[164:167], v53 offset:1024
    ds_read_b128 v[168:171], v53 offset:2048
    v_cmp_gt_u32 vcc, 16, v2
    v_mov_b32 v7, 0x10000000
    v_lshrrev_b32 v4, 3, v2
    v_cndmask_b32 v6, v7, v1, vcc
    v_lshlrev_b32 v4, 8, v4
    v_lshl_add_u32 v4, v8, 4, v4
    v_add_u32 v5, 4096, v4
    v_cndmask_b32 v5, v7, v5, vcc
    s_lshr_b32 s45, s27, 1
    s_mul_i32 s45, s45, 18432
ffn0_part_pad0_10x:
    s_cbranch_execz ffn0_part_padret0
    s_and_b32 s28, s27, 1
    s_lshl_b32 s28, s28, 7
    s_add_u32 s45, s45, s28
    s_mul_i32 s28, s20, 4608
    s_add_u32 s45, s45, s28
    s_mul_i32 s28, s16, 4096
    s_add_u32 s45, s45, s28
    s_lshl_b32 s19, s20, 9
    s_add_u32 s19, s19, s13
    s_mov_b32 s52, 16
    s_mov_b32 m0, s26
    s_mov_b32 s31, s25
    s_waitcnt lgkmcnt(0)
    s_bfe_u32 s50, s50, s33
    v_lshlrev_b32 v172, 16, v160
    v_and_b32 v173, 0xffff0000, v160
    v_lshlrev_b32 v174, 16, v161
    v_and_b32 v175, 0xffff0000, v161
    v_lshlrev_b32 v176, 16, v162
    v_and_b32 v177, 0xffff0000, v162
    v_lshlrev_b32 v178, 16, v163
    v_and_b32 v179, 0xffff0000, v163
    v_lshlrev_b32 v180, 16, v164
    v_and_b32 v181, 0xffff0000, v164
    v_lshlrev_b32 v182, 16, v165
    v_and_b32 v183, 0xffff0000, v165
    v_lshlrev_b32 v184, 16, v166
    v_and_b32 v185, 0xffff0000, v166
    v_lshlrev_b32 v186, 16, v167
    v_and_b32 v187, 0xffff0000, v167
    v_lshlrev_b32 v188, 16, v168
    v_and_b32 v189, 0xffff0000, v168
    v_lshlrev_b32 v190, 16, v169
    v_and_b32 v191, 0xffff0000, v169
    v_lshlrev_b32 v192, 16, v170
    v_and_b32 v193, 0xffff0000, v170
    v_lshlrev_b32 v194, 16, v171
    v_and_b32 v195, 0xffff0000, v171
    s_waitcnt vmcnt(3)
    s_barrier
    s_atomic_add s18, s[4:5], s19 offset:2176
    s_atomic_add s18, s[4:5], s19 offset:2432
    s_andn2_b32 s53, s50, s51
    s_cbranch_scc1 ffn0_part_dwe
    s_cmp_eq_u32 s52, 0
    s_cbranch_scc1 ffn0_part_dwe
ffn0_part_dw:
    buffer_load_dwordx4 v1, s[4:7], s31 offen sc1 lds
    s_addk_i32 m0, 4096
    s_addk_i32 s31, 4096
    s_sub_u32 s52, s52, 1
    s_cmp_lg_u32 s52, 0
    s_cbranch_scc1 ffn0_part_dw
ffn0_part_dwe:
    s_bcnt1_i32_b32 s53, s51
    s_cmp_eq_u32 s53, 1
    s_cbranch_scc1 ffn0_part_en1
    s_cmp_eq_u32 s53, 2
    s_cbranch_scc1 ffn0_part_en2
    s_cmp_eq_u32 s53, 3
    s_cbranch_scc1 ffn0_part_en3
ffn0_part_en0:
    s_andn2_b32 s53, s50, s51
    s_cbranch_scc0 ffn0_part_dp0
ffn0_part_dh0:
    s_ff1_i32_b32 s53, s53
    s_bitset1_b32 s51, s53
    s_mul_i32 s53, s53, 155648
    s_add_u32 s53, s53, s44
    buffer_load_dwordx4 v[112:115], v1, s[4:7], s53 offen offset:0 sc1
    buffer_load_dwordx4 v[116:119], v1, s[4:7], s53 offen offset:1024 sc1
    buffer_load_dwordx4 v[120:123], v6, s[4:7], s53 offen offset:2048 sc1
ffn0_part_en1:
    s_andn2_b32 s53, s50, s51
    s_cbranch_scc0 ffn0_part_dp1
ffn0_part_dh1:
    s_ff1_i32_b32 s53, s53
    s_bitset1_b32 s51, s53
    s_mul_i32 s53, s53, 155648
    s_add_u32 s53, s53, s44
    buffer_load_dwordx4 v[124:127], v1, s[4:7], s53 offen offset:0 sc1
    buffer_load_dwordx4 v[128:131], v1, s[4:7], s53 offen offset:1024 sc1
    buffer_load_dwordx4 v[132:135], v6, s[4:7], s53 offen offset:2048 sc1
ffn0_part_en2:
    s_andn2_b32 s53, s50, s51
    s_cbranch_scc0 ffn0_part_dp2
ffn0_part_dh2:
    s_ff1_i32_b32 s53, s53
    s_bitset1_b32 s51, s53
    s_mul_i32 s53, s53, 155648
    s_add_u32 s53, s53, s44
    buffer_load_dwordx4 v[136:139], v1, s[4:7], s53 offen offset:0 sc1
    buffer_load_dwordx4 v[140:143], v1, s[4:7], s53 offen offset:1024 sc1
    buffer_load_dwordx4 v[144:147], v6, s[4:7], s53 offen offset:2048 sc1
ffn0_part_en3:
    s_andn2_b32 s53, s50, s51
    s_cbranch_scc0 ffn0_part_dp3
ffn0_part_dh3:
    s_ff1_i32_b32 s53, s53
    s_bitset1_b32 s51, s53
    s_mul_i32 s53, s53, 155648
    s_add_u32 s53, s53, s44
    buffer_load_dwordx4 v[64:67], v1, s[4:7], s53 offen offset:0 sc1
    buffer_load_dwordx4 v[68:71], v1, s[4:7], s53 offen offset:1024 sc1
    buffer_load_dwordx4 v[72:75], v6, s[4:7], s53 offen offset:2048 sc1
ffn0_part_en4:
    s_andn2_b32 s53, s50, s51
    s_cbranch_scc0 ffn0_part_dp4
ffn0_part_dh4:
    s_ff1_i32_b32 s53, s53
    s_bitset1_b32 s51, s53
    s_mul_i32 s53, s53, 155648
    s_add_u32 s53, s53, s44
    buffer_load_dwordx4 v[76:79], v1, s[4:7], s53 offen offset:0 sc1
    buffer_load_dwordx4 v[80:83], v1, s[4:7], s53 offen offset:1024 sc1
    buffer_load_dwordx4 v[84:87], v6, s[4:7], s53 offen offset:2048 sc1
ffn0_part_en5:
    s_andn2_b32 s53, s50, s51
    s_cbranch_scc0 ffn0_part_dp5
ffn0_part_dh5:
    s_ff1_i32_b32 s53, s53
    s_bitset1_b32 s51, s53
    s_mul_i32 s53, s53, 155648
    s_add_u32 s53, s53, s44
    buffer_load_dwordx4 v[88:91], v1, s[4:7], s53 offen offset:0 sc1
    buffer_load_dwordx4 v[92:95], v1, s[4:7], s53 offen offset:1024 sc1
    buffer_load_dwordx4 v[96:99], v6, s[4:7], s53 offen offset:2048 sc1
    s_waitcnt vmcnt(17)
    v_lshlrev_b32 v16, 16, v112
    v_and_b32 v17, 0xffff0000, v112
    v_lshlrev_b32 v18, 16, v113
    v_and_b32 v19, 0xffff0000, v113
    v_lshlrev_b32 v20, 16, v114
    v_and_b32 v21, 0xffff0000, v114
    v_lshlrev_b32 v22, 16, v115
    v_and_b32 v23, 0xffff0000, v115
    s_waitcnt vmcnt(16)
    v_lshlrev_b32 v24, 16, v116
    v_and_b32 v25, 0xffff0000, v116
    v_lshlrev_b32 v26, 16, v117
    v_and_b32 v27, 0xffff0000, v117
    v_lshlrev_b32 v28, 16, v118
    v_and_b32 v29, 0xffff0000, v118
    v_lshlrev_b32 v30, 16, v119
    v_and_b32 v31, 0xffff0000, v119
    s_waitcnt vmcnt(15)
    v_lshlrev_b32 v32, 16, v120
    v_and_b32 v33, 0xffff0000, v120
    v_lshlrev_b32 v34, 16, v121
    v_and_b32 v35, 0xffff0000, v121
    v_lshlrev_b32 v36, 16, v122
    v_and_b32 v37, 0xffff0000, v122
    v_lshlrev_b32 v38, 16, v123
    v_and_b32 v39, 0xffff0000, v123
ffn0_part_en6:
    s_andn2_b32 s53, s50, s51
    s_cbranch_scc0 ffn0_part_dp6
ffn0_part_dh6:
    s_ff1_i32_b32 s53, s53
    s_bitset1_b32 s51, s53
    s_mul_i32 s53, s53, 155648
    s_add_u32 s53, s53, s44
    buffer_load_dwordx4 v[100:103], v1, s[4:7], s53 offen offset:0 sc1
    buffer_load_dwordx4 v[104:107], v1, s[4:7], s53 offen offset:1024 sc1
    buffer_load_dwordx4 v[108:111], v6, s[4:7], s53 offen offset:2048 sc1
    s_waitcnt vmcnt(17)
    v_lshlrev_b32 v40, 16, v124
    v_and_b32 v41, 0xffff0000, v124
    v_lshlrev_b32 v42, 16, v125
    v_and_b32 v43, 0xffff0000, v125
    v_lshlrev_b32 v44, 16, v126
    v_and_b32 v45, 0xffff0000, v126
    v_lshlrev_b32 v46, 16, v127
    v_and_b32 v47, 0xffff0000, v127
    v_pk_add_f32 v[16:17], v[16:17], v[40:41]
    v_pk_add_f32 v[18:19], v[18:19], v[42:43]
    v_pk_add_f32 v[20:21], v[20:21], v[44:45]
    v_pk_add_f32 v[22:23], v[22:23], v[46:47]
    s_waitcnt vmcnt(16)
    v_lshlrev_b32 v40, 16, v128
    v_and_b32 v41, 0xffff0000, v128
    v_lshlrev_b32 v42, 16, v129
    v_and_b32 v43, 0xffff0000, v129
    v_lshlrev_b32 v44, 16, v130
    v_and_b32 v45, 0xffff0000, v130
    v_lshlrev_b32 v46, 16, v131
    v_and_b32 v47, 0xffff0000, v131
    v_pk_add_f32 v[24:25], v[24:25], v[40:41]
    v_pk_add_f32 v[26:27], v[26:27], v[42:43]
    v_pk_add_f32 v[28:29], v[28:29], v[44:45]
    v_pk_add_f32 v[30:31], v[30:31], v[46:47]
    s_waitcnt vmcnt(15)
    v_lshlrev_b32 v40, 16, v132
    v_and_b32 v41, 0xffff0000, v132
    v_lshlrev_b32 v42, 16, v133
    v_and_b32 v43, 0xffff0000, v133
    v_lshlrev_b32 v44, 16, v134
    v_and_b32 v45, 0xffff0000, v134
    v_lshlrev_b32 v46, 16, v135
    v_and_b32 v47, 0xffff0000, v135
    v_pk_add_f32 v[32:33], v[32:33], v[40:41]
    v_pk_add_f32 v[34:35], v[34:35], v[42:43]
    v_pk_add_f32 v[36:37], v[36:37], v[44:45]
    v_pk_add_f32 v[38:39], v[38:39], v[46:47]
ffn0_part_en7:
    s_andn2_b32 s53, s50, s51
    s_cbranch_scc0 ffn0_part_dp7
ffn0_part_dh7:
    s_ff1_i32_b32 s53, s53
    s_bitset1_b32 s51, s53
    s_mul_i32 s53, s53, 155648
    s_add_u32 s53, s53, s44
    buffer_load_dwordx4 v[148:151], v1, s[4:7], s53 offen offset:0 sc1
    buffer_load_dwordx4 v[152:155], v1, s[4:7], s53 offen offset:1024 sc1
    buffer_load_dwordx4 v[156:159], v6, s[4:7], s53 offen offset:2048 sc1
    s_waitcnt vmcnt(17)
    v_lshlrev_b32 v40, 16, v136
    v_and_b32 v41, 0xffff0000, v136
    v_lshlrev_b32 v42, 16, v137
    v_and_b32 v43, 0xffff0000, v137
    v_lshlrev_b32 v44, 16, v138
    v_and_b32 v45, 0xffff0000, v138
    v_lshlrev_b32 v46, 16, v139
    v_and_b32 v47, 0xffff0000, v139
    v_pk_add_f32 v[16:17], v[16:17], v[40:41]
    v_pk_add_f32 v[18:19], v[18:19], v[42:43]
    v_pk_add_f32 v[20:21], v[20:21], v[44:45]
    v_pk_add_f32 v[22:23], v[22:23], v[46:47]
    s_waitcnt vmcnt(16)
    v_lshlrev_b32 v40, 16, v140
    v_and_b32 v41, 0xffff0000, v140
    v_lshlrev_b32 v42, 16, v141
    v_and_b32 v43, 0xffff0000, v141
    v_lshlrev_b32 v44, 16, v142
    v_and_b32 v45, 0xffff0000, v142
    v_lshlrev_b32 v46, 16, v143
    v_and_b32 v47, 0xffff0000, v143
    v_pk_add_f32 v[24:25], v[24:25], v[40:41]
    v_pk_add_f32 v[26:27], v[26:27], v[42:43]
    v_pk_add_f32 v[28:29], v[28:29], v[44:45]
    v_pk_add_f32 v[30:31], v[30:31], v[46:47]
    s_waitcnt vmcnt(15)
    v_lshlrev_b32 v40, 16, v144
    v_and_b32 v41, 0xffff0000, v144
    v_lshlrev_b32 v42, 16, v145
    v_and_b32 v43, 0xffff0000, v145
    v_lshlrev_b32 v44, 16, v146
    v_and_b32 v45, 0xffff0000, v146
    v_lshlrev_b32 v46, 16, v147
    v_and_b32 v47, 0xffff0000, v147
    v_pk_add_f32 v[32:33], v[32:33], v[40:41]
    v_pk_add_f32 v[34:35], v[34:35], v[42:43]
    v_pk_add_f32 v[36:37], v[36:37], v[44:45]
    v_pk_add_f32 v[38:39], v[38:39], v[46:47]
    s_waitcnt vmcnt(14)
    v_lshlrev_b32 v40, 16, v64
    v_and_b32 v41, 0xffff0000, v64
    v_lshlrev_b32 v42, 16, v65
    v_and_b32 v43, 0xffff0000, v65
    v_lshlrev_b32 v44, 16, v66
    v_and_b32 v45, 0xffff0000, v66
    v_lshlrev_b32 v46, 16, v67
    v_and_b32 v47, 0xffff0000, v67
    v_pk_add_f32 v[16:17], v[16:17], v[40:41]
    v_pk_add_f32 v[18:19], v[18:19], v[42:43]
    v_pk_add_f32 v[20:21], v[20:21], v[44:45]
    v_pk_add_f32 v[22:23], v[22:23], v[46:47]
    s_waitcnt vmcnt(13)
    v_lshlrev_b32 v40, 16, v68
    v_and_b32 v41, 0xffff0000, v68
    v_lshlrev_b32 v42, 16, v69
    v_and_b32 v43, 0xffff0000, v69
    v_lshlrev_b32 v44, 16, v70
    v_and_b32 v45, 0xffff0000, v70
    v_lshlrev_b32 v46, 16, v71
    v_and_b32 v47, 0xffff0000, v71
    v_pk_add_f32 v[24:25], v[24:25], v[40:41]
    v_pk_add_f32 v[26:27], v[26:27], v[42:43]
    v_pk_add_f32 v[28:29], v[28:29], v[44:45]
    v_pk_add_f32 v[30:31], v[30:31], v[46:47]
    s_waitcnt vmcnt(12)
    v_lshlrev_b32 v40, 16, v72
    v_and_b32 v41, 0xffff0000, v72
    v_lshlrev_b32 v42, 16, v73
    v_and_b32 v43, 0xffff0000, v73
    v_lshlrev_b32 v44, 16, v74
    v_and_b32 v45, 0xffff0000, v74
    v_lshlrev_b32 v46, 16, v75
    v_and_b32 v47, 0xffff0000, v75
    v_pk_add_f32 v[32:33], v[32:33], v[40:41]
    v_pk_add_f32 v[34:35], v[34:35], v[42:43]
    v_pk_add_f32 v[36:37], v[36:37], v[44:45]
    v_pk_add_f32 v[38:39], v[38:39], v[46:47]
    v_mov_b32 v54, 0x3727c5ac
    v_fmac_f32 v54, 0x3ae38e39, v50
    v_rsq_f32 v54, v54
    v_add_f32 v51, v51, v52
    v_mul_f32 v54, 0x40088e99, v54
    s_waitcnt vmcnt(11)
    v_lshlrev_b32 v40, 16, v76
    v_and_b32 v41, 0xffff0000, v76
    v_lshlrev_b32 v42, 16, v77
    v_and_b32 v43, 0xffff0000, v77
    v_lshlrev_b32 v44, 16, v78
    v_and_b32 v45, 0xffff0000, v78
    v_lshlrev_b32 v46, 16, v79
    v_and_b32 v47, 0xffff0000, v79
    v_pk_add_f32 v[16:17], v[16:17], v[40:41]
    v_pk_add_f32 v[18:19], v[18:19], v[42:43]
    v_pk_add_f32 v[20:21], v[20:21], v[44:45]
    v_pk_add_f32 v[22:23], v[22:23], v[46:47]
    s_waitcnt vmcnt(10)
    v_lshlrev_b32 v40, 16, v80
    v_and_b32 v41, 0xffff0000, v80
    v_lshlrev_b32 v42, 16, v81
    v_and_b32 v43, 0xffff0000, v81
    v_lshlrev_b32 v44, 16, v82
    v_and_b32 v45, 0xffff0000, v82
    v_lshlrev_b32 v46, 16, v83
    v_and_b32 v47, 0xffff0000, v83
    v_pk_add_f32 v[24:25], v[24:25], v[40:41]
    v_pk_add_f32 v[26:27], v[26:27], v[42:43]
    v_pk_add_f32 v[28:29], v[28:29], v[44:45]
    v_pk_add_f32 v[30:31], v[30:31], v[46:47]
    s_waitcnt vmcnt(9)
    v_lshlrev_b32 v40, 16, v84
    v_and_b32 v41, 0xffff0000, v84
    v_lshlrev_b32 v42, 16, v85
    v_and_b32 v43, 0xffff0000, v85
    v_lshlrev_b32 v44, 16, v86
    v_and_b32 v45, 0xffff0000, v86
    v_lshlrev_b32 v46, 16, v87
    v_and_b32 v47, 0xffff0000, v87
    v_pk_add_f32 v[32:33], v[32:33], v[40:41]
    v_pk_add_f32 v[34:35], v[34:35], v[42:43]
    v_pk_add_f32 v[36:37], v[36:37], v[44:45]
    v_pk_add_f32 v[38:39], v[38:39], v[46:47]
    s_waitcnt vmcnt(8)
    v_lshlrev_b32 v40, 16, v88
    v_and_b32 v41, 0xffff0000, v88
    v_lshlrev_b32 v42, 16, v89
    v_and_b32 v43, 0xffff0000, v89
    v_lshlrev_b32 v44, 16, v90
    v_and_b32 v45, 0xffff0000, v90
    v_lshlrev_b32 v46, 16, v91
    v_and_b32 v47, 0xffff0000, v91
    v_pk_add_f32 v[16:17], v[16:17], v[40:41]
    v_pk_add_f32 v[18:19], v[18:19], v[42:43]
    v_pk_add_f32 v[20:21], v[20:21], v[44:45]
    v_pk_add_f32 v[22:23], v[22:23], v[46:47]
    s_waitcnt vmcnt(7)
    v_lshlrev_b32 v40, 16, v92
    v_and_b32 v41, 0xffff0000, v92
    v_lshlrev_b32 v42, 16, v93
    v_and_b32 v43, 0xffff0000, v93
    v_lshlrev_b32 v44, 16, v94
    v_and_b32 v45, 0xffff0000, v94
    v_lshlrev_b32 v46, 16, v95
    v_and_b32 v47, 0xffff0000, v95
    v_pk_add_f32 v[24:25], v[24:25], v[40:41]
    v_pk_add_f32 v[26:27], v[26:27], v[42:43]
    v_pk_add_f32 v[28:29], v[28:29], v[44:45]
    v_pk_add_f32 v[30:31], v[30:31], v[46:47]
    s_waitcnt vmcnt(6)
    v_lshlrev_b32 v40, 16, v96
    v_and_b32 v41, 0xffff0000, v96
    v_lshlrev_b32 v42, 16, v97
    v_and_b32 v43, 0xffff0000, v97
    v_lshlrev_b32 v44, 16, v98
    v_and_b32 v45, 0xffff0000, v98
    v_lshlrev_b32 v46, 16, v99
    v_and_b32 v47, 0xffff0000, v99
    v_pk_add_f32 v[32:33], v[32:33], v[40:41]
    v_pk_add_f32 v[34:35], v[34:35], v[42:43]
    v_pk_add_f32 v[36:37], v[36:37], v[44:45]
    v_pk_add_f32 v[38:39], v[38:39], v[46:47]
    s_waitcnt vmcnt(5)
    v_lshlrev_b32 v40, 16, v100
    v_and_b32 v41, 0xffff0000, v100
    v_lshlrev_b32 v42, 16, v101
    v_and_b32 v43, 0xffff0000, v101
    v_lshlrev_b32 v44, 16, v102
    v_and_b32 v45, 0xffff0000, v102
    v_lshlrev_b32 v46, 16, v103
    v_and_b32 v47, 0xffff0000, v103
    v_pk_add_f32 v[16:17], v[16:17], v[40:41]
    v_pk_add_f32 v[18:19], v[18:19], v[42:43]
    v_pk_add_f32 v[20:21], v[20:21], v[44:45]
    v_pk_add_f32 v[22:23], v[22:23], v[46:47]
    s_waitcnt vmcnt(4)
    v_lshlrev_b32 v40, 16, v104
    v_and_b32 v41, 0xffff0000, v104
    v_lshlrev_b32 v42, 16, v105
    v_and_b32 v43, 0xffff0000, v105
    v_lshlrev_b32 v44, 16, v106
    v_and_b32 v45, 0xffff0000, v106
    v_lshlrev_b32 v46, 16, v107
    v_and_b32 v47, 0xffff0000, v107
    v_pk_add_f32 v[24:25], v[24:25], v[40:41]
    v_pk_add_f32 v[26:27], v[26:27], v[42:43]
    v_pk_add_f32 v[28:29], v[28:29], v[44:45]
    v_pk_add_f32 v[30:31], v[30:31], v[46:47]
    s_waitcnt vmcnt(3)
    v_lshlrev_b32 v40, 16, v108
    v_and_b32 v41, 0xffff0000, v108
    v_lshlrev_b32 v42, 16, v109
    v_and_b32 v43, 0xffff0000, v109
    v_lshlrev_b32 v44, 16, v110
    v_and_b32 v45, 0xffff0000, v110
    v_lshlrev_b32 v46, 16, v111
    v_and_b32 v47, 0xffff0000, v111
    v_pk_add_f32 v[32:33], v[32:33], v[40:41]
    v_pk_add_f32 v[34:35], v[34:35], v[42:43]
    v_pk_add_f32 v[36:37], v[36:37], v[44:45]
    v_pk_add_f32 v[38:39], v[38:39], v[46:47]
    s_waitcnt vmcnt(2)
    v_lshlrev_b32 v40, 16, v148
    v_and_b32 v41, 0xffff0000, v148
    v_lshlrev_b32 v42, 16, v149
    v_and_b32 v43, 0xffff0000, v149
    v_lshlrev_b32 v44, 16, v150
    v_and_b32 v45, 0xffff0000, v150
    v_lshlrev_b32 v46, 16, v151
    v_and_b32 v47, 0xffff0000, v151
    v_pk_add_f32 v[16:17], v[16:17], v[40:41]
    v_pk_add_f32 v[18:19], v[18:19], v[42:43]
    v_pk_add_f32 v[20:21], v[20:21], v[44:45]
    v_pk_add_f32 v[22:23], v[22:23], v[46:47]
    s_waitcnt vmcnt(1)
    v_lshlrev_b32 v40, 16, v152
    v_and_b32 v41, 0xffff0000, v152
    v_lshlrev_b32 v42, 16, v153
    v_and_b32 v43, 0xffff0000, v153
    v_lshlrev_b32 v44, 16, v154
    v_and_b32 v45, 0xffff0000, v154
    v_lshlrev_b32 v46, 16, v155
    v_and_b32 v47, 0xffff0000, v155
    v_pk_add_f32 v[24:25], v[24:25], v[40:41]
    v_pk_add_f32 v[26:27], v[26:27], v[42:43]
    v_pk_add_f32 v[28:29], v[28:29], v[44:45]
    v_pk_add_f32 v[30:31], v[30:31], v[46:47]
    s_waitcnt vmcnt(0)
    v_lshlrev_b32 v40, 16, v156
    v_and_b32 v41, 0xffff0000, v156
    v_lshlrev_b32 v42, 16, v157
    v_and_b32 v43, 0xffff0000, v157
    v_lshlrev_b32 v44, 16, v158
    v_and_b32 v45, 0xffff0000, v158
    v_lshlrev_b32 v46, 16, v159
    v_and_b32 v47, 0xffff0000, v159
    v_pk_add_f32 v[32:33], v[32:33], v[40:41]
    v_pk_add_f32 v[34:35], v[34:35], v[42:43]
    v_pk_add_f32 v[36:37], v[36:37], v[44:45]
    v_pk_add_f32 v[38:39], v[38:39], v[46:47]
    v_pk_fma_f32 v[16:17], v[16:17], v[54:55], v[172:173] op_sel_hi:[1,0,1]
    v_pk_fma_f32 v[18:19], v[18:19], v[54:55], v[174:175] op_sel_hi:[1,0,1]
    v_pk_fma_f32 v[20:21], v[20:21], v[54:55], v[176:177] op_sel_hi:[1,0,1]
    v_pk_fma_f32 v[22:23], v[22:23], v[54:55], v[178:179] op_sel_hi:[1,0,1]
    v_pk_fma_f32 v[24:25], v[24:25], v[54:55], v[180:181] op_sel_hi:[1,0,1]
    v_pk_fma_f32 v[26:27], v[26:27], v[54:55], v[182:183] op_sel_hi:[1,0,1]
    v_pk_fma_f32 v[28:29], v[28:29], v[54:55], v[184:185] op_sel_hi:[1,0,1]
    v_pk_fma_f32 v[30:31], v[30:31], v[54:55], v[186:187] op_sel_hi:[1,0,1]
    v_pk_fma_f32 v[32:33], v[32:33], v[54:55], v[188:189] op_sel_hi:[1,0,1]
    v_pk_fma_f32 v[34:35], v[34:35], v[54:55], v[190:191] op_sel_hi:[1,0,1]
    v_pk_fma_f32 v[36:37], v[36:37], v[54:55], v[192:193] op_sel_hi:[1,0,1]
    v_pk_fma_f32 v[38:39], v[38:39], v[54:55], v[194:195] op_sel_hi:[1,0,1]
    v_pk_add_f32 v[48:49], v[16:17], v[18:19]
    v_pk_mul_f32 v[56:57], v[16:17], v[16:17]
    v_pk_fma_f32 v[56:57], v[18:19], v[18:19], v[56:57]
    v_pk_add_f32 v[48:49], v[48:49], v[20:21]
    v_pk_fma_f32 v[56:57], v[20:21], v[20:21], v[56:57]
    v_pk_add_f32 v[48:49], v[48:49], v[22:23]
    v_pk_fma_f32 v[56:57], v[22:23], v[22:23], v[56:57]
    v_pk_add_f32 v[48:49], v[48:49], v[24:25]
    v_pk_fma_f32 v[56:57], v[24:25], v[24:25], v[56:57]
    v_pk_add_f32 v[48:49], v[48:49], v[26:27]
    v_pk_fma_f32 v[56:57], v[26:27], v[26:27], v[56:57]
    v_pk_add_f32 v[48:49], v[48:49], v[28:29]
    v_pk_fma_f32 v[56:57], v[28:29], v[28:29], v[56:57]
    v_pk_add_f32 v[48:49], v[48:49], v[30:31]
    v_pk_fma_f32 v[56:57], v[30:31], v[30:31], v[56:57]
    v_pk_add_f32 v[48:49], v[48:49], v[32:33]
    v_pk_fma_f32 v[56:57], v[32:33], v[32:33], v[56:57]
    v_pk_add_f32 v[48:49], v[48:49], v[34:35]
    v_pk_fma_f32 v[56:57], v[34:35], v[34:35], v[56:57]
    v_pk_add_f32 v[48:49], v[48:49], v[36:37]
    v_pk_fma_f32 v[56:57], v[36:37], v[36:37], v[56:57]
    v_pk_add_f32 v[48:49], v[48:49], v[38:39]
    v_pk_fma_f32 v[56:57], v[38:39], v[38:39], v[56:57]
    v_add_f32 v48, v48, v49
    v_add_f32 v49, v56, v57
    v_lshrrev_b32 v58, 5, v2
    v_lshlrev_b32 v59, 5, v8
    v_add_f32_dpp v48, v48, v48 row_ror:8 row_mask:0xf bank_mask:0xf
    v_add_f32_dpp v49, v49, v49 row_ror:8 row_mask:0xf bank_mask:0xf
    s_lshl_b32 s28, s20, 2
    v_add_u32 v59, 0x20000, v59
    v_permlane32_swap_b32 v48, v49
    v_add_f32 v48, v48, v49
    v_mov_b32 v49, v48
    v_lshl_add_u32 v58, v58, 4, v59
    v_add_u32 v58, s28, v58
    v_permlane16_swap_b32 v48, v49
    v_add_f32 v48, v48, v49
    ds_write_b32 v58, v48
    s_waitcnt lgkmcnt(0)
    s_barrier
    ds_read_b128 v[40:43], v59
    ds_read_b128 v[44:47], v59 offset:16
    s_add_u32 s46, s45, 24117248
    s_add_u32 s28, s47, 40697856
    s_add_u32 s29, s47, 40706048
    s_waitcnt lgkmcnt(0)
    v_pk_add_f32 v[40:41], v[40:41], v[42:43]
    v_pk_add_f32 v[44:45], v[44:45], v[46:47]
    v_add_f32 v40, v40, v41
    v_add_f32 v44, v44, v45
    v_mul_f32 v40, 0xbae38e39, v40
    v_mul_f32 v44, 0x3ae38e39, v44
    v_pk_add_f32 v[16:17], v[16:17], v[40:41] op_sel_hi:[1,0]
    v_pk_add_f32 v[18:19], v[18:19], v[40:41] op_sel_hi:[1,0]
    v_pk_add_f32 v[20:21], v[20:21], v[40:41] op_sel_hi:[1,0]
    v_pk_add_f32 v[22:23], v[22:23], v[40:41] op_sel_hi:[1,0]
    v_cvt_pk_bf16_f32 v160, v16, v17
    v_cvt_pk_bf16_f32 v161, v18, v19
    v_cvt_pk_bf16_f32 v162, v20, v21
    v_cvt_pk_bf16_f32 v163, v22, v23
    buffer_store_dwordx4 v[160:163], v4, s[4:7], s46 offen offset:0 sc1
    v_pk_add_f32 v[24:25], v[24:25], v[40:41] op_sel_hi:[1,0]
    v_pk_add_f32 v[26:27], v[26:27], v[40:41] op_sel_hi:[1,0]
    v_pk_add_f32 v[28:29], v[28:29], v[40:41] op_sel_hi:[1,0]
    v_pk_add_f32 v[30:31], v[30:31], v[40:41] op_sel_hi:[1,0]
    v_cvt_pk_bf16_f32 v164, v24, v25
    v_cvt_pk_bf16_f32 v165, v26, v27
    v_cvt_pk_bf16_f32 v166, v28, v29
    v_cvt_pk_bf16_f32 v167, v30, v31
    buffer_store_dwordx4 v[164:167], v4, s[4:7], s46 offen offset:2048 sc1
    v_pk_add_f32 v[32:33], v[32:33], v[40:41] op_sel_hi:[1,0]
    v_pk_add_f32 v[34:35], v[34:35], v[40:41] op_sel_hi:[1,0]
    v_pk_add_f32 v[36:37], v[36:37], v[40:41] op_sel_hi:[1,0]
    v_pk_add_f32 v[38:39], v[38:39], v[40:41] op_sel_hi:[1,0]
    v_cvt_pk_bf16_f32 v168, v32, v33
    v_cvt_pk_bf16_f32 v169, v34, v35
    v_cvt_pk_bf16_f32 v170, v36, v37
    v_cvt_pk_bf16_f32 v171, v38, v39
    buffer_store_dwordx4 v[168:171], v5, s[4:7], s46 offen offset:0 sc1
    v_fma_f32 v44, -v40, v40, v44
    v_max_f32 v44, 0, v44
    v_add_f32 v44, 0x3727c5ac, v44
    v_rsq_f32 v44, v44
    v_cmp_gt_u32 vcc, 8, v0
    v_sub_f32 v51, v51, v40
    s_nop 0
    v_cndmask_b32 v9, v7, v9, vcc
    buffer_store_dword v44, v9, s[4:7], s28 offen sc1
    buffer_store_dword v51, v9, s[4:7], s29 offen sc1
    s_mov_b32 s8, 0
    s_lshl_b32 s9, s21, 11
    s_add_u32 s9, s9, 40042496
    s_lshl_b32 s27, s22, 7
    s_add_u32 s27, s27, s9
    v_mov_b32 v48, 1
    v_lshlrev_b32 v49, 7, v11
    s_lshl_b32 s9, s16, 11
    s_add_u32 s9, s9, 40042496
    s_add_u32 m0, s26, 65536
    s_add_u32 s31, s25, 65536
    buffer_load_dwordx4 v1, s[4:7], s31 offen sc1 lds
    s_add_u32 m0, s26, 69632
    s_add_u32 s31, s25, 69632
    buffer_load_dwordx4 v1, s[4:7], s31 offen sc1 lds
    s_add_u32 m0, s26, 73728
    s_add_u32 s31, s25, 73728
    buffer_load_dwordx4 v1, s[4:7], s31 offen sc1 lds
    s_add_u32 m0, s26, 77824
    s_add_u32 s31, s25, 77824
    buffer_load_dwordx4 v1, s[4:7], s31 offen sc1 lds
    s_add_u32 m0, s26, 81920
    s_add_u32 s31, s25, 81920
    buffer_load_dwordx4 v1, s[4:7], s31 offen sc1 lds
    s_add_u32 m0, s26, 86016
    s_add_u32 s31, s25, 86016
    buffer_load_dwordx4 v1, s[4:7], s31 offen sc1 lds
    s_add_u32 m0, s26, 90112
    s_add_u32 s31, s25, 90112
    buffer_load_dwordx4 v1, s[4:7], s31 offen sc1 lds
    s_add_u32 m0, s26, 94208
    s_add_u32 s31, s25, 94208
    buffer_load_dwordx4 v1, s[4:7], s31 offen sc1 lds
    s_add_u32 m0, s26, 98304
    s_add_u32 s31, s25, 98304
    buffer_load_dwordx4 v1, s[4:7], s31 offen sc1 lds
    s_add_u32 m0, s26, 102400
    s_add_u32 s31, s25, 102400
    buffer_load_dwordx4 v1, s[4:7], s31 offen sc1 lds
    s_mov_b64 exec, 0
    s_cmp_eq_u32 s20, 0
    s_cbranch_scc1 ffn0_part_pad1_0x
    s_cmp_eq_u32 s20, 1
    s_cbranch_scc1 ffn0_part_pad1_1x
    s_cmp_eq_u32 s20, 2
    s_cbranch_scc1 ffn0_part_padret1
    s_branch ffn0_part_padret1
ffn0_part_padret1:
    s_mov_b64 exec, -1
    s_waitcnt vmcnt(10)
    s_barrier
    s_mul_i32 s50, s20, 512
    s_add_u32 s50, s50, s9
    s_atomic_add s3, s[4:5], s50 offset:0
    s_atomic_add s3, s[4:5], s50 offset:128
    s_atomic_add s3, s[4:5], s50 offset:256
    s_atomic_add s3, s[4:5], s50 offset:384
    s_mov_b32 m0, s26
    s_mov_b32 s31, s25
    s_cmp_eq_u32 s52, 0
    s_cbranch_scc1 ffn0_part_dwze
ffn0_part_dwz:
    buffer_load_dwordx4 v1, s[4:7], s31 offen sc1 lds
    s_addk_i32 m0, 4096
    s_addk_i32 s31, 4096
    s_sub_u32 s52, s52, 1
    s_cmp_lg_u32 s52, 0
    s_cbranch_scc1 ffn0_part_dwz
ffn0_part_dwze:
    s_add_u32 m0, s26, 106496
    s_add_u32 s31, s25, 106496
    buffer_load_dwordx4 v1, s[4:7], s31 offen sc1 lds
    s_add_u32 m0, s26, 110592
    s_add_u32 s31, s25, 110592
    buffer_load_dwordx4 v1, s[4:7], s31 offen sc1 lds
    s_add_u32 m0, s26, 114688
    s_add_u32 s31, s25, 114688
    buffer_load_dwordx4 v1, s[4:7], s31 offen sc1 lds
    s_add_u32 m0, s26, 118784
    s_add_u32 s31, s25, 118784
    buffer_load_dwordx4 v1, s[4:7], s31 offen sc1 lds
    s_add_u32 m0, s26, 122880
    s_add_u32 s31, s25, 122880
    buffer_load_dwordx4 v1, s[4:7], s31 offen sc1 lds
    s_add_u32 m0, s26, 126976
    s_add_u32 s31, s49, 126976
    buffer_load_dwordx4 v1, s[4:7], s31 offen sc1 lds
    s_cmp_lg_u32 s20, 3
    s_cbranch_scc1 ffn0_part_np
ffn0_part_pollc:
    s_mov_b32 s28, 0
    s_atomic_add s28, s[4:5], s27 offset:0 glc
    s_add_u32 s8, s8, 1
    s_waitcnt lgkmcnt(0)
    s_cmp_ge_u32 s28, 16
    s_cbranch_scc1 ffn0_part_pollck
    s_cmp_lt_u32 s8, 0x80000
    s_cbranch_scc1 ffn0_part_pollc
ffn0_part_pollck:
ffn0_part_pk:
    s_barrier
    s_branch ffn0_part_go
ffn0_part_np:
    s_barrier
ffn0_part_go:
    s_add_u32 s30, s24, 0
    buffer_load_dwordx4 a[0:3], v1, s[4:7], s30 offen offset:0 sc1
    buffer_load_dwordx4 a[4:7], v3, s[4:7], s30 offen offset:0 sc1
    buffer_load_dwordx4 a[8:11], v1, s[4:7], s30 offen offset:1024 sc1
    buffer_load_dwordx4 a[12:15], v3, s[4:7], s30 offen offset:1024 sc1
    buffer_load_dwordx4 a[16:19], v1, s[4:7], s30 offen offset:2048 sc1
    buffer_load_dwordx4 a[20:23], v3, s[4:7], s30 offen offset:2048 sc1
    buffer_load_dwordx4 a[24:27], v1, s[4:7], s30 offen offset:3072 sc1
    buffer_load_dwordx4 a[28:31], v3, s[4:7], s30 offen offset:3072 sc1
ffn0_part_pad1_0x:
    s_cbranch_execz ffn0_part_padret1
    s_add_u32 s30, s24, 4096
    buffer_load_dwordx4 a[32:35], v1, s[4:7], s30 offen offset:0 sc1
    buffer_load_dwordx4 a[36:39], v3, s[4:7], s30 offen offset:0 sc1
    s_lshl_b32 s27, s21, 9
    s_lshl_b32 s28, s20, 7
    s_add_u32 s27, s27, s28
    s_add_u32 s27, s27, 40697856
    v_lshlrev_b32 v13, 2, v11
    v_lshlrev_b32 v14, 4, v12
    s_getpc_b64 s[60:61]
ffn0_partq_pc:
    s_add_u32 s60, s60, ffn1_part-ffn0_partq_pc
    s_addc_u32 s61, s61, (ffn1_part-ffn0_partq_pc)>>32
    s_bfe_u32 s62, s2, 0x50003
    s_lshl_b32 s62, s62, 12
    v_and_b32 v190, 31, v0
    v_lshl_add_u32 v190, v190, 7, s62
    v_min_u32 v190, ffn1_part_end-ffn1_part-4, v190
    s_waitcnt vmcnt(10)
    s_barrier
    ds_read_b128 v[80:83], v1 offset:2048
    ds_read_b128 v[84:87], v1 offset:3072
    ds_read_b128 v[88:91], v1 offset:6144
    ds_read_b128 v[92:95], v1 offset:4096
    ds_read_b128 v[96:99], v1 offset:5120
    ds_read_b128 v[100:103], v1 offset:0
    ds_read_b128 v[104:107], v1 offset:1024
    s_waitcnt vmcnt(8) lgkmcnt(4)
    s_mov_b32 s54, 132096
    s_mul_i32 s42, s20, 3072
    s_add_u32 s42, s42, 132096
    s_and_b32 s29, s2, 1
    s_lshl_b32 s29, s29, 1
    s_bfe_u32 s23, s2, 0x10003
    s_add_u32 s29, s29, s23
    s_mul_i32 s29, s29, 3
    s_add_u32 s29, s29, s20
    s_mul_i32 s29, s29, 55296
    s_add_u32 s29, s29, 18939904
    s_cmp_eq_u32 s20, 3
    s_cselect_b32 s29, 0x10000000, s29
    v_mfma_f32_16x16x32_bf16 v[32:35], a[0:3], v[80:83], 0
    ds_read_b128 v[108:111], v1 offset:9216
    ds_read_b128 v[112:115], v1 offset:16384
    v_mfma_f32_16x16x32_bf16 v[36:39], a[4:7], v[80:83], 0
    v_mfma_f32_16x16x32_bf16 v[40:43], a[0:3], v[84:87], 0
    ds_read_b128 v[116:119], v1 offset:10240
    ds_read_b128 v[120:123], v1 offset:17408
    v_mfma_f32_16x16x32_bf16 v[44:47], a[4:7], v[84:87], 0
    buffer_load_dwordx4 a[40:43], v1, s[4:7], s30 offen offset:1024 sc1
    v_mfma_f32_16x16x32_bf16 v[64:67], a[0:3], v[88:91], 0
    v_mfma_f32_16x16x32_bf16 v[68:71], a[4:7], v[88:91], 0
    s_waitcnt lgkmcnt(4)
    v_mfma_f32_16x16x32_bf16 v[48:51], a[0:3], v[92:95], 0
    ds_read_b128 v[124:127], v1 offset:13312
    ds_read_b128 v[128:131], v1 offset:20480
    v_mfma_f32_16x16x32_bf16 v[52:55], a[4:7], v[92:95], 0
    buffer_load_dwordx4 a[44:47], v3, s[4:7], s30 offen offset:1024 sc1
    v_mfma_f32_16x16x32_bf16 v[56:59], a[0:3], v[96:99], 0
    v_mfma_f32_16x16x32_bf16 v[60:63], a[4:7], v[96:99], 0
    v_mfma_f32_16x16x32_bf16 v[16:19], v[100:103], a[0:3], 0
    ds_read_b128 v[132:135], v1 offset:11264
    ds_read_b128 v[80:83], v1 offset:18432
    v_mfma_f32_16x16x32_bf16 v[24:27], v[100:103], a[4:7], 0
    buffer_load_dwordx4 a[48:51], v1, s[4:7], s30 offen offset:2048 sc1
    v_mfma_f32_16x16x32_bf16 v[20:23], v[104:107], a[0:3], 0
    v_mfma_f32_16x16x32_bf16 v[28:31], v[104:107], a[4:7], 0
    s_waitcnt vmcnt(7) lgkmcnt(6)
    v_mfma_f32_16x16x32_bf16 v[32:35], a[8:11], v[108:111], v[32:35]
    ds_read_b128 v[84:87], v1 offset:12288
    ds_read_b128 v[88:91], v1 offset:19456
    v_mfma_f32_16x16x32_bf16 v[32:35], a[16:19], v[112:115], v[32:35]
    buffer_load_dwordx4 a[52:55], v3, s[4:7], s30 offen offset:2048 sc1
    v_mfma_f32_16x16x32_bf16 v[36:39], a[12:15], v[108:111], v[36:39]
    v_mfma_f32_16x16x32_bf16 v[36:39], a[20:23], v[112:115], v[36:39]
    s_waitcnt lgkmcnt(6)
    v_mfma_f32_16x16x32_bf16 v[40:43], a[8:11], v[116:119], v[40:43]
    ds_read_b128 v[92:95], v1 offset:7168
    ds_read_b128 v[96:99], v1 offset:14336
    v_mfma_f32_16x16x32_bf16 v[40:43], a[16:19], v[120:123], v[40:43]
    buffer_load_dwordx4 a[56:59], v1, s[4:7], s30 offen offset:3072 sc1
    v_mfma_f32_16x16x32_bf16 v[44:47], a[12:15], v[116:119], v[44:47]
    v_mfma_f32_16x16x32_bf16 v[44:47], a[20:23], v[120:123], v[44:47]
    s_waitcnt lgkmcnt(6)
    v_mfma_f32_16x16x32_bf16 v[64:67], a[8:11], v[124:127], v[64:67]
    ds_read_b128 v[100:103], v1 offset:8192
    ds_read_b128 v[104:107], v1 offset:15360
    v_mfma_f32_16x16x32_bf16 v[64:67], a[16:19], v[128:131], v[64:67]
    buffer_load_dwordx4 a[60:63], v3, s[4:7], s30 offen offset:3072 sc1
    v_mfma_f32_16x16x32_bf16 v[68:71], a[12:15], v[124:127], v[68:71]
    s_add_u32 s30, s24, 8192
    v_mfma_f32_16x16x32_bf16 v[68:71], a[20:23], v[128:131], v[68:71]
    s_waitcnt lgkmcnt(6)
    v_mfma_f32_16x16x32_bf16 v[48:51], a[8:11], v[132:135], v[48:51]
    ds_read_b128 v[108:111], v1 offset:23552
    ds_read_b128 v[112:115], v1 offset:30720
    v_mfma_f32_16x16x32_bf16 v[48:51], a[16:19], v[80:83], v[48:51]
    ds_read_b128 v[116:119], v1 offset:37888
    v_mfma_f32_16x16x32_bf16 v[52:55], a[12:15], v[132:135], v[52:55]
    buffer_load_dwordx4 a[64:67], v1, s[4:7], s30 offen offset:0 sc1
    v_mfma_f32_16x16x32_bf16 v[52:55], a[20:23], v[80:83], v[52:55]
    s_waitcnt lgkmcnt(7)
    v_mfma_f32_16x16x32_bf16 v[56:59], a[8:11], v[84:87], v[56:59]
    buffer_load_dword v136, v13, s[4:7], s27 offen offset:0 sc1
    v_mfma_f32_16x16x32_bf16 v[56:59], a[16:19], v[88:91], v[56:59]
    v_mfma_f32_16x16x32_bf16 v[60:63], a[12:15], v[84:87], v[60:63]
    ds_read_b128 v[120:123], v1 offset:24576
    ds_read_b128 v[124:127], v1 offset:31744
    v_mfma_f32_16x16x32_bf16 v[60:63], a[20:23], v[88:91], v[60:63]
    s_waitcnt lgkmcnt(7)
    ds_read_b128 v[128:131], v1 offset:38912
    v_mfma_f32_16x16x32_bf16 v[16:19], v[92:95], a[8:11], v[16:19]
    buffer_load_dwordx4 a[68:71], v3, s[4:7], s30 offen offset:0 sc1
    v_mfma_f32_16x16x32_bf16 v[16:19], v[96:99], a[16:19], v[16:19]
    v_mfma_f32_16x16x32_bf16 v[24:27], v[92:95], a[12:15], v[24:27]
    v_mfma_f32_16x16x32_bf16 v[24:27], v[96:99], a[20:23], v[24:27]
    s_waitcnt lgkmcnt(6)
    v_mfma_f32_16x16x32_bf16 v[20:23], v[100:103], a[8:11], v[20:23]
    ds_read_b128 v[132:135], v1 offset:27648
    ds_read_b128 v[80:83], v1 offset:34816
    v_mfma_f32_16x16x32_bf16 v[20:23], v[104:107], a[16:19], v[20:23]
    ds_read_b128 v[84:87], v1 offset:41984
    v_mfma_f32_16x16x32_bf16 v[28:31], v[100:103], a[12:15], v[28:31]
    buffer_load_dwordx4 a[72:75], v1, s[4:7], s30 offen offset:1024 sc1
    v_mfma_f32_16x16x32_bf16 v[28:31], v[104:107], a[20:23], v[28:31]
    s_waitcnt vmcnt(8) lgkmcnt(6)
    v_mfma_f32_16x16x32_bf16 v[32:35], a[24:27], v[108:111], v[32:35]
    buffer_load_dwordx4 v[144:147], v14, s[4:7], s27 offen offset:0 sc1
    v_mfma_f32_16x16x32_bf16 v[32:35], a[32:35], v[112:115], v[32:35]
    v_mfma_f32_16x16x32_bf16 v[32:35], a[40:43], v[116:119], v[32:35]
    ds_read_b128 v[88:91], v1 offset:25600
    ds_read_b128 v[92:95], v1 offset:32768
    v_mfma_f32_16x16x32_bf16 v[36:39], a[28:31], v[108:111], v[36:39]
    ds_read_b128 v[96:99], v1 offset:39936
    v_mfma_f32_16x16x32_bf16 v[36:39], a[36:39], v[112:115], v[36:39]
    buffer_load_dwordx4 a[76:79], v3, s[4:7], s30 offen offset:1024 sc1
    v_mfma_f32_16x16x32_bf16 v[36:39], a[44:47], v[116:119], v[36:39]
    s_waitcnt lgkmcnt(6)
    v_mfma_f32_16x16x32_bf16 v[40:43], a[24:27], v[120:123], v[40:43]
    buffer_load_dword v138, v13, s[4:7], s27 offen offset:64 sc1
    v_mfma_f32_16x16x32_bf16 v[40:43], a[32:35], v[124:127], v[40:43]
    v_mfma_f32_16x16x32_bf16 v[40:43], a[40:43], v[128:131], v[40:43]
    ds_read_b128 v[100:103], v1 offset:26624
    ds_read_b128 v[104:107], v1 offset:33792
    v_mfma_f32_16x16x32_bf16 v[44:47], a[28:31], v[120:123], v[44:47]
    ds_read_b128 v[108:111], v1 offset:40960
    v_mfma_f32_16x16x32_bf16 v[44:47], a[36:39], v[124:127], v[44:47]
    buffer_load_dwordx4 a[80:83], v1, s[4:7], s30 offen offset:2048 sc1
    v_mfma_f32_16x16x32_bf16 v[44:47], a[44:47], v[128:131], v[44:47]
    s_waitcnt lgkmcnt(6)
    v_mfma_f32_16x16x32_bf16 v[64:67], a[24:27], v[132:135], v[64:67]
    buffer_load_dwordx4 v[148:151], v14, s[4:7], s27 offen offset:64 sc1
    v_mfma_f32_16x16x32_bf16 v[64:67], a[32:35], v[80:83], v[64:67]
    v_mfma_f32_16x16x32_bf16 v[64:67], a[40:43], v[84:87], v[64:67]
    ds_read_b128 v[112:115], v1 offset:21504
    ds_read_b128 v[116:119], v1 offset:28672
    v_mfma_f32_16x16x32_bf16 v[68:71], a[28:31], v[132:135], v[68:71]
    ds_read_b128 v[120:123], v1 offset:35840
    v_mfma_f32_16x16x32_bf16 v[68:71], a[36:39], v[80:83], v[68:71]
    buffer_load_dwordx4 a[84:87], v3, s[4:7], s30 offen offset:2048 sc1
    v_mfma_f32_16x16x32_bf16 v[68:71], a[44:47], v[84:87], v[68:71]
    s_waitcnt lgkmcnt(6)
    v_mfma_f32_16x16x32_bf16 v[48:51], a[24:27], v[88:91], v[48:51]
    v_mfma_f32_16x16x32_bf16 v[48:51], a[32:35], v[92:95], v[48:51]
    v_mfma_f32_16x16x32_bf16 v[48:51], a[40:43], v[96:99], v[48:51]
    ds_read_b128 v[124:127], v1 offset:22528
    ds_read_b128 v[128:131], v1 offset:29696
    v_mfma_f32_16x16x32_bf16 v[52:55], a[28:31], v[88:91], v[52:55]
    ds_read_b128 v[132:135], v1 offset:36864
    v_mfma_f32_16x16x32_bf16 v[52:55], a[36:39], v[92:95], v[52:55]
    buffer_load_dwordx4 a[88:91], v1, s[4:7], s30 offen offset:3072 sc1
    v_mfma_f32_16x16x32_bf16 v[52:55], a[44:47], v[96:99], v[52:55]
    s_waitcnt lgkmcnt(6)
    v_mfma_f32_16x16x32_bf16 v[56:59], a[24:27], v[100:103], v[56:59]
    v_mfma_f32_16x16x32_bf16 v[56:59], a[32:35], v[104:107], v[56:59]
    v_mfma_f32_16x16x32_bf16 v[56:59], a[40:43], v[108:111], v[56:59]
    ds_read_b128 v[80:83], v1 offset:45056
    ds_read_b128 v[84:87], v1 offset:52224
    v_mfma_f32_16x16x32_bf16 v[60:63], a[28:31], v[100:103], v[60:63]
    ds_read_b128 v[88:91], v1 offset:59392
    v_mfma_f32_16x16x32_bf16 v[60:63], a[36:39], v[104:107], v[60:63]
    buffer_load_dwordx4 a[92:95], v3, s[4:7], s30 offen offset:3072 sc1
    v_mfma_f32_16x16x32_bf16 v[60:63], a[44:47], v[108:111], v[60:63]
    s_waitcnt lgkmcnt(6)
    v_mfma_f32_16x16x32_bf16 v[16:19], v[112:115], a[24:27], v[16:19]
    s_add_u32 s30, s24, 12288
    v_mfma_f32_16x16x32_bf16 v[16:19], v[116:119], a[32:35], v[16:19]
    v_mfma_f32_16x16x32_bf16 v[16:19], v[120:123], a[40:43], v[16:19]
    ds_read_b128 v[92:95], v1 offset:46080
    ds_read_b128 v[96:99], v1 offset:53248
    v_mfma_f32_16x16x32_bf16 v[24:27], v[112:115], a[28:31], v[24:27]
    ds_read_b128 v[100:103], v1 offset:60416
    v_mfma_f32_16x16x32_bf16 v[24:27], v[116:119], a[36:39], v[24:27]
    buffer_load_dwordx4 a[96:99], v1, s[4:7], s30 offen offset:0 sc1
    v_mfma_f32_16x16x32_bf16 v[24:27], v[120:123], a[44:47], v[24:27]
    s_waitcnt lgkmcnt(6)
    v_mfma_f32_16x16x32_bf16 v[20:23], v[124:127], a[24:27], v[20:23]
    v_mfma_f32_16x16x32_bf16 v[20:23], v[128:131], a[32:35], v[20:23]
    v_mfma_f32_16x16x32_bf16 v[20:23], v[132:135], a[40:43], v[20:23]
    ds_read_b128 v[104:107], v1 offset:49152
    ds_read_b128 v[108:111], v1 offset:56320
    v_mfma_f32_16x16x32_bf16 v[28:31], v[124:127], a[28:31], v[28:31]
    ds_read_b128 v[112:115], v1 offset:63488
    v_mfma_f32_16x16x32_bf16 v[28:31], v[128:131], a[36:39], v[28:31]
    buffer_load_dwordx4 a[100:103], v3, s[4:7], s30 offen offset:0 sc1
    v_mfma_f32_16x16x32_bf16 v[28:31], v[132:135], a[44:47], v[28:31]
    s_waitcnt vmcnt(11) lgkmcnt(6)
    v_mfma_f32_16x16x32_bf16 v[32:35], a[48:51], v[80:83], v[32:35]
    v_mfma_f32_16x16x32_bf16 v[32:35], a[56:59], v[84:87], v[32:35]
    v_mfma_f32_16x16x32_bf16 v[32:35], a[64:67], v[88:91], v[32:35]
    ds_read_b128 v[116:119], v1 offset:47104
    ds_read_b128 v[120:123], v1 offset:54272
    v_mfma_f32_16x16x32_bf16 v[36:39], a[52:55], v[80:83], v[36:39]
    ds_read_b128 v[124:127], v1 offset:61440
    v_mfma_f32_16x16x32_bf16 v[36:39], a[60:63], v[84:87], v[36:39]
    buffer_load_dwordx4 a[104:107], v1, s[4:7], s30 offen offset:1024 sc1
    v_mfma_f32_16x16x32_bf16 v[36:39], a[68:71], v[88:91], v[36:39]
    s_waitcnt lgkmcnt(6)
    v_mfma_f32_16x16x32_bf16 v[40:43], a[48:51], v[92:95], v[40:43]
    v_mfma_f32_16x16x32_bf16 v[40:43], a[56:59], v[96:99], v[40:43]
    v_mfma_f32_16x16x32_bf16 v[40:43], a[64:67], v[100:103], v[40:43]
    ds_read_b128 v[128:131], v1 offset:48128
    ds_read_b128 v[132:135], v1 offset:55296
    v_mfma_f32_16x16x32_bf16 v[44:47], a[52:55], v[92:95], v[44:47]
    ds_read_b128 v[80:83], v1 offset:62464
    v_mfma_f32_16x16x32_bf16 v[44:47], a[60:63], v[96:99], v[44:47]
    buffer_load_dwordx4 a[108:111], v3, s[4:7], s30 offen offset:1024 sc1
    v_mfma_f32_16x16x32_bf16 v[44:47], a[68:71], v[100:103], v[44:47]
    s_waitcnt lgkmcnt(6)
    v_mfma_f32_16x16x32_bf16 v[64:67], a[48:51], v[104:107], v[64:67]
    v_mfma_f32_16x16x32_bf16 v[64:67], a[56:59], v[108:111], v[64:67]
    v_mfma_f32_16x16x32_bf16 v[64:67], a[64:67], v[112:115], v[64:67]
    ds_read_b128 v[84:87], v1 offset:43008
    ds_read_b128 v[88:91], v1 offset:50176
    v_mfma_f32_16x16x32_bf16 v[68:71], a[52:55], v[104:107], v[68:71]
    ds_read_b128 v[92:95], v1 offset:57344
    v_mfma_f32_16x16x32_bf16 v[68:71], a[60:63], v[108:111], v[68:71]
    buffer_load_dwordx4 a[112:115], v1, s[4:7], s30 offen offset:2048 sc1
    v_mfma_f32_16x16x32_bf16 v[68:71], a[68:71], v[112:115], v[68:71]
    s_waitcnt lgkmcnt(6)
    v_mfma_f32_16x16x32_bf16 v[48:51], a[48:51], v[116:119], v[48:51]
    v_mfma_f32_16x16x32_bf16 v[48:51], a[56:59], v[120:123], v[48:51]
    v_mfma_f32_16x16x32_bf16 v[48:51], a[64:67], v[124:127], v[48:51]
    ds_read_b128 v[96:99], v1 offset:44032
    ds_read_b128 v[100:103], v1 offset:51200
    v_mfma_f32_16x16x32_bf16 v[52:55], a[52:55], v[116:119], v[52:55]
    ds_read_b128 v[104:107], v1 offset:58368
    v_mfma_f32_16x16x32_bf16 v[52:55], a[60:63], v[120:123], v[52:55]
    buffer_load_dwordx4 a[116:119], v3, s[4:7], s30 offen offset:2048 sc1
    v_mfma_f32_16x16x32_bf16 v[52:55], a[68:71], v[124:127], v[52:55]
    s_waitcnt lgkmcnt(6)
    v_mfma_f32_16x16x32_bf16 v[56:59], a[48:51], v[128:131], v[56:59]
    v_mfma_f32_16x16x32_bf16 v[56:59], a[56:59], v[132:135], v[56:59]
    v_mfma_f32_16x16x32_bf16 v[56:59], a[64:67], v[80:83], v[56:59]
    s_add_u32 s23, s29, 8192
    ds_read_b128 v[108:111], v10 offset:1024
    ds_read_b128 v[112:115], v10 offset:8192
    v_mfma_f32_16x16x32_bf16 v[60:63], a[52:55], v[128:131], v[60:63]
    ds_read_b128 v[116:119], v10 offset:15360
    v_mfma_f32_16x16x32_bf16 v[60:63], a[60:63], v[132:135], v[60:63]
    buffer_load_dwordx4 a[120:123], v1, s[4:7], s30 offen offset:3072 sc1
    v_mfma_f32_16x16x32_bf16 v[60:63], a[68:71], v[80:83], v[60:63]
    s_waitcnt lgkmcnt(6)
    v_mfma_f32_16x16x32_bf16 v[16:19], v[84:87], a[48:51], v[16:19]
    buffer_load_dwordx4 a[144:147], v1, s[4:7], s23 offen offset:1024 sc1
    v_mfma_f32_16x16x32_bf16 v[16:19], v[88:91], a[56:59], v[16:19]
    v_mfma_f32_16x16x32_bf16 v[16:19], v[92:95], a[64:67], v[16:19]
    ds_read_b128 v[120:123], v10 offset:2048
    ds_read_b128 v[124:127], v10 offset:9216
    v_mfma_f32_16x16x32_bf16 v[24:27], v[84:87], a[52:55], v[24:27]
    ds_read_b128 v[128:131], v10 offset:16384
    v_mfma_f32_16x16x32_bf16 v[24:27], v[88:91], a[60:63], v[24:27]
    buffer_load_dwordx4 a[124:127], v3, s[4:7], s30 offen offset:3072 sc1
    v_mfma_f32_16x16x32_bf16 v[24:27], v[92:95], a[68:71], v[24:27]
    s_waitcnt lgkmcnt(6)
    v_mfma_f32_16x16x32_bf16 v[20:23], v[96:99], a[48:51], v[20:23]
    s_add_u32 s30, s24, 16384
    v_mfma_f32_16x16x32_bf16 v[20:23], v[100:103], a[56:59], v[20:23]
    buffer_load_dwordx4 a[148:151], v1, s[4:7], s23 offen offset:2048 sc1
    v_mfma_f32_16x16x32_bf16 v[20:23], v[104:107], a[64:67], v[20:23]
    ds_read_b128 v[132:135], v10 offset:5120
    ds_read_b128 v[80:83], v10 offset:12288
    v_mfma_f32_16x16x32_bf16 v[28:31], v[96:99], a[52:55], v[28:31]
    ds_read_b128 v[84:87], v10 offset:19456
    v_mfma_f32_16x16x32_bf16 v[28:31], v[100:103], a[60:63], v[28:31]
    buffer_load_dwordx4 a[128:131], v1, s[4:7], s30 offen offset:0 sc1
    v_mfma_f32_16x16x32_bf16 v[28:31], v[104:107], a[68:71], v[28:31]
    s_waitcnt vmcnt(11) lgkmcnt(6)
    v_mfma_f32_16x16x32_bf16 v[32:35], a[72:75], v[108:111], v[32:35]
    buffer_load_dwordx4 a[152:155], v1, s[4:7], s23 offen offset:3072 sc1
    v_mfma_f32_16x16x32_bf16 v[32:35], a[80:83], v[112:115], v[32:35]
    v_mfma_f32_16x16x32_bf16 v[32:35], a[88:91], v[116:119], v[32:35]
    ds_read_b128 v[88:91], v10 offset:3072
    ds_read_b128 v[92:95], v10 offset:10240
    v_mfma_f32_16x16x32_bf16 v[36:39], a[76:79], v[108:111], v[36:39]
    ds_read_b128 v[96:99], v10 offset:17408
    v_mfma_f32_16x16x32_bf16 v[36:39], a[84:87], v[112:115], v[36:39]
    buffer_load_dwordx4 a[132:135], v3, s[4:7], s30 offen offset:0 sc1
    v_mfma_f32_16x16x32_bf16 v[36:39], a[92:95], v[116:119], v[36:39]
    s_waitcnt lgkmcnt(6)
    v_mfma_f32_16x16x32_bf16 v[40:43], a[72:75], v[120:123], v[40:43]
    s_add_u32 s23, s29, 20480
    v_mfma_f32_16x16x32_bf16 v[40:43], a[80:83], v[124:127], v[40:43]
    buffer_load_dwordx4 a[156:159], v1, s[4:7], s23 offen offset:1024 sc1
    v_mfma_f32_16x16x32_bf16 v[40:43], a[88:91], v[128:131], v[40:43]
    ds_read_b128 v[100:103], v10 offset:4096
    ds_read_b128 v[104:107], v10 offset:11264
    v_mfma_f32_16x16x32_bf16 v[44:47], a[76:79], v[120:123], v[44:47]
    ds_read_b128 v[108:111], v10 offset:18432
    v_mfma_f32_16x16x32_bf16 v[44:47], a[84:87], v[124:127], v[44:47]
    buffer_load_dwordx4 a[136:139], v1, s[4:7], s30 offen offset:1024 sc1
    v_mfma_f32_16x16x32_bf16 v[44:47], a[92:95], v[128:131], v[44:47]
    s_waitcnt lgkmcnt(6)
    v_mfma_f32_16x16x32_bf16 v[64:67], a[72:75], v[132:135], v[64:67]
    buffer_load_dwordx4 a[160:163], v1, s[4:7], s23 offen offset:2048 sc1
    v_mfma_f32_16x16x32_bf16 v[64:67], a[80:83], v[80:83], v[64:67]
    v_mfma_f32_16x16x32_bf16 v[64:67], a[88:91], v[84:87], v[64:67]
    ds_read_b128 v[112:115], v1 offset:64512
    ds_read_b128 v[116:119], v10 offset:6144
    v_mfma_f32_16x16x32_bf16 v[68:71], a[76:79], v[132:135], v[68:71]
    ds_read_b128 v[120:123], v10 offset:13312
    v_mfma_f32_16x16x32_bf16 v[68:71], a[84:87], v[80:83], v[68:71]
    buffer_load_dwordx4 a[140:143], v3, s[4:7], s30 offen offset:1024 sc1
    v_mfma_f32_16x16x32_bf16 v[68:71], a[92:95], v[84:87], v[68:71]
    s_waitcnt lgkmcnt(6)
    v_mfma_f32_16x16x32_bf16 v[48:51], a[72:75], v[88:91], v[48:51]
    buffer_load_dwordx4 a[164:167], v1, s[4:7], s23 offen offset:3072 sc1
    v_mfma_f32_16x16x32_bf16 v[48:51], a[80:83], v[92:95], v[48:51]
    v_mfma_f32_16x16x32_bf16 v[48:51], a[88:91], v[96:99], v[48:51]
    ds_read_b128 v[124:127], v10 offset:0
    ds_read_b128 v[128:131], v10 offset:7168
    v_mfma_f32_16x16x32_bf16 v[52:55], a[76:79], v[88:91], v[52:55]
    ds_read_b128 v[132:135], v10 offset:14336
    v_mfma_f32_16x16x32_bf16 v[52:55], a[84:87], v[92:95], v[52:55]
    global_load_dword v191, v190, s[60:61]
    v_mfma_f32_16x16x32_bf16 v[52:55], a[92:95], v[96:99], v[52:55]
    s_waitcnt lgkmcnt(6)
    v_mfma_f32_16x16x32_bf16 v[56:59], a[72:75], v[100:103], v[56:59]
    s_add_u32 s23, s29, 32768
    v_mfma_f32_16x16x32_bf16 v[56:59], a[80:83], v[104:107], v[56:59]
    buffer_load_dwordx4 a[168:171], v1, s[4:7], s23 offen offset:1024 sc1
    v_mfma_f32_16x16x32_bf16 v[56:59], a[88:91], v[108:111], v[56:59]
    ds_read_b128 v[80:83], v10 offset:22528
    ds_read_b128 v[84:87], v10 offset:29696
    v_mfma_f32_16x16x32_bf16 v[60:63], a[76:79], v[100:103], v[60:63]
    ds_read_b128 v[88:91], v10 offset:36864
    v_mfma_f32_16x16x32_bf16 v[60:63], a[84:87], v[104:107], v[60:63]
    v_mfma_f32_16x16x32_bf16 v[60:63], a[92:95], v[108:111], v[60:63]
    s_waitcnt lgkmcnt(6)
    v_mfma_f32_16x16x32_bf16 v[16:19], v[112:115], a[72:75], v[16:19]
    buffer_load_dwordx4 a[172:175], v1, s[4:7], s23 offen offset:2048 sc1
    v_mfma_f32_16x16x32_bf16 v[16:19], v[116:119], a[80:83], v[16:19]
    v_mfma_f32_16x16x32_bf16 v[16:19], v[120:123], a[88:91], v[16:19]
    ds_read_b128 v[92:95], v10 offset:23552
    ds_read_b128 v[96:99], v10 offset:30720
    v_mfma_f32_16x16x32_bf16 v[24:27], v[112:115], a[76:79], v[24:27]
    ds_read_b128 v[100:103], v10 offset:37888
    v_mfma_f32_16x16x32_bf16 v[24:27], v[116:119], a[84:87], v[24:27]
    buffer_load_dwordx4 a[176:179], v1, s[4:7], s23 offen offset:3072 sc1
    v_mfma_f32_16x16x32_bf16 v[24:27], v[120:123], a[92:95], v[24:27]
    s_waitcnt lgkmcnt(6)
    v_mfma_f32_16x16x32_bf16 v[20:23], v[124:127], a[72:75], v[20:23]
    v_mfma_f32_16x16x32_bf16 v[20:23], v[128:131], a[80:83], v[20:23]
    v_mfma_f32_16x16x32_bf16 v[20:23], v[132:135], a[88:91], v[20:23]
    s_add_u32 s23, s29, 45056
    ds_read_b128 v[104:107], v10 offset:26624
    ds_read_b128 v[108:111], v10 offset:33792
    v_mfma_f32_16x16x32_bf16 v[28:31], v[124:127], a[76:79], v[28:31]
    ds_read_b128 v[112:115], v10 offset:40960
    v_mfma_f32_16x16x32_bf16 v[28:31], v[128:131], a[84:87], v[28:31]
    buffer_load_dwordx4 a[180:183], v1, s[4:7], s23 offen offset:1024 sc1
    v_mfma_f32_16x16x32_bf16 v[28:31], v[132:135], a[92:95], v[28:31]
    s_waitcnt vmcnt(17) lgkmcnt(6)
    v_mfma_f32_16x16x32_bf16 v[32:35], a[96:99], v[80:83], v[32:35]
    s_mul_i32 s28, s22, 3072
    v_mul_f32 v152, 0x3fb8aa3b, v144
    v_mul_f32 v153, 0x3fb8aa3b, v145
    v_mfma_f32_16x16x32_bf16 v[32:35], a[104:107], v[84:87], v[32:35]
    s_add_u32 s28, s28, 39903232
    v_mul_f32 v154, 0x3fb8aa3b, v146
    v_mul_f32 v155, 0x3fb8aa3b, v147
    v_mfma_f32_16x16x32_bf16 v[32:35], a[112:115], v[88:91], v[32:35]
    s_lshl_b32 s43, s21, 2
    ds_read_b128 v[116:119], v10 offset:24576
    ds_read_b128 v[120:123], v10 offset:31744
    v_mfma_f32_16x16x32_bf16 v[36:39], a[100:103], v[80:83], v[36:39]
    s_add_u32 s43, s43, s20
    ds_read_b128 v[124:127], v10 offset:38912
    v_mul_f32 v156, 0x3fb8aa3b, v148
    v_mfma_f32_16x16x32_bf16 v[36:39], a[108:111], v[84:87], v[36:39]
    s_lshl_b32 s43, s43, 4
    v_mul_f32 v157, 0x3fb8aa3b, v149
    v_mul_f32 v158, 0x3fb8aa3b, v150
    v_mfma_f32_16x16x32_bf16 v[36:39], a[116:119], v[88:91], v[36:39]
    s_waitcnt lgkmcnt(6)
    v_mul_f32 v159, 0x3fb8aa3b, v151
    v_mul_f32 v140, 0x3fb8aa3b, v136
    v_mfma_f32_16x16x32_bf16 v[40:43], a[96:99], v[92:95], v[40:43]
    s_add_u32 s43, s43, s22
    v_mul_f32 v141, 0x3fb8aa3b, v136
    v_mov_b32 v137, v136
    v_mfma_f32_16x16x32_bf16 v[40:43], a[104:107], v[96:99], v[40:43]
    s_mul_i32 s43, s43, 2304
    v_mul_f32 v142, 0x3fb8aa3b, v138
    v_mul_f32 v143, 0x3fb8aa3b, v138
    v_mfma_f32_16x16x32_bf16 v[40:43], a[112:115], v[100:103], v[40:43]
    s_add_u32 s43, s43, 36700160
    ds_read_b128 v[128:131], v10 offset:25600
    ds_read_b128 v[132:135], v10 offset:32768
    v_mfma_f32_16x16x32_bf16 v[44:47], a[100:103], v[92:95], v[44:47]
    s_lshl_b32 s14, s22, 4
    ds_read_b128 v[80:83], v10 offset:39936
    v_mov_b32 v139, v138
    v_mfma_f32_16x16x32_bf16 v[44:47], a[108:111], v[96:99], v[44:47]
    s_add_u32 s14, s14, s21
    v_lshrrev_b32 v7, 2, v11
    v_mov_b32 v8, 897988541
    v_mfma_f32_16x16x32_bf16 v[44:47], a[116:119], v[100:103], v[44:47]
    s_waitcnt lgkmcnt(6)
    v_lshl_add_u32 v7, v7, 6, v14
    v_mov_b32 v9, 897988541
    v_mfma_f32_16x16x32_bf16 v[64:67], a[96:99], v[104:107], v[64:67]
    s_and_b32 s15, s14, 0
    v_mov_b32 v15, 0x10000000
    v_add_u32 v4, s42, v1
    v_mfma_f32_16x16x32_bf16 v[64:67], a[104:107], v[108:111], v[64:67]
    s_lshr_b32 s14, s14, 0
    v_and_b32 v13, 3, v11
    v_lshl_add_u32 v5, v2, 3, s42
    v_mfma_f32_16x16x32_bf16 v[64:67], a[112:115], v[112:115], v[64:67]
    s_lshl_b32 s14, s14, 5
    ds_read_b128 v[84:87], v10 offset:20480
    ds_read_b128 v[88:91], v10 offset:27648
    v_mfma_f32_16x16x32_bf16 v[68:71], a[100:103], v[104:107], v[68:71]
    s_add_u32 s14, s14, s15
    ds_read_b128 v[92:95], v10 offset:34816
    v_cmp_eq_u32 vcc, 1, v13
    v_mfma_f32_16x16x32_bf16 v[68:71], a[108:111], v[108:111], v[68:71]
    s_lshl_b32 s14, s14, 2
    v_and_b32 v13, 2, v11
    v_lshlrev_b32 v6, 2, v0
    v_mfma_f32_16x16x32_bf16 v[68:71], a[116:119], v[112:115], v[68:71]
    s_waitcnt lgkmcnt(6)
    v_cndmask_b32 v7, v15, v7, vcc
    v_lshl_add_u32 v186, v0, 2, s54
    v_mfma_f32_16x16x32_bf16 v[48:51], a[96:99], v[116:119], v[48:51]
    s_add_u32 s14, s14, 40534016
    v_cmp_ne_u32 s[40:41], 0, v13
    v_mfma_f32_16x16x32_bf16 v[48:51], a[104:107], v[120:123], v[48:51]
    v_lshrrev_b32 v13, 3, v11
    v_mfma_f32_16x16x32_bf16 v[48:51], a[112:115], v[124:127], v[48:51]
    ds_read_b128 v[96:99], v10 offset:21504
    ds_read_b128 v[100:103], v10 offset:28672
    v_mfma_f32_16x16x32_bf16 v[52:55], a[100:103], v[116:119], v[52:55]
    ds_read_b128 v[104:107], v10 offset:35840
    v_and_b32 v14, 1, v11
    v_mfma_f32_16x16x32_bf16 v[52:55], a[108:111], v[120:123], v[52:55]
    v_cndmask_b32 v13, v14, v13, s[40:41]
    v_mfma_f32_16x16x32_bf16 v[52:55], a[116:119], v[124:127], v[52:55]
    s_waitcnt lgkmcnt(6)
    v_lshrrev_b32 v14, 1, v12
    v_mfma_f32_16x16x32_bf16 v[56:59], a[96:99], v[128:131], v[56:59]
    v_cmp_ne_u32 s[34:35], 0, v13
    v_mfma_f32_16x16x32_bf16 v[56:59], a[104:107], v[132:135], v[56:59]
    v_cmp_ne_u32 s[36:37], 0, v14
    v_mfma_f32_16x16x32_bf16 v[56:59], a[112:115], v[80:83], v[56:59]
    ds_read_b128 v[108:111], v10 offset:44032
    ds_read_b128 v[112:115], v10 offset:51200
    v_mfma_f32_16x16x32_bf16 v[60:63], a[100:103], v[128:131], v[60:63]
    ds_read_b128 v[116:119], v10 offset:58368
    v_cmp_eq_u32 s[38:39], v13, v14
    v_mfma_f32_16x16x32_bf16 v[60:63], a[108:111], v[132:135], v[60:63]
    v_mov_b32 v15, 0x3f803f80
    v_mfma_f32_16x16x32_bf16 v[60:63], a[116:119], v[80:83], v[60:63]
    s_waitcnt lgkmcnt(6)
    v_lshrrev_b32 v185, 2, v11
    v_mfma_f32_16x16x32_bf16 v[16:19], v[84:87], a[96:99], v[16:19]
    v_cndmask_b32 v185, 0, v185, s[40:41]
    v_mfma_f32_16x16x32_bf16 v[16:19], v[88:91], a[104:107], v[16:19]
    v_and_b32 v13, 3, v11
    v_mfma_f32_16x16x32_bf16 v[16:19], v[92:95], a[112:115], v[16:19]
    ds_read_b128 v[120:123], v10 offset:45056
    ds_read_b128 v[124:127], v10 offset:52224
    v_mfma_f32_16x16x32_bf16 v[24:27], v[84:87], a[100:103], v[24:27]
    ds_read_b128 v[128:131], v10 offset:59392
    v_add_u32 v185, v185, v13
    v_mfma_f32_16x16x32_bf16 v[24:27], v[88:91], a[108:111], v[24:27]
    v_mad_u32_u24 v185, v12, 6, v185
    v_mfma_f32_16x16x32_bf16 v[24:27], v[92:95], a[116:119], v[24:27]
    s_waitcnt lgkmcnt(6)
    v_cmp_eq_u32 vcc, 3, v13
    v_mfma_f32_16x16x32_bf16 v[20:23], v[96:99], a[96:99], v[20:23]
    v_nop
    v_mfma_f32_16x16x32_bf16 v[20:23], v[100:103], a[104:107], v[20:23]
    v_cndmask_b32 v185, v185, 24, vcc
    v_mfma_f32_16x16x32_bf16 v[20:23], v[104:107], a[112:115], v[20:23]
    ds_read_b128 v[132:135], v10 offset:48128
    ds_read_b128 v[80:83], v10 offset:55296
    v_mfma_f32_16x16x32_bf16 v[28:31], v[96:99], a[100:103], v[28:31]
    ds_read_b128 v[84:87], v10 offset:62464
    v_lshl_add_u32 v185, v185, 4, s42
    v_mfma_f32_16x16x32_bf16 v[28:31], v[100:103], a[108:111], v[28:31]
    buffer_load_dwordx4 a[184:187], v1, s[4:7], s23 offen offset:2048 sc1
    v_mfma_f32_16x16x32_bf16 v[28:31], v[104:107], a[116:119], v[28:31]
    s_waitcnt vmcnt(7) lgkmcnt(6)
    v_mfma_f32_16x16x32_bf16 v[32:35], a[120:123], v[108:111], v[32:35]
    v_mfma_f32_16x16x32_bf16 v[32:35], a[128:131], v[112:115], v[32:35]
    v_mfma_f32_16x16x32_bf16 v[32:35], a[136:139], v[116:119], v[32:35]
    ds_read_b128 v[88:91], v10 offset:46080
    ds_read_b128 v[92:95], v10 offset:53248
    v_mfma_f32_16x16x32_bf16 v[36:39], a[124:127], v[108:111], v[36:39]
    ds_read_b128 v[96:99], v10 offset:60416
    v_mfma_f32_16x16x32_bf16 v[36:39], a[132:135], v[112:115], v[36:39]
    buffer_load_dwordx4 a[188:191], v1, s[4:7], s23 offen offset:3072 sc1
    v_mfma_f32_16x16x32_bf16 v[36:39], a[140:143], v[116:119], v[36:39]
    s_waitcnt lgkmcnt(6)
    v_mfma_f32_16x16x32_bf16 v[40:43], a[120:123], v[120:123], v[40:43]
    v_mfma_f32_16x16x32_bf16 v[40:43], a[128:131], v[124:127], v[40:43]
    v_mfma_f32_16x16x32_bf16 v[40:43], a[136:139], v[128:131], v[40:43]
    s_add_u32 s23, s29, 49152
    ds_read_b128 v[100:103], v10 offset:47104
    ds_read_b128 v[104:107], v10 offset:54272
    v_mfma_f32_16x16x32_bf16 v[44:47], a[124:127], v[120:123], v[44:47]
    ds_read_b128 v[108:111], v10 offset:61440
    v_mfma_f32_16x16x32_bf16 v[44:47], a[132:135], v[124:127], v[44:47]
    buffer_load_dwordx4 a[192:195], v1, s[4:7], s23 offen offset:0 sc1
    v_mfma_f32_16x16x32_bf16 v[44:47], a[140:143], v[128:131], v[44:47]
    s_waitcnt lgkmcnt(6)
    v_mfma_f32_16x16x32_bf16 v[64:67], a[120:123], v[132:135], v[64:67]
    v_mfma_f32_16x16x32_bf16 v[64:67], a[128:131], v[80:83], v[64:67]
    v_mfma_f32_16x16x32_bf16 v[64:67], a[136:139], v[84:87], v[64:67]
    ds_read_b128 v[112:115], v10 offset:41984
    ds_read_b128 v[116:119], v10 offset:49152
    v_mfma_f32_16x16x32_bf16 v[68:71], a[124:127], v[132:135], v[68:71]
    ds_read_b128 v[120:123], v10 offset:56320
    v_mfma_f32_16x16x32_bf16 v[68:71], a[132:135], v[80:83], v[68:71]
    buffer_load_dwordx4 a[196:199], v1, s[4:7], s23 offen offset:1024 sc1
    v_mfma_f32_16x16x32_bf16 v[68:71], a[140:143], v[84:87], v[68:71]
    s_waitcnt lgkmcnt(6)
    v_mfma_f32_16x16x32_bf16 v[48:51], a[120:123], v[88:91], v[48:51]
    v_mfma_f32_16x16x32_bf16 v[48:51], a[128:131], v[92:95], v[48:51]
    v_mfma_f32_16x16x32_bf16 v[48:51], a[136:139], v[96:99], v[48:51]
    ds_read_b128 v[124:127], v10 offset:43008
    ds_read_b128 v[128:131], v10 offset:50176
    v_mfma_f32_16x16x32_bf16 v[52:55], a[124:127], v[88:91], v[52:55]
    ds_read_b128 v[132:135], v10 offset:57344
    v_mfma_f32_16x16x32_bf16 v[52:55], a[132:135], v[92:95], v[52:55]
    buffer_load_dwordx4 a[200:203], v1, s[4:7], s23 offen offset:2048 sc1
    v_mfma_f32_16x16x32_bf16 v[52:55], a[140:143], v[96:99], v[52:55]
    s_waitcnt lgkmcnt(6)
    v_mfma_f32_16x16x32_bf16 v[56:59], a[120:123], v[100:103], v[56:59]
    v_mfma_f32_16x16x32_bf16 v[56:59], a[128:131], v[104:107], v[56:59]
    v_mfma_f32_16x16x32_bf16 v[56:59], a[136:139], v[108:111], v[56:59]
    buffer_load_dwordx4 a[204:207], v1, s[4:7], s23 offen offset:3072 sc1
    v_mfma_f32_16x16x32_bf16 v[60:63], a[124:127], v[100:103], v[60:63]
    v_mfma_f32_16x16x32_bf16 v[60:63], a[132:135], v[104:107], v[60:63]
ffn0_part_pad1_1x:
    s_cbranch_execz ffn0_part_padret1
    v_mfma_f32_16x16x32_bf16 v[60:63], a[140:143], v[108:111], v[60:63]
    s_waitcnt lgkmcnt(3)
    v_mfma_f32_16x16x32_bf16 v[16:19], v[112:115], a[120:123], v[16:19]
    s_add_u32 s23, s29, 53248
    v_mfma_f32_16x16x32_bf16 v[16:19], v[116:119], a[128:131], v[16:19]
    buffer_load_dwordx4 a[208:211], v1, s[4:7], s23 offen offset:0 sc1
    v_mfma_f32_16x16x32_bf16 v[16:19], v[120:123], a[136:139], v[16:19]
    v_mfma_f32_16x16x32_bf16 v[24:27], v[112:115], a[124:127], v[24:27]
    v_mfma_f32_16x16x32_bf16 v[24:27], v[116:119], a[132:135], v[24:27]
    v_mfma_f32_16x16x32_bf16 v[24:27], v[120:123], a[140:143], v[24:27]
    s_waitcnt lgkmcnt(0)
    v_mfma_f32_16x16x32_bf16 v[20:23], v[124:127], a[120:123], v[20:23]
    v_mfma_f32_16x16x32_bf16 v[20:23], v[128:131], a[128:131], v[20:23]
    v_mfma_f32_16x16x32_bf16 v[20:23], v[132:135], a[136:139], v[20:23]
    v_mfma_f32_16x16x32_bf16 v[28:31], v[124:127], a[124:127], v[28:31]
    v_mfma_f32_16x16x32_bf16 v[28:31], v[128:131], a[132:135], v[28:31]
    v_mfma_f32_16x16x32_bf16 v[28:31], v[132:135], a[140:143], v[28:31]
    v_pk_mul_f32 v[160:161], v[32:33], v[152:153]
    v_pk_mul_f32 v[162:163], v[34:35], v[154:155]
    v_pk_mul_f32 v[164:165], v[36:37], v[156:157]
    v_pk_mul_f32 v[166:167], v[38:39], v[158:159]
    v_exp_f32 v160, v160 clamp
    v_pk_fma_f32 v[32:33], v[32:33], v[144:145], v[8:9]
    v_exp_f32 v161, v161 clamp
    v_exp_f32 v162, v162 clamp
    v_pk_fma_f32 v[34:35], v[34:35], v[146:147], v[8:9]
    v_exp_f32 v163, v163 clamp
    buffer_load_dwordx4 a[212:215], v1, s[4:7], s23 offen offset:1024 sc1
    v_exp_f32 v164, v164 clamp
    v_pk_fma_f32 v[36:37], v[36:37], v[148:149], v[8:9]
    v_exp_f32 v165, v165 clamp
    v_exp_f32 v166, v166 clamp
    v_pk_fma_f32 v[38:39], v[38:39], v[150:151], v[8:9]
    v_exp_f32 v167, v167 clamp
    v_max_f32 v32, v8, v32
    v_max_f32 v33, v8, v33
    v_max_f32 v34, v8, v34
    v_max_f32 v35, v8, v35
    s_add_u32 s23, s29, 0
    buffer_load_dwordx4 a[0:3], v1, s[4:7], s23 offen offset:0 sc1
    v_max_f32 v36, v8, v36
    v_max_f32 v37, v8, v37
    v_max_f32 v38, v8, v38
    v_max_f32 v39, v8, v39
    v_pk_add_f32 v[32:33], v[32:33], v[160:161]
    v_pk_add_f32 v[34:35], v[34:35], v[162:163]
    v_pk_add_f32 v[36:37], v[36:37], v[164:165]
    v_pk_add_f32 v[38:39], v[38:39], v[166:167]
    v_cvt_pk_bf16_f32 v80, v32, v33
    v_cvt_pk_bf16_f32 v81, v34, v35
    buffer_load_dwordx4 a[4:7], v1, s[4:7], s23 offen offset:1024 sc1
    v_cvt_pk_bf16_f32 v82, v36, v37
    v_cvt_pk_bf16_f32 v83, v38, v39
    v_pk_mul_f32 v[160:161], v[40:41], v[152:153]
    v_pk_mul_f32 v[162:163], v[42:43], v[154:155]
    v_pk_mul_f32 v[164:165], v[44:45], v[156:157]
    v_pk_mul_f32 v[166:167], v[46:47], v[158:159]
    v_exp_f32 v160, v160 clamp
    v_pk_fma_f32 v[40:41], v[40:41], v[144:145], v[8:9]
    v_exp_f32 v161, v161 clamp
    v_exp_f32 v162, v162 clamp
    buffer_load_dwordx4 a[8:11], v1, s[4:7], s23 offen offset:2048 sc1
    v_pk_fma_f32 v[42:43], v[42:43], v[146:147], v[8:9]
    v_exp_f32 v163, v163 clamp
    v_exp_f32 v164, v164 clamp
    v_pk_fma_f32 v[44:45], v[44:45], v[148:149], v[8:9]
    v_exp_f32 v165, v165 clamp
    v_exp_f32 v166, v166 clamp
    v_pk_fma_f32 v[46:47], v[46:47], v[150:151], v[8:9]
    v_exp_f32 v167, v167 clamp
    v_max_f32 v40, v8, v40
    v_max_f32 v41, v8, v41
    s_add_u32 s23, s29, 12288
    buffer_load_dwordx4 a[12:15], v1, s[4:7], s23 offen offset:0 sc1
    v_max_f32 v42, v8, v42
    v_max_f32 v43, v8, v43
    v_max_f32 v44, v8, v44
    v_max_f32 v45, v8, v45
    v_max_f32 v46, v8, v46
    v_max_f32 v47, v8, v47
    v_pk_add_f32 v[40:41], v[40:41], v[160:161]
    v_pk_add_f32 v[42:43], v[42:43], v[162:163]
    v_pk_add_f32 v[44:45], v[44:45], v[164:165]
    v_pk_add_f32 v[46:47], v[46:47], v[166:167]
    buffer_load_dwordx4 a[16:19], v1, s[4:7], s23 offen offset:1024 sc1
    v_cvt_pk_bf16_f32 v84, v40, v41
    v_cvt_pk_bf16_f32 v85, v42, v43
    v_cvt_pk_bf16_f32 v86, v44, v45
    v_cvt_pk_bf16_f32 v87, v46, v47
    v_pk_mul_f32 v[160:161], v[64:65], v[152:153]
    v_pk_mul_f32 v[162:163], v[66:67], v[154:155]
    v_pk_mul_f32 v[164:165], v[68:69], v[156:157]
    v_pk_mul_f32 v[166:167], v[70:71], v[158:159]
    v_exp_f32 v160, v160 clamp
    v_pk_fma_f32 v[176:177], v[64:65], v[144:145], v[8:9]
    buffer_load_dwordx4 a[20:23], v1, s[4:7], s23 offen offset:2048 sc1
    v_exp_f32 v161, v161 clamp
    v_exp_f32 v162, v162 clamp
    v_pk_fma_f32 v[178:179], v[66:67], v[146:147], v[8:9]
    v_exp_f32 v163, v163 clamp
    v_exp_f32 v164, v164 clamp
    v_pk_fma_f32 v[180:181], v[68:69], v[148:149], v[8:9]
    v_exp_f32 v165, v165 clamp
    v_exp_f32 v166, v166 clamp
    v_pk_fma_f32 v[182:183], v[70:71], v[150:151], v[8:9]
    v_exp_f32 v167, v167 clamp
    s_add_u32 s23, s29, 24576
    buffer_load_dwordx4 a[24:27], v1, s[4:7], s23 offen offset:0 sc1
    v_max_f32 v176, v8, v176
    v_max_f32 v177, v8, v177
    v_max_f32 v178, v8, v178
    v_max_f32 v179, v8, v179
    v_max_f32 v180, v8, v180
    v_max_f32 v181, v8, v181
    v_max_f32 v182, v8, v182
    v_max_f32 v183, v8, v183
    v_pk_add_f32 v[176:177], v[176:177], v[160:161]
    v_pk_add_f32 v[178:179], v[178:179], v[162:163]
    buffer_load_dwordx4 a[28:31], v1, s[4:7], s23 offen offset:1024 sc1
    v_pk_add_f32 v[180:181], v[180:181], v[164:165]
    v_pk_add_f32 v[182:183], v[182:183], v[166:167]
    v_cvt_pk_bf16_f32 v96, v176, v177
    v_cvt_pk_bf16_f32 v97, v178, v179
    v_cvt_pk_bf16_f32 v98, v180, v181
    v_cvt_pk_bf16_f32 v99, v182, v183
    v_pk_mul_f32 v[64:65], v[64:65], v[144:145]
    v_pk_mul_f32 v[66:67], v[66:67], v[146:147]
    v_pk_mul_f32 v[68:69], v[68:69], v[148:149]
    v_pk_mul_f32 v[70:71], v[70:71], v[150:151]
    buffer_load_dwordx4 a[32:35], v1, s[4:7], s23 offen offset:2048 sc1
    v_cvt_pk_bf16_f32 v100, v64, v65
    v_cvt_pk_bf16_f32 v101, v66, v67
    v_cvt_pk_bf16_f32 v102, v68, v69
    v_cvt_pk_bf16_f32 v103, v70, v71
    v_cndmask_b32 v100, v15, v100, s[40:41]
    v_cndmask_b32 v101, v15, v101, s[40:41]
    v_cndmask_b32 v102, v15, v102, s[40:41]
    v_cndmask_b32 v103, v15, v103, s[40:41]
    v_pk_mul_f32 v[48:49], v[48:49], v[144:145]
    v_pk_mul_f32 v[50:51], v[50:51], v[146:147]
    s_add_u32 s23, s29, 36864
    buffer_load_dwordx4 a[36:39], v1, s[4:7], s23 offen offset:0 sc1
    v_pk_mul_f32 v[52:53], v[52:53], v[148:149]
    v_pk_mul_f32 v[54:55], v[54:55], v[150:151]
    v_cvt_pk_bf16_f32 v88, v48, v49
    v_cvt_pk_bf16_f32 v89, v50, v51
    v_cvt_pk_bf16_f32 v90, v52, v53
    v_cvt_pk_bf16_f32 v91, v54, v55
    v_pk_mul_f32 v[56:57], v[56:57], v[144:145]
    v_pk_mul_f32 v[58:59], v[58:59], v[146:147]
    v_pk_mul_f32 v[60:61], v[60:61], v[148:149]
    v_pk_mul_f32 v[62:63], v[62:63], v[150:151]
    v_cvt_pk_bf16_f32 v92, v56, v57
    v_cvt_pk_bf16_f32 v93, v58, v59
    v_cvt_pk_bf16_f32 v94, v60, v61
    v_cvt_pk_bf16_f32 v95, v62, v63
    s_nop 0
    v_mfma_f32_16x16x32_bf16 v[112:115], v[80:83], v[100:103], 0
    v_cvt_pk_bf16_f32 v132, v176, v180
    v_mfma_f32_16x16x32_bf16 v[116:119], v[84:87], v[100:103], 0
    v_cvt_pk_bf16_f32 v133, v177, v181
    v_mfma_f32_16x16x32_bf16 v[128:131], v[96:99], v[100:103], 0
    v_cvt_pk_bf16_f32 v134, v178, v182
    v_mfma_f32_16x16x32_bf16 v[120:123], v[96:99], v[88:91], 0
    v_cvt_pk_bf16_f32 v135, v179, v183
    v_mfma_f32_16x16x32_bf16 v[124:127], v[96:99], v[92:95], 0
    v_mfma_f32_16x16x32_bf16 v[104:107], v[80:83], v[88:91], 0
    v_mfma_f32_16x16x32_bf16 v[108:111], v[84:87], v[92:95], 0
    v_cndmask_b32 v112, v112, v116, s[34:35]
    v_cndmask_b32 v113, v113, v117, s[34:35]
    v_cndmask_b32 v114, v114, v118, s[34:35]
    v_cndmask_b32 v115, v115, v119, s[34:35]
    v_cndmask_b32 v121, 0, v128, s[38:39]
    v_cndmask_b32 v120, v120, v124, s[36:37]
    ds_write_b128 v185, v[112:115] offset:2560
    ds_write_b64 v5, v[120:121] offset:2048
    ds_write_b128 v4, v[104:107]
    ds_write_b128 v4, v[108:111] offset:1024
    buffer_store_dwordx4 v[132:135], v7, s[4:7], s43 offen offset:2048 sc1
    s_waitcnt lgkmcnt(0)
    s_barrier
    ds_read2st64_b32 v[104:105], v186 offset0:0 offset1:12
    ds_read2st64_b32 v[106:107], v186 offset0:24 offset1:36
    ds_read2st64_b32 v[108:109], v186 offset0:4 offset1:16
    ds_read2st64_b32 v[110:111], v186 offset0:28 offset1:40
    ds_read2st64_b32 v[112:113], v186 offset0:8 offset1:20
    ds_read2st64_b32 v[114:115], v186 offset0:32 offset1:44
    s_waitcnt lgkmcnt(4)
    v_pk_add_f32 v[104:105], v[104:105], v[106:107]
    v_add_f32 v104, v104, v105
    buffer_atomic_add_f32 v104, v6, s[4:7], s28 offen offset:0
    s_waitcnt lgkmcnt(2)
    v_pk_add_f32 v[108:109], v[108:109], v[110:111]
    v_add_f32 v108, v108, v109
    buffer_atomic_add_f32 v108, v6, s[4:7], s28 offen offset:1024
    s_waitcnt lgkmcnt(0)
    v_pk_add_f32 v[112:113], v[112:113], v[114:115]
    v_add_f32 v112, v112, v113
    buffer_atomic_add_f32 v112, v6, s[4:7], s28 offen offset:2048
ffn0_part_na:
    v_pk_mul_f32 v[160:161], v[16:17], v[140:141]
    v_pk_mul_f32 v[162:163], v[18:19], v[140:141]
    v_pk_mul_f32 v[164:165], v[20:21], v[140:141]
    v_pk_mul_f32 v[166:167], v[22:23], v[140:141]
    v_exp_f32 v160, v160 clamp
    v_pk_fma_f32 v[176:177], v[16:17], v[136:137], v[8:9]
    v_exp_f32 v161, v161 clamp
    v_exp_f32 v162, v162 clamp
    v_pk_fma_f32 v[178:179], v[18:19], v[136:137], v[8:9]
    v_exp_f32 v163, v163 clamp
    v_exp_f32 v164, v164 clamp
    v_pk_fma_f32 v[180:181], v[20:21], v[136:137], v[8:9]
    v_exp_f32 v165, v165 clamp
    v_exp_f32 v166, v166 clamp
    v_pk_fma_f32 v[182:183], v[22:23], v[136:137], v[8:9]
    v_exp_f32 v167, v167 clamp
    v_max_f32 v176, v8, v176
    v_max_f32 v177, v8, v177
    v_max_f32 v178, v8, v178
    v_max_f32 v179, v8, v179
    v_max_f32 v180, v8, v180
    v_max_f32 v181, v8, v181
    v_max_f32 v182, v8, v182
    v_max_f32 v183, v8, v183
    v_pk_add_f32 v[176:177], v[176:177], v[160:161]
    v_pk_add_f32 v[178:179], v[178:179], v[162:163]
    v_pk_add_f32 v[180:181], v[180:181], v[164:165]
    v_pk_add_f32 v[182:183], v[182:183], v[166:167]
    v_cvt_pk_bf16_f32 v80, v176, v177
    v_cvt_pk_bf16_f32 v81, v178, v179
    v_cvt_pk_bf16_f32 v82, v180, v181
    v_cvt_pk_bf16_f32 v83, v182, v183
    buffer_store_dwordx4 v[80:83], v1, s[4:7], s43 offen offset:0 sc1
    v_pk_mul_f32 v[160:161], v[24:25], v[142:143]
    v_pk_mul_f32 v[162:163], v[26:27], v[142:143]
    v_pk_mul_f32 v[164:165], v[28:29], v[142:143]
    v_pk_mul_f32 v[166:167], v[30:31], v[142:143]
    v_exp_f32 v160, v160 clamp
    v_pk_fma_f32 v[176:177], v[24:25], v[138:139], v[8:9]
    v_exp_f32 v161, v161 clamp
    v_exp_f32 v162, v162 clamp
    v_pk_fma_f32 v[178:179], v[26:27], v[138:139], v[8:9]
    v_exp_f32 v163, v163 clamp
    v_exp_f32 v164, v164 clamp
    v_pk_fma_f32 v[180:181], v[28:29], v[138:139], v[8:9]
    v_exp_f32 v165, v165 clamp
    v_exp_f32 v166, v166 clamp
    v_pk_fma_f32 v[182:183], v[30:31], v[138:139], v[8:9]
    v_exp_f32 v167, v167 clamp
    v_max_f32 v176, v8, v176
    v_max_f32 v177, v8, v177
    v_max_f32 v178, v8, v178
    v_max_f32 v179, v8, v179
    v_max_f32 v180, v8, v180
    v_max_f32 v181, v8, v181
    v_max_f32 v182, v8, v182
    v_max_f32 v183, v8, v183
    v_pk_add_f32 v[176:177], v[176:177], v[160:161]
    v_pk_add_f32 v[178:179], v[178:179], v[162:163]
    v_pk_add_f32 v[180:181], v[180:181], v[164:165]
    v_pk_add_f32 v[182:183], v[182:183], v[166:167]
    v_cvt_pk_bf16_f32 v84, v176, v177
    v_cvt_pk_bf16_f32 v85, v178, v179
    v_cvt_pk_bf16_f32 v86, v180, v181
    v_cvt_pk_bf16_f32 v87, v182, v183
    buffer_store_dwordx4 v[84:87], v1, s[4:7], s43 offen offset:1024 sc1
    s_branch ffn1_part_body
ffn0_part_slow0:
    buffer_load_dword v254, off, s[4:7], s49 offset:0 sc1
    s_waitcnt vmcnt(0)
    v_readfirstlane_b32 s27, v254
    s_add_u32 s8, s8, 1
    s_cmp_lg_u32 s27, 0
    s_cbranch_scc1 ffn0_part_back0
    s_cmp_lt_u32 s8, 0x80000
    s_cbranch_scc1 ffn0_part_slow0
    s_branch ffn0_part_back0
ffn0_part_slow1:
    buffer_load_dword v254, off, s[4:7], s49 offset:128 sc1
    s_waitcnt vmcnt(0)
    v_readfirstlane_b32 s27, v254
    s_add_u32 s8, s8, 1
    s_cmp_lg_u32 s27, 0
    s_cbranch_scc1 ffn0_part_back1
    s_cmp_lt_u32 s8, 0x80000
    s_cbranch_scc1 ffn0_part_slow1
    s_branch ffn0_part_back1
ffn0_part_slow2:
    buffer_load_dword v254, off, s[4:7], s49 offset:256 sc1
    s_waitcnt vmcnt(0)
    v_readfirstlane_b32 s27, v254
    s_add_u32 s8, s8, 1
    s_cmp_lg_u32 s27, 0
    s_cbranch_scc1 ffn0_part_back2
    s_cmp_lt_u32 s8, 0x80000
    s_cbranch_scc1 ffn0_part_slow2
    s_branch ffn0_part_back2
ffn0_part_wdw:
    s_mov_b32 s27, 0
    s_atomic_add s27, s[4:5], s100 offset:0 glc
    s_add_u32 s8, s8, 1
    s_waitcnt lgkmcnt(0)
    s_cmp_ge_u32 s27, 18
    s_cbranch_scc1 ffn0_part_wdwk
    s_cmp_lt_u32 s8, 0x80000
    s_cbranch_scc1 ffn0_part_wdw
ffn0_part_wdwk:
    s_branch ffn0_part_wdb
ffn0_part_w1w:
    s_mov_b32 s27, 0
    s_atomic_add s27, s[4:5], s15 offset:0 glc
    s_add_u32 s8, s8, 1
    s_waitcnt lgkmcnt(0)
    s_cmp_ge_u32 s27, 16
    s_cbranch_scc1 ffn0_part_w1wk
    s_cmp_lt_u32 s8, 0x80000
    s_cbranch_scc1 ffn0_part_w1w
ffn0_part_w1wk:
    s_branch ffn0_part_w1b
ffn0_part_dp0:
    s_mov_b32 s50, 0
    s_atomic_add s50, s[4:5], s32 offset:128 glc
    s_add_u32 s8, s8, 1
    s_waitcnt lgkmcnt(0)
    s_bfe_u32 s50, s50, s33
    s_andn2_b32 s53, s50, s51
    s_cbranch_scc1 ffn0_part_dh0
    s_cmp_lt_u32 s8, 0x80000
    s_cbranch_scc1 ffn0_part_dp0
    s_andn2_b32 s53, 0xff, s51
    s_branch ffn0_part_dh0
ffn0_part_dp1:
    s_mov_b32 s50, 0
    s_atomic_add s50, s[4:5], s32 offset:128 glc
    s_add_u32 s8, s8, 1
    s_waitcnt lgkmcnt(0)
    s_bfe_u32 s50, s50, s33
    s_andn2_b32 s53, s50, s51
    s_cbranch_scc1 ffn0_part_dh1
    s_cmp_lt_u32 s8, 0x80000
    s_cbranch_scc1 ffn0_part_dp1
    s_andn2_b32 s53, 0xff, s51
    s_branch ffn0_part_dh1
ffn0_part_dp2:
    s_mov_b32 s50, 0
    s_atomic_add s50, s[4:5], s32 offset:128 glc
    s_add_u32 s8, s8, 1
    s_waitcnt lgkmcnt(0)
    s_bfe_u32 s50, s50, s33
    s_andn2_b32 s53, s50, s51
    s_cbranch_scc1 ffn0_part_dh2
    s_cmp_lt_u32 s8, 0x80000
    s_cbranch_scc1 ffn0_part_dp2
    s_andn2_b32 s53, 0xff, s51
    s_branch ffn0_part_dh2
ffn0_part_dp3:
    s_mov_b32 s50, 0
    s_atomic_add s50, s[4:5], s32 offset:128 glc
    s_add_u32 s8, s8, 1
    s_waitcnt lgkmcnt(0)
    s_bfe_u32 s50, s50, s33
    s_andn2_b32 s53, s50, s51
    s_cbranch_scc1 ffn0_part_dh3
    s_cmp_lt_u32 s8, 0x80000
    s_cbranch_scc1 ffn0_part_dp3
    s_andn2_b32 s53, 0xff, s51
    s_branch ffn0_part_dh3
ffn0_part_dp4:
    s_mov_b32 s50, 0
    s_atomic_add s50, s[4:5], s32 offset:128 glc
    s_add_u32 s8, s8, 1
    s_waitcnt lgkmcnt(0)
    s_bfe_u32 s50, s50, s33
    s_andn2_b32 s53, s50, s51
    s_cbranch_scc1 ffn0_part_dh4
    s_cmp_lt_u32 s8, 0x80000
    s_cbranch_scc1 ffn0_part_dp4
    s_andn2_b32 s53, 0xff, s51
    s_branch ffn0_part_dh4
ffn0_part_dp5:
    s_mov_b32 s50, 0
    s_atomic_add s50, s[4:5], s32 offset:128 glc
    s_add_u32 s8, s8, 1
    s_waitcnt lgkmcnt(0)
    s_bfe_u32 s50, s50, s33
    s_andn2_b32 s53, s50, s51
    s_cbranch_scc1 ffn0_part_dh5
    s_cmp_lt_u32 s8, 0x80000
    s_cbranch_scc1 ffn0_part_dp5
    s_andn2_b32 s53, 0xff, s51
    s_branch ffn0_part_dh5
ffn0_part_dp6:
    s_mov_b32 s50, 0
    s_atomic_add s50, s[4:5], s32 offset:128 glc
    s_add_u32 s8, s8, 1
    s_waitcnt lgkmcnt(0)
    s_bfe_u32 s50, s50, s33
    s_andn2_b32 s53, s50, s51
    s_cbranch_scc1 ffn0_part_dh6
    s_cmp_lt_u32 s8, 0x80000
    s_cbranch_scc1 ffn0_part_dp6
    s_andn2_b32 s53, 0xff, s51
    s_branch ffn0_part_dh6
ffn0_part_dp7:
    s_mov_b32 s50, 0
    s_atomic_add s50, s[4:5], s32 offset:128 glc
    s_add_u32 s8, s8, 1
    s_waitcnt lgkmcnt(0)
    s_bfe_u32 s50, s50, s33
    s_andn2_b32 s53, s50, s51
    s_cbranch_scc1 ffn0_part_dh7
    s_cmp_lt_u32 s8, 0x80000
    s_cbranch_scc1 ffn0_part_dp7
    s_andn2_b32 s53, 0xff, s51
    s_branch ffn0_part_dh7
ffn0_part_end:
    s_endpgm
ffn1_part:
    s_branch ffn1_part_body
.p2align 12
ffn1_part_body:
    v_and_b32 v2, 63, v0
    v_lshrrev_b32 v10, 6, v0
    s_and_b32 s21, s2, 7
    s_lshl_b32 s21, s21, 1
    s_bfe_u32 s23, s2, 65539
    s_add_u32 s21, s21, s23
    s_lshr_b32 s22, s2, 4
    v_readfirstlane_b32 s20, v10
    s_lshl_b32 s12, s22, 2
    s_lshr_b32 s13, s21, 2
    s_add_u32 s12, s12, s13
    s_and_b32 s13, s21, 3
    v_lshlrev_b32 v1, 4, v2
    v_lshlrev_b32 v3, 3, v2
    v_lshlrev_b32 v4, 2, v2
    v_and_b32 v11, 15, v2
    v_lshrrev_b32 v12, 4, v2
    s_mul_i32 s24, s20, 12288
    s_add_u32 s24, s24, 39903232
    s_lshl_b32 s25, s12, 2
    s_add_u32 s25, s25, s20
    s_mul_i32 s25, s25, 9216
    s_add_u32 s25, s25, 36700160
    s_mul_i32 s26, s13, 3
    s_add_u32 s26, s26, s20
    s_mul_i32 s29, s26, 55296
    s_add_u32 s29, s29, 18939904
    s_cmp_eq_u32 s20, 3
    s_cbranch_scc1 ffn1_part_s3a
    s_add_u32 s30, s29, 36864
    buffer_load_dwordx4 a[40:43], v1, s[4:7], s30 offen offset:1024 sc1
    buffer_load_dwordx4 a[44:47], v1, s[4:7], s30 offen offset:2048 sc1
    s_add_u32 s30, s29, 0
    buffer_load_dwordx4 a[48:51], v1, s[4:7], s30 offen offset:3072 sc1
    s_add_u32 s30, s29, 4096
    buffer_load_dwordx4 a[52:55], v1, s[4:7], s30 offen offset:0 sc1
    buffer_load_dwordx4 a[56:59], v1, s[4:7], s30 offen offset:1024 sc1
    s_add_u32 s30, s29, 12288
    buffer_load_dwordx4 a[60:63], v1, s[4:7], s30 offen offset:3072 sc1
    s_add_u32 s30, s29, 16384
    buffer_load_dwordx4 a[64:67], v1, s[4:7], s30 offen offset:0 sc1
    buffer_load_dwordx4 a[68:71], v1, s[4:7], s30 offen offset:1024 sc1
    s_add_u32 s30, s29, 24576
    buffer_load_dwordx4 a[72:75], v1, s[4:7], s30 offen offset:3072 sc1
    s_add_u32 s30, s29, 28672
    buffer_load_dwordx4 a[76:79], v1, s[4:7], s30 offen offset:0 sc1
ffn1_part_s3a:
    v_and_b32 v13, 2, v11
    v_cmp_ne_u32 vcc, 0, v13
    v_lshrrev_b32 v13, 3, v11
    v_and_b32 v14, 1, v11
    v_cndmask_b32 v13, v14, v13, vcc
    v_cmp_ne_u32 s[34:35], 0, v13
    v_cmp_lt_u32 s[36:37], 31, v2
    v_lshrrev_b32 v15, 2, v11
    v_add_u32 v15, 2, v15
    v_cndmask_b32 v15, v14, v15, vcc
    v_mad_u32_u24 v15, v12, 6, v15
    v_lshlrev_b32 v15, 4, v15
    v_mov_b32 v73, 0
    v_mov_b32 v79, 0
    v_mov_b32 v81, 0
    v_mov_b32 v87, 0
    v_mov_b32 v89, 0
    v_mov_b32 v95, 0
    v_mov_b32 v97, 0
    v_mov_b32 v103, 0
    v_mov_b32 v105, 0
    v_mov_b32 v111, 0
    v_mov_b32 v113, 0
    v_mov_b32 v119, 0
    v_mov_b32 v121, 0
    v_mov_b32 v127, 0
    v_mov_b32 v129, 0
    v_mov_b32 v135, 0
    v_mov_b32 v137, 0
    v_mov_b32 v143, 0
    v_mov_b32 v145, 0
    v_mov_b32 v151, 0
    v_mov_b32 v153, 0
    v_mov_b32 v159, 0
    v_mov_b32 v161, 0
    v_mov_b32 v167, 0
    s_lshl_b32 s27, s20, 12
    v_add_u32 v5, s27, v1
    s_lshr_b32 s27, s20, 1
    s_lshl_b32 s27, s27, 10
    s_and_b32 s28, s20, 1
    s_lshl_b32 s28, s28, 3
    s_add_u32 s27, s27, s28
    s_add_u32 s27, s27, 16384
    v_add_u32 v6, s27, v1
    v_mov_b32 v8, 897988541
    v_mov_b32 v9, 897988541
    s_mul_i32 s27, s12, 36864
    s_mul_i32 s28, s26, 1536
    s_add_u32 s27, s27, s28
    s_lshr_b32 s28, s12, 2
    s_mul_i32 s28, s28, 4096
    s_add_u32 s27, s27, s28
    s_add_u32 s40, s27, 24117248
    s_add_u32 s41, s27, 24135680
    s_add_u32 s42, s27, 30408704
    s_add_u32 s43, s27, 30427136
    v_lshrrev_b32 v7, 5, v2
    v_mul_u32_u24 v7, 17920, v7
    v_add_u32 v7, v7, v1
    v_mov_b32 v254, 1
    v_lshlrev_b32 v10, 7, v0
    s_mov_b32 s9, 40534016
    s_mov_b32 s8, 0
    s_cmp_eq_u32 s20, 3
    s_cbranch_scc1 ffn1_part_s3b
    s_waitcnt vmcnt(10)
    s_barrier
    s_and_b32 s14, s14, 0xfffff800
    s_lshl_b32 s27, s20, 9
    s_add_u32 s14, s14, s27
    s_atomic_add s3, s[4:5], s14 offset:0
    s_atomic_add s3, s[4:5], s14 offset:128
    s_atomic_add s3, s[4:5], s14 offset:256
    s_atomic_add s3, s[4:5], s14 offset:384
    s_add_u32 s30, s29, 28672
    buffer_load_dwordx4 a[80:83], v1, s[4:7], s30 offen offset:1024 sc1
    s_add_u32 s30, s29, 36864
    buffer_load_dwordx4 a[84:87], v1, s[4:7], s30 offen offset:3072 sc1
    s_add_u32 s30, s29, 40960
    buffer_load_dwordx4 a[88:91], v1, s[4:7], s30 offen offset:0 sc1
    buffer_load_dwordx4 a[92:95], v1, s[4:7], s30 offen offset:1024 sc1
    s_add_u32 s30, s29, 4096
    buffer_load_dwordx4 a[96:99], v1, s[4:7], s30 offen offset:2048 sc1
    buffer_load_dwordx4 a[100:103], v1, s[4:7], s30 offen offset:3072 sc1
    s_add_u32 s30, s29, 8192
    buffer_load_dwordx4 a[104:107], v1, s[4:7], s30 offen offset:0 sc1
    s_add_u32 s30, s29, 16384
    buffer_load_dwordx4 a[108:111], v1, s[4:7], s30 offen offset:2048 sc1
    buffer_load_dwordx4 a[112:115], v1, s[4:7], s30 offen offset:3072 sc1
    s_add_u32 s30, s29, 20480
    buffer_load_dwordx4 a[116:119], v1, s[4:7], s30 offen offset:0 sc1
    s_add_u32 s30, s29, 28672
    buffer_load_dwordx4 a[120:123], v1, s[4:7], s30 offen offset:2048 sc1
    buffer_load_dwordx4 a[124:127], v1, s[4:7], s30 offen offset:3072 sc1
    s_branch ffn1_part_s3c
ffn1_part_s3b:
    s_waitcnt vmcnt(0)
    s_barrier
    s_and_b32 s14, s14, 0xfffff800
    s_lshl_b32 s27, s20, 9
    s_add_u32 s14, s14, s27
    s_atomic_add s3, s[4:5], s14 offset:0
    s_atomic_add s3, s[4:5], s14 offset:128
    s_atomic_add s3, s[4:5], s14 offset:256
    s_atomic_add s3, s[4:5], s14 offset:384
    v_and_b32 v13, 1, v11
    v_lshlrev_b32 v13, 6, v13
    v_lshl_add_u32 v13, v12, 4, v13
    s_mov_b32 s30, 19922944
    buffer_load_dwordx4 a[144:147], v13, s[4:7], s30 offen offset:0 sc1
    buffer_load_dwordx4 a[148:151], v13, s[4:7], s30 offen offset:128 sc1
    buffer_load_dwordx4 a[152:155], v13, s[4:7], s30 offen offset:256 sc1
    buffer_load_dwordx4 a[156:159], v13, s[4:7], s30 offen offset:384 sc1
    buffer_load_dwordx4 a[160:163], v13, s[4:7], s30 offen offset:512 sc1
    buffer_load_dwordx4 a[164:167], v13, s[4:7], s30 offen offset:640 sc1
    buffer_load_dwordx4 a[168:171], v13, s[4:7], s30 offen offset:768 sc1
    buffer_load_dwordx4 a[172:175], v13, s[4:7], s30 offen offset:896 sc1
    buffer_load_dwordx4 a[176:179], v13, s[4:7], s30 offen offset:1024 sc1
    buffer_load_dwordx4 a[180:183], v13, s[4:7], s30 offen offset:1152 sc1
    buffer_load_dwordx4 a[184:187], v13, s[4:7], s30 offen offset:1280 sc1
    buffer_load_dwordx4 a[188:191], v13, s[4:7], s30 offen offset:1408 sc1
    buffer_load_dwordx4 a[192:195], v13, s[4:7], s30 offen offset:1536 sc1
    buffer_load_dwordx4 a[196:199], v13, s[4:7], s30 offen offset:1664 sc1
    buffer_load_dwordx4 a[200:203], v13, s[4:7], s30 offen offset:1792 sc1
    buffer_load_dwordx4 a[204:207], v13, s[4:7], s30 offen offset:1920 sc1
    buffer_load_dwordx4 a[208:211], v13, s[4:7], s30 offen offset:2048 sc1
    buffer_load_dwordx4 a[212:215], v13, s[4:7], s30 offen offset:2176 sc1
ffn1_part_s3c:
    s_mov_b64 exec, 0
    s_cmp_eq_u32 s20, 0
    s_cbranch_scc1 ffn1_part_pad0_0x
    s_cmp_eq_u32 s20, 1
    s_cbranch_scc1 ffn1_part_pad0_1x
    s_cmp_eq_u32 s20, 2
    s_cbranch_scc1 ffn1_part_pad0_2x
    s_branch ffn1_part_pad0_3x
ffn1_part_padret0:
    s_mov_b64 exec, -1
    s_lshl_b32 s48, s20, 13
    s_add_u32 s9, s9, s48
    s_lshl_b32 s48, s22, 7
    s_add_u32 s9, s9, s48
ffn1_part_sq:
    s_mov_b32 s48, 0
    s_atomic_add s48, s[4:5], s9 offset:0 glc
    s_mov_b32 s49, 0
    s_atomic_add s49, s[4:5], s9 offset:2048 glc
    s_mov_b32 s50, 0
    s_atomic_add s50, s[4:5], s9 offset:4096 glc
    s_mov_b32 s51, 0
    s_atomic_add s51, s[4:5], s9 offset:6144 glc
    s_add_u32 s8, s8, 1
    s_waitcnt lgkmcnt(0)
    s_min_u32 s48, s48, s49
    s_min_u32 s48, s48, s50
    s_min_u32 s48, s48, s51
    s_cmp_ge_u32 s48, 16
    s_cbranch_scc1 ffn1_part_sqk
    s_cmp_lt_u32 s8, 0x80000
    s_cbranch_scc1 ffn1_part_sq
ffn1_part_sqk:
    buffer_load_dwordx4 v[16:19], v1, s[4:7], s24 offen offset:0 sc1
    buffer_load_dwordx4 v[20:23], v1, s[4:7], s24 offen offset:1024 sc1
    buffer_load_dwordx4 v[24:27], v15, s[4:7], s24 offen offset:2560 sc1
    buffer_load_dwordx2 v[28:29], v3, s[4:7], s24 offen offset:2048 sc1
    buffer_load_dwordx4 v[74:77], v1, s[4:7], s25 offen offset:0 sc1
    buffer_load_dwordx4 v[82:85], v1, s[4:7], s25 offen offset:1024 sc1
    buffer_load_dword v72, v4, s[4:7], s25 offen offset:2048 sc1
    s_add_u32 s24, s24, 3072
    s_add_u32 s25, s25, 2304
    buffer_load_dwordx4 v[30:33], v1, s[4:7], s24 offen offset:0 sc1
    buffer_load_dwordx4 v[34:37], v1, s[4:7], s24 offen offset:1024 sc1
    buffer_load_dwordx4 v[38:41], v15, s[4:7], s24 offen offset:2560 sc1
    buffer_load_dwordx2 v[42:43], v3, s[4:7], s24 offen offset:2048 sc1
    buffer_load_dwordx4 v[90:93], v1, s[4:7], s25 offen offset:0 sc1
    buffer_load_dwordx4 v[98:101], v1, s[4:7], s25 offen offset:1024 sc1
    buffer_load_dword v88, v4, s[4:7], s25 offen offset:2048 sc1
    s_add_u32 s24, s24, 3072
    s_add_u32 s25, s25, 2304
    buffer_load_dwordx4 v[44:47], v1, s[4:7], s24 offen offset:0 sc1
    buffer_load_dwordx4 v[48:51], v1, s[4:7], s24 offen offset:1024 sc1
    buffer_load_dwordx4 v[52:55], v15, s[4:7], s24 offen offset:2560 sc1
    buffer_load_dwordx2 v[56:57], v3, s[4:7], s24 offen offset:2048 sc1
    buffer_load_dwordx4 v[106:109], v1, s[4:7], s25 offen offset:0 sc1
    buffer_load_dwordx4 v[114:117], v1, s[4:7], s25 offen offset:1024 sc1
    buffer_load_dword v104, v4, s[4:7], s25 offen offset:2048 sc1
    s_add_u32 s24, s24, 3072
    s_add_u32 s25, s25, 2304
    buffer_load_dwordx4 v[58:61], v1, s[4:7], s24 offen offset:0 sc1
    buffer_load_dwordx4 v[62:65], v1, s[4:7], s24 offen offset:1024 sc1
    buffer_load_dwordx4 v[66:69], v15, s[4:7], s24 offen offset:2560 sc1
    buffer_load_dwordx2 v[70:71], v3, s[4:7], s24 offen offset:2048 sc1
    buffer_load_dwordx4 v[122:125], v1, s[4:7], s25 offen offset:0 sc1
    buffer_load_dwordx4 v[130:133], v1, s[4:7], s25 offen offset:1024 sc1
    buffer_load_dword v120, v4, s[4:7], s25 offen offset:2048 sc1
    s_cmp_eq_u32 s20, 3
    s_cbranch_scc1 ffn1_part_w3
    s_mul_i32 s24, s21, 1036288
    s_add_u32 s24, s24, 0
    v_lshlrev_b32 v3, 4, v0
    v_mov_b32 v252, 897988541
    v_mov_b32 v253, 897988541
    v_mov_b32 v254, 0
    v_mov_b32 v255, 0
    s_waitcnt vmcnt(24)
    v_cvt_pk_bf16_f32 v24, v24, v25
    v_cvt_pk_bf16_f32 v25, v26, v27
    v_cvt_pk_bf16_f32 v28, v28, 0
    v_cvt_pk_bf16_f32 v29, v29, 0
    v_cvt_pk_bf16_f32 v138, v16, v17
    v_cvt_pk_bf16_f32 v139, v18, v19
    v_cvt_pk_bf16_f32 v140, v20, v21
    v_cvt_pk_bf16_f32 v141, v22, v23
    v_cndmask_b32 v146, v24, 0, s[34:35]
    v_cndmask_b32 v147, v25, 0, s[34:35]
    v_cndmask_b32 v148, 0, v24, s[34:35]
    v_cndmask_b32 v149, 0, v25, s[34:35]
    s_waitcnt vmcnt(21)
    v_mov_b32 v78, v72
    v_lshrrev_b32 v80, 16, v72
    v_lshrrev_b32 v86, 16, v72
    v_cndmask_b32 v144, v29, 0, s[36:37]
    v_cndmask_b32 v150, 0, v29, s[36:37]
    v_cndmask_b32 v136, v28, 0, s[36:37]
    v_cndmask_b32 v142, 0, v28, s[36:37]
    s_nop 0
    v_mfma_f32_16x16x32_bf16 v[176:179], v[144:147], v[72:75], v[252:255]
    s_waitcnt vmcnt(17)
    v_cvt_pk_bf16_f32 v38, v38, v39
    v_cvt_pk_bf16_f32 v39, v40, v41
    v_mfma_f32_16x16x32_bf16 v[176:179], v[148:151], v[76:79], v[176:179]
    s_add_u32 s30, s29, 32768
    buffer_load_dwordx4 a[128:131], v1, s[4:7], s30 offen sc1
    v_cvt_pk_bf16_f32 v42, v42, 0
    v_cvt_pk_bf16_f32 v43, v43, 0
    v_cvt_pk_bf16_f32 v154, v30, v31
    v_mfma_f32_16x16x32_bf16 v[188:191], v[144:147], v[80:83], v[252:255]
    v_cvt_pk_bf16_f32 v155, v32, v33
    v_cvt_pk_bf16_f32 v156, v34, v35
    v_mfma_f32_16x16x32_bf16 v[188:191], v[148:151], v[84:87], v[188:191]
    s_add_u32 s30, s29, 43008
    buffer_load_dwordx4 a[132:135], v1, s[4:7], s30 offen sc1
    v_cvt_pk_bf16_f32 v157, v36, v37
    v_cndmask_b32 v162, v38, 0, s[34:35]
    v_cndmask_b32 v163, v39, 0, s[34:35]
    v_mfma_f32_16x16x32_bf16 v[168:171], v[136:139], v[72:75], 0
    v_cndmask_b32 v164, 0, v38, s[34:35]
    v_cndmask_b32 v165, 0, v39, s[34:35]
    s_waitcnt vmcnt(16)
    v_mfma_f32_16x16x32_bf16 v[172:175], v[140:143], v[76:79], 0
    s_add_u32 s30, s29, 44032
    buffer_load_dwordx4 a[136:139], v1, s[4:7], s30 offen sc1
    v_mov_b32 v94, v88
    v_lshrrev_b32 v96, 16, v88
    v_mfma_f32_16x16x32_bf16 v[180:183], v[136:139], v[80:83], 0
    v_lshrrev_b32 v102, 16, v88
    v_cndmask_b32 v160, v43, 0, s[36:37]
    v_cndmask_b32 v166, 0, v43, s[36:37]
    v_mfma_f32_16x16x32_bf16 v[184:187], v[140:143], v[84:87], 0
    s_add_u32 s30, s29, 45056
    buffer_load_dwordx4 a[140:143], v1, s[4:7], s30 offen sc1
    v_cndmask_b32 v152, v42, 0, s[36:37]
    v_cndmask_b32 v158, 0, v42, s[36:37]
    v_mfma_f32_16x16x32_bf16 v[200:203], v[160:163], v[88:91], v[252:255]
    v_rcp_f32 v176, v176
    v_rcp_f32 v177, v177
    v_rcp_f32 v188, v188
    v_rcp_f32 v189, v189
    v_mul_f32 v168, v168, v176
    v_mfma_f32_16x16x32_bf16 v[200:203], v[164:167], v[92:95], v[200:203]
    buffer_load_dwordx4 v[240:243], v1, s[4:7], s40 offen offset:0 sc1
    v_mul_f32 v169, v169, v176
    v_mul_f32 v170, v170, v176
    v_mul_f32 v171, v171, v176
    v_mul_f32 v172, v172, v177
    v_mfma_f32_16x16x32_bf16 v[212:215], v[160:163], v[96:99], v[252:255]
    v_mul_f32 v173, v173, v177
    v_mul_f32 v174, v174, v177
    v_mul_f32 v175, v175, v177
    v_cndmask_b32 v176, v176, v177, s[36:37]
    v_mfma_f32_16x16x32_bf16 v[212:215], v[164:167], v[100:103], v[212:215]
    buffer_load_dwordx4 v[244:247], v1, s[4:7], s41 offen offset:0 sc1
    v_cvt_pk_bf16_f32 v216, v168, v169
    v_cvt_pk_bf16_f32 v217, v170, v171
    v_cvt_pk_bf16_f32 v218, v172, v173
    v_cvt_pk_bf16_f32 v219, v174, v175
    v_mfma_f32_16x16x32_bf16 v[192:195], v[152:155], v[88:91], 0
    v_mul_f32 v232, v178, v176
    v_mfma_f32_16x16x32_bf16 v[196:199], v[156:159], v[92:95], 0
    buffer_load_dwordx4 v[248:251], v7, s[4:7], s40 offen offset:1024 sc1
    ds_write_b128 v5, v[216:219] offset:0
    v_mul_f32 v180, v180, v188
    v_mul_f32 v181, v181, v188
    v_mul_f32 v182, v182, v188
    v_mul_f32 v183, v183, v188
    v_mul_f32 v184, v184, v189
    v_mul_f32 v185, v185, v189
    v_mul_f32 v186, v186, v189
    v_mfma_f32_16x16x32_bf16 v[204:207], v[152:155], v[96:99], 0
    v_mul_f32 v187, v187, v189
    v_cndmask_b32 v188, v188, v189, s[36:37]
    v_cvt_pk_bf16_f32 v220, v180, v181
    v_cvt_pk_bf16_f32 v221, v182, v183
    v_mfma_f32_16x16x32_bf16 v[208:211], v[156:159], v[100:103], 0
    v_cvt_pk_bf16_f32 v222, v184, v185
    v_cvt_pk_bf16_f32 v223, v186, v187
    v_mul_f32 v236, v190, v188
    ds_write_b128 v5, v[220:223] offset:18432
    s_waitcnt vmcnt(17)
    v_cvt_pk_bf16_f32 v52, v52, v53
    v_cvt_pk_bf16_f32 v53, v54, v55
    v_cvt_pk_bf16_f32 v56, v56, 0
    v_cvt_pk_bf16_f32 v57, v57, 0
    v_cvt_pk_bf16_f32 v138, v44, v45
    v_cvt_pk_bf16_f32 v139, v46, v47
    v_cvt_pk_bf16_f32 v140, v48, v49
    v_cvt_pk_bf16_f32 v141, v50, v51
    s_waitcnt lgkmcnt(0)
    s_barrier
    ds_read_b128 v[72:75], v1 offset:0
    ds_read_b128 v[76:79], v1 offset:18432
    ds_read_b128 v[80:83], v1 offset:4096
    ds_read_b128 v[84:87], v1 offset:22528
    ds_read_b128 v[88:91], v1 offset:8192
    ds_read_b128 v[92:95], v1 offset:26624
    v_cndmask_b32 v146, v52, 0, s[34:35]
    v_cndmask_b32 v147, v53, 0, s[34:35]
    v_cndmask_b32 v148, 0, v52, s[34:35]
    v_cndmask_b32 v149, 0, v53, s[34:35]
    s_waitcnt lgkmcnt(4)
    v_mfma_f32_16x16x32_bf16 v[16:19], a[0:3], v[72:75], 0
    ds_read_b128 v[96:99], v1 offset:12288
    ds_read_b128 v[100:103], v1 offset:30720
    v_rcp_f32 v200, v200
    v_rcp_f32 v201, v201
    v_rcp_f32 v212, v212
    v_mfma_f32_16x16x32_bf16 v[24:27], a[0:3], v[76:79], 0
    v_rcp_f32 v213, v213
    v_mul_f32 v192, v192, v200
    v_mfma_f32_16x16x32_bf16 v[20:23], a[4:7], v[72:75], 0
    v_mul_f32 v193, v193, v200
    v_mul_f32 v194, v194, v200
    v_mul_f32 v195, v195, v200
    v_mfma_f32_16x16x32_bf16 v[28:31], a[4:7], v[76:79], 0
    v_mul_f32 v196, v196, v201
    v_mul_f32 v197, v197, v201
    v_mfma_f32_16x16x32_bf16 v[32:35], a[8:11], v[72:75], 0
    v_mul_f32 v198, v198, v201
    v_mul_f32 v199, v199, v201
    v_cndmask_b32 v200, v200, v201, s[36:37]
    v_mfma_f32_16x16x32_bf16 v[36:39], a[8:11], v[76:79], 0
    v_cvt_pk_bf16_f32 v224, v192, v193
    v_cvt_pk_bf16_f32 v225, v194, v195
    s_waitcnt lgkmcnt(4)
    v_mfma_f32_16x16x32_bf16 v[16:19], a[12:15], v[80:83], v[16:19]
    v_cvt_pk_bf16_f32 v226, v196, v197
    v_cvt_pk_bf16_f32 v227, v198, v199
    v_mfma_f32_16x16x32_bf16 v[24:27], a[12:15], v[84:87], v[24:27]
    s_add_u32 s30, s24, 0
    buffer_load_dwordx4 a[0:3], v3, s[4:7], s30 offen sc1
    v_mul_f32 v233, v202, v200
    v_mfma_f32_16x16x32_bf16 v[20:23], a[16:19], v[80:83], v[20:23]
    ds_write_b128 v5, v[224:227] offset:1024
    v_mul_f32 v204, v204, v212
    v_mul_f32 v205, v205, v212
    v_mul_f32 v206, v206, v212
    v_mfma_f32_16x16x32_bf16 v[28:31], a[16:19], v[84:87], v[28:31]
    s_add_u32 s30, s24, 4096
    buffer_load_dwordx4 a[4:7], v3, s[4:7], s30 offen sc1
    v_mul_f32 v207, v207, v212
    v_mul_f32 v208, v208, v213
    v_mul_f32 v209, v209, v213
    v_mfma_f32_16x16x32_bf16 v[32:35], a[20:23], v[80:83], v[32:35]
    v_mul_f32 v210, v210, v213
    v_mul_f32 v211, v211, v213
    v_mfma_f32_16x16x32_bf16 v[36:39], a[20:23], v[84:87], v[36:39]
    s_add_u32 s30, s24, 8192
    buffer_load_dwordx4 a[8:11], v3, s[4:7], s30 offen sc1
    v_cndmask_b32 v212, v212, v213, s[36:37]
    v_cvt_pk_bf16_f32 v228, v204, v205
    v_cvt_pk_bf16_f32 v229, v206, v207
    s_waitcnt lgkmcnt(3)
    v_mfma_f32_16x16x32_bf16 v[16:19], a[24:27], v[88:91], v[16:19]
    v_cvt_pk_bf16_f32 v230, v208, v209
    v_cvt_pk_bf16_f32 v231, v210, v211
    v_mfma_f32_16x16x32_bf16 v[24:27], a[24:27], v[92:95], v[24:27]
    s_add_u32 s30, s24, 12288
    buffer_load_dwordx4 a[12:15], v3, s[4:7], s30 offen sc1
    v_mul_f32 v237, v214, v212
    v_mfma_f32_16x16x32_bf16 v[20:23], a[28:31], v[88:91], v[20:23]
    ds_write_b128 v5, v[228:231] offset:19456
    s_waitcnt vmcnt(18)
    v_mov_b32 v110, v104
    v_lshrrev_b32 v112, 16, v104
    v_mfma_f32_16x16x32_bf16 v[28:31], a[28:31], v[92:95], v[28:31]
    s_add_u32 s30, s24, 16384
    buffer_load_dwordx4 a[16:19], v3, s[4:7], s30 offen sc1
    v_lshrrev_b32 v118, 16, v104
    v_cndmask_b32 v144, v57, 0, s[36:37]
    v_mfma_f32_16x16x32_bf16 v[32:35], a[32:35], v[88:91], v[32:35]
    v_cndmask_b32 v150, 0, v57, s[36:37]
    v_cndmask_b32 v136, v56, 0, s[36:37]
    v_cndmask_b32 v142, 0, v56, s[36:37]
    v_mfma_f32_16x16x32_bf16 v[36:39], a[32:35], v[92:95], v[36:39]
    s_add_u32 s30, s24, 20480
    buffer_load_dwordx4 a[20:23], v3, s[4:7], s30 offen sc1
    s_waitcnt lgkmcnt(0)
    s_barrier
    v_mfma_f32_16x16x32_bf16 v[16:19], a[36:39], v[96:99], v[16:19]
    ds_read_b128 v[72:75], v1 offset:1024
    ds_read_b128 v[76:79], v1 offset:19456
    ds_read_b128 v[80:83], v1 offset:5120
    ds_read_b128 v[84:87], v1 offset:23552
    ds_read_b128 v[88:91], v1 offset:9216
    ds_read_b128 v[92:95], v1 offset:27648
    v_mfma_f32_16x16x32_bf16 v[24:27], a[36:39], v[100:103], v[24:27]
    s_add_u32 s30, s24, 24576
    buffer_load_dwordx4 a[24:27], v3, s[4:7], s30 offen sc1
    v_mfma_f32_16x16x32_bf16 v[20:23], a[40:43], v[96:99], v[20:23]
    v_mfma_f32_16x16x32_bf16 v[28:31], a[40:43], v[100:103], v[28:31]
    s_add_u32 s30, s24, 28672
    buffer_load_dwordx4 a[28:31], v3, s[4:7], s30 offen sc1
    v_mfma_f32_16x16x32_bf16 v[32:35], a[44:47], v[96:99], v[32:35]
    v_mfma_f32_16x16x32_bf16 v[36:39], a[44:47], v[100:103], v[36:39]
    s_add_u32 s30, s24, 32768
    buffer_load_dwordx4 a[32:35], v3, s[4:7], s30 offen sc1
    v_mfma_f32_16x16x32_bf16 v[176:179], v[144:147], v[104:107], v[252:255]
    s_waitcnt vmcnt(19)
    v_cvt_pk_bf16_f32 v66, v66, v67
    v_mfma_f32_16x16x32_bf16 v[176:179], v[148:151], v[108:111], v[176:179]
    v_cvt_pk_bf16_f32 v67, v68, v69
    v_cvt_pk_bf16_f32 v70, v70, 0
    v_mfma_f32_16x16x32_bf16 v[188:191], v[144:147], v[112:115], v[252:255]
    v_cvt_pk_bf16_f32 v71, v71, 0
    v_mfma_f32_16x16x32_bf16 v[188:191], v[148:151], v[116:119], v[188:191]
    v_cvt_pk_bf16_f32 v154, v58, v59
    v_cvt_pk_bf16_f32 v155, v60, v61
    v_mfma_f32_16x16x32_bf16 v[168:171], v[136:139], v[104:107], 0
    v_cvt_pk_bf16_f32 v156, v62, v63
    v_cvt_pk_bf16_f32 v157, v64, v65
    v_mfma_f32_16x16x32_bf16 v[172:175], v[140:143], v[108:111], 0
    v_cndmask_b32 v162, v66, 0, s[34:35]
    v_mfma_f32_16x16x32_bf16 v[180:183], v[136:139], v[112:115], 0
    v_cndmask_b32 v163, v67, 0, s[34:35]
    v_cndmask_b32 v164, 0, v66, s[34:35]
    v_mfma_f32_16x16x32_bf16 v[184:187], v[140:143], v[116:119], 0
    v_cndmask_b32 v165, 0, v67, s[34:35]
    s_waitcnt lgkmcnt(4)
    v_mfma_f32_16x16x32_bf16 v[16:19], a[48:51], v[72:75], v[16:19]
    ds_read_b128 v[96:99], v1 offset:13312
    ds_read_b128 v[100:103], v1 offset:31744
    v_rcp_f32 v176, v176
    v_rcp_f32 v177, v177
    v_rcp_f32 v188, v188
    v_mfma_f32_16x16x32_bf16 v[24:27], a[48:51], v[76:79], v[24:27]
    s_add_u32 s30, s24, 36864
    buffer_load_dwordx4 a[36:39], v3, s[4:7], s30 offen sc1
    v_rcp_f32 v189, v189
    v_mul_f32 v168, v168, v176
    v_mfma_f32_16x16x32_bf16 v[20:23], a[52:55], v[72:75], v[20:23]
    v_mul_f32 v169, v169, v176
    v_mul_f32 v170, v170, v176
    v_mul_f32 v171, v171, v176
    v_mfma_f32_16x16x32_bf16 v[28:31], a[52:55], v[76:79], v[28:31]
    s_add_u32 s30, s24, 40960
    buffer_load_dwordx4 a[40:43], v3, s[4:7], s30 offen sc1
    v_mul_f32 v172, v172, v177
    v_mul_f32 v173, v173, v177
    v_mfma_f32_16x16x32_bf16 v[32:35], a[56:59], v[72:75], v[32:35]
    v_mul_f32 v174, v174, v177
    v_mul_f32 v175, v175, v177
    v_cndmask_b32 v176, v176, v177, s[36:37]
    v_mfma_f32_16x16x32_bf16 v[36:39], a[56:59], v[76:79], v[36:39]
    s_add_u32 s30, s24, 45056
    buffer_load_dwordx4 a[44:47], v3, s[4:7], s30 offen sc1
    v_cvt_pk_bf16_f32 v216, v168, v169
    v_cvt_pk_bf16_f32 v217, v170, v171
    s_waitcnt lgkmcnt(4)
    v_mfma_f32_16x16x32_bf16 v[16:19], a[60:63], v[80:83], v[16:19]
    v_cvt_pk_bf16_f32 v218, v172, v173
    v_cvt_pk_bf16_f32 v219, v174, v175
    v_mfma_f32_16x16x32_bf16 v[24:27], a[60:63], v[84:87], v[24:27]
    s_add_u32 s30, s24, 49152
    buffer_load_dwordx4 a[48:51], v3, s[4:7], s30 offen sc1
    v_mul_f32 v234, v178, v176
    v_mfma_f32_16x16x32_bf16 v[20:23], a[64:67], v[80:83], v[20:23]
    ds_write_b128 v5, v[216:219] offset:2048
    v_mul_f32 v180, v180, v188
    v_mul_f32 v181, v181, v188
    v_mul_f32 v182, v182, v188
    v_mfma_f32_16x16x32_bf16 v[28:31], a[64:67], v[84:87], v[28:31]
    s_add_u32 s30, s24, 53248
    buffer_load_dwordx4 a[52:55], v3, s[4:7], s30 offen sc1
    v_mul_f32 v183, v183, v188
    v_mul_f32 v184, v184, v189
    v_mul_f32 v185, v185, v189
    v_mfma_f32_16x16x32_bf16 v[32:35], a[68:71], v[80:83], v[32:35]
    v_mul_f32 v186, v186, v189
    v_mul_f32 v187, v187, v189
    v_mfma_f32_16x16x32_bf16 v[36:39], a[68:71], v[84:87], v[36:39]
    s_add_u32 s30, s24, 57344
    buffer_load_dwordx4 a[56:59], v3, s[4:7], s30 offen sc1
    v_cndmask_b32 v188, v188, v189, s[36:37]
    v_cvt_pk_bf16_f32 v220, v180, v181
    v_cvt_pk_bf16_f32 v221, v182, v183
    s_waitcnt lgkmcnt(3)
    v_mfma_f32_16x16x32_bf16 v[16:19], a[72:75], v[88:91], v[16:19]
    v_cvt_pk_bf16_f32 v222, v184, v185
    v_cvt_pk_bf16_f32 v223, v186, v187
    v_mfma_f32_16x16x32_bf16 v[24:27], a[72:75], v[92:95], v[24:27]
    s_add_u32 s30, s24, 61440
    buffer_load_dwordx4 a[60:63], v3, s[4:7], s30 offen sc1
    v_mul_f32 v238, v190, v188
    v_mfma_f32_16x16x32_bf16 v[20:23], a[76:79], v[88:91], v[20:23]
    ds_write_b128 v5, v[220:223] offset:20480
    s_waitcnt vmcnt(23)
    v_mov_b32 v126, v120
    v_lshrrev_b32 v128, 16, v120
    v_mfma_f32_16x16x32_bf16 v[28:31], a[76:79], v[92:95], v[28:31]
    s_add_u32 s30, s24, 65536
    buffer_load_dwordx4 a[64:67], v3, s[4:7], s30 offen sc1
    v_lshrrev_b32 v134, 16, v120
    v_cndmask_b32 v160, v71, 0, s[36:37]
    v_mfma_f32_16x16x32_bf16 v[32:35], a[80:83], v[88:91], v[32:35]
    v_cndmask_b32 v166, 0, v71, s[36:37]
    v_cndmask_b32 v152, v70, 0, s[36:37]
    v_cndmask_b32 v158, 0, v70, s[36:37]
    v_mfma_f32_16x16x32_bf16 v[36:39], a[80:83], v[92:95], v[36:39]
    s_add_u32 s30, s24, 69632
    buffer_load_dwordx4 a[68:71], v3, s[4:7], s30 offen sc1
    s_waitcnt lgkmcnt(0)
    s_barrier
    v_mfma_f32_16x16x32_bf16 v[16:19], a[84:87], v[96:99], v[16:19]
    ds_read_b128 v[72:75], v1 offset:2048
    ds_read_b128 v[76:79], v1 offset:20480
    ds_read_b128 v[80:83], v1 offset:6144
    ds_read_b128 v[84:87], v1 offset:24576
    ds_read_b128 v[88:91], v1 offset:10240
    ds_read_b128 v[92:95], v1 offset:28672
    v_mfma_f32_16x16x32_bf16 v[24:27], a[84:87], v[100:103], v[24:27]
    s_add_u32 s30, s24, 73728
    buffer_load_dwordx4 a[72:75], v3, s[4:7], s30 offen sc1
    v_mfma_f32_16x16x32_bf16 v[20:23], a[88:91], v[96:99], v[20:23]
    v_mfma_f32_16x16x32_bf16 v[28:31], a[88:91], v[100:103], v[28:31]
    s_add_u32 s30, s24, 77824
    buffer_load_dwordx4 a[76:79], v3, s[4:7], s30 offen sc1
    v_mfma_f32_16x16x32_bf16 v[32:35], a[92:95], v[96:99], v[32:35]
    v_mfma_f32_16x16x32_bf16 v[36:39], a[92:95], v[100:103], v[36:39]
    s_add_u32 s30, s24, 81920
    buffer_load_dwordx4 a[80:83], v3, s[4:7], s30 offen sc1
    v_mfma_f32_16x16x32_bf16 v[200:203], v[160:163], v[120:123], v[252:255]
    v_mfma_f32_16x16x32_bf16 v[200:203], v[164:167], v[124:127], v[200:203]
    v_mfma_f32_16x16x32_bf16 v[212:215], v[160:163], v[128:131], v[252:255]
    v_mfma_f32_16x16x32_bf16 v[212:215], v[164:167], v[132:135], v[212:215]
    v_mfma_f32_16x16x32_bf16 v[192:195], v[152:155], v[120:123], 0
    v_mfma_f32_16x16x32_bf16 v[196:199], v[156:159], v[124:127], 0
    v_mfma_f32_16x16x32_bf16 v[204:207], v[152:155], v[128:131], 0
    v_rcp_f32 v200, v200
    v_rcp_f32 v201, v201
    v_rcp_f32 v212, v212
    v_mfma_f32_16x16x32_bf16 v[208:211], v[156:159], v[132:135], 0
    v_rcp_f32 v213, v213
    v_mul_f32 v192, v192, v200
    s_waitcnt lgkmcnt(4)
    v_mfma_f32_16x16x32_bf16 v[16:19], a[96:99], v[72:75], v[16:19]
    ds_read_b128 v[96:99], v1 offset:14336
    ds_read_b128 v[100:103], v1 offset:32768
    v_mul_f32 v193, v193, v200
    v_mul_f32 v194, v194, v200
    v_mfma_f32_16x16x32_bf16 v[24:27], a[96:99], v[76:79], v[24:27]
    s_add_u32 s30, s24, 86016
    buffer_load_dwordx4 a[84:87], v3, s[4:7], s30 offen sc1
    v_mul_f32 v195, v195, v200
    v_mul_f32 v196, v196, v201
    v_mul_f32 v197, v197, v201
    v_mfma_f32_16x16x32_bf16 v[20:23], a[100:103], v[72:75], v[20:23]
    v_mul_f32 v198, v198, v201
    v_mul_f32 v199, v199, v201
    v_mfma_f32_16x16x32_bf16 v[28:31], a[100:103], v[76:79], v[28:31]
    s_add_u32 s30, s24, 90112
    buffer_load_dwordx4 a[88:91], v3, s[4:7], s30 offen sc1
    v_cndmask_b32 v200, v200, v201, s[36:37]
    v_cvt_pk_bf16_f32 v224, v192, v193
    v_mfma_f32_16x16x32_bf16 v[32:35], a[104:107], v[72:75], v[32:35]
    v_cvt_pk_bf16_f32 v225, v194, v195
    v_cvt_pk_bf16_f32 v226, v196, v197
    v_cvt_pk_bf16_f32 v227, v198, v199
    v_mfma_f32_16x16x32_bf16 v[36:39], a[104:107], v[76:79], v[36:39]
ffn1_part_pad0_0x:
    s_cbranch_execz ffn1_part_pad0_4x
    s_add_u32 s30, s24, 94208
    buffer_load_dwordx4 a[92:95], v3, s[4:7], s30 offen sc1
    v_mul_f32 v235, v202, v200
    s_waitcnt lgkmcnt(4)
    v_mfma_f32_16x16x32_bf16 v[16:19], a[108:111], v[80:83], v[16:19]
    ds_write_b128 v5, v[224:227] offset:3072
    v_mul_f32 v204, v204, v212
    v_mul_f32 v205, v205, v212
    v_mfma_f32_16x16x32_bf16 v[24:27], a[108:111], v[84:87], v[24:27]
    s_add_u32 s30, s24, 98304
    buffer_load_dwordx4 a[96:99], v3, s[4:7], s30 offen sc1
    v_mul_f32 v206, v206, v212
    v_mul_f32 v207, v207, v212
    v_mul_f32 v208, v208, v213
    v_mfma_f32_16x16x32_bf16 v[20:23], a[112:115], v[80:83], v[20:23]
    v_mul_f32 v209, v209, v213
    v_mul_f32 v210, v210, v213
    v_mfma_f32_16x16x32_bf16 v[28:31], a[112:115], v[84:87], v[28:31]
    s_add_u32 s30, s24, 102400
    buffer_load_dwordx4 a[100:103], v3, s[4:7], s30 offen sc1
    v_mul_f32 v211, v211, v213
    v_cndmask_b32 v212, v212, v213, s[36:37]
    v_mfma_f32_16x16x32_bf16 v[32:35], a[116:119], v[80:83], v[32:35]
    v_cvt_pk_bf16_f32 v228, v204, v205
    v_cvt_pk_bf16_f32 v229, v206, v207
    v_cvt_pk_bf16_f32 v230, v208, v209
    v_mfma_f32_16x16x32_bf16 v[36:39], a[116:119], v[84:87], v[36:39]
    s_add_u32 s30, s24, 106496
    buffer_load_dwordx4 a[104:107], v3, s[4:7], s30 offen sc1
    v_cvt_pk_bf16_f32 v231, v210, v211
    v_mul_f32 v239, v214, v212
    s_waitcnt vmcnt(33) lgkmcnt(3)
    v_mfma_f32_16x16x32_bf16 v[16:19], a[120:123], v[88:91], v[16:19]
    ds_write_b128 v5, v[228:231] offset:21504
    v_cvt_pk_bf16_f32 v232, v232, v233
    v_mfma_f32_16x16x32_bf16 v[24:27], a[120:123], v[92:95], v[24:27]
    v_cvt_pk_bf16_f32 v233, v234, v235
    v_mfma_f32_16x16x32_bf16 v[20:23], a[124:127], v[88:91], v[20:23]
    ds_write_b64 v6, v[232:233] offset:0
    v_cvt_pk_bf16_f32 v236, v236, v237
    v_cvt_pk_bf16_f32 v237, v238, v239
    v_mfma_f32_16x16x32_bf16 v[28:31], a[124:127], v[92:95], v[28:31]
    ds_write_b64 v6, v[236:237] offset:18432
    v_lshlrev_b32 v13, 2, v11
    v_lshrrev_b32 v14, 5, v2
    v_mfma_f32_16x16x32_bf16 v[32:35], a[128:131], v[88:91], v[32:35]
    v_lshl_add_u32 v14, v14, 6, v13
    v_and_b32 v15, 1, v12
    v_cmp_eq_u32 vcc, 0, v15
    v_mfma_f32_16x16x32_bf16 v[36:39], a[128:131], v[92:95], v[36:39]
    s_waitcnt lgkmcnt(0)
    s_barrier
    s_waitcnt vmcnt(30)
    v_mfma_f32_16x16x32_bf16 v[16:19], a[132:135], v[96:99], v[16:19]
    ds_read_b128 v[72:75], v1 offset:3072
    ds_read_b128 v[76:79], v1 offset:21504
    ds_read_b128 v[80:83], v1 offset:7168
    ds_read_b128 v[84:87], v1 offset:25600
    ds_read_b128 v[88:91], v1 offset:11264
    ds_read_b128 v[92:95], v1 offset:29696
    v_mfma_f32_16x16x32_bf16 v[24:27], a[132:135], v[100:103], v[24:27]
    v_mfma_f32_16x16x32_bf16 v[20:23], a[136:139], v[96:99], v[20:23]
    v_mfma_f32_16x16x32_bf16 v[28:31], a[136:139], v[100:103], v[28:31]
    v_mfma_f32_16x16x32_bf16 v[32:35], a[140:143], v[96:99], v[32:35]
    v_mfma_f32_16x16x32_bf16 v[36:39], a[140:143], v[100:103], v[36:39]
    s_waitcnt lgkmcnt(4)
    v_mfma_f32_16x16x32_bf16 v[16:19], a[144:147], v[72:75], v[16:19]
    ds_read_b128 v[96:99], v1 offset:15360
    ds_read_b128 v[100:103], v1 offset:33792
    s_waitcnt vmcnt(27)
    v_mfma_f32_16x16x32_bf16 v[24:27], a[144:147], v[76:79], v[24:27]
    v_lshlrev_b32 v168, 16, v240
    v_mfma_f32_16x16x32_bf16 v[20:23], a[148:151], v[72:75], v[20:23]
    v_and_b32 v169, 0xffff0000, v240
    v_mfma_f32_16x16x32_bf16 v[28:31], a[148:151], v[76:79], v[28:31]
    v_lshlrev_b32 v170, 16, v241
    v_mfma_f32_16x16x32_bf16 v[32:35], a[152:155], v[72:75], v[32:35]
    v_and_b32 v171, 0xffff0000, v241
    v_mfma_f32_16x16x32_bf16 v[36:39], a[152:155], v[76:79], v[36:39]
    v_lshlrev_b32 v172, 16, v242
    s_waitcnt lgkmcnt(4)
    v_mfma_f32_16x16x32_bf16 v[16:19], a[156:159], v[80:83], v[16:19]
    ds_read_b128 v[72:75], v1 offset:16384
    ds_read_b128 v[76:79], v1 offset:34816
    v_and_b32 v173, 0xffff0000, v242
    v_mfma_f32_16x16x32_bf16 v[24:27], a[156:159], v[84:87], v[24:27]
    v_lshlrev_b32 v174, 16, v243
    v_mfma_f32_16x16x32_bf16 v[20:23], a[160:163], v[80:83], v[20:23]
    v_and_b32 v175, 0xffff0000, v243
    v_mfma_f32_16x16x32_bf16 v[28:31], a[160:163], v[84:87], v[28:31]
    v_lshlrev_b32 v176, 16, v244
    v_mfma_f32_16x16x32_bf16 v[32:35], a[164:167], v[80:83], v[32:35]
    v_mfma_f32_16x16x32_bf16 v[36:39], a[164:167], v[84:87], v[36:39]
    v_and_b32 v177, 0xffff0000, v244
    s_waitcnt lgkmcnt(4)
    v_mfma_f32_16x16x32_bf16 v[16:19], a[168:171], v[88:91], v[16:19]
    ds_read_b128 v[80:83], v1 offset:17408
    ds_read_b128 v[84:87], v1 offset:35840
    v_lshlrev_b32 v178, 16, v245
    v_mfma_f32_16x16x32_bf16 v[24:27], a[168:171], v[92:95], v[24:27]
    v_and_b32 v179, 0xffff0000, v245
    v_mfma_f32_16x16x32_bf16 v[20:23], a[172:175], v[88:91], v[20:23]
    v_lshlrev_b32 v180, 16, v246
    v_mfma_f32_16x16x32_bf16 v[28:31], a[172:175], v[92:95], v[28:31]
    v_and_b32 v181, 0xffff0000, v246
    v_mfma_f32_16x16x32_bf16 v[32:35], a[176:179], v[88:91], v[32:35]
    v_lshlrev_b32 v182, 16, v247
    v_mfma_f32_16x16x32_bf16 v[36:39], a[176:179], v[92:95], v[36:39]
    v_and_b32 v183, 0xffff0000, v247
    s_waitcnt lgkmcnt(4)
    v_mfma_f32_16x16x32_bf16 v[16:19], a[180:183], v[96:99], v[16:19]
    v_lshlrev_b32 v184, 16, v248
    v_mfma_f32_16x16x32_bf16 v[24:27], a[180:183], v[100:103], v[24:27]
    v_and_b32 v185, 0xffff0000, v248
    v_mfma_f32_16x16x32_bf16 v[20:23], a[184:187], v[96:99], v[20:23]
    v_mfma_f32_16x16x32_bf16 v[28:31], a[184:187], v[100:103], v[28:31]
    v_lshlrev_b32 v186, 16, v249
    v_mfma_f32_16x16x32_bf16 v[32:35], a[188:191], v[96:99], v[32:35]
    v_and_b32 v187, 0xffff0000, v249
    v_mfma_f32_16x16x32_bf16 v[36:39], a[188:191], v[100:103], v[36:39]
    v_lshlrev_b32 v188, 16, v250
    s_waitcnt lgkmcnt(2)
    v_mfma_f32_16x16x32_bf16 v[16:19], a[192:195], v[72:75], v[16:19]
    v_and_b32 v189, 0xffff0000, v250
    v_mfma_f32_16x16x32_bf16 v[24:27], a[192:195], v[76:79], v[24:27]
    v_lshlrev_b32 v190, 16, v251
    v_mfma_f32_16x16x32_bf16 v[20:23], a[196:199], v[72:75], v[20:23]
    v_and_b32 v191, 0xffff0000, v251
    v_mfma_f32_16x16x32_bf16 v[28:31], a[196:199], v[76:79], v[28:31]
    s_lshl_b32 s27, s12, 7
    v_mfma_f32_16x16x32_bf16 v[32:35], a[200:203], v[72:75], v[32:35]
    s_add_u32 s27, s27, 39968768
    v_mfma_f32_16x16x32_bf16 v[36:39], a[200:203], v[76:79], v[36:39]
    s_barrier
    ds_read_b32 v192, v13 offset:36864
    ds_read_b32 v194, v13 offset:36928
    ds_read_b32 v196, v14 offset:36864
    s_waitcnt lgkmcnt(3)
    v_mfma_f32_16x16x32_bf16 v[16:19], a[204:207], v[80:83], v[16:19]
    v_mfma_f32_16x16x32_bf16 v[24:27], a[204:207], v[84:87], v[24:27]
    v_mfma_f32_16x16x32_bf16 v[20:23], a[208:211], v[80:83], v[20:23]
    v_mfma_f32_16x16x32_bf16 v[28:31], a[208:211], v[84:87], v[28:31]
    v_mfma_f32_16x16x32_bf16 v[32:35], a[212:215], v[80:83], v[32:35]
    v_mfma_f32_16x16x32_bf16 v[36:39], a[212:215], v[84:87], v[36:39]
    s_waitcnt lgkmcnt(0)
    v_pk_add_f32 v[168:169], v[168:169], v[192:193] op_sel_hi:[1,0] neg_lo:[0,1] neg_hi:[0,1]
    v_pk_add_f32 v[170:171], v[170:171], v[192:193] op_sel_hi:[1,0] neg_lo:[0,1] neg_hi:[0,1]
    v_pk_add_f32 v[172:173], v[172:173], v[192:193] op_sel_hi:[1,0] neg_lo:[0,1] neg_hi:[0,1]
    v_pk_add_f32 v[174:175], v[174:175], v[192:193] op_sel_hi:[1,0] neg_lo:[0,1] neg_hi:[0,1]
    v_pk_add_f32 v[176:177], v[176:177], v[194:195] op_sel_hi:[1,0] neg_lo:[0,1] neg_hi:[0,1]
    v_pk_add_f32 v[178:179], v[178:179], v[194:195] op_sel_hi:[1,0] neg_lo:[0,1] neg_hi:[0,1]
    v_pk_add_f32 v[180:181], v[180:181], v[194:195] op_sel_hi:[1,0] neg_lo:[0,1] neg_hi:[0,1]
    v_pk_add_f32 v[182:183], v[182:183], v[194:195] op_sel_hi:[1,0] neg_lo:[0,1] neg_hi:[0,1]
    v_pk_add_f32 v[184:185], v[184:185], v[196:197] op_sel_hi:[1,0] neg_lo:[0,1] neg_hi:[0,1]
    v_pk_add_f32 v[186:187], v[186:187], v[196:197] op_sel_hi:[1,0] neg_lo:[0,1] neg_hi:[0,1]
    v_pk_add_f32 v[188:189], v[188:189], v[196:197] op_sel_hi:[1,0] neg_lo:[0,1] neg_hi:[0,1]
    v_pk_add_f32 v[190:191], v[190:191], v[196:197] op_sel_hi:[1,0] neg_lo:[0,1] neg_hi:[0,1]
    v_pk_add_f32 v[16:17], v[16:17], v[168:169]
    v_pk_add_f32 v[18:19], v[18:19], v[170:171]
    v_pk_add_f32 v[20:21], v[20:21], v[172:173]
    v_pk_add_f32 v[22:23], v[22:23], v[174:175]
    v_cvt_pk_bf16_f32 v200, v16, v17
    v_cvt_pk_bf16_f32 v201, v18, v19
    v_cvt_pk_bf16_f32 v202, v20, v21
    v_cvt_pk_bf16_f32 v203, v22, v23
    buffer_store_dwordx4 v[200:203], v1, s[4:7], s42 offen sc1
    v_permlane32_swap_b32 v32, v36
    v_permlane32_swap_b32 v33, v37
    v_permlane32_swap_b32 v34, v38
    v_permlane32_swap_b32 v35, v39
    v_pk_add_f32 v[24:25], v[24:25], v[176:177]
    v_pk_add_f32 v[26:27], v[26:27], v[178:179]
    v_pk_add_f32 v[28:29], v[28:29], v[180:181]
    v_pk_add_f32 v[30:31], v[30:31], v[182:183]
    v_cvt_pk_bf16_f32 v204, v24, v25
    v_cvt_pk_bf16_f32 v205, v26, v27
    v_cvt_pk_bf16_f32 v206, v28, v29
    v_cvt_pk_bf16_f32 v207, v30, v31
    buffer_store_dwordx4 v[204:207], v1, s[4:7], s43 offen sc1
    v_pk_add_f32 v[32:33], v[32:33], v[184:185]
    v_pk_add_f32 v[34:35], v[34:35], v[186:187]
    v_pk_add_f32 v[36:37], v[36:37], v[188:189]
    v_pk_add_f32 v[38:39], v[38:39], v[190:191]
    v_cvt_pk_bf16_f32 v208, v32, v33
    v_cvt_pk_bf16_f32 v209, v34, v35
    v_cvt_pk_bf16_f32 v210, v36, v37
    v_cvt_pk_bf16_f32 v211, v38, v39
    buffer_store_dwordx4 v[208:211], v7, s[4:7], s42 offen offset:1024 sc1
    v_pk_mul_f32 v[192:193], v[16:17], v[16:17]
    v_pk_mul_f32 v[194:195], v[24:25], v[24:25]
    v_pk_mul_f32 v[196:197], v[32:33], v[32:33]
    v_pk_fma_f32 v[192:193], v[18:19], v[18:19], v[192:193]
    v_pk_fma_f32 v[194:195], v[26:27], v[26:27], v[194:195]
    v_pk_fma_f32 v[196:197], v[34:35], v[34:35], v[196:197]
    v_pk_fma_f32 v[192:193], v[20:21], v[20:21], v[192:193]
    v_pk_fma_f32 v[194:195], v[28:29], v[28:29], v[194:195]
    v_pk_fma_f32 v[196:197], v[36:37], v[36:37], v[196:197]
    v_pk_fma_f32 v[192:193], v[22:23], v[22:23], v[192:193]
    v_pk_fma_f32 v[194:195], v[30:31], v[30:31], v[194:195]
    v_pk_fma_f32 v[196:197], v[38:39], v[38:39], v[196:197]
    v_add_f32 v192, v192, v193
    v_add_f32 v193, v194, v195
    v_add_f32 v194, v196, v197
    s_nop 0
    v_permlane32_swap_b32 v192, v193
    v_add_f32 v192, v192, v193
    v_add_f32 v192, v192, v194
    v_mov_b32 v193, v192
    s_nop 1
    v_permlane16_swap_b32 v192, v193
    v_add_f32 v192, v192, v193
    s_and_saveexec_b64 s[38:39], vcc
    buffer_atomic_add_f32 v192, v14, s[4:7], s27 offen
    s_mov_b64 exec, -1
    s_branch ffn1_part_ffn
ffn1_part_w3:
    s_mul_i32 s24, s21, 1036288
    s_add_u32 s24, s24, 0
    v_lshlrev_b32 v3, 4, v0
    v_mov_b32 v252, 897988541
    v_mov_b32 v253, 897988541
    v_mov_b32 v254, 0
    v_mov_b32 v255, 0
    s_waitcnt vmcnt(24)
    v_cvt_pk_bf16_f32 v24, v24, v25
    v_cvt_pk_bf16_f32 v25, v26, v27
    v_cvt_pk_bf16_f32 v28, v28, 0
    v_cvt_pk_bf16_f32 v29, v29, 0
    v_cvt_pk_bf16_f32 v138, v16, v17
    v_cvt_pk_bf16_f32 v139, v18, v19
    v_cvt_pk_bf16_f32 v140, v20, v21
    v_cvt_pk_bf16_f32 v141, v22, v23
    v_cndmask_b32 v146, v24, 0, s[34:35]
    v_cndmask_b32 v147, v25, 0, s[34:35]
    v_cndmask_b32 v148, 0, v24, s[34:35]
    v_cndmask_b32 v149, 0, v25, s[34:35]
    s_waitcnt vmcnt(21)
    v_mov_b32 v78, v72
    v_lshrrev_b32 v80, 16, v72
    v_lshrrev_b32 v86, 16, v72
    v_cndmask_b32 v144, v29, 0, s[36:37]
    v_cndmask_b32 v150, 0, v29, s[36:37]
    v_cndmask_b32 v136, v28, 0, s[36:37]
    v_cndmask_b32 v142, 0, v28, s[36:37]
    s_nop 0
    v_mfma_f32_16x16x32_bf16 v[176:179], v[144:147], v[72:75], v[252:255]
    s_waitcnt vmcnt(17)
    v_cvt_pk_bf16_f32 v38, v38, v39
    v_cvt_pk_bf16_f32 v39, v40, v41
    v_mfma_f32_16x16x32_bf16 v[176:179], v[148:151], v[76:79], v[176:179]
    v_cvt_pk_bf16_f32 v42, v42, 0
    v_cvt_pk_bf16_f32 v43, v43, 0
    v_cvt_pk_bf16_f32 v154, v30, v31
    v_mfma_f32_16x16x32_bf16 v[188:191], v[144:147], v[80:83], v[252:255]
    v_cvt_pk_bf16_f32 v155, v32, v33
    v_cvt_pk_bf16_f32 v156, v34, v35
    v_mfma_f32_16x16x32_bf16 v[188:191], v[148:151], v[84:87], v[188:191]
    v_cvt_pk_bf16_f32 v157, v36, v37
    v_cndmask_b32 v162, v38, 0, s[34:35]
    v_cndmask_b32 v163, v39, 0, s[34:35]
    v_mfma_f32_16x16x32_bf16 v[168:171], v[136:139], v[72:75], 0
    v_cndmask_b32 v164, 0, v38, s[34:35]
    v_cndmask_b32 v165, 0, v39, s[34:35]
    s_waitcnt vmcnt(14)
    v_mfma_f32_16x16x32_bf16 v[172:175], v[140:143], v[76:79], 0
    v_mov_b32 v94, v88
    v_lshrrev_b32 v96, 16, v88
    v_mfma_f32_16x16x32_bf16 v[180:183], v[136:139], v[80:83], 0
    v_lshrrev_b32 v102, 16, v88
    v_cndmask_b32 v160, v43, 0, s[36:37]
    v_cndmask_b32 v166, 0, v43, s[36:37]
    v_mfma_f32_16x16x32_bf16 v[184:187], v[140:143], v[84:87], 0
    v_cndmask_b32 v152, v42, 0, s[36:37]
    v_cndmask_b32 v158, 0, v42, s[36:37]
    v_mfma_f32_16x16x32_bf16 v[200:203], v[160:163], v[88:91], v[252:255]
    v_rcp_f32 v176, v176
    v_rcp_f32 v177, v177
    v_rcp_f32 v188, v188
    v_rcp_f32 v189, v189
    v_mul_f32 v168, v168, v176
    v_mfma_f32_16x16x32_bf16 v[200:203], v[164:167], v[92:95], v[200:203]
    v_mul_f32 v169, v169, v176
    v_mul_f32 v170, v170, v176
    v_mul_f32 v171, v171, v176
    v_mul_f32 v172, v172, v177
    v_mfma_f32_16x16x32_bf16 v[212:215], v[160:163], v[96:99], v[252:255]
    v_mul_f32 v173, v173, v177
    v_mul_f32 v174, v174, v177
    v_mul_f32 v175, v175, v177
    v_cndmask_b32 v176, v176, v177, s[36:37]
    v_mfma_f32_16x16x32_bf16 v[212:215], v[164:167], v[100:103], v[212:215]
    v_cvt_pk_bf16_f32 v216, v168, v169
    v_cvt_pk_bf16_f32 v217, v170, v171
    v_cvt_pk_bf16_f32 v218, v172, v173
    v_cvt_pk_bf16_f32 v219, v174, v175
    v_mfma_f32_16x16x32_bf16 v[192:195], v[152:155], v[88:91], 0
    v_mul_f32 v232, v178, v176
    v_mfma_f32_16x16x32_bf16 v[196:199], v[156:159], v[92:95], 0
    ds_write_b128 v5, v[216:219] offset:0
    v_mul_f32 v180, v180, v188
    v_mul_f32 v181, v181, v188
    v_mul_f32 v182, v182, v188
    v_mul_f32 v183, v183, v188
    v_mul_f32 v184, v184, v189
    v_mul_f32 v185, v185, v189
    v_mul_f32 v186, v186, v189
    v_mfma_f32_16x16x32_bf16 v[204:207], v[152:155], v[96:99], 0
    v_mul_f32 v187, v187, v189
    v_cndmask_b32 v188, v188, v189, s[36:37]
    v_cvt_pk_bf16_f32 v220, v180, v181
    v_cvt_pk_bf16_f32 v221, v182, v183
    v_mfma_f32_16x16x32_bf16 v[208:211], v[156:159], v[100:103], 0
    v_cvt_pk_bf16_f32 v222, v184, v185
    v_cvt_pk_bf16_f32 v223, v186, v187
    v_mul_f32 v236, v190, v188
    ds_write_b128 v5, v[220:223] offset:18432
    s_waitcnt vmcnt(10)
    v_cvt_pk_bf16_f32 v52, v52, v53
    v_cvt_pk_bf16_f32 v53, v54, v55
    v_cvt_pk_bf16_f32 v56, v56, 0
    v_cvt_pk_bf16_f32 v57, v57, 0
    v_cvt_pk_bf16_f32 v138, v44, v45
    v_cvt_pk_bf16_f32 v139, v46, v47
    v_cvt_pk_bf16_f32 v140, v48, v49
    v_cvt_pk_bf16_f32 v141, v50, v51
    s_waitcnt lgkmcnt(0)
    s_barrier
    ds_read_b128 v[72:75], v1 offset:0
    ds_read_b128 v[76:79], v1 offset:18432
    ds_read_b128 v[80:83], v1 offset:4096
    ds_read_b128 v[84:87], v1 offset:22528
    ds_read_b128 v[88:91], v1 offset:8192
    ds_read_b128 v[92:95], v1 offset:26624
    v_cndmask_b32 v146, v52, 0, s[34:35]
    v_cndmask_b32 v147, v53, 0, s[34:35]
    v_cndmask_b32 v148, 0, v52, s[34:35]
    v_cndmask_b32 v149, 0, v53, s[34:35]
    s_waitcnt lgkmcnt(4)
    v_mfma_f32_16x16x32_bf16 v[16:19], a[144:147], v[72:75], 0
    ds_read_b128 v[96:99], v1 offset:12288
    ds_read_b128 v[100:103], v1 offset:30720
    v_rcp_f32 v200, v200
    v_rcp_f32 v201, v201
    v_rcp_f32 v212, v212
    v_rcp_f32 v213, v213
    v_mul_f32 v192, v192, v200
    v_mul_f32 v193, v193, v200
    v_mul_f32 v194, v194, v200
    v_mfma_f32_16x16x32_bf16 v[24:27], a[144:147], v[76:79], 0
    s_add_u32 s30, s24, 0
    buffer_load_dwordx4 a[0:3], v3, s[4:7], s30 offen sc1
    v_mul_f32 v195, v195, v200
    v_mul_f32 v196, v196, v201
    v_mul_f32 v197, v197, v201
    v_mul_f32 v198, v198, v201
    v_mul_f32 v199, v199, v201
    v_cndmask_b32 v200, v200, v201, s[36:37]
    v_cvt_pk_bf16_f32 v224, v192, v193
    s_waitcnt lgkmcnt(4)
    v_mfma_f32_16x16x32_bf16 v[16:19], a[160:163], v[80:83], v[16:19]
    v_cvt_pk_bf16_f32 v225, v194, v195
    v_cvt_pk_bf16_f32 v226, v196, v197
    v_cvt_pk_bf16_f32 v227, v198, v199
    v_mul_f32 v233, v202, v200
    v_mfma_f32_16x16x32_bf16 v[24:27], a[160:163], v[84:87], v[24:27]
    s_add_u32 s30, s24, 4096
    buffer_load_dwordx4 a[4:7], v3, s[4:7], s30 offen sc1
    ds_write_b128 v5, v[224:227] offset:1024
    v_mul_f32 v204, v204, v212
    v_mul_f32 v205, v205, v212
    v_mul_f32 v206, v206, v212
    v_mul_f32 v207, v207, v212
    v_mul_f32 v208, v208, v213
    v_mul_f32 v209, v209, v213
    v_mul_f32 v210, v210, v213
    v_mul_f32 v211, v211, v213
    s_waitcnt lgkmcnt(3)
    v_mfma_f32_16x16x32_bf16 v[16:19], a[176:179], v[88:91], v[16:19]
    v_cndmask_b32 v212, v212, v213, s[36:37]
    v_cvt_pk_bf16_f32 v228, v204, v205
    v_cvt_pk_bf16_f32 v229, v206, v207
    v_cvt_pk_bf16_f32 v230, v208, v209
    v_cvt_pk_bf16_f32 v231, v210, v211
    v_mul_f32 v237, v214, v212
    v_mfma_f32_16x16x32_bf16 v[24:27], a[176:179], v[92:95], v[24:27]
    s_add_u32 s30, s24, 8192
    buffer_load_dwordx4 a[8:11], v3, s[4:7], s30 offen sc1
    ds_write_b128 v5, v[228:231] offset:19456
    s_waitcnt vmcnt(10)
    v_mov_b32 v110, v104
    v_lshrrev_b32 v112, 16, v104
    v_lshrrev_b32 v118, 16, v104
    v_cndmask_b32 v144, v57, 0, s[36:37]
    v_cndmask_b32 v150, 0, v57, s[36:37]
    s_waitcnt lgkmcnt(2)
    v_mfma_f32_16x16x32_bf16 v[16:19], a[192:195], v[96:99], v[16:19]
    v_cndmask_b32 v136, v56, 0, s[36:37]
    v_cndmask_b32 v142, 0, v56, s[36:37]
    s_waitcnt lgkmcnt(0)
    s_barrier
    ds_read_b128 v[72:75], v1 offset:1024
    ds_read_b128 v[76:79], v1 offset:19456
    ds_read_b128 v[80:83], v1 offset:5120
    ds_read_b128 v[84:87], v1 offset:23552
    ds_read_b128 v[88:91], v1 offset:9216
    ds_read_b128 v[92:95], v1 offset:27648
    v_mfma_f32_16x16x32_bf16 v[24:27], a[192:195], v[100:103], v[24:27]
    s_add_u32 s30, s24, 12288
    buffer_load_dwordx4 a[12:15], v3, s[4:7], s30 offen sc1
    v_mfma_f32_16x16x32_bf16 v[176:179], v[144:147], v[104:107], v[252:255]
    s_waitcnt vmcnt(7)
    v_cvt_pk_bf16_f32 v66, v66, v67
    v_mfma_f32_16x16x32_bf16 v[176:179], v[148:151], v[108:111], v[176:179]
    s_add_u32 s30, s24, 16384
    buffer_load_dwordx4 a[16:19], v3, s[4:7], s30 offen sc1
    v_cvt_pk_bf16_f32 v67, v68, v69
    v_cvt_pk_bf16_f32 v70, v70, 0
    v_mfma_f32_16x16x32_bf16 v[188:191], v[144:147], v[112:115], v[252:255]
    v_cvt_pk_bf16_f32 v71, v71, 0
    v_mfma_f32_16x16x32_bf16 v[188:191], v[148:151], v[116:119], v[188:191]
    s_add_u32 s30, s24, 20480
    buffer_load_dwordx4 a[20:23], v3, s[4:7], s30 offen sc1
    v_cvt_pk_bf16_f32 v154, v58, v59
    v_cvt_pk_bf16_f32 v155, v60, v61
    v_mfma_f32_16x16x32_bf16 v[168:171], v[136:139], v[104:107], 0
    v_cvt_pk_bf16_f32 v156, v62, v63
    v_cvt_pk_bf16_f32 v157, v64, v65
    v_mfma_f32_16x16x32_bf16 v[172:175], v[140:143], v[108:111], 0
    s_add_u32 s30, s24, 24576
    buffer_load_dwordx4 a[24:27], v3, s[4:7], s30 offen sc1
    v_cndmask_b32 v162, v66, 0, s[34:35]
    v_mfma_f32_16x16x32_bf16 v[180:183], v[136:139], v[112:115], 0
    v_cndmask_b32 v163, v67, 0, s[34:35]
    v_cndmask_b32 v164, 0, v66, s[34:35]
    v_mfma_f32_16x16x32_bf16 v[184:187], v[140:143], v[116:119], 0
    s_add_u32 s30, s24, 28672
    buffer_load_dwordx4 a[28:31], v3, s[4:7], s30 offen sc1
    v_cndmask_b32 v165, 0, v67, s[34:35]
    s_waitcnt lgkmcnt(4)
    v_mfma_f32_16x16x32_bf16 v[16:19], a[148:151], v[72:75], v[16:19]
    ds_read_b128 v[96:99], v1 offset:13312
    ds_read_b128 v[100:103], v1 offset:31744
    v_rcp_f32 v176, v176
    v_rcp_f32 v177, v177
    v_rcp_f32 v188, v188
    v_rcp_f32 v189, v189
    v_mul_f32 v168, v168, v176
    v_mul_f32 v169, v169, v176
    v_mul_f32 v170, v170, v176
    v_mfma_f32_16x16x32_bf16 v[24:27], a[148:151], v[76:79], v[24:27]
    s_add_u32 s30, s24, 32768
    buffer_load_dwordx4 a[32:35], v3, s[4:7], s30 offen sc1
    v_mul_f32 v171, v171, v176
    v_mul_f32 v172, v172, v177
    v_mul_f32 v173, v173, v177
    v_mul_f32 v174, v174, v177
    v_mul_f32 v175, v175, v177
    v_cndmask_b32 v176, v176, v177, s[36:37]
    v_cvt_pk_bf16_f32 v216, v168, v169
    s_waitcnt lgkmcnt(4)
    v_mfma_f32_16x16x32_bf16 v[16:19], a[164:167], v[80:83], v[16:19]
    v_cvt_pk_bf16_f32 v217, v170, v171
    v_cvt_pk_bf16_f32 v218, v172, v173
    v_cvt_pk_bf16_f32 v219, v174, v175
    v_mul_f32 v234, v178, v176
    v_mfma_f32_16x16x32_bf16 v[24:27], a[164:167], v[84:87], v[24:27]
    s_add_u32 s30, s24, 36864
    buffer_load_dwordx4 a[36:39], v3, s[4:7], s30 offen sc1
    ds_write_b128 v5, v[216:219] offset:2048
    v_mul_f32 v180, v180, v188
    v_mul_f32 v181, v181, v188
    v_mul_f32 v182, v182, v188
    v_mul_f32 v183, v183, v188
    v_mul_f32 v184, v184, v189
    v_mul_f32 v185, v185, v189
    v_mul_f32 v186, v186, v189
    v_mul_f32 v187, v187, v189
    s_waitcnt lgkmcnt(3)
    v_mfma_f32_16x16x32_bf16 v[16:19], a[180:183], v[88:91], v[16:19]
    v_cndmask_b32 v188, v188, v189, s[36:37]
    v_cvt_pk_bf16_f32 v220, v180, v181
    v_cvt_pk_bf16_f32 v221, v182, v183
    v_cvt_pk_bf16_f32 v222, v184, v185
    v_cvt_pk_bf16_f32 v223, v186, v187
    v_mul_f32 v238, v190, v188
    v_mfma_f32_16x16x32_bf16 v[24:27], a[180:183], v[92:95], v[24:27]
    s_add_u32 s30, s24, 40960
    buffer_load_dwordx4 a[40:43], v3, s[4:7], s30 offen sc1
    ds_write_b128 v5, v[220:223] offset:20480
    s_waitcnt vmcnt(11)
    v_mov_b32 v126, v120
    v_lshrrev_b32 v128, 16, v120
    v_lshrrev_b32 v134, 16, v120
    v_cndmask_b32 v160, v71, 0, s[36:37]
    v_cndmask_b32 v166, 0, v71, s[36:37]
    s_waitcnt lgkmcnt(2)
    v_mfma_f32_16x16x32_bf16 v[16:19], a[196:199], v[96:99], v[16:19]
    v_cndmask_b32 v152, v70, 0, s[36:37]
    v_cndmask_b32 v158, 0, v70, s[36:37]
    s_waitcnt lgkmcnt(0)
    s_barrier
    ds_read_b128 v[72:75], v1 offset:2048
    ds_read_b128 v[76:79], v1 offset:20480
    ds_read_b128 v[80:83], v1 offset:6144
    ds_read_b128 v[84:87], v1 offset:24576
    ds_read_b128 v[88:91], v1 offset:10240
    ds_read_b128 v[92:95], v1 offset:28672
    v_mfma_f32_16x16x32_bf16 v[24:27], a[196:199], v[100:103], v[24:27]
    s_add_u32 s30, s24, 45056
    buffer_load_dwordx4 a[44:47], v3, s[4:7], s30 offen sc1
    v_mfma_f32_16x16x32_bf16 v[200:203], v[160:163], v[120:123], v[252:255]
    v_mfma_f32_16x16x32_bf16 v[200:203], v[164:167], v[124:127], v[200:203]
    s_add_u32 s30, s24, 49152
    buffer_load_dwordx4 a[48:51], v3, s[4:7], s30 offen sc1
    v_mfma_f32_16x16x32_bf16 v[212:215], v[160:163], v[128:131], v[252:255]
    v_mfma_f32_16x16x32_bf16 v[212:215], v[164:167], v[132:135], v[212:215]
    s_add_u32 s30, s24, 53248
    buffer_load_dwordx4 a[52:55], v3, s[4:7], s30 offen sc1
    v_mfma_f32_16x16x32_bf16 v[192:195], v[152:155], v[120:123], 0
    v_mfma_f32_16x16x32_bf16 v[196:199], v[156:159], v[124:127], 0
    s_add_u32 s30, s24, 57344
    buffer_load_dwordx4 a[56:59], v3, s[4:7], s30 offen sc1
    v_mfma_f32_16x16x32_bf16 v[204:207], v[152:155], v[128:131], 0
    v_mfma_f32_16x16x32_bf16 v[208:211], v[156:159], v[132:135], 0
    s_add_u32 s30, s24, 61440
    buffer_load_dwordx4 a[60:63], v3, s[4:7], s30 offen sc1
    s_waitcnt lgkmcnt(4)
    v_mfma_f32_16x16x32_bf16 v[16:19], a[152:155], v[72:75], v[16:19]
    ds_read_b128 v[96:99], v1 offset:14336
    ds_read_b128 v[100:103], v1 offset:32768
    v_rcp_f32 v200, v200
    v_rcp_f32 v201, v201
    v_rcp_f32 v212, v212
    v_rcp_f32 v213, v213
    v_mul_f32 v192, v192, v200
    v_mul_f32 v193, v193, v200
    v_mul_f32 v194, v194, v200
    v_mfma_f32_16x16x32_bf16 v[24:27], a[152:155], v[76:79], v[24:27]
    s_add_u32 s30, s24, 65536
    buffer_load_dwordx4 a[64:67], v3, s[4:7], s30 offen sc1
    v_mul_f32 v195, v195, v200
    v_mul_f32 v196, v196, v201
    v_mul_f32 v197, v197, v201
    v_mul_f32 v198, v198, v201
    v_mul_f32 v199, v199, v201
    v_cndmask_b32 v200, v200, v201, s[36:37]
    v_cvt_pk_bf16_f32 v224, v192, v193
    s_waitcnt lgkmcnt(4)
    v_mfma_f32_16x16x32_bf16 v[16:19], a[168:171], v[80:83], v[16:19]
    v_cvt_pk_bf16_f32 v225, v194, v195
    v_cvt_pk_bf16_f32 v226, v196, v197
    v_cvt_pk_bf16_f32 v227, v198, v199
    v_mul_f32 v235, v202, v200
    v_mfma_f32_16x16x32_bf16 v[24:27], a[168:171], v[84:87], v[24:27]
    s_add_u32 s30, s24, 69632
    buffer_load_dwordx4 a[68:71], v3, s[4:7], s30 offen sc1
    ds_write_b128 v5, v[224:227] offset:3072
    v_mul_f32 v204, v204, v212
    v_mul_f32 v205, v205, v212
    v_mul_f32 v206, v206, v212
    v_mul_f32 v207, v207, v212
    v_mul_f32 v208, v208, v213
    v_mul_f32 v209, v209, v213
    v_mul_f32 v210, v210, v213
    v_mul_f32 v211, v211, v213
    v_cndmask_b32 v212, v212, v213, s[36:37]
    s_waitcnt lgkmcnt(3)
    v_mfma_f32_16x16x32_bf16 v[16:19], a[184:187], v[88:91], v[16:19]
    v_cvt_pk_bf16_f32 v228, v204, v205
    v_cvt_pk_bf16_f32 v229, v206, v207
    v_cvt_pk_bf16_f32 v230, v208, v209
    v_cvt_pk_bf16_f32 v231, v210, v211
    v_mul_f32 v239, v214, v212
    v_mfma_f32_16x16x32_bf16 v[24:27], a[184:187], v[92:95], v[24:27]
    s_add_u32 s30, s24, 73728
    buffer_load_dwordx4 a[72:75], v3, s[4:7], s30 offen sc1
    ds_write_b128 v5, v[228:231] offset:21504
    v_cvt_pk_bf16_f32 v232, v232, v233
    v_cvt_pk_bf16_f32 v233, v234, v235
    s_waitcnt lgkmcnt(2)
    v_mfma_f32_16x16x32_bf16 v[16:19], a[200:203], v[96:99], v[16:19]
    ds_write_b64 v6, v[232:233] offset:0
    v_cvt_pk_bf16_f32 v236, v236, v237
    v_cvt_pk_bf16_f32 v237, v238, v239
    ds_write_b64 v6, v[236:237] offset:18432
    v_lshlrev_b32 v13, 2, v11
    v_lshrrev_b32 v14, 5, v2
    v_lshl_add_u32 v14, v14, 6, v13
    v_and_b32 v15, 1, v12
    v_cmp_eq_u32 vcc, 0, v15
    s_waitcnt lgkmcnt(0)
    s_barrier
    ds_read_b128 v[72:75], v1 offset:3072
    ds_read_b128 v[76:79], v1 offset:21504
    ds_read_b128 v[80:83], v1 offset:7168
    ds_read_b128 v[84:87], v1 offset:25600
    ds_read_b128 v[88:91], v1 offset:11264
    ds_read_b128 v[92:95], v1 offset:29696
    v_mfma_f32_16x16x32_bf16 v[24:27], a[200:203], v[100:103], v[24:27]
    s_add_u32 s30, s24, 77824
    buffer_load_dwordx4 a[76:79], v3, s[4:7], s30 offen sc1
    s_waitcnt lgkmcnt(4)
    v_mfma_f32_16x16x32_bf16 v[16:19], a[156:159], v[72:75], v[16:19]
    ds_read_b128 v[96:99], v1 offset:15360
    ds_read_b128 v[100:103], v1 offset:33792
    v_and_b32 v13, 1, v12
    v_mfma_f32_16x16x32_bf16 v[24:27], a[156:159], v[76:79], v[24:27]
    s_add_u32 s30, s24, 81920
    buffer_load_dwordx4 a[80:83], v3, s[4:7], s30 offen sc1
    s_waitcnt lgkmcnt(4)
    v_mfma_f32_16x16x32_bf16 v[16:19], a[172:175], v[80:83], v[16:19]
ffn1_part_pad0_1x:
    s_cbranch_execz ffn1_part_pad0_5x
    ds_read_b128 v[72:75], v1 offset:16384
    ds_read_b128 v[76:79], v1 offset:34816
    v_mfma_f32_16x16x32_bf16 v[24:27], a[172:175], v[84:87], v[24:27]
    s_add_u32 s30, s24, 86016
    buffer_load_dwordx4 a[84:87], v3, s[4:7], s30 offen sc1
    s_waitcnt lgkmcnt(4)
    v_mfma_f32_16x16x32_bf16 v[16:19], a[188:191], v[88:91], v[16:19]
    ds_read_b128 v[80:83], v1 offset:17408
    ds_read_b128 v[84:87], v1 offset:35840
    v_mfma_f32_16x16x32_bf16 v[24:27], a[188:191], v[92:95], v[24:27]
    s_add_u32 s30, s24, 90112
    buffer_load_dwordx4 a[88:91], v3, s[4:7], s30 offen sc1
    s_waitcnt lgkmcnt(4)
    v_mfma_f32_16x16x32_bf16 v[16:19], a[204:207], v[96:99], v[16:19]
    v_cmp_ne_u32 vcc, 0, v13
    v_mfma_f32_16x16x32_bf16 v[24:27], a[204:207], v[100:103], v[24:27]
    s_add_u32 s30, s24, 94208
    buffer_load_dwordx4 a[92:95], v3, s[4:7], s30 offen sc1
    s_waitcnt lgkmcnt(2)
    v_mfma_f32_16x16x32_bf16 v[16:19], a[208:211], v[72:75], v[16:19]
    v_mfma_f32_16x16x32_bf16 v[24:27], a[208:211], v[76:79], v[24:27]
    s_add_u32 s30, s24, 98304
    buffer_load_dwordx4 a[96:99], v3, s[4:7], s30 offen sc1
    s_waitcnt lgkmcnt(0)
    v_mfma_f32_16x16x32_bf16 v[16:19], a[212:215], v[80:83], v[16:19]
    v_mfma_f32_16x16x32_bf16 v[24:27], a[212:215], v[84:87], v[24:27]
    s_add_u32 s30, s24, 102400
    buffer_load_dwordx4 a[100:103], v3, s[4:7], s30 offen sc1
    s_add_u32 s30, s24, 106496
    buffer_load_dwordx4 a[104:107], v3, s[4:7], s30 offen sc1
    s_nop 7
    v_add_f32 v16, v16, v17
    v_add_f32 v24, v24, v25
    v_cndmask_b32 v16, v16, v24, vcc
    ds_write_b32 v4, v16 offset:36864
    s_waitcnt lgkmcnt(0)
    s_barrier
    s_cmp_lg_u32 s13, 0
    s_cbranch_scc1 ffn1_part_ndm
    s_lshl_b32 s27, s12, 7
    s_add_u32 s27, s27, 20914176
    s_mov_b64 exec, 0xffffffff
    buffer_store_dword v16, v4, s[4:7], s27 offen sc1
    s_mov_b64 exec, -1
ffn1_part_ndm:
ffn1_part_ffn:
    v_lshlrev_b32 v1, 4, v2
    v_lshlrev_b32 v3, 4, v0
    s_mul_i32 s24, s21, 1036288
    s_add_u32 s24, s24, 0
    s_mul_i32 s25, s22, 151552
    s_add_u32 s25, s25, 30408704
    s_lshl_b32 s26, s20, 10
    s_cmp_ge_u32 s20, 1
    s_cselect_b32 s27, 27648, 0
    s_add_u32 s16, s25, s27
    s_cmp_ge_u32 s20, 2
    s_cselect_b32 s27, 27648, 0
    s_add_u32 s17, s25, s27
    s_cmp_ge_u32 s20, 3
    s_cselect_b32 s27, 27648, 0
    s_add_u32 s18, s25, s27
    s_add_u32 s30, s24, 110592
    buffer_load_dwordx4 a[108:111], v3, s[4:7], s30 offen sc1
    s_add_u32 s30, s24, 114688
    buffer_load_dwordx4 a[112:115], v3, s[4:7], s30 offen sc1
    s_add_u32 s30, s24, 118784
    buffer_load_dwordx4 a[116:119], v3, s[4:7], s30 offen sc1
    s_add_u32 s30, s24, 122880
    buffer_load_dwordx4 a[120:123], v3, s[4:7], s30 offen sc1
    v_and_b32 v11, 15, v2
    v_lshrrev_b32 v12, 4, v2
    v_add_u32 v4, 0x10000, v1
    v_add_u32 v5, 0x20000, v1
    v_lshrrev_b32 v13, 3, v11
    v_mul_u32_u24 v13, 4608, v13
    v_and_b32 v14, 7, v11
    v_lshl_add_u32 v13, v14, 4, v13
    v_lshl_add_u32 v6, v12, 7, v13
    v_lshrrev_b32 v14, 1, v12
    v_mul_u32_u24 v14, 18432, v14
    v_add_u32 v13, v13, v14
    v_and_b32 v14, 1, v12
    v_lshl_add_u32 v7, v14, 7, v13
    s_lshr_b32 s27, s20, 1
    s_lshl_b32 s27, s27, 8
    s_add_u32 s27, s27, 4096
    s_sub_u32 s27, s27, s26
    v_add_u32 v7, s27, v7
    s_lshl_b32 s27, s22, 4
    s_add_u32 s27, s27, s21
    s_xor_b32 s28, s27, 1
    s_mul_i32 s46, s27, 77824
    s_add_u32 s46, s46, 146800640
    s_mul_i32 s47, s28, 77824
    s_add_u32 s47, s47, 146800640
    s_lshl_b32 s48, s27, 9
    s_lshl_b32 s49, s28, 9
    s_lshl_b32 s27, s20, 5
    s_add_u32 s27, s27, 40239104
    s_add_u32 s48, s48, s27
    s_add_u32 s49, s49, s27
    s_add_u32 s28, s47, s26
    s_and_b32 s19, s20, 1
    s_mul_i32 s27, s19, 9216
    s_add_u32 s32, s28, s27
    s_sub_u32 s33, s28, s27
    s_add_u32 s36, s32, 0
    s_add_u32 s37, s33, 9216
    s_add_u32 s38, s32, 18432
    s_add_u32 s39, s33, 27648
    s_add_u32 s40, s32, 36864
    s_add_u32 s41, s33, 46080
    s_add_u32 s42, s32, 55296
    s_add_u32 s43, s33, 64512
    s_mov_b32 s8, 0
    s_mul_i32 s34, s20, 9216
    s_add_u32 s34, s34, 4096
    v_add_u32 v9, 5120, v3
    s_lshl_b32 s27, s20, 2
    s_add_u32 s27, s27, 4096
    v_add_u32 v8, s27, v1
    v_add_u32 v253, s34, v1
    s_mov_b32 s29, 0xc09d30fc
    s_lshl_b32 s44, s22, 9
    s_add_u32 s44, s44, 39968768
    v_lshlrev_b32 v13, 2, v11
    s_mov_b32 s45, 0x3c017fae
    v_mov_b32 v252, 0x383ef424
    s_mul_i32 s27, s19, 9216
    v_add_u32 v11, s27, v1
    v_add_u32 v12, 73728, v11
    s_sub_u32 s27, 9216, s27
    v_add_u32 v14, s27, v1
    v_add_u32 v15, 73728, v14
    s_lshl_b32 s9, s22, 11
    s_add_u32 s9, s9, 40009728
    s_lshl_b32 s27, s21, 7
    s_add_u32 s27, s27, s9
    v_mov_b32 v254, 1
    v_and_b32 v10, 15, v2
    v_lshlrev_b32 v10, 7, v10
    s_cmp_lg_u32 s20, 3
    s_cbranch_scc1 ffn1_part_backx
    s_waitcnt vmcnt(4)
    s_barrier
    s_mul_i32 s35, s20, 512
    s_add_u32 s35, s35, s9
    s_atomic_add s3, s[4:5], s35 offset:0
    s_atomic_add s3, s[4:5], s35 offset:128
    s_atomic_add s3, s[4:5], s35 offset:256
    s_atomic_add s3, s[4:5], s35 offset:384
    s_add_u32 s30, s24, 126976
    buffer_load_dwordx4 a[124:127], v3, s[4:7], s30 offen sc1
    s_add_u32 s30, s24, 131072
    buffer_load_dwordx4 a[128:131], v3, s[4:7], s30 offen sc1
    s_add_u32 s30, s24, 135168
    buffer_load_dwordx4 a[132:135], v3, s[4:7], s30 offen sc1
    s_add_u32 s30, s24, 139264
    buffer_load_dwordx4 a[136:139], v3, s[4:7], s30 offen sc1
    s_add_u32 s30, s24, 143360
    buffer_load_dwordx4 a[140:143], v3, s[4:7], s30 offen sc1
    s_add_u32 s30, s24, 147456
    buffer_load_dwordx4 a[144:147], v3, s[4:7], s30 offen sc1
    s_add_u32 s30, s24, 151552
    buffer_load_dwordx4 a[148:151], v3, s[4:7], s30 offen sc1
ffn1_part_slowx:
    s_mov_b32 s28, 0
    s_atomic_add s28, s[4:5], s27 offset:0 glc
    s_add_u32 s8, s8, 1
    s_waitcnt lgkmcnt(0)
    s_cmp_ge_u32 s28, 16
    s_cbranch_scc1 ffn1_part_slowxk
    s_cmp_lt_u32 s8, 0x80000
    s_cbranch_scc1 ffn1_part_slowx
ffn1_part_slowxk:
    s_branch ffn1_part_backy
ffn1_part_backx:
    s_waitcnt vmcnt(4)
    s_barrier
    s_mul_i32 s35, s20, 512
    s_add_u32 s35, s35, s9
    s_atomic_add s3, s[4:5], s35 offset:0
    s_atomic_add s3, s[4:5], s35 offset:128
    s_atomic_add s3, s[4:5], s35 offset:256
    s_atomic_add s3, s[4:5], s35 offset:384
    s_add_u32 s30, s24, 126976
    buffer_load_dwordx4 a[124:127], v3, s[4:7], s30 offen sc1
    s_add_u32 s30, s24, 131072
    buffer_load_dwordx4 a[128:131], v3, s[4:7], s30 offen sc1
    s_add_u32 s30, s24, 135168
    buffer_load_dwordx4 a[132:135], v3, s[4:7], s30 offen sc1
    s_add_u32 s30, s24, 139264
    buffer_load_dwordx4 a[136:139], v3, s[4:7], s30 offen sc1
    s_add_u32 s30, s24, 143360
    buffer_load_dwordx4 a[140:143], v3, s[4:7], s30 offen sc1
    s_add_u32 s30, s24, 147456
    buffer_load_dwordx4 a[144:147], v3, s[4:7], s30 offen sc1
    s_add_u32 s30, s24, 151552
    buffer_load_dwordx4 a[148:151], v3, s[4:7], s30 offen sc1
ffn1_part_backy:
    s_barrier
    s_add_u32 m0, s26, 0
    s_add_u32 s31, s25, 0
    buffer_load_dwordx4 v3, s[4:7], s31 offen sc1 lds
    s_add_u32 m0, s26, 4096
    s_add_u32 s31, s25, 4096
    buffer_load_dwordx4 v3, s[4:7], s31 offen sc1 lds
    s_add_u32 m0, s26, 8192
    s_add_u32 s31, s16, 8192
    buffer_load_dwordx4 v3, s[4:7], s31 offen sc1 lds
    s_add_u32 m0, s26, 12288
    s_add_u32 s31, s25, 39936
    buffer_load_dwordx4 v3, s[4:7], s31 offen sc1 lds
    s_add_u32 m0, s26, 16384
    s_add_u32 s31, s17, 44032
    buffer_load_dwordx4 v3, s[4:7], s31 offen sc1 lds
    s_add_u32 m0, s26, 20480
    s_add_u32 s31, s25, 75776
    buffer_load_dwordx4 v3, s[4:7], s31 offen sc1 lds
    s_add_u32 m0, s26, 24576
    s_add_u32 s31, s18, 79872
    buffer_load_dwordx4 v3, s[4:7], s31 offen sc1 lds
    s_waitcnt vmcnt(4)
    s_barrier
    ds_read_b128 v[184:187], v1 offset:0
    ds_read_b128 v[188:191], v1 offset:1024
    ds_read_b128 v[192:195], v1 offset:2048
    ds_read_b128 v[196:199], v1 offset:3072
    ds_read_b128 v[200:203], v1 offset:4096
    ds_read_b128 v[204:207], v1 offset:5120
    ds_read_b128 v[208:211], v1 offset:6144
    ds_read_b128 v[212:215], v1 offset:7168
    ds_read_b128 v[216:219], v1 offset:8192
    s_waitcnt lgkmcnt(6)
    s_getpc_b64 s[10:11]
ffn1_parts_pc:
    s_add_u32 s10, s10, ffn1_part-ffn1_parts_pc
    s_addc_u32 s11, s11, (ffn1_part-ffn1_parts_pc)>>32
    s_bfe_u32 s12, s2, 0x50003
    s_lshl_b32 s12, s12, 12
    s_add_u32 s52, s46, 0
    s_add_u32 s53, s46, 9216
    s_add_u32 s54, s46, 18432
    s_add_u32 s60, s46, 27648
    s_add_u32 s61, s46, 36864
    s_add_u32 s62, s46, 46080
    s_add_u32 s63, s46, 55296
    s_add_u32 s23, s46, 64512
    v_mfma_f32_16x16x32_bf16 v[16:19], a[0:3], v[184:187], 0
    s_add_u32 m0, s26, 28672
    v_mfma_f32_16x16x32_bf16 v[16:19], a[4:7], v[188:191], v[16:19]
    s_add_u32 s31, s25, 111616
    v_mfma_f32_16x16x32_bf16 v[16:19], a[8:11], v[192:195], v[16:19]
    s_waitcnt lgkmcnt(3)
    v_mfma_f32_16x16x32_bf16 v[16:19], a[12:15], v[196:199], v[16:19]
    buffer_load_dwordx4 v3, s[4:7], s31 offen sc1 lds
    v_mfma_f32_16x16x32_bf16 v[16:19], a[16:19], v[200:203], v[16:19]
    s_add_u32 m0, s26, 32768
    v_mfma_f32_16x16x32_bf16 v[16:19], a[20:23], v[204:207], v[16:19]
    s_waitcnt vmcnt(2) lgkmcnt(0)
    v_mfma_f32_16x16x32_bf16 v[16:19], a[24:27], v[208:211], v[16:19]
    s_add_u32 s31, s25, 115712
    v_mfma_f32_16x16x32_bf16 v[16:19], a[28:31], v[212:215], v[16:19]
    buffer_load_dwordx4 v3, s[4:7], s31 offen sc1 lds
    v_mfma_f32_16x16x32_bf16 v[16:19], a[32:35], v[216:219], v[16:19]
    s_add_u32 m0, s26, 36864
    v_mfma_f32_16x16x32_bf16 v[20:23], a[36:39], v[184:187], 0
    s_add_u32 s31, s25, 18432
    ds_read_b128 v[220:223], v1 offset:9216
    ds_read_b128 v[224:227], v1 offset:10240
    v_mfma_f32_16x16x32_bf16 v[20:23], a[40:43], v[188:191], v[20:23]
    s_barrier
    ds_read_b128 v[228:231], v1 offset:11264
    v_mfma_f32_16x16x32_bf16 v[20:23], a[44:47], v[192:195], v[20:23]
    buffer_load_dwordx4 v3, s[4:7], s31 offen sc1 lds
    v_mfma_f32_16x16x32_bf16 v[20:23], a[48:51], v[196:199], v[20:23]
    s_add_u32 m0, s26, 40960
    v_mfma_f32_16x16x32_bf16 v[20:23], a[52:55], v[200:203], v[20:23]
    s_add_u32 s31, s25, 22528
    v_mfma_f32_16x16x32_bf16 v[20:23], a[56:59], v[204:207], v[20:23]
    v_mfma_f32_16x16x32_bf16 v[20:23], a[60:63], v[208:211], v[20:23]
    buffer_load_dwordx4 v3, s[4:7], s31 offen sc1 lds
    v_mfma_f32_16x16x32_bf16 v[20:23], a[64:67], v[212:215], v[20:23]
    s_add_u32 m0, s26, 45056
    ds_read_b128 a[232:235], v1 offset:12288
    ds_read_b128 a[236:239], v1 offset:13312
    v_mfma_f32_16x16x32_bf16 v[20:23], a[68:71], v[216:219], v[20:23]
    s_add_u32 s31, s16, 26624
    ds_read_b128 a[240:243], v1 offset:14336
    v_mfma_f32_16x16x32_bf16 v[24:27], a[72:75], v[184:187], 0
    ds_read_b128 a[244:247], v1 offset:15360
    ds_read_b128 a[248:251], v1 offset:16384
    v_mfma_f32_16x16x32_bf16 v[24:27], a[76:79], v[188:191], v[24:27]
    ds_read_b128 a[252:255], v1 offset:17408
    v_mfma_f32_16x16x32_bf16 v[24:27], a[80:83], v[192:195], v[24:27]
    buffer_load_dwordx4 v3, s[4:7], s31 offen sc1 lds
    v_mfma_f32_16x16x32_bf16 v[24:27], a[84:87], v[196:199], v[24:27]
    s_add_u32 m0, s26, 49152
    v_mfma_f32_16x16x32_bf16 v[24:27], a[88:91], v[200:203], v[24:27]
    s_add_u32 s31, s25, 58368
    v_mfma_f32_16x16x32_bf16 v[24:27], a[92:95], v[204:207], v[24:27]
    v_mfma_f32_16x16x32_bf16 v[24:27], a[96:99], v[208:211], v[24:27]
    buffer_load_dwordx4 v3, s[4:7], s31 offen sc1 lds
    v_mfma_f32_16x16x32_bf16 v[24:27], a[100:103], v[212:215], v[24:27]
    v_mfma_f32_16x16x32_bf16 v[24:27], a[104:107], v[216:219], v[24:27]
    s_waitcnt lgkmcnt(3)
    v_mfma_f32_16x16x32_bf16 v[28:31], a[0:3], v[220:223], 0
    s_add_u32 m0, s26, 53248
    v_mfma_f32_16x16x32_bf16 v[28:31], a[4:7], v[224:227], v[28:31]
    s_add_u32 s31, s17, 62464
    v_mfma_f32_16x16x32_bf16 v[28:31], a[8:11], v[228:231], v[28:31]
    buffer_load_dwordx4 v3, s[4:7], s31 offen sc1 lds
    v_mfma_f32_16x16x32_bf16 v[28:31], a[12:15], a[232:235], v[28:31]
    v_mfma_f32_16x16x32_bf16 v[28:31], a[16:19], a[236:239], v[28:31]
    s_add_u32 s30, s24, 155648
    v_mfma_f32_16x16x32_bf16 v[28:31], a[20:23], a[240:243], v[28:31]
    s_waitcnt lgkmcnt(0)
    v_mfma_f32_16x16x32_bf16 v[28:31], a[24:27], a[244:247], v[28:31]
    buffer_load_dwordx4 a[152:155], v3, s[4:7], s30 offen sc1
    v_mfma_f32_16x16x32_bf16 v[28:31], a[28:31], a[248:251], v[28:31]
    v_mfma_f32_16x16x32_bf16 v[28:31], a[32:35], a[252:255], v[28:31]
    v_mfma_f32_16x16x32_bf16 v[32:35], a[36:39], v[220:223], 0
    s_add_u32 s30, s24, 159744
    ds_read_b128 v[184:187], v1 offset:18432
    ds_read_b128 v[188:191], v1 offset:19456
    v_mfma_f32_16x16x32_bf16 v[32:35], a[40:43], v[224:227], v[32:35]
    ds_read_b128 v[192:195], v1 offset:20480
    v_mfma_f32_16x16x32_bf16 v[32:35], a[44:47], v[228:231], v[32:35]
    buffer_load_dwordx4 a[156:159], v3, s[4:7], s30 offen sc1
    v_mfma_f32_16x16x32_bf16 v[32:35], a[48:51], a[232:235], v[32:35]
    s_add_u32 m0, s26, 57344
    v_mfma_f32_16x16x32_bf16 v[32:35], a[52:55], a[236:239], v[32:35]
    s_add_u32 s31, s25, 94208
    v_mfma_f32_16x16x32_bf16 v[32:35], a[56:59], a[240:243], v[32:35]
    v_mfma_f32_16x16x32_bf16 v[32:35], a[60:63], a[244:247], v[32:35]
    buffer_load_dwordx4 v3, s[4:7], s31 offen sc1 lds
    v_mfma_f32_16x16x32_bf16 v[32:35], a[64:67], a[248:251], v[32:35]
    s_waitcnt vmcnt(7)
    ds_read_b128 v[196:199], v1 offset:21504
    ds_read_b128 v[200:203], v1 offset:22528
    v_mfma_f32_16x16x32_bf16 v[32:35], a[68:71], a[252:255], v[32:35]
    s_barrier
    ds_read_b128 v[204:207], v1 offset:23552
    v_mfma_f32_16x16x32_bf16 v[36:39], a[72:75], v[220:223], 0
    s_add_u32 s30, s24, 163840
    ds_read_b128 v[208:211], v1 offset:24576
    ds_read_b128 v[212:215], v1 offset:25600
    v_mfma_f32_16x16x32_bf16 v[36:39], a[76:79], v[224:227], v[36:39]
    ds_read_b128 v[216:219], v1 offset:26624
    v_mfma_f32_16x16x32_bf16 v[36:39], a[80:83], v[228:231], v[36:39]
    buffer_load_dwordx4 a[160:163], v3, s[4:7], s30 offen sc1
    v_mfma_f32_16x16x32_bf16 v[36:39], a[84:87], a[232:235], v[36:39]
    v_mfma_f32_16x16x32_bf16 v[36:39], a[88:91], a[236:239], v[36:39]
    s_add_u32 m0, s26, 61440
    v_mfma_f32_16x16x32_bf16 v[36:39], a[92:95], a[240:243], v[36:39]
    s_add_u32 s31, s18, 98304
    v_mfma_f32_16x16x32_bf16 v[36:39], a[96:99], a[244:247], v[36:39]
    v_mfma_f32_16x16x32_bf16 v[36:39], a[100:103], a[248:251], v[36:39]
    buffer_load_dwordx4 v3, s[4:7], s31 offen sc1 lds
    v_mfma_f32_16x16x32_bf16 v[36:39], a[104:107], a[252:255], v[36:39]
    s_waitcnt lgkmcnt(3)
    v_mfma_f32_16x16x32_bf16 v[40:43], a[0:3], v[184:187], 0
    s_add_u32 s30, s24, 167936
    v_mfma_f32_16x16x32_bf16 v[40:43], a[4:7], v[188:191], v[40:43]
    v_mfma_f32_16x16x32_bf16 v[40:43], a[8:11], v[192:195], v[40:43]
    buffer_load_dwordx4 a[164:167], v3, s[4:7], s30 offen sc1
    v_mfma_f32_16x16x32_bf16 v[40:43], a[12:15], v[196:199], v[40:43]
    v_mfma_f32_16x16x32_bf16 v[40:43], a[16:19], v[200:203], v[40:43]
    v_mfma_f32_16x16x32_bf16 v[40:43], a[20:23], v[204:207], v[40:43]
    s_waitcnt lgkmcnt(0)
    v_mfma_f32_16x16x32_bf16 v[40:43], a[24:27], v[208:211], v[40:43]
    s_add_u32 s30, s24, 172032
    v_mfma_f32_16x16x32_bf16 v[40:43], a[28:31], v[212:215], v[40:43]
    buffer_load_dwordx4 a[168:171], v3, s[4:7], s30 offen sc1
    v_mfma_f32_16x16x32_bf16 v[40:43], a[32:35], v[216:219], v[40:43]
    s_add_u32 m0, s26, 65536
    v_mfma_f32_16x16x32_bf16 v[44:47], a[36:39], v[184:187], 0
    s_add_u32 s31, s25, 130048
    ds_read_b128 v[220:223], v1 offset:27648
    ds_read_b128 v[224:227], v1 offset:28672
    v_mfma_f32_16x16x32_bf16 v[44:47], a[40:43], v[188:191], v[44:47]
    ds_read_b128 v[228:231], v1 offset:29696
    v_mfma_f32_16x16x32_bf16 v[44:47], a[44:47], v[192:195], v[44:47]
    buffer_load_dwordx4 v3, s[4:7], s31 offen sc1 lds
    v_mfma_f32_16x16x32_bf16 v[44:47], a[48:51], v[196:199], v[44:47]
    buffer_load_dword v244, v13, s[4:7], s44 offen offset:0 sc1
    v_mfma_f32_16x16x32_bf16 v[44:47], a[52:55], v[200:203], v[44:47]
    v_mfma_f32_16x16x32_bf16 v[44:47], a[56:59], v[204:207], v[44:47]
    s_add_u32 s30, s24, 176128
    v_mfma_f32_16x16x32_bf16 v[44:47], a[60:63], v[208:211], v[44:47]
    buffer_load_dword v245, v13, s[4:7], s44 offen offset:128 sc1
    v_mfma_f32_16x16x32_bf16 v[44:47], a[64:67], v[212:215], v[44:47]
    ds_read_b128 a[232:235], v1 offset:30720
    ds_read_b128 a[236:239], v1 offset:31744
    v_mfma_f32_16x16x32_bf16 v[44:47], a[68:71], v[216:219], v[44:47]
    ds_read_b128 a[240:243], v1 offset:32768
    v_mfma_f32_16x16x32_bf16 v[48:51], a[72:75], v[184:187], 0
    ds_read_b128 a[244:247], v1 offset:33792
    ds_read_b128 a[248:251], v1 offset:34816
    v_mfma_f32_16x16x32_bf16 v[48:51], a[76:79], v[188:191], v[48:51]
    ds_read_b128 a[252:255], v1 offset:35840
    v_mfma_f32_16x16x32_bf16 v[48:51], a[80:83], v[192:195], v[48:51]
    buffer_load_dwordx4 a[172:175], v3, s[4:7], s30 offen sc1
    v_mfma_f32_16x16x32_bf16 v[48:51], a[84:87], v[196:199], v[48:51]
    s_add_u32 m0, s26, 69632
    v_mfma_f32_16x16x32_bf16 v[48:51], a[88:91], v[200:203], v[48:51]
    s_add_u32 s31, s25, 134144
    v_mfma_f32_16x16x32_bf16 v[48:51], a[92:95], v[204:207], v[48:51]
    buffer_load_dwordx4 v3, s[4:7], s31 offen sc1 lds
    v_mfma_f32_16x16x32_bf16 v[48:51], a[96:99], v[208:211], v[48:51]
    buffer_load_dword v246, v13, s[4:7], s44 offen offset:256 sc1
    v_mfma_f32_16x16x32_bf16 v[48:51], a[100:103], v[212:215], v[48:51]
    s_add_u32 s30, s24, 180224
    v_mfma_f32_16x16x32_bf16 v[48:51], a[104:107], v[216:219], v[48:51]
    s_waitcnt lgkmcnt(3)
    v_mfma_f32_16x16x32_bf16 v[52:55], a[0:3], v[220:223], 0
    buffer_load_dwordx4 a[176:179], v3, s[4:7], s30 offen sc1
    v_mfma_f32_16x16x32_bf16 v[52:55], a[4:7], v[224:227], v[52:55]
    buffer_load_dword v247, v13, s[4:7], s44 offen offset:384 sc1
    v_mfma_f32_16x16x32_bf16 v[52:55], a[8:11], v[228:231], v[52:55]
    v_mfma_f32_16x16x32_bf16 v[52:55], a[12:15], a[232:235], v[52:55]
    s_add_u32 s30, s24, 184320
    v_mfma_f32_16x16x32_bf16 v[52:55], a[16:19], a[236:239], v[52:55]
    buffer_load_dword v248, v13, s[4:7], s44 offen offset:64 sc1
    v_mfma_f32_16x16x32_bf16 v[52:55], a[20:23], a[240:243], v[52:55]
    s_waitcnt lgkmcnt(0)
    v_mfma_f32_16x16x32_bf16 v[52:55], a[24:27], a[244:247], v[52:55]
    buffer_load_dwordx4 a[180:183], v3, s[4:7], s30 offen sc1
    v_mfma_f32_16x16x32_bf16 v[52:55], a[28:31], a[248:251], v[52:55]
    s_add_u32 m0, s26, 73728
    v_mfma_f32_16x16x32_bf16 v[52:55], a[32:35], a[252:255], v[52:55]
    s_add_u32 s31, s25, 9216
    v_mfma_f32_16x16x32_bf16 v[56:59], a[36:39], v[220:223], 0
    ds_read_b128 v[184:187], v1 offset:36864
    ds_read_b128 v[188:191], v1 offset:37888
    v_mfma_f32_16x16x32_bf16 v[56:59], a[40:43], v[224:227], v[56:59]
    s_waitcnt vmcnt(17)
    ds_read_b128 v[192:195], v1 offset:38912
    v_mfma_f32_16x16x32_bf16 v[56:59], a[44:47], v[228:231], v[56:59]
    buffer_load_dwordx4 v3, s[4:7], s31 offen sc1 lds
    v_mfma_f32_16x16x32_bf16 v[56:59], a[48:51], a[232:235], v[56:59]
    s_add_u32 s30, s24, 188416
    v_mfma_f32_16x16x32_bf16 v[56:59], a[52:55], a[236:239], v[56:59]
    buffer_load_dword v249, v13, s[4:7], s44 offen offset:192 sc1
    v_mfma_f32_16x16x32_bf16 v[56:59], a[56:59], a[240:243], v[56:59]
    buffer_load_dwordx4 a[184:187], v3, s[4:7], s30 offen sc1
    v_mfma_f32_16x16x32_bf16 v[56:59], a[60:63], a[244:247], v[56:59]
    s_barrier
    v_mfma_f32_16x16x32_bf16 v[56:59], a[64:67], a[248:251], v[56:59]
    s_add_u32 m0, s26, 77824
    ds_read_b128 v[196:199], v1 offset:39936
    ds_read_b128 v[200:203], v1 offset:40960
    v_mfma_f32_16x16x32_bf16 v[56:59], a[68:71], a[252:255], v[56:59]
    s_add_u32 s31, s25, 13312
    ds_read_b128 v[204:207], v1 offset:41984
    v_mfma_f32_16x16x32_bf16 v[60:63], a[72:75], v[220:223], 0
    ds_read_b128 v[208:211], v1 offset:43008
    ds_read_b128 v[212:215], v1 offset:44032
    v_mfma_f32_16x16x32_bf16 v[60:63], a[76:79], v[224:227], v[60:63]
    ds_read_b128 v[216:219], v1 offset:45056
    v_mfma_f32_16x16x32_bf16 v[60:63], a[80:83], v[228:231], v[60:63]
    buffer_load_dwordx4 v3, s[4:7], s31 offen sc1 lds
    v_mfma_f32_16x16x32_bf16 v[60:63], a[84:87], a[232:235], v[60:63]
    s_add_u32 s30, s24, 192512
    v_mfma_f32_16x16x32_bf16 v[60:63], a[88:91], a[236:239], v[60:63]
    buffer_load_dword v250, v13, s[4:7], s44 offen offset:320 sc1
    v_mfma_f32_16x16x32_bf16 v[60:63], a[92:95], a[240:243], v[60:63]
    buffer_load_dwordx4 a[188:191], v3, s[4:7], s30 offen sc1
    v_mfma_f32_16x16x32_bf16 v[60:63], a[96:99], a[244:247], v[60:63]
    v_mfma_f32_16x16x32_bf16 v[60:63], a[100:103], a[248:251], v[60:63]
    buffer_load_dword v251, v13, s[4:7], s44 offen offset:448 sc1
    v_mfma_f32_16x16x32_bf16 v[60:63], a[104:107], a[252:255], v[60:63]
    s_waitcnt lgkmcnt(3)
    v_mfma_f32_16x16x32_bf16 v[64:67], a[0:3], v[184:187], 0
    s_add_u32 s30, s24, 196608
    v_mfma_f32_16x16x32_bf16 v[64:67], a[4:7], v[188:191], v[64:67]
    buffer_load_dwordx4 a[192:195], v3, s[4:7], s30 offen sc1
    v_mfma_f32_16x16x32_bf16 v[64:67], a[8:11], v[192:195], v[64:67]
    s_add_u32 m0, s26, 81920
    v_mfma_f32_16x16x32_bf16 v[64:67], a[12:15], v[196:199], v[64:67]
    s_add_u32 s31, s16, 17408
    v_mfma_f32_16x16x32_bf16 v[64:67], a[16:19], v[200:203], v[64:67]
    v_mfma_f32_16x16x32_bf16 v[64:67], a[20:23], v[204:207], v[64:67]
    s_waitcnt lgkmcnt(0)
    v_mfma_f32_16x16x32_bf16 v[64:67], a[24:27], v[208:211], v[64:67]
    buffer_load_dwordx4 v3, s[4:7], s31 offen sc1 lds
    v_mfma_f32_16x16x32_bf16 v[64:67], a[28:31], v[212:215], v[64:67]
    v_mfma_f32_16x16x32_bf16 v[64:67], a[32:35], v[216:219], v[64:67]
    s_add_u32 s30, s24, 200704
    v_mfma_f32_16x16x32_bf16 v[68:71], a[36:39], v[184:187], 0
    ds_read_b128 v[220:223], v1 offset:46080
    ds_read_b128 v[224:227], v1 offset:47104
    v_mfma_f32_16x16x32_bf16 v[68:71], a[40:43], v[188:191], v[68:71]
    ds_read_b128 v[228:231], v1 offset:48128
    v_mfma_f32_16x16x32_bf16 v[68:71], a[44:47], v[192:195], v[68:71]
    buffer_load_dwordx4 a[196:199], v3, s[4:7], s30 offen sc1
    v_mfma_f32_16x16x32_bf16 v[68:71], a[48:51], v[196:199], v[68:71]
    v_mfma_f32_16x16x32_bf16 v[68:71], a[52:55], v[200:203], v[68:71]
    s_add_u32 s30, s24, 204800
    v_mfma_f32_16x16x32_bf16 v[68:71], a[56:59], v[204:207], v[68:71]
    v_mfma_f32_16x16x32_bf16 v[68:71], a[60:63], v[208:211], v[68:71]
    buffer_load_dwordx4 a[200:203], v3, s[4:7], s30 offen sc1
    v_mfma_f32_16x16x32_bf16 v[68:71], a[64:67], v[212:215], v[68:71]
    s_add_u32 m0, s26, 86016
    ds_read_b128 a[232:235], v1 offset:49152
    ds_read_b128 a[236:239], v1 offset:50176
    v_mfma_f32_16x16x32_bf16 v[68:71], a[68:71], v[216:219], v[68:71]
    s_add_u32 s31, s25, 49152
    ds_read_b128 a[240:243], v1 offset:51200
    v_mfma_f32_16x16x32_bf16 v[72:75], a[72:75], v[184:187], 0
    ds_read_b128 a[244:247], v1 offset:52224
    ds_read_b128 a[248:251], v1 offset:53248
    v_mfma_f32_16x16x32_bf16 v[72:75], a[76:79], v[188:191], v[72:75]
    ds_read_b128 a[252:255], v1 offset:54272
    v_mfma_f32_16x16x32_bf16 v[72:75], a[80:83], v[192:195], v[72:75]
    buffer_load_dwordx4 v3, s[4:7], s31 offen sc1 lds
    v_mfma_f32_16x16x32_bf16 v[72:75], a[84:87], v[196:199], v[72:75]
    v_mfma_f32_16x16x32_bf16 v[72:75], a[88:91], v[200:203], v[72:75]
    s_add_u32 s30, s24, 208896
    v_mfma_f32_16x16x32_bf16 v[72:75], a[92:95], v[204:207], v[72:75]
    v_mfma_f32_16x16x32_bf16 v[72:75], a[96:99], v[208:211], v[72:75]
    buffer_load_dwordx4 a[204:207], v3, s[4:7], s30 offen sc1
    v_mfma_f32_16x16x32_bf16 v[72:75], a[100:103], v[212:215], v[72:75]
    s_add_u32 m0, s26, 90112
    v_mfma_f32_16x16x32_bf16 v[72:75], a[104:107], v[216:219], v[72:75]
    s_waitcnt lgkmcnt(3)
    v_mfma_f32_16x16x32_bf16 v[76:79], a[0:3], v[220:223], 0
    s_add_u32 s31, s17, 53248
    v_mfma_f32_16x16x32_bf16 v[76:79], a[4:7], v[224:227], v[76:79]
    buffer_load_dwordx4 v3, s[4:7], s31 offen sc1 lds
    v_mfma_f32_16x16x32_bf16 v[76:79], a[8:11], v[228:231], v[76:79]
    v_mfma_f32_16x16x32_bf16 v[76:79], a[12:15], a[232:235], v[76:79]
    v_mfma_f32_16x16x32_bf16 v[76:79], a[16:19], a[236:239], v[76:79]
    s_add_u32 s30, s24, 212992
    v_mfma_f32_16x16x32_bf16 v[76:79], a[20:23], a[240:243], v[76:79]
    s_waitcnt lgkmcnt(0)
    v_mfma_f32_16x16x32_bf16 v[76:79], a[24:27], a[244:247], v[76:79]
    buffer_load_dwordx4 a[208:211], v3, s[4:7], s30 offen sc1
    v_mfma_f32_16x16x32_bf16 v[76:79], a[28:31], a[248:251], v[76:79]
    v_mfma_f32_16x16x32_bf16 v[76:79], a[32:35], a[252:255], v[76:79]
    s_waitcnt vmcnt(20)
    v_mfma_f32_16x16x32_bf16 v[80:83], a[36:39], v[220:223], 0
    s_add_u32 s30, s24, 217088
    ds_read_b128 v[184:187], v1 offset:55296
    ds_read_b128 v[188:191], v1 offset:56320
    v_mfma_f32_16x16x32_bf16 v[80:83], a[40:43], v[224:227], v[80:83]
    s_barrier
    ds_read_b128 v[192:195], v1 offset:57344
    v_mfma_f32_16x16x32_bf16 v[80:83], a[44:47], v[228:231], v[80:83]
    buffer_load_dwordx4 a[212:215], v3, s[4:7], s30 offen sc1
    v_mfma_f32_16x16x32_bf16 v[80:83], a[48:51], a[232:235], v[80:83]
    s_add_u32 m0, s26, 94208
    v_mfma_f32_16x16x32_bf16 v[80:83], a[52:55], a[236:239], v[80:83]
    s_add_u32 s31, s25, 84992
    v_mfma_f32_16x16x32_bf16 v[80:83], a[56:59], a[240:243], v[80:83]
    v_mfma_f32_16x16x32_bf16 v[80:83], a[60:63], a[244:247], v[80:83]
    buffer_load_dwordx4 v3, s[4:7], s31 offen sc1 lds
    v_mfma_f32_16x16x32_bf16 v[80:83], a[64:67], a[248:251], v[80:83]
    ds_read_b128 v[196:199], v1 offset:58368
    ds_read_b128 v[200:203], v1 offset:59392
    v_mfma_f32_16x16x32_bf16 v[80:83], a[68:71], a[252:255], v[80:83]
    ds_read_b128 v[204:207], v1 offset:60416
    v_mfma_f32_16x16x32_bf16 v[84:87], a[72:75], v[220:223], 0
    ds_read_b128 v[208:211], v1 offset:61440
    ds_read_b128 v[212:215], v1 offset:62464
    v_mfma_f32_16x16x32_bf16 v[84:87], a[76:79], v[224:227], v[84:87]
    ds_read_b128 v[216:219], v1 offset:63488
    v_mfma_f32_16x16x32_bf16 v[84:87], a[80:83], v[228:231], v[84:87]
    v_mfma_f32_16x16x32_bf16 v[84:87], a[84:87], a[232:235], v[84:87]
ffn1_part_pad0_2x:
    s_cbranch_execz ffn1_part_pad0_6x
    v_mfma_f32_16x16x32_bf16 v[84:87], a[88:91], a[236:239], v[84:87]
    s_add_u32 m0, s26, 98304
    v_mfma_f32_16x16x32_bf16 v[84:87], a[92:95], a[240:243], v[84:87]
    s_add_u32 s31, s18, 89088
    v_mfma_f32_16x16x32_bf16 v[84:87], a[96:99], a[244:247], v[84:87]
    v_mfma_f32_16x16x32_bf16 v[84:87], a[100:103], a[248:251], v[84:87]
    buffer_load_dwordx4 v3, s[4:7], s31 offen sc1 lds
    v_mfma_f32_16x16x32_bf16 v[84:87], a[104:107], a[252:255], v[84:87]
    s_waitcnt lgkmcnt(3)
    v_mfma_f32_16x16x32_bf16 v[88:91], a[0:3], v[184:187], 0
    v_mfma_f32_16x16x32_bf16 v[88:91], a[4:7], v[188:191], v[88:91]
    v_mfma_f32_16x16x32_bf16 v[88:91], a[8:11], v[192:195], v[88:91]
    v_mfma_f32_16x16x32_bf16 v[88:91], a[12:15], v[196:199], v[88:91]
    v_mfma_f32_16x16x32_bf16 v[88:91], a[16:19], v[200:203], v[88:91]
    v_mfma_f32_16x16x32_bf16 v[88:91], a[20:23], v[204:207], v[88:91]
    s_waitcnt lgkmcnt(0)
    v_mfma_f32_16x16x32_bf16 v[88:91], a[24:27], v[208:211], v[88:91]
    v_mfma_f32_16x16x32_bf16 v[88:91], a[28:31], v[212:215], v[88:91]
    s_add_u32 m0, s26, 102400
    v_mfma_f32_16x16x32_bf16 v[88:91], a[32:35], v[216:219], v[88:91]
    s_add_u32 s31, s25, 120832
    v_mfma_f32_16x16x32_bf16 v[92:95], a[36:39], v[184:187], 0
    ds_read_b128 v[220:223], v1 offset:64512
    ds_read_b128 v[224:227], v4 offset:0
    v_mfma_f32_16x16x32_bf16 v[92:95], a[40:43], v[188:191], v[92:95]
    ds_read_b128 v[228:231], v4 offset:1024
    v_mfma_f32_16x16x32_bf16 v[92:95], a[44:47], v[192:195], v[92:95]
    buffer_load_dwordx4 v3, s[4:7], s31 offen sc1 lds
    v_mfma_f32_16x16x32_bf16 v[92:95], a[48:51], v[196:199], v[92:95]
    v_mfma_f32_16x16x32_bf16 v[92:95], a[52:55], v[200:203], v[92:95]
    v_mfma_f32_16x16x32_bf16 v[92:95], a[56:59], v[204:207], v[92:95]
    v_mfma_f32_16x16x32_bf16 v[92:95], a[60:63], v[208:211], v[92:95]
    v_mfma_f32_16x16x32_bf16 v[92:95], a[64:67], v[212:215], v[92:95]
    ds_read_b128 a[232:235], v4 offset:2048
    ds_read_b128 a[236:239], v4 offset:3072
    v_mfma_f32_16x16x32_bf16 v[92:95], a[68:71], v[216:219], v[92:95]
    ds_read_b128 a[240:243], v4 offset:4096
    v_mfma_f32_16x16x32_bf16 v[96:99], a[72:75], v[184:187], 0
    ds_read_b128 a[244:247], v4 offset:5120
    ds_read_b128 a[248:251], v4 offset:6144
    v_mfma_f32_16x16x32_bf16 v[96:99], a[76:79], v[188:191], v[96:99]
    s_add_u32 m0, s26, 106496
    ds_read_b128 a[252:255], v4 offset:7168
    v_mfma_f32_16x16x32_bf16 v[96:99], a[80:83], v[192:195], v[96:99]
    s_add_u32 s31, s25, 124928
    v_mfma_f32_16x16x32_bf16 v[96:99], a[84:87], v[196:199], v[96:99]
    v_mfma_f32_16x16x32_bf16 v[96:99], a[88:91], v[200:203], v[96:99]
    buffer_load_dwordx4 v3, s[4:7], s31 offen sc1 lds
    v_mfma_f32_16x16x32_bf16 v[96:99], a[92:95], v[204:207], v[96:99]
    v_mfma_f32_16x16x32_bf16 v[96:99], a[96:99], v[208:211], v[96:99]
    v_mfma_f32_16x16x32_bf16 v[96:99], a[100:103], v[212:215], v[96:99]
    v_mfma_f32_16x16x32_bf16 v[96:99], a[104:107], v[216:219], v[96:99]
    s_waitcnt lgkmcnt(3)
    v_mfma_f32_16x16x32_bf16 v[100:103], a[0:3], v[220:223], 0
    s_add_u32 s30, s24, 221184
    v_mfma_f32_16x16x32_bf16 v[100:103], a[4:7], v[224:227], v[100:103]
    buffer_load_dwordx4 a[0:3], v3, s[4:7], s30 offen sc1
    v_mfma_f32_16x16x32_bf16 v[100:103], a[8:11], v[228:231], v[100:103]
    s_add_u32 s30, s24, 225280
    v_mfma_f32_16x16x32_bf16 v[100:103], a[12:15], a[232:235], v[100:103]
    v_mfma_f32_16x16x32_bf16 v[100:103], a[16:19], a[236:239], v[100:103]
    buffer_load_dwordx4 a[4:7], v3, s[4:7], s30 offen sc1
    v_mfma_f32_16x16x32_bf16 v[100:103], a[20:23], a[240:243], v[100:103]
    s_waitcnt vmcnt(13) lgkmcnt(0)
    v_mfma_f32_16x16x32_bf16 v[100:103], a[24:27], a[244:247], v[100:103]
    s_add_u32 m0, s26, 110592
    v_mfma_f32_16x16x32_bf16 v[100:103], a[28:31], a[248:251], v[100:103]
    s_add_u32 s31, s25, 27648
    v_mfma_f32_16x16x32_bf16 v[100:103], a[32:35], a[252:255], v[100:103]
    buffer_load_dwordx4 v3, s[4:7], s31 offen sc1 lds
    v_mfma_f32_16x16x32_bf16 v[104:107], a[36:39], v[220:223], 0
    s_barrier
    ds_read_b128 v[184:187], v4 offset:8192
    ds_read_b128 v[188:191], v4 offset:9216
    v_mfma_f32_16x16x32_bf16 v[104:107], a[40:43], v[224:227], v[104:107]
    ds_read_b128 v[192:195], v4 offset:10240
    v_mfma_f32_16x16x32_bf16 v[104:107], a[44:47], v[228:231], v[104:107]
    s_add_u32 s30, s24, 229376
    v_mfma_f32_16x16x32_bf16 v[104:107], a[48:51], a[232:235], v[104:107]
    v_mfma_f32_16x16x32_bf16 v[104:107], a[52:55], a[236:239], v[104:107]
    buffer_load_dwordx4 a[8:11], v3, s[4:7], s30 offen sc1
    v_mfma_f32_16x16x32_bf16 v[104:107], a[56:59], a[240:243], v[104:107]
    v_mfma_f32_16x16x32_bf16 v[104:107], a[60:63], a[244:247], v[104:107]
    s_add_u32 s30, s24, 233472
    v_mfma_f32_16x16x32_bf16 v[104:107], a[64:67], a[248:251], v[104:107]
    ds_read_b128 v[196:199], v4 offset:11264
    ds_read_b128 v[200:203], v4 offset:12288
    v_mfma_f32_16x16x32_bf16 v[104:107], a[68:71], a[252:255], v[104:107]
    ds_read_b128 v[204:207], v4 offset:13312
    v_mfma_f32_16x16x32_bf16 v[108:111], a[72:75], v[220:223], 0
    ds_read_b128 v[208:211], v4 offset:14336
    ds_read_b128 v[212:215], v4 offset:15360
    v_mfma_f32_16x16x32_bf16 v[108:111], a[76:79], v[224:227], v[108:111]
    ds_read_b128 v[216:219], v4 offset:16384
    v_mfma_f32_16x16x32_bf16 v[108:111], a[80:83], v[228:231], v[108:111]
    buffer_load_dwordx4 a[12:15], v3, s[4:7], s30 offen sc1
    v_mfma_f32_16x16x32_bf16 v[108:111], a[84:87], a[232:235], v[108:111]
    s_add_u32 m0, s26, 114688
    v_mfma_f32_16x16x32_bf16 v[108:111], a[88:91], a[236:239], v[108:111]
    s_add_u32 s31, s25, 31744
    v_mfma_f32_16x16x32_bf16 v[108:111], a[92:95], a[240:243], v[108:111]
    buffer_load_dwordx4 v3, s[4:7], s31 offen sc1 lds
    v_mfma_f32_16x16x32_bf16 v[108:111], a[96:99], a[244:247], v[108:111]
    v_mfma_f32_16x16x32_bf16 v[108:111], a[100:103], a[248:251], v[108:111]
    s_add_u32 s30, s24, 237568
    v_mfma_f32_16x16x32_bf16 v[108:111], a[104:107], a[252:255], v[108:111]
    s_waitcnt lgkmcnt(3)
    v_fma_f32 v244, v244, s45, v252
    v_fma_f32 v245, v245, s45, v252
    v_mfma_f32_16x16x32_bf16 v[16:19], a[108:111], v[184:187], v[16:19]
    buffer_load_dwordx4 a[16:19], v3, s[4:7], s30 offen sc1
    v_mfma_f32_16x16x32_bf16 v[16:19], a[112:115], v[188:191], v[16:19]
    v_rsq_f32 v244, v244
    v_mfma_f32_16x16x32_bf16 v[16:19], a[116:119], v[192:195], v[16:19]
    s_add_u32 m0, s26, 118784
    v_rsq_f32 v245, v245
    v_mfma_f32_16x16x32_bf16 v[16:19], a[120:123], v[196:199], v[16:19]
    s_add_u32 s31, s16, 35840
    v_fma_f32 v246, v246, s45, v252
    v_fma_f32 v247, v247, s45, v252
    v_mfma_f32_16x16x32_bf16 v[16:19], a[124:127], v[200:203], v[16:19]
    v_rsq_f32 v246, v246
    v_mfma_f32_16x16x32_bf16 v[16:19], a[128:131], v[204:207], v[16:19]
    s_waitcnt lgkmcnt(0)
    v_rsq_f32 v247, v247
    v_mfma_f32_16x16x32_bf16 v[16:19], a[132:135], v[208:211], v[16:19]
    buffer_load_dwordx4 v3, s[4:7], s31 offen sc1 lds
    v_mfma_f32_16x16x32_bf16 v[16:19], a[136:139], v[212:215], v[16:19]
    s_add_u32 s30, s24, 241664
    v_fma_f32 v248, v248, s45, v252
    v_fma_f32 v249, v249, s45, v252
    v_mfma_f32_16x16x32_bf16 v[16:19], a[140:143], v[216:219], v[16:19]
    v_rsq_f32 v248, v248
    v_mfma_f32_16x16x32_bf16 v[20:23], a[144:147], v[184:187], v[20:23]
    ds_read_b128 v[220:223], v4 offset:17408
    ds_read_b128 v[224:227], v4 offset:18432
    v_mfma_f32_16x16x32_bf16 v[20:23], a[148:151], v[188:191], v[20:23]
    s_waitcnt vmcnt(9)
    ds_read_b128 v[228:231], v4 offset:19456
    v_fma_f32 v250, v250, s45, v252
    v_mfma_f32_16x16x32_bf16 v[20:23], a[152:155], v[192:195], v[20:23]
    buffer_load_dwordx4 a[20:23], v3, s[4:7], s30 offen sc1
    v_mfma_f32_16x16x32_bf16 v[20:23], a[156:159], v[196:199], v[20:23]
    s_add_u32 s30, s24, 245760
    v_rsq_f32 v249, v249
    v_mfma_f32_16x16x32_bf16 v[20:23], a[160:163], v[200:203], v[20:23]
    s_barrier
    v_rsq_f32 v250, v250
    v_mfma_f32_16x16x32_bf16 v[20:23], a[164:167], v[204:207], v[20:23]
    buffer_load_dwordx4 a[24:27], v3, s[4:7], s30 offen sc1
    v_mfma_f32_16x16x32_bf16 v[20:23], a[168:171], v[208:211], v[20:23]
    v_fma_f32 v251, v251, s45, v252
    v_and_b32 v13, 31, v0
    v_mfma_f32_16x16x32_bf16 v[20:23], a[172:175], v[212:215], v[20:23]
    s_add_u32 m0, s26, 122880
    ds_read_b128 a[232:235], v4 offset:20480
    ds_read_b128 a[236:239], v4 offset:21504
    v_mfma_f32_16x16x32_bf16 v[20:23], a[176:179], v[216:219], v[20:23]
    s_add_u32 s31, s25, 67584
    ds_read_b128 a[240:243], v4 offset:22528
    v_mov_b32 v252, 1
    v_mfma_f32_16x16x32_bf16 v[24:27], a[180:183], v[184:187], v[24:27]
    ds_read_b128 a[244:247], v4 offset:23552
    ds_read_b128 a[248:251], v4 offset:24576
    v_mfma_f32_16x16x32_bf16 v[24:27], a[184:187], v[188:191], v[24:27]
    ds_read_b128 a[252:255], v4 offset:25600
    v_lshl_add_u32 v13, v13, 7, s12
    v_mfma_f32_16x16x32_bf16 v[24:27], a[188:191], v[192:195], v[24:27]
    buffer_load_dwordx4 v3, s[4:7], s31 offen sc1 lds
    v_mfma_f32_16x16x32_bf16 v[24:27], a[192:195], v[196:199], v[24:27]
    s_add_u32 s30, s24, 249856
    v_rsq_f32 v251, v251
    v_mfma_f32_16x16x32_bf16 v[24:27], a[196:199], v[200:203], v[24:27]
    v_min_u32 v13, ffn1_part_end-ffn1_part-4, v13
    v_mul_f32 v16, v16, v244
    v_mfma_f32_16x16x32_bf16 v[24:27], a[200:203], v[204:207], v[24:27]
    buffer_load_dwordx4 a[28:31], v3, s[4:7], s30 offen sc1
    v_mfma_f32_16x16x32_bf16 v[24:27], a[204:207], v[208:211], v[24:27]
    v_mul_f32 v17, v17, v244
    v_fma_f32 v232, -v16, v16, s29
    v_mfma_f32_16x16x32_bf16 v[24:27], a[208:211], v[212:215], v[24:27]
    s_add_u32 m0, s26, 126976
    v_fma_f32 v233, -v17, v17, s29
    v_mul_f32 v232, v232, v16
    v_mfma_f32_16x16x32_bf16 v[24:27], a[212:215], v[216:219], v[24:27]
    s_waitcnt lgkmcnt(3)
    v_mul_f32 v233, v233, v17
    v_mul_f32 v18, v16, v18
    v_mfma_f32_16x16x32_bf16 v[28:31], a[108:111], v[220:223], v[28:31]
    s_add_u32 s31, s17, 71680
    v_exp_f32 v232, v232
    v_mfma_f32_16x16x32_bf16 v[28:31], a[112:115], v[224:227], v[28:31]
    buffer_load_dwordx4 v3, s[4:7], s31 offen sc1 lds
    v_mfma_f32_16x16x32_bf16 v[28:31], a[116:119], v[228:231], v[28:31]
    v_exp_f32 v233, v233
    v_mfma_f32_16x16x32_bf16 v[28:31], a[120:123], a[232:235], v[28:31]
    s_add_u32 s30, s24, 253952
    v_mul_f32 v19, v17, v19
    v_add_f32 v232, 1.0, v232
    v_mfma_f32_16x16x32_bf16 v[28:31], a[124:127], a[236:239], v[28:31]
    v_add_f32 v233, 1.0, v233
    v_mul_f32 v20, v20, v244
    v_mfma_f32_16x16x32_bf16 v[28:31], a[128:131], a[240:243], v[28:31]
    s_waitcnt lgkmcnt(0)
    v_rcp_f32 v232, v232
    v_mfma_f32_16x16x32_bf16 v[28:31], a[132:135], a[244:247], v[28:31]
    buffer_load_dwordx4 a[32:35], v3, s[4:7], s30 offen sc1
    v_mfma_f32_16x16x32_bf16 v[28:31], a[136:139], a[248:251], v[28:31]
    v_rcp_f32 v233, v233
    v_mfma_f32_16x16x32_bf16 v[28:31], a[140:143], a[252:255], v[28:31]
    s_add_u32 s30, s24, 258048
    v_mul_f32 v232, v18, v232
    v_mul_f32 v233, v19, v233
    v_mfma_f32_16x16x32_bf16 v[32:35], a[144:147], v[220:223], v[32:35]
    ds_read_b128 v[184:187], v4 offset:26624
    ds_read_b128 v[188:191], v4 offset:27648
    v_mfma_f32_16x16x32_bf16 v[32:35], a[148:151], v[224:227], v[32:35]
    ds_read_b128 v[192:195], v4 offset:28672
    v_cvt_pk_bf16_f32 v112, v232, v233
    v_mfma_f32_16x16x32_bf16 v[32:35], a[152:155], v[228:231], v[32:35]
    buffer_load_dwordx4 a[36:39], v3, s[4:7], s30 offen sc1
    v_mfma_f32_16x16x32_bf16 v[32:35], a[156:159], a[232:235], v[32:35]
    s_add_u32 m0, s26, 131072
    v_mul_f32 v21, v21, v244
    v_fma_f32 v234, -v20, v20, s29
    v_mfma_f32_16x16x32_bf16 v[32:35], a[160:163], a[236:239], v[32:35]
    s_add_u32 s31, s25, 103424
    v_fma_f32 v235, -v21, v21, s29
    v_mul_f32 v234, v234, v20
    v_mfma_f32_16x16x32_bf16 v[32:35], a[164:167], a[240:243], v[32:35]
    v_mul_f32 v235, v235, v21
    v_mul_f32 v22, v20, v22
    v_mfma_f32_16x16x32_bf16 v[32:35], a[168:171], a[244:247], v[32:35]
    buffer_load_dwordx4 v3, s[4:7], s31 offen sc1 lds
    v_mfma_f32_16x16x32_bf16 v[32:35], a[172:175], a[248:251], v[32:35]
    ds_read_b128 v[196:199], v4 offset:29696
    ds_read_b128 v[200:203], v4 offset:30720
    v_mfma_f32_16x16x32_bf16 v[32:35], a[176:179], a[252:255], v[32:35]
    s_add_u32 s30, s24, 262144
    ds_read_b128 v[204:207], v4 offset:31744
    v_mul_f32 v23, v21, v23
    v_mfma_f32_16x16x32_bf16 v[36:39], a[180:183], v[220:223], v[36:39]
    ds_read_b128 v[208:211], v4 offset:32768
    ds_read_b128 v[212:215], v4 offset:33792
    v_mfma_f32_16x16x32_bf16 v[36:39], a[184:187], v[224:227], v[36:39]
    ds_read_b128 v[216:219], v4 offset:34816
    v_mul_f32 v24, v24, v244
    v_mfma_f32_16x16x32_bf16 v[36:39], a[188:191], v[228:231], v[36:39]
    buffer_load_dwordx4 a[40:43], v3, s[4:7], s30 offen sc1
    v_mfma_f32_16x16x32_bf16 v[36:39], a[192:195], a[232:235], v[36:39]
    v_exp_f32 v234, v234
    v_mfma_f32_16x16x32_bf16 v[36:39], a[196:199], a[236:239], v[36:39]
    s_add_u32 s30, s24, 266240
    v_exp_f32 v235, v235
    v_mfma_f32_16x16x32_bf16 v[36:39], a[200:203], a[240:243], v[36:39]
    v_add_f32 v234, 1.0, v234
    v_add_f32 v235, 1.0, v235
    v_mfma_f32_16x16x32_bf16 v[36:39], a[204:207], a[244:247], v[36:39]
    buffer_load_dwordx4 a[44:47], v3, s[4:7], s30 offen sc1
    v_mfma_f32_16x16x32_bf16 v[36:39], a[208:211], a[248:251], v[36:39]
    s_add_u32 m0, s26, 135168
    v_rcp_f32 v234, v234
    v_mfma_f32_16x16x32_bf16 v[36:39], a[212:215], a[252:255], v[36:39]
    s_waitcnt lgkmcnt(3)
    v_rcp_f32 v235, v235
    v_mfma_f32_16x16x32_bf16 v[40:43], a[108:111], v[184:187], v[40:43]
    s_add_u32 s31, s18, 107520
    v_mul_f32 v234, v22, v234
    v_mul_f32 v235, v23, v235
    v_mfma_f32_16x16x32_bf16 v[40:43], a[112:115], v[188:191], v[40:43]
    buffer_load_dwordx4 v3, s[4:7], s31 offen sc1 lds
    v_mfma_f32_16x16x32_bf16 v[40:43], a[116:119], v[192:195], v[40:43]
    v_cvt_pk_bf16_f32 v113, v234, v235
    v_mul_f32 v25, v25, v244
    v_mfma_f32_16x16x32_bf16 v[40:43], a[120:123], v[196:199], v[40:43]
    v_fma_f32 v236, -v24, v24, s29
    v_fma_f32 v237, -v25, v25, s29
    v_mfma_f32_16x16x32_bf16 v[40:43], a[124:127], v[200:203], v[40:43]
    s_add_u32 s30, s24, 270336
    v_mul_f32 v236, v236, v24
    v_mul_f32 v237, v237, v25
    v_mfma_f32_16x16x32_bf16 v[40:43], a[128:131], v[204:207], v[40:43]
    s_waitcnt lgkmcnt(0)
    v_exp_f32 v236, v236
    v_mfma_f32_16x16x32_bf16 v[40:43], a[132:135], v[208:211], v[40:43]
    buffer_load_dwordx4 a[48:51], v3, s[4:7], s30 offen sc1
    v_mfma_f32_16x16x32_bf16 v[40:43], a[136:139], v[212:215], v[40:43]
    v_exp_f32 v237, v237
    v_mfma_f32_16x16x32_bf16 v[40:43], a[140:143], v[216:219], v[40:43]
    s_add_u32 m0, s26, 139264
    v_mul_f32 v26, v24, v26
    v_mul_f32 v27, v25, v27
    v_mfma_f32_16x16x32_bf16 v[44:47], a[144:147], v[184:187], v[44:47]
    s_add_u32 s31, s25, 139264
    ds_read_b128 v[220:223], v4 offset:35840
    ds_read_b128 v[224:227], v4 offset:36864
    v_mfma_f32_16x16x32_bf16 v[44:47], a[148:151], v[188:191], v[44:47]
    ds_read_b128 v[228:231], v4 offset:37888
    v_add_f32 v236, 1.0, v236
    v_mfma_f32_16x16x32_bf16 v[44:47], a[152:155], v[192:195], v[44:47]
    buffer_load_dwordx4 v3, s[4:7], s31 offen sc1 lds
    v_mfma_f32_16x16x32_bf16 v[44:47], a[156:159], v[196:199], v[44:47]
    v_add_f32 v237, 1.0, v237
    v_mul_f32 v28, v28, v245
    v_mfma_f32_16x16x32_bf16 v[44:47], a[160:163], v[200:203], v[44:47]
    s_add_u32 s30, s24, 274432
    v_rcp_f32 v236, v236
    v_mfma_f32_16x16x32_bf16 v[44:47], a[164:167], v[204:207], v[44:47]
    v_rcp_f32 v237, v237
    v_mfma_f32_16x16x32_bf16 v[44:47], a[168:171], v[208:211], v[44:47]
    buffer_load_dwordx4 a[52:55], v3, s[4:7], s30 offen sc1
    v_mfma_f32_16x16x32_bf16 v[44:47], a[172:175], v[212:215], v[44:47]
    s_waitcnt vmcnt(11)
    ds_read_b128 a[232:235], v4 offset:38912
    ds_read_b128 a[236:239], v4 offset:39936
    v_mfma_f32_16x16x32_bf16 v[44:47], a[176:179], v[216:219], v[44:47]
    s_barrier
    ds_read_b128 a[240:243], v4 offset:40960
    v_mul_f32 v236, v26, v236
    v_mfma_f32_16x16x32_bf16 v[48:51], a[180:183], v[184:187], v[48:51]
    s_add_u32 s30, s24, 278528
    ds_read_b128 a[244:247], v4 offset:41984
    ds_read_b128 a[248:251], v4 offset:43008
    v_mfma_f32_16x16x32_bf16 v[48:51], a[184:187], v[188:191], v[48:51]
    ds_read_b128 a[252:255], v4 offset:44032
    v_mul_f32 v237, v27, v237
    v_mfma_f32_16x16x32_bf16 v[48:51], a[188:191], v[192:195], v[48:51]
    buffer_load_dwordx4 a[56:59], v3, s[4:7], s30 offen sc1
    v_mfma_f32_16x16x32_bf16 v[48:51], a[192:195], v[196:199], v[48:51]
    s_add_u32 m0, s26, 143360
    v_cvt_pk_bf16_f32 v114, v236, v237
    v_mul_f32 v29, v29, v245
    v_mfma_f32_16x16x32_bf16 v[48:51], a[196:199], v[200:203], v[48:51]
    s_add_u32 s31, s25, 143360
    v_fma_f32 v238, -v28, v28, s29
    v_fma_f32 v239, -v29, v29, s29
    v_mfma_f32_16x16x32_bf16 v[48:51], a[200:203], v[204:207], v[48:51]
    v_mul_f32 v238, v238, v28
    v_mul_f32 v239, v239, v29
    v_mfma_f32_16x16x32_bf16 v[48:51], a[204:207], v[208:211], v[48:51]
    buffer_load_dwordx4 v3, s[4:7], s31 offen sc1 lds
    v_mfma_f32_16x16x32_bf16 v[48:51], a[208:211], v[212:215], v[48:51]
    v_exp_f32 v238, v238
    v_mfma_f32_16x16x32_bf16 v[48:51], a[212:215], v[216:219], v[48:51]
    s_waitcnt lgkmcnt(3)
    v_exp_f32 v239, v239
    v_mfma_f32_16x16x32_bf16 v[52:55], a[108:111], v[220:223], v[52:55]
    s_add_u32 s30, s24, 282624
    v_mul_f32 v30, v28, v30
    v_mul_f32 v31, v29, v31
    v_mfma_f32_16x16x32_bf16 v[52:55], a[112:115], v[224:227], v[52:55]
    v_add_f32 v238, 1.0, v238
    v_add_f32 v239, 1.0, v239
    v_mfma_f32_16x16x32_bf16 v[52:55], a[116:119], v[228:231], v[52:55]
    buffer_load_dwordx4 a[60:63], v3, s[4:7], s30 offen sc1
    v_mfma_f32_16x16x32_bf16 v[52:55], a[120:123], a[232:235], v[52:55]
    v_rcp_f32 v238, v238
    v_mfma_f32_16x16x32_bf16 v[52:55], a[124:127], a[236:239], v[52:55]
    v_rcp_f32 v239, v239
    v_mfma_f32_16x16x32_bf16 v[52:55], a[128:131], a[240:243], v[52:55]
    s_waitcnt lgkmcnt(0)
    v_mul_f32 v238, v30, v238
    v_mul_f32 v239, v31, v239
    v_mfma_f32_16x16x32_bf16 v[52:55], a[132:135], a[244:247], v[52:55]
    s_add_u32 s30, s24, 286720
    v_cvt_pk_bf16_f32 v116, v238, v239
    v_mul_f32 v32, v32, v245
    v_mfma_f32_16x16x32_bf16 v[52:55], a[136:139], a[248:251], v[52:55]
    buffer_load_dwordx4 a[64:67], v3, s[4:7], s30 offen sc1
    v_mfma_f32_16x16x32_bf16 v[52:55], a[140:143], a[252:255], v[52:55]
    v_mul_f32 v33, v33, v245
    v_fma_f32 v240, -v32, v32, s29
    v_mfma_f32_16x16x32_bf16 v[56:59], a[144:147], v[220:223], v[56:59]
    s_add_u32 s30, s24, 290816
    ds_read_b128 v[184:187], v4 offset:45056
    ds_read_b128 v[188:191], v4 offset:46080
    v_mfma_f32_16x16x32_bf16 v[56:59], a[148:151], v[224:227], v[56:59]
    ds_read_b128 v[192:195], v4 offset:47104
    v_fma_f32 v241, -v33, v33, s29
    v_mfma_f32_16x16x32_bf16 v[56:59], a[152:155], v[228:231], v[56:59]
    buffer_load_dwordx4 a[68:71], v3, s[4:7], s30 offen sc1
    v_mfma_f32_16x16x32_bf16 v[56:59], a[156:159], a[232:235], v[56:59]
    v_mul_f32 v240, v240, v32
    v_mul_f32 v241, v241, v33
    v_mfma_f32_16x16x32_bf16 v[56:59], a[160:163], a[236:239], v[56:59]
    v_exp_f32 v240, v240
    v_mfma_f32_16x16x32_bf16 v[56:59], a[164:167], a[240:243], v[56:59]
    s_add_u32 s30, s24, 294912
    v_exp_f32 v241, v241
    v_mfma_f32_16x16x32_bf16 v[56:59], a[168:171], a[244:247], v[56:59]
    v_mul_f32 v34, v32, v34
    v_mul_f32 v35, v33, v35
    v_mfma_f32_16x16x32_bf16 v[56:59], a[172:175], a[248:251], v[56:59]
    ds_read_b128 v[196:199], v4 offset:48128
    ds_read_b128 v[200:203], v4 offset:49152
    v_mfma_f32_16x16x32_bf16 v[56:59], a[176:179], a[252:255], v[56:59]
    ds_read_b128 v[204:207], v4 offset:50176
    v_add_f32 v240, 1.0, v240
    v_mfma_f32_16x16x32_bf16 v[60:63], a[180:183], v[220:223], v[60:63]
    ds_read_b128 v[208:211], v4 offset:51200
    ds_read_b128 v[212:215], v4 offset:52224
    v_mfma_f32_16x16x32_bf16 v[60:63], a[184:187], v[224:227], v[60:63]
    ds_read_b128 v[216:219], v4 offset:53248
    v_add_f32 v241, 1.0, v241
    v_mfma_f32_16x16x32_bf16 v[60:63], a[188:191], v[228:231], v[60:63]
    buffer_load_dwordx4 a[72:75], v3, s[4:7], s30 offen sc1
    v_mfma_f32_16x16x32_bf16 v[60:63], a[192:195], a[232:235], v[60:63]
    s_add_u32 s30, s24, 299008
    v_rcp_f32 v240, v240
    v_mfma_f32_16x16x32_bf16 v[60:63], a[196:199], a[236:239], v[60:63]
    v_rcp_f32 v241, v241
    v_mfma_f32_16x16x32_bf16 v[60:63], a[200:203], a[240:243], v[60:63]
    buffer_load_dwordx4 a[76:79], v3, s[4:7], s30 offen sc1
    v_mfma_f32_16x16x32_bf16 v[60:63], a[204:207], a[244:247], v[60:63]
    v_mul_f32 v240, v34, v240
    v_mul_f32 v241, v35, v241
    v_mfma_f32_16x16x32_bf16 v[60:63], a[208:211], a[248:251], v[60:63]
    s_add_u32 s30, s24, 303104
    v_cvt_pk_bf16_f32 v117, v240, v241
    v_mul_f32 v36, v36, v245
    v_mfma_f32_16x16x32_bf16 v[60:63], a[212:215], a[252:255], v[60:63]
    s_waitcnt lgkmcnt(3)
    v_mul_f32 v37, v37, v245
    v_fma_f32 v242, -v36, v36, s29
    v_mfma_f32_16x16x32_bf16 v[64:67], a[108:111], v[184:187], v[64:67]
    buffer_load_dwordx4 a[80:83], v3, s[4:7], s30 offen sc1
    v_mfma_f32_16x16x32_bf16 v[64:67], a[112:115], v[188:191], v[64:67]
    v_fma_f32 v243, -v37, v37, s29
    v_mul_f32 v242, v242, v36
    v_mfma_f32_16x16x32_bf16 v[64:67], a[116:119], v[192:195], v[64:67]
    v_mul_f32 v243, v243, v37
    v_mul_f32 v38, v36, v38
    v_mfma_f32_16x16x32_bf16 v[64:67], a[120:123], v[196:199], v[64:67]
    s_add_u32 s30, s24, 307200
    v_exp_f32 v242, v242
    v_mfma_f32_16x16x32_bf16 v[64:67], a[124:127], v[200:203], v[64:67]
    v_exp_f32 v243, v243
    v_mfma_f32_16x16x32_bf16 v[64:67], a[128:131], v[204:207], v[64:67]
    s_waitcnt lgkmcnt(0)
    v_mul_f32 v39, v37, v39
    v_add_f32 v242, 1.0, v242
    v_mfma_f32_16x16x32_bf16 v[64:67], a[132:135], v[208:211], v[64:67]
    buffer_load_dwordx4 a[84:87], v3, s[4:7], s30 offen sc1
    v_mfma_f32_16x16x32_bf16 v[64:67], a[136:139], v[212:215], v[64:67]
    s_add_u32 s30, s24, 311296
    v_add_f32 v243, 1.0, v243
    v_mul_f32 v40, v40, v246
    v_mfma_f32_16x16x32_bf16 v[64:67], a[140:143], v[216:219], v[64:67]
    v_rcp_f32 v242, v242
    v_mfma_f32_16x16x32_bf16 v[68:71], a[144:147], v[184:187], v[68:71]
    ds_read_b128 v[220:223], v4 offset:54272
    ds_read_b128 v[224:227], v4 offset:55296
    v_mfma_f32_16x16x32_bf16 v[68:71], a[148:151], v[188:191], v[68:71]
    ds_read_b128 v[228:231], v4 offset:56320
    v_mul_f32 v242, v38, v242
    v_mfma_f32_16x16x32_bf16 v[68:71], a[152:155], v[192:195], v[68:71]
    buffer_load_dwordx4 a[88:91], v3, s[4:7], s30 offen sc1
    v_mfma_f32_16x16x32_bf16 v[68:71], a[156:159], v[196:199], v[68:71]
    s_add_u32 s30, s24, 315392
    v_rcp_f32 v243, v243
    v_mfma_f32_16x16x32_bf16 v[68:71], a[160:163], v[200:203], v[68:71]
    v_mul_f32 v243, v39, v243
    v_mul_f32 v41, v41, v246
    v_mfma_f32_16x16x32_bf16 v[68:71], a[164:167], v[204:207], v[68:71]
    buffer_load_dwordx4 a[92:95], v3, s[4:7], s30 offen sc1
    v_mfma_f32_16x16x32_bf16 v[68:71], a[168:171], v[208:211], v[68:71]
    v_cvt_pk_bf16_f32 v118, v242, v243
    v_fma_f32 v232, -v40, v40, s29
    v_mfma_f32_16x16x32_bf16 v[68:71], a[172:175], v[212:215], v[68:71]
    s_waitcnt vmcnt(9)
    ds_read_b128 a[232:235], v4 offset:57344
    ds_read_b128 a[236:239], v4 offset:58368
    v_mfma_f32_16x16x32_bf16 v[68:71], a[176:179], v[216:219], v[68:71]
    s_add_u32 s30, s24, 319488
    ds_read_b128 a[240:243], v4 offset:59392
    v_fma_f32 v233, -v41, v41, s29
    v_mfma_f32_16x16x32_bf16 v[72:75], a[180:183], v[184:187], v[72:75]
    s_barrier
    ds_read_b128 a[244:247], v4 offset:60416
    ds_read_b128 a[248:251], v4 offset:61440
    v_mfma_f32_16x16x32_bf16 v[72:75], a[184:187], v[188:191], v[72:75]
    ds_read_b128 a[252:255], v4 offset:62464
    v_mul_f32 v232, v232, v40
    v_mfma_f32_16x16x32_bf16 v[72:75], a[188:191], v[192:195], v[72:75]
    buffer_load_dwordx4 a[96:99], v3, s[4:7], s30 offen sc1
    v_mfma_f32_16x16x32_bf16 v[72:75], a[192:195], v[196:199], v[72:75]
    s_add_u32 s30, s24, 323584
    v_mul_f32 v233, v233, v41
    v_mul_f32 v42, v40, v42
    v_mfma_f32_16x16x32_bf16 v[72:75], a[196:199], v[200:203], v[72:75]
    v_exp_f32 v232, v232
    v_mfma_f32_16x16x32_bf16 v[72:75], a[200:203], v[204:207], v[72:75]
    buffer_load_dwordx4 a[100:103], v3, s[4:7], s30 offen sc1
    v_mfma_f32_16x16x32_bf16 v[72:75], a[204:207], v[208:211], v[72:75]
    v_exp_f32 v233, v233
    v_mfma_f32_16x16x32_bf16 v[72:75], a[208:211], v[212:215], v[72:75]
    v_mul_f32 v43, v41, v43
    v_add_f32 v232, 1.0, v232
    v_mfma_f32_16x16x32_bf16 v[72:75], a[212:215], v[216:219], v[72:75]
    s_waitcnt lgkmcnt(3)
    v_add_f32 v233, 1.0, v233
    v_mul_f32 v44, v44, v246
    v_mfma_f32_16x16x32_bf16 v[76:79], a[108:111], v[220:223], v[76:79]
    s_add_u32 s30, s24, 327680
    v_rcp_f32 v232, v232
    v_mfma_f32_16x16x32_bf16 v[76:79], a[112:115], v[224:227], v[76:79]
    buffer_load_dwordx4 a[104:107], v3, s[4:7], s30 offen sc1
    v_mfma_f32_16x16x32_bf16 v[76:79], a[116:119], v[228:231], v[76:79]
    v_rcp_f32 v233, v233
    v_mfma_f32_16x16x32_bf16 v[76:79], a[120:123], a[232:235], v[76:79]
    v_mul_f32 v232, v42, v232
    v_mul_f32 v233, v43, v233
    v_mfma_f32_16x16x32_bf16 v[76:79], a[124:127], a[236:239], v[76:79]
    v_cvt_pk_bf16_f32 v120, v232, v233
    v_mul_f32 v45, v45, v246
    v_mfma_f32_16x16x32_bf16 v[76:79], a[128:131], a[240:243], v[76:79]
    s_waitcnt lgkmcnt(0)
    v_fma_f32 v234, -v44, v44, s29
    v_fma_f32 v235, -v45, v45, s29
    v_mfma_f32_16x16x32_bf16 v[76:79], a[132:135], a[244:247], v[76:79]
    v_mul_f32 v234, v234, v44
    v_mul_f32 v235, v235, v45
    v_mfma_f32_16x16x32_bf16 v[76:79], a[136:139], a[248:251], v[76:79]
    v_exp_f32 v234, v234
    v_mfma_f32_16x16x32_bf16 v[76:79], a[140:143], a[252:255], v[76:79]
    v_exp_f32 v235, v235
    v_mfma_f32_16x16x32_bf16 v[80:83], a[144:147], v[220:223], v[80:83]
    ds_read_b128 v[184:187], v4 offset:63488
    ds_read_b128 v[188:191], v4 offset:64512
    v_mfma_f32_16x16x32_bf16 v[80:83], a[148:151], v[224:227], v[80:83]
    ds_read_b128 v[192:195], v5 offset:0
    v_mul_f32 v46, v44, v46
    v_mfma_f32_16x16x32_bf16 v[80:83], a[152:155], v[228:231], v[80:83]
    v_mul_f32 v47, v45, v47
    v_add_f32 v234, 1.0, v234
    v_mfma_f32_16x16x32_bf16 v[80:83], a[156:159], a[232:235], v[80:83]
    v_add_f32 v235, 1.0, v235
    v_mul_f32 v48, v48, v246
    v_mfma_f32_16x16x32_bf16 v[80:83], a[160:163], a[236:239], v[80:83]
    v_rcp_f32 v234, v234
    v_mfma_f32_16x16x32_bf16 v[80:83], a[164:167], a[240:243], v[80:83]
    v_rcp_f32 v235, v235
    v_mfma_f32_16x16x32_bf16 v[80:83], a[168:171], a[244:247], v[80:83]
    v_mul_f32 v234, v46, v234
    v_mul_f32 v235, v47, v235
    v_mfma_f32_16x16x32_bf16 v[80:83], a[172:175], a[248:251], v[80:83]
    ds_read_b128 v[196:199], v5 offset:1024
    ds_read_b128 v[200:203], v5 offset:2048
    v_mfma_f32_16x16x32_bf16 v[80:83], a[176:179], a[252:255], v[80:83]
    ds_read_b128 v[204:207], v5 offset:3072
    v_cvt_pk_bf16_f32 v121, v234, v235
    v_mfma_f32_16x16x32_bf16 v[84:87], a[180:183], v[220:223], v[84:87]
    ds_read_b128 v[208:211], v5 offset:4096
    ds_read_b128 v[212:215], v5 offset:5120
    v_mfma_f32_16x16x32_bf16 v[84:87], a[184:187], v[224:227], v[84:87]
    ds_read_b128 v[216:219], v5 offset:6144
    v_mul_f32 v49, v49, v246
    v_mfma_f32_16x16x32_bf16 v[84:87], a[188:191], v[228:231], v[84:87]
    v_fma_f32 v236, -v48, v48, s29
    v_fma_f32 v237, -v49, v49, s29
    v_mfma_f32_16x16x32_bf16 v[84:87], a[192:195], a[232:235], v[84:87]
    v_mul_f32 v236, v236, v48
    v_mul_f32 v237, v237, v49
    v_mfma_f32_16x16x32_bf16 v[84:87], a[196:199], a[236:239], v[84:87]
    v_exp_f32 v236, v236
    v_mfma_f32_16x16x32_bf16 v[84:87], a[200:203], a[240:243], v[84:87]
    v_exp_f32 v237, v237
    v_mfma_f32_16x16x32_bf16 v[84:87], a[204:207], a[244:247], v[84:87]
    v_mul_f32 v50, v48, v50
    v_mul_f32 v51, v49, v51
    v_mfma_f32_16x16x32_bf16 v[84:87], a[208:211], a[248:251], v[84:87]
    v_add_f32 v236, 1.0, v236
    v_add_f32 v237, 1.0, v237
    v_mfma_f32_16x16x32_bf16 v[84:87], a[212:215], a[252:255], v[84:87]
    s_waitcnt lgkmcnt(3)
    v_rcp_f32 v236, v236
    v_mfma_f32_16x16x32_bf16 v[88:91], a[108:111], v[184:187], v[88:91]
    v_rcp_f32 v237, v237
    v_mfma_f32_16x16x32_bf16 v[88:91], a[112:115], v[188:191], v[88:91]
    v_mul_f32 v236, v50, v236
    v_mul_f32 v237, v51, v237
    v_mfma_f32_16x16x32_bf16 v[88:91], a[116:119], v[192:195], v[88:91]
    v_cvt_pk_bf16_f32 v122, v236, v237
    v_mul_f32 v52, v52, v247
    v_mfma_f32_16x16x32_bf16 v[88:91], a[120:123], v[196:199], v[88:91]
    v_mul_f32 v53, v53, v247
    v_fma_f32 v238, -v52, v52, s29
    v_mfma_f32_16x16x32_bf16 v[88:91], a[124:127], v[200:203], v[88:91]
    v_fma_f32 v239, -v53, v53, s29
    v_mul_f32 v238, v238, v52
    v_mfma_f32_16x16x32_bf16 v[88:91], a[128:131], v[204:207], v[88:91]
    s_waitcnt lgkmcnt(0)
    v_mul_f32 v239, v239, v53
    v_mul_f32 v54, v52, v54
    v_mfma_f32_16x16x32_bf16 v[88:91], a[132:135], v[208:211], v[88:91]
ffn1_part_pad0_3x:
    s_cbranch_execz ffn1_part_pad0_7x
    v_exp_f32 v238, v238
    v_mfma_f32_16x16x32_bf16 v[88:91], a[136:139], v[212:215], v[88:91]
    v_exp_f32 v239, v239
    v_mfma_f32_16x16x32_bf16 v[88:91], a[140:143], v[216:219], v[88:91]
    v_mul_f32 v55, v53, v55
    v_add_f32 v238, 1.0, v238
    v_mfma_f32_16x16x32_bf16 v[92:95], a[144:147], v[184:187], v[92:95]
    ds_read_b128 v[220:223], v5 offset:7168
    ds_read_b128 v[224:227], v5 offset:8192
    v_mfma_f32_16x16x32_bf16 v[92:95], a[148:151], v[188:191], v[92:95]
    ds_read_b128 v[228:231], v5 offset:9216
    v_add_f32 v239, 1.0, v239
    v_mfma_f32_16x16x32_bf16 v[92:95], a[152:155], v[192:195], v[92:95]
    v_rcp_f32 v238, v238
    v_mfma_f32_16x16x32_bf16 v[92:95], a[156:159], v[196:199], v[92:95]
    v_rcp_f32 v239, v239
    v_mfma_f32_16x16x32_bf16 v[92:95], a[160:163], v[200:203], v[92:95]
    v_mul_f32 v238, v54, v238
    v_mul_f32 v239, v55, v239
    v_mfma_f32_16x16x32_bf16 v[92:95], a[164:167], v[204:207], v[92:95]
    v_cvt_pk_bf16_f32 v124, v238, v239
    v_mul_f32 v56, v56, v247
    v_mfma_f32_16x16x32_bf16 v[92:95], a[168:171], v[208:211], v[92:95]
    v_mul_f32 v57, v57, v247
    v_fma_f32 v240, -v56, v56, s29
    v_mfma_f32_16x16x32_bf16 v[92:95], a[172:175], v[212:215], v[92:95]
    ds_read_b128 a[232:235], v5 offset:10240
    ds_read_b128 a[236:239], v5 offset:11264
    v_mfma_f32_16x16x32_bf16 v[92:95], a[176:179], v[216:219], v[92:95]
    ds_read_b128 a[240:243], v5 offset:12288
    v_fma_f32 v241, -v57, v57, s29
    v_mfma_f32_16x16x32_bf16 v[96:99], a[180:183], v[184:187], v[96:99]
    ds_read_b128 a[244:247], v5 offset:13312
    ds_read_b128 a[248:251], v5 offset:14336
    v_mfma_f32_16x16x32_bf16 v[96:99], a[184:187], v[188:191], v[96:99]
    ds_read_b128 a[252:255], v5 offset:15360
    v_mul_f32 v240, v240, v56
    v_mfma_f32_16x16x32_bf16 v[96:99], a[188:191], v[192:195], v[96:99]
    v_mul_f32 v241, v241, v57
    v_mul_f32 v58, v56, v58
    v_mfma_f32_16x16x32_bf16 v[96:99], a[192:195], v[196:199], v[96:99]
    v_exp_f32 v240, v240
    v_mfma_f32_16x16x32_bf16 v[96:99], a[196:199], v[200:203], v[96:99]
    v_exp_f32 v241, v241
    v_mfma_f32_16x16x32_bf16 v[96:99], a[200:203], v[204:207], v[96:99]
    v_mul_f32 v59, v57, v59
    v_add_f32 v240, 1.0, v240
    v_mfma_f32_16x16x32_bf16 v[96:99], a[204:207], v[208:211], v[96:99]
    v_add_f32 v241, 1.0, v241
    v_mul_f32 v60, v60, v247
    v_mfma_f32_16x16x32_bf16 v[96:99], a[208:211], v[212:215], v[96:99]
    v_rcp_f32 v240, v240
    v_mfma_f32_16x16x32_bf16 v[96:99], a[212:215], v[216:219], v[96:99]
    s_waitcnt lgkmcnt(3)
    v_rcp_f32 v241, v241
    v_mfma_f32_16x16x32_bf16 v[100:103], a[108:111], v[220:223], v[100:103]
    v_mul_f32 v240, v58, v240
    v_mul_f32 v241, v59, v241
    v_mfma_f32_16x16x32_bf16 v[100:103], a[112:115], v[224:227], v[100:103]
    v_cvt_pk_bf16_f32 v125, v240, v241
    v_mul_f32 v61, v61, v247
    v_mfma_f32_16x16x32_bf16 v[100:103], a[116:119], v[228:231], v[100:103]
    v_fma_f32 v242, -v60, v60, s29
    v_fma_f32 v243, -v61, v61, s29
    v_mfma_f32_16x16x32_bf16 v[100:103], a[120:123], a[232:235], v[100:103]
    v_mul_f32 v242, v242, v60
    v_mul_f32 v243, v243, v61
    v_mfma_f32_16x16x32_bf16 v[100:103], a[124:127], a[236:239], v[100:103]
    v_exp_f32 v242, v242
    v_mfma_f32_16x16x32_bf16 v[100:103], a[128:131], a[240:243], v[100:103]
    s_waitcnt lgkmcnt(0)
    v_exp_f32 v243, v243
    v_mfma_f32_16x16x32_bf16 v[100:103], a[132:135], a[244:247], v[100:103]
    v_mul_f32 v62, v60, v62
    v_mul_f32 v63, v61, v63
    v_mfma_f32_16x16x32_bf16 v[100:103], a[136:139], a[248:251], v[100:103]
    v_add_f32 v242, 1.0, v242
    v_add_f32 v243, 1.0, v243
    v_mfma_f32_16x16x32_bf16 v[100:103], a[140:143], a[252:255], v[100:103]
    v_rcp_f32 v242, v242
    v_mfma_f32_16x16x32_bf16 v[104:107], a[144:147], v[220:223], v[104:107]
    ds_read_b128 v[184:187], v1 offset:0
    ds_read_b128 v[188:191], v1 offset:1024
    v_mfma_f32_16x16x32_bf16 v[104:107], a[148:151], v[224:227], v[104:107]
    ds_read_b128 v[192:195], v1 offset:2048
    v_mul_f32 v242, v62, v242
    v_mfma_f32_16x16x32_bf16 v[104:107], a[152:155], v[228:231], v[104:107]
    v_rcp_f32 v243, v243
    v_mfma_f32_16x16x32_bf16 v[104:107], a[156:159], a[232:235], v[104:107]
    v_mul_f32 v243, v63, v243
    v_mul_f32 v64, v64, v248
    v_mfma_f32_16x16x32_bf16 v[104:107], a[160:163], a[236:239], v[104:107]
    v_cvt_pk_bf16_f32 v126, v242, v243
    v_mul_f32 v65, v65, v248
    v_mfma_f32_16x16x32_bf16 v[104:107], a[164:167], a[240:243], v[104:107]
    v_fma_f32 v232, -v64, v64, s29
    v_fma_f32 v233, -v65, v65, s29
    v_mfma_f32_16x16x32_bf16 v[104:107], a[168:171], a[244:247], v[104:107]
    v_mul_f32 v232, v232, v64
    v_mul_f32 v233, v233, v65
    v_mfma_f32_16x16x32_bf16 v[104:107], a[172:175], a[248:251], v[104:107]
    ds_read_b128 v[196:199], v1 offset:3072
    ds_read_b128 v[200:203], v1 offset:4096
    v_mfma_f32_16x16x32_bf16 v[104:107], a[176:179], a[252:255], v[104:107]
    ds_read_b128 v[204:207], v1 offset:5120
    v_mul_f32 v66, v64, v66
    v_mfma_f32_16x16x32_bf16 v[108:111], a[180:183], v[220:223], v[108:111]
    ds_read_b128 v[208:211], v1 offset:6144
    ds_read_b128 v[212:215], v1 offset:7168
    v_mfma_f32_16x16x32_bf16 v[108:111], a[184:187], v[224:227], v[108:111]
    ds_read_b128 v[216:219], v1 offset:8192
    v_mul_f32 v67, v65, v67
    v_mfma_f32_16x16x32_bf16 v[108:111], a[188:191], v[228:231], v[108:111]
    v_exp_f32 v232, v232
    v_mfma_f32_16x16x32_bf16 v[108:111], a[192:195], a[232:235], v[108:111]
    v_exp_f32 v233, v233
    v_mfma_f32_16x16x32_bf16 v[108:111], a[196:199], a[236:239], v[108:111]
    v_add_f32 v232, 1.0, v232
    v_add_f32 v233, 1.0, v233
    v_mfma_f32_16x16x32_bf16 v[108:111], a[200:203], a[240:243], v[108:111]
    v_rcp_f32 v232, v232
    v_mfma_f32_16x16x32_bf16 v[108:111], a[204:207], a[244:247], v[108:111]
    v_rcp_f32 v233, v233
    v_mfma_f32_16x16x32_bf16 v[108:111], a[208:211], a[248:251], v[108:111]
    s_add_u32 s30, s24, 331776
    v_mul_f32 v232, v66, v232
    v_mul_f32 v233, v67, v233
    v_mfma_f32_16x16x32_bf16 v[108:111], a[212:215], a[252:255], v[108:111]
    s_waitcnt lgkmcnt(3)
    v_cvt_pk_bf16_f32 v128, v232, v233
    v_mul_f32 v68, v68, v248
    v_mfma_f32_16x16x32_bf16 v[16:19], a[0:3], v[184:187], 0
    buffer_load_dwordx4 a[108:111], v3, s[4:7], s30 offen sc1
    v_mfma_f32_16x16x32_bf16 v[16:19], a[4:7], v[188:191], v[16:19]
    v_mul_f32 v69, v69, v248
    v_fma_f32 v234, -v68, v68, s29
    v_mfma_f32_16x16x32_bf16 v[16:19], a[8:11], v[192:195], v[16:19]
    s_add_u32 s30, s24, 335872
    v_fma_f32 v235, -v69, v69, s29
    v_mul_f32 v234, v234, v68
    v_mfma_f32_16x16x32_bf16 v[16:19], a[12:15], v[196:199], v[16:19]
    v_mul_f32 v235, v235, v69
    v_mul_f32 v70, v68, v70
    v_mfma_f32_16x16x32_bf16 v[16:19], a[16:19], v[200:203], v[16:19]
    buffer_load_dwordx4 a[112:115], v3, s[4:7], s30 offen sc1
    v_mfma_f32_16x16x32_bf16 v[16:19], a[20:23], v[204:207], v[16:19]
    s_waitcnt lgkmcnt(0)
    v_exp_f32 v234, v234
    v_mfma_f32_16x16x32_bf16 v[16:19], a[24:27], v[208:211], v[16:19]
    v_exp_f32 v235, v235
    v_mfma_f32_16x16x32_bf16 v[16:19], a[28:31], v[212:215], v[16:19]
    s_add_u32 s30, s24, 339968
    v_mul_f32 v71, v69, v71
    v_add_f32 v234, 1.0, v234
    v_mfma_f32_16x16x32_bf16 v[16:19], a[32:35], v[216:219], v[16:19]
    s_waitcnt vmcnt(11)
    v_add_f32 v235, 1.0, v235
    v_mul_f32 v72, v72, v248
    v_mfma_f32_16x16x32_bf16 v[20:23], a[36:39], v[184:187], 0
    ds_read_b128 v[220:223], v1 offset:9216
    ds_read_b128 v[224:227], v1 offset:10240
    v_mfma_f32_16x16x32_bf16 v[20:23], a[40:43], v[188:191], v[20:23]
    ds_read_b128 v[228:231], v1 offset:11264
    v_mul_f32 v73, v73, v248
    v_mfma_f32_16x16x32_bf16 v[20:23], a[44:47], v[192:195], v[20:23]
    buffer_load_dwordx4 a[116:119], v3, s[4:7], s30 offen sc1
    v_mfma_f32_16x16x32_bf16 v[20:23], a[48:51], v[196:199], v[20:23]
    v_rcp_f32 v234, v234
    v_mfma_f32_16x16x32_bf16 v[20:23], a[52:55], v[200:203], v[20:23]
    s_add_u32 s30, s24, 344064
    v_rcp_f32 v235, v235
    v_mfma_f32_16x16x32_bf16 v[20:23], a[56:59], v[204:207], v[20:23]
    v_mul_f32 v234, v70, v234
    v_mul_f32 v235, v71, v235
    v_mfma_f32_16x16x32_bf16 v[20:23], a[60:63], v[208:211], v[20:23]
    buffer_load_dwordx4 a[120:123], v3, s[4:7], s30 offen sc1
    v_mfma_f32_16x16x32_bf16 v[20:23], a[64:67], v[212:215], v[20:23]
    ds_read_b128 a[232:235], v1 offset:12288
    ds_read_b128 a[236:239], v1 offset:13312
    v_mfma_f32_16x16x32_bf16 v[20:23], a[68:71], v[216:219], v[20:23]
    s_waitcnt vmcnt(4)
    ds_read_b128 a[240:243], v1 offset:14336
    v_cvt_pk_bf16_f32 v129, v234, v235
    v_mfma_f32_16x16x32_bf16 v[24:27], a[72:75], v[184:187], 0
    s_add_u32 s30, s24, 348160
    ds_read_b128 a[244:247], v1 offset:15360
    ds_read_b128 a[248:251], v1 offset:16384
    v_mfma_f32_16x16x32_bf16 v[24:27], a[76:79], v[188:191], v[24:27]
    ds_read_b128 a[252:255], v1 offset:17408
    v_fma_f32 v236, -v72, v72, s29
    v_mfma_f32_16x16x32_bf16 v[24:27], a[80:83], v[192:195], v[24:27]
    buffer_load_dwordx4 a[124:127], v3, s[4:7], s30 offen sc1
    v_mfma_f32_16x16x32_bf16 v[24:27], a[84:87], v[196:199], v[24:27]
    v_fma_f32 v237, -v73, v73, s29
    v_mul_f32 v236, v236, v72
    v_mfma_f32_16x16x32_bf16 v[24:27], a[88:91], v[200:203], v[24:27]
    v_mul_f32 v237, v237, v73
    v_mul_f32 v74, v72, v74
    v_mfma_f32_16x16x32_bf16 v[24:27], a[92:95], v[204:207], v[24:27]
    v_exp_f32 v236, v236
    v_mfma_f32_16x16x32_bf16 v[24:27], a[96:99], v[208:211], v[24:27]
    s_add_u32 s30, s24, 352256
    v_exp_f32 v237, v237
    v_mfma_f32_16x16x32_bf16 v[24:27], a[100:103], v[212:215], v[24:27]
    v_mul_f32 v75, v73, v75
    v_add_f32 v236, 1.0, v236
    v_mfma_f32_16x16x32_bf16 v[24:27], a[104:107], v[216:219], v[24:27]
    s_waitcnt lgkmcnt(3)
    v_add_f32 v237, 1.0, v237
    v_mul_f32 v76, v76, v249
    v_mfma_f32_16x16x32_bf16 v[28:31], a[0:3], v[220:223], 0
    buffer_load_dwordx4 a[128:131], v3, s[4:7], s30 offen sc1
    v_mfma_f32_16x16x32_bf16 v[28:31], a[4:7], v[224:227], v[28:31]
    v_rcp_f32 v236, v236
    v_mfma_f32_16x16x32_bf16 v[28:31], a[8:11], v[228:231], v[28:31]
    s_add_u32 s30, s24, 356352
    v_rcp_f32 v237, v237
    v_mfma_f32_16x16x32_bf16 v[28:31], a[12:15], a[232:235], v[28:31]
    v_mul_f32 v236, v74, v236
    v_mul_f32 v237, v75, v237
    v_mfma_f32_16x16x32_bf16 v[28:31], a[16:19], a[236:239], v[28:31]
    buffer_load_dwordx4 a[132:135], v3, s[4:7], s30 offen sc1
    v_mfma_f32_16x16x32_bf16 v[28:31], a[20:23], a[240:243], v[28:31]
    s_waitcnt lgkmcnt(0)
    v_cvt_pk_bf16_f32 v130, v236, v237
    v_mul_f32 v77, v77, v249
    v_mfma_f32_16x16x32_bf16 v[28:31], a[24:27], a[244:247], v[28:31]
    v_fma_f32 v238, -v76, v76, s29
    v_fma_f32 v239, -v77, v77, s29
    v_mfma_f32_16x16x32_bf16 v[28:31], a[28:31], a[248:251], v[28:31]
    v_mul_f32 v238, v238, v76
    v_mul_f32 v239, v239, v77
    v_mfma_f32_16x16x32_bf16 v[28:31], a[32:35], a[252:255], v[28:31]
    s_add_u32 s30, s24, 360448
    v_exp_f32 v238, v238
    v_mfma_f32_16x16x32_bf16 v[32:35], a[36:39], v[220:223], 0
    ds_read_b128 v[184:187], v1 offset:18432
    ds_read_b128 v[188:191], v1 offset:19456
    v_mfma_f32_16x16x32_bf16 v[32:35], a[40:43], v[224:227], v[32:35]
    ds_read_b128 v[192:195], v1 offset:20480
    v_mul_f32 v78, v76, v78
    v_mfma_f32_16x16x32_bf16 v[32:35], a[44:47], v[228:231], v[32:35]
    buffer_load_dwordx4 a[136:139], v3, s[4:7], s30 offen sc1
    v_mfma_f32_16x16x32_bf16 v[32:35], a[48:51], a[232:235], v[32:35]
    v_exp_f32 v239, v239
    v_mfma_f32_16x16x32_bf16 v[32:35], a[52:55], a[236:239], v[32:35]
    s_add_u32 s30, s24, 364544
    v_mul_f32 v79, v77, v79
    v_add_f32 v238, 1.0, v238
    v_mfma_f32_16x16x32_bf16 v[32:35], a[56:59], a[240:243], v[32:35]
    v_add_f32 v239, 1.0, v239
    v_mul_f32 v80, v80, v249
    v_mfma_f32_16x16x32_bf16 v[32:35], a[60:63], a[244:247], v[32:35]
    buffer_load_dwordx4 a[140:143], v3, s[4:7], s30 offen sc1
    v_mfma_f32_16x16x32_bf16 v[32:35], a[64:67], a[248:251], v[32:35]
    ds_read_b128 v[196:199], v1 offset:21504
    ds_read_b128 v[200:203], v1 offset:22528
    v_mfma_f32_16x16x32_bf16 v[32:35], a[68:71], a[252:255], v[32:35]
    ds_read_b128 v[204:207], v1 offset:23552
    v_mul_f32 v81, v81, v249
    v_mfma_f32_16x16x32_bf16 v[36:39], a[72:75], v[220:223], 0
    ds_read_b128 v[208:211], v1 offset:24576
    ds_read_b128 v[212:215], v1 offset:25600
    v_mfma_f32_16x16x32_bf16 v[36:39], a[76:79], v[224:227], v[36:39]
    s_add_u32 s30, s24, 368640
    ds_read_b128 v[216:219], v1 offset:26624
    v_fma_f32 v240, -v80, v80, s29
    v_mfma_f32_16x16x32_bf16 v[36:39], a[80:83], v[228:231], v[36:39]
    v_rcp_f32 v238, v238
    v_mfma_f32_16x16x32_bf16 v[36:39], a[84:87], a[232:235], v[36:39]
    buffer_load_dwordx4 a[144:147], v3, s[4:7], s30 offen sc1
    v_mfma_f32_16x16x32_bf16 v[36:39], a[88:91], a[236:239], v[36:39]
    v_rcp_f32 v239, v239
    v_mfma_f32_16x16x32_bf16 v[36:39], a[92:95], a[240:243], v[36:39]
    v_mul_f32 v238, v78, v238
    v_mul_f32 v239, v79, v239
    v_mfma_f32_16x16x32_bf16 v[36:39], a[96:99], a[244:247], v[36:39]
    s_add_u32 s30, s24, 372736
    v_cvt_pk_bf16_f32 v132, v238, v239
    v_fma_f32 v241, -v81, v81, s29
    v_mfma_f32_16x16x32_bf16 v[36:39], a[100:103], a[248:251], v[36:39]
    v_mul_f32 v240, v240, v80
    v_mul_f32 v241, v241, v81
    v_mfma_f32_16x16x32_bf16 v[36:39], a[104:107], a[252:255], v[36:39]
    s_waitcnt lgkmcnt(3)
    v_exp_f32 v240, v240
    v_mfma_f32_16x16x32_bf16 v[40:43], a[0:3], v[184:187], 0
    buffer_load_dwordx4 a[148:151], v3, s[4:7], s30 offen sc1
    v_mfma_f32_16x16x32_bf16 v[40:43], a[4:7], v[188:191], v[40:43]
    v_exp_f32 v241, v241
    v_mfma_f32_16x16x32_bf16 v[40:43], a[8:11], v[192:195], v[40:43]
    v_mul_f32 v82, v80, v82
    v_mul_f32 v83, v81, v83
    v_mfma_f32_16x16x32_bf16 v[40:43], a[12:15], v[196:199], v[40:43]
    s_add_u32 s30, s24, 376832
    v_add_f32 v240, 1.0, v240
    v_add_f32 v241, 1.0, v241
    v_mfma_f32_16x16x32_bf16 v[40:43], a[16:19], v[200:203], v[40:43]
    v_rcp_f32 v240, v240
    v_mfma_f32_16x16x32_bf16 v[40:43], a[20:23], v[204:207], v[40:43]
    s_waitcnt lgkmcnt(0)
    v_rcp_f32 v241, v241
    v_mfma_f32_16x16x32_bf16 v[40:43], a[24:27], v[208:211], v[40:43]
    buffer_load_dwordx4 a[152:155], v3, s[4:7], s30 offen sc1
    v_mfma_f32_16x16x32_bf16 v[40:43], a[28:31], v[212:215], v[40:43]
    v_mul_f32 v240, v82, v240
    v_mul_f32 v241, v83, v241
    v_mfma_f32_16x16x32_bf16 v[40:43], a[32:35], v[216:219], v[40:43]
    s_add_u32 s30, s24, 380928
    v_cvt_pk_bf16_f32 v133, v240, v241
    v_mul_f32 v84, v84, v249
    v_mfma_f32_16x16x32_bf16 v[44:47], a[36:39], v[184:187], 0
    ds_read_b128 v[220:223], v1 offset:27648
    ds_read_b128 v[224:227], v1 offset:28672
    v_mfma_f32_16x16x32_bf16 v[44:47], a[40:43], v[188:191], v[44:47]
    ds_read_b128 v[228:231], v1 offset:29696
    v_mul_f32 v85, v85, v249
    v_mfma_f32_16x16x32_bf16 v[44:47], a[44:47], v[192:195], v[44:47]
    buffer_load_dwordx4 a[156:159], v3, s[4:7], s30 offen sc1
    v_mfma_f32_16x16x32_bf16 v[44:47], a[48:51], v[196:199], v[44:47]
    v_fma_f32 v242, -v84, v84, s29
    v_fma_f32 v243, -v85, v85, s29
    v_mfma_f32_16x16x32_bf16 v[44:47], a[52:55], v[200:203], v[44:47]
    v_mul_f32 v242, v242, v84
    v_mul_f32 v243, v243, v85
    v_mfma_f32_16x16x32_bf16 v[44:47], a[56:59], v[204:207], v[44:47]
    s_add_u32 s30, s24, 385024
    v_exp_f32 v242, v242
    v_mfma_f32_16x16x32_bf16 v[44:47], a[60:63], v[208:211], v[44:47]
    global_load_dword v255, v13, s[10:11]
    v_mfma_f32_16x16x32_bf16 v[44:47], a[64:67], v[212:215], v[44:47]
    ds_read_b128 a[232:235], v1 offset:30720
    ds_read_b128 a[236:239], v1 offset:31744
    v_mfma_f32_16x16x32_bf16 v[44:47], a[68:71], v[216:219], v[44:47]
    ds_read_b128 a[240:243], v1 offset:32768
    v_mul_f32 v86, v84, v86
    v_mfma_f32_16x16x32_bf16 v[48:51], a[72:75], v[184:187], 0
    ds_read_b128 a[244:247], v1 offset:33792
    ds_read_b128 a[248:251], v1 offset:34816
    v_mfma_f32_16x16x32_bf16 v[48:51], a[76:79], v[188:191], v[48:51]
    ds_read_b128 a[252:255], v1 offset:35840
    v_mul_f32 v87, v85, v87
    v_mfma_f32_16x16x32_bf16 v[48:51], a[80:83], v[192:195], v[48:51]
    buffer_load_dwordx4 a[160:163], v3, s[4:7], s30 offen sc1
    v_mfma_f32_16x16x32_bf16 v[48:51], a[84:87], v[196:199], v[48:51]
    v_exp_f32 v243, v243
    v_mfma_f32_16x16x32_bf16 v[48:51], a[88:91], v[200:203], v[48:51]
    s_add_u32 s30, s24, 389120
    v_add_f32 v242, 1.0, v242
    v_add_f32 v243, 1.0, v243
    v_mfma_f32_16x16x32_bf16 v[48:51], a[92:95], v[204:207], v[48:51]
    v_rcp_f32 v242, v242
    v_mfma_f32_16x16x32_bf16 v[48:51], a[96:99], v[208:211], v[48:51]
    buffer_load_dwordx4 a[164:167], v3, s[4:7], s30 offen sc1
    v_mfma_f32_16x16x32_bf16 v[48:51], a[100:103], v[212:215], v[48:51]
    v_rcp_f32 v243, v243
    v_mfma_f32_16x16x32_bf16 v[48:51], a[104:107], v[216:219], v[48:51]
    s_waitcnt lgkmcnt(3)
    v_mul_f32 v242, v86, v242
    v_mul_f32 v243, v87, v243
    v_mfma_f32_16x16x32_bf16 v[52:55], a[0:3], v[220:223], 0
    s_add_u32 s30, s24, 393216
    v_cvt_pk_bf16_f32 v134, v242, v243
    v_mul_f32 v88, v88, v250
    v_mfma_f32_16x16x32_bf16 v[52:55], a[4:7], v[224:227], v[52:55]
    v_mul_f32 v89, v89, v250
    v_fma_f32 v232, -v88, v88, s29
    v_mfma_f32_16x16x32_bf16 v[52:55], a[8:11], v[228:231], v[52:55]
    buffer_load_dwordx4 a[168:171], v3, s[4:7], s30 offen sc1
    v_mfma_f32_16x16x32_bf16 v[52:55], a[12:15], a[232:235], v[52:55]
    v_fma_f32 v233, -v89, v89, s29
    v_mul_f32 v232, v232, v88
    v_mfma_f32_16x16x32_bf16 v[52:55], a[16:19], a[236:239], v[52:55]
    v_mul_f32 v233, v233, v89
    v_mul_f32 v90, v88, v90
    v_mfma_f32_16x16x32_bf16 v[52:55], a[20:23], a[240:243], v[52:55]
    s_waitcnt lgkmcnt(0)
    v_exp_f32 v232, v232
    v_mfma_f32_16x16x32_bf16 v[52:55], a[24:27], a[244:247], v[52:55]
    s_add_u32 s30, s24, 397312
    v_exp_f32 v233, v233
    v_mfma_f32_16x16x32_bf16 v[52:55], a[28:31], a[248:251], v[52:55]
    v_mul_f32 v91, v89, v91
    v_add_f32 v232, 1.0, v232
    v_mfma_f32_16x16x32_bf16 v[52:55], a[32:35], a[252:255], v[52:55]
    buffer_load_dwordx4 a[172:175], v3, s[4:7], s30 offen sc1
    v_mfma_f32_16x16x32_bf16 v[56:59], a[36:39], v[220:223], 0
    ds_read_b128 v[184:187], v1 offset:36864
    ds_read_b128 v[188:191], v1 offset:37888
    v_mfma_f32_16x16x32_bf16 v[56:59], a[40:43], v[224:227], v[56:59]
    ds_read_b128 v[192:195], v1 offset:38912
    v_add_f32 v233, 1.0, v233
    v_mfma_f32_16x16x32_bf16 v[56:59], a[44:47], v[228:231], v[56:59]
    s_add_u32 s30, s24, 401408
    v_rcp_f32 v232, v232
    v_mfma_f32_16x16x32_bf16 v[56:59], a[48:51], a[232:235], v[56:59]
    v_rcp_f32 v233, v233
    v_mfma_f32_16x16x32_bf16 v[56:59], a[52:55], a[236:239], v[56:59]
    buffer_load_dwordx4 a[176:179], v3, s[4:7], s30 offen sc1
    v_mfma_f32_16x16x32_bf16 v[56:59], a[56:59], a[240:243], v[56:59]
    v_mul_f32 v232, v90, v232
    v_mul_f32 v233, v91, v233
    v_mfma_f32_16x16x32_bf16 v[56:59], a[60:63], a[244:247], v[56:59]
    v_cvt_pk_bf16_f32 v136, v232, v233
    v_mul_f32 v92, v92, v250
    v_mfma_f32_16x16x32_bf16 v[56:59], a[64:67], a[248:251], v[56:59]
    ds_read_b128 v[196:199], v1 offset:39936
    ds_read_b128 v[200:203], v1 offset:40960
    v_mfma_f32_16x16x32_bf16 v[56:59], a[68:71], a[252:255], v[56:59]
    s_add_u32 s30, s24, 405504
    ds_read_b128 v[204:207], v1 offset:41984
    v_mul_f32 v93, v93, v250
    v_mfma_f32_16x16x32_bf16 v[60:63], a[72:75], v[220:223], 0
    ds_read_b128 v[208:211], v1 offset:43008
    ds_read_b128 v[212:215], v1 offset:44032
    v_mfma_f32_16x16x32_bf16 v[60:63], a[76:79], v[224:227], v[60:63]
    ds_read_b128 v[216:219], v1 offset:45056
    v_fma_f32 v234, -v92, v92, s29
    v_mfma_f32_16x16x32_bf16 v[60:63], a[80:83], v[228:231], v[60:63]
    buffer_load_dwordx4 a[180:183], v3, s[4:7], s30 offen sc1
    v_mfma_f32_16x16x32_bf16 v[60:63], a[84:87], a[232:235], v[60:63]
    v_fma_f32 v235, -v93, v93, s29
    v_mul_f32 v234, v234, v92
    v_mfma_f32_16x16x32_bf16 v[60:63], a[88:91], a[236:239], v[60:63]
    s_add_u32 s30, s24, 409600
    v_mul_f32 v235, v235, v93
    v_mul_f32 v94, v92, v94
    v_mfma_f32_16x16x32_bf16 v[60:63], a[92:95], a[240:243], v[60:63]
    v_exp_f32 v234, v234
    v_mfma_f32_16x16x32_bf16 v[60:63], a[96:99], a[244:247], v[60:63]
    buffer_load_dwordx4 a[184:187], v3, s[4:7], s30 offen sc1
    v_mfma_f32_16x16x32_bf16 v[60:63], a[100:103], a[248:251], v[60:63]
    v_exp_f32 v235, v235
    v_mfma_f32_16x16x32_bf16 v[60:63], a[104:107], a[252:255], v[60:63]
    s_waitcnt lgkmcnt(3)
    v_mul_f32 v95, v93, v95
    v_add_f32 v234, 1.0, v234
    v_mfma_f32_16x16x32_bf16 v[64:67], a[0:3], v[184:187], 0
    v_add_f32 v235, 1.0, v235
    v_mul_f32 v96, v96, v250
    v_mfma_f32_16x16x32_bf16 v[64:67], a[4:7], v[188:191], v[64:67]
    s_add_u32 s30, s24, 413696
    v_rcp_f32 v234, v234
    v_mfma_f32_16x16x32_bf16 v[64:67], a[8:11], v[192:195], v[64:67]
    v_rcp_f32 v235, v235
    v_mfma_f32_16x16x32_bf16 v[64:67], a[12:15], v[196:199], v[64:67]
    buffer_load_dwordx4 a[188:191], v3, s[4:7], s30 offen sc1
    v_mfma_f32_16x16x32_bf16 v[64:67], a[16:19], v[200:203], v[64:67]
    v_mul_f32 v234, v94, v234
    v_mul_f32 v235, v95, v235
    v_mfma_f32_16x16x32_bf16 v[64:67], a[20:23], v[204:207], v[64:67]
    s_waitcnt lgkmcnt(0)
    v_cvt_pk_bf16_f32 v137, v234, v235
    v_mul_f32 v97, v97, v250
    v_mfma_f32_16x16x32_bf16 v[64:67], a[24:27], v[208:211], v[64:67]
    s_add_u32 s30, s24, 417792
    v_fma_f32 v236, -v96, v96, s29
    v_fma_f32 v237, -v97, v97, s29
    v_mfma_f32_16x16x32_bf16 v[64:67], a[28:31], v[212:215], v[64:67]
    v_mul_f32 v236, v236, v96
    v_mul_f32 v237, v237, v97
    v_mfma_f32_16x16x32_bf16 v[64:67], a[32:35], v[216:219], v[64:67]
    buffer_load_dwordx4 a[192:195], v3, s[4:7], s30 offen sc1
    v_mfma_f32_16x16x32_bf16 v[68:71], a[36:39], v[184:187], 0
    ds_read_b128 v[220:223], v1 offset:46080
    ds_read_b128 v[224:227], v1 offset:47104
    v_mfma_f32_16x16x32_bf16 v[68:71], a[40:43], v[188:191], v[68:71]
    s_mov_b32 s16, s22
    ds_read_b128 v[228:231], v1 offset:48128
    v_mul_f32 v98, v96, v98
    v_mfma_f32_16x16x32_bf16 v[68:71], a[44:47], v[192:195], v[68:71]
    s_and_b32 s17, s21, 1
    v_exp_f32 v236, v236
    v_mfma_f32_16x16x32_bf16 v[68:71], a[48:51], v[196:199], v[68:71]
    s_add_u32 s30, s24, 421888
    v_exp_f32 v237, v237
    v_mfma_f32_16x16x32_bf16 v[68:71], a[52:55], v[200:203], v[68:71]
    s_lshl_b32 s17, s17, 3
    v_mul_f32 v99, v97, v99
    v_add_f32 v236, 1.0, v236
    v_mfma_f32_16x16x32_bf16 v[68:71], a[56:59], v[204:207], v[68:71]
    buffer_load_dwordx4 a[196:199], v3, s[4:7], s30 offen sc1
    v_mfma_f32_16x16x32_bf16 v[68:71], a[60:63], v[208:211], v[68:71]
    s_lshr_b32 s18, s21, 1
    v_add_f32 v237, 1.0, v237
    v_mul_f32 v100, v100, v251
    v_mfma_f32_16x16x32_bf16 v[68:71], a[64:67], v[212:215], v[68:71]
    s_add_u32 s17, s17, s18
    ds_read_b128 a[232:235], v1 offset:49152
    ds_read_b128 a[236:239], v1 offset:50176
    v_mfma_f32_16x16x32_bf16 v[68:71], a[68:71], v[216:219], v[68:71]
    s_add_u32 s30, s24, 425984
    ds_read_b128 a[240:243], v1 offset:51200
    v_mul_f32 v101, v101, v251
    v_mfma_f32_16x16x32_bf16 v[72:75], a[72:75], v[184:187], 0
    s_bfe_u32 s18, s21, 0x20002
    ds_read_b128 a[244:247], v1 offset:52224
    ds_read_b128 a[248:251], v1 offset:53248
    v_mfma_f32_16x16x32_bf16 v[72:75], a[76:79], v[188:191], v[72:75]
    s_lshl_b32 s18, s18, 1
    ds_read_b128 a[252:255], v1 offset:54272
    v_fma_f32 v238, -v100, v100, s29
    v_mfma_f32_16x16x32_bf16 v[72:75], a[80:83], v[192:195], v[72:75]
    buffer_load_dwordx4 a[200:203], v3, s[4:7], s30 offen sc1
    v_mfma_f32_16x16x32_bf16 v[72:75], a[84:87], v[196:199], v[72:75]
    s_and_b32 s28, s21, 1
    v_and_b32 v254, 7, v0
    v_fma_f32 v239, -v101, v101, s29
    v_mfma_f32_16x16x32_bf16 v[72:75], a[88:91], v[200:203], v[72:75]
    s_add_u32 s18, s18, s28
    v_bfe_u32 v10, v0, 3, 3
    v_mul_f32 v238, v238, v100
    v_mfma_f32_16x16x32_bf16 v[72:75], a[92:95], v[204:207], v[72:75]
    s_add_u32 s30, s24, 430080
    v_lshlrev_b32 v254, 4, v254
    v_mul_f32 v239, v239, v101
    v_mfma_f32_16x16x32_bf16 v[72:75], a[96:99], v[208:211], v[72:75]
    s_mul_i32 s18, s18, 18432
    v_lshl_add_u32 v254, v10, 8, v254
    v_mul_f32 v102, v100, v102
    v_mfma_f32_16x16x32_bf16 v[72:75], a[100:103], v[212:215], v[72:75]
    buffer_load_dwordx4 a[204:207], v3, s[4:7], s30 offen sc1
    v_mfma_f32_16x16x32_bf16 v[72:75], a[104:107], v[216:219], v[72:75]
    s_waitcnt lgkmcnt(3)
    v_bfe_u32 v10, v0, 4, 2
    v_mul_f32 v103, v101, v103
    v_mfma_f32_16x16x32_bf16 v[76:79], a[0:3], v[220:223], 0
    s_add_u32 s18, s18, s25
    v_lshl_add_u32 v10, v10, 28, v254
    v_mul_f32 v104, v104, v251
    v_mfma_f32_16x16x32_bf16 v[76:79], a[4:7], v[224:227], v[76:79]
    s_add_u32 s30, s24, 434176
    v_add_u32 v10, 4096, v10
    v_mul_f32 v105, v105, v251
    v_mfma_f32_16x16x32_bf16 v[76:79], a[8:11], v[228:231], v[76:79]
    s_bfe_u32 s28, s21, 0x10001
    v_rcp_f32 v236, v236
    v_mfma_f32_16x16x32_bf16 v[76:79], a[12:15], a[232:235], v[76:79]
    buffer_load_dwordx4 a[208:211], v3, s[4:7], s30 offen sc1
    v_mfma_f32_16x16x32_bf16 v[76:79], a[16:19], a[236:239], v[76:79]
    s_lshl_b32 s28, s28, 7
    v_rcp_f32 v237, v237
    v_mfma_f32_16x16x32_bf16 v[76:79], a[20:23], a[240:243], v[76:79]
    s_waitcnt lgkmcnt(0)
    v_mul_f32 v236, v98, v236
    v_mul_f32 v237, v99, v237
    v_mfma_f32_16x16x32_bf16 v[76:79], a[24:27], a[244:247], v[76:79]
    s_add_u32 s18, s18, s28
    v_cvt_pk_bf16_f32 v138, v236, v237
    v_fma_f32 v240, -v104, v104, s29
    v_mfma_f32_16x16x32_bf16 v[76:79], a[28:31], a[248:251], v[76:79]
    s_add_u32 s30, s24, 438272
    v_exp_f32 v238, v238
    v_mfma_f32_16x16x32_bf16 v[76:79], a[32:35], a[252:255], v[76:79]
    s_mul_i32 s28, s20, 4608
    v_exp_f32 v239, v239
    v_mfma_f32_16x16x32_bf16 v[80:83], a[36:39], v[220:223], 0
    s_add_u32 s18, s18, s28
    ds_read_b128 v[184:187], v1 offset:55296
    ds_read_b128 v[188:191], v1 offset:56320
    v_mfma_f32_16x16x32_bf16 v[80:83], a[40:43], v[224:227], v[80:83]
    s_mul_i32 s28, s20, 3072
    ds_read_b128 v[192:195], v1 offset:57344
    v_add_f32 v238, 1.0, v238
    v_mfma_f32_16x16x32_bf16 v[80:83], a[44:47], v[228:231], v[80:83]
    buffer_load_dwordx4 a[212:215], v3, s[4:7], s30 offen sc1
    v_mfma_f32_16x16x32_bf16 v[80:83], a[48:51], a[232:235], v[80:83]
    v_add_f32 v239, 1.0, v239
    v_fma_f32 v241, -v105, v105, s29
    v_mfma_f32_16x16x32_bf16 v[80:83], a[52:55], a[236:239], v[80:83]
    v_rcp_f32 v238, v238
    v_mfma_f32_16x16x32_bf16 v[80:83], a[56:59], a[240:243], v[80:83]
    v_rcp_f32 v239, v239
    v_mfma_f32_16x16x32_bf16 v[80:83], a[60:63], a[244:247], v[80:83]
    v_mul_f32 v238, v102, v238
    v_mul_f32 v239, v103, v239
    v_mfma_f32_16x16x32_bf16 v[80:83], a[64:67], a[248:251], v[80:83]
    ds_read_b128 v[196:199], v1 offset:58368
    ds_read_b128 v[200:203], v1 offset:59392
    v_mfma_f32_16x16x32_bf16 v[80:83], a[68:71], a[252:255], v[80:83]
    ds_read_b128 v[204:207], v1 offset:60416
    v_cvt_pk_bf16_f32 v140, v238, v239
    v_mfma_f32_16x16x32_bf16 v[84:87], a[72:75], v[220:223], 0
    ds_read_b128 v[208:211], v1 offset:61440
    ds_read_b128 v[212:215], v1 offset:62464
    v_mfma_f32_16x16x32_bf16 v[84:87], a[76:79], v[224:227], v[84:87]
    s_mul_i32 s35, s22, 6
    ds_read_b128 v[216:219], v1 offset:63488
    v_bfe_u32 v2, v0, 3, 3
    v_mfma_f32_16x16x32_bf16 v[84:87], a[80:83], v[228:231], v[84:87]
    s_min_u32 s35, s35, 84
    v_min_u32 v2, 5, v2
    v_mul_f32 v240, v240, v104
    v_mfma_f32_16x16x32_bf16 v[84:87], a[84:87], a[232:235], v[84:87]
    s_lshl_b32 s35, s35, 12
    v_lshlrev_b32 v2, 5, v2
    v_mul_f32 v241, v241, v105
    v_mfma_f32_16x16x32_bf16 v[84:87], a[88:91], a[236:239], v[84:87]
    s_add_u32 s35, s35, s24
    v_and_or_b32 v2, v0, 7, v2
    v_mul_f32 v106, v104, v106
    v_mfma_f32_16x16x32_bf16 v[84:87], a[92:95], a[240:243], v[84:87]
    s_add_u32 m0, s28, 147456
    v_lshlrev_b32 v2, 7, v2
    v_mul_f32 v107, v105, v107
    v_mfma_f32_16x16x32_bf16 v[84:87], a[96:99], a[244:247], v[84:87]
    buffer_load_dwordx4 v254, s[4:7], s18 offen offset:0 sc1 lds
    v_mfma_f32_16x16x32_bf16 v[84:87], a[100:103], a[248:251], v[84:87]
    s_add_u32 m0, s28, 146432
    v_exp_f32 v240, v240
    v_mfma_f32_16x16x32_bf16 v[84:87], a[104:107], a[252:255], v[84:87]
    s_waitcnt lgkmcnt(3)
    v_exp_f32 v241, v241
    v_mfma_f32_16x16x32_bf16 v[88:91], a[0:3], v[184:187], 0
    buffer_load_dwordx4 v254, s[4:7], s18 offen offset:2048 sc1 lds
    v_mfma_f32_16x16x32_bf16 v[88:91], a[4:7], v[188:191], v[88:91]
    s_add_u32 m0, s28, 149504
    v_add_f32 v240, 1.0, v240
    v_add_f32 v241, 1.0, v241
    v_mfma_f32_16x16x32_bf16 v[88:91], a[8:11], v[192:195], v[88:91]
    buffer_load_dwordx4 v10, s[4:7], s18 offen offset:0 sc1 lds
    v_mfma_f32_16x16x32_bf16 v[88:91], a[12:15], v[196:199], v[88:91]
    s_add_u32 s35, s35, s26
    v_rcp_f32 v240, v240
    v_mfma_f32_16x16x32_bf16 v[88:91], a[16:19], v[200:203], v[88:91]
ffn1_part_pad0_4x:
    s_cbranch_execz ffn1_part_pad0_8x
    s_add_u32 s35, s35, 663552
    v_rcp_f32 v241, v241
    v_mfma_f32_16x16x32_bf16 v[88:91], a[20:23], v[204:207], v[88:91]
    s_waitcnt lgkmcnt(0)
    v_mul_f32 v240, v106, v240
    v_mul_f32 v241, v107, v241
    v_mfma_f32_16x16x32_bf16 v[88:91], a[24:27], v[208:211], v[88:91]
    buffer_load_dword v255, v2, s[4:7], s35 offen sc1
    v_mfma_f32_16x16x32_bf16 v[88:91], a[28:31], v[212:215], v[88:91]
    v_cvt_pk_bf16_f32 v141, v240, v241
    v_mul_f32 v108, v108, v251
    v_mfma_f32_16x16x32_bf16 v[88:91], a[32:35], v[216:219], v[88:91]
    v_mul_f32 v109, v109, v251
    v_fma_f32 v242, -v108, v108, s29
    v_mfma_f32_16x16x32_bf16 v[92:95], a[36:39], v[184:187], 0
    ds_read_b128 v[220:223], v1 offset:64512
    ds_read_b128 v[224:227], v4 offset:0
    v_mfma_f32_16x16x32_bf16 v[92:95], a[40:43], v[188:191], v[92:95]
    ds_read_b128 v[228:231], v4 offset:1024
    v_fma_f32 v243, -v109, v109, s29
    v_mfma_f32_16x16x32_bf16 v[92:95], a[44:47], v[192:195], v[92:95]
    v_mul_f32 v242, v242, v108
    v_mul_f32 v243, v243, v109
    v_mfma_f32_16x16x32_bf16 v[92:95], a[48:51], v[196:199], v[92:95]
    v_exp_f32 v242, v242
    v_mfma_f32_16x16x32_bf16 v[92:95], a[52:55], v[200:203], v[92:95]
    v_exp_f32 v243, v243
    v_mfma_f32_16x16x32_bf16 v[92:95], a[56:59], v[204:207], v[92:95]
    v_mul_f32 v110, v108, v110
    v_mul_f32 v111, v109, v111
    v_mfma_f32_16x16x32_bf16 v[92:95], a[60:63], v[208:211], v[92:95]
    v_add_f32 v242, 1.0, v242
    v_add_f32 v243, 1.0, v243
    v_mfma_f32_16x16x32_bf16 v[92:95], a[64:67], v[212:215], v[92:95]
    ds_read_b128 a[232:235], v4 offset:2048
    ds_read_b128 a[236:239], v4 offset:3072
    v_mfma_f32_16x16x32_bf16 v[92:95], a[68:71], v[216:219], v[92:95]
    ds_read_b128 a[240:243], v4 offset:4096
    v_mfma_f32_16x16x32_bf16 v[96:99], a[72:75], v[184:187], 0
    ds_read_b128 a[244:247], v4 offset:5120
    ds_read_b128 a[248:251], v4 offset:6144
    v_mfma_f32_16x16x32_bf16 v[96:99], a[76:79], v[188:191], v[96:99]
    ds_read_b128 a[252:255], v4 offset:7168
    v_mfma_f32_16x16x32_bf16 v[96:99], a[80:83], v[192:195], v[96:99]
    v_rcp_f32 v242, v242
    v_mfma_f32_16x16x32_bf16 v[96:99], a[84:87], v[196:199], v[96:99]
    v_rcp_f32 v243, v243
    v_mfma_f32_16x16x32_bf16 v[96:99], a[88:91], v[200:203], v[96:99]
    v_mul_f32 v242, v110, v242
    v_mul_f32 v243, v111, v243
    v_mfma_f32_16x16x32_bf16 v[96:99], a[92:95], v[204:207], v[96:99]
    v_cvt_pk_bf16_f32 v142, v242, v243
    v_mfma_f32_16x16x32_bf16 v[96:99], a[96:99], v[208:211], v[96:99]
    v_mfma_f32_16x16x32_bf16 v[96:99], a[100:103], v[212:215], v[96:99]
    v_mfma_f32_16x16x32_bf16 v[96:99], a[104:107], v[216:219], v[96:99]
    s_waitcnt lgkmcnt(3)
    v_mfma_f32_16x16x32_bf16 v[100:103], a[0:3], v[220:223], 0
    v_mfma_f32_16x16x32_bf16 v[100:103], a[4:7], v[224:227], v[100:103]
    v_mfma_f32_16x16x32_bf16 v[100:103], a[8:11], v[228:231], v[100:103]
    v_mfma_f32_16x16x32_bf16 v[100:103], a[12:15], a[232:235], v[100:103]
    v_mfma_f32_16x16x32_bf16 v[100:103], a[16:19], a[236:239], v[100:103]
    v_mfma_f32_16x16x32_bf16 v[100:103], a[20:23], a[240:243], v[100:103]
    s_waitcnt lgkmcnt(0)
    v_mfma_f32_16x16x32_bf16 v[100:103], a[24:27], a[244:247], v[100:103]
    v_mfma_f32_16x16x32_bf16 v[100:103], a[28:31], a[248:251], v[100:103]
    v_mfma_f32_16x16x32_bf16 v[100:103], a[32:35], a[252:255], v[100:103]
    v_mfma_f32_16x16x32_bf16 v[104:107], a[36:39], v[220:223], 0
    ds_read_b128 v[184:187], v4 offset:8192
    ds_read_b128 v[188:191], v4 offset:9216
    v_mfma_f32_16x16x32_bf16 v[104:107], a[40:43], v[224:227], v[104:107]
    ds_read_b128 v[192:195], v4 offset:10240
    v_mfma_f32_16x16x32_bf16 v[104:107], a[44:47], v[228:231], v[104:107]
    v_mfma_f32_16x16x32_bf16 v[104:107], a[48:51], a[232:235], v[104:107]
    v_mfma_f32_16x16x32_bf16 v[104:107], a[52:55], a[236:239], v[104:107]
    v_mfma_f32_16x16x32_bf16 v[104:107], a[56:59], a[240:243], v[104:107]
    v_mfma_f32_16x16x32_bf16 v[104:107], a[60:63], a[244:247], v[104:107]
    v_mfma_f32_16x16x32_bf16 v[104:107], a[64:67], a[248:251], v[104:107]
    ds_read_b128 v[196:199], v4 offset:11264
    ds_read_b128 v[200:203], v4 offset:12288
    v_mfma_f32_16x16x32_bf16 v[104:107], a[68:71], a[252:255], v[104:107]
    ds_read_b128 v[204:207], v4 offset:13312
    v_mfma_f32_16x16x32_bf16 v[108:111], a[72:75], v[220:223], 0
    ds_read_b128 v[208:211], v4 offset:14336
    ds_read_b128 v[212:215], v4 offset:15360
    v_mfma_f32_16x16x32_bf16 v[108:111], a[76:79], v[224:227], v[108:111]
    ds_read_b128 v[216:219], v4 offset:16384
    v_mfma_f32_16x16x32_bf16 v[108:111], a[80:83], v[228:231], v[108:111]
    v_mfma_f32_16x16x32_bf16 v[108:111], a[84:87], a[232:235], v[108:111]
    v_mfma_f32_16x16x32_bf16 v[108:111], a[88:91], a[236:239], v[108:111]
    v_mfma_f32_16x16x32_bf16 v[108:111], a[92:95], a[240:243], v[108:111]
    v_mfma_f32_16x16x32_bf16 v[108:111], a[96:99], a[244:247], v[108:111]
    v_mfma_f32_16x16x32_bf16 v[108:111], a[100:103], a[248:251], v[108:111]
    s_add_u32 s30, s24, 442368
    v_mfma_f32_16x16x32_bf16 v[108:111], a[104:107], a[252:255], v[108:111]
    s_waitcnt vmcnt(23) lgkmcnt(3)
    v_mfma_f32_16x16x32_bf16 v[16:19], a[108:111], v[184:187], v[16:19]
    buffer_load_dwordx4 a[0:3], v3, s[4:7], s30 offen sc1
    v_mfma_f32_16x16x32_bf16 v[16:19], a[112:115], v[188:191], v[16:19]
    v_mfma_f32_16x16x32_bf16 v[16:19], a[116:119], v[192:195], v[16:19]
    s_add_u32 s30, s24, 446464
    v_mfma_f32_16x16x32_bf16 v[16:19], a[120:123], v[196:199], v[16:19]
    v_mfma_f32_16x16x32_bf16 v[16:19], a[124:127], v[200:203], v[16:19]
    buffer_load_dwordx4 a[4:7], v3, s[4:7], s30 offen sc1
    v_mfma_f32_16x16x32_bf16 v[16:19], a[128:131], v[204:207], v[16:19]
    s_waitcnt lgkmcnt(0)
    v_mfma_f32_16x16x32_bf16 v[16:19], a[132:135], v[208:211], v[16:19]
    v_mfma_f32_16x16x32_bf16 v[16:19], a[136:139], v[212:215], v[16:19]
    s_add_u32 s30, s24, 450560
    v_mfma_f32_16x16x32_bf16 v[16:19], a[140:143], v[216:219], v[16:19]
    s_waitcnt vmcnt(15)
    v_mfma_f32_16x16x32_bf16 v[20:23], a[144:147], v[184:187], v[20:23]
    ds_read_b128 v[220:223], v4 offset:17408
    ds_read_b128 v[224:227], v4 offset:18432
    v_mfma_f32_16x16x32_bf16 v[20:23], a[148:151], v[188:191], v[20:23]
    ds_read_b128 v[228:231], v4 offset:19456
    v_mfma_f32_16x16x32_bf16 v[20:23], a[152:155], v[192:195], v[20:23]
    buffer_load_dwordx4 a[8:11], v3, s[4:7], s30 offen sc1
    v_mfma_f32_16x16x32_bf16 v[20:23], a[156:159], v[196:199], v[20:23]
    v_mul_f32 v16, v16, v244
    v_mul_f32 v17, v17, v244
    v_mfma_f32_16x16x32_bf16 v[20:23], a[160:163], v[200:203], v[20:23]
    s_add_u32 s30, s24, 454656
    v_fma_f32 v232, -v16, v16, s29
    v_fma_f32 v233, -v17, v17, s29
    v_mfma_f32_16x16x32_bf16 v[20:23], a[164:167], v[204:207], v[20:23]
    v_mul_f32 v232, v232, v16
    v_mul_f32 v233, v233, v17
    v_mfma_f32_16x16x32_bf16 v[20:23], a[168:171], v[208:211], v[20:23]
    buffer_load_dwordx4 a[12:15], v3, s[4:7], s30 offen sc1
    v_mfma_f32_16x16x32_bf16 v[20:23], a[172:175], v[212:215], v[20:23]
    ds_read_b128 a[232:235], v4 offset:20480
    ds_read_b128 a[236:239], v4 offset:21504
    v_mfma_f32_16x16x32_bf16 v[20:23], a[176:179], v[216:219], v[20:23]
    s_waitcnt vmcnt(8)
    ds_read_b128 a[240:243], v4 offset:22528
    v_mul_f32 v18, v16, v18
    v_mfma_f32_16x16x32_bf16 v[24:27], a[180:183], v[184:187], v[24:27]
    s_add_u32 s30, s24, 458752
    ds_read_b128 a[244:247], v4 offset:23552
    ds_read_b128 a[248:251], v4 offset:24576
    v_mfma_f32_16x16x32_bf16 v[24:27], a[184:187], v[188:191], v[24:27]
    ds_read_b128 a[252:255], v4 offset:25600
    v_mul_f32 v19, v17, v19
    v_mfma_f32_16x16x32_bf16 v[24:27], a[188:191], v[192:195], v[24:27]
    buffer_load_dwordx4 a[16:19], v3, s[4:7], s30 offen sc1
    v_mfma_f32_16x16x32_bf16 v[24:27], a[192:195], v[196:199], v[24:27]
    v_exp_f32 v232, v232
    v_mfma_f32_16x16x32_bf16 v[24:27], a[196:199], v[200:203], v[24:27]
    v_exp_f32 v233, v233
    v_mfma_f32_16x16x32_bf16 v[24:27], a[200:203], v[204:207], v[24:27]
    v_add_f32 v232, 1.0, v232
    v_add_f32 v233, 1.0, v233
    v_mfma_f32_16x16x32_bf16 v[24:27], a[204:207], v[208:211], v[24:27]
    s_add_u32 s30, s24, 462848
    v_rcp_f32 v232, v232
    v_mfma_f32_16x16x32_bf16 v[24:27], a[208:211], v[212:215], v[24:27]
    v_rcp_f32 v233, v233
    v_mfma_f32_16x16x32_bf16 v[24:27], a[212:215], v[216:219], v[24:27]
    s_waitcnt lgkmcnt(3)
    v_mul_f32 v232, v18, v232
    v_mul_f32 v233, v19, v233
    v_mfma_f32_16x16x32_bf16 v[28:31], a[108:111], v[220:223], v[28:31]
    buffer_load_dwordx4 a[20:23], v3, s[4:7], s30 offen sc1
    v_mfma_f32_16x16x32_bf16 v[28:31], a[112:115], v[224:227], v[28:31]
    v_cvt_pk_bf16_f32 v115, v232, v233
    v_mul_f32 v20, v20, v244
    v_mfma_f32_16x16x32_bf16 v[28:31], a[116:119], v[228:231], v[28:31]
    s_add_u32 s30, s24, 466944
    v_mul_f32 v21, v21, v244
    v_fma_f32 v234, -v20, v20, s29
    v_mfma_f32_16x16x32_bf16 v[28:31], a[120:123], a[232:235], v[28:31]
    v_fma_f32 v235, -v21, v21, s29
    v_mul_f32 v234, v234, v20
    v_mfma_f32_16x16x32_bf16 v[28:31], a[124:127], a[236:239], v[28:31]
    buffer_load_dwordx4 a[24:27], v3, s[4:7], s30 offen sc1
    v_mfma_f32_16x16x32_bf16 v[28:31], a[128:131], a[240:243], v[28:31]
    s_waitcnt lgkmcnt(0)
    v_mul_f32 v235, v235, v21
    v_mul_f32 v22, v20, v22
    v_mfma_f32_16x16x32_bf16 v[28:31], a[132:135], a[244:247], v[28:31]
    v_exp_f32 v234, v234
    v_mfma_f32_16x16x32_bf16 v[28:31], a[136:139], a[248:251], v[28:31]
    v_exp_f32 v235, v235
    v_mfma_f32_16x16x32_bf16 v[28:31], a[140:143], a[252:255], v[28:31]
    s_add_u32 s30, s24, 471040
    v_mul_f32 v23, v21, v23
    v_add_f32 v234, 1.0, v234
    v_mfma_f32_16x16x32_bf16 v[32:35], a[144:147], v[220:223], v[32:35]
    ds_read_b128 v[184:187], v4 offset:26624
    ds_read_b128 v[188:191], v4 offset:27648
    v_mfma_f32_16x16x32_bf16 v[32:35], a[148:151], v[224:227], v[32:35]
    ds_read_b128 v[192:195], v4 offset:28672
    v_add_f32 v235, 1.0, v235
    v_mfma_f32_16x16x32_bf16 v[32:35], a[152:155], v[228:231], v[32:35]
    buffer_load_dwordx4 a[28:31], v3, s[4:7], s30 offen sc1
    v_mfma_f32_16x16x32_bf16 v[32:35], a[156:159], a[232:235], v[32:35]
    v_rcp_f32 v234, v234
    v_mfma_f32_16x16x32_bf16 v[32:35], a[160:163], a[236:239], v[32:35]
    s_add_u32 s30, s24, 475136
    v_rcp_f32 v235, v235
    v_mfma_f32_16x16x32_bf16 v[32:35], a[164:167], a[240:243], v[32:35]
    v_mul_f32 v234, v22, v234
    v_mul_f32 v235, v23, v235
    v_mfma_f32_16x16x32_bf16 v[32:35], a[168:171], a[244:247], v[32:35]
    buffer_load_dwordx4 a[32:35], v3, s[4:7], s30 offen sc1
    v_mfma_f32_16x16x32_bf16 v[32:35], a[172:175], a[248:251], v[32:35]
    ds_read_b128 v[196:199], v4 offset:29696
    ds_read_b128 v[200:203], v4 offset:30720
    v_mfma_f32_16x16x32_bf16 v[32:35], a[176:179], a[252:255], v[32:35]
    ds_read_b128 v[204:207], v4 offset:31744
    v_cvt_pk_bf16_f32 v176, v234, v235
    v_mfma_f32_16x16x32_bf16 v[36:39], a[180:183], v[220:223], v[36:39]
    ds_read_b128 v[208:211], v4 offset:32768
    ds_read_b128 v[212:215], v4 offset:33792
    v_mfma_f32_16x16x32_bf16 v[36:39], a[184:187], v[224:227], v[36:39]
    s_add_u32 s30, s24, 479232
    ds_read_b128 v[216:219], v4 offset:34816
    v_mul_f32 v24, v24, v244
    v_mfma_f32_16x16x32_bf16 v[36:39], a[188:191], v[228:231], v[36:39]
    v_mul_f32 v25, v25, v244
    v_fma_f32 v236, -v24, v24, s29
    v_mfma_f32_16x16x32_bf16 v[36:39], a[192:195], a[232:235], v[36:39]
    buffer_load_dwordx4 a[36:39], v3, s[4:7], s30 offen sc1
    v_mfma_f32_16x16x32_bf16 v[36:39], a[196:199], a[236:239], v[36:39]
    v_fma_f32 v237, -v25, v25, s29
    v_mul_f32 v236, v236, v24
    v_mfma_f32_16x16x32_bf16 v[36:39], a[200:203], a[240:243], v[36:39]
    v_mul_f32 v237, v237, v25
    v_mul_f32 v26, v24, v26
    v_mfma_f32_16x16x32_bf16 v[36:39], a[204:207], a[244:247], v[36:39]
    s_add_u32 s30, s24, 483328
    v_exp_f32 v236, v236
    v_mfma_f32_16x16x32_bf16 v[36:39], a[208:211], a[248:251], v[36:39]
    v_exp_f32 v237, v237
    v_mfma_f32_16x16x32_bf16 v[36:39], a[212:215], a[252:255], v[36:39]
    s_waitcnt lgkmcnt(3)
    v_mul_f32 v27, v25, v27
    v_add_f32 v236, 1.0, v236
    v_mfma_f32_16x16x32_bf16 v[40:43], a[108:111], v[184:187], v[40:43]
    buffer_load_dwordx4 a[40:43], v3, s[4:7], s30 offen sc1
    v_mfma_f32_16x16x32_bf16 v[40:43], a[112:115], v[188:191], v[40:43]
    v_add_f32 v237, 1.0, v237
    v_mul_f32 v28, v28, v245
    v_mfma_f32_16x16x32_bf16 v[40:43], a[116:119], v[192:195], v[40:43]
    v_rcp_f32 v236, v236
    v_mfma_f32_16x16x32_bf16 v[40:43], a[120:123], v[196:199], v[40:43]
    s_add_u32 s30, s24, 487424
    v_rcp_f32 v237, v237
    v_mfma_f32_16x16x32_bf16 v[40:43], a[124:127], v[200:203], v[40:43]
    v_mul_f32 v236, v26, v236
    v_mul_f32 v237, v27, v237
    v_mfma_f32_16x16x32_bf16 v[40:43], a[128:131], v[204:207], v[40:43]
    s_waitcnt lgkmcnt(0)
    v_cvt_pk_bf16_f32 v144, v236, v237
    v_mul_f32 v29, v29, v245
    v_mfma_f32_16x16x32_bf16 v[40:43], a[132:135], v[208:211], v[40:43]
    buffer_load_dwordx4 a[44:47], v3, s[4:7], s30 offen sc1
    v_mfma_f32_16x16x32_bf16 v[40:43], a[136:139], v[212:215], v[40:43]
    v_fma_f32 v238, -v28, v28, s29
    v_fma_f32 v239, -v29, v29, s29
    v_mfma_f32_16x16x32_bf16 v[40:43], a[140:143], v[216:219], v[40:43]
    s_add_u32 s30, s24, 491520
    v_mul_f32 v238, v238, v28
    v_mul_f32 v239, v239, v29
    v_mfma_f32_16x16x32_bf16 v[44:47], a[144:147], v[184:187], v[44:47]
    ds_read_b128 v[220:223], v4 offset:35840
    ds_read_b128 v[224:227], v4 offset:36864
    v_mfma_f32_16x16x32_bf16 v[44:47], a[148:151], v[188:191], v[44:47]
    ds_read_b128 v[228:231], v4 offset:37888
    v_mul_f32 v30, v28, v30
    v_mfma_f32_16x16x32_bf16 v[44:47], a[152:155], v[192:195], v[44:47]
    buffer_store_dwordx4 v[112:115], v3, s[4:7], s52 offen sc1
    v_mfma_f32_16x16x32_bf16 v[44:47], a[156:159], v[196:199], v[44:47]
    v_exp_f32 v238, v238
    v_mfma_f32_16x16x32_bf16 v[44:47], a[160:163], v[200:203], v[44:47]
    v_exp_f32 v239, v239
    v_mfma_f32_16x16x32_bf16 v[44:47], a[164:167], v[204:207], v[44:47]
    v_mul_f32 v31, v29, v31
    v_add_f32 v238, 1.0, v238
    v_mfma_f32_16x16x32_bf16 v[44:47], a[168:171], v[208:211], v[44:47]
    buffer_load_dwordx4 a[48:51], v3, s[4:7], s30 offen sc1
    v_mfma_f32_16x16x32_bf16 v[44:47], a[172:175], v[212:215], v[44:47]
    ds_read_b128 a[232:235], v4 offset:38912
    ds_read_b128 a[236:239], v4 offset:39936
    v_mfma_f32_16x16x32_bf16 v[44:47], a[176:179], v[216:219], v[44:47]
    s_add_u32 s30, s24, 495616
    ds_read_b128 a[240:243], v4 offset:40960
    v_add_f32 v239, 1.0, v239
    v_mfma_f32_16x16x32_bf16 v[48:51], a[180:183], v[184:187], v[48:51]
    ds_read_b128 a[244:247], v4 offset:41984
    ds_read_b128 a[248:251], v4 offset:43008
    v_mfma_f32_16x16x32_bf16 v[48:51], a[184:187], v[188:191], v[48:51]
    ds_read_b128 a[252:255], v4 offset:44032
    v_mul_f32 v32, v32, v245
    v_mfma_f32_16x16x32_bf16 v[48:51], a[188:191], v[192:195], v[48:51]
    buffer_load_dwordx4 a[52:55], v3, s[4:7], s30 offen sc1
    v_mfma_f32_16x16x32_bf16 v[48:51], a[192:195], v[196:199], v[48:51]
    v_rcp_f32 v238, v238
    v_mfma_f32_16x16x32_bf16 v[48:51], a[196:199], v[200:203], v[48:51]
    s_add_u32 s30, s24, 499712
    v_rcp_f32 v239, v239
    v_mfma_f32_16x16x32_bf16 v[48:51], a[200:203], v[204:207], v[48:51]
    v_mul_f32 v238, v30, v238
    v_mul_f32 v239, v31, v239
    v_mfma_f32_16x16x32_bf16 v[48:51], a[204:207], v[208:211], v[48:51]
    buffer_load_dwordx4 a[56:59], v3, s[4:7], s30 offen sc1
    v_mfma_f32_16x16x32_bf16 v[48:51], a[208:211], v[212:215], v[48:51]
    v_cvt_pk_bf16_f32 v119, v238, v239
    v_mul_f32 v33, v33, v245
    v_mfma_f32_16x16x32_bf16 v[48:51], a[212:215], v[216:219], v[48:51]
    s_waitcnt lgkmcnt(3)
    v_fma_f32 v240, -v32, v32, s29
    v_fma_f32 v241, -v33, v33, s29
    v_mfma_f32_16x16x32_bf16 v[52:55], a[108:111], v[220:223], v[52:55]
    v_mul_f32 v240, v240, v32
    v_mul_f32 v241, v241, v33
    v_mfma_f32_16x16x32_bf16 v[52:55], a[112:115], v[224:227], v[52:55]
    s_add_u32 s30, s24, 503808
    v_exp_f32 v240, v240
    v_mfma_f32_16x16x32_bf16 v[52:55], a[116:119], v[228:231], v[52:55]
    v_exp_f32 v241, v241
    v_mfma_f32_16x16x32_bf16 v[52:55], a[120:123], a[232:235], v[52:55]
    buffer_load_dwordx4 a[60:63], v3, s[4:7], s30 offen sc1
    v_mfma_f32_16x16x32_bf16 v[52:55], a[124:127], a[236:239], v[52:55]
    v_mul_f32 v34, v32, v34
    v_mul_f32 v35, v33, v35
    v_mfma_f32_16x16x32_bf16 v[52:55], a[128:131], a[240:243], v[52:55]
    s_waitcnt lgkmcnt(0)
    v_add_f32 v240, 1.0, v240
    v_add_f32 v241, 1.0, v241
    v_mfma_f32_16x16x32_bf16 v[52:55], a[132:135], a[244:247], v[52:55]
    s_add_u32 s30, s24, 507904
    v_rcp_f32 v240, v240
    v_mfma_f32_16x16x32_bf16 v[52:55], a[136:139], a[248:251], v[52:55]
    v_rcp_f32 v241, v241
    v_mfma_f32_16x16x32_bf16 v[52:55], a[140:143], a[252:255], v[52:55]
    buffer_load_dwordx4 a[64:67], v3, s[4:7], s30 offen sc1
    v_mfma_f32_16x16x32_bf16 v[56:59], a[144:147], v[220:223], v[56:59]
    ds_read_b128 v[184:187], v4 offset:45056
    ds_read_b128 v[188:191], v4 offset:46080
    v_mfma_f32_16x16x32_bf16 v[56:59], a[148:151], v[224:227], v[56:59]
    ds_read_b128 v[192:195], v4 offset:47104
    v_mul_f32 v240, v34, v240
    v_mfma_f32_16x16x32_bf16 v[56:59], a[152:155], v[228:231], v[56:59]
    v_mul_f32 v241, v35, v241
    v_mul_f32 v36, v36, v245
    v_mfma_f32_16x16x32_bf16 v[56:59], a[156:159], a[232:235], v[56:59]
    s_add_u32 s30, s24, 512000
    v_cvt_pk_bf16_f32 v177, v240, v241
    v_mul_f32 v37, v37, v245
    v_mfma_f32_16x16x32_bf16 v[56:59], a[160:163], a[236:239], v[56:59]
    v_fma_f32 v242, -v36, v36, s29
    v_fma_f32 v243, -v37, v37, s29
    v_mfma_f32_16x16x32_bf16 v[56:59], a[164:167], a[240:243], v[56:59]
    buffer_load_dwordx4 a[68:71], v3, s[4:7], s30 offen sc1
    v_mfma_f32_16x16x32_bf16 v[56:59], a[168:171], a[244:247], v[56:59]
    v_mul_f32 v242, v242, v36
    v_mul_f32 v243, v243, v37
    v_mfma_f32_16x16x32_bf16 v[56:59], a[172:175], a[248:251], v[56:59]
    ds_read_b128 v[196:199], v4 offset:48128
    ds_read_b128 v[200:203], v4 offset:49152
    v_mfma_f32_16x16x32_bf16 v[56:59], a[176:179], a[252:255], v[56:59]
    s_add_u32 s30, s24, 516096
    ds_read_b128 v[204:207], v4 offset:50176
    v_mul_f32 v38, v36, v38
    v_mfma_f32_16x16x32_bf16 v[60:63], a[180:183], v[220:223], v[60:63]
    ds_read_b128 v[208:211], v4 offset:51200
    ds_read_b128 v[212:215], v4 offset:52224
    v_mfma_f32_16x16x32_bf16 v[60:63], a[184:187], v[224:227], v[60:63]
    ds_read_b128 v[216:219], v4 offset:53248
    v_mul_f32 v39, v37, v39
    v_mfma_f32_16x16x32_bf16 v[60:63], a[188:191], v[228:231], v[60:63]
    buffer_load_dwordx4 a[72:75], v3, s[4:7], s30 offen sc1
    v_mfma_f32_16x16x32_bf16 v[60:63], a[192:195], a[232:235], v[60:63]
    v_exp_f32 v242, v242
    v_mfma_f32_16x16x32_bf16 v[60:63], a[196:199], a[236:239], v[60:63]
    v_exp_f32 v243, v243
    v_mfma_f32_16x16x32_bf16 v[60:63], a[200:203], a[240:243], v[60:63]
    s_add_u32 s30, s24, 520192
    v_add_f32 v242, 1.0, v242
    v_add_f32 v243, 1.0, v243
    v_mfma_f32_16x16x32_bf16 v[60:63], a[204:207], a[244:247], v[60:63]
    v_rcp_f32 v242, v242
    v_mfma_f32_16x16x32_bf16 v[60:63], a[208:211], a[248:251], v[60:63]
    buffer_load_dwordx4 a[76:79], v3, s[4:7], s30 offen sc1
    v_mfma_f32_16x16x32_bf16 v[60:63], a[212:215], a[252:255], v[60:63]
    s_waitcnt lgkmcnt(3)
    v_rcp_f32 v243, v243
    v_mfma_f32_16x16x32_bf16 v[64:67], a[108:111], v[184:187], v[64:67]
    v_mul_f32 v242, v38, v242
    v_mul_f32 v243, v39, v243
    v_mfma_f32_16x16x32_bf16 v[64:67], a[112:115], v[188:191], v[64:67]
    s_add_u32 s30, s24, 524288
    v_cvt_pk_bf16_f32 v148, v242, v243
    v_mul_f32 v40, v40, v246
    v_mfma_f32_16x16x32_bf16 v[64:67], a[116:119], v[192:195], v[64:67]
    buffer_store_dwordx4 v[116:119], v3, s[4:7], s53 offen sc1
    v_mfma_f32_16x16x32_bf16 v[64:67], a[120:123], v[196:199], v[64:67]
    v_mul_f32 v41, v41, v246
    v_fma_f32 v232, -v40, v40, s29
    v_mfma_f32_16x16x32_bf16 v[64:67], a[124:127], v[200:203], v[64:67]
    v_fma_f32 v233, -v41, v41, s29
    v_mul_f32 v232, v232, v40
    v_mfma_f32_16x16x32_bf16 v[64:67], a[128:131], v[204:207], v[64:67]
    s_waitcnt lgkmcnt(0)
    v_mul_f32 v233, v233, v41
    v_mul_f32 v42, v40, v42
    v_mfma_f32_16x16x32_bf16 v[64:67], a[132:135], v[208:211], v[64:67]
    v_exp_f32 v232, v232
    v_mfma_f32_16x16x32_bf16 v[64:67], a[136:139], v[212:215], v[64:67]
    v_exp_f32 v233, v233
    v_mfma_f32_16x16x32_bf16 v[64:67], a[140:143], v[216:219], v[64:67]
    v_mul_f32 v43, v41, v43
    v_add_f32 v232, 1.0, v232
    v_mfma_f32_16x16x32_bf16 v[68:71], a[144:147], v[184:187], v[68:71]
    ds_read_b128 v[220:223], v4 offset:54272
    ds_read_b128 v[224:227], v4 offset:55296
    v_mfma_f32_16x16x32_bf16 v[68:71], a[148:151], v[188:191], v[68:71]
    ds_read_b128 v[228:231], v4 offset:56320
    v_add_f32 v233, 1.0, v233
    v_mfma_f32_16x16x32_bf16 v[68:71], a[152:155], v[192:195], v[68:71]
    buffer_load_dwordx4 a[80:83], v3, s[4:7], s30 offen sc1
    v_mfma_f32_16x16x32_bf16 v[68:71], a[156:159], v[196:199], v[68:71]
    v_rcp_f32 v232, v232
    v_mfma_f32_16x16x32_bf16 v[68:71], a[160:163], v[200:203], v[68:71]
    s_add_u32 s30, s24, 528384
    v_rcp_f32 v233, v233
    v_mfma_f32_16x16x32_bf16 v[68:71], a[164:167], v[204:207], v[68:71]
    v_mul_f32 v232, v42, v232
    v_mul_f32 v233, v43, v233
    v_mfma_f32_16x16x32_bf16 v[68:71], a[168:171], v[208:211], v[68:71]
    buffer_load_dwordx4 a[84:87], v3, s[4:7], s30 offen sc1
    v_mfma_f32_16x16x32_bf16 v[68:71], a[172:175], v[212:215], v[68:71]
    ds_read_b128 a[232:235], v4 offset:57344
    ds_read_b128 a[236:239], v4 offset:58368
    v_mfma_f32_16x16x32_bf16 v[68:71], a[176:179], v[216:219], v[68:71]
    ds_read_b128 a[240:243], v4 offset:59392
    v_cvt_pk_bf16_f32 v123, v232, v233
    v_mfma_f32_16x16x32_bf16 v[72:75], a[180:183], v[184:187], v[72:75]
    s_add_u32 s30, s24, 532480
    ds_read_b128 a[244:247], v4 offset:60416
    ds_read_b128 a[248:251], v4 offset:61440
    v_mfma_f32_16x16x32_bf16 v[72:75], a[184:187], v[188:191], v[72:75]
    ds_read_b128 a[252:255], v4 offset:62464
    v_mul_f32 v44, v44, v246
    v_mfma_f32_16x16x32_bf16 v[72:75], a[188:191], v[192:195], v[72:75]
    buffer_load_dwordx4 a[88:91], v3, s[4:7], s30 offen sc1
    v_mfma_f32_16x16x32_bf16 v[72:75], a[192:195], v[196:199], v[72:75]
    v_mul_f32 v45, v45, v246
    v_fma_f32 v234, -v44, v44, s29
    v_mfma_f32_16x16x32_bf16 v[72:75], a[196:199], v[200:203], v[72:75]
    v_fma_f32 v235, -v45, v45, s29
    v_mul_f32 v234, v234, v44
    v_mfma_f32_16x16x32_bf16 v[72:75], a[200:203], v[204:207], v[72:75]
    v_mul_f32 v235, v235, v45
    v_mul_f32 v46, v44, v46
    v_mfma_f32_16x16x32_bf16 v[72:75], a[204:207], v[208:211], v[72:75]
    s_add_u32 s30, s24, 536576
    v_exp_f32 v234, v234
    v_mfma_f32_16x16x32_bf16 v[72:75], a[208:211], v[212:215], v[72:75]
    v_exp_f32 v235, v235
    v_mfma_f32_16x16x32_bf16 v[72:75], a[212:215], v[216:219], v[72:75]
    s_waitcnt lgkmcnt(3)
    v_mul_f32 v47, v45, v47
    v_add_f32 v234, 1.0, v234
    v_mfma_f32_16x16x32_bf16 v[76:79], a[108:111], v[220:223], v[76:79]
    buffer_load_dwordx4 a[92:95], v3, s[4:7], s30 offen sc1
    v_mfma_f32_16x16x32_bf16 v[76:79], a[112:115], v[224:227], v[76:79]
    v_add_f32 v235, 1.0, v235
    v_mul_f32 v48, v48, v246
    v_mfma_f32_16x16x32_bf16 v[76:79], a[116:119], v[228:231], v[76:79]
    s_add_u32 s30, s24, 540672
    v_rcp_f32 v234, v234
    v_mfma_f32_16x16x32_bf16 v[76:79], a[120:123], a[232:235], v[76:79]
    v_rcp_f32 v235, v235
    v_mfma_f32_16x16x32_bf16 v[76:79], a[124:127], a[236:239], v[76:79]
    buffer_load_dwordx4 a[96:99], v3, s[4:7], s30 offen sc1
    v_mfma_f32_16x16x32_bf16 v[76:79], a[128:131], a[240:243], v[76:79]
    s_waitcnt lgkmcnt(0)
    v_mul_f32 v234, v46, v234
    v_mul_f32 v235, v47, v235
    v_mfma_f32_16x16x32_bf16 v[76:79], a[132:135], a[244:247], v[76:79]
    v_cvt_pk_bf16_f32 v178, v234, v235
    v_mul_f32 v49, v49, v246
    v_mfma_f32_16x16x32_bf16 v[76:79], a[136:139], a[248:251], v[76:79]
    v_fma_f32 v236, -v48, v48, s29
    v_fma_f32 v237, -v49, v49, s29
    v_mfma_f32_16x16x32_bf16 v[76:79], a[140:143], a[252:255], v[76:79]
    s_add_u32 s30, s24, 544768
    v_mul_f32 v236, v236, v48
    v_mul_f32 v237, v237, v49
    v_mfma_f32_16x16x32_bf16 v[80:83], a[144:147], v[220:223], v[80:83]
    ds_read_b128 v[184:187], v4 offset:63488
    ds_read_b128 v[188:191], v4 offset:64512
    v_mfma_f32_16x16x32_bf16 v[80:83], a[148:151], v[224:227], v[80:83]
    ds_read_b128 v[192:195], v5 offset:0
    v_mul_f32 v50, v48, v50
    v_mfma_f32_16x16x32_bf16 v[80:83], a[152:155], v[228:231], v[80:83]
    buffer_load_dwordx4 a[100:103], v3, s[4:7], s30 offen sc1
    v_mfma_f32_16x16x32_bf16 v[80:83], a[156:159], a[232:235], v[80:83]
    v_exp_f32 v236, v236
    v_mfma_f32_16x16x32_bf16 v[80:83], a[160:163], a[236:239], v[80:83]
    s_add_u32 s30, s24, 548864
    v_exp_f32 v237, v237
    v_mfma_f32_16x16x32_bf16 v[80:83], a[164:167], a[240:243], v[80:83]
    v_mul_f32 v51, v49, v51
    v_add_f32 v236, 1.0, v236
    v_mfma_f32_16x16x32_bf16 v[80:83], a[168:171], a[244:247], v[80:83]
    buffer_load_dwordx4 a[104:107], v3, s[4:7], s30 offen sc1
    v_mfma_f32_16x16x32_bf16 v[80:83], a[172:175], a[248:251], v[80:83]
    ds_read_b128 v[196:199], v5 offset:1024
    ds_read_b128 v[200:203], v5 offset:2048
    v_mfma_f32_16x16x32_bf16 v[80:83], a[176:179], a[252:255], v[80:83]
    ds_read_b128 v[204:207], v5 offset:3072
    v_add_f32 v237, 1.0, v237
    v_mfma_f32_16x16x32_bf16 v[84:87], a[180:183], v[220:223], v[84:87]
    ds_read_b128 v[208:211], v5 offset:4096
    ds_read_b128 v[212:215], v5 offset:5120
    v_mfma_f32_16x16x32_bf16 v[84:87], a[184:187], v[224:227], v[84:87]
    ds_read_b128 v[216:219], v5 offset:6144
    v_mul_f32 v52, v52, v247
    v_mfma_f32_16x16x32_bf16 v[84:87], a[188:191], v[228:231], v[84:87]
    v_rcp_f32 v236, v236
    v_mfma_f32_16x16x32_bf16 v[84:87], a[192:195], a[232:235], v[84:87]
    v_rcp_f32 v237, v237
    v_mfma_f32_16x16x32_bf16 v[84:87], a[196:199], a[236:239], v[84:87]
    v_mul_f32 v236, v50, v236
    v_mul_f32 v237, v51, v237
    v_mfma_f32_16x16x32_bf16 v[84:87], a[200:203], a[240:243], v[84:87]
    v_cvt_pk_bf16_f32 v152, v236, v237
    v_mul_f32 v53, v53, v247
    v_mfma_f32_16x16x32_bf16 v[84:87], a[204:207], a[244:247], v[84:87]
    buffer_store_dwordx4 v[120:123], v3, s[4:7], s54 offen sc1
    v_mfma_f32_16x16x32_bf16 v[84:87], a[208:211], a[248:251], v[84:87]
    v_fma_f32 v238, -v52, v52, s29
    v_fma_f32 v239, -v53, v53, s29
    v_mfma_f32_16x16x32_bf16 v[84:87], a[212:215], a[252:255], v[84:87]
    s_waitcnt lgkmcnt(3)
    v_mul_f32 v238, v238, v52
    v_mul_f32 v239, v239, v53
    v_mfma_f32_16x16x32_bf16 v[88:91], a[108:111], v[184:187], v[88:91]
    v_exp_f32 v238, v238
    v_mfma_f32_16x16x32_bf16 v[88:91], a[112:115], v[188:191], v[88:91]
    v_exp_f32 v239, v239
    v_mfma_f32_16x16x32_bf16 v[88:91], a[116:119], v[192:195], v[88:91]
    v_mul_f32 v54, v52, v54
    v_mul_f32 v55, v53, v55
    v_mfma_f32_16x16x32_bf16 v[88:91], a[120:123], v[196:199], v[88:91]
    v_add_f32 v238, 1.0, v238
    v_add_f32 v239, 1.0, v239
    v_mfma_f32_16x16x32_bf16 v[88:91], a[124:127], v[200:203], v[88:91]
    v_rcp_f32 v238, v238
    v_mfma_f32_16x16x32_bf16 v[88:91], a[128:131], v[204:207], v[88:91]
    s_waitcnt lgkmcnt(0)
    v_rcp_f32 v239, v239
    v_mfma_f32_16x16x32_bf16 v[88:91], a[132:135], v[208:211], v[88:91]
    v_mul_f32 v238, v54, v238
    v_mul_f32 v239, v55, v239
    v_mfma_f32_16x16x32_bf16 v[88:91], a[136:139], v[212:215], v[88:91]
    v_cvt_pk_bf16_f32 v127, v238, v239
    v_mul_f32 v56, v56, v247
    v_mfma_f32_16x16x32_bf16 v[88:91], a[140:143], v[216:219], v[88:91]
    v_mul_f32 v57, v57, v247
    v_fma_f32 v240, -v56, v56, s29
    v_mfma_f32_16x16x32_bf16 v[92:95], a[144:147], v[184:187], v[92:95]
    ds_read_b128 v[220:223], v5 offset:7168
    ds_read_b128 v[224:227], v5 offset:8192
    v_mfma_f32_16x16x32_bf16 v[92:95], a[148:151], v[188:191], v[92:95]
    ds_read_b128 v[228:231], v5 offset:9216
    v_fma_f32 v241, -v57, v57, s29
    v_mfma_f32_16x16x32_bf16 v[92:95], a[152:155], v[192:195], v[92:95]
    v_mul_f32 v240, v240, v56
    v_mul_f32 v241, v241, v57
    v_mfma_f32_16x16x32_bf16 v[92:95], a[156:159], v[196:199], v[92:95]
    v_exp_f32 v240, v240
    v_mfma_f32_16x16x32_bf16 v[92:95], a[160:163], v[200:203], v[92:95]
    v_exp_f32 v241, v241
    v_mfma_f32_16x16x32_bf16 v[92:95], a[164:167], v[204:207], v[92:95]
    v_mul_f32 v58, v56, v58
    v_mul_f32 v59, v57, v59
    v_mfma_f32_16x16x32_bf16 v[92:95], a[168:171], v[208:211], v[92:95]
    v_add_f32 v240, 1.0, v240
    v_add_f32 v241, 1.0, v241
    v_mfma_f32_16x16x32_bf16 v[92:95], a[172:175], v[212:215], v[92:95]
    ds_read_b128 a[232:235], v5 offset:10240
    ds_read_b128 a[236:239], v5 offset:11264
    v_mfma_f32_16x16x32_bf16 v[92:95], a[176:179], v[216:219], v[92:95]
    ds_read_b128 a[240:243], v5 offset:12288
    v_mul_f32 v60, v60, v247
    v_mfma_f32_16x16x32_bf16 v[96:99], a[180:183], v[184:187], v[96:99]
    ds_read_b128 a[244:247], v5 offset:13312
    ds_read_b128 a[248:251], v5 offset:14336
    v_mfma_f32_16x16x32_bf16 v[96:99], a[184:187], v[188:191], v[96:99]
    ds_read_b128 a[252:255], v5 offset:15360
    v_mul_f32 v61, v61, v247
    v_mfma_f32_16x16x32_bf16 v[96:99], a[188:191], v[192:195], v[96:99]
    v_rcp_f32 v240, v240
    v_mfma_f32_16x16x32_bf16 v[96:99], a[192:195], v[196:199], v[96:99]
    v_rcp_f32 v241, v241
    v_mfma_f32_16x16x32_bf16 v[96:99], a[196:199], v[200:203], v[96:99]
    v_mul_f32 v240, v58, v240
    v_mul_f32 v241, v59, v241
    v_mfma_f32_16x16x32_bf16 v[96:99], a[200:203], v[204:207], v[96:99]
    v_cvt_pk_bf16_f32 v179, v240, v241
    v_fma_f32 v242, -v60, v60, s29
    v_mfma_f32_16x16x32_bf16 v[96:99], a[204:207], v[208:211], v[96:99]
ffn1_part_pad0_5x:
    s_cbranch_execz ffn1_part_pad0_9x
    v_fma_f32 v243, -v61, v61, s29
    v_mul_f32 v242, v242, v60
    v_mfma_f32_16x16x32_bf16 v[96:99], a[208:211], v[212:215], v[96:99]
    v_mul_f32 v243, v243, v61
    v_mul_f32 v62, v60, v62
    v_mfma_f32_16x16x32_bf16 v[96:99], a[212:215], v[216:219], v[96:99]
    s_waitcnt lgkmcnt(3)
    v_exp_f32 v242, v242
    v_mfma_f32_16x16x32_bf16 v[100:103], a[108:111], v[220:223], v[100:103]
    v_exp_f32 v243, v243
    v_mfma_f32_16x16x32_bf16 v[100:103], a[112:115], v[224:227], v[100:103]
    v_mul_f32 v63, v61, v63
    v_add_f32 v242, 1.0, v242
    v_mfma_f32_16x16x32_bf16 v[100:103], a[116:119], v[228:231], v[100:103]
    v_add_f32 v243, 1.0, v243
    v_mul_f32 v64, v64, v248
    v_mfma_f32_16x16x32_bf16 v[100:103], a[120:123], a[232:235], v[100:103]
    v_rcp_f32 v242, v242
    v_mfma_f32_16x16x32_bf16 v[100:103], a[124:127], a[236:239], v[100:103]
    v_rcp_f32 v243, v243
    v_mfma_f32_16x16x32_bf16 v[100:103], a[128:131], a[240:243], v[100:103]
    s_waitcnt lgkmcnt(0)
    v_mul_f32 v242, v62, v242
    v_mul_f32 v243, v63, v243
    v_mfma_f32_16x16x32_bf16 v[100:103], a[132:135], a[244:247], v[100:103]
    v_cvt_pk_bf16_f32 v156, v242, v243
    v_mul_f32 v65, v65, v248
    v_mfma_f32_16x16x32_bf16 v[100:103], a[136:139], a[248:251], v[100:103]
    buffer_store_dwordx4 v[124:127], v3, s[4:7], s60 offen sc1
    v_mfma_f32_16x16x32_bf16 v[100:103], a[140:143], a[252:255], v[100:103]
    v_fma_f32 v232, -v64, v64, s29
    v_fma_f32 v233, -v65, v65, s29
    v_mfma_f32_16x16x32_bf16 v[104:107], a[144:147], v[220:223], v[104:107]
    ds_read_b128 v[184:187], v1 offset:0
    ds_read_b128 v[188:191], v1 offset:1024
    v_mfma_f32_16x16x32_bf16 v[104:107], a[148:151], v[224:227], v[104:107]
    ds_read_b128 v[192:195], v1 offset:2048
    v_mul_f32 v232, v232, v64
    v_mfma_f32_16x16x32_bf16 v[104:107], a[152:155], v[228:231], v[104:107]
    v_mul_f32 v233, v233, v65
    v_mul_f32 v66, v64, v66
    v_mfma_f32_16x16x32_bf16 v[104:107], a[156:159], a[232:235], v[104:107]
    v_exp_f32 v232, v232
    v_mfma_f32_16x16x32_bf16 v[104:107], a[160:163], a[236:239], v[104:107]
    v_exp_f32 v233, v233
    v_mfma_f32_16x16x32_bf16 v[104:107], a[164:167], a[240:243], v[104:107]
    v_mul_f32 v67, v65, v67
    v_add_f32 v232, 1.0, v232
    v_mfma_f32_16x16x32_bf16 v[104:107], a[168:171], a[244:247], v[104:107]
    v_add_f32 v233, 1.0, v233
    v_mul_f32 v68, v68, v248
    v_mfma_f32_16x16x32_bf16 v[104:107], a[172:175], a[248:251], v[104:107]
    ds_read_b128 v[196:199], v1 offset:3072
    ds_read_b128 v[200:203], v1 offset:4096
    v_mfma_f32_16x16x32_bf16 v[104:107], a[176:179], a[252:255], v[104:107]
    ds_read_b128 v[204:207], v1 offset:5120
    v_mul_f32 v69, v69, v248
    v_mfma_f32_16x16x32_bf16 v[108:111], a[180:183], v[220:223], v[108:111]
    ds_read_b128 v[208:211], v1 offset:6144
    ds_read_b128 v[212:215], v1 offset:7168
    v_mfma_f32_16x16x32_bf16 v[108:111], a[184:187], v[224:227], v[108:111]
    ds_read_b128 v[216:219], v1 offset:8192
    v_fma_f32 v234, -v68, v68, s29
    v_mfma_f32_16x16x32_bf16 v[108:111], a[188:191], v[228:231], v[108:111]
    v_rcp_f32 v232, v232
    v_mfma_f32_16x16x32_bf16 v[108:111], a[192:195], a[232:235], v[108:111]
    v_rcp_f32 v233, v233
    v_mfma_f32_16x16x32_bf16 v[108:111], a[196:199], a[236:239], v[108:111]
    v_mul_f32 v232, v66, v232
    v_mul_f32 v233, v67, v233
    v_mfma_f32_16x16x32_bf16 v[108:111], a[200:203], a[240:243], v[108:111]
    v_cvt_pk_bf16_f32 v131, v232, v233
    v_fma_f32 v235, -v69, v69, s29
    v_mfma_f32_16x16x32_bf16 v[108:111], a[204:207], a[244:247], v[108:111]
    v_mul_f32 v234, v234, v68
    v_mul_f32 v235, v235, v69
    v_mfma_f32_16x16x32_bf16 v[108:111], a[208:211], a[248:251], v[108:111]
    s_add_u32 s30, s24, 552960
    v_exp_f32 v234, v234
    v_mfma_f32_16x16x32_bf16 v[108:111], a[212:215], a[252:255], v[108:111]
    s_waitcnt vmcnt(22) lgkmcnt(3)
    v_exp_f32 v235, v235
    v_mfma_f32_16x16x32_bf16 v[16:19], a[0:3], v[184:187], 0
    buffer_load_dwordx4 a[108:111], v3, s[4:7], s30 offen sc1
    v_mfma_f32_16x16x32_bf16 v[16:19], a[4:7], v[188:191], v[16:19]
    v_mul_f32 v70, v68, v70
    v_mul_f32 v71, v69, v71
    v_mfma_f32_16x16x32_bf16 v[16:19], a[8:11], v[192:195], v[16:19]
    s_add_u32 s30, s24, 557056
    v_add_f32 v234, 1.0, v234
    v_add_f32 v235, 1.0, v235
    v_mfma_f32_16x16x32_bf16 v[16:19], a[12:15], v[196:199], v[16:19]
    v_rcp_f32 v234, v234
    v_mfma_f32_16x16x32_bf16 v[16:19], a[16:19], v[200:203], v[16:19]
    buffer_load_dwordx4 a[112:115], v3, s[4:7], s30 offen sc1
    v_mfma_f32_16x16x32_bf16 v[16:19], a[20:23], v[204:207], v[16:19]
    s_waitcnt lgkmcnt(0)
    v_rcp_f32 v235, v235
    v_mfma_f32_16x16x32_bf16 v[16:19], a[24:27], v[208:211], v[16:19]
    v_mul_f32 v234, v70, v234
    v_mul_f32 v235, v71, v235
    v_mfma_f32_16x16x32_bf16 v[16:19], a[28:31], v[212:215], v[16:19]
    s_add_u32 s30, s24, 561152
    v_cvt_pk_bf16_f32 v180, v234, v235
    v_mul_f32 v72, v72, v248
    v_mfma_f32_16x16x32_bf16 v[16:19], a[32:35], v[216:219], v[16:19]
    s_waitcnt vmcnt(14)
    v_mul_f32 v73, v73, v248
    v_fma_f32 v236, -v72, v72, s29
    v_mfma_f32_16x16x32_bf16 v[20:23], a[36:39], v[184:187], 0
    ds_read_b128 v[220:223], v1 offset:9216
    ds_read_b128 v[224:227], v1 offset:10240
    v_mfma_f32_16x16x32_bf16 v[20:23], a[40:43], v[188:191], v[20:23]
    ds_read_b128 v[228:231], v1 offset:11264
    v_fma_f32 v237, -v73, v73, s29
    v_mfma_f32_16x16x32_bf16 v[20:23], a[44:47], v[192:195], v[20:23]
    buffer_load_dwordx4 a[116:119], v3, s[4:7], s30 offen sc1
    v_mfma_f32_16x16x32_bf16 v[20:23], a[48:51], v[196:199], v[20:23]
    v_mul_f32 v236, v236, v72
    v_mul_f32 v237, v237, v73
    v_mfma_f32_16x16x32_bf16 v[20:23], a[52:55], v[200:203], v[20:23]
    s_add_u32 s30, s24, 565248
    v_exp_f32 v236, v236
    v_mfma_f32_16x16x32_bf16 v[20:23], a[56:59], v[204:207], v[20:23]
    v_exp_f32 v237, v237
    v_mfma_f32_16x16x32_bf16 v[20:23], a[60:63], v[208:211], v[20:23]
    buffer_load_dwordx4 a[120:123], v3, s[4:7], s30 offen sc1
    v_mfma_f32_16x16x32_bf16 v[20:23], a[64:67], v[212:215], v[20:23]
    ds_read_b128 a[232:235], v1 offset:12288
    ds_read_b128 a[236:239], v1 offset:13312
    v_mfma_f32_16x16x32_bf16 v[20:23], a[68:71], v[216:219], v[20:23]
    s_waitcnt vmcnt(6)
    ds_read_b128 a[240:243], v1 offset:14336
    v_mul_f32 v74, v72, v74
    v_mfma_f32_16x16x32_bf16 v[24:27], a[72:75], v[184:187], 0
    s_add_u32 s30, s24, 569344
    ds_read_b128 a[244:247], v1 offset:15360
    ds_read_b128 a[248:251], v1 offset:16384
    v_mfma_f32_16x16x32_bf16 v[24:27], a[76:79], v[188:191], v[24:27]
    ds_read_b128 a[252:255], v1 offset:17408
    v_mul_f32 v75, v73, v75
    v_mfma_f32_16x16x32_bf16 v[24:27], a[80:83], v[192:195], v[24:27]
    buffer_load_dwordx4 a[124:127], v3, s[4:7], s30 offen sc1
    v_mfma_f32_16x16x32_bf16 v[24:27], a[84:87], v[196:199], v[24:27]
    v_add_f32 v236, 1.0, v236
    v_add_f32 v237, 1.0, v237
    v_mfma_f32_16x16x32_bf16 v[24:27], a[88:91], v[200:203], v[24:27]
    v_rcp_f32 v236, v236
    v_mfma_f32_16x16x32_bf16 v[24:27], a[92:95], v[204:207], v[24:27]
    v_rcp_f32 v237, v237
    v_mfma_f32_16x16x32_bf16 v[24:27], a[96:99], v[208:211], v[24:27]
    s_add_u32 s30, s24, 573440
    v_mul_f32 v236, v74, v236
    v_mul_f32 v237, v75, v237
    v_mfma_f32_16x16x32_bf16 v[24:27], a[100:103], v[212:215], v[24:27]
    v_cvt_pk_bf16_f32 v160, v236, v237
    v_mul_f32 v76, v76, v249
    v_mfma_f32_16x16x32_bf16 v[24:27], a[104:107], v[216:219], v[24:27]
    s_waitcnt lgkmcnt(3)
    v_mul_f32 v77, v77, v249
    v_fma_f32 v238, -v76, v76, s29
    v_mfma_f32_16x16x32_bf16 v[28:31], a[0:3], v[220:223], 0
    buffer_load_dwordx4 a[128:131], v3, s[4:7], s30 offen sc1
    v_mfma_f32_16x16x32_bf16 v[28:31], a[4:7], v[224:227], v[28:31]
    v_fma_f32 v239, -v77, v77, s29
    v_mul_f32 v238, v238, v76
    v_mfma_f32_16x16x32_bf16 v[28:31], a[8:11], v[228:231], v[28:31]
    s_add_u32 s30, s24, 577536
    v_mul_f32 v239, v239, v77
    v_mul_f32 v78, v76, v78
    v_mfma_f32_16x16x32_bf16 v[28:31], a[12:15], a[232:235], v[28:31]
    buffer_store_dwordx4 v[128:131], v3, s[4:7], s61 offen sc1
    v_mfma_f32_16x16x32_bf16 v[28:31], a[16:19], a[236:239], v[28:31]
    v_exp_f32 v238, v238
    v_mfma_f32_16x16x32_bf16 v[28:31], a[20:23], a[240:243], v[28:31]
    s_waitcnt lgkmcnt(0)
    v_exp_f32 v239, v239
    v_mfma_f32_16x16x32_bf16 v[28:31], a[24:27], a[244:247], v[28:31]
    v_mul_f32 v79, v77, v79
    v_add_f32 v238, 1.0, v238
    v_mfma_f32_16x16x32_bf16 v[28:31], a[28:31], a[248:251], v[28:31]
    v_add_f32 v239, 1.0, v239
    v_mul_f32 v80, v80, v249
    v_mfma_f32_16x16x32_bf16 v[28:31], a[32:35], a[252:255], v[28:31]
    v_rcp_f32 v238, v238
    v_mfma_f32_16x16x32_bf16 v[32:35], a[36:39], v[220:223], 0
    ds_read_b128 v[184:187], v1 offset:18432
    ds_read_b128 v[188:191], v1 offset:19456
    v_mfma_f32_16x16x32_bf16 v[32:35], a[40:43], v[224:227], v[32:35]
    ds_read_b128 v[192:195], v1 offset:20480
    v_mul_f32 v238, v78, v238
    v_mfma_f32_16x16x32_bf16 v[32:35], a[44:47], v[228:231], v[32:35]
    buffer_load_dwordx4 a[132:135], v3, s[4:7], s30 offen sc1
    v_mfma_f32_16x16x32_bf16 v[32:35], a[48:51], a[232:235], v[32:35]
    v_rcp_f32 v239, v239
    v_mfma_f32_16x16x32_bf16 v[32:35], a[52:55], a[236:239], v[32:35]
    s_add_u32 s30, s24, 581632
    v_mul_f32 v239, v79, v239
    v_mul_f32 v81, v81, v249
    v_mfma_f32_16x16x32_bf16 v[32:35], a[56:59], a[240:243], v[32:35]
    v_cvt_pk_bf16_f32 v135, v238, v239
    v_fma_f32 v240, -v80, v80, s29
    v_mfma_f32_16x16x32_bf16 v[32:35], a[60:63], a[244:247], v[32:35]
    buffer_load_dwordx4 a[136:139], v3, s[4:7], s30 offen sc1
    v_mfma_f32_16x16x32_bf16 v[32:35], a[64:67], a[248:251], v[32:35]
    ds_read_b128 v[196:199], v1 offset:21504
    ds_read_b128 v[200:203], v1 offset:22528
    v_mfma_f32_16x16x32_bf16 v[32:35], a[68:71], a[252:255], v[32:35]
    ds_read_b128 v[204:207], v1 offset:23552
    v_fma_f32 v241, -v81, v81, s29
    v_mfma_f32_16x16x32_bf16 v[36:39], a[72:75], v[220:223], 0
    s_add_u32 s30, s24, 585728
    ds_read_b128 v[208:211], v1 offset:24576
    ds_read_b128 v[212:215], v1 offset:25600
    v_mfma_f32_16x16x32_bf16 v[36:39], a[76:79], v[224:227], v[36:39]
    ds_read_b128 v[216:219], v1 offset:26624
    v_mul_f32 v240, v240, v80
    v_mfma_f32_16x16x32_bf16 v[36:39], a[80:83], v[228:231], v[36:39]
    buffer_load_dwordx4 a[140:143], v3, s[4:7], s30 offen sc1
    v_mfma_f32_16x16x32_bf16 v[36:39], a[84:87], a[232:235], v[36:39]
    v_mul_f32 v241, v241, v81
    v_mul_f32 v82, v80, v82
    v_mfma_f32_16x16x32_bf16 v[36:39], a[88:91], a[236:239], v[36:39]
    v_exp_f32 v240, v240
    v_mfma_f32_16x16x32_bf16 v[36:39], a[92:95], a[240:243], v[36:39]
    v_exp_f32 v241, v241
    v_mfma_f32_16x16x32_bf16 v[36:39], a[96:99], a[244:247], v[36:39]
    s_add_u32 s30, s24, 589824
    v_mul_f32 v83, v81, v83
    v_add_f32 v240, 1.0, v240
    v_mfma_f32_16x16x32_bf16 v[36:39], a[100:103], a[248:251], v[36:39]
    v_add_f32 v241, 1.0, v241
    v_mul_f32 v84, v84, v249
    v_mfma_f32_16x16x32_bf16 v[36:39], a[104:107], a[252:255], v[36:39]
    s_waitcnt lgkmcnt(3)
    v_rcp_f32 v240, v240
    v_mfma_f32_16x16x32_bf16 v[40:43], a[0:3], v[184:187], 0
    buffer_load_dwordx4 a[144:147], v3, s[4:7], s30 offen sc1
    v_mfma_f32_16x16x32_bf16 v[40:43], a[4:7], v[188:191], v[40:43]
    v_rcp_f32 v241, v241
    v_mfma_f32_16x16x32_bf16 v[40:43], a[8:11], v[192:195], v[40:43]
    s_add_u32 s30, s24, 593920
    v_mul_f32 v240, v82, v240
    v_mul_f32 v241, v83, v241
    v_mfma_f32_16x16x32_bf16 v[40:43], a[12:15], v[196:199], v[40:43]
    v_cvt_pk_bf16_f32 v181, v240, v241
    v_mul_f32 v85, v85, v249
    v_mfma_f32_16x16x32_bf16 v[40:43], a[16:19], v[200:203], v[40:43]
    buffer_load_dwordx4 a[148:151], v3, s[4:7], s30 offen sc1
    v_mfma_f32_16x16x32_bf16 v[40:43], a[20:23], v[204:207], v[40:43]
    s_waitcnt lgkmcnt(0)
    v_fma_f32 v242, -v84, v84, s29
    v_fma_f32 v243, -v85, v85, s29
    v_mfma_f32_16x16x32_bf16 v[40:43], a[24:27], v[208:211], v[40:43]
    v_mul_f32 v242, v242, v84
    v_mul_f32 v243, v243, v85
    v_mfma_f32_16x16x32_bf16 v[40:43], a[28:31], v[212:215], v[40:43]
    v_exp_f32 v242, v242
    v_mfma_f32_16x16x32_bf16 v[40:43], a[32:35], v[216:219], v[40:43]
    s_add_u32 s30, s24, 598016
    v_exp_f32 v243, v243
    v_mfma_f32_16x16x32_bf16 v[44:47], a[36:39], v[184:187], 0
    ds_read_b128 v[220:223], v1 offset:27648
    ds_read_b128 v[224:227], v1 offset:28672
    v_mfma_f32_16x16x32_bf16 v[44:47], a[40:43], v[188:191], v[44:47]
    ds_read_b128 v[228:231], v1 offset:29696
    v_mul_f32 v86, v84, v86
    v_mfma_f32_16x16x32_bf16 v[44:47], a[44:47], v[192:195], v[44:47]
    buffer_load_dwordx4 a[152:155], v3, s[4:7], s30 offen sc1
    v_mfma_f32_16x16x32_bf16 v[44:47], a[48:51], v[196:199], v[44:47]
    v_mul_f32 v87, v85, v87
    v_add_f32 v242, 1.0, v242
    v_mfma_f32_16x16x32_bf16 v[44:47], a[52:55], v[200:203], v[44:47]
    s_add_u32 s30, s24, 602112
    v_add_f32 v243, 1.0, v243
    v_mul_f32 v88, v88, v250
    v_mfma_f32_16x16x32_bf16 v[44:47], a[56:59], v[204:207], v[44:47]
    v_rcp_f32 v242, v242
    v_mfma_f32_16x16x32_bf16 v[44:47], a[60:63], v[208:211], v[44:47]
    buffer_load_dwordx4 a[156:159], v3, s[4:7], s30 offen sc1
    v_mfma_f32_16x16x32_bf16 v[44:47], a[64:67], v[212:215], v[44:47]
    ds_read_b128 a[232:235], v1 offset:30720
    ds_read_b128 a[236:239], v1 offset:31744
    v_mfma_f32_16x16x32_bf16 v[44:47], a[68:71], v[216:219], v[44:47]
    ds_read_b128 a[240:243], v1 offset:32768
    v_mul_f32 v242, v86, v242
    v_mfma_f32_16x16x32_bf16 v[48:51], a[72:75], v[184:187], 0
    ds_read_b128 a[244:247], v1 offset:33792
    ds_read_b128 a[248:251], v1 offset:34816
    v_mfma_f32_16x16x32_bf16 v[48:51], a[76:79], v[188:191], v[48:51]
    s_add_u32 s30, s24, 606208
    ds_read_b128 a[252:255], v1 offset:35840
    v_mul_f32 v89, v89, v250
    v_mfma_f32_16x16x32_bf16 v[48:51], a[80:83], v[192:195], v[48:51]
    v_rcp_f32 v243, v243
    v_mfma_f32_16x16x32_bf16 v[48:51], a[84:87], v[196:199], v[48:51]
    buffer_load_dwordx4 a[160:163], v3, s[4:7], s30 offen sc1
    v_mfma_f32_16x16x32_bf16 v[48:51], a[88:91], v[200:203], v[48:51]
    v_mul_f32 v243, v87, v243
    v_fma_f32 v232, -v88, v88, s29
    v_mfma_f32_16x16x32_bf16 v[48:51], a[92:95], v[204:207], v[48:51]
    v_cvt_pk_bf16_f32 v164, v242, v243
    v_fma_f32 v233, -v89, v89, s29
    v_mfma_f32_16x16x32_bf16 v[48:51], a[96:99], v[208:211], v[48:51]
    s_add_u32 s30, s24, 610304
    v_mul_f32 v232, v232, v88
    v_mul_f32 v233, v233, v89
    v_mfma_f32_16x16x32_bf16 v[48:51], a[100:103], v[212:215], v[48:51]
    buffer_store_dwordx4 v[132:135], v3, s[4:7], s62 offen sc1
    v_mfma_f32_16x16x32_bf16 v[48:51], a[104:107], v[216:219], v[48:51]
    s_waitcnt lgkmcnt(3)
    v_exp_f32 v232, v232
    v_mfma_f32_16x16x32_bf16 v[52:55], a[0:3], v[220:223], 0
    v_exp_f32 v233, v233
    v_mfma_f32_16x16x32_bf16 v[52:55], a[4:7], v[224:227], v[52:55]
    v_mul_f32 v90, v88, v90
    v_mul_f32 v91, v89, v91
    v_mfma_f32_16x16x32_bf16 v[52:55], a[8:11], v[228:231], v[52:55]
    v_add_f32 v232, 1.0, v232
    v_add_f32 v233, 1.0, v233
    v_mfma_f32_16x16x32_bf16 v[52:55], a[12:15], a[232:235], v[52:55]
    v_rcp_f32 v232, v232
    v_mfma_f32_16x16x32_bf16 v[52:55], a[16:19], a[236:239], v[52:55]
    v_rcp_f32 v233, v233
    v_mfma_f32_16x16x32_bf16 v[52:55], a[20:23], a[240:243], v[52:55]
    s_waitcnt lgkmcnt(0)
    v_mul_f32 v232, v90, v232
    v_mul_f32 v233, v91, v233
    v_mfma_f32_16x16x32_bf16 v[52:55], a[24:27], a[244:247], v[52:55]
    buffer_load_dwordx4 a[164:167], v3, s[4:7], s30 offen sc1
    v_mfma_f32_16x16x32_bf16 v[52:55], a[28:31], a[248:251], v[52:55]
    v_cvt_pk_bf16_f32 v139, v232, v233
    v_mul_f32 v92, v92, v250
    v_mfma_f32_16x16x32_bf16 v[52:55], a[32:35], a[252:255], v[52:55]
    s_add_u32 s30, s24, 614400
    v_mul_f32 v93, v93, v250
    v_fma_f32 v234, -v92, v92, s29
    v_mfma_f32_16x16x32_bf16 v[56:59], a[36:39], v[220:223], 0
    ds_read_b128 v[184:187], v1 offset:36864
    ds_read_b128 v[188:191], v1 offset:37888
    v_mfma_f32_16x16x32_bf16 v[56:59], a[40:43], v[224:227], v[56:59]
    ds_read_b128 v[192:195], v1 offset:38912
    v_fma_f32 v235, -v93, v93, s29
    v_mfma_f32_16x16x32_bf16 v[56:59], a[44:47], v[228:231], v[56:59]
    buffer_load_dwordx4 a[168:171], v3, s[4:7], s30 offen sc1
    v_mfma_f32_16x16x32_bf16 v[56:59], a[48:51], a[232:235], v[56:59]
    v_mul_f32 v234, v234, v92
    v_mul_f32 v235, v235, v93
    v_mfma_f32_16x16x32_bf16 v[56:59], a[52:55], a[236:239], v[56:59]
    s_add_u32 s30, s24, 618496
    v_exp_f32 v234, v234
    v_mfma_f32_16x16x32_bf16 v[56:59], a[56:59], a[240:243], v[56:59]
    v_exp_f32 v235, v235
    v_mfma_f32_16x16x32_bf16 v[56:59], a[60:63], a[244:247], v[56:59]
    buffer_load_dwordx4 a[172:175], v3, s[4:7], s30 offen sc1
    v_mfma_f32_16x16x32_bf16 v[56:59], a[64:67], a[248:251], v[56:59]
    ds_read_b128 v[196:199], v1 offset:39936
    ds_read_b128 v[200:203], v1 offset:40960
    v_mfma_f32_16x16x32_bf16 v[56:59], a[68:71], a[252:255], v[56:59]
    ds_read_b128 v[204:207], v1 offset:41984
    v_mul_f32 v94, v92, v94
    v_mfma_f32_16x16x32_bf16 v[60:63], a[72:75], v[220:223], 0
    ds_read_b128 v[208:211], v1 offset:43008
    ds_read_b128 v[212:215], v1 offset:44032
    v_mfma_f32_16x16x32_bf16 v[60:63], a[76:79], v[224:227], v[60:63]
    s_add_u32 s30, s24, 622592
    ds_read_b128 v[216:219], v1 offset:45056
    v_mul_f32 v95, v93, v95
    v_mfma_f32_16x16x32_bf16 v[60:63], a[80:83], v[228:231], v[60:63]
    v_add_f32 v234, 1.0, v234
    v_add_f32 v235, 1.0, v235
    v_mfma_f32_16x16x32_bf16 v[60:63], a[84:87], a[232:235], v[60:63]
    buffer_load_dwordx4 a[176:179], v3, s[4:7], s30 offen sc1
    v_mfma_f32_16x16x32_bf16 v[60:63], a[88:91], a[236:239], v[60:63]
    v_rcp_f32 v234, v234
    v_mfma_f32_16x16x32_bf16 v[60:63], a[92:95], a[240:243], v[60:63]
    v_rcp_f32 v235, v235
    v_mfma_f32_16x16x32_bf16 v[60:63], a[96:99], a[244:247], v[60:63]
    s_add_u32 s30, s24, 626688
    v_mul_f32 v234, v94, v234
    v_mul_f32 v235, v95, v235
    v_mfma_f32_16x16x32_bf16 v[60:63], a[100:103], a[248:251], v[60:63]
    v_cvt_pk_bf16_f32 v182, v234, v235
    v_mul_f32 v96, v96, v250
    v_mfma_f32_16x16x32_bf16 v[60:63], a[104:107], a[252:255], v[60:63]
    s_waitcnt lgkmcnt(3)
    v_mul_f32 v97, v97, v250
    v_fma_f32 v236, -v96, v96, s29
    v_mfma_f32_16x16x32_bf16 v[64:67], a[0:3], v[184:187], 0
    buffer_load_dwordx4 a[180:183], v3, s[4:7], s30 offen sc1
    v_mfma_f32_16x16x32_bf16 v[64:67], a[4:7], v[188:191], v[64:67]
    v_fma_f32 v237, -v97, v97, s29
    v_mul_f32 v236, v236, v96
    v_mfma_f32_16x16x32_bf16 v[64:67], a[8:11], v[192:195], v[64:67]
    v_mul_f32 v237, v237, v97
    v_mul_f32 v98, v96, v98
    v_mfma_f32_16x16x32_bf16 v[64:67], a[12:15], v[196:199], v[64:67]
    s_add_u32 s30, s24, 630784
    v_exp_f32 v236, v236
    v_mfma_f32_16x16x32_bf16 v[64:67], a[16:19], v[200:203], v[64:67]
    v_exp_f32 v237, v237
    v_mfma_f32_16x16x32_bf16 v[64:67], a[20:23], v[204:207], v[64:67]
    s_waitcnt lgkmcnt(0)
    v_mul_f32 v99, v97, v99
    v_add_f32 v236, 1.0, v236
    v_mfma_f32_16x16x32_bf16 v[64:67], a[24:27], v[208:211], v[64:67]
    buffer_load_dwordx4 a[184:187], v3, s[4:7], s30 offen sc1
    v_mfma_f32_16x16x32_bf16 v[64:67], a[28:31], v[212:215], v[64:67]
    v_add_f32 v237, 1.0, v237
    v_mul_f32 v100, v100, v251
    v_mfma_f32_16x16x32_bf16 v[64:67], a[32:35], v[216:219], v[64:67]
    s_add_u32 s30, s24, 634880
    v_rcp_f32 v236, v236
    v_mfma_f32_16x16x32_bf16 v[68:71], a[36:39], v[184:187], 0
    ds_read_b128 v[220:223], v1 offset:46080
    ds_read_b128 v[224:227], v1 offset:47104
    v_mfma_f32_16x16x32_bf16 v[68:71], a[40:43], v[188:191], v[68:71]
    ds_read_b128 v[228:231], v1 offset:48128
    v_mul_f32 v236, v98, v236
    v_mfma_f32_16x16x32_bf16 v[68:71], a[44:47], v[192:195], v[68:71]
    buffer_load_dwordx4 a[188:191], v3, s[4:7], s30 offen sc1
    v_mfma_f32_16x16x32_bf16 v[68:71], a[48:51], v[196:199], v[68:71]
    v_rcp_f32 v237, v237
    v_mfma_f32_16x16x32_bf16 v[68:71], a[52:55], v[200:203], v[68:71]
    v_mul_f32 v237, v99, v237
    v_mul_f32 v101, v101, v251
    v_mfma_f32_16x16x32_bf16 v[68:71], a[56:59], v[204:207], v[68:71]
    s_add_u32 s30, s24, 638976
    v_cvt_pk_bf16_f32 v168, v236, v237
    v_fma_f32 v238, -v100, v100, s29
    v_mfma_f32_16x16x32_bf16 v[68:71], a[60:63], v[208:211], v[68:71]
    buffer_store_dwordx4 v[136:139], v3, s[4:7], s63 offen sc1
    v_mfma_f32_16x16x32_bf16 v[68:71], a[64:67], v[212:215], v[68:71]
    ds_read_b128 a[232:235], v1 offset:49152
    ds_read_b128 a[236:239], v1 offset:50176
    v_mfma_f32_16x16x32_bf16 v[68:71], a[68:71], v[216:219], v[68:71]
    ds_read_b128 a[240:243], v1 offset:51200
    v_fma_f32 v239, -v101, v101, s29
    v_mfma_f32_16x16x32_bf16 v[72:75], a[72:75], v[184:187], 0
    ds_read_b128 a[244:247], v1 offset:52224
    ds_read_b128 a[248:251], v1 offset:53248
    v_mfma_f32_16x16x32_bf16 v[72:75], a[76:79], v[188:191], v[72:75]
    ds_read_b128 a[252:255], v1 offset:54272
    v_mul_f32 v238, v238, v100
    v_mfma_f32_16x16x32_bf16 v[72:75], a[80:83], v[192:195], v[72:75]
    buffer_load_dwordx4 a[192:195], v3, s[4:7], s30 offen sc1
    v_mfma_f32_16x16x32_bf16 v[72:75], a[84:87], v[196:199], v[72:75]
    v_mul_f32 v239, v239, v101
    v_mul_f32 v102, v100, v102
    v_mfma_f32_16x16x32_bf16 v[72:75], a[88:91], v[200:203], v[72:75]
    s_add_u32 s30, s24, 643072
    v_exp_f32 v238, v238
    v_mfma_f32_16x16x32_bf16 v[72:75], a[92:95], v[204:207], v[72:75]
    v_exp_f32 v239, v239
    v_mfma_f32_16x16x32_bf16 v[72:75], a[96:99], v[208:211], v[72:75]
    v_mul_f32 v103, v101, v103
    v_add_f32 v238, 1.0, v238
    v_mfma_f32_16x16x32_bf16 v[72:75], a[100:103], v[212:215], v[72:75]
    v_add_f32 v239, 1.0, v239
    v_mul_f32 v104, v104, v251
    v_mfma_f32_16x16x32_bf16 v[72:75], a[104:107], v[216:219], v[72:75]
    s_waitcnt lgkmcnt(3)
    v_rcp_f32 v238, v238
    v_mfma_f32_16x16x32_bf16 v[76:79], a[0:3], v[220:223], 0
    v_rcp_f32 v239, v239
    v_mfma_f32_16x16x32_bf16 v[76:79], a[4:7], v[224:227], v[76:79]
    global_load_dword v255, v13, s[10:11]
    v_mfma_f32_16x16x32_bf16 v[76:79], a[8:11], v[228:231], v[76:79]
    buffer_load_dwordx4 a[196:199], v3, s[4:7], s30 offen sc1
    v_mfma_f32_16x16x32_bf16 v[76:79], a[12:15], a[232:235], v[76:79]
    v_mul_f32 v238, v102, v238
    v_mul_f32 v239, v103, v239
    v_mfma_f32_16x16x32_bf16 v[76:79], a[16:19], a[236:239], v[76:79]
    s_add_u32 s30, s24, 647168
    v_cvt_pk_bf16_f32 v143, v238, v239
    v_mul_f32 v105, v105, v251
    v_mfma_f32_16x16x32_bf16 v[76:79], a[20:23], a[240:243], v[76:79]
    s_waitcnt lgkmcnt(0)
    v_fma_f32 v240, -v104, v104, s29
    v_fma_f32 v241, -v105, v105, s29
    v_mfma_f32_16x16x32_bf16 v[76:79], a[24:27], a[244:247], v[76:79]
    buffer_load_dwordx4 a[200:203], v3, s[4:7], s30 offen sc1
    v_mfma_f32_16x16x32_bf16 v[76:79], a[28:31], a[248:251], v[76:79]
    v_mul_f32 v240, v240, v104
    v_mul_f32 v241, v241, v105
    v_mfma_f32_16x16x32_bf16 v[76:79], a[32:35], a[252:255], v[76:79]
    v_exp_f32 v240, v240
    v_mfma_f32_16x16x32_bf16 v[80:83], a[36:39], v[220:223], 0
    s_add_u32 s30, s24, 651264
    ds_read_b128 v[184:187], v1 offset:55296
    ds_read_b128 v[188:191], v1 offset:56320
    v_mfma_f32_16x16x32_bf16 v[80:83], a[40:43], v[224:227], v[80:83]
    ds_read_b128 v[192:195], v1 offset:57344
    v_mul_f32 v106, v104, v106
    v_mfma_f32_16x16x32_bf16 v[80:83], a[44:47], v[228:231], v[80:83]
    buffer_load_dwordx4 a[204:207], v3, s[4:7], s30 offen sc1
    v_mfma_f32_16x16x32_bf16 v[80:83], a[48:51], a[232:235], v[80:83]
    v_exp_f32 v241, v241
    v_mfma_f32_16x16x32_bf16 v[80:83], a[52:55], a[236:239], v[80:83]
    v_mul_f32 v107, v105, v107
    v_add_f32 v240, 1.0, v240
    v_mfma_f32_16x16x32_bf16 v[80:83], a[56:59], a[240:243], v[80:83]
    v_add_f32 v241, 1.0, v241
    v_mul_f32 v108, v108, v251
    v_mfma_f32_16x16x32_bf16 v[80:83], a[60:63], a[244:247], v[80:83]
    s_add_u32 s30, s24, 655360
    v_rcp_f32 v240, v240
    v_mfma_f32_16x16x32_bf16 v[80:83], a[64:67], a[248:251], v[80:83]
    ds_read_b128 v[196:199], v1 offset:58368
    ds_read_b128 v[200:203], v1 offset:59392
    v_mfma_f32_16x16x32_bf16 v[80:83], a[68:71], a[252:255], v[80:83]
    ds_read_b128 v[204:207], v1 offset:60416
    v_mul_f32 v240, v106, v240
    v_mfma_f32_16x16x32_bf16 v[84:87], a[72:75], v[220:223], 0
    ds_read_b128 v[208:211], v1 offset:61440
    ds_read_b128 v[212:215], v1 offset:62464
    v_mfma_f32_16x16x32_bf16 v[84:87], a[76:79], v[224:227], v[84:87]
    ds_read_b128 v[216:219], v1 offset:63488
    v_mul_f32 v109, v109, v251
    v_mfma_f32_16x16x32_bf16 v[84:87], a[80:83], v[228:231], v[84:87]
    buffer_load_dwordx4 a[208:211], v3, s[4:7], s30 offen sc1
    v_mfma_f32_16x16x32_bf16 v[84:87], a[84:87], a[232:235], v[84:87]
    v_rcp_f32 v241, v241
    v_mfma_f32_16x16x32_bf16 v[84:87], a[88:91], a[236:239], v[84:87]
    s_add_u32 s30, s24, 659456
    v_mul_f32 v241, v107, v241
    v_fma_f32 v242, -v108, v108, s29
    v_mfma_f32_16x16x32_bf16 v[84:87], a[92:95], a[240:243], v[84:87]
    v_cvt_pk_bf16_f32 v183, v240, v241
    v_fma_f32 v243, -v109, v109, s29
    v_mfma_f32_16x16x32_bf16 v[84:87], a[96:99], a[244:247], v[84:87]
    buffer_load_dwordx4 a[212:215], v3, s[4:7], s30 offen sc1
    v_mfma_f32_16x16x32_bf16 v[84:87], a[100:103], a[248:251], v[84:87]
    v_mul_f32 v242, v242, v108
    v_mul_f32 v243, v243, v109
    v_mfma_f32_16x16x32_bf16 v[84:87], a[104:107], a[252:255], v[84:87]
    s_waitcnt lgkmcnt(3)
    v_exp_f32 v242, v242
    v_mfma_f32_16x16x32_bf16 v[88:91], a[0:3], v[184:187], 0
    s_add_u32 s30, s24, 765952
    v_exp_f32 v243, v243
    v_mfma_f32_16x16x32_bf16 v[88:91], a[4:7], v[188:191], v[88:91]
    v_mul_f32 v110, v108, v110
    v_mul_f32 v111, v109, v111
    v_mfma_f32_16x16x32_bf16 v[88:91], a[8:11], v[192:195], v[88:91]
    buffer_load_dwordx4 a[216:219], v3, s[4:7], s30 offen sc1
    v_mfma_f32_16x16x32_bf16 v[88:91], a[12:15], v[196:199], v[88:91]
    v_add_f32 v242, 1.0, v242
    v_add_f32 v243, 1.0, v243
    v_mfma_f32_16x16x32_bf16 v[88:91], a[16:19], v[200:203], v[88:91]
    v_rcp_f32 v242, v242
    v_mfma_f32_16x16x32_bf16 v[88:91], a[20:23], v[204:207], v[88:91]
    s_waitcnt lgkmcnt(0)
    v_rcp_f32 v243, v243
    v_mfma_f32_16x16x32_bf16 v[88:91], a[24:27], v[208:211], v[88:91]
    s_add_u32 s30, s24, 770048
    v_mul_f32 v242, v110, v242
    v_mul_f32 v243, v111, v243
    v_mfma_f32_16x16x32_bf16 v[88:91], a[28:31], v[212:215], v[88:91]
    v_cvt_pk_bf16_f32 v172, v242, v243
    v_mfma_f32_16x16x32_bf16 v[88:91], a[32:35], v[216:219], v[88:91]
    buffer_load_dwordx4 a[220:223], v3, s[4:7], s30 offen sc1
    v_mfma_f32_16x16x32_bf16 v[92:95], a[36:39], v[184:187], 0
    ds_read_b128 v[220:223], v1 offset:64512
    ds_read_b128 v[224:227], v4 offset:0
    v_mfma_f32_16x16x32_bf16 v[92:95], a[40:43], v[188:191], v[92:95]
    ds_read_b128 v[228:231], v4 offset:1024
    v_mfma_f32_16x16x32_bf16 v[92:95], a[44:47], v[192:195], v[92:95]
    s_add_u32 s30, s24, 774144
    v_mfma_f32_16x16x32_bf16 v[92:95], a[48:51], v[196:199], v[92:95]
    buffer_store_dwordx4 v[140:143], v3, s[4:7], s23 offen sc1
    v_mfma_f32_16x16x32_bf16 v[92:95], a[52:55], v[200:203], v[92:95]
    v_mfma_f32_16x16x32_bf16 v[92:95], a[56:59], v[204:207], v[92:95]
    v_mfma_f32_16x16x32_bf16 v[92:95], a[60:63], v[208:211], v[92:95]
    v_mfma_f32_16x16x32_bf16 v[92:95], a[64:67], v[212:215], v[92:95]
    ds_read_b128 a[232:235], v4 offset:2048
    ds_read_b128 a[236:239], v4 offset:3072
    v_mfma_f32_16x16x32_bf16 v[92:95], a[68:71], v[216:219], v[92:95]
    ds_read_b128 a[240:243], v4 offset:4096
    v_mfma_f32_16x16x32_bf16 v[96:99], a[72:75], v[184:187], 0
    ds_read_b128 a[244:247], v4 offset:5120
    ds_read_b128 a[248:251], v4 offset:6144
    v_mfma_f32_16x16x32_bf16 v[96:99], a[76:79], v[188:191], v[96:99]
    ds_read_b128 a[252:255], v4 offset:7168
    v_mfma_f32_16x16x32_bf16 v[96:99], a[80:83], v[192:195], v[96:99]
    v_mfma_f32_16x16x32_bf16 v[96:99], a[84:87], v[196:199], v[96:99]
    buffer_load_dwordx4 a[224:227], v3, s[4:7], s30 offen sc1
    v_mfma_f32_16x16x32_bf16 v[96:99], a[88:91], v[200:203], v[96:99]
    v_mfma_f32_16x16x32_bf16 v[96:99], a[92:95], v[204:207], v[96:99]
    s_add_u32 s30, s24, 778240
    v_mfma_f32_16x16x32_bf16 v[96:99], a[96:99], v[208:211], v[96:99]
    v_mfma_f32_16x16x32_bf16 v[96:99], a[100:103], v[212:215], v[96:99]
    buffer_load_dwordx4 a[228:231], v3, s[4:7], s30 offen sc1
    v_mfma_f32_16x16x32_bf16 v[96:99], a[104:107], v[216:219], v[96:99]
    s_waitcnt lgkmcnt(3)
    v_mfma_f32_16x16x32_bf16 v[100:103], a[0:3], v[220:223], 0
    v_mfma_f32_16x16x32_bf16 v[100:103], a[4:7], v[224:227], v[100:103]
    v_mfma_f32_16x16x32_bf16 v[100:103], a[8:11], v[228:231], v[100:103]
    v_mfma_f32_16x16x32_bf16 v[100:103], a[12:15], a[232:235], v[100:103]
    v_mfma_f32_16x16x32_bf16 v[100:103], a[16:19], a[236:239], v[100:103]
    v_mfma_f32_16x16x32_bf16 v[100:103], a[20:23], a[240:243], v[100:103]
    s_waitcnt lgkmcnt(0)
    v_mfma_f32_16x16x32_bf16 v[100:103], a[24:27], a[244:247], v[100:103]
    v_mfma_f32_16x16x32_bf16 v[100:103], a[28:31], a[248:251], v[100:103]
    v_mfma_f32_16x16x32_bf16 v[100:103], a[32:35], a[252:255], v[100:103]
    v_mfma_f32_16x16x32_bf16 v[104:107], a[36:39], v[220:223], 0
    ds_read_b128 v[184:187], v4 offset:8192
    ds_read_b128 v[188:191], v4 offset:9216
    v_mfma_f32_16x16x32_bf16 v[104:107], a[40:43], v[224:227], v[104:107]
    ds_read_b128 v[192:195], v4 offset:10240
    v_mfma_f32_16x16x32_bf16 v[104:107], a[44:47], v[228:231], v[104:107]
    v_mfma_f32_16x16x32_bf16 v[104:107], a[48:51], a[232:235], v[104:107]
ffn1_part_pad0_6x:
    s_cbranch_execz ffn1_part_pad0_10x
    v_mfma_f32_16x16x32_bf16 v[104:107], a[52:55], a[236:239], v[104:107]
    v_mfma_f32_16x16x32_bf16 v[104:107], a[56:59], a[240:243], v[104:107]
    v_mfma_f32_16x16x32_bf16 v[104:107], a[60:63], a[244:247], v[104:107]
    v_mfma_f32_16x16x32_bf16 v[104:107], a[64:67], a[248:251], v[104:107]
    ds_read_b128 v[196:199], v4 offset:11264
    ds_read_b128 v[200:203], v4 offset:12288
    v_mfma_f32_16x16x32_bf16 v[104:107], a[68:71], a[252:255], v[104:107]
    ds_read_b128 v[204:207], v4 offset:13312
    v_mfma_f32_16x16x32_bf16 v[108:111], a[72:75], v[220:223], 0
    ds_read_b128 v[208:211], v4 offset:14336
    ds_read_b128 v[212:215], v4 offset:15360
    v_mfma_f32_16x16x32_bf16 v[108:111], a[76:79], v[224:227], v[108:111]
    ds_read_b128 v[216:219], v4 offset:16384
    v_mfma_f32_16x16x32_bf16 v[108:111], a[80:83], v[228:231], v[108:111]
    v_mfma_f32_16x16x32_bf16 v[108:111], a[84:87], a[232:235], v[108:111]
    v_mfma_f32_16x16x32_bf16 v[108:111], a[88:91], a[236:239], v[108:111]
    v_mfma_f32_16x16x32_bf16 v[108:111], a[92:95], a[240:243], v[108:111]
    v_mfma_f32_16x16x32_bf16 v[108:111], a[96:99], a[244:247], v[108:111]
    v_mfma_f32_16x16x32_bf16 v[108:111], a[100:103], a[248:251], v[108:111]
    s_add_u32 s30, s24, 663552
    v_mfma_f32_16x16x32_bf16 v[108:111], a[104:107], a[252:255], v[108:111]
    s_waitcnt vmcnt(26) lgkmcnt(3)
    v_mfma_f32_16x16x32_bf16 v[16:19], a[108:111], v[184:187], v[16:19]
    buffer_load_dwordx4 a[0:3], v3, s[4:7], s30 offen sc1
    v_mfma_f32_16x16x32_bf16 v[16:19], a[112:115], v[188:191], v[16:19]
    s_add_u32 s30, s24, 667648
    v_mfma_f32_16x16x32_bf16 v[16:19], a[116:119], v[192:195], v[16:19]
    buffer_load_dwordx4 a[4:7], v3, s[4:7], s30 offen sc1
    v_mfma_f32_16x16x32_bf16 v[16:19], a[120:123], v[196:199], v[16:19]
    s_barrier
    v_mfma_f32_16x16x32_bf16 v[16:19], a[124:127], v[200:203], v[16:19]
    ds_write_b32 v8, v176 offset:0
    v_mfma_f32_16x16x32_bf16 v[16:19], a[128:131], v[204:207], v[16:19]
    s_waitcnt lgkmcnt(1)
    ds_write_b128 v3, v[112:115] offset:0
    v_mfma_f32_16x16x32_bf16 v[16:19], a[132:135], v[208:211], v[16:19]
    s_add_u32 s30, s24, 671744
    v_mfma_f32_16x16x32_bf16 v[16:19], a[136:139], v[212:215], v[16:19]
    buffer_load_dwordx4 a[8:11], v3, s[4:7], s30 offen sc1
    v_mfma_f32_16x16x32_bf16 v[16:19], a[140:143], v[216:219], v[16:19]
    s_waitcnt vmcnt(19)
    v_mfma_f32_16x16x32_bf16 v[20:23], a[144:147], v[184:187], v[20:23]
    s_add_u32 s30, s24, 675840
    ds_read_b128 v[220:223], v4 offset:17408
    ds_read_b128 v[224:227], v4 offset:18432
    v_mfma_f32_16x16x32_bf16 v[20:23], a[148:151], v[188:191], v[20:23]
    ds_read_b128 v[228:231], v4 offset:19456
    v_mfma_f32_16x16x32_bf16 v[20:23], a[152:155], v[192:195], v[20:23]
    buffer_load_dwordx4 a[12:15], v3, s[4:7], s30 offen sc1
    v_mfma_f32_16x16x32_bf16 v[20:23], a[156:159], v[196:199], v[20:23]
    ds_write_b32 v8, v177 offset:9216
    v_mfma_f32_16x16x32_bf16 v[20:23], a[160:163], v[200:203], v[20:23]
    ds_write_b128 v3, v[116:119] offset:9216
    v_mfma_f32_16x16x32_bf16 v[20:23], a[164:167], v[204:207], v[20:23]
    s_add_u32 s30, s24, 679936
    v_mul_f32 v16, v16, v244
    v_mul_f32 v17, v17, v244
    v_mfma_f32_16x16x32_bf16 v[20:23], a[168:171], v[208:211], v[20:23]
    v_fma_f32 v232, -v16, v16, s29
    v_fma_f32 v233, -v17, v17, s29
    v_mfma_f32_16x16x32_bf16 v[20:23], a[172:175], v[212:215], v[20:23]
    buffer_load_dwordx4 a[16:19], v3, s[4:7], s30 offen sc1
    v_mfma_f32_16x16x32_bf16 v[20:23], a[176:179], v[216:219], v[20:23]
    s_waitcnt vmcnt(10)
    v_mul_f32 v232, v232, v16
    v_mul_f32 v233, v233, v17
    v_mfma_f32_16x16x32_bf16 v[24:27], a[180:183], v[184:187], v[24:27]
    s_add_u32 s30, s24, 684032
    v_exp_f32 v232, v232
    v_mfma_f32_16x16x32_bf16 v[24:27], a[184:187], v[188:191], v[24:27]
    ds_read_b128 v[184:187], v4 offset:20480
    v_mul_f32 v18, v16, v18
    v_mfma_f32_16x16x32_bf16 v[24:27], a[188:191], v[192:195], v[24:27]
    ds_read_b128 v[188:191], v4 offset:21504
    v_mul_f32 v19, v17, v19
    v_mfma_f32_16x16x32_bf16 v[24:27], a[192:195], v[196:199], v[24:27]
    ds_read_b128 v[192:195], v4 offset:22528
    v_add_f32 v232, 1.0, v232
    v_mfma_f32_16x16x32_bf16 v[24:27], a[196:199], v[200:203], v[24:27]
    ds_read_b128 v[196:199], v4 offset:23552
    v_mul_f32 v20, v20, v244
    v_mfma_f32_16x16x32_bf16 v[24:27], a[200:203], v[204:207], v[24:27]
    ds_read_b128 v[200:203], v4 offset:24576
    v_mul_f32 v21, v21, v244
    v_mfma_f32_16x16x32_bf16 v[24:27], a[204:207], v[208:211], v[24:27]
    ds_read_b128 v[204:207], v4 offset:25600
    v_fma_f32 v234, -v20, v20, s29
    v_mfma_f32_16x16x32_bf16 v[24:27], a[208:211], v[212:215], v[24:27]
    buffer_load_dwordx4 a[20:23], v3, s[4:7], s30 offen sc1
    v_mfma_f32_16x16x32_bf16 v[24:27], a[212:215], v[216:219], v[24:27]
    s_waitcnt lgkmcnt(8)
    ds_write_b32 v8, v178 offset:18432
    v_mfma_f32_16x16x32_bf16 v[28:31], a[108:111], v[220:223], v[28:31]
    s_add_u32 s30, s24, 688128
    ds_write_b128 v3, v[120:123] offset:18432
    v_mfma_f32_16x16x32_bf16 v[28:31], a[112:115], v[224:227], v[28:31]
    buffer_load_dwordx4 a[24:27], v3, s[4:7], s30 offen sc1
    v_mfma_f32_16x16x32_bf16 v[28:31], a[116:119], v[228:231], v[28:31]
    s_waitcnt lgkmcnt(6)
    v_exp_f32 v233, v233
    v_mfma_f32_16x16x32_bf16 v[28:31], a[120:123], v[184:187], v[28:31]
    s_add_u32 s30, s24, 692224
    v_add_f32 v233, 1.0, v233
    v_fma_f32 v235, -v21, v21, s29
    v_mfma_f32_16x16x32_bf16 v[28:31], a[124:127], v[188:191], v[28:31]
    s_waitcnt lgkmcnt(4)
    v_rcp_f32 v232, v232
    v_mul_f32 v234, v234, v20
    v_mfma_f32_16x16x32_bf16 v[28:31], a[128:131], v[192:195], v[28:31]
    buffer_load_dwordx4 a[28:31], v3, s[4:7], s30 offen sc1
    v_mfma_f32_16x16x32_bf16 v[28:31], a[132:135], v[196:199], v[28:31]
    s_waitcnt lgkmcnt(2)
    ds_write_b32 v8, v179 offset:27648
    v_mfma_f32_16x16x32_bf16 v[28:31], a[136:139], v[200:203], v[28:31]
    s_add_u32 s30, s24, 696320
    v_rcp_f32 v233, v233
    v_mfma_f32_16x16x32_bf16 v[28:31], a[140:143], v[204:207], v[28:31]
    v_mul_f32 v232, v18, v232
    v_mul_f32 v233, v19, v233
    v_mfma_f32_16x16x32_bf16 v[32:35], a[144:147], v[220:223], v[32:35]
    ds_read_b128 v[208:211], v4 offset:26624
    ds_read_b128 v[212:215], v4 offset:27648
    v_mfma_f32_16x16x32_bf16 v[32:35], a[148:151], v[224:227], v[32:35]
    ds_read_b128 v[216:219], v4 offset:28672
    v_cvt_pk_bf16_f32 v145, v232, v233
    v_mfma_f32_16x16x32_bf16 v[32:35], a[152:155], v[228:231], v[32:35]
    buffer_load_dwordx4 a[32:35], v3, s[4:7], s30 offen sc1
    v_mul_f32 v235, v235, v21
    v_mfma_f32_16x16x32_bf16 v[32:35], a[156:159], v[184:187], v[32:35]
    s_add_u32 s30, s24, 700416
    ds_write_b128 v3, v[124:127] offset:27648
    v_mfma_f32_16x16x32_bf16 v[32:35], a[160:163], v[188:191], v[32:35]
    v_exp_f32 v234, v234
    v_mfma_f32_16x16x32_bf16 v[32:35], a[164:167], v[192:195], v[32:35]
    buffer_load_dwordx4 a[36:39], v3, s[4:7], s30 offen sc1
    v_mfma_f32_16x16x32_bf16 v[32:35], a[168:171], v[196:199], v[32:35]
    v_exp_f32 v235, v235
    v_mfma_f32_16x16x32_bf16 v[32:35], a[172:175], v[200:203], v[32:35]
    s_add_u32 s30, s24, 704512
    v_mul_f32 v22, v20, v22
    v_mul_f32 v23, v21, v23
    v_mfma_f32_16x16x32_bf16 v[32:35], a[176:179], v[204:207], v[32:35]
    v_add_f32 v234, 1.0, v234
    v_add_f32 v235, 1.0, v235
    v_mfma_f32_16x16x32_bf16 v[36:39], a[180:183], v[220:223], v[36:39]
    buffer_load_dwordx4 a[40:43], v3, s[4:7], s30 offen sc1
    v_mul_f32 v24, v24, v244
    v_mfma_f32_16x16x32_bf16 v[36:39], a[184:187], v[224:227], v[36:39]
    ds_read_b128 v[220:223], v4 offset:29696
    v_mul_f32 v25, v25, v244
    v_mfma_f32_16x16x32_bf16 v[36:39], a[188:191], v[228:231], v[36:39]
    s_add_u32 s30, s24, 708608
    ds_read_b128 v[224:227], v4 offset:30720
    v_fma_f32 v236, -v24, v24, s29
    v_mfma_f32_16x16x32_bf16 v[36:39], a[192:195], v[184:187], v[36:39]
    ds_read_b128 v[228:231], v4 offset:31744
    v_fma_f32 v237, -v25, v25, s29
    v_mfma_f32_16x16x32_bf16 v[36:39], a[196:199], v[188:191], v[36:39]
    ds_read_b128 v[184:187], v4 offset:32768
    v_mul_f32 v236, v236, v24
    v_mfma_f32_16x16x32_bf16 v[36:39], a[200:203], v[192:195], v[36:39]
    ds_read_b128 v[188:191], v4 offset:33792
    v_mul_f32 v237, v237, v25
    v_mfma_f32_16x16x32_bf16 v[36:39], a[204:207], v[196:199], v[36:39]
    ds_read_b128 v[192:195], v4 offset:34816
    v_mul_f32 v26, v24, v26
    v_mfma_f32_16x16x32_bf16 v[36:39], a[208:211], v[200:203], v[36:39]
    buffer_load_dwordx4 a[44:47], v3, s[4:7], s30 offen sc1
    v_mul_f32 v27, v25, v27
    v_mfma_f32_16x16x32_bf16 v[36:39], a[212:215], v[204:207], v[36:39]
    s_waitcnt lgkmcnt(7)
    ds_write_b32 v8, v180 offset:36864
    v_mfma_f32_16x16x32_bf16 v[40:43], a[108:111], v[208:211], v[40:43]
    s_add_u32 s30, s24, 712704
    ds_write_b128 v3, v[128:131] offset:36864
    v_mfma_f32_16x16x32_bf16 v[40:43], a[112:115], v[212:215], v[40:43]
    buffer_load_dwordx4 a[48:51], v3, s[4:7], s30 offen sc1
    v_mfma_f32_16x16x32_bf16 v[40:43], a[116:119], v[216:219], v[40:43]
    s_waitcnt lgkmcnt(6)
    v_rcp_f32 v234, v234
    v_mfma_f32_16x16x32_bf16 v[40:43], a[120:123], v[220:223], v[40:43]
    s_add_u32 s30, s24, 716800
    v_rcp_f32 v235, v235
    v_mfma_f32_16x16x32_bf16 v[40:43], a[124:127], v[224:227], v[40:43]
    s_waitcnt lgkmcnt(4)
    v_mul_f32 v234, v22, v234
    v_mul_f32 v235, v23, v235
    v_mfma_f32_16x16x32_bf16 v[40:43], a[128:131], v[228:231], v[40:43]
    buffer_load_dwordx4 a[52:55], v3, s[4:7], s30 offen sc1
    v_cvt_pk_bf16_f32 v146, v234, v235
    v_mfma_f32_16x16x32_bf16 v[40:43], a[132:135], v[184:187], v[40:43]
    s_waitcnt lgkmcnt(2)
    ds_write_b32 v8, v181 offset:46080
    v_mfma_f32_16x16x32_bf16 v[40:43], a[136:139], v[188:191], v[40:43]
    s_add_u32 s30, s24, 720896
    v_exp_f32 v236, v236
    v_mfma_f32_16x16x32_bf16 v[40:43], a[140:143], v[192:195], v[40:43]
    v_exp_f32 v237, v237
    v_mfma_f32_16x16x32_bf16 v[44:47], a[144:147], v[208:211], v[44:47]
    ds_read_b128 v[196:199], v4 offset:35840
    ds_read_b128 v[200:203], v4 offset:36864
    v_mfma_f32_16x16x32_bf16 v[44:47], a[148:151], v[212:215], v[44:47]
    ds_read_b128 v[204:207], v4 offset:37888
    v_add_f32 v236, 1.0, v236
    v_mfma_f32_16x16x32_bf16 v[44:47], a[152:155], v[216:219], v[44:47]
    buffer_load_dwordx4 a[56:59], v3, s[4:7], s30 offen sc1
    v_mfma_f32_16x16x32_bf16 v[44:47], a[156:159], v[220:223], v[44:47]
    s_add_u32 s30, s24, 724992
    ds_write_b128 v3, v[132:135] offset:46080
    v_add_f32 v237, 1.0, v237
    v_mfma_f32_16x16x32_bf16 v[44:47], a[160:163], v[224:227], v[44:47]
    v_rcp_f32 v236, v236
    v_mfma_f32_16x16x32_bf16 v[44:47], a[164:167], v[228:231], v[44:47]
    buffer_load_dwordx4 a[60:63], v3, s[4:7], s30 offen sc1
    v_mfma_f32_16x16x32_bf16 v[44:47], a[168:171], v[184:187], v[44:47]
    v_rcp_f32 v237, v237
    v_mfma_f32_16x16x32_bf16 v[44:47], a[172:175], v[188:191], v[44:47]
    s_add_u32 s30, s24, 729088
    v_mul_f32 v236, v26, v236
    v_mul_f32 v237, v27, v237
    v_mfma_f32_16x16x32_bf16 v[44:47], a[176:179], v[192:195], v[44:47]
    v_cvt_pk_bf16_f32 v147, v236, v237
    v_mul_f32 v28, v28, v245
    v_mfma_f32_16x16x32_bf16 v[48:51], a[180:183], v[208:211], v[48:51]
    buffer_load_dwordx4 a[64:67], v3, s[4:7], s30 offen sc1
    v_mfma_f32_16x16x32_bf16 v[48:51], a[184:187], v[212:215], v[48:51]
    ds_read_b128 v[208:211], v4 offset:38912
    v_mul_f32 v29, v29, v245
    v_fma_f32 v238, -v28, v28, s29
    v_mfma_f32_16x16x32_bf16 v[48:51], a[188:191], v[216:219], v[48:51]
    s_add_u32 s30, s24, 733184
    ds_read_b128 v[212:215], v4 offset:39936
    v_fma_f32 v239, -v29, v29, s29
    v_mfma_f32_16x16x32_bf16 v[48:51], a[192:195], v[220:223], v[48:51]
    ds_read_b128 v[216:219], v4 offset:40960
    v_mul_f32 v238, v238, v28
    v_mfma_f32_16x16x32_bf16 v[48:51], a[196:199], v[224:227], v[48:51]
    ds_read_b128 v[220:223], v4 offset:41984
    v_mul_f32 v239, v239, v29
    v_mfma_f32_16x16x32_bf16 v[48:51], a[200:203], v[228:231], v[48:51]
    ds_read_b128 v[224:227], v4 offset:43008
    v_mul_f32 v30, v28, v30
    v_mfma_f32_16x16x32_bf16 v[48:51], a[204:207], v[184:187], v[48:51]
    ds_read_b128 v[228:231], v4 offset:44032
    v_mul_f32 v31, v29, v31
    v_mfma_f32_16x16x32_bf16 v[48:51], a[208:211], v[188:191], v[48:51]
    ds_write_b32 v8, v182 offset:55296
    v_mfma_f32_16x16x32_bf16 v[48:51], a[212:215], v[192:195], v[48:51]
    s_waitcnt lgkmcnt(8)
    ds_write_b128 v3, v[136:139] offset:55296
    v_mul_f32 v32, v32, v245
    v_mfma_f32_16x16x32_bf16 v[52:55], a[108:111], v[196:199], v[52:55]
    buffer_load_dwordx4 a[68:71], v3, s[4:7], s30 offen sc1
    v_mfma_f32_16x16x32_bf16 v[52:55], a[112:115], v[200:203], v[52:55]
    s_add_u32 s30, s24, 737280
    ds_write_b128 v9, v[144:147] offset:0
    v_mfma_f32_16x16x32_bf16 v[52:55], a[116:119], v[204:207], v[52:55]
    s_waitcnt lgkmcnt(7)
    v_exp_f32 v238, v238
    v_mfma_f32_16x16x32_bf16 v[52:55], a[120:123], v[208:211], v[52:55]
    buffer_load_dwordx4 a[72:75], v3, s[4:7], s30 offen sc1
    v_mfma_f32_16x16x32_bf16 v[52:55], a[124:127], v[212:215], v[52:55]
    s_waitcnt lgkmcnt(5)
    v_exp_f32 v239, v239
    v_mfma_f32_16x16x32_bf16 v[52:55], a[128:131], v[216:219], v[52:55]
    s_add_u32 s30, s24, 741376
    ds_write_b32 v8, v183 offset:64512
    v_mfma_f32_16x16x32_bf16 v[52:55], a[132:135], v[220:223], v[52:55]
    s_waitcnt lgkmcnt(4)
    v_add_f32 v238, 1.0, v238
    v_add_f32 v239, 1.0, v239
    v_mul_f32 v33, v33, v245
    v_mfma_f32_16x16x32_bf16 v[52:55], a[136:139], v[224:227], v[52:55]
    buffer_load_dwordx4 a[76:79], v3, s[4:7], s30 offen sc1
    v_mfma_f32_16x16x32_bf16 v[52:55], a[140:143], v[228:231], v[52:55]
    v_rcp_f32 v238, v238
    v_mfma_f32_16x16x32_bf16 v[56:59], a[144:147], v[196:199], v[56:59]
    s_add_u32 s30, s24, 745472
    ds_read_b128 v[184:187], v4 offset:45056
    ds_read_b128 v[188:191], v4 offset:46080
    v_mfma_f32_16x16x32_bf16 v[56:59], a[148:151], v[200:203], v[56:59]
    ds_read_b128 v[192:195], v4 offset:47104
    v_mul_f32 v238, v30, v238
    v_mfma_f32_16x16x32_bf16 v[56:59], a[152:155], v[204:207], v[56:59]
    buffer_load_dwordx4 a[80:83], v3, s[4:7], s30 offen sc1
    v_mfma_f32_16x16x32_bf16 v[56:59], a[156:159], v[208:211], v[56:59]
    ds_write_b128 v3, v[140:143] offset:64512
    v_mfma_f32_16x16x32_bf16 v[56:59], a[160:163], v[212:215], v[56:59]
    v_rcp_f32 v239, v239
    v_fma_f32 v240, -v32, v32, s29
    v_mfma_f32_16x16x32_bf16 v[56:59], a[164:167], v[216:219], v[56:59]
    s_add_u32 s30, s24, 749568
    v_mul_f32 v239, v31, v239
    v_fma_f32 v241, -v33, v33, s29
    v_mfma_f32_16x16x32_bf16 v[56:59], a[168:171], v[220:223], v[56:59]
    v_cvt_pk_bf16_f32 v149, v238, v239
    v_mul_f32 v240, v240, v32
    v_mfma_f32_16x16x32_bf16 v[56:59], a[172:175], v[224:227], v[56:59]
    buffer_load_dwordx4 a[84:87], v3, s[4:7], s30 offen sc1
    v_mfma_f32_16x16x32_bf16 v[56:59], a[176:179], v[228:231], v[56:59]
    v_mul_f32 v241, v241, v33
    v_mul_f32 v34, v32, v34
    v_mfma_f32_16x16x32_bf16 v[60:63], a[180:183], v[196:199], v[60:63]
    s_add_u32 s30, s24, 753664
    v_exp_f32 v240, v240
    v_mfma_f32_16x16x32_bf16 v[60:63], a[184:187], v[200:203], v[60:63]
    ds_read_b128 v[196:199], v4 offset:48128
    v_mul_f32 v35, v33, v35
    v_mfma_f32_16x16x32_bf16 v[60:63], a[188:191], v[204:207], v[60:63]
    ds_read_b128 v[200:203], v4 offset:49152
    buffer_store_dwordx4 v[144:147], v9, s[4:7], s52 offen sc1
    v_mfma_f32_16x16x32_bf16 v[60:63], a[192:195], v[208:211], v[60:63]
    s_waitcnt lgkmcnt(2)
    ds_read_b128 v[204:207], v4 offset:50176
    v_add_f32 v240, 1.0, v240
    v_mfma_f32_16x16x32_bf16 v[60:63], a[196:199], v[212:215], v[60:63]
    s_barrier
    ds_read_b128 v[208:211], v4 offset:51200
    ds_read_b128 v[176:179], v253 offset:0
    v_mfma_f32_16x16x32_bf16 v[60:63], a[200:203], v[216:219], v[60:63]
    ds_read_b128 v[212:215], v4 offset:52224
    ds_read_b128 v[180:183], v253 offset:36864
    v_mfma_f32_16x16x32_bf16 v[60:63], a[204:207], v[220:223], v[60:63]
    ds_read_b128 v[216:219], v4 offset:53248
    v_mul_f32 v36, v36, v245
    v_mfma_f32_16x16x32_bf16 v[60:63], a[208:211], v[224:227], v[60:63]
    buffer_load_dwordx4 a[88:91], v3, s[4:7], s30 offen sc1
    v_mfma_f32_16x16x32_bf16 v[60:63], a[212:215], v[228:231], v[60:63]
    v_exp_f32 v241, v241
    v_mfma_f32_16x16x32_bf16 v[64:67], a[108:111], v[184:187], v[64:67]
    s_add_u32 s30, s24, 757760
    v_add_f32 v241, 1.0, v241
    v_rcp_f32 v240, v240
    v_mfma_f32_16x16x32_bf16 v[64:67], a[112:115], v[188:191], v[64:67]
    buffer_load_dwordx4 a[92:95], v3, s[4:7], s30 offen sc1
    v_mfma_f32_16x16x32_bf16 v[64:67], a[116:119], v[192:195], v[64:67]
    s_waitcnt lgkmcnt(6)
    v_rcp_f32 v241, v241
    v_mfma_f32_16x16x32_bf16 v[64:67], a[120:123], v[196:199], v[64:67]
    s_add_u32 s30, s24, 761856
    v_mul_f32 v240, v34, v240
    v_mul_f32 v241, v35, v241
    v_mfma_f32_16x16x32_bf16 v[64:67], a[124:127], v[200:203], v[64:67]
    s_waitcnt lgkmcnt(4)
    v_cvt_pk_bf16_f32 v150, v240, v241
    v_mul_f32 v37, v37, v245
    v_mfma_f32_16x16x32_bf16 v[64:67], a[128:131], v[204:207], v[64:67]
    buffer_load_dwordx4 a[96:99], v3, s[4:7], s30 offen sc1
    v_mfma_f32_16x16x32_bf16 v[64:67], a[132:135], v[208:211], v[64:67]
    s_waitcnt lgkmcnt(0)
    v_fma_f32 v242, -v36, v36, s29
    v_fma_f32 v243, -v37, v37, s29
    v_mfma_f32_16x16x32_bf16 v[64:67], a[136:139], v[212:215], v[64:67]
    s_add_u32 s30, s24, 782336
    v_mul_f32 v242, v242, v36
    v_mul_f32 v243, v243, v37
    v_mul_f32 v38, v36, v38
    v_mfma_f32_16x16x32_bf16 v[64:67], a[140:143], v[216:219], v[64:67]
    s_add_u32 s35, s46, 0
    v_exp_f32 v242, v242
    v_mfma_f32_16x16x32_bf16 v[68:71], a[144:147], v[184:187], v[68:71]
    ds_read_b128 v[220:223], v4 offset:54272
    ds_read_b128 v[224:227], v4 offset:55296
    v_mfma_f32_16x16x32_bf16 v[68:71], a[148:151], v[188:191], v[68:71]
    ds_read_b128 v[228:231], v4 offset:56320
    v_mul_f32 v39, v37, v39
    v_mfma_f32_16x16x32_bf16 v[68:71], a[152:155], v[192:195], v[68:71]
    buffer_load_dwordx4 a[232:235], v3, s[4:7], s30 offen sc1
    v_mfma_f32_16x16x32_bf16 v[68:71], a[156:159], v[196:199], v[68:71]
    s_add_u32 s30, s24, 786432
    v_exp_f32 v243, v243
    v_mfma_f32_16x16x32_bf16 v[68:71], a[160:163], v[200:203], v[68:71]
    buffer_store_dwordx4 v[176:179], v253, s[4:7], s35 offen sc1
    v_mfma_f32_16x16x32_bf16 v[68:71], a[164:167], v[204:207], v[68:71]
    s_add_u32 s35, s46, 36864
    v_add_f32 v242, 1.0, v242
    v_add_f32 v243, 1.0, v243
    v_mul_f32 v40, v40, v246
    v_mfma_f32_16x16x32_bf16 v[68:71], a[168:171], v[208:211], v[68:71]
    v_rcp_f32 v242, v242
    v_mfma_f32_16x16x32_bf16 v[68:71], a[172:175], v[212:215], v[68:71]
    v_rcp_f32 v243, v243
    v_mfma_f32_16x16x32_bf16 v[68:71], a[176:179], v[216:219], v[68:71]
    buffer_store_dwordx4 v[180:183], v253, s[4:7], s35 offen sc1
    v_mfma_f32_16x16x32_bf16 v[72:75], a[180:183], v[184:187], v[72:75]
    v_mul_f32 v242, v38, v242
    v_mul_f32 v243, v39, v243
    v_mfma_f32_16x16x32_bf16 v[72:75], a[184:187], v[188:191], v[72:75]
    ds_read_b128 v[184:187], v4 offset:57344
    v_cvt_pk_bf16_f32 v151, v242, v243
    v_mfma_f32_16x16x32_bf16 v[72:75], a[188:191], v[192:195], v[72:75]
    ds_read_b128 v[188:191], v4 offset:58368
    v_mul_f32 v41, v41, v246
    v_mfma_f32_16x16x32_bf16 v[72:75], a[192:195], v[196:199], v[72:75]
    ds_read_b128 v[192:195], v4 offset:59392
    buffer_store_dwordx4 v[148:151], v9, s[4:7], s53 offen sc1
    v_mfma_f32_16x16x32_bf16 v[72:75], a[196:199], v[200:203], v[72:75]
    ds_read_b128 v[196:199], v4 offset:60416
    v_fma_f32 v232, -v40, v40, s29
    v_mfma_f32_16x16x32_bf16 v[72:75], a[200:203], v[204:207], v[72:75]
    ds_read_b128 v[200:203], v4 offset:61440
    v_fma_f32 v233, -v41, v41, s29
    v_mfma_f32_16x16x32_bf16 v[72:75], a[204:207], v[208:211], v[72:75]
    ds_read_b128 v[204:207], v4 offset:62464
    v_mul_f32 v232, v232, v40
    v_mfma_f32_16x16x32_bf16 v[72:75], a[208:211], v[212:215], v[72:75]
    buffer_load_dwordx4 a[236:239], v3, s[4:7], s30 offen sc1
    v_mfma_f32_16x16x32_bf16 v[72:75], a[212:215], v[216:219], v[72:75]
    s_waitcnt lgkmcnt(6)
    ds_write_b128 v9, v[148:151] offset:9216
    v_mfma_f32_16x16x32_bf16 v[76:79], a[108:111], v[220:223], v[76:79]
    s_add_u32 s30, s24, 790528
    v_mul_f32 v233, v233, v41
    v_mul_f32 v42, v40, v42
    v_mfma_f32_16x16x32_bf16 v[76:79], a[112:115], v[224:227], v[76:79]
    buffer_load_dwordx4 a[240:243], v3, s[4:7], s30 offen sc1
    v_mul_f32 v43, v41, v43
    v_mfma_f32_16x16x32_bf16 v[76:79], a[116:119], v[228:231], v[76:79]
    s_waitcnt lgkmcnt(5)
    v_exp_f32 v232, v232
    v_mfma_f32_16x16x32_bf16 v[76:79], a[120:123], v[184:187], v[76:79]
    s_add_u32 s30, s24, 794624
    v_exp_f32 v233, v233
    v_mfma_f32_16x16x32_bf16 v[76:79], a[124:127], v[188:191], v[76:79]
    s_waitcnt lgkmcnt(3)
    v_add_f32 v232, 1.0, v232
    v_add_f32 v233, 1.0, v233
    v_mfma_f32_16x16x32_bf16 v[76:79], a[128:131], v[192:195], v[76:79]
    buffer_load_dwordx4 a[244:247], v3, s[4:7], s30 offen sc1
    v_mfma_f32_16x16x32_bf16 v[76:79], a[132:135], v[196:199], v[76:79]
    s_waitcnt lgkmcnt(1)
    v_rcp_f32 v232, v232
    v_mfma_f32_16x16x32_bf16 v[76:79], a[136:139], v[200:203], v[76:79]
    s_add_u32 s30, s24, 798720
    v_rcp_f32 v233, v233
    v_mfma_f32_16x16x32_bf16 v[76:79], a[140:143], v[204:207], v[76:79]
    v_mul_f32 v232, v42, v232
    v_mul_f32 v233, v43, v233
    v_mul_f32 v44, v44, v246
    v_mfma_f32_16x16x32_bf16 v[80:83], a[144:147], v[220:223], v[80:83]
    ds_read_b128 v[208:211], v4 offset:63488
    ds_read_b128 v[212:215], v4 offset:64512
    v_mfma_f32_16x16x32_bf16 v[80:83], a[148:151], v[224:227], v[80:83]
    ds_read_b128 v[216:219], v5 offset:0
    v_cvt_pk_bf16_f32 v153, v232, v233
    v_mfma_f32_16x16x32_bf16 v[80:83], a[152:155], v[228:231], v[80:83]
    v_mul_f32 v45, v45, v246
    v_fma_f32 v234, -v44, v44, s29
    v_mfma_f32_16x16x32_bf16 v[80:83], a[156:159], v[184:187], v[80:83]
    v_fma_f32 v235, -v45, v45, s29
    v_mul_f32 v234, v234, v44
    v_mfma_f32_16x16x32_bf16 v[80:83], a[160:163], v[188:191], v[80:83]
    v_mul_f32 v235, v235, v45
    v_mul_f32 v46, v44, v46
    v_mfma_f32_16x16x32_bf16 v[80:83], a[164:167], v[192:195], v[80:83]
    v_exp_f32 v234, v234
    v_mfma_f32_16x16x32_bf16 v[80:83], a[168:171], v[196:199], v[80:83]
    v_exp_f32 v235, v235
    v_mul_f32 v47, v45, v47
    v_mfma_f32_16x16x32_bf16 v[80:83], a[172:175], v[200:203], v[80:83]
    buffer_load_dwordx4 a[248:251], v3, s[4:7], s30 offen sc1
    v_mfma_f32_16x16x32_bf16 v[80:83], a[176:179], v[204:207], v[80:83]
    s_add_u32 s30, s24, 802816
    v_add_f32 v234, 1.0, v234
    v_add_f32 v235, 1.0, v235
    v_mfma_f32_16x16x32_bf16 v[84:87], a[180:183], v[220:223], v[84:87]
    buffer_load_dwordx4 a[252:255], v3, s[4:7], s30 offen sc1
    v_mfma_f32_16x16x32_bf16 v[84:87], a[184:187], v[224:227], v[84:87]
    ds_read_b128 v[220:223], v5 offset:1024
    v_mul_f32 v48, v48, v246
    v_mfma_f32_16x16x32_bf16 v[84:87], a[188:191], v[228:231], v[84:87]
    ds_read_b128 v[224:227], v5 offset:2048
    v_mul_f32 v49, v49, v246
    v_mfma_f32_16x16x32_bf16 v[84:87], a[192:195], v[184:187], v[84:87]
    s_add_u32 s30, s24, 806912
    ds_read_b128 v[228:231], v5 offset:3072
    v_fma_f32 v236, -v48, v48, s29
    v_mfma_f32_16x16x32_bf16 v[84:87], a[196:199], v[188:191], v[84:87]
    ds_read_b128 v[184:187], v5 offset:4096
    v_rcp_f32 v234, v234
    v_mfma_f32_16x16x32_bf16 v[84:87], a[200:203], v[192:195], v[84:87]
    ds_read_b128 v[188:191], v5 offset:5120
    v_mul_f32 v234, v46, v234
    v_mfma_f32_16x16x32_bf16 v[84:87], a[204:207], v[196:199], v[84:87]
    ds_read_b128 v[192:195], v5 offset:6144
    v_fma_f32 v237, -v49, v49, s29
    v_mfma_f32_16x16x32_bf16 v[84:87], a[208:211], v[200:203], v[84:87]
    buffer_load_dwordx4 a[100:103], v3, s[4:7], s30 offen sc1
    v_mfma_f32_16x16x32_bf16 v[84:87], a[212:215], v[204:207], v[84:87]
    s_waitcnt lgkmcnt(6)
    v_rcp_f32 v235, v235
    v_mfma_f32_16x16x32_bf16 v[88:91], a[108:111], v[208:211], v[88:91]
    s_add_u32 s30, s24, 811008
    v_mul_f32 v235, v47, v235
    v_mul_f32 v236, v236, v48
    v_mfma_f32_16x16x32_bf16 v[88:91], a[112:115], v[212:215], v[88:91]
    buffer_load_dwordx4 a[104:107], v3, s[4:7], s30 offen sc1
    v_mfma_f32_16x16x32_bf16 v[88:91], a[116:119], v[216:219], v[88:91]
    s_waitcnt lgkmcnt(4)
    v_cvt_pk_bf16_f32 v154, v234, v235
    v_mul_f32 v237, v237, v49
    v_mul_f32 v50, v48, v50
    v_mfma_f32_16x16x32_bf16 v[88:91], a[120:123], v[220:223], v[88:91]
    s_waitcnt vmcnt(8)
    v_exp_f32 v236, v236
    v_mfma_f32_16x16x32_bf16 v[88:91], a[124:127], v[224:227], v[88:91]
    s_waitcnt lgkmcnt(2)
    v_exp_f32 v237, v237
    v_mfma_f32_16x16x32_bf16 v[88:91], a[128:131], v[228:231], v[88:91]
    v_mul_f32 v51, v49, v51
    v_add_f32 v236, 1.0, v236
    v_mfma_f32_16x16x32_bf16 v[88:91], a[132:135], v[184:187], v[88:91]
    s_waitcnt lgkmcnt(0)
    v_add_f32 v237, 1.0, v237
    v_mul_f32 v52, v52, v247
    v_mfma_f32_16x16x32_bf16 v[88:91], a[136:139], v[188:191], v[88:91]
    v_rcp_f32 v236, v236
    v_mfma_f32_16x16x32_bf16 v[88:91], a[140:143], v[192:195], v[88:91]
    v_rcp_f32 v237, v237
    v_mfma_f32_16x16x32_bf16 v[92:95], a[144:147], v[208:211], v[92:95]
    ds_read_b128 v[196:199], v5 offset:7168
    ds_read_b128 v[200:203], v5 offset:8192
    buffer_store_dword v252, off, s[4:7], s48 offset:0 sc1
    v_mul_f32 v236, v50, v236
    v_mfma_f32_16x16x32_bf16 v[92:95], a[148:151], v[212:215], v[92:95]
    ds_read_b128 v[204:207], v5 offset:9216
    v_mul_f32 v237, v51, v237
    v_mfma_f32_16x16x32_bf16 v[92:95], a[152:155], v[216:219], v[92:95]
    v_cvt_pk_bf16_f32 v155, v236, v237
    v_mul_f32 v53, v53, v247
    v_mfma_f32_16x16x32_bf16 v[92:95], a[156:159], v[220:223], v[92:95]
    buffer_store_dwordx4 v[152:155], v9, s[4:7], s54 offen sc1
    v_mfma_f32_16x16x32_bf16 v[92:95], a[160:163], v[224:227], v[92:95]
    ds_write_b128 v9, v[152:155] offset:18432
    v_mfma_f32_16x16x32_bf16 v[92:95], a[164:167], v[228:231], v[92:95]
    v_fma_f32 v238, -v52, v52, s29
    v_fma_f32 v239, -v53, v53, s29
    v_mfma_f32_16x16x32_bf16 v[92:95], a[168:171], v[184:187], v[92:95]
    v_mul_f32 v238, v238, v52
    v_mul_f32 v239, v239, v53
    v_mfma_f32_16x16x32_bf16 v[92:95], a[172:175], v[188:191], v[92:95]
    v_exp_f32 v238, v238
    v_mul_f32 v54, v52, v54
    v_mfma_f32_16x16x32_bf16 v[92:95], a[176:179], v[192:195], v[92:95]
    v_exp_f32 v239, v239
    v_mfma_f32_16x16x32_bf16 v[96:99], a[180:183], v[208:211], v[96:99]
    v_mul_f32 v55, v53, v55
    v_add_f32 v238, 1.0, v238
    v_mfma_f32_16x16x32_bf16 v[96:99], a[184:187], v[212:215], v[96:99]
    ds_read_b128 v[208:211], v5 offset:10240
    v_add_f32 v239, 1.0, v239
    v_mfma_f32_16x16x32_bf16 v[96:99], a[188:191], v[216:219], v[96:99]
    ds_read_b128 v[212:215], v5 offset:11264
    v_mul_f32 v56, v56, v247
    v_mfma_f32_16x16x32_bf16 v[96:99], a[192:195], v[220:223], v[96:99]
    ds_read_b128 v[216:219], v5 offset:12288
    v_mul_f32 v57, v57, v247
    v_mfma_f32_16x16x32_bf16 v[96:99], a[196:199], v[224:227], v[96:99]
    ds_read_b128 v[220:223], v5 offset:13312
    v_fma_f32 v240, -v56, v56, s29
    v_mfma_f32_16x16x32_bf16 v[96:99], a[200:203], v[228:231], v[96:99]
    ds_read_b128 v[224:227], v5 offset:14336
    v_rcp_f32 v238, v238
    v_mfma_f32_16x16x32_bf16 v[96:99], a[204:207], v[184:187], v[96:99]
    ds_read_b128 v[228:231], v5 offset:15360
    v_mul_f32 v238, v54, v238
    v_mfma_f32_16x16x32_bf16 v[96:99], a[208:211], v[188:191], v[96:99]
    v_rcp_f32 v239, v239
    v_mfma_f32_16x16x32_bf16 v[96:99], a[212:215], v[192:195], v[96:99]
    s_waitcnt lgkmcnt(7)
    v_mul_f32 v239, v55, v239
    v_fma_f32 v241, -v57, v57, s29
    v_mfma_f32_16x16x32_bf16 v[100:103], a[108:111], v[196:199], v[100:103]
    s_add_u32 s30, s24, 815104
    ds_read_b128 v[184:187], v11 offset:0
    ds_read_b128 v[188:191], v11 offset:1024
    v_mfma_f32_16x16x32_bf16 v[100:103], a[112:115], v[200:203], v[100:103]
    ds_read_b128 v[192:195], v11 offset:2048
    v_cvt_pk_bf16_f32 v157, v238, v239
    v_mfma_f32_16x16x32_bf16 v[100:103], a[116:119], v[204:207], v[100:103]
    s_waitcnt lgkmcnt(7)
    v_mul_f32 v240, v240, v56
    v_mul_f32 v241, v241, v57
    v_mfma_f32_16x16x32_bf16 v[100:103], a[120:123], v[208:211], v[100:103]
    buffer_load_dwordx4 a[108:111], v3, s[4:7], s30 offen sc1
    v_mul_f32 v58, v56, v58
    v_mfma_f32_16x16x32_bf16 v[100:103], a[124:127], v[212:215], v[100:103]
    s_waitcnt lgkmcnt(5)
    v_exp_f32 v240, v240
    v_mfma_f32_16x16x32_bf16 v[100:103], a[128:131], v[216:219], v[100:103]
    s_add_u32 s30, s24, 819200
    v_exp_f32 v241, v241
    v_mfma_f32_16x16x32_bf16 v[100:103], a[132:135], v[220:223], v[100:103]
    s_waitcnt lgkmcnt(3)
    v_mul_f32 v59, v57, v59
    v_add_f32 v240, 1.0, v240
    v_mfma_f32_16x16x32_bf16 v[100:103], a[136:139], v[224:227], v[100:103]
    buffer_load_dwordx4 a[112:115], v3, s[4:7], s30 offen sc1
    v_mfma_f32_16x16x32_bf16 v[100:103], a[140:143], v[228:231], v[100:103]
    s_add_u32 s30, s24, 823296
    v_add_f32 v241, 1.0, v241
    v_mul_f32 v60, v60, v247
    v_mfma_f32_16x16x32_bf16 v[104:107], a[144:147], v[196:199], v[104:107]
    v_rcp_f32 v240, v240
    v_mfma_f32_16x16x32_bf16 v[104:107], a[148:151], v[200:203], v[104:107]
ffn1_part_pad0_7x:
    s_cbranch_execz ffn1_part_padret0
    buffer_load_dwordx4 a[116:119], v3, s[4:7], s30 offen sc1
    v_mul_f32 v240, v58, v240
    v_mfma_f32_16x16x32_bf16 v[104:107], a[152:155], v[204:207], v[104:107]
    v_rcp_f32 v241, v241
    v_mfma_f32_16x16x32_bf16 v[104:107], a[156:159], v[208:211], v[104:107]
    s_add_u32 s30, s24, 827392
    v_mul_f32 v241, v59, v241
    v_mul_f32 v61, v61, v247
    v_mfma_f32_16x16x32_bf16 v[104:107], a[160:163], v[212:215], v[104:107]
    v_cvt_pk_bf16_f32 v158, v240, v241
    v_fma_f32 v242, -v60, v60, s29
    v_mfma_f32_16x16x32_bf16 v[104:107], a[164:167], v[216:219], v[104:107]
    buffer_load_dwordx4 a[120:123], v3, s[4:7], s30 offen sc1
    v_mfma_f32_16x16x32_bf16 v[104:107], a[168:171], v[220:223], v[104:107]
    v_fma_f32 v243, -v61, v61, s29
    v_mul_f32 v242, v242, v60
    v_mfma_f32_16x16x32_bf16 v[104:107], a[172:175], v[224:227], v[104:107]
    v_mul_f32 v243, v243, v61
    v_mul_f32 v62, v60, v62
    v_mfma_f32_16x16x32_bf16 v[104:107], a[176:179], v[228:231], v[104:107]
    s_add_u32 s30, s24, 831488
    v_exp_f32 v242, v242
    v_mul_f32 v63, v61, v63
    v_mfma_f32_16x16x32_bf16 v[108:111], a[180:183], v[196:199], v[108:111]
    v_exp_f32 v243, v243
    v_mfma_f32_16x16x32_bf16 v[108:111], a[184:187], v[200:203], v[108:111]
    ds_read_b128 v[196:199], v11 offset:3072
    v_add_f32 v242, 1.0, v242
    v_mfma_f32_16x16x32_bf16 v[108:111], a[188:191], v[204:207], v[108:111]
    ds_read_b128 v[200:203], v11 offset:4096
    v_add_f32 v243, 1.0, v243
    v_mfma_f32_16x16x32_bf16 v[108:111], a[192:195], v[208:211], v[108:111]
    buffer_load_dwordx4 a[124:127], v3, s[4:7], s30 offen sc1
    v_mfma_f32_16x16x32_bf16 v[108:111], a[196:199], v[212:215], v[108:111]
    s_add_u32 s30, s24, 835584
    v_rcp_f32 v242, v242
    v_mfma_f32_16x16x32_bf16 v[108:111], a[200:203], v[216:219], v[108:111]
    buffer_load_dwordx4 a[128:131], v3, s[4:7], s30 offen sc1
    v_mfma_f32_16x16x32_bf16 v[108:111], a[204:207], v[220:223], v[108:111]
    v_rcp_f32 v243, v243
    v_mul_f32 v242, v62, v242
    v_mfma_f32_16x16x32_bf16 v[108:111], a[208:211], v[224:227], v[108:111]
    v_mul_f32 v243, v63, v243
    v_mul_f32 v64, v64, v248
    v_mfma_f32_16x16x32_bf16 v[108:111], a[212:215], v[228:231], v[108:111]
    s_waitcnt lgkmcnt(2)
    v_cvt_pk_bf16_f32 v159, v242, v243
    v_mul_f32 v65, v65, v248
    v_mfma_f32_16x16x32_bf16 v[16:19], a[0:3], v[184:187], 0
    s_add_u32 s30, s24, 839680
    ds_read_b128 v[204:207], v14 offset:0
    ds_read_b128 v[208:211], v14 offset:1024
    v_mfma_f32_16x16x32_bf16 v[16:19], a[4:7], v[188:191], v[16:19]
    s_barrier
    ds_read_b128 v[212:215], v14 offset:2048
    ds_read_b128 v[216:219], v14 offset:3072
    v_mfma_f32_16x16x32_bf16 v[16:19], a[8:11], v[192:195], v[16:19]
    s_waitcnt lgkmcnt(4)
    ds_read_b128 v[220:223], v14 offset:4096
    v_fma_f32 v232, -v64, v64, s29
    v_mfma_f32_16x16x32_bf16 v[16:19], a[12:15], v[196:199], v[16:19]
    buffer_load_dwordx4 a[132:135], v3, s[4:7], s30 offen sc1
    v_mfma_f32_16x16x32_bf16 v[16:19], a[16:19], v[200:203], v[16:19]
    s_add_u32 s30, s24, 843776
    ds_write_b128 v9, v[156:159] offset:27648
    v_fma_f32 v233, -v65, v65, s29
    v_mfma_f32_16x16x32_bf16 v[20:23], a[20:23], v[184:187], 0
    buffer_store_dwordx4 v[156:159], v9, s[4:7], s60 offen sc1
    v_mfma_f32_16x16x32_bf16 v[20:23], a[24:27], v[188:191], v[20:23]
    v_mul_f32 v232, v232, v64
    v_mul_f32 v233, v233, v65
    v_mfma_f32_16x16x32_bf16 v[20:23], a[28:31], v[192:195], v[20:23]
    v_exp_f32 v232, v232
    v_mfma_f32_16x16x32_bf16 v[20:23], a[32:35], v[196:199], v[20:23]
    v_exp_f32 v233, v233
    v_mfma_f32_16x16x32_bf16 v[20:23], a[36:39], v[200:203], v[20:23]
    v_mul_f32 v66, v64, v66
    v_mul_f32 v67, v65, v67
    v_mfma_f32_16x16x32_bf16 v[24:27], a[40:43], v[184:187], 0
    v_add_f32 v232, 1.0, v232
    v_add_f32 v233, 1.0, v233
    v_mfma_f32_16x16x32_bf16 v[24:27], a[44:47], v[188:191], v[24:27]
    v_rcp_f32 v232, v232
    v_mul_f32 v68, v68, v248
    v_mfma_f32_16x16x32_bf16 v[24:27], a[48:51], v[192:195], v[24:27]
    buffer_load_dwordx4 a[136:139], v3, s[4:7], s30 offen sc1
    v_mfma_f32_16x16x32_bf16 v[24:27], a[52:55], v[196:199], v[24:27]
    s_add_u32 s30, s24, 847872
    v_rcp_f32 v233, v233
    v_mfma_f32_16x16x32_bf16 v[24:27], a[56:59], v[200:203], v[24:27]
    buffer_load_dwordx4 a[140:143], v3, s[4:7], s30 offen sc1
    v_mfma_f32_16x16x32_bf16 v[28:31], a[60:63], v[184:187], 0
    v_mul_f32 v232, v66, v232
    v_mul_f32 v233, v67, v233
    v_mfma_f32_16x16x32_bf16 v[28:31], a[64:67], v[188:191], v[28:31]
    v_cvt_pk_bf16_f32 v161, v232, v233
    v_mul_f32 v69, v69, v248
    v_mfma_f32_16x16x32_bf16 v[28:31], a[68:71], v[192:195], v[28:31]
    v_fma_f32 v234, -v68, v68, s29
    v_fma_f32 v235, -v69, v69, s29
    v_mfma_f32_16x16x32_bf16 v[28:31], a[72:75], v[196:199], v[28:31]
    v_mul_f32 v234, v234, v68
    v_mul_f32 v235, v235, v69
    v_mul_f32 v70, v68, v70
    v_mfma_f32_16x16x32_bf16 v[28:31], a[76:79], v[200:203], v[28:31]
    buffer_load_dword v254, off, s[4:7], s49 offset:0 sc1
    v_mfma_f32_16x16x32_bf16 v[112:115], a[80:83], v[184:187], 0
    s_add_u32 s30, s24, 851968
    v_exp_f32 v234, v234
    v_mfma_f32_16x16x32_bf16 v[112:115], a[84:87], v[188:191], v[112:115]
    buffer_load_dwordx4 a[144:147], v3, s[4:7], s30 offen sc1
    v_mfma_f32_16x16x32_bf16 v[112:115], a[88:91], v[192:195], v[112:115]
    s_add_u32 s30, s24, 856064
    v_exp_f32 v235, v235
    v_mfma_f32_16x16x32_bf16 v[112:115], a[92:95], v[196:199], v[112:115]
    v_mul_f32 v71, v69, v71
    v_add_f32 v234, 1.0, v234
    v_mfma_f32_16x16x32_bf16 v[112:115], a[96:99], v[200:203], v[112:115]
    s_waitcnt lgkmcnt(1)
    v_add_f32 v235, 1.0, v235
    v_mul_f32 v72, v72, v248
    v_mfma_f32_16x16x32_bf16 v[116:119], a[0:3], v[204:207], 0
    ds_read_b128 v[224:227], v11 offset:18432
    ds_read_b128 v[228:231], v11 offset:19456
    v_mul_f32 v73, v73, v248
    v_mfma_f32_16x16x32_bf16 v[116:119], a[4:7], v[208:211], v[116:119]
    ds_read_b128 v[184:187], v11 offset:20480
    ds_read_b128 v[188:191], v11 offset:21504
    v_mfma_f32_16x16x32_bf16 v[116:119], a[8:11], v[212:215], v[116:119]
    ds_read_b128 v[192:195], v11 offset:22528
    v_fma_f32 v236, -v72, v72, s29
    v_mfma_f32_16x16x32_bf16 v[116:119], a[12:15], v[216:219], v[116:119]
    buffer_load_dwordx4 a[148:151], v3, s[4:7], s30 offen sc1
    v_mfma_f32_16x16x32_bf16 v[116:119], a[16:19], v[220:223], v[116:119]
    s_add_u32 s30, s24, 860160
    v_rcp_f32 v234, v234
    v_mfma_f32_16x16x32_bf16 v[120:123], a[20:23], v[204:207], 0
    buffer_load_dwordx4 a[152:155], v3, s[4:7], s30 offen sc1
    v_mfma_f32_16x16x32_bf16 v[120:123], a[24:27], v[208:211], v[120:123]
    v_rcp_f32 v235, v235
    v_mfma_f32_16x16x32_bf16 v[120:123], a[28:31], v[212:215], v[120:123]
    v_mul_f32 v234, v70, v234
    v_mul_f32 v235, v71, v235
    v_fma_f32 v237, -v73, v73, s29
    v_mfma_f32_16x16x32_bf16 v[120:123], a[32:35], v[216:219], v[120:123]
    s_add_u32 s30, s24, 864256
    v_cvt_pk_bf16_f32 v162, v234, v235
    v_mul_f32 v236, v236, v72
    v_mfma_f32_16x16x32_bf16 v[120:123], a[36:39], v[220:223], v[120:123]
    v_mul_f32 v237, v237, v73
    v_mul_f32 v74, v72, v74
    v_mfma_f32_16x16x32_bf16 v[124:127], a[40:43], v[204:207], 0
    buffer_load_dwordx4 a[156:159], v3, s[4:7], s30 offen sc1
    v_mfma_f32_16x16x32_bf16 v[124:127], a[44:47], v[208:211], v[124:127]
    v_exp_f32 v236, v236
    v_mfma_f32_16x16x32_bf16 v[124:127], a[48:51], v[212:215], v[124:127]
    s_add_u32 s30, s24, 868352
    v_exp_f32 v237, v237
    v_mfma_f32_16x16x32_bf16 v[124:127], a[52:55], v[216:219], v[124:127]
    v_mul_f32 v75, v73, v75
    v_add_f32 v236, 1.0, v236
    v_mfma_f32_16x16x32_bf16 v[124:127], a[56:59], v[220:223], v[124:127]
    buffer_load_dwordx4 a[160:163], v3, s[4:7], s30 offen sc1
    v_add_f32 v237, 1.0, v237
    v_mfma_f32_16x16x32_bf16 v[128:131], a[60:63], v[204:207], 0
    v_rcp_f32 v236, v236
    v_mfma_f32_16x16x32_bf16 v[128:131], a[64:67], v[208:211], v[128:131]
    s_add_u32 s30, s24, 872448
    v_rcp_f32 v237, v237
    v_mfma_f32_16x16x32_bf16 v[128:131], a[68:71], v[212:215], v[128:131]
    v_mul_f32 v236, v74, v236
    v_mul_f32 v237, v75, v237
    v_mfma_f32_16x16x32_bf16 v[128:131], a[72:75], v[216:219], v[128:131]
    buffer_load_dwordx4 a[164:167], v3, s[4:7], s30 offen sc1
    v_mfma_f32_16x16x32_bf16 v[128:131], a[76:79], v[220:223], v[128:131]
    s_waitcnt lgkmcnt(0)
    v_cvt_pk_bf16_f32 v163, v236, v237
    v_mul_f32 v76, v76, v249
    v_mfma_f32_16x16x32_bf16 v[132:135], a[0:3], v[224:227], 0
    s_add_u32 s30, s24, 876544
    ds_read_b128 v[196:199], v14 offset:18432
    ds_read_b128 v[200:203], v14 offset:19456
    v_mfma_f32_16x16x32_bf16 v[132:135], a[4:7], v[228:231], v[132:135]
    s_waitcnt vmcnt(9)
    ds_read_b128 v[204:207], v14 offset:20480
    ds_read_b128 v[208:211], v14 offset:21504
    v_mul_f32 v77, v77, v249
    v_mfma_f32_16x16x32_bf16 v[132:135], a[8:11], v[184:187], v[132:135]
    ds_read_b128 v[212:215], v14 offset:22528
    v_fma_f32 v238, -v76, v76, s29
    v_mfma_f32_16x16x32_bf16 v[132:135], a[12:15], v[188:191], v[132:135]
    buffer_load_dwordx4 a[168:171], v3, s[4:7], s30 offen sc1
    v_mfma_f32_16x16x32_bf16 v[132:135], a[16:19], v[192:195], v[132:135]
    ds_write_b128 v9, v[160:163] offset:36864
    v_mfma_f32_16x16x32_bf16 v[136:139], a[20:23], v[224:227], 0
    s_add_u32 s30, s24, 880640
    v_fma_f32 v239, -v77, v77, s29
    v_mul_f32 v238, v238, v76
    v_mfma_f32_16x16x32_bf16 v[136:139], a[24:27], v[228:231], v[136:139]
    buffer_store_dwordx4 v[160:163], v9, s[4:7], s61 offen sc1
    v_mfma_f32_16x16x32_bf16 v[136:139], a[28:31], v[184:187], v[136:139]
    buffer_store_dword v252, off, s[4:7], s48 offset:128 sc1
    v_mul_f32 v239, v239, v77
    v_mul_f32 v78, v76, v78
    v_mfma_f32_16x16x32_bf16 v[136:139], a[32:35], v[188:191], v[136:139]
    v_exp_f32 v238, v238
    v_mul_f32 v79, v77, v79
    v_mfma_f32_16x16x32_bf16 v[136:139], a[36:39], v[192:195], v[136:139]
    v_exp_f32 v239, v239
    v_mfma_f32_16x16x32_bf16 v[140:143], a[40:43], v[224:227], 0
    v_add_f32 v238, 1.0, v238
    v_add_f32 v239, 1.0, v239
    v_mfma_f32_16x16x32_bf16 v[140:143], a[44:47], v[228:231], v[140:143]
    v_rcp_f32 v238, v238
    v_mfma_f32_16x16x32_bf16 v[140:143], a[48:51], v[184:187], v[140:143]
    v_rcp_f32 v239, v239
    v_mfma_f32_16x16x32_bf16 v[140:143], a[52:55], v[188:191], v[140:143]
    v_mul_f32 v238, v78, v238
    v_mul_f32 v239, v79, v239
    v_mfma_f32_16x16x32_bf16 v[140:143], a[56:59], v[192:195], v[140:143]
    buffer_load_dwordx4 a[172:175], v3, s[4:7], s30 offen sc1
    v_mfma_f32_16x16x32_bf16 v[32:35], a[60:63], v[224:227], 0
    s_waitcnt vmcnt(10)
    v_readfirstlane_b32 s27, v254
    s_nop 0
    s_cmp_lg_u32 s27, 0
    s_cbranch_scc0 ffn1_part_slow0
ffn1_part_back0:
    v_cvt_pk_bf16_f32 v165, v238, v239
    v_mfma_f32_16x16x32_bf16 v[32:35], a[64:67], v[228:231], v[32:35]
    s_add_u32 s30, s24, 884736
    v_mul_f32 v80, v80, v249
    v_mul_f32 v81, v81, v249
    v_mfma_f32_16x16x32_bf16 v[32:35], a[68:71], v[184:187], v[32:35]
    buffer_load_dwordx4 a[176:179], v3, s[4:7], s30 offen sc1
    v_mfma_f32_16x16x32_bf16 v[32:35], a[72:75], v[188:191], v[32:35]
    s_add_u32 m0, s26, 73728
    v_fma_f32 v240, -v80, v80, s29
    v_fma_f32 v241, -v81, v81, s29
    v_mfma_f32_16x16x32_bf16 v[32:35], a[76:79], v[192:195], v[32:35]
    s_add_u32 s31, s47, 0
    v_mul_f32 v240, v240, v80
    v_mul_f32 v241, v241, v81
    v_mfma_f32_16x16x32_bf16 v[144:147], a[80:83], v[224:227], 0
    v_exp_f32 v240, v240
    v_mfma_f32_16x16x32_bf16 v[144:147], a[84:87], v[228:231], v[144:147]
    buffer_load_dwordx4 v3, s[4:7], s31 offen sc1 lds
    v_mfma_f32_16x16x32_bf16 v[144:147], a[88:91], v[184:187], v[144:147]
    v_exp_f32 v241, v241
    v_mul_f32 v82, v80, v82
    v_mfma_f32_16x16x32_bf16 v[144:147], a[92:95], v[188:191], v[144:147]
    s_add_u32 s30, s24, 888832
    v_mul_f32 v83, v81, v83
    v_add_f32 v240, 1.0, v240
    v_mfma_f32_16x16x32_bf16 v[144:147], a[96:99], v[192:195], v[144:147]
    s_waitcnt lgkmcnt(1)
    v_add_f32 v241, 1.0, v241
    v_mul_f32 v84, v84, v249
    v_mfma_f32_16x16x32_bf16 v[176:179], a[0:3], v[196:199], 0
    ds_read_b128 v[216:219], v11 offset:36864
    ds_read_b128 v[220:223], v11 offset:37888
    v_mfma_f32_16x16x32_bf16 v[176:179], a[4:7], v[200:203], v[176:179]
    ds_read_b128 v[184:187], v11 offset:38912
    ds_read_b128 v[188:191], v11 offset:39936
    v_mfma_f32_16x16x32_bf16 v[176:179], a[8:11], v[204:207], v[176:179]
    ds_read_b128 v[192:195], v11 offset:40960
    v_mul_f32 v85, v85, v249
    v_mfma_f32_16x16x32_bf16 v[176:179], a[12:15], v[208:211], v[176:179]
    buffer_load_dwordx4 a[180:183], v3, s[4:7], s30 offen sc1
    v_mfma_f32_16x16x32_bf16 v[176:179], a[16:19], v[212:215], v[176:179]
    s_add_u32 m0, s26, 82944
    v_rcp_f32 v240, v240
    v_fma_f32 v242, -v84, v84, s29
    v_mfma_f32_16x16x32_bf16 v[36:39], a[20:23], v[196:199], 0
    s_add_u32 s31, s47, 9216
    v_rcp_f32 v241, v241
    v_mfma_f32_16x16x32_bf16 v[36:39], a[24:27], v[200:203], v[36:39]
    buffer_load_dwordx4 v3, s[4:7], s31 offen sc1 lds
    v_mfma_f32_16x16x32_bf16 v[36:39], a[28:31], v[204:207], v[36:39]
    v_mul_f32 v240, v82, v240
    v_mul_f32 v241, v83, v241
    v_mfma_f32_16x16x32_bf16 v[36:39], a[32:35], v[208:211], v[36:39]
    s_add_u32 s30, s24, 892928
    v_cvt_pk_bf16_f32 v166, v240, v241
    v_fma_f32 v243, -v85, v85, s29
    v_mfma_f32_16x16x32_bf16 v[36:39], a[36:39], v[212:215], v[36:39]
    v_mul_f32 v242, v242, v84
    v_mul_f32 v243, v243, v85
    v_mfma_f32_16x16x32_bf16 v[180:183], a[40:43], v[196:199], 0
    buffer_load_dwordx4 a[184:187], v3, s[4:7], s30 offen sc1
    v_mfma_f32_16x16x32_bf16 v[180:183], a[44:47], v[200:203], v[180:183]
    s_add_u32 m0, s26, 92160
    v_exp_f32 v242, v242
    v_mul_f32 v86, v84, v86
    v_mfma_f32_16x16x32_bf16 v[180:183], a[48:51], v[204:207], v[180:183]
    s_add_u32 s31, s47, 18432
    v_exp_f32 v243, v243
    v_mfma_f32_16x16x32_bf16 v[180:183], a[52:55], v[208:211], v[180:183]
    v_mul_f32 v87, v85, v87
    v_add_f32 v242, 1.0, v242
    v_mfma_f32_16x16x32_bf16 v[180:183], a[56:59], v[212:215], v[180:183]
    buffer_load_dwordx4 v3, s[4:7], s31 offen sc1 lds
    v_mfma_f32_16x16x32_bf16 v[40:43], a[60:63], v[196:199], 0
    v_add_f32 v243, 1.0, v243
    v_mul_f32 v88, v88, v250
    v_mfma_f32_16x16x32_bf16 v[40:43], a[64:67], v[200:203], v[40:43]
    s_add_u32 s30, s24, 897024
    v_rcp_f32 v242, v242
    v_mfma_f32_16x16x32_bf16 v[40:43], a[68:71], v[204:207], v[40:43]
    v_rcp_f32 v243, v243
    v_mfma_f32_16x16x32_bf16 v[40:43], a[72:75], v[208:211], v[40:43]
    buffer_load_dwordx4 a[188:191], v3, s[4:7], s30 offen sc1
    v_mul_f32 v242, v86, v242
    v_mfma_f32_16x16x32_bf16 v[40:43], a[76:79], v[212:215], v[40:43]
    s_waitcnt lgkmcnt(0)
    v_mul_f32 v243, v87, v243
    v_mul_f32 v89, v89, v250
    v_mfma_f32_16x16x32_bf16 v[148:151], a[0:3], v[216:219], 0
    s_add_u32 m0, s26, 101376
    ds_read_b128 v[224:227], v14 offset:36864
    ds_read_b128 v[228:231], v14 offset:37888
    v_mfma_f32_16x16x32_bf16 v[148:151], a[4:7], v[220:223], v[148:151]
    s_add_u32 s31, s47, 27648
    ds_read_b128 v[196:199], v14 offset:38912
    ds_read_b128 v[200:203], v14 offset:39936
    v_mfma_f32_16x16x32_bf16 v[148:151], a[8:11], v[184:187], v[148:151]
    ds_read_b128 v[204:207], v14 offset:40960
    v_cvt_pk_bf16_f32 v167, v242, v243
    v_mfma_f32_16x16x32_bf16 v[148:151], a[12:15], v[188:191], v[148:151]
    buffer_load_dwordx4 v3, s[4:7], s31 offen sc1 lds
    v_mfma_f32_16x16x32_bf16 v[148:151], a[16:19], v[192:195], v[148:151]
    ds_write_b128 v9, v[164:167] offset:46080
    v_mfma_f32_16x16x32_bf16 v[44:47], a[20:23], v[216:219], 0
    s_add_u32 s30, s24, 901120
    v_fma_f32 v232, -v88, v88, s29
    v_fma_f32 v233, -v89, v89, s29
    v_mul_f32 v90, v88, v90
    v_mfma_f32_16x16x32_bf16 v[44:47], a[24:27], v[220:223], v[44:47]
    v_mul_f32 v232, v232, v88
    v_mul_f32 v233, v233, v89
    v_mfma_f32_16x16x32_bf16 v[44:47], a[28:31], v[184:187], v[44:47]
    buffer_load_dwordx4 a[192:195], v3, s[4:7], s30 offen sc1
    v_mfma_f32_16x16x32_bf16 v[44:47], a[32:35], v[188:191], v[44:47]
    s_add_u32 m0, s34, 73728
    v_exp_f32 v232, v232
    v_mfma_f32_16x16x32_bf16 v[44:47], a[36:39], v[192:195], v[44:47]
    s_add_u32 s31, s47, 0
    v_exp_f32 v233, v233
    v_mfma_f32_16x16x32_bf16 v[48:51], a[40:43], v[216:219], 0
    buffer_store_dwordx4 v[164:167], v9, s[4:7], s62 offen sc1
    v_mfma_f32_16x16x32_bf16 v[48:51], a[44:47], v[220:223], v[48:51]
    v_mul_f32 v91, v89, v91
    v_add_f32 v232, 1.0, v232
    v_mfma_f32_16x16x32_bf16 v[48:51], a[48:51], v[184:187], v[48:51]
    v_add_f32 v233, 1.0, v233
    v_rcp_f32 v232, v232
    v_mfma_f32_16x16x32_bf16 v[48:51], a[52:55], v[188:191], v[48:51]
    v_rcp_f32 v233, v233
    v_mfma_f32_16x16x32_bf16 v[48:51], a[56:59], v[192:195], v[48:51]
    v_mul_f32 v232, v90, v232
    v_mul_f32 v233, v91, v233
    v_mfma_f32_16x16x32_bf16 v[152:155], a[60:63], v[216:219], 0
    v_cvt_pk_bf16_f32 v169, v232, v233
    v_mul_f32 v92, v92, v250
    v_mfma_f32_16x16x32_bf16 v[152:155], a[64:67], v[220:223], v[152:155]
    v_mul_f32 v93, v93, v250
    v_fma_f32 v234, -v92, v92, s29
    v_mfma_f32_16x16x32_bf16 v[152:155], a[68:71], v[184:187], v[152:155]
    buffer_load_dwordx4 v253, s[4:7], s31 offen sc1 lds
    v_mfma_f32_16x16x32_bf16 v[152:155], a[72:75], v[188:191], v[152:155]
    s_add_u32 s30, s24, 905216
    v_fma_f32 v235, -v93, v93, s29
    v_mul_f32 v234, v234, v92
    v_mfma_f32_16x16x32_bf16 v[152:155], a[76:79], v[192:195], v[152:155]
    buffer_load_dwordx4 a[196:199], v3, s[4:7], s30 offen sc1
    v_mul_f32 v235, v235, v93
    v_mfma_f32_16x16x32_bf16 v[52:55], a[80:83], v[216:219], 0
    v_exp_f32 v234, v234
    v_mfma_f32_16x16x32_bf16 v[52:55], a[84:87], v[220:223], v[52:55]
    s_add_u32 m0, s34, 110592
    v_exp_f32 v235, v235
    v_mfma_f32_16x16x32_bf16 v[52:55], a[88:91], v[184:187], v[52:55]
    s_add_u32 s31, s47, 36864
    v_mul_f32 v94, v92, v94
    v_mul_f32 v95, v93, v95
    v_mfma_f32_16x16x32_bf16 v[52:55], a[92:95], v[188:191], v[52:55]
    v_add_f32 v234, 1.0, v234
    v_add_f32 v235, 1.0, v235
    v_mfma_f32_16x16x32_bf16 v[52:55], a[96:99], v[192:195], v[52:55]
    s_waitcnt lgkmcnt(1)
    v_rcp_f32 v234, v234
    v_mfma_f32_16x16x32_bf16 v[56:59], a[0:3], v[224:227], 0
    ds_read_b128 v[208:211], v11 offset:55296
    ds_read_b128 v[212:215], v11 offset:56320
    v_mfma_f32_16x16x32_bf16 v[56:59], a[4:7], v[228:231], v[56:59]
    ds_read_b128 v[184:187], v11 offset:57344
    ds_read_b128 v[188:191], v11 offset:58368
    v_mul_f32 v234, v94, v234
    v_mfma_f32_16x16x32_bf16 v[56:59], a[8:11], v[196:199], v[56:59]
    ds_read_b128 v[192:195], v11 offset:59392
    v_mul_f32 v96, v96, v250
    v_mfma_f32_16x16x32_bf16 v[56:59], a[12:15], v[200:203], v[56:59]
    buffer_load_dwordx4 v253, s[4:7], s31 offen sc1 lds
    v_mfma_f32_16x16x32_bf16 v[56:59], a[16:19], v[204:207], v[56:59]
    s_add_u32 s30, s24, 909312
    v_rcp_f32 v235, v235
    v_mfma_f32_16x16x32_bf16 v[60:63], a[20:23], v[224:227], 0
    buffer_load_dwordx4 a[200:203], v3, s[4:7], s30 offen sc1
    v_mfma_f32_16x16x32_bf16 v[60:63], a[24:27], v[228:231], v[60:63]
    v_mul_f32 v235, v95, v235
    v_mul_f32 v97, v97, v250
    v_mfma_f32_16x16x32_bf16 v[60:63], a[28:31], v[196:199], v[60:63]
    v_cvt_pk_bf16_f32 v170, v234, v235
    v_fma_f32 v236, -v96, v96, s29
    v_mfma_f32_16x16x32_bf16 v[60:63], a[32:35], v[200:203], v[60:63]
    s_add_u32 s30, s24, 913408
    v_fma_f32 v237, -v97, v97, s29
    v_mul_f32 v236, v236, v96
    v_mul_f32 v98, v96, v98
    v_mfma_f32_16x16x32_bf16 v[60:63], a[36:39], v[204:207], v[60:63]
    v_mul_f32 v237, v237, v97
    v_mul_f32 v99, v97, v99
    v_mfma_f32_16x16x32_bf16 v[64:67], a[40:43], v[224:227], 0
    buffer_load_dwordx4 a[204:207], v3, s[4:7], s30 offen sc1
    v_mfma_f32_16x16x32_bf16 v[64:67], a[44:47], v[228:231], v[64:67]
    v_exp_f32 v236, v236
    v_mfma_f32_16x16x32_bf16 v[64:67], a[48:51], v[196:199], v[64:67]
    s_add_u32 s30, s24, 917504
    v_exp_f32 v237, v237
    v_mfma_f32_16x16x32_bf16 v[64:67], a[52:55], v[200:203], v[64:67]
    v_add_f32 v236, 1.0, v236
    v_add_f32 v237, 1.0, v237
    v_mfma_f32_16x16x32_bf16 v[64:67], a[56:59], v[204:207], v[64:67]
    buffer_load_dwordx4 a[208:211], v3, s[4:7], s30 offen sc1
    v_mfma_f32_16x16x32_bf16 v[156:159], a[60:63], v[224:227], 0
    v_rcp_f32 v236, v236
    v_mul_f32 v100, v100, v251
    v_mfma_f32_16x16x32_bf16 v[156:159], a[64:67], v[228:231], v[156:159]
    s_add_u32 s30, s24, 921600
    v_rcp_f32 v237, v237
    v_mfma_f32_16x16x32_bf16 v[156:159], a[68:71], v[196:199], v[156:159]
    v_mul_f32 v236, v98, v236
    v_mul_f32 v237, v99, v237
    v_mfma_f32_16x16x32_bf16 v[156:159], a[72:75], v[200:203], v[156:159]
    buffer_load_dwordx4 a[212:215], v3, s[4:7], s30 offen sc1
    v_mfma_f32_16x16x32_bf16 v[156:159], a[76:79], v[204:207], v[156:159]
    s_waitcnt lgkmcnt(0)
    v_cvt_pk_bf16_f32 v171, v236, v237
    v_mul_f32 v101, v101, v251
    v_mfma_f32_16x16x32_bf16 v[68:71], a[0:3], v[208:211], 0
    s_add_u32 s30, s24, 925696
    ds_read_b128 v[216:219], v14 offset:55296
    ds_read_b128 v[220:223], v14 offset:56320
    v_mfma_f32_16x16x32_bf16 v[68:71], a[4:7], v[212:215], v[68:71]
    ds_read_b128 v[196:199], v14 offset:57344
    ds_read_b128 v[200:203], v14 offset:58368
    v_mfma_f32_16x16x32_bf16 v[68:71], a[8:11], v[184:187], v[68:71]
    ds_read_b128 v[204:207], v14 offset:59392
    buffer_store_dwordx4 v[168:171], v9, s[4:7], s63 offen sc1
    v_mfma_f32_16x16x32_bf16 v[68:71], a[12:15], v[188:191], v[68:71]
    ds_write_b128 v9, v[168:171] offset:55296
    v_mfma_f32_16x16x32_bf16 v[68:71], a[16:19], v[192:195], v[68:71]
    v_fma_f32 v238, -v100, v100, s29
    v_fma_f32 v239, -v101, v101, s29
    v_mfma_f32_16x16x32_bf16 v[72:75], a[20:23], v[208:211], 0
    v_mul_f32 v238, v238, v100
    v_mul_f32 v239, v239, v101
    v_mfma_f32_16x16x32_bf16 v[72:75], a[24:27], v[212:215], v[72:75]
    v_exp_f32 v238, v238
    v_mfma_f32_16x16x32_bf16 v[72:75], a[28:31], v[184:187], v[72:75]
    v_exp_f32 v239, v239
    v_mfma_f32_16x16x32_bf16 v[72:75], a[32:35], v[188:191], v[72:75]
    v_mul_f32 v102, v100, v102
    v_mul_f32 v103, v101, v103
    v_mfma_f32_16x16x32_bf16 v[72:75], a[36:39], v[192:195], v[72:75]
    v_add_f32 v238, 1.0, v238
    v_add_f32 v239, 1.0, v239
    v_mul_f32 v104, v104, v251
    v_mfma_f32_16x16x32_bf16 v[76:79], a[40:43], v[208:211], 0
    v_rcp_f32 v238, v238
    v_mfma_f32_16x16x32_bf16 v[76:79], a[44:47], v[212:215], v[76:79]
    buffer_load_dwordx4 v[160:163], v3, s[4:7], s30 offen sc1
    v_mfma_f32_16x16x32_bf16 v[76:79], a[48:51], v[184:187], v[76:79]
    v_rcp_f32 v239, v239
    v_mfma_f32_16x16x32_bf16 v[76:79], a[52:55], v[188:191], v[76:79]
    v_mul_f32 v238, v102, v238
    v_mul_f32 v239, v103, v239
    v_mfma_f32_16x16x32_bf16 v[76:79], a[56:59], v[192:195], v[76:79]
    v_cvt_pk_bf16_f32 v173, v238, v239
    v_mul_f32 v105, v105, v251
    v_mfma_f32_16x16x32_bf16 v[80:83], a[60:63], v[208:211], 0
    v_fma_f32 v240, -v104, v104, s29
    v_fma_f32 v241, -v105, v105, s29
    v_mfma_f32_16x16x32_bf16 v[80:83], a[64:67], v[212:215], v[80:83]
    v_mul_f32 v240, v240, v104
    v_mul_f32 v241, v241, v105
    v_mfma_f32_16x16x32_bf16 v[80:83], a[68:71], v[184:187], v[80:83]
    v_exp_f32 v240, v240
    v_mfma_f32_16x16x32_bf16 v[80:83], a[72:75], v[188:191], v[80:83]
    v_exp_f32 v241, v241
    v_mfma_f32_16x16x32_bf16 v[80:83], a[76:79], v[192:195], v[80:83]
    v_mul_f32 v106, v104, v106
    v_mul_f32 v107, v105, v107
    v_mfma_f32_16x16x32_bf16 v[84:87], a[80:83], v[208:211], 0
    v_add_f32 v240, 1.0, v240
    v_add_f32 v241, 1.0, v241
    v_mfma_f32_16x16x32_bf16 v[84:87], a[84:87], v[212:215], v[84:87]
    v_rcp_f32 v240, v240
    v_mfma_f32_16x16x32_bf16 v[84:87], a[88:91], v[184:187], v[84:87]
    v_rcp_f32 v241, v241
    v_mfma_f32_16x16x32_bf16 v[84:87], a[92:95], v[188:191], v[84:87]
    v_mul_f32 v240, v106, v240
    v_mul_f32 v241, v107, v241
    v_mfma_f32_16x16x32_bf16 v[84:87], a[96:99], v[192:195], v[84:87]
    s_waitcnt lgkmcnt(1)
    v_cvt_pk_bf16_f32 v174, v240, v241
    v_mul_f32 v108, v108, v251
    v_mfma_f32_16x16x32_bf16 v[88:91], a[0:3], v[216:219], 0
    s_barrier
    ds_read_b128 v[224:227], v11 offset:5120
    ds_read_b128 v[228:231], v11 offset:6144
    v_mfma_f32_16x16x32_bf16 v[88:91], a[4:7], v[220:223], v[88:91]
    ds_read_b128 v[184:187], v11 offset:7168
    ds_read_b128 v[188:191], v11 offset:8192
    v_mfma_f32_16x16x32_bf16 v[88:91], a[8:11], v[196:199], v[88:91]
    buffer_load_dword v254, off, s[4:7], s49 offset:128 sc1
    v_mfma_f32_16x16x32_bf16 v[88:91], a[12:15], v[200:203], v[88:91]
    s_add_u32 s30, s24, 929792
    v_mul_f32 v109, v109, v251
    v_fma_f32 v242, -v108, v108, s29
    v_mfma_f32_16x16x32_bf16 v[88:91], a[16:19], v[204:207], v[88:91]
    buffer_load_dwordx4 a[0:3], v3, s[4:7], s30 offen sc1
    v_mfma_f32_16x16x32_bf16 v[164:167], a[20:23], v[216:219], 0
    s_add_u32 s30, s24, 933888
    v_fma_f32 v243, -v109, v109, s29
    v_mul_f32 v242, v242, v108
    v_mfma_f32_16x16x32_bf16 v[164:167], a[24:27], v[220:223], v[164:167]
    buffer_load_dwordx4 a[4:7], v3, s[4:7], s30 offen sc1
    v_mfma_f32_16x16x32_bf16 v[164:167], a[28:31], v[196:199], v[164:167]
    v_mul_f32 v243, v243, v109
    v_mul_f32 v110, v108, v110
    v_mfma_f32_16x16x32_bf16 v[164:167], a[32:35], v[200:203], v[164:167]
    v_exp_f32 v242, v242
    v_mfma_f32_16x16x32_bf16 v[164:167], a[36:39], v[204:207], v[164:167]
    s_add_u32 s30, s24, 937984
    v_exp_f32 v243, v243
    v_mfma_f32_16x16x32_bf16 v[92:95], a[40:43], v[216:219], 0
    v_mul_f32 v111, v109, v111
    v_add_f32 v242, 1.0, v242
    v_mfma_f32_16x16x32_bf16 v[92:95], a[44:47], v[220:223], v[92:95]
    buffer_load_dwordx4 a[8:11], v3, s[4:7], s30 offen sc1
    v_mfma_f32_16x16x32_bf16 v[92:95], a[48:51], v[196:199], v[92:95]
    v_add_f32 v243, 1.0, v243
    v_mfma_f32_16x16x32_bf16 v[92:95], a[52:55], v[200:203], v[92:95]
    s_add_u32 s30, s24, 942080
    v_rcp_f32 v242, v242
    v_mfma_f32_16x16x32_bf16 v[92:95], a[56:59], v[204:207], v[92:95]
    v_rcp_f32 v243, v243
    v_mfma_f32_16x16x32_bf16 v[96:99], a[60:63], v[216:219], 0
    buffer_load_dwordx4 a[12:15], v3, s[4:7], s30 offen sc1
    v_mfma_f32_16x16x32_bf16 v[96:99], a[64:67], v[220:223], v[96:99]
    v_mul_f32 v242, v110, v242
    v_mul_f32 v243, v111, v243
    v_mfma_f32_16x16x32_bf16 v[96:99], a[68:71], v[196:199], v[96:99]
    s_add_u32 s30, s24, 946176
    v_cvt_pk_bf16_f32 v175, v242, v243
    v_mfma_f32_16x16x32_bf16 v[96:99], a[72:75], v[200:203], v[96:99]
    buffer_store_dwordx4 v[172:175], v9, s[4:7], s23 offen sc1
    v_mfma_f32_16x16x32_bf16 v[96:99], a[76:79], v[204:207], v[96:99]
    s_waitcnt lgkmcnt(0)
    v_mfma_f32_16x16x32_bf16 v[16:19], a[216:219], v[224:227], v[16:19]
    ds_read_b128 v[192:195], v14 offset:5120
    ds_read_b128 v[208:211], v14 offset:6144
    v_mfma_f32_16x16x32_bf16 v[16:19], a[220:223], v[228:231], v[16:19]
    ds_read_b128 v[212:215], v14 offset:7168
    ds_read_b128 v[196:199], v14 offset:8192
    v_mfma_f32_16x16x32_bf16 v[16:19], a[224:227], v[184:187], v[16:19]
    ds_write_b128 v9, v[172:175] offset:64512
    v_mfma_f32_16x16x32_bf16 v[16:19], a[228:231], v[188:191], v[16:19]
    v_mfma_f32_16x16x32_bf16 v[20:23], a[232:235], v[224:227], v[20:23]
    v_mfma_f32_16x16x32_bf16 v[20:23], a[236:239], v[228:231], v[20:23]
    v_mfma_f32_16x16x32_bf16 v[20:23], a[240:243], v[184:187], v[20:23]
    buffer_load_dwordx4 a[16:19], v3, s[4:7], s30 offen sc1
    v_mfma_f32_16x16x32_bf16 v[20:23], a[244:247], v[188:191], v[20:23]
    s_add_u32 s30, s24, 950272
    v_mfma_f32_16x16x32_bf16 v[24:27], a[248:251], v[224:227], v[24:27]
    buffer_load_dwordx4 a[20:23], v3, s[4:7], s30 offen sc1
    v_mfma_f32_16x16x32_bf16 v[24:27], a[252:255], v[228:231], v[24:27]
    v_mfma_f32_16x16x32_bf16 v[24:27], a[100:103], v[184:187], v[24:27]
    v_mfma_f32_16x16x32_bf16 v[24:27], a[104:107], v[188:191], v[24:27]
    s_add_u32 s30, s24, 954368
    v_mfma_f32_16x16x32_bf16 v[28:31], a[108:111], v[224:227], v[28:31]
    v_mfma_f32_16x16x32_bf16 v[28:31], a[112:115], v[228:231], v[28:31]
    buffer_load_dwordx4 a[24:27], v3, s[4:7], s30 offen sc1
    v_mfma_f32_16x16x32_bf16 v[28:31], a[116:119], v[184:187], v[28:31]
    v_mfma_f32_16x16x32_bf16 v[28:31], a[120:123], v[188:191], v[28:31]
    s_add_u32 s30, s24, 958464
    v_mfma_f32_16x16x32_bf16 v[112:115], a[124:127], v[224:227], v[112:115]
    v_mfma_f32_16x16x32_bf16 v[112:115], a[128:131], v[228:231], v[112:115]
    buffer_load_dwordx4 a[28:31], v3, s[4:7], s30 offen sc1
    v_mfma_f32_16x16x32_bf16 v[112:115], a[132:135], v[184:187], v[112:115]
    s_add_u32 m0, s26, 110592
    v_mfma_f32_16x16x32_bf16 v[112:115], a[136:139], v[188:191], v[112:115]
    s_waitcnt lgkmcnt(1)
    v_mfma_f32_16x16x32_bf16 v[116:119], a[216:219], v[192:195], v[116:119]
    s_add_u32 s31, s47, 36864
    ds_read_b128 v[200:203], v11 offset:23552
    ds_read_b128 v[204:207], v11 offset:24576
    v_mfma_f32_16x16x32_bf16 v[116:119], a[220:223], v[208:211], v[116:119]
    ds_read_b128 v[216:219], v11 offset:25600
    ds_read_b128 v[220:223], v11 offset:26624
    v_mfma_f32_16x16x32_bf16 v[116:119], a[224:227], v[212:215], v[116:119]
    buffer_load_dwordx4 v3, s[4:7], s31 offen sc1 lds
    v_mfma_f32_16x16x32_bf16 v[116:119], a[228:231], v[196:199], v[116:119]
    s_add_u32 s30, s24, 962560
    v_mfma_f32_16x16x32_bf16 v[120:123], a[232:235], v[192:195], v[120:123]
ffn1_part_pad0_8x:
    s_cbranch_execz ffn1_part_padret0
    v_mfma_f32_16x16x32_bf16 v[120:123], a[236:239], v[208:211], v[120:123]
    s_waitcnt vmcnt(10)
    v_readfirstlane_b32 s27, v254
    s_nop 0
    s_cmp_lg_u32 s27, 0
    s_cbranch_scc0 ffn1_part_slow1
ffn1_part_back1:
    v_mfma_f32_16x16x32_bf16 v[120:123], a[240:243], v[212:215], v[120:123]
    buffer_load_dwordx4 a[32:35], v3, s[4:7], s30 offen sc1
    v_mfma_f32_16x16x32_bf16 v[120:123], a[244:247], v[196:199], v[120:123]
    s_add_u32 m0, s26, 119808
    v_mfma_f32_16x16x32_bf16 v[124:127], a[248:251], v[192:195], v[124:127]
    s_add_u32 s31, s47, 46080
    v_mfma_f32_16x16x32_bf16 v[124:127], a[252:255], v[208:211], v[124:127]
    v_mfma_f32_16x16x32_bf16 v[124:127], a[100:103], v[212:215], v[124:127]
    buffer_load_dwordx4 v3, s[4:7], s31 offen sc1 lds
    v_mfma_f32_16x16x32_bf16 v[124:127], a[104:107], v[196:199], v[124:127]
    s_add_u32 m0, s26, 78848
    v_mfma_f32_16x16x32_bf16 v[128:131], a[108:111], v[192:195], v[128:131]
    s_add_u32 s31, s47, 5120
    v_mfma_f32_16x16x32_bf16 v[128:131], a[112:115], v[208:211], v[128:131]
    v_mfma_f32_16x16x32_bf16 v[128:131], a[116:119], v[212:215], v[128:131]
    buffer_load_dwordx4 v3, s[4:7], s31 offen sc1 lds
    v_mfma_f32_16x16x32_bf16 v[128:131], a[120:123], v[196:199], v[128:131]
    s_waitcnt lgkmcnt(0)
    v_mfma_f32_16x16x32_bf16 v[132:135], a[216:219], v[200:203], v[132:135]
    s_add_u32 m0, s26, 88064
    ds_read_b128 v[184:187], v14 offset:23552
    ds_read_b128 v[188:191], v14 offset:24576
    v_mfma_f32_16x16x32_bf16 v[132:135], a[220:223], v[204:207], v[132:135]
    s_add_u32 s31, s47, 14336
    ds_read_b128 v[224:227], v14 offset:25600
    ds_read_b128 v[228:231], v14 offset:26624
    v_mfma_f32_16x16x32_bf16 v[132:135], a[224:227], v[216:219], v[132:135]
    buffer_load_dwordx4 v3, s[4:7], s31 offen sc1 lds
    v_mfma_f32_16x16x32_bf16 v[132:135], a[228:231], v[220:223], v[132:135]
    s_waitcnt vmcnt(9)
    v_mfma_f32_16x16x32_bf16 v[136:139], a[232:235], v[200:203], v[136:139]
    s_add_u32 m0, s26, 129024
    v_mfma_f32_16x16x32_bf16 v[136:139], a[236:239], v[204:207], v[136:139]
    s_add_u32 s31, s47, 55296
    v_mfma_f32_16x16x32_bf16 v[136:139], a[240:243], v[216:219], v[136:139]
    buffer_store_dword v252, off, s[4:7], s48 offset:256 sc1
    v_mfma_f32_16x16x32_bf16 v[136:139], a[244:247], v[220:223], v[136:139]
    buffer_load_dwordx4 v3, s[4:7], s31 offen sc1 lds
    v_mfma_f32_16x16x32_bf16 v[140:143], a[248:251], v[200:203], v[140:143]
    s_add_u32 m0, s26, 97280
    v_mfma_f32_16x16x32_bf16 v[140:143], a[252:255], v[204:207], v[140:143]
    s_add_u32 s31, s47, 23552
    v_mfma_f32_16x16x32_bf16 v[140:143], a[100:103], v[216:219], v[140:143]
    v_mfma_f32_16x16x32_bf16 v[140:143], a[104:107], v[220:223], v[140:143]
    buffer_load_dwordx4 v3, s[4:7], s31 offen sc1 lds
    v_mfma_f32_16x16x32_bf16 v[32:35], a[108:111], v[200:203], v[32:35]
    s_add_u32 m0, s26, 138240
    v_mfma_f32_16x16x32_bf16 v[32:35], a[112:115], v[204:207], v[32:35]
    s_add_u32 s31, s47, 64512
    v_mfma_f32_16x16x32_bf16 v[32:35], a[116:119], v[216:219], v[32:35]
    v_mfma_f32_16x16x32_bf16 v[32:35], a[120:123], v[220:223], v[32:35]
    buffer_load_dwordx4 v3, s[4:7], s31 offen sc1 lds
    v_mfma_f32_16x16x32_bf16 v[144:147], a[124:127], v[200:203], v[144:147]
    v_mfma_f32_16x16x32_bf16 v[144:147], a[128:131], v[204:207], v[144:147]
    s_add_u32 m0, s26, 106496
    v_mfma_f32_16x16x32_bf16 v[144:147], a[132:135], v[216:219], v[144:147]
    s_add_u32 s31, s47, 32768
    v_mfma_f32_16x16x32_bf16 v[144:147], a[136:139], v[220:223], v[144:147]
    s_waitcnt lgkmcnt(0)
    v_mfma_f32_16x16x32_bf16 v[176:179], a[216:219], v[184:187], v[176:179]
    s_barrier
    ds_read_b128 v[192:195], v12 offset:0
    ds_read_b128 v[196:199], v12 offset:1024
    v_mfma_f32_16x16x32_bf16 v[176:179], a[220:223], v[188:191], v[176:179]
    ds_read_b128 v[208:211], v12 offset:2048
    ds_read_b128 v[212:215], v12 offset:3072
    v_mfma_f32_16x16x32_bf16 v[176:179], a[224:227], v[224:227], v[176:179]
    buffer_load_dwordx4 v3, s[4:7], s31 offen sc1 lds
    v_mfma_f32_16x16x32_bf16 v[176:179], a[228:231], v[228:231], v[176:179]
    s_add_u32 s30, s24, 966656
    v_mfma_f32_16x16x32_bf16 v[36:39], a[232:235], v[184:187], v[36:39]
    buffer_load_dwordx4 a[36:39], v3, s[4:7], s30 offen sc1
    v_mfma_f32_16x16x32_bf16 v[36:39], a[236:239], v[188:191], v[36:39]
    v_mfma_f32_16x16x32_bf16 v[36:39], a[240:243], v[224:227], v[36:39]
    v_mfma_f32_16x16x32_bf16 v[36:39], a[244:247], v[228:231], v[36:39]
    s_add_u32 s30, s24, 970752
    v_mfma_f32_16x16x32_bf16 v[180:183], a[248:251], v[184:187], v[180:183]
    v_mfma_f32_16x16x32_bf16 v[180:183], a[252:255], v[188:191], v[180:183]
    buffer_load_dwordx4 a[40:43], v3, s[4:7], s30 offen sc1
    v_mfma_f32_16x16x32_bf16 v[180:183], a[100:103], v[224:227], v[180:183]
    v_mfma_f32_16x16x32_bf16 v[180:183], a[104:107], v[228:231], v[180:183]
    s_add_u32 s30, s24, 974848
    v_mfma_f32_16x16x32_bf16 v[40:43], a[108:111], v[184:187], v[40:43]
    v_mfma_f32_16x16x32_bf16 v[40:43], a[112:115], v[188:191], v[40:43]
    buffer_load_dwordx4 a[44:47], v3, s[4:7], s30 offen sc1
    v_mfma_f32_16x16x32_bf16 v[40:43], a[116:119], v[224:227], v[40:43]
    v_mfma_f32_16x16x32_bf16 v[40:43], a[120:123], v[228:231], v[40:43]
    s_waitcnt lgkmcnt(0)
    v_mfma_f32_16x16x32_bf16 v[16:19], a[140:143], v[192:195], v[16:19]
    s_add_u32 s30, s24, 978944
    ds_read_b128 v[200:203], v15 offset:0
    ds_read_b128 v[204:207], v15 offset:1024
    v_mfma_f32_16x16x32_bf16 v[16:19], a[144:147], v[196:199], v[16:19]
    ds_read_b128 v[216:219], v15 offset:2048
    ds_read_b128 v[220:223], v15 offset:3072
    v_mfma_f32_16x16x32_bf16 v[16:19], a[148:151], v[208:211], v[16:19]
    buffer_load_dwordx4 a[48:51], v3, s[4:7], s30 offen sc1
    v_mfma_f32_16x16x32_bf16 v[16:19], a[152:155], v[212:215], v[16:19]
    s_add_u32 s30, s24, 983040
    v_mfma_f32_16x16x32_bf16 v[20:23], a[156:159], v[192:195], v[20:23]
    v_mfma_f32_16x16x32_bf16 v[20:23], a[160:163], v[196:199], v[20:23]
    buffer_load_dwordx4 a[52:55], v3, s[4:7], s30 offen sc1
    v_mfma_f32_16x16x32_bf16 v[20:23], a[164:167], v[208:211], v[20:23]
    v_mfma_f32_16x16x32_bf16 v[20:23], a[168:171], v[212:215], v[20:23]
    v_mfma_f32_16x16x32_bf16 v[24:27], a[172:175], v[192:195], v[24:27]
    s_add_u32 s30, s24, 987136
    v_mfma_f32_16x16x32_bf16 v[24:27], a[176:179], v[196:199], v[24:27]
    v_mfma_f32_16x16x32_bf16 v[24:27], a[180:183], v[208:211], v[24:27]
    buffer_load_dwordx4 a[56:59], v3, s[4:7], s30 offen sc1
    v_mfma_f32_16x16x32_bf16 v[24:27], a[184:187], v[212:215], v[24:27]
    v_mfma_f32_16x16x32_bf16 v[28:31], a[188:191], v[192:195], v[28:31]
    s_add_u32 s30, s24, 991232
    v_mfma_f32_16x16x32_bf16 v[28:31], a[192:195], v[196:199], v[28:31]
    v_mfma_f32_16x16x32_bf16 v[28:31], a[196:199], v[208:211], v[28:31]
    buffer_load_dwordx4 a[60:63], v3, s[4:7], s30 offen sc1
    v_mfma_f32_16x16x32_bf16 v[28:31], a[200:203], v[212:215], v[28:31]
    v_mfma_f32_16x16x32_bf16 v[112:115], a[204:207], v[192:195], v[112:115]
    s_add_u32 s30, s24, 995328
    v_mfma_f32_16x16x32_bf16 v[112:115], a[208:211], v[196:199], v[112:115]
    v_mfma_f32_16x16x32_bf16 v[112:115], a[212:215], v[208:211], v[112:115]
    buffer_load_dwordx4 a[64:67], v3, s[4:7], s30 offen sc1
    v_mfma_f32_16x16x32_bf16 v[112:115], v[160:163], v[212:215], v[112:115]
    s_waitcnt lgkmcnt(0)
    v_mfma_f32_16x16x32_bf16 v[116:119], a[140:143], v[200:203], v[116:119]
    ds_read_b128 v[184:187], v12 offset:18432
    ds_read_b128 v[188:191], v12 offset:19456
    v_mfma_f32_16x16x32_bf16 v[116:119], a[144:147], v[204:207], v[116:119]
    s_add_u32 s30, s24, 999424
    ds_read_b128 v[224:227], v12 offset:20480
    ds_read_b128 v[228:231], v12 offset:21504
    v_mfma_f32_16x16x32_bf16 v[116:119], a[148:151], v[216:219], v[116:119]
    v_mfma_f32_16x16x32_bf16 v[116:119], a[152:155], v[220:223], v[116:119]
    buffer_load_dwordx4 a[68:71], v3, s[4:7], s30 offen sc1
    v_mfma_f32_16x16x32_bf16 v[120:123], a[156:159], v[200:203], v[120:123]
    v_mfma_f32_16x16x32_bf16 v[120:123], a[160:163], v[204:207], v[120:123]
    s_add_u32 s30, s24, 1003520
    v_mfma_f32_16x16x32_bf16 v[120:123], a[164:167], v[216:219], v[120:123]
    v_mfma_f32_16x16x32_bf16 v[120:123], a[168:171], v[220:223], v[120:123]
    buffer_load_dwordx4 a[72:75], v3, s[4:7], s30 offen sc1
    v_mfma_f32_16x16x32_bf16 v[124:127], a[172:175], v[200:203], v[124:127]
    v_mfma_f32_16x16x32_bf16 v[124:127], a[176:179], v[204:207], v[124:127]
    s_add_u32 s30, s24, 1007616
    v_mfma_f32_16x16x32_bf16 v[124:127], a[180:183], v[216:219], v[124:127]
    v_mfma_f32_16x16x32_bf16 v[124:127], a[184:187], v[220:223], v[124:127]
    buffer_load_dwordx4 a[76:79], v3, s[4:7], s30 offen sc1
    v_mfma_f32_16x16x32_bf16 v[128:131], a[188:191], v[200:203], v[128:131]
    v_mfma_f32_16x16x32_bf16 v[128:131], a[192:195], v[204:207], v[128:131]
    v_mfma_f32_16x16x32_bf16 v[128:131], a[196:199], v[216:219], v[128:131]
    s_add_u32 s30, s24, 1011712
    v_mfma_f32_16x16x32_bf16 v[128:131], a[200:203], v[220:223], v[128:131]
    s_waitcnt lgkmcnt(0)
    v_mfma_f32_16x16x32_bf16 v[132:135], a[140:143], v[184:187], v[132:135]
    ds_read_b128 v[192:195], v15 offset:18432
    ds_read_b128 v[196:199], v15 offset:19456
    v_mfma_f32_16x16x32_bf16 v[132:135], a[144:147], v[188:191], v[132:135]
    ds_read_b128 v[208:211], v15 offset:20480
    ds_read_b128 v[212:215], v15 offset:21504
    v_mfma_f32_16x16x32_bf16 v[132:135], a[148:151], v[224:227], v[132:135]
    buffer_load_dwordx4 a[80:83], v3, s[4:7], s30 offen sc1
    v_mfma_f32_16x16x32_bf16 v[132:135], a[152:155], v[228:231], v[132:135]
    v_mfma_f32_16x16x32_bf16 v[136:139], a[156:159], v[184:187], v[136:139]
    buffer_load_dword v254, off, s[4:7], s49 offset:256 sc1
    v_mfma_f32_16x16x32_bf16 v[136:139], a[160:163], v[188:191], v[136:139]
    s_add_u32 s30, s24, 1015808
    v_mfma_f32_16x16x32_bf16 v[136:139], a[164:167], v[224:227], v[136:139]
    buffer_load_dwordx4 a[84:87], v3, s[4:7], s30 offen sc1
    v_mfma_f32_16x16x32_bf16 v[136:139], a[168:171], v[228:231], v[136:139]
    v_mfma_f32_16x16x32_bf16 v[140:143], a[172:175], v[184:187], v[140:143]
    s_add_u32 s30, s24, 1019904
    v_mfma_f32_16x16x32_bf16 v[140:143], a[176:179], v[188:191], v[140:143]
    v_mfma_f32_16x16x32_bf16 v[140:143], a[180:183], v[224:227], v[140:143]
    buffer_load_dwordx4 a[88:91], v3, s[4:7], s30 offen sc1
    v_mfma_f32_16x16x32_bf16 v[140:143], a[184:187], v[228:231], v[140:143]
    v_mfma_f32_16x16x32_bf16 v[32:35], a[188:191], v[184:187], v[32:35]
    s_add_u32 s30, s24, 1024000
    v_mfma_f32_16x16x32_bf16 v[32:35], a[192:195], v[188:191], v[32:35]
    v_mfma_f32_16x16x32_bf16 v[32:35], a[196:199], v[224:227], v[32:35]
    buffer_load_dwordx4 a[92:95], v3, s[4:7], s30 offen sc1
    v_mfma_f32_16x16x32_bf16 v[32:35], a[200:203], v[228:231], v[32:35]
    v_mfma_f32_16x16x32_bf16 v[144:147], a[204:207], v[184:187], v[144:147]
    s_add_u32 s30, s24, 1028096
    v_mfma_f32_16x16x32_bf16 v[144:147], a[208:211], v[188:191], v[144:147]
    v_mfma_f32_16x16x32_bf16 v[144:147], a[212:215], v[224:227], v[144:147]
    buffer_load_dwordx4 a[96:99], v3, s[4:7], s30 offen sc1
    v_mfma_f32_16x16x32_bf16 v[144:147], v[160:163], v[228:231], v[144:147]
    s_waitcnt vmcnt(17) lgkmcnt(0)
    v_mfma_f32_16x16x32_bf16 v[176:179], a[140:143], v[192:195], v[176:179]
    s_barrier
    ds_read_b128 v[200:203], v12 offset:4096
    ds_read_b128 v[204:207], v12 offset:5120
    v_mfma_f32_16x16x32_bf16 v[176:179], a[144:147], v[196:199], v[176:179]
    ds_read_b128 v[216:219], v12 offset:6144
    ds_read_b128 v[220:223], v12 offset:7168
    v_mfma_f32_16x16x32_bf16 v[176:179], a[148:151], v[208:211], v[176:179]
    ds_read_b128 v[184:187], v12 offset:8192
    v_mfma_f32_16x16x32_bf16 v[176:179], a[152:155], v[212:215], v[176:179]
    v_mfma_f32_16x16x32_bf16 v[36:39], a[156:159], v[192:195], v[36:39]
    v_mfma_f32_16x16x32_bf16 v[36:39], a[160:163], v[196:199], v[36:39]
    v_mfma_f32_16x16x32_bf16 v[36:39], a[164:167], v[208:211], v[36:39]
    v_mfma_f32_16x16x32_bf16 v[36:39], a[168:171], v[212:215], v[36:39]
    v_mfma_f32_16x16x32_bf16 v[180:183], a[172:175], v[192:195], v[180:183]
    v_mfma_f32_16x16x32_bf16 v[180:183], a[176:179], v[196:199], v[180:183]
    v_mfma_f32_16x16x32_bf16 v[180:183], a[180:183], v[208:211], v[180:183]
    v_mfma_f32_16x16x32_bf16 v[180:183], a[184:187], v[212:215], v[180:183]
    v_mfma_f32_16x16x32_bf16 v[40:43], a[188:191], v[192:195], v[40:43]
    v_mfma_f32_16x16x32_bf16 v[40:43], a[192:195], v[196:199], v[40:43]
    v_mfma_f32_16x16x32_bf16 v[40:43], a[196:199], v[208:211], v[40:43]
    v_mfma_f32_16x16x32_bf16 v[40:43], a[200:203], v[212:215], v[40:43]
    s_waitcnt lgkmcnt(0)
    v_mfma_f32_16x16x32_bf16 v[16:19], a[0:3], v[200:203], v[16:19]
    ds_read_b128 v[188:191], v15 offset:4096
    ds_read_b128 v[224:227], v15 offset:5120
    v_mfma_f32_16x16x32_bf16 v[16:19], a[4:7], v[204:207], v[16:19]
    ds_read_b128 v[228:231], v15 offset:6144
    ds_read_b128 v[192:195], v15 offset:7168
    v_mfma_f32_16x16x32_bf16 v[16:19], a[8:11], v[216:219], v[16:19]
    ds_read_b128 v[196:199], v15 offset:8192
    v_mfma_f32_16x16x32_bf16 v[16:19], a[12:15], v[220:223], v[16:19]
    v_mfma_f32_16x16x32_bf16 v[16:19], a[16:19], v[184:187], v[16:19]
    v_mfma_f32_16x16x32_bf16 v[20:23], a[20:23], v[200:203], v[20:23]
    v_mfma_f32_16x16x32_bf16 v[20:23], a[24:27], v[204:207], v[20:23]
    v_mfma_f32_16x16x32_bf16 v[20:23], a[28:31], v[216:219], v[20:23]
    v_mfma_f32_16x16x32_bf16 v[20:23], a[32:35], v[220:223], v[20:23]
    s_waitcnt vmcnt(8)
    v_cvt_pk_bf16_f32 v100, v16, v17
    v_cvt_pk_bf16_f32 v101, v18, v19
    v_mfma_f32_16x16x32_bf16 v[20:23], a[36:39], v[184:187], v[20:23]
    v_mfma_f32_16x16x32_bf16 v[24:27], a[40:43], v[200:203], v[24:27]
    v_mfma_f32_16x16x32_bf16 v[24:27], a[44:47], v[204:207], v[24:27]
    s_waitcnt vmcnt(4)
    v_readfirstlane_b32 s27, v254
    s_nop 0
    s_cmp_lg_u32 s27, 0
    s_cbranch_scc0 ffn1_part_slow2
ffn1_part_back2:
    v_mfma_f32_16x16x32_bf16 v[24:27], a[48:51], v[216:219], v[24:27]
    s_add_u32 m0, s26, 115712
    v_mfma_f32_16x16x32_bf16 v[24:27], a[52:55], v[220:223], v[24:27]
    s_add_u32 s31, s47, 41984
    v_cvt_pk_bf16_f32 v102, v20, v21
    v_cvt_pk_bf16_f32 v103, v22, v23
    v_mfma_f32_16x16x32_bf16 v[24:27], a[56:59], v[184:187], v[24:27]
    v_mfma_f32_16x16x32_bf16 v[28:31], a[60:63], v[200:203], v[28:31]
    buffer_load_dwordx4 v3, s[4:7], s31 offen sc1 lds
    v_mfma_f32_16x16x32_bf16 v[28:31], a[64:67], v[204:207], v[28:31]
    v_mfma_f32_16x16x32_bf16 v[28:31], a[68:71], v[216:219], v[28:31]
    s_waitcnt vmcnt(1)
    v_mfma_f32_16x16x32_bf16 v[28:31], a[72:75], v[220:223], v[28:31]
    s_add_u32 m0, s26, 124928
    v_cvt_pk_bf16_f32 v168, v24, v25
    v_cvt_pk_bf16_f32 v169, v26, v27
    v_mfma_f32_16x16x32_bf16 v[28:31], a[76:79], v[184:187], v[28:31]
    s_add_u32 s31, s47, 51200
    v_mfma_f32_16x16x32_bf16 v[112:115], a[80:83], v[200:203], v[112:115]
    v_mfma_f32_16x16x32_bf16 v[112:115], a[84:87], v[204:207], v[112:115]
    buffer_load_dwordx4 v3, s[4:7], s31 offen sc1 lds
    v_mfma_f32_16x16x32_bf16 v[112:115], a[88:91], v[216:219], v[112:115]
    v_mfma_f32_16x16x32_bf16 v[112:115], a[92:95], v[220:223], v[112:115]
    buffer_store_dwordx4 v[100:103], v6, s[4:7], s36 offen offset:0 sc1
    v_mfma_f32_16x16x32_bf16 v[112:115], a[96:99], v[184:187], v[112:115]
    s_waitcnt lgkmcnt(0)
    v_cvt_pk_bf16_f32 v170, v28, v29
    v_cvt_pk_bf16_f32 v171, v30, v31
    v_mfma_f32_16x16x32_bf16 v[116:119], a[0:3], v[188:191], v[116:119]
    s_add_u32 m0, s26, 134144
    ds_read_b128 v[208:211], v12 offset:22528
    ds_read_b128 v[212:215], v12 offset:23552
    v_mfma_f32_16x16x32_bf16 v[116:119], a[4:7], v[224:227], v[116:119]
    s_add_u32 s31, s47, 60416
    ds_read_b128 v[184:187], v12 offset:24576
    ds_read_b128 v[200:203], v12 offset:25600
    v_mfma_f32_16x16x32_bf16 v[116:119], a[8:11], v[228:231], v[116:119]
    ds_read_b128 v[204:207], v12 offset:26624
    v_mfma_f32_16x16x32_bf16 v[116:119], a[12:15], v[192:195], v[116:119]
    buffer_load_dwordx4 v3, s[4:7], s31 offen sc1 lds
    v_mfma_f32_16x16x32_bf16 v[116:119], a[16:19], v[196:199], v[116:119]
    v_cvt_pk_bf16_f32 v172, v112, v113
    v_cvt_pk_bf16_f32 v173, v114, v115
    v_mfma_f32_16x16x32_bf16 v[120:123], a[20:23], v[188:191], v[120:123]
    s_add_u32 m0, s26, 143360
    v_mfma_f32_16x16x32_bf16 v[120:123], a[24:27], v[224:227], v[120:123]
    s_add_u32 s31, s47, 69632
    v_mfma_f32_16x16x32_bf16 v[120:123], a[28:31], v[228:231], v[120:123]
    v_mfma_f32_16x16x32_bf16 v[120:123], a[32:35], v[192:195], v[120:123]
    buffer_load_dwordx4 v3, s[4:7], s31 offen sc1 lds
    v_mfma_f32_16x16x32_bf16 v[120:123], a[36:39], v[196:199], v[120:123]
    v_cvt_pk_bf16_f32 v104, v116, v117
    v_cvt_pk_bf16_f32 v105, v118, v119
    v_mfma_f32_16x16x32_bf16 v[124:127], a[40:43], v[188:191], v[124:127]
    buffer_store_dwordx4 v[168:171], v6, s[4:7], s36 offen offset:512 sc1
    v_mfma_f32_16x16x32_bf16 v[124:127], a[44:47], v[224:227], v[124:127]
    v_mfma_f32_16x16x32_bf16 v[124:127], a[48:51], v[228:231], v[124:127]
    v_mfma_f32_16x16x32_bf16 v[124:127], a[52:55], v[192:195], v[124:127]
    v_cvt_pk_bf16_f32 v106, v120, v121
    v_cvt_pk_bf16_f32 v107, v122, v123
    v_mfma_f32_16x16x32_bf16 v[124:127], a[56:59], v[196:199], v[124:127]
    buffer_store_dwordx4 v[104:107], v6, s[4:7], s37 offen offset:0 sc1
    v_mfma_f32_16x16x32_bf16 v[128:131], a[60:63], v[188:191], v[128:131]
    v_mfma_f32_16x16x32_bf16 v[128:131], a[64:67], v[224:227], v[128:131]
    v_mfma_f32_16x16x32_bf16 v[128:131], a[68:71], v[228:231], v[128:131]
    v_mfma_f32_16x16x32_bf16 v[128:131], a[72:75], v[192:195], v[128:131]
    v_cvt_pk_bf16_f32 v108, v124, v125
    v_cvt_pk_bf16_f32 v109, v126, v127
    v_mfma_f32_16x16x32_bf16 v[128:131], a[76:79], v[196:199], v[128:131]
    s_waitcnt lgkmcnt(0)
    v_mfma_f32_16x16x32_bf16 v[132:135], a[0:3], v[208:211], v[132:135]
    ds_read_b128 v[216:219], v15 offset:22528
    ds_read_b128 v[220:223], v15 offset:23552
    v_mfma_f32_16x16x32_bf16 v[132:135], a[4:7], v[212:215], v[132:135]
    ds_read_b128 v[188:191], v15 offset:24576
    ds_read_b128 v[192:195], v15 offset:25600
    v_mfma_f32_16x16x32_bf16 v[132:135], a[8:11], v[184:187], v[132:135]
    ds_read_b128 v[196:199], v15 offset:26624
    v_mfma_f32_16x16x32_bf16 v[132:135], a[12:15], v[200:203], v[132:135]
    v_cvt_pk_bf16_f32 v110, v128, v129
    v_cvt_pk_bf16_f32 v111, v130, v131
    v_mfma_f32_16x16x32_bf16 v[132:135], a[16:19], v[204:207], v[132:135]
    buffer_store_dwordx4 v[108:111], v6, s[4:7], s37 offen offset:512 sc1
    v_mfma_f32_16x16x32_bf16 v[136:139], a[20:23], v[208:211], v[136:139]
    v_mfma_f32_16x16x32_bf16 v[136:139], a[24:27], v[212:215], v[136:139]
    v_mfma_f32_16x16x32_bf16 v[136:139], a[28:31], v[184:187], v[136:139]
    v_mfma_f32_16x16x32_bf16 v[136:139], a[32:35], v[200:203], v[136:139]
    v_cvt_pk_bf16_f32 v100, v132, v133
    v_cvt_pk_bf16_f32 v101, v134, v135
    v_mfma_f32_16x16x32_bf16 v[136:139], a[36:39], v[204:207], v[136:139]
    v_mfma_f32_16x16x32_bf16 v[140:143], a[40:43], v[208:211], v[140:143]
    v_mfma_f32_16x16x32_bf16 v[140:143], a[44:47], v[212:215], v[140:143]
    v_mfma_f32_16x16x32_bf16 v[140:143], a[48:51], v[184:187], v[140:143]
    v_mfma_f32_16x16x32_bf16 v[140:143], a[52:55], v[200:203], v[140:143]
    v_cvt_pk_bf16_f32 v102, v136, v137
    v_cvt_pk_bf16_f32 v103, v138, v139
    v_mfma_f32_16x16x32_bf16 v[140:143], a[56:59], v[204:207], v[140:143]
    buffer_store_dwordx4 v[100:103], v6, s[4:7], s38 offen offset:0 sc1
    v_mfma_f32_16x16x32_bf16 v[32:35], a[60:63], v[208:211], v[32:35]
    v_mfma_f32_16x16x32_bf16 v[32:35], a[64:67], v[212:215], v[32:35]
    s_lshl_b32 s13, s22, 12
    v_mfma_f32_16x16x32_bf16 v[32:35], a[68:71], v[184:187], v[32:35]
    s_add_u32 s13, s13, 40435712
    v_mfma_f32_16x16x32_bf16 v[32:35], a[72:75], v[200:203], v[32:35]
    s_lshl_b32 s14, s22, 4
    v_cvt_pk_bf16_f32 v168, v140, v141
    v_cvt_pk_bf16_f32 v169, v142, v143
    v_mfma_f32_16x16x32_bf16 v[32:35], a[76:79], v[204:207], v[32:35]
    s_add_u32 s14, s14, s21
    v_mfma_f32_16x16x32_bf16 v[144:147], a[80:83], v[208:211], v[144:147]
    s_lshl_b32 s14, s14, 8
    v_mfma_f32_16x16x32_bf16 v[144:147], a[84:87], v[212:215], v[144:147]
    s_lshl_b32 s15, s20, 2
    v_mfma_f32_16x16x32_bf16 v[144:147], a[88:91], v[184:187], v[144:147]
    s_add_u32 s14, s14, s15
    v_mfma_f32_16x16x32_bf16 v[144:147], a[92:95], v[200:203], v[144:147]
    s_add_u32 s14, s14, 40435712
    v_cvt_pk_bf16_f32 v170, v32, v33
    v_cvt_pk_bf16_f32 v171, v34, v35
    v_mfma_f32_16x16x32_bf16 v[144:147], a[96:99], v[204:207], v[144:147]
    s_waitcnt lgkmcnt(0)
    v_mfma_f32_16x16x32_bf16 v[176:179], a[0:3], v[216:219], v[176:179]
    s_barrier
    ds_read_b128 v[224:227], v11 offset:41984
    ds_read_b128 v[228:231], v11 offset:43008
    v_mfma_f32_16x16x32_bf16 v[176:179], a[4:7], v[220:223], v[176:179]
    s_bfe_u32 s21, s2, 0x20001
    ds_read_b128 v[184:187], v11 offset:44032
    ds_read_b128 v[200:203], v11 offset:45056
    v_mfma_f32_16x16x32_bf16 v[176:179], a[8:11], v[188:191], v[176:179]
    buffer_store_dwordx4 v[168:171], v6, s[4:7], s38 offen offset:512 sc1
    v_mfma_f32_16x16x32_bf16 v[176:179], a[12:15], v[192:195], v[176:179]
    s_lshl_b32 s21, s21, 2
    v_cvt_pk_bf16_f32 v174, v144, v145
    v_cvt_pk_bf16_f32 v175, v146, v147
    v_mfma_f32_16x16x32_bf16 v[176:179], a[16:19], v[196:199], v[176:179]
    s_bfe_u32 s22, s2, 0x20003
    v_mfma_f32_16x16x32_bf16 v[36:39], a[20:23], v[216:219], v[36:39]
    s_add_u32 s21, s21, s22
    v_permlane32_swap_b32 v172, v174
    v_mfma_f32_16x16x32_bf16 v[36:39], a[24:27], v[220:223], v[36:39]
    s_and_b32 s22, s2, 1
    v_permlane32_swap_b32 v173, v175
    v_mfma_f32_16x16x32_bf16 v[36:39], a[28:31], v[188:191], v[36:39]
    s_lshl_b32 s22, s22, 3
    v_mfma_f32_16x16x32_bf16 v[36:39], a[32:35], v[192:195], v[36:39]
    buffer_store_dwordx4 v[172:175], v7, s[4:7], s36 offen sc1
    v_mfma_f32_16x16x32_bf16 v[36:39], a[36:39], v[196:199], v[36:39]
    s_lshr_b32 s15, s2, 5
    v_cvt_pk_bf16_f32 v104, v176, v177
    v_cvt_pk_bf16_f32 v105, v178, v179
    v_mfma_f32_16x16x32_bf16 v[180:183], a[40:43], v[216:219], v[180:183]
    s_add_u32 s22, s22, s15
    v_mfma_f32_16x16x32_bf16 v[180:183], a[44:47], v[220:223], v[180:183]
    s_lshl_b32 s15, s16, 12
    v_mfma_f32_16x16x32_bf16 v[180:183], a[48:51], v[188:191], v[180:183]
    s_add_u32 s15, s15, 40435712
    v_mfma_f32_16x16x32_bf16 v[180:183], a[52:55], v[192:195], v[180:183]
    s_lshl_b32 s27, s16, 4
    v_cvt_pk_bf16_f32 v106, v36, v37
    v_cvt_pk_bf16_f32 v107, v38, v39
    v_mfma_f32_16x16x32_bf16 v[180:183], a[56:59], v[196:199], v[180:183]
    s_lshr_b32 s28, s20, 1
    v_mfma_f32_16x16x32_bf16 v[40:43], a[60:63], v[216:219], v[40:43]
    s_sub_u32 s28, s27, s28
    v_mfma_f32_16x16x32_bf16 v[40:43], a[64:67], v[220:223], v[40:43]
    s_mul_i32 s44, s28, 77824
    v_mfma_f32_16x16x32_bf16 v[40:43], a[68:71], v[188:191], v[40:43]
    s_lshl_b32 s28, s17, 1
    v_mfma_f32_16x16x32_bf16 v[40:43], a[72:75], v[192:195], v[40:43]
    buffer_store_dwordx4 v[104:107], v6, s[4:7], s39 offen offset:0 sc1
    v_mfma_f32_16x16x32_bf16 v[40:43], a[76:79], v[196:199], v[40:43]
    s_waitcnt lgkmcnt(0)
    v_cvt_pk_bf16_f32 v108, v180, v181
    v_cvt_pk_bf16_f32 v109, v182, v183
    v_mfma_f32_16x16x32_bf16 v[148:151], a[216:219], v[224:227], v[148:151]
    s_and_b32 s27, s20, 1
    ds_read_b128 v[204:207], v12 offset:36864
    ds_read_b128 v[208:211], v12 offset:37888
    v_mfma_f32_16x16x32_bf16 v[148:151], a[220:223], v[228:231], v[148:151]
    s_add_u32 s28, s28, s27
    ds_read_b128 v[212:215], v12 offset:38912
    ds_read_b128 v[188:191], v12 offset:39936
    v_mfma_f32_16x16x32_bf16 v[148:151], a[224:227], v[184:187], v[148:151]
    s_mul_i32 s28, s28, 2304
    v_mfma_f32_16x16x32_bf16 v[148:151], a[228:231], v[200:203], v[148:151]
    s_add_u32 s44, s44, s28
    v_cvt_pk_bf16_f32 v110, v40, v41
    v_cvt_pk_bf16_f32 v111, v42, v43
    v_mfma_f32_16x16x32_bf16 v[44:47], a[232:235], v[224:227], v[44:47]
    s_add_u32 s44, s44, 146878464
    v_mfma_f32_16x16x32_bf16 v[44:47], a[236:239], v[228:231], v[44:47]
    s_lshl_b32 s18, 1, s17
    v_mfma_f32_16x16x32_bf16 v[44:47], a[240:243], v[184:187], v[44:47]
    s_lshl_b32 s32, s17, 8
    v_mfma_f32_16x16x32_bf16 v[44:47], a[244:247], v[200:203], v[44:47]
    s_add_u32 s32, s32, s13
    v_mfma_f32_16x16x32_bf16 v[48:51], a[248:251], v[224:227], v[48:51]
    buffer_store_dwordx4 v[108:111], v6, s[4:7], s39 offen offset:512 sc1
    v_mfma_f32_16x16x32_bf16 v[48:51], a[252:255], v[228:231], v[48:51]
    s_lshr_b32 s33, s20, 1
    v_mfma_f32_16x16x32_bf16 v[48:51], a[100:103], v[184:187], v[48:51]
    s_lshl_b32 s33, s33, 3
    v_mfma_f32_16x16x32_bf16 v[48:51], a[104:107], v[200:203], v[48:51]
    s_or_b32 s33, s33, 0x80000
    v_mfma_f32_16x16x32_bf16 v[152:155], a[108:111], v[224:227], v[152:155]
    s_mov_b32 s51, 0
    v_mfma_f32_16x16x32_bf16 v[152:155], a[112:115], v[228:231], v[152:155]
    v_lshrrev_b32 v13, 3, v0
    v_mfma_f32_16x16x32_bf16 v[152:155], a[116:119], v[184:187], v[152:155]
    v_min_u32 v13, 1, v13
    v_mfma_f32_16x16x32_bf16 v[152:155], a[120:123], v[200:203], v[152:155]
    v_lshlrev_b32 v13, 28, v13
    v_mfma_f32_16x16x32_bf16 v[52:55], a[124:127], v[224:227], v[52:55]
    v_lshl_add_u32 v13, v0, 8, v13
    v_mfma_f32_16x16x32_bf16 v[52:55], a[128:131], v[228:231], v[52:55]
    v_mov_b32 v255, s18
    v_mfma_f32_16x16x32_bf16 v[52:55], a[132:135], v[184:187], v[52:55]
    v_bfe_u32 v10, v0, 4, 2
    v_mfma_f32_16x16x32_bf16 v[52:55], a[136:139], v[200:203], v[52:55]
    s_waitcnt vmcnt(8) lgkmcnt(0)
    v_lshl_add_u32 v10, v10, 28, v1
    v_mfma_f32_16x16x32_bf16 v[148:151], a[140:143], v[204:207], v[148:151]
    s_barrier
    ds_read_b128 v[192:195], v12 offset:40960
    ds_read_b128 v[196:199], v12 offset:41984
    v_mfma_f32_16x16x32_bf16 v[148:151], a[144:147], v[208:211], v[148:151]
    ds_read_b128 v[216:219], v12 offset:43008
    ds_read_b128 v[220:223], v12 offset:44032
    v_mfma_f32_16x16x32_bf16 v[148:151], a[148:151], v[212:215], v[148:151]
    ds_read_b128 v[184:187], v12 offset:45056
    v_min_u32 v2, 1, v1
    v_mfma_f32_16x16x32_bf16 v[148:151], a[152:155], v[188:191], v[148:151]
    v_lshlrev_b32 v2, 28, v2
    v_mfma_f32_16x16x32_bf16 v[44:47], a[156:159], v[204:207], v[44:47]
    v_mov_b32 v254, 0
    v_mfma_f32_16x16x32_bf16 v[44:47], a[160:163], v[208:211], v[44:47]
    v_mfma_f32_16x16x32_bf16 v[44:47], a[164:167], v[212:215], v[44:47]
    v_mfma_f32_16x16x32_bf16 v[44:47], a[168:171], v[188:191], v[44:47]
    v_mfma_f32_16x16x32_bf16 v[48:51], a[172:175], v[204:207], v[48:51]
    v_mfma_f32_16x16x32_bf16 v[48:51], a[176:179], v[208:211], v[48:51]
    v_mfma_f32_16x16x32_bf16 v[48:51], a[180:183], v[212:215], v[48:51]
    v_mfma_f32_16x16x32_bf16 v[48:51], a[184:187], v[188:191], v[48:51]
    v_mfma_f32_16x16x32_bf16 v[152:155], a[188:191], v[204:207], v[152:155]
    v_mfma_f32_16x16x32_bf16 v[152:155], a[192:195], v[208:211], v[152:155]
    v_mfma_f32_16x16x32_bf16 v[152:155], a[196:199], v[212:215], v[152:155]
    v_mfma_f32_16x16x32_bf16 v[152:155], a[200:203], v[188:191], v[152:155]
    v_mfma_f32_16x16x32_bf16 v[52:55], a[204:207], v[204:207], v[52:55]
    v_mfma_f32_16x16x32_bf16 v[52:55], a[208:211], v[208:211], v[52:55]
    v_mfma_f32_16x16x32_bf16 v[52:55], a[212:215], v[212:215], v[52:55]
    v_mfma_f32_16x16x32_bf16 v[52:55], v[160:163], v[188:191], v[52:55]
    s_waitcnt lgkmcnt(0)
    v_mfma_f32_16x16x32_bf16 v[148:151], a[0:3], v[192:195], v[148:151]
    ds_read_b128 v[200:203], v14 offset:41984
    ds_read_b128 v[224:227], v14 offset:43008
    v_mfma_f32_16x16x32_bf16 v[148:151], a[4:7], v[196:199], v[148:151]
    ds_read_b128 v[228:231], v14 offset:44032
    ds_read_b128 v[188:191], v14 offset:45056
    v_mfma_f32_16x16x32_bf16 v[148:151], a[8:11], v[216:219], v[148:151]
    v_mfma_f32_16x16x32_bf16 v[148:151], a[12:15], v[220:223], v[148:151]
    v_mfma_f32_16x16x32_bf16 v[148:151], a[16:19], v[184:187], v[148:151]
    v_mfma_f32_16x16x32_bf16 v[44:47], a[20:23], v[192:195], v[44:47]
    v_mfma_f32_16x16x32_bf16 v[44:47], a[24:27], v[196:199], v[44:47]
    v_mfma_f32_16x16x32_bf16 v[44:47], a[28:31], v[216:219], v[44:47]
    v_mfma_f32_16x16x32_bf16 v[44:47], a[32:35], v[220:223], v[44:47]
    v_cvt_pk_bf16_f32 v100, v148, v149
    v_cvt_pk_bf16_f32 v101, v150, v151
    v_mfma_f32_16x16x32_bf16 v[44:47], a[36:39], v[184:187], v[44:47]
    v_mfma_f32_16x16x32_bf16 v[48:51], a[40:43], v[192:195], v[48:51]
    v_mfma_f32_16x16x32_bf16 v[48:51], a[44:47], v[196:199], v[48:51]
    v_mfma_f32_16x16x32_bf16 v[48:51], a[48:51], v[216:219], v[48:51]
    v_mfma_f32_16x16x32_bf16 v[48:51], a[52:55], v[220:223], v[48:51]
    v_cvt_pk_bf16_f32 v102, v44, v45
    v_cvt_pk_bf16_f32 v103, v46, v47
    v_mfma_f32_16x16x32_bf16 v[48:51], a[56:59], v[184:187], v[48:51]
    buffer_store_dwordx4 v[100:103], v6, s[4:7], s40 offen offset:0 sc1
    v_mfma_f32_16x16x32_bf16 v[152:155], a[60:63], v[192:195], v[152:155]
    v_mfma_f32_16x16x32_bf16 v[152:155], a[64:67], v[196:199], v[152:155]
    v_mfma_f32_16x16x32_bf16 v[152:155], a[68:71], v[216:219], v[152:155]
    v_mfma_f32_16x16x32_bf16 v[152:155], a[72:75], v[220:223], v[152:155]
    v_cvt_pk_bf16_f32 v168, v48, v49
    v_cvt_pk_bf16_f32 v169, v50, v51
    v_mfma_f32_16x16x32_bf16 v[152:155], a[76:79], v[184:187], v[152:155]
    v_mfma_f32_16x16x32_bf16 v[52:55], a[80:83], v[192:195], v[52:55]
    v_mfma_f32_16x16x32_bf16 v[52:55], a[84:87], v[196:199], v[52:55]
    v_mfma_f32_16x16x32_bf16 v[52:55], a[88:91], v[216:219], v[52:55]
    v_mfma_f32_16x16x32_bf16 v[52:55], a[92:95], v[220:223], v[52:55]
    v_cvt_pk_bf16_f32 v170, v152, v153
    v_cvt_pk_bf16_f32 v171, v154, v155
    v_mfma_f32_16x16x32_bf16 v[52:55], a[96:99], v[184:187], v[52:55]
    s_waitcnt lgkmcnt(0)
    v_mfma_f32_16x16x32_bf16 v[56:59], a[216:219], v[200:203], v[56:59]
    ds_read_b128 v[204:207], v15 offset:36864
    ds_read_b128 v[208:211], v15 offset:37888
    v_mfma_f32_16x16x32_bf16 v[56:59], a[220:223], v[224:227], v[56:59]
    ds_read_b128 v[212:215], v15 offset:38912
    ds_read_b128 v[184:187], v15 offset:39936
    v_mfma_f32_16x16x32_bf16 v[56:59], a[224:227], v[228:231], v[56:59]
    buffer_store_dwordx4 v[168:171], v6, s[4:7], s40 offen offset:512 sc1
    v_mfma_f32_16x16x32_bf16 v[56:59], a[228:231], v[188:191], v[56:59]
    v_cvt_pk_bf16_f32 v172, v52, v53
    v_cvt_pk_bf16_f32 v173, v54, v55
    v_mfma_f32_16x16x32_bf16 v[60:63], a[232:235], v[200:203], v[60:63]
    v_mfma_f32_16x16x32_bf16 v[60:63], a[236:239], v[224:227], v[60:63]
ffn1_part_pad0_9x:
    s_cbranch_execz ffn1_part_padret0
    v_mfma_f32_16x16x32_bf16 v[60:63], a[240:243], v[228:231], v[60:63]
    v_mfma_f32_16x16x32_bf16 v[60:63], a[244:247], v[188:191], v[60:63]
    v_mfma_f32_16x16x32_bf16 v[64:67], a[248:251], v[200:203], v[64:67]
    v_mfma_f32_16x16x32_bf16 v[64:67], a[252:255], v[224:227], v[64:67]
    v_mfma_f32_16x16x32_bf16 v[64:67], a[100:103], v[228:231], v[64:67]
    v_mfma_f32_16x16x32_bf16 v[64:67], a[104:107], v[188:191], v[64:67]
    v_mfma_f32_16x16x32_bf16 v[156:159], a[108:111], v[200:203], v[156:159]
    v_mfma_f32_16x16x32_bf16 v[156:159], a[112:115], v[224:227], v[156:159]
    s_waitcnt vmcnt(2)
    v_mfma_f32_16x16x32_bf16 v[156:159], a[116:119], v[228:231], v[156:159]
    s_barrier
    v_mfma_f32_16x16x32_bf16 v[156:159], a[120:123], v[188:191], v[156:159]
    s_waitcnt lgkmcnt(0)
    v_mfma_f32_16x16x32_bf16 v[56:59], a[140:143], v[204:207], v[56:59]
    ds_read_b128 v[192:195], v15 offset:40960
    ds_read_b128 v[196:199], v15 offset:41984
    v_mfma_f32_16x16x32_bf16 v[56:59], a[144:147], v[208:211], v[56:59]
    ds_read_b128 v[216:219], v15 offset:43008
    ds_read_b128 v[220:223], v15 offset:44032
    v_mfma_f32_16x16x32_bf16 v[56:59], a[148:151], v[212:215], v[56:59]
    ds_read_b128 v[188:191], v15 offset:45056
    v_mfma_f32_16x16x32_bf16 v[56:59], a[152:155], v[184:187], v[56:59]
    buffer_atomic_add v255, v13, s[4:7], s13 offen offset:128 sc1
    v_mfma_f32_16x16x32_bf16 v[60:63], a[156:159], v[204:207], v[60:63]
    v_mfma_f32_16x16x32_bf16 v[60:63], a[160:163], v[208:211], v[60:63]
    v_mfma_f32_16x16x32_bf16 v[60:63], a[164:167], v[212:215], v[60:63]
    v_mfma_f32_16x16x32_bf16 v[60:63], a[168:171], v[184:187], v[60:63]
    v_mfma_f32_16x16x32_bf16 v[64:67], a[172:175], v[204:207], v[64:67]
    v_mfma_f32_16x16x32_bf16 v[64:67], a[176:179], v[208:211], v[64:67]
    v_mfma_f32_16x16x32_bf16 v[64:67], a[180:183], v[212:215], v[64:67]
    buffer_atomic_add v254, v2, s[4:7], s32 offen offset:128 sc0 sc1
    v_mfma_f32_16x16x32_bf16 v[64:67], a[184:187], v[184:187], v[64:67]
    v_mfma_f32_16x16x32_bf16 v[156:159], a[188:191], v[204:207], v[156:159]
    v_mfma_f32_16x16x32_bf16 v[156:159], a[192:195], v[208:211], v[156:159]
    v_mfma_f32_16x16x32_bf16 v[156:159], a[196:199], v[212:215], v[156:159]
    v_mfma_f32_16x16x32_bf16 v[156:159], a[200:203], v[184:187], v[156:159]
    s_waitcnt lgkmcnt(0)
    v_mfma_f32_16x16x32_bf16 v[56:59], a[0:3], v[192:195], v[56:59]
    ds_read_b128 v[200:203], v11 offset:60416
    ds_read_b128 v[224:227], v11 offset:61440
    v_mfma_f32_16x16x32_bf16 v[56:59], a[4:7], v[196:199], v[56:59]
    ds_read_b128 v[228:231], v11 offset:62464
    ds_read_b128 v[184:187], v11 offset:63488
    v_mfma_f32_16x16x32_bf16 v[56:59], a[8:11], v[216:219], v[56:59]
    v_mfma_f32_16x16x32_bf16 v[56:59], a[12:15], v[220:223], v[56:59]
    v_mfma_f32_16x16x32_bf16 v[56:59], a[16:19], v[188:191], v[56:59]
    v_mfma_f32_16x16x32_bf16 v[60:63], a[20:23], v[192:195], v[60:63]
    v_mfma_f32_16x16x32_bf16 v[60:63], a[24:27], v[196:199], v[60:63]
    v_mfma_f32_16x16x32_bf16 v[60:63], a[28:31], v[216:219], v[60:63]
    v_mfma_f32_16x16x32_bf16 v[60:63], a[32:35], v[220:223], v[60:63]
    v_cvt_pk_bf16_f32 v104, v56, v57
    v_cvt_pk_bf16_f32 v105, v58, v59
    v_mfma_f32_16x16x32_bf16 v[60:63], a[36:39], v[188:191], v[60:63]
    v_mfma_f32_16x16x32_bf16 v[64:67], a[40:43], v[192:195], v[64:67]
    v_mfma_f32_16x16x32_bf16 v[64:67], a[44:47], v[196:199], v[64:67]
    v_mfma_f32_16x16x32_bf16 v[64:67], a[48:51], v[216:219], v[64:67]
    v_mfma_f32_16x16x32_bf16 v[64:67], a[52:55], v[220:223], v[64:67]
    v_cvt_pk_bf16_f32 v106, v60, v61
    v_cvt_pk_bf16_f32 v107, v62, v63
    v_mfma_f32_16x16x32_bf16 v[64:67], a[56:59], v[188:191], v[64:67]
    buffer_store_dwordx4 v[104:107], v6, s[4:7], s41 offen offset:0 sc1
    v_mfma_f32_16x16x32_bf16 v[156:159], a[60:63], v[192:195], v[156:159]
    v_mfma_f32_16x16x32_bf16 v[156:159], a[64:67], v[196:199], v[156:159]
    v_mfma_f32_16x16x32_bf16 v[156:159], a[68:71], v[216:219], v[156:159]
    v_mfma_f32_16x16x32_bf16 v[156:159], a[72:75], v[220:223], v[156:159]
    v_cvt_pk_bf16_f32 v108, v64, v65
    v_cvt_pk_bf16_f32 v109, v66, v67
    v_mfma_f32_16x16x32_bf16 v[156:159], a[76:79], v[188:191], v[156:159]
    s_waitcnt lgkmcnt(0)
    v_mfma_f32_16x16x32_bf16 v[68:71], a[216:219], v[200:203], v[68:71]
    ds_read_b128 v[204:207], v12 offset:55296
    ds_read_b128 v[208:211], v12 offset:56320
    v_mfma_f32_16x16x32_bf16 v[68:71], a[220:223], v[224:227], v[68:71]
    ds_read_b128 v[212:215], v12 offset:57344
    ds_read_b128 v[188:191], v12 offset:58368
    v_mfma_f32_16x16x32_bf16 v[68:71], a[224:227], v[228:231], v[68:71]
    v_mfma_f32_16x16x32_bf16 v[68:71], a[228:231], v[184:187], v[68:71]
    v_cvt_pk_bf16_f32 v110, v156, v157
    v_cvt_pk_bf16_f32 v111, v158, v159
    v_mfma_f32_16x16x32_bf16 v[72:75], a[232:235], v[200:203], v[72:75]
    buffer_store_dwordx4 v[108:111], v6, s[4:7], s41 offen offset:512 sc1
    v_mfma_f32_16x16x32_bf16 v[72:75], a[236:239], v[224:227], v[72:75]
    v_mfma_f32_16x16x32_bf16 v[72:75], a[240:243], v[228:231], v[72:75]
    v_mfma_f32_16x16x32_bf16 v[72:75], a[244:247], v[184:187], v[72:75]
    v_mfma_f32_16x16x32_bf16 v[76:79], a[248:251], v[200:203], v[76:79]
    v_mfma_f32_16x16x32_bf16 v[76:79], a[252:255], v[224:227], v[76:79]
    v_mfma_f32_16x16x32_bf16 v[76:79], a[100:103], v[228:231], v[76:79]
    v_mfma_f32_16x16x32_bf16 v[76:79], a[104:107], v[184:187], v[76:79]
    v_mfma_f32_16x16x32_bf16 v[80:83], a[108:111], v[200:203], v[80:83]
    v_mfma_f32_16x16x32_bf16 v[80:83], a[112:115], v[224:227], v[80:83]
    v_mfma_f32_16x16x32_bf16 v[80:83], a[116:119], v[228:231], v[80:83]
    v_mfma_f32_16x16x32_bf16 v[80:83], a[120:123], v[184:187], v[80:83]
    v_mfma_f32_16x16x32_bf16 v[84:87], a[124:127], v[200:203], v[84:87]
    v_mfma_f32_16x16x32_bf16 v[84:87], a[128:131], v[224:227], v[84:87]
    v_mfma_f32_16x16x32_bf16 v[84:87], a[132:135], v[228:231], v[84:87]
    v_mfma_f32_16x16x32_bf16 v[84:87], a[136:139], v[184:187], v[84:87]
    s_waitcnt lgkmcnt(0)
    v_mfma_f32_16x16x32_bf16 v[68:71], a[140:143], v[204:207], v[68:71]
    ds_read_b128 v[192:195], v12 offset:59392
    ds_read_b128 v[196:199], v12 offset:60416
    v_mfma_f32_16x16x32_bf16 v[68:71], a[144:147], v[208:211], v[68:71]
    ds_read_b128 v[216:219], v12 offset:61440
    ds_read_b128 v[220:223], v12 offset:62464
    v_mfma_f32_16x16x32_bf16 v[68:71], a[148:151], v[212:215], v[68:71]
    ds_read_b128 v[184:187], v12 offset:63488
    v_mfma_f32_16x16x32_bf16 v[68:71], a[152:155], v[188:191], v[68:71]
    s_waitcnt vmcnt(2)
    v_readfirstlane_b32 s50, v254
    v_mfma_f32_16x16x32_bf16 v[72:75], a[156:159], v[204:207], v[72:75]
    v_mfma_f32_16x16x32_bf16 v[72:75], a[160:163], v[208:211], v[72:75]
    s_bfe_u32 s50, s50, s33
    v_mfma_f32_16x16x32_bf16 v[72:75], a[164:167], v[212:215], v[72:75]
    s_andn2_b32 s53, s50, s51
    v_mfma_f32_16x16x32_bf16 v[72:75], a[168:171], v[188:191], v[72:75]
    s_ff1_i32_b32 s52, s53
    v_mfma_f32_16x16x32_bf16 v[76:79], a[172:175], v[204:207], v[76:79]
    s_lshl_b32 s27, 1, s52
    v_mfma_f32_16x16x32_bf16 v[76:79], a[176:179], v[208:211], v[76:79]
    s_and_b32 s27, s27, 0xff
    v_mfma_f32_16x16x32_bf16 v[76:79], a[180:183], v[212:215], v[76:79]
    s_or_b32 s51, s51, s27
    v_mfma_f32_16x16x32_bf16 v[76:79], a[184:187], v[188:191], v[76:79]
    s_mul_i32 s52, s52, 155648
    v_mfma_f32_16x16x32_bf16 v[80:83], a[188:191], v[204:207], v[80:83]
    s_add_u32 s52, s52, s44
    v_mfma_f32_16x16x32_bf16 v[80:83], a[192:195], v[208:211], v[80:83]
    s_cmp_eq_u32 s53, 0
    s_cselect_b32 s54, 0x10000000, s52
    v_mfma_f32_16x16x32_bf16 v[80:83], a[196:199], v[212:215], v[80:83]
    buffer_load_dwordx4 v[112:115], v1, s[4:7], s54 offen offset:0 sc1
    v_mfma_f32_16x16x32_bf16 v[80:83], a[200:203], v[188:191], v[80:83]
    s_andn2_b32 s53, s50, s51
    v_mfma_f32_16x16x32_bf16 v[84:87], a[204:207], v[204:207], v[84:87]
    s_ff1_i32_b32 s52, s53
    v_mfma_f32_16x16x32_bf16 v[84:87], a[208:211], v[208:211], v[84:87]
    s_lshl_b32 s27, 1, s52
    v_mfma_f32_16x16x32_bf16 v[84:87], a[212:215], v[212:215], v[84:87]
    buffer_load_dwordx4 v[116:119], v1, s[4:7], s54 offen offset:1024 sc1
    v_mfma_f32_16x16x32_bf16 v[84:87], v[160:163], v[188:191], v[84:87]
    s_waitcnt lgkmcnt(0)
    v_mfma_f32_16x16x32_bf16 v[68:71], a[0:3], v[192:195], v[68:71]
    s_and_b32 s27, s27, 0xff
    ds_read_b128 v[200:203], v14 offset:60416
    ds_read_b128 v[224:227], v14 offset:61440
    v_mfma_f32_16x16x32_bf16 v[68:71], a[4:7], v[196:199], v[68:71]
    s_or_b32 s51, s51, s27
    ds_read_b128 v[228:231], v14 offset:62464
    ds_read_b128 v[188:191], v14 offset:63488
    v_mfma_f32_16x16x32_bf16 v[68:71], a[8:11], v[216:219], v[68:71]
    buffer_load_dwordx4 v[120:123], v10, s[4:7], s54 offen offset:2048 sc1
    v_mfma_f32_16x16x32_bf16 v[68:71], a[12:15], v[220:223], v[68:71]
    s_mul_i32 s52, s52, 155648
    v_mfma_f32_16x16x32_bf16 v[68:71], a[16:19], v[184:187], v[68:71]
    s_add_u32 s52, s52, s44
    v_mfma_f32_16x16x32_bf16 v[72:75], a[20:23], v[192:195], v[72:75]
    s_cmp_eq_u32 s53, 0
    s_cselect_b32 s54, 0x10000000, s52
    v_mfma_f32_16x16x32_bf16 v[72:75], a[24:27], v[196:199], v[72:75]
    buffer_load_dwordx4 v[124:127], v1, s[4:7], s54 offen offset:0 sc1
    v_mfma_f32_16x16x32_bf16 v[72:75], a[28:31], v[216:219], v[72:75]
    s_andn2_b32 s53, s50, s51
    v_mfma_f32_16x16x32_bf16 v[72:75], a[32:35], v[220:223], v[72:75]
    s_ff1_i32_b32 s52, s53
    v_cvt_pk_bf16_f32 v100, v68, v69
    v_cvt_pk_bf16_f32 v101, v70, v71
    v_mfma_f32_16x16x32_bf16 v[72:75], a[36:39], v[184:187], v[72:75]
    s_lshl_b32 s27, 1, s52
    v_mfma_f32_16x16x32_bf16 v[76:79], a[40:43], v[192:195], v[76:79]
    buffer_load_dwordx4 v[128:131], v1, s[4:7], s54 offen offset:1024 sc1
    v_mfma_f32_16x16x32_bf16 v[76:79], a[44:47], v[196:199], v[76:79]
    s_and_b32 s27, s27, 0xff
    v_mfma_f32_16x16x32_bf16 v[76:79], a[48:51], v[216:219], v[76:79]
    s_or_b32 s51, s51, s27
    v_mfma_f32_16x16x32_bf16 v[76:79], a[52:55], v[220:223], v[76:79]
    s_mul_i32 s52, s52, 155648
    v_cvt_pk_bf16_f32 v102, v72, v73
    v_cvt_pk_bf16_f32 v103, v74, v75
    v_mfma_f32_16x16x32_bf16 v[76:79], a[56:59], v[184:187], v[76:79]
    buffer_store_dwordx4 v[100:103], v6, s[4:7], s42 offen offset:0 sc1
    v_mfma_f32_16x16x32_bf16 v[80:83], a[60:63], v[192:195], v[80:83]
    s_add_u32 s52, s52, s44
    v_mfma_f32_16x16x32_bf16 v[80:83], a[64:67], v[196:199], v[80:83]
    v_mfma_f32_16x16x32_bf16 v[80:83], a[68:71], v[216:219], v[80:83]
    v_mfma_f32_16x16x32_bf16 v[80:83], a[72:75], v[220:223], v[80:83]
    v_cvt_pk_bf16_f32 v168, v76, v77
    v_cvt_pk_bf16_f32 v169, v78, v79
    v_mfma_f32_16x16x32_bf16 v[80:83], a[76:79], v[184:187], v[80:83]
    buffer_load_dwordx4 v[132:135], v10, s[4:7], s54 offen offset:2048 sc1
    v_mfma_f32_16x16x32_bf16 v[84:87], a[80:83], v[192:195], v[84:87]
    s_cmp_eq_u32 s53, 0
    s_cselect_b32 s54, 0x10000000, s52
    v_mfma_f32_16x16x32_bf16 v[84:87], a[84:87], v[196:199], v[84:87]
    buffer_load_dwordx4 v[136:139], v1, s[4:7], s54 offen offset:0 sc1
    v_mfma_f32_16x16x32_bf16 v[84:87], a[88:91], v[216:219], v[84:87]
    v_mfma_f32_16x16x32_bf16 v[84:87], a[92:95], v[220:223], v[84:87]
    v_cvt_pk_bf16_f32 v170, v80, v81
    v_cvt_pk_bf16_f32 v171, v82, v83
    v_mfma_f32_16x16x32_bf16 v[84:87], a[96:99], v[184:187], v[84:87]
    s_waitcnt lgkmcnt(0)
    v_mfma_f32_16x16x32_bf16 v[88:91], a[216:219], v[200:203], v[88:91]
    ds_read_b128 v[204:207], v15 offset:55296
    ds_read_b128 v[208:211], v15 offset:56320
    v_mfma_f32_16x16x32_bf16 v[88:91], a[220:223], v[224:227], v[88:91]
    ds_read_b128 v[212:215], v15 offset:57344
    ds_read_b128 v[184:187], v15 offset:58368
    v_mfma_f32_16x16x32_bf16 v[88:91], a[224:227], v[228:231], v[88:91]
    buffer_store_dwordx4 v[168:171], v6, s[4:7], s42 offen offset:512 sc1
    v_mfma_f32_16x16x32_bf16 v[88:91], a[228:231], v[188:191], v[88:91]
    v_cvt_pk_bf16_f32 v174, v84, v85
    v_cvt_pk_bf16_f32 v175, v86, v87
    v_mfma_f32_16x16x32_bf16 v[164:167], a[232:235], v[200:203], v[164:167]
    v_mfma_f32_16x16x32_bf16 v[164:167], a[236:239], v[224:227], v[164:167]
    v_permlane32_swap_b32 v172, v174
    v_mfma_f32_16x16x32_bf16 v[164:167], a[240:243], v[228:231], v[164:167]
    v_permlane32_swap_b32 v173, v175
    v_mfma_f32_16x16x32_bf16 v[164:167], a[244:247], v[188:191], v[164:167]
    v_mfma_f32_16x16x32_bf16 v[92:95], a[248:251], v[200:203], v[92:95]
    buffer_store_dwordx4 v[172:175], v7, s[4:7], s40 offen sc1
    v_mfma_f32_16x16x32_bf16 v[92:95], a[252:255], v[224:227], v[92:95]
    v_mfma_f32_16x16x32_bf16 v[92:95], a[100:103], v[228:231], v[92:95]
    v_mfma_f32_16x16x32_bf16 v[92:95], a[104:107], v[188:191], v[92:95]
    v_mfma_f32_16x16x32_bf16 v[96:99], a[108:111], v[200:203], v[96:99]
    buffer_load_dwordx4 v[140:143], v1, s[4:7], s54 offen offset:1024 sc1
    v_mfma_f32_16x16x32_bf16 v[96:99], a[112:115], v[224:227], v[96:99]
    v_mfma_f32_16x16x32_bf16 v[96:99], a[116:119], v[228:231], v[96:99]
    v_mfma_f32_16x16x32_bf16 v[96:99], a[120:123], v[188:191], v[96:99]
    s_waitcnt lgkmcnt(0)
    v_mfma_f32_16x16x32_bf16 v[88:91], a[140:143], v[204:207], v[88:91]
    ds_read_b128 v[192:195], v15 offset:59392
    ds_read_b128 v[196:199], v15 offset:60416
    v_mfma_f32_16x16x32_bf16 v[88:91], a[144:147], v[208:211], v[88:91]
    ds_read_b128 v[216:219], v15 offset:61440
    ds_read_b128 v[220:223], v15 offset:62464
    v_mfma_f32_16x16x32_bf16 v[88:91], a[148:151], v[212:215], v[88:91]
    ds_read_b128 v[188:191], v15 offset:63488
    v_mfma_f32_16x16x32_bf16 v[88:91], a[152:155], v[184:187], v[88:91]
    buffer_load_dwordx4 v[144:147], v10, s[4:7], s54 offen offset:2048 sc1
    v_mfma_f32_16x16x32_bf16 v[164:167], a[156:159], v[204:207], v[164:167]
    v_mfma_f32_16x16x32_bf16 v[164:167], a[160:163], v[208:211], v[164:167]
    v_mfma_f32_16x16x32_bf16 v[164:167], a[164:167], v[212:215], v[164:167]
    v_mfma_f32_16x16x32_bf16 v[164:167], a[168:171], v[184:187], v[164:167]
    v_mfma_f32_16x16x32_bf16 v[92:95], a[172:175], v[204:207], v[92:95]
    v_mfma_f32_16x16x32_bf16 v[92:95], a[176:179], v[208:211], v[92:95]
    v_mfma_f32_16x16x32_bf16 v[92:95], a[180:183], v[212:215], v[92:95]
    v_mfma_f32_16x16x32_bf16 v[92:95], a[184:187], v[184:187], v[92:95]
    v_mfma_f32_16x16x32_bf16 v[96:99], a[188:191], v[204:207], v[96:99]
    v_mfma_f32_16x16x32_bf16 v[96:99], a[192:195], v[208:211], v[96:99]
    v_mfma_f32_16x16x32_bf16 v[96:99], a[196:199], v[212:215], v[96:99]
    v_mfma_f32_16x16x32_bf16 v[96:99], a[200:203], v[184:187], v[96:99]
    s_waitcnt lgkmcnt(0)
    v_mfma_f32_16x16x32_bf16 v[88:91], a[0:3], v[192:195], v[88:91]
    v_mfma_f32_16x16x32_bf16 v[88:91], a[4:7], v[196:199], v[88:91]
    v_mfma_f32_16x16x32_bf16 v[88:91], a[8:11], v[216:219], v[88:91]
    v_mfma_f32_16x16x32_bf16 v[88:91], a[12:15], v[220:223], v[88:91]
    v_mfma_f32_16x16x32_bf16 v[88:91], a[16:19], v[188:191], v[88:91]
    v_mfma_f32_16x16x32_bf16 v[164:167], a[20:23], v[192:195], v[164:167]
    v_mfma_f32_16x16x32_bf16 v[164:167], a[24:27], v[196:199], v[164:167]
    v_mfma_f32_16x16x32_bf16 v[164:167], a[28:31], v[216:219], v[164:167]
    v_mfma_f32_16x16x32_bf16 v[164:167], a[32:35], v[220:223], v[164:167]
    v_cvt_pk_bf16_f32 v104, v88, v89
    v_cvt_pk_bf16_f32 v105, v90, v91
    v_mfma_f32_16x16x32_bf16 v[164:167], a[36:39], v[188:191], v[164:167]
    v_mfma_f32_16x16x32_bf16 v[92:95], a[40:43], v[192:195], v[92:95]
    v_mfma_f32_16x16x32_bf16 v[92:95], a[44:47], v[196:199], v[92:95]
    v_mfma_f32_16x16x32_bf16 v[92:95], a[48:51], v[216:219], v[92:95]
    v_mfma_f32_16x16x32_bf16 v[92:95], a[52:55], v[220:223], v[92:95]
    v_cvt_pk_bf16_f32 v106, v164, v165
    v_cvt_pk_bf16_f32 v107, v166, v167
    v_mfma_f32_16x16x32_bf16 v[92:95], a[56:59], v[188:191], v[92:95]
    buffer_store_dwordx4 v[104:107], v6, s[4:7], s43 offen offset:0 sc1
    v_mfma_f32_16x16x32_bf16 v[96:99], a[60:63], v[192:195], v[96:99]
    v_mfma_f32_16x16x32_bf16 v[96:99], a[64:67], v[196:199], v[96:99]
    v_mfma_f32_16x16x32_bf16 v[96:99], a[68:71], v[216:219], v[96:99]
    v_mfma_f32_16x16x32_bf16 v[96:99], a[72:75], v[220:223], v[96:99]
    v_cvt_pk_bf16_f32 v108, v92, v93
    v_cvt_pk_bf16_f32 v109, v94, v95
    v_mfma_f32_16x16x32_bf16 v[96:99], a[76:79], v[188:191], v[96:99]
    s_nop 7
    v_cvt_pk_bf16_f32 v110, v96, v97
    v_cvt_pk_bf16_f32 v111, v98, v99
    s_nop 1
    buffer_store_dwordx4 v[108:111], v6, s[4:7], s43 offen offset:512 sc1
    s_load_dwordx2 s[40:41], s[0:1], 56
    s_mov_b32 s42, 2359296
    s_mov_b32 s43, 0x00020000
    v_and_b32 v2, 63, v0
    v_lshlrev_b32 v1, 4, v2
    v_and_b32 v11, 15, v2
    v_lshrrev_b32 v12, 4, v2
    s_barrier
    s_mov_b32 s50, 0
    s_atomic_add s50, s[4:5], s32 offset:128 glc
    s_lshl_b32 s27, s16, 4
    s_lshr_b32 s28, s20, 1
    s_sub_u32 s28, s27, s28
    s_mul_i32 s44, s28, 77824
    s_lshl_b32 s28, s17, 1
    s_and_b32 s29, s20, 1
    s_add_u32 s28, s28, s29
    s_mul_i32 s28, s28, 2304
    s_add_u32 s44, s44, s28
    s_add_u32 s44, s44, 146878464
    s_bfe_u32 s28, s17, 0x20001
    s_lshl_b32 s28, s28, 2
    s_add_u32 s27, s27, s28
    s_lshr_b32 s28, s17, 3
    s_lshl_b32 s28, s28, 1
    s_add_u32 s27, s27, s28
    s_and_b32 s28, s17, 1
    s_add_u32 s27, s27, s28
    v_and_b32 v8, 7, v2
    v_lshlrev_b32 v9, 2, v8
    s_lshl_b32 s47, s27, 5
    s_add_u32 s28, s47, 39968768
    s_add_u32 s29, s47, 40706048
    s_add_u32 s48, s47, 20914176
    buffer_load_dword v50, v9, s[4:7], s28 offen sc1
    buffer_load_dword v51, v9, s[4:7], s29 offen sc1
    buffer_load_dword v52, v9, s[4:7], s48 offen sc1
    s_mul_i32 s28, s20, 3072
    s_add_u32 s28, s28, 147456
    v_add_u32 v53, s28, v1
    ds_read_b128 v[160:163], v53 offset:0
    ds_read_b128 v[164:167], v53 offset:1024
    ds_read_b128 v[168:171], v53 offset:2048
    v_cmp_gt_u32 vcc, 16, v2
    v_mov_b32 v7, 0x10000000
    v_lshrrev_b32 v4, 3, v2
    v_cndmask_b32 v6, v7, v1, vcc
    v_lshlrev_b32 v4, 8, v4
    v_lshl_add_u32 v4, v8, 4, v4
    v_add_u32 v5, 4096, v4
    v_cndmask_b32 v5, v7, v5, vcc
    s_lshr_b32 s45, s27, 1
    s_mul_i32 s45, s45, 18432
    s_and_b32 s28, s27, 1
    s_lshl_b32 s28, s28, 7
    s_add_u32 s45, s45, s28
    s_mul_i32 s28, s20, 4608
    s_add_u32 s45, s45, s28
    s_mul_i32 s28, s16, 4096
    s_add_u32 s45, s45, s28
    s_lshl_b32 s19, s20, 9
    s_add_u32 s19, s19, s13
    s_mov_b32 s52, 0
    s_mul_i32 s54, s20, 288
    v_and_b32 v56, 7, v2
    v_mul_u32_u24 v56, 1168, v56
    v_lshrrev_b32 v57, 3, v2
    v_lshl_add_u32 v56, v57, 4, v56
    v_add_u32 v56, s54, v56
    v_add_u32 v57, 0, v0
    v_mul_u32_u24 v58, 911, v57
    v_lshrrev_b32 v58, 16, v58
    v_add_lshl_u32 v58, v58, v57, 4
    v_add_u32 v57, 256, v0
    v_mul_u32_u24 v59, 911, v57
    v_lshrrev_b32 v59, 16, v59
    v_add_lshl_u32 v59, v59, v57, 4
    v_add_u32 v57, 512, v0
    v_mul_u32_u24 v60, 911, v57
    v_lshrrev_b32 v60, 16, v60
    v_add_lshl_u32 v60, v60, v57, 4
    v_lshlrev_b32 v61, 4, v0
    s_waitcnt lgkmcnt(0)
    s_bfe_u32 s50, s50, s33
    v_lshlrev_b32 v172, 16, v160
    v_and_b32 v173, 0xffff0000, v160
    v_lshlrev_b32 v174, 16, v161
    v_and_b32 v175, 0xffff0000, v161
    v_lshlrev_b32 v176, 16, v162
    v_and_b32 v177, 0xffff0000, v162
    v_lshlrev_b32 v178, 16, v163
    v_and_b32 v179, 0xffff0000, v163
    v_lshlrev_b32 v180, 16, v164
    v_and_b32 v181, 0xffff0000, v164
    v_lshlrev_b32 v182, 16, v165
    v_and_b32 v183, 0xffff0000, v165
    v_lshlrev_b32 v184, 16, v166
    v_and_b32 v185, 0xffff0000, v166
    v_lshlrev_b32 v186, 16, v167
    v_and_b32 v187, 0xffff0000, v167
    v_lshlrev_b32 v188, 16, v168
    v_and_b32 v189, 0xffff0000, v168
    v_lshlrev_b32 v190, 16, v169
    v_and_b32 v191, 0xffff0000, v169
    v_lshlrev_b32 v192, 16, v170
    v_and_b32 v193, 0xffff0000, v170
    v_lshlrev_b32 v194, 16, v171
    v_and_b32 v195, 0xffff0000, v171
    s_waitcnt vmcnt(3)
    s_barrier
    s_atomic_add s18, s[4:5], s19 offset:2176
    s_atomic_add s18, s[4:5], s19 offset:2432
    s_bcnt1_i32_b32 s53, s51
    s_cmp_eq_u32 s53, 1
    s_cbranch_scc1 ffn1_part_en1
    s_cmp_eq_u32 s53, 2
    s_cbranch_scc1 ffn1_part_en2
    s_cmp_eq_u32 s53, 3
    s_cbranch_scc1 ffn1_part_en3
ffn1_part_en0:
    s_andn2_b32 s53, s50, s51
    s_cbranch_scc0 ffn1_part_dp0
ffn1_part_dh0:
    s_ff1_i32_b32 s53, s53
    s_bitset1_b32 s51, s53
    s_mul_i32 s53, s53, 155648
    s_add_u32 s53, s53, s44
    buffer_load_dwordx4 v[112:115], v1, s[4:7], s53 offen offset:0 sc1
    buffer_load_dwordx4 v[116:119], v1, s[4:7], s53 offen offset:1024 sc1
    buffer_load_dwordx4 v[120:123], v6, s[4:7], s53 offen offset:2048 sc1
ffn1_part_en1:
    s_andn2_b32 s53, s50, s51
    s_cbranch_scc0 ffn1_part_dp1
ffn1_part_dh1:
    s_ff1_i32_b32 s53, s53
    s_bitset1_b32 s51, s53
    s_mul_i32 s53, s53, 155648
    s_add_u32 s53, s53, s44
    buffer_load_dwordx4 v[124:127], v1, s[4:7], s53 offen offset:0 sc1
    buffer_load_dwordx4 v[128:131], v1, s[4:7], s53 offen offset:1024 sc1
    buffer_load_dwordx4 v[132:135], v6, s[4:7], s53 offen offset:2048 sc1
ffn1_part_en2:
    s_andn2_b32 s53, s50, s51
    s_cbranch_scc0 ffn1_part_dp2
ffn1_part_dh2:
    s_ff1_i32_b32 s53, s53
    s_bitset1_b32 s51, s53
    s_mul_i32 s53, s53, 155648
    s_add_u32 s53, s53, s44
    buffer_load_dwordx4 v[136:139], v1, s[4:7], s53 offen offset:0 sc1
    buffer_load_dwordx4 v[140:143], v1, s[4:7], s53 offen offset:1024 sc1
    buffer_load_dwordx4 v[144:147], v6, s[4:7], s53 offen offset:2048 sc1
ffn1_part_en3:
    s_andn2_b32 s53, s50, s51
    s_cbranch_scc0 ffn1_part_dp3
ffn1_part_dh3:
    s_ff1_i32_b32 s53, s53
    s_bitset1_b32 s51, s53
    s_mul_i32 s53, s53, 155648
    s_add_u32 s53, s53, s44
    buffer_load_dwordx4 v[64:67], v1, s[4:7], s53 offen offset:0 sc1
    buffer_load_dwordx4 v[68:71], v1, s[4:7], s53 offen offset:1024 sc1
    buffer_load_dwordx4 v[72:75], v6, s[4:7], s53 offen offset:2048 sc1
ffn1_part_en4:
    s_andn2_b32 s53, s50, s51
    s_cbranch_scc0 ffn1_part_dp4
ffn1_part_dh4:
    s_ff1_i32_b32 s53, s53
    s_bitset1_b32 s51, s53
    s_mul_i32 s53, s53, 155648
    s_add_u32 s53, s53, s44
    buffer_load_dwordx4 v[76:79], v1, s[4:7], s53 offen offset:0 sc1
    buffer_load_dwordx4 v[80:83], v1, s[4:7], s53 offen offset:1024 sc1
    buffer_load_dwordx4 v[84:87], v6, s[4:7], s53 offen offset:2048 sc1
ffn1_part_en5:
    s_andn2_b32 s53, s50, s51
    s_cbranch_scc0 ffn1_part_dp5
ffn1_part_dh5:
    s_ff1_i32_b32 s53, s53
    s_bitset1_b32 s51, s53
    s_mul_i32 s53, s53, 155648
    s_add_u32 s53, s53, s44
    buffer_load_dwordx4 v[88:91], v1, s[4:7], s53 offen offset:0 sc1
    buffer_load_dwordx4 v[92:95], v1, s[4:7], s53 offen offset:1024 sc1
    buffer_load_dwordx4 v[96:99], v6, s[4:7], s53 offen offset:2048 sc1
    s_waitcnt vmcnt(17)
    v_lshlrev_b32 v16, 16, v112
    v_and_b32 v17, 0xffff0000, v112
    v_lshlrev_b32 v18, 16, v113
    v_and_b32 v19, 0xffff0000, v113
    v_lshlrev_b32 v20, 16, v114
    v_and_b32 v21, 0xffff0000, v114
    v_lshlrev_b32 v22, 16, v115
    v_and_b32 v23, 0xffff0000, v115
    s_waitcnt vmcnt(16)
    v_lshlrev_b32 v24, 16, v116
    v_and_b32 v25, 0xffff0000, v116
    v_lshlrev_b32 v26, 16, v117
    v_and_b32 v27, 0xffff0000, v117
    v_lshlrev_b32 v28, 16, v118
    v_and_b32 v29, 0xffff0000, v118
    v_lshlrev_b32 v30, 16, v119
    v_and_b32 v31, 0xffff0000, v119
    s_waitcnt vmcnt(15)
    v_lshlrev_b32 v32, 16, v120
    v_and_b32 v33, 0xffff0000, v120
    v_lshlrev_b32 v34, 16, v121
    v_and_b32 v35, 0xffff0000, v121
    v_lshlrev_b32 v36, 16, v122
    v_and_b32 v37, 0xffff0000, v122
    v_lshlrev_b32 v38, 16, v123
    v_and_b32 v39, 0xffff0000, v123
ffn1_part_en6:
    s_andn2_b32 s53, s50, s51
    s_cbranch_scc0 ffn1_part_dp6
ffn1_part_dh6:
    s_ff1_i32_b32 s53, s53
    s_bitset1_b32 s51, s53
    s_mul_i32 s53, s53, 155648
    s_add_u32 s53, s53, s44
    buffer_load_dwordx4 v[100:103], v1, s[4:7], s53 offen offset:0 sc1
    buffer_load_dwordx4 v[104:107], v1, s[4:7], s53 offen offset:1024 sc1
    buffer_load_dwordx4 v[108:111], v6, s[4:7], s53 offen offset:2048 sc1
    s_waitcnt vmcnt(17)
    v_lshlrev_b32 v40, 16, v124
    v_and_b32 v41, 0xffff0000, v124
    v_lshlrev_b32 v42, 16, v125
    v_and_b32 v43, 0xffff0000, v125
    v_lshlrev_b32 v44, 16, v126
    v_and_b32 v45, 0xffff0000, v126
    v_lshlrev_b32 v46, 16, v127
    v_and_b32 v47, 0xffff0000, v127
    v_pk_add_f32 v[16:17], v[16:17], v[40:41]
    v_pk_add_f32 v[18:19], v[18:19], v[42:43]
    v_pk_add_f32 v[20:21], v[20:21], v[44:45]
    v_pk_add_f32 v[22:23], v[22:23], v[46:47]
    s_waitcnt vmcnt(16)
    v_lshlrev_b32 v40, 16, v128
    v_and_b32 v41, 0xffff0000, v128
    v_lshlrev_b32 v42, 16, v129
    v_and_b32 v43, 0xffff0000, v129
    v_lshlrev_b32 v44, 16, v130
    v_and_b32 v45, 0xffff0000, v130
    v_lshlrev_b32 v46, 16, v131
    v_and_b32 v47, 0xffff0000, v131
    v_pk_add_f32 v[24:25], v[24:25], v[40:41]
    v_pk_add_f32 v[26:27], v[26:27], v[42:43]
    v_pk_add_f32 v[28:29], v[28:29], v[44:45]
    v_pk_add_f32 v[30:31], v[30:31], v[46:47]
    s_waitcnt vmcnt(15)
    v_lshlrev_b32 v40, 16, v132
    v_and_b32 v41, 0xffff0000, v132
    v_lshlrev_b32 v42, 16, v133
    v_and_b32 v43, 0xffff0000, v133
    v_lshlrev_b32 v44, 16, v134
    v_and_b32 v45, 0xffff0000, v134
    v_lshlrev_b32 v46, 16, v135
    v_and_b32 v47, 0xffff0000, v135
    v_pk_add_f32 v[32:33], v[32:33], v[40:41]
    v_pk_add_f32 v[34:35], v[34:35], v[42:43]
    v_pk_add_f32 v[36:37], v[36:37], v[44:45]
    v_pk_add_f32 v[38:39], v[38:39], v[46:47]
ffn1_part_en7:
    s_andn2_b32 s53, s50, s51
    s_cbranch_scc0 ffn1_part_dp7
ffn1_part_dh7:
    s_ff1_i32_b32 s53, s53
    s_bitset1_b32 s51, s53
    s_mul_i32 s53, s53, 155648
    s_add_u32 s53, s53, s44
    buffer_load_dwordx4 v[148:151], v1, s[4:7], s53 offen offset:0 sc1
    buffer_load_dwordx4 v[152:155], v1, s[4:7], s53 offen offset:1024 sc1
    buffer_load_dwordx4 v[156:159], v6, s[4:7], s53 offen offset:2048 sc1
    s_waitcnt vmcnt(17)
    v_lshlrev_b32 v40, 16, v136
    v_and_b32 v41, 0xffff0000, v136
    v_lshlrev_b32 v42, 16, v137
    v_and_b32 v43, 0xffff0000, v137
    v_lshlrev_b32 v44, 16, v138
    v_and_b32 v45, 0xffff0000, v138
    v_lshlrev_b32 v46, 16, v139
    v_and_b32 v47, 0xffff0000, v139
    v_pk_add_f32 v[16:17], v[16:17], v[40:41]
    v_pk_add_f32 v[18:19], v[18:19], v[42:43]
    v_pk_add_f32 v[20:21], v[20:21], v[44:45]
    v_pk_add_f32 v[22:23], v[22:23], v[46:47]
    s_waitcnt vmcnt(16)
    v_lshlrev_b32 v40, 16, v140
    v_and_b32 v41, 0xffff0000, v140
    v_lshlrev_b32 v42, 16, v141
    v_and_b32 v43, 0xffff0000, v141
    v_lshlrev_b32 v44, 16, v142
    v_and_b32 v45, 0xffff0000, v142
    v_lshlrev_b32 v46, 16, v143
    v_and_b32 v47, 0xffff0000, v143
    v_pk_add_f32 v[24:25], v[24:25], v[40:41]
    v_pk_add_f32 v[26:27], v[26:27], v[42:43]
    v_pk_add_f32 v[28:29], v[28:29], v[44:45]
    v_pk_add_f32 v[30:31], v[30:31], v[46:47]
    s_waitcnt vmcnt(15)
    v_lshlrev_b32 v40, 16, v144
    v_and_b32 v41, 0xffff0000, v144
    v_lshlrev_b32 v42, 16, v145
    v_and_b32 v43, 0xffff0000, v145
    v_lshlrev_b32 v44, 16, v146
    v_and_b32 v45, 0xffff0000, v146
    v_lshlrev_b32 v46, 16, v147
    v_and_b32 v47, 0xffff0000, v147
    v_pk_add_f32 v[32:33], v[32:33], v[40:41]
    v_pk_add_f32 v[34:35], v[34:35], v[42:43]
    v_pk_add_f32 v[36:37], v[36:37], v[44:45]
    v_pk_add_f32 v[38:39], v[38:39], v[46:47]
    s_waitcnt vmcnt(14)
    v_lshlrev_b32 v40, 16, v64
    v_and_b32 v41, 0xffff0000, v64
    v_lshlrev_b32 v42, 16, v65
    v_and_b32 v43, 0xffff0000, v65
    v_lshlrev_b32 v44, 16, v66
    v_and_b32 v45, 0xffff0000, v66
    v_lshlrev_b32 v46, 16, v67
    v_and_b32 v47, 0xffff0000, v67
    v_pk_add_f32 v[16:17], v[16:17], v[40:41]
    v_pk_add_f32 v[18:19], v[18:19], v[42:43]
    v_pk_add_f32 v[20:21], v[20:21], v[44:45]
    v_pk_add_f32 v[22:23], v[22:23], v[46:47]
    s_waitcnt vmcnt(13)
    v_lshlrev_b32 v40, 16, v68
    v_and_b32 v41, 0xffff0000, v68
    v_lshlrev_b32 v42, 16, v69
    v_and_b32 v43, 0xffff0000, v69
    v_lshlrev_b32 v44, 16, v70
    v_and_b32 v45, 0xffff0000, v70
    v_lshlrev_b32 v46, 16, v71
    v_and_b32 v47, 0xffff0000, v71
    v_pk_add_f32 v[24:25], v[24:25], v[40:41]
    v_pk_add_f32 v[26:27], v[26:27], v[42:43]
    v_pk_add_f32 v[28:29], v[28:29], v[44:45]
    v_pk_add_f32 v[30:31], v[30:31], v[46:47]
    s_waitcnt vmcnt(12)
    v_lshlrev_b32 v40, 16, v72
    v_and_b32 v41, 0xffff0000, v72
    v_lshlrev_b32 v42, 16, v73
    v_and_b32 v43, 0xffff0000, v73
    v_lshlrev_b32 v44, 16, v74
    v_and_b32 v45, 0xffff0000, v74
    v_lshlrev_b32 v46, 16, v75
    v_and_b32 v47, 0xffff0000, v75
ffn1_part_pad0_10x:
    s_cbranch_execz ffn1_part_padret0
    v_pk_add_f32 v[32:33], v[32:33], v[40:41]
    v_pk_add_f32 v[34:35], v[34:35], v[42:43]
    v_pk_add_f32 v[36:37], v[36:37], v[44:45]
    v_pk_add_f32 v[38:39], v[38:39], v[46:47]
    v_mov_b32 v54, 0x3727c5ac
    v_fmac_f32 v54, 0x3ae38e39, v50
    v_rsq_f32 v54, v54
    v_add_f32 v51, v51, v52
    v_mul_f32 v54, 0x40088e99, v54
    s_waitcnt vmcnt(11)
    v_lshlrev_b32 v40, 16, v76
    v_and_b32 v41, 0xffff0000, v76
    v_lshlrev_b32 v42, 16, v77
    v_and_b32 v43, 0xffff0000, v77
    v_lshlrev_b32 v44, 16, v78
    v_and_b32 v45, 0xffff0000, v78
    v_lshlrev_b32 v46, 16, v79
    v_and_b32 v47, 0xffff0000, v79
    v_pk_add_f32 v[16:17], v[16:17], v[40:41]
    v_pk_add_f32 v[18:19], v[18:19], v[42:43]
    v_pk_add_f32 v[20:21], v[20:21], v[44:45]
    v_pk_add_f32 v[22:23], v[22:23], v[46:47]
    s_waitcnt vmcnt(10)
    v_lshlrev_b32 v40, 16, v80
    v_and_b32 v41, 0xffff0000, v80
    v_lshlrev_b32 v42, 16, v81
    v_and_b32 v43, 0xffff0000, v81
    v_lshlrev_b32 v44, 16, v82
    v_and_b32 v45, 0xffff0000, v82
    v_lshlrev_b32 v46, 16, v83
    v_and_b32 v47, 0xffff0000, v83
    v_pk_add_f32 v[24:25], v[24:25], v[40:41]
    v_pk_add_f32 v[26:27], v[26:27], v[42:43]
    v_pk_add_f32 v[28:29], v[28:29], v[44:45]
    v_pk_add_f32 v[30:31], v[30:31], v[46:47]
    s_waitcnt vmcnt(9)
    v_lshlrev_b32 v40, 16, v84
    v_and_b32 v41, 0xffff0000, v84
    v_lshlrev_b32 v42, 16, v85
    v_and_b32 v43, 0xffff0000, v85
    v_lshlrev_b32 v44, 16, v86
    v_and_b32 v45, 0xffff0000, v86
    v_lshlrev_b32 v46, 16, v87
    v_and_b32 v47, 0xffff0000, v87
    v_pk_add_f32 v[32:33], v[32:33], v[40:41]
    v_pk_add_f32 v[34:35], v[34:35], v[42:43]
    v_pk_add_f32 v[36:37], v[36:37], v[44:45]
    v_pk_add_f32 v[38:39], v[38:39], v[46:47]
    s_waitcnt vmcnt(8)
    v_lshlrev_b32 v40, 16, v88
    v_and_b32 v41, 0xffff0000, v88
    v_lshlrev_b32 v42, 16, v89
    v_and_b32 v43, 0xffff0000, v89
    v_lshlrev_b32 v44, 16, v90
    v_and_b32 v45, 0xffff0000, v90
    v_lshlrev_b32 v46, 16, v91
    v_and_b32 v47, 0xffff0000, v91
    v_pk_add_f32 v[16:17], v[16:17], v[40:41]
    v_pk_add_f32 v[18:19], v[18:19], v[42:43]
    v_pk_add_f32 v[20:21], v[20:21], v[44:45]
    v_pk_add_f32 v[22:23], v[22:23], v[46:47]
    s_waitcnt vmcnt(7)
    v_lshlrev_b32 v40, 16, v92
    v_and_b32 v41, 0xffff0000, v92
    v_lshlrev_b32 v42, 16, v93
    v_and_b32 v43, 0xffff0000, v93
    v_lshlrev_b32 v44, 16, v94
    v_and_b32 v45, 0xffff0000, v94
    v_lshlrev_b32 v46, 16, v95
    v_and_b32 v47, 0xffff0000, v95
    v_pk_add_f32 v[24:25], v[24:25], v[40:41]
    v_pk_add_f32 v[26:27], v[26:27], v[42:43]
    v_pk_add_f32 v[28:29], v[28:29], v[44:45]
    v_pk_add_f32 v[30:31], v[30:31], v[46:47]
    s_waitcnt vmcnt(6)
    v_lshlrev_b32 v40, 16, v96
    v_and_b32 v41, 0xffff0000, v96
    v_lshlrev_b32 v42, 16, v97
    v_and_b32 v43, 0xffff0000, v97
    v_lshlrev_b32 v44, 16, v98
    v_and_b32 v45, 0xffff0000, v98
    v_lshlrev_b32 v46, 16, v99
    v_and_b32 v47, 0xffff0000, v99
    v_pk_add_f32 v[32:33], v[32:33], v[40:41]
    v_pk_add_f32 v[34:35], v[34:35], v[42:43]
    v_pk_add_f32 v[36:37], v[36:37], v[44:45]
    v_pk_add_f32 v[38:39], v[38:39], v[46:47]
    s_waitcnt vmcnt(5)
    v_lshlrev_b32 v40, 16, v100
    v_and_b32 v41, 0xffff0000, v100
    v_lshlrev_b32 v42, 16, v101
    v_and_b32 v43, 0xffff0000, v101
    v_lshlrev_b32 v44, 16, v102
    v_and_b32 v45, 0xffff0000, v102
    v_lshlrev_b32 v46, 16, v103
    v_and_b32 v47, 0xffff0000, v103
    v_pk_add_f32 v[16:17], v[16:17], v[40:41]
    v_pk_add_f32 v[18:19], v[18:19], v[42:43]
    v_pk_add_f32 v[20:21], v[20:21], v[44:45]
    v_pk_add_f32 v[22:23], v[22:23], v[46:47]
    s_waitcnt vmcnt(4)
    v_lshlrev_b32 v40, 16, v104
    v_and_b32 v41, 0xffff0000, v104
    v_lshlrev_b32 v42, 16, v105
    v_and_b32 v43, 0xffff0000, v105
    v_lshlrev_b32 v44, 16, v106
    v_and_b32 v45, 0xffff0000, v106
    v_lshlrev_b32 v46, 16, v107
    v_and_b32 v47, 0xffff0000, v107
    v_pk_add_f32 v[24:25], v[24:25], v[40:41]
    v_pk_add_f32 v[26:27], v[26:27], v[42:43]
    v_pk_add_f32 v[28:29], v[28:29], v[44:45]
    v_pk_add_f32 v[30:31], v[30:31], v[46:47]
    s_waitcnt vmcnt(3)
    v_lshlrev_b32 v40, 16, v108
    v_and_b32 v41, 0xffff0000, v108
    v_lshlrev_b32 v42, 16, v109
    v_and_b32 v43, 0xffff0000, v109
    v_lshlrev_b32 v44, 16, v110
    v_and_b32 v45, 0xffff0000, v110
    v_lshlrev_b32 v46, 16, v111
    v_and_b32 v47, 0xffff0000, v111
    v_pk_add_f32 v[32:33], v[32:33], v[40:41]
    v_pk_add_f32 v[34:35], v[34:35], v[42:43]
    v_pk_add_f32 v[36:37], v[36:37], v[44:45]
    v_pk_add_f32 v[38:39], v[38:39], v[46:47]
    s_waitcnt vmcnt(2)
    v_lshlrev_b32 v40, 16, v148
    v_and_b32 v41, 0xffff0000, v148
    v_lshlrev_b32 v42, 16, v149
    v_and_b32 v43, 0xffff0000, v149
    v_lshlrev_b32 v44, 16, v150
    v_and_b32 v45, 0xffff0000, v150
    v_lshlrev_b32 v46, 16, v151
    v_and_b32 v47, 0xffff0000, v151
    v_pk_add_f32 v[16:17], v[16:17], v[40:41]
    v_pk_add_f32 v[18:19], v[18:19], v[42:43]
    v_pk_add_f32 v[20:21], v[20:21], v[44:45]
    v_pk_add_f32 v[22:23], v[22:23], v[46:47]
    s_waitcnt vmcnt(1)
    v_lshlrev_b32 v40, 16, v152
    v_and_b32 v41, 0xffff0000, v152
    v_lshlrev_b32 v42, 16, v153
    v_and_b32 v43, 0xffff0000, v153
    v_lshlrev_b32 v44, 16, v154
    v_and_b32 v45, 0xffff0000, v154
    v_lshlrev_b32 v46, 16, v155
    v_and_b32 v47, 0xffff0000, v155
    v_pk_add_f32 v[24:25], v[24:25], v[40:41]
    v_pk_add_f32 v[26:27], v[26:27], v[42:43]
    v_pk_add_f32 v[28:29], v[28:29], v[44:45]
    v_pk_add_f32 v[30:31], v[30:31], v[46:47]
    s_waitcnt vmcnt(0)
    v_lshlrev_b32 v40, 16, v156
    v_and_b32 v41, 0xffff0000, v156
    v_lshlrev_b32 v42, 16, v157
    v_and_b32 v43, 0xffff0000, v157
    v_lshlrev_b32 v44, 16, v158
    v_and_b32 v45, 0xffff0000, v158
    v_lshlrev_b32 v46, 16, v159
    v_and_b32 v47, 0xffff0000, v159
    v_pk_add_f32 v[32:33], v[32:33], v[40:41]
    v_pk_add_f32 v[34:35], v[34:35], v[42:43]
    v_pk_add_f32 v[36:37], v[36:37], v[44:45]
    v_pk_add_f32 v[38:39], v[38:39], v[46:47]
    v_pk_fma_f32 v[16:17], v[16:17], v[54:55], v[172:173] op_sel_hi:[1,0,1]
    v_pk_fma_f32 v[18:19], v[18:19], v[54:55], v[174:175] op_sel_hi:[1,0,1]
    v_pk_fma_f32 v[20:21], v[20:21], v[54:55], v[176:177] op_sel_hi:[1,0,1]
    v_pk_fma_f32 v[22:23], v[22:23], v[54:55], v[178:179] op_sel_hi:[1,0,1]
    v_pk_fma_f32 v[24:25], v[24:25], v[54:55], v[180:181] op_sel_hi:[1,0,1]
    v_pk_fma_f32 v[26:27], v[26:27], v[54:55], v[182:183] op_sel_hi:[1,0,1]
    v_pk_fma_f32 v[28:29], v[28:29], v[54:55], v[184:185] op_sel_hi:[1,0,1]
    v_pk_fma_f32 v[30:31], v[30:31], v[54:55], v[186:187] op_sel_hi:[1,0,1]
    v_pk_fma_f32 v[32:33], v[32:33], v[54:55], v[188:189] op_sel_hi:[1,0,1]
    v_pk_fma_f32 v[34:35], v[34:35], v[54:55], v[190:191] op_sel_hi:[1,0,1]
    v_pk_fma_f32 v[36:37], v[36:37], v[54:55], v[192:193] op_sel_hi:[1,0,1]
    v_pk_fma_f32 v[38:39], v[38:39], v[54:55], v[194:195] op_sel_hi:[1,0,1]
    v_mov_b32 v50, v51
    s_mul_i32 s49, s47, 288
    v_pk_add_f32 v[16:17], v[16:17], v[50:51]
    v_pk_add_f32 v[18:19], v[18:19], v[50:51]
    v_pk_add_f32 v[20:21], v[20:21], v[50:51]
    v_pk_add_f32 v[22:23], v[22:23], v[50:51]
    v_cvt_pk_bf16_f32 v160, v16, v17
    v_cvt_pk_bf16_f32 v161, v18, v19
    v_cvt_pk_bf16_f32 v162, v20, v21
    v_cvt_pk_bf16_f32 v163, v22, v23
    ds_write_b128 v56, v[160:163] offset:0
    v_pk_add_f32 v[24:25], v[24:25], v[50:51]
    v_pk_add_f32 v[26:27], v[26:27], v[50:51]
    v_pk_add_f32 v[28:29], v[28:29], v[50:51]
    v_pk_add_f32 v[30:31], v[30:31], v[50:51]
    v_cvt_pk_bf16_f32 v164, v24, v25
    v_cvt_pk_bf16_f32 v165, v26, v27
    v_cvt_pk_bf16_f32 v166, v28, v29
    v_cvt_pk_bf16_f32 v167, v30, v31
    ds_write_b128 v56, v[164:167] offset:128
    v_pk_add_f32 v[32:33], v[32:33], v[50:51]
    v_pk_add_f32 v[34:35], v[34:35], v[50:51]
    v_pk_add_f32 v[36:37], v[36:37], v[50:51]
    v_pk_add_f32 v[38:39], v[38:39], v[50:51]
    v_cvt_pk_bf16_f32 v168, v32, v33
    v_cvt_pk_bf16_f32 v169, v34, v35
    v_cvt_pk_bf16_f32 v170, v36, v37
    v_cvt_pk_bf16_f32 v171, v38, v39
    s_mov_b64 exec, 0xffff
    ds_write_b128 v56, v[168:171] offset:256
    s_mov_b64 exec, -1
    s_waitcnt lgkmcnt(0)
    s_barrier
    ds_read_b128 v[16:19], v58
    ds_read_b128 v[20:23], v59
    ds_read_b128 v[24:27], v60
    s_waitcnt lgkmcnt(2)
    buffer_store_dwordx4 v[16:19], v61, s[40:43], s49 offen sc1
    s_add_u32 s49, s49, 4096
    s_waitcnt lgkmcnt(1)
    buffer_store_dwordx4 v[20:23], v61, s[40:43], s49 offen sc1
    s_add_u32 s49, s49, 4096
    s_cmp_lg_u32 s20, 0
    s_cbranch_scc1 ffn1_part_od
    s_waitcnt lgkmcnt(0)
    buffer_store_dwordx4 v[24:27], v61, s[40:43], s49 offen sc1
    s_add_u32 s49, s49, 4096
ffn1_part_od:
    s_endpgm
ffn1_part_slow0:
    buffer_load_dword v254, off, s[4:7], s49 offset:0 sc1
    s_waitcnt vmcnt(0)
    v_readfirstlane_b32 s27, v254
    s_add_u32 s8, s8, 1
    s_cmp_lg_u32 s27, 0
    s_cbranch_scc1 ffn1_part_back0
    s_cmp_lt_u32 s8, 0x80000
    s_cbranch_scc1 ffn1_part_slow0
    s_branch ffn1_part_back0
ffn1_part_slow1:
    buffer_load_dword v254, off, s[4:7], s49 offset:128 sc1
    s_waitcnt vmcnt(0)
    v_readfirstlane_b32 s27, v254
    s_add_u32 s8, s8, 1
    s_cmp_lg_u32 s27, 0
    s_cbranch_scc1 ffn1_part_back1
    s_cmp_lt_u32 s8, 0x80000
    s_cbranch_scc1 ffn1_part_slow1
    s_branch ffn1_part_back1
ffn1_part_slow2:
    buffer_load_dword v254, off, s[4:7], s49 offset:256 sc1
    s_waitcnt vmcnt(0)
    v_readfirstlane_b32 s27, v254
    s_add_u32 s8, s8, 1
    s_cmp_lg_u32 s27, 0
    s_cbranch_scc1 ffn1_part_back2
    s_cmp_lt_u32 s8, 0x80000
    s_cbranch_scc1 ffn1_part_slow2
    s_branch ffn1_part_back2
ffn1_part_dp0:
    s_mov_b32 s50, 0
    s_atomic_add s50, s[4:5], s32 offset:128 glc
    s_add_u32 s8, s8, 1
    s_waitcnt lgkmcnt(0)
    s_bfe_u32 s50, s50, s33
    s_andn2_b32 s53, s50, s51
    s_cbranch_scc1 ffn1_part_dh0
    s_cmp_lt_u32 s8, 0x80000
    s_cbranch_scc1 ffn1_part_dp0
    s_andn2_b32 s53, 0xff, s51
    s_branch ffn1_part_dh0
ffn1_part_dp1:
    s_mov_b32 s50, 0
    s_atomic_add s50, s[4:5], s32 offset:128 glc
    s_add_u32 s8, s8, 1
    s_waitcnt lgkmcnt(0)
    s_bfe_u32 s50, s50, s33
    s_andn2_b32 s53, s50, s51
    s_cbranch_scc1 ffn1_part_dh1
    s_cmp_lt_u32 s8, 0x80000
    s_cbranch_scc1 ffn1_part_dp1
    s_andn2_b32 s53, 0xff, s51
    s_branch ffn1_part_dh1
ffn1_part_dp2:
    s_mov_b32 s50, 0
    s_atomic_add s50, s[4:5], s32 offset:128 glc
    s_add_u32 s8, s8, 1
    s_waitcnt lgkmcnt(0)
    s_bfe_u32 s50, s50, s33
    s_andn2_b32 s53, s50, s51
    s_cbranch_scc1 ffn1_part_dh2
    s_cmp_lt_u32 s8, 0x80000
    s_cbranch_scc1 ffn1_part_dp2
    s_andn2_b32 s53, 0xff, s51
    s_branch ffn1_part_dh2
ffn1_part_dp3:
    s_mov_b32 s50, 0
    s_atomic_add s50, s[4:5], s32 offset:128 glc
    s_add_u32 s8, s8, 1
    s_waitcnt lgkmcnt(0)
    s_bfe_u32 s50, s50, s33
    s_andn2_b32 s53, s50, s51
    s_cbranch_scc1 ffn1_part_dh3
    s_cmp_lt_u32 s8, 0x80000
    s_cbranch_scc1 ffn1_part_dp3
    s_andn2_b32 s53, 0xff, s51
    s_branch ffn1_part_dh3
ffn1_part_dp4:
    s_mov_b32 s50, 0
    s_atomic_add s50, s[4:5], s32 offset:128 glc
    s_add_u32 s8, s8, 1
    s_waitcnt lgkmcnt(0)
    s_bfe_u32 s50, s50, s33
    s_andn2_b32 s53, s50, s51
    s_cbranch_scc1 ffn1_part_dh4
    s_cmp_lt_u32 s8, 0x80000
    s_cbranch_scc1 ffn1_part_dp4
    s_andn2_b32 s53, 0xff, s51
    s_branch ffn1_part_dh4
ffn1_part_dp5:
    s_mov_b32 s50, 0
    s_atomic_add s50, s[4:5], s32 offset:128 glc
    s_add_u32 s8, s8, 1
    s_waitcnt lgkmcnt(0)
    s_bfe_u32 s50, s50, s33
    s_andn2_b32 s53, s50, s51
    s_cbranch_scc1 ffn1_part_dh5
    s_cmp_lt_u32 s8, 0x80000
    s_cbranch_scc1 ffn1_part_dp5
    s_andn2_b32 s53, 0xff, s51
    s_branch ffn1_part_dh5
ffn1_part_dp6:
    s_mov_b32 s50, 0
    s_atomic_add s50, s[4:5], s32 offset:128 glc
    s_add_u32 s8, s8, 1
    s_waitcnt lgkmcnt(0)
    s_bfe_u32 s50, s50, s33
    s_andn2_b32 s53, s50, s51
    s_cbranch_scc1 ffn1_part_dh6
    s_cmp_lt_u32 s8, 0x80000
    s_cbranch_scc1 ffn1_part_dp6
    s_andn2_b32 s53, 0xff, s51
    s_branch ffn1_part_dh6
ffn1_part_dp7:
    s_mov_b32 s50, 0
    s_atomic_add s50, s[4:5], s32 offset:128 glc
    s_add_u32 s8, s8, 1
    s_waitcnt lgkmcnt(0)
    s_bfe_u32 s50, s50, s33
    s_andn2_b32 s53, s50, s51
    s_cbranch_scc1 ffn1_part_dh7
    s_cmp_lt_u32 s8, 0x80000
    s_cbranch_scc1 ffn1_part_dp7
    s_andn2_b32 s53, 0xff, s51
    s_branch ffn1_part_dh7
ffn1_part_end:
    s_endpgm
.section .rodata,"a"
.p2align 6
.amdhsa_kernel interleave_layers__linear_attn_block__glu_gated_geglu__prompt_kernel
  .amdhsa_next_free_vgpr 512
  .amdhsa_next_free_sgpr 102
  .amdhsa_accum_offset 256
  .amdhsa_group_segment_fixed_size 0
  .amdhsa_kernarg_size 80
  .amdhsa_user_sgpr_count 2
  .amdhsa_user_sgpr_kernarg_segment_ptr 1
  .amdhsa_system_sgpr_workgroup_id_x 1
  .amdhsa_float_denorm_mode_32 3
.end_amdhsa_kernel
```
